```python
import torch

def _softmax(x, axis=-1):
    return torch.softmax(x, dim=axis)
def _gelu(x):
    return torch.nn.functional.gelu(x, approximate="tanh")
def _silu(x):
    return torch.nn.functional.silu(x)
def _sigmoid(x):
    return torch.sigmoid(x)
def _layernorm(x, axis=-1, eps=1e-5):
    m = x.mean(dim=axis, keepdim=True)
    v = x.var(dim=axis, keepdim=True, unbiased=False)
    return (x - m) / torch.sqrt(v + eps)
def _scatter_add(tgt, idx, src, axis=0):
    return tgt.clone().index_add_(axis, idx, src)
def _segment_sum(src, seg, n):
    out = torch.zeros((n,) + src.shape[1:], dtype=src.dtype)
    return out.index_add_(0, seg, src)
def _pad(x, pw):
    flat = tuple(v for pair in reversed(pw) for v in pair)
    return torch.nn.functional.pad(x, flat)

kernel_name = 'standalone__sequential_behavior_din__recsys'

def setup_inputs():

    _w = (lambda a: (lambda t: t.to(torch.bfloat16) if t.is_floating_point() else t)(torch.as_tensor(a)))
    B, L, D = 16384, 200, 64
    H = D
    return {
        "target": _w((lambda *s: torch.randn(*s, dtype=torch.bfloat16) * 1.6)(B, D)),
        "hist": _w((lambda *s: torch.randn(*s, dtype=torch.bfloat16) * 1.6)(B, L, D)),
        "mask": _w((lambda lo, hi, *s: torch.randint(lo, hi, s))(0, 2, B, L).to(float)),
        "w1": _w((lambda *s: torch.randn(*s, dtype=torch.bfloat16) * 1.6)(4 * D, H) * (4 * D) ** -0.5),
        "b1": _w((lambda *s: torch.randn(*s, dtype=torch.bfloat16) * 1.6)(H) * 0.1),
        "w2": _w((lambda *s: torch.randn(*s, dtype=torch.bfloat16) * 0.05)(H, 1) * H ** -0.5),
        "b2": _w((lambda *s: torch.randn(*s, dtype=torch.bfloat16) * 0.05)(1) * 0.1),
    }

def reference(target, hist, mask, w1, b1, w2, b2):
    L = hist.shape[1]
    tgt = (lambda x, n, axis: torch.repeat_interleave(x, n, dim=axis))(target[:, None, :], L, axis=1)
    feat = torch.concatenate([hist, tgt, hist - tgt, hist * tgt], axis=-1)
    h = _sigmoid(feat @ w1 + b1)
    scores = (h @ w2 + b2)[..., 0] * mask
    return torch.einsum('bl,bld->bd', scores, hist)
```

```asm
; @launch grid=(256,1,1) block=(512,1,1) lds=163840
.amdgcn_target "amdgcn-amd-amdhsa--gfx950"
.text
.globl standalone__sequential_behavior_din__recsys_kernel
.p2align 8
.type standalone__sequential_behavior_din__recsys_kernel,@function
standalone__sequential_behavior_din__recsys_kernel:
    s_load_dwordx16 s[4:19], s[0:1], 0
    s_cmp_ge_u32 s2, 256
    s_cbranch_scc1 L_end
    v_lshrrev_b32 v1, 6, v0
    v_and_b32 v0, 63, v0
    v_readfirstlane_b32 s54, v1
    v_lshlrev_b32 v1, 3, v0
    v_mov_b32 v2, 0x80000000
    v_cmp_gt_u32 vcc, 50, v0
    s_lshl_b32 s53, s2, 3
    s_add_u32 s53, s53, s54
    s_mul_i32 s52, s54, 20480
    v_cndmask_b32 v1, v2, v1, vcc
    s_mul_i32 s93, s53, 400
    v_lshrrev_b32 v2, 3, v0
    v_lshlrev_b32 v243, 18, v2
    v_and_b32 v3, 7, v0
    v_lshl_add_u32 v243, v3, 4, v243
    s_lshl_b32 s66, s53, 7
    v_add_u32 v243, s66, v243
    s_waitcnt lgkmcnt(0)
    s_mov_b32 s24, s8
    s_and_b32 s25, s9, 0xffff
    s_mov_b32 s26, 6553600
    s_mov_b32 s27, 0x20000
    buffer_load_dwordx2 v[100:101], v1, s[24:27], s93 offen nt
    s_add_u32 s93, s93, 819200
    buffer_load_dwordx2 v[102:103], v1, s[24:27], s93 offen nt
    s_add_u32 s93, s93, 819200
    buffer_load_dwordx2 v[104:105], v1, s[24:27], s93 offen nt
    s_add_u32 s93, s93, 819200
    buffer_load_dwordx2 v[106:107], v1, s[24:27], s93 offen nt
    s_add_u32 s93, s93, 819200
    buffer_load_dwordx2 v[108:109], v1, s[24:27], s93 offen nt
    s_add_u32 s93, s93, 819200
    buffer_load_dwordx2 v[110:111], v1, s[24:27], s93 offen nt
    s_add_u32 s93, s93, 819200
    buffer_load_dwordx2 v[112:113], v1, s[24:27], s93 offen nt
    s_add_u32 s93, s93, 819200
    buffer_load_dwordx2 v[114:115], v1, s[24:27], s93 offen nt
    s_mov_b32 s28, s4
    s_and_b32 s29, s5, 0xffff
    s_mov_b32 s30, 2097152
    s_mov_b32 s31, 0x20000
    s_add_u32 m0, s52, 14560
    s_mov_b32 s32, s10
    s_and_b32 s33, s11, 0xffff
    s_mov_b32 s34, 32768
    s_mov_b32 s35, 0x20000
    buffer_load_dwordx4 v243, s[28:31], 0 offen nt lds
    v_bfe_u32 v1, v0, 4, 1
    v_lshlrev_b32 v246, 1, v1
    v_xor_b32 v246, v246, v3
    v_lshlrev_b32 v246, 4, v246
    v_lshl_add_u32 v246, v2, 7, v246
    s_lshl_b32 s66, s54, 12
    v_add_u32 v246, s66, v246
    v_xor_b32 v247, 64, v246
    s_add_u32 m0, s52, 10400
    s_mov_b32 s36, s12
    s_and_b32 s37, s13, 0xffff
    s_mov_b32 s38, 128
    s_mov_b32 s39, 0x20000
    buffer_load_dwordx4 v246, s[32:35], 0 offen offset:0 lds
    buffer_load_dwordx4 v247, s[32:35], 0 offen offset:1024 lds
    buffer_load_dwordx4 v246, s[32:35], 0 offen offset:2048 lds
    buffer_load_dwordx4 v247, s[32:35], 0 offen offset:3072 lds
    v_lshlrev_b32 v231, 2, v1
    v_xor_b32 v231, v231, v3
    v_lshlrev_b32 v231, 4, v231
    v_mov_b32 v233, v231
    v_lshrrev_b32 v1, 4, v0
    v_lshlrev_b32 v248, 3, v1
    s_mov_b32 s40, s14
    s_and_b32 s41, s15, 0xffff
    s_mov_b32 s42, 128
    s_mov_b32 s43, 0x20000
    s_mov_b32 s44, s16
    s_and_b32 s45, s17, 0xffff
    s_mov_b32 s46, 2
    s_mov_b32 s47, 0x20000
    buffer_load_dwordx2 v[20:21], v248, s[36:39], 0 offen offset:0
    buffer_load_dwordx2 v[22:23], v248, s[36:39], 0 offen offset:32
    buffer_load_dwordx2 v[24:25], v248, s[36:39], 0 offen offset:64
    buffer_load_dwordx2 v[26:27], v248, s[36:39], 0 offen offset:96
    buffer_load_dwordx2 v[196:197], v248, s[40:43], 0 offen offset:0
    buffer_load_dwordx2 v[198:199], v248, s[40:43], 0 offen offset:32
    buffer_load_dwordx2 v[200:201], v248, s[40:43], 0 offen offset:64
    buffer_load_dwordx2 v[202:203], v248, s[40:43], 0 offen offset:96
    buffer_load_ushort v204, off, s[44:47], 0
    s_mul_i32 s66, s53, 25600
    s_add_u32 s6, s6, s66
    s_addc_u32 s7, s7, 0
    s_mov_b32 s20, s6
    s_and_b32 s21, s7, 0xffff
    s_or_b32 s21, s21, 0x800000
    s_mov_b32 s22, 200
    s_mov_b32 s23, 0x20000
    s_mov_b32 s48, s18
    s_and_b32 s49, s19, 0xffff
    s_mov_b32 s50, 2097152
    s_mov_b32 s51, 0x20000
    v_mov_b32 v148, -1
    v_mov_b32 v149, -1
    v_mov_b32 v150, -1
    v_mov_b32 v151, -1
    s_add_u32 s66, s52, 17632
    v_lshl_add_u32 v152, v0, 4, s66
    ds_write_b128 v152, v[148:151]
    ds_write_b128 v152, v[148:151] offset:1024
    v_add_u32 v237, s66, v2
    v_add_u32 v237, 16, v237
    v_lshl_add_u32 v244, v1, 2, s66
    v_mul_u32_u24 v136, 0x40004, v0
    v_add_u32 v137, 0x30002, v136
    v_add_u32 v136, 0x10000, v136
    v_mov_b32 v138, 0x3f80
    s_mov_b32 s64, 0
    s_mov_b64 s[56:57], 0
    s_mov_b64 s[58:59], 0
    s_mov_b64 s[84:85], 0
    s_mov_b32 s65, 7
    s_mov_b32 s92, 0xbfb8aa3b
    v_and_b32 v249, 15, v0
    v_lshrrev_b32 v250, 3, v249
    v_lshlrev_b32 v250, 5, v250
    v_lshl_add_u32 v250, v249, 7, v250
    v_add_u32 v250, s52, v250
    v_bfe_u32 v251, v0, 1, 1
    v_lshlrev_b32 v251, 2, v251
    v_xor_b32 v251, v251, v1
    v_lshl_add_u32 v234, v251, 4, v250
    v_xor_b32 v251, 4, v251
    v_lshl_add_u32 v235, v251, 4, v250
    v_bfe_u32 v250, v0, 2, 2
    v_bfe_u32 v251, v0, 1, 1
    v_lshl_add_u32 v251, v1, 1, v251
    v_bfe_u32 v252, v0, 3, 1
    v_lshlrev_b32 v253, 2, v252
    v_xor_b32 v251, v251, v253
    v_lshlrev_b32 v251, 4, v251
    v_lshl_add_u32 v251, v250, 7, v251
    v_and_b32 v253, 1, v0
    v_lshl_add_u32 v251, v253, 3, v251
    v_add_u32 v236, s52, v251
    v_and_b32 v251, 3, v0
    v_lshl_add_u32 v253, v250, 3, v251
    s_add_u32 s66, s52, 14560
    v_lshl_add_u32 v238, v253, 1, s66
    v_lshl_add_u32 v240, v0, 1, s66
    s_add_u32 s66, s52, 15584
    v_lshl_add_u32 v239, v1, 4, s66
    v_and_b32 v253, 1, v0
    v_lshlrev_b32 v253, 4, v253
    v_lshlrev_b32 v253, v253, 1
    v_cmp_eq_u32 vcc, v250, v1
    s_nop 1
    v_cndmask_b32 v253, 0, v253, vcc
    v_cmp_gt_u32 vcc, 2, v251
    s_nop 1
    v_cndmask_b32 v241, 0, v253, vcc
    v_sub_u32 v242, v253, v241
    v_cmp_gt_u32 vcc, 32, v0
    s_nop 1
    v_cndmask_b32 v228, 0, v138, vcc
    v_mov_b32 v229, 0
    v_lshl_add_u32 v251, v1, 3, v250
    v_lshlrev_b32 v251, 7, v251
    v_and_b32 v253, 1, v0
    v_lshl_add_u32 v251, v253, 3, v251
    v_add_u32 v251, 10400, v251
    v_and_b32 v253, 1, v1
    v_lshlrev_b32 v253, 1, v253
    v_add_u32 v253, v253, v252
    v_lshlrev_b32 v253, 1, v253
    v_bfe_u32 v252, v0, 1, 1
    v_xor_b32 v253, v253, v252
    v_xor_b32 v252, 0, v253
    v_lshl_add_u32 v216, v252, 4, v251
    v_add_u32 v220, 81920, v216
    v_xor_b32 v252, 2, v253
    v_lshl_add_u32 v217, v252, 4, v251
    v_add_u32 v221, 81920, v217
    v_xor_b32 v252, 4, v253
    v_lshl_add_u32 v218, v252, 4, v251
    v_add_u32 v222, 81920, v218
    v_xor_b32 v252, 6, v253
    v_lshl_add_u32 v219, v252, 4, v251
    v_add_u32 v223, 81920, v219
    s_waitcnt vmcnt(14)
    v_cmp_neq_f16_sdwa s[68:69], v100, 0 src0_sel:WORD_0 src1_sel:WORD_0
    v_cmp_neq_f16_sdwa s[70:71], v100, 0 src0_sel:WORD_1 src1_sel:WORD_0
    v_cmp_neq_f16_sdwa s[72:73], v101, 0 src0_sel:WORD_0 src1_sel:WORD_0
    v_cmp_neq_f16_sdwa s[74:75], v101, 0 src0_sel:WORD_1 src1_sel:WORD_0
    s_lshl_b32 s66, s64, 4
    s_add_u32 s66, s66, s52
    s_add_u32 s66, s66, 17648
    v_mov_b32 v132, s66
    v_mbcnt_lo_u32_b32 v132, s68, v132
    v_mbcnt_hi_u32_b32 v132, s69, v132
    v_mbcnt_lo_u32_b32 v132, s70, v132
    v_mbcnt_hi_u32_b32 v132, s71, v132
    v_mbcnt_lo_u32_b32 v132, s72, v132
    v_mbcnt_hi_u32_b32 v132, s73, v132
    v_mbcnt_lo_u32_b32 v132, s74, v132
    v_mbcnt_hi_u32_b32 v132, s75, v132
    v_addc_co_u32 v133, vcc, 0, v132, s[68:69]
    v_addc_co_u32 v134, vcc, 0, v133, s[70:71]
    v_addc_co_u32 v135, vcc, 0, v134, s[72:73]
    s_mov_b64 exec, s[68:69]
    ds_write_b8 v132, v136
    s_mov_b64 exec, s[70:71]
    ds_write_b8_d16_hi v133, v136
    s_mov_b64 exec, s[72:73]
    ds_write_b8 v134, v137
    s_mov_b64 exec, s[74:75]
    ds_write_b8_d16_hi v135, v137
    s_mov_b64 exec, -1
    v_cmp_eq_u16_sdwa s[76:77], v100, v138 src0_sel:WORD_0 src1_sel:WORD_0
    v_cmp_eq_u16_sdwa s[78:79], v100, v138 src0_sel:WORD_1 src1_sel:WORD_0
    v_cmp_eq_u16_sdwa s[80:81], v101, v138 src0_sel:WORD_0 src1_sel:WORD_0
    v_cmp_eq_u16_sdwa s[82:83], v101, v138 src0_sel:WORD_1 src1_sel:WORD_0
    s_bcnt1_i32_b64 s66, s[68:69]
    s_bcnt1_i32_b64 s67, s[70:71]
    s_add_u32 s66, s66, s67
    s_bcnt1_i32_b64 s67, s[72:73]
    s_add_u32 s66, s66, s67
    s_bcnt1_i32_b64 s67, s[74:75]
    s_add_u32 s66, s66, s67
    s_add_u32 s66, s66, 15
    s_lshr_b32 s66, s66, 4
    s_max_u32 s66, s66, 1
    s_add_u32 s64, s64, s66
    s_lshl_b64 s[86:87], 1, s64
    s_cmp_lt_u32 s64, 64
    s_cselect_b64 s[88:89], s[86:87], 0
    s_cselect_b64 s[90:91], 0, s[86:87]
    s_or_b64 s[56:57], s[56:57], s[88:89]
    s_or_b64 s[58:59], s[58:59], s[90:91]
    s_andn2_b64 s[86:87], s[68:69], s[76:77]
    s_or_b64 s[84:85], s[84:85], s[86:87]
    s_andn2_b64 s[86:87], s[70:71], s[78:79]
    s_or_b64 s[84:85], s[84:85], s[86:87]
    s_andn2_b64 s[86:87], s[72:73], s[80:81]
    s_or_b64 s[84:85], s[84:85], s[86:87]
    s_andn2_b64 s[86:87], s[74:75], s[82:83]
    s_or_b64 s[84:85], s[84:85], s[86:87]
    s_mov_b32 s94, s64
    s_cmp_lt_u32 s64, 5
    s_cbranch_scc1 L_noearly
    ds_read_u8 v148, v237 offset:0
    ds_read_u8 v149, v237 offset:8
    ds_read_u8 v150, v237 offset:16
    ds_read_u8 v151, v237 offset:24
    ds_read_u8 v152, v237 offset:32
    ds_read_u8 v153, v237 offset:40
    ds_read_u8 v154, v237 offset:48
    ds_read_u8 v155, v237 offset:56
    ds_read_u8 v156, v237 offset:64
    ds_read_u8 v157, v237 offset:72
    s_waitcnt lgkmcnt(8)
    v_mov_b32 v230, v148
    v_mov_b32 v232, v149
    s_add_u32 m0, s52, 0
    s_nop 0
    buffer_load_dwordx4 v[230:231], s[20:23], 0 idxen offen nt lds
    s_add_u32 m0, s52, 1056
    s_nop 0
    buffer_load_dwordx4 v[232:233], s[20:23], 0 idxen offen nt lds
    s_waitcnt lgkmcnt(6)
    v_mov_b32 v230, v150
    v_mov_b32 v232, v151
    s_add_u32 m0, s52, 2080
    s_nop 0
    buffer_load_dwordx4 v[230:231], s[20:23], 0 idxen offen nt lds
    s_add_u32 m0, s52, 3136
    s_nop 0
    buffer_load_dwordx4 v[232:233], s[20:23], 0 idxen offen nt lds
    s_waitcnt lgkmcnt(4)
    v_mov_b32 v230, v152
    v_mov_b32 v232, v153
    s_add_u32 m0, s52, 4160
    s_nop 0
    buffer_load_dwordx4 v[230:231], s[20:23], 0 idxen offen nt lds
    s_add_u32 m0, s52, 5216
    s_nop 0
    buffer_load_dwordx4 v[232:233], s[20:23], 0 idxen offen nt lds
    s_waitcnt lgkmcnt(2)
    v_mov_b32 v230, v154
    v_mov_b32 v232, v155
    s_add_u32 m0, s52, 6240
    s_nop 0
    buffer_load_dwordx4 v[230:231], s[20:23], 0 idxen offen nt lds
    s_add_u32 m0, s52, 7296
    s_nop 0
    buffer_load_dwordx4 v[232:233], s[20:23], 0 idxen offen nt lds
    s_waitcnt lgkmcnt(0)
    v_mov_b32 v230, v156
    v_mov_b32 v232, v157
    s_add_u32 m0, s52, 8320
    s_nop 0
    buffer_load_dwordx4 v[230:231], s[20:23], 0 idxen offen nt lds
    s_add_u32 m0, s52, 9376
    s_nop 0
    buffer_load_dwordx4 v[232:233], s[20:23], 0 idxen offen nt lds
L_noearly:
    v_cmp_neq_f16_sdwa s[68:69], v102, 0 src0_sel:WORD_0 src1_sel:WORD_0
    v_cmp_neq_f16_sdwa s[70:71], v102, 0 src0_sel:WORD_1 src1_sel:WORD_0
    v_cmp_neq_f16_sdwa s[72:73], v103, 0 src0_sel:WORD_0 src1_sel:WORD_0
    v_cmp_neq_f16_sdwa s[74:75], v103, 0 src0_sel:WORD_1 src1_sel:WORD_0
    s_lshl_b32 s66, s64, 4
    s_add_u32 s66, s66, s52
    s_add_u32 s66, s66, 17648
    v_mov_b32 v132, s66
    v_mbcnt_lo_u32_b32 v132, s68, v132
    v_mbcnt_hi_u32_b32 v132, s69, v132
    v_mbcnt_lo_u32_b32 v132, s70, v132
    v_mbcnt_hi_u32_b32 v132, s71, v132
    v_mbcnt_lo_u32_b32 v132, s72, v132
    v_mbcnt_hi_u32_b32 v132, s73, v132
    v_mbcnt_lo_u32_b32 v132, s74, v132
    v_mbcnt_hi_u32_b32 v132, s75, v132
    v_addc_co_u32 v133, vcc, 0, v132, s[68:69]
    v_addc_co_u32 v134, vcc, 0, v133, s[70:71]
    v_addc_co_u32 v135, vcc, 0, v134, s[72:73]
    s_mov_b64 exec, s[68:69]
    ds_write_b8 v132, v136
    s_mov_b64 exec, s[70:71]
    ds_write_b8_d16_hi v133, v136
    s_mov_b64 exec, s[72:73]
    ds_write_b8 v134, v137
    s_mov_b64 exec, s[74:75]
    ds_write_b8_d16_hi v135, v137
    s_mov_b64 exec, -1
    v_cmp_eq_u16_sdwa s[76:77], v102, v138 src0_sel:WORD_0 src1_sel:WORD_0
    v_cmp_eq_u16_sdwa s[78:79], v102, v138 src0_sel:WORD_1 src1_sel:WORD_0
    v_cmp_eq_u16_sdwa s[80:81], v103, v138 src0_sel:WORD_0 src1_sel:WORD_0
    v_cmp_eq_u16_sdwa s[82:83], v103, v138 src0_sel:WORD_1 src1_sel:WORD_0
    s_bcnt1_i32_b64 s66, s[68:69]
    s_bcnt1_i32_b64 s67, s[70:71]
    s_add_u32 s66, s66, s67
    s_bcnt1_i32_b64 s67, s[72:73]
    s_add_u32 s66, s66, s67
    s_bcnt1_i32_b64 s67, s[74:75]
    s_add_u32 s66, s66, s67
    s_add_u32 s66, s66, 15
    s_lshr_b32 s66, s66, 4
    s_max_u32 s66, s66, 1
    s_add_u32 s64, s64, s66
    s_lshl_b64 s[86:87], 1, s64
    s_cmp_lt_u32 s64, 64
    s_cselect_b64 s[88:89], s[86:87], 0
    s_cselect_b64 s[90:91], 0, s[86:87]
    s_or_b64 s[56:57], s[56:57], s[88:89]
    s_or_b64 s[58:59], s[58:59], s[90:91]
    s_andn2_b64 s[86:87], s[68:69], s[76:77]
    s_or_b64 s[84:85], s[84:85], s[86:87]
    s_andn2_b64 s[86:87], s[70:71], s[78:79]
    s_or_b64 s[84:85], s[84:85], s[86:87]
    s_andn2_b64 s[86:87], s[72:73], s[80:81]
    s_or_b64 s[84:85], s[84:85], s[86:87]
    s_andn2_b64 s[86:87], s[74:75], s[82:83]
    s_or_b64 s[84:85], s[84:85], s[86:87]
    v_cmp_neq_f16_sdwa s[68:69], v104, 0 src0_sel:WORD_0 src1_sel:WORD_0
    v_cmp_neq_f16_sdwa s[70:71], v104, 0 src0_sel:WORD_1 src1_sel:WORD_0
    v_cmp_neq_f16_sdwa s[72:73], v105, 0 src0_sel:WORD_0 src1_sel:WORD_0
    v_cmp_neq_f16_sdwa s[74:75], v105, 0 src0_sel:WORD_1 src1_sel:WORD_0
    s_lshl_b32 s66, s64, 4
    s_add_u32 s66, s66, s52
    s_add_u32 s66, s66, 17648
    v_mov_b32 v132, s66
    v_mbcnt_lo_u32_b32 v132, s68, v132
    v_mbcnt_hi_u32_b32 v132, s69, v132
    v_mbcnt_lo_u32_b32 v132, s70, v132
    v_mbcnt_hi_u32_b32 v132, s71, v132
    v_mbcnt_lo_u32_b32 v132, s72, v132
    v_mbcnt_hi_u32_b32 v132, s73, v132
    v_mbcnt_lo_u32_b32 v132, s74, v132
    v_mbcnt_hi_u32_b32 v132, s75, v132
    v_addc_co_u32 v133, vcc, 0, v132, s[68:69]
    v_addc_co_u32 v134, vcc, 0, v133, s[70:71]
    v_addc_co_u32 v135, vcc, 0, v134, s[72:73]
    s_mov_b64 exec, s[68:69]
    ds_write_b8 v132, v136
    s_mov_b64 exec, s[70:71]
    ds_write_b8_d16_hi v133, v136
    s_mov_b64 exec, s[72:73]
    ds_write_b8 v134, v137
    s_mov_b64 exec, s[74:75]
    ds_write_b8_d16_hi v135, v137
    s_mov_b64 exec, -1
    v_cmp_eq_u16_sdwa s[76:77], v104, v138 src0_sel:WORD_0 src1_sel:WORD_0
    v_cmp_eq_u16_sdwa s[78:79], v104, v138 src0_sel:WORD_1 src1_sel:WORD_0
    v_cmp_eq_u16_sdwa s[80:81], v105, v138 src0_sel:WORD_0 src1_sel:WORD_0
    v_cmp_eq_u16_sdwa s[82:83], v105, v138 src0_sel:WORD_1 src1_sel:WORD_0
    s_bcnt1_i32_b64 s66, s[68:69]
    s_bcnt1_i32_b64 s67, s[70:71]
    s_add_u32 s66, s66, s67
    s_bcnt1_i32_b64 s67, s[72:73]
    s_add_u32 s66, s66, s67
    s_bcnt1_i32_b64 s67, s[74:75]
    s_add_u32 s66, s66, s67
    s_add_u32 s66, s66, 15
    s_lshr_b32 s66, s66, 4
    s_max_u32 s66, s66, 1
    s_add_u32 s64, s64, s66
    s_lshl_b64 s[86:87], 1, s64
    s_cmp_lt_u32 s64, 64
    s_cselect_b64 s[88:89], s[86:87], 0
    s_cselect_b64 s[90:91], 0, s[86:87]
    s_or_b64 s[56:57], s[56:57], s[88:89]
    s_or_b64 s[58:59], s[58:59], s[90:91]
    s_andn2_b64 s[86:87], s[68:69], s[76:77]
    s_or_b64 s[84:85], s[84:85], s[86:87]
    s_andn2_b64 s[86:87], s[70:71], s[78:79]
    s_or_b64 s[84:85], s[84:85], s[86:87]
    s_andn2_b64 s[86:87], s[72:73], s[80:81]
    s_or_b64 s[84:85], s[84:85], s[86:87]
    s_andn2_b64 s[86:87], s[74:75], s[82:83]
    s_or_b64 s[84:85], s[84:85], s[86:87]
    v_cmp_neq_f16_sdwa s[68:69], v106, 0 src0_sel:WORD_0 src1_sel:WORD_0
    v_cmp_neq_f16_sdwa s[70:71], v106, 0 src0_sel:WORD_1 src1_sel:WORD_0
    v_cmp_neq_f16_sdwa s[72:73], v107, 0 src0_sel:WORD_0 src1_sel:WORD_0
    v_cmp_neq_f16_sdwa s[74:75], v107, 0 src0_sel:WORD_1 src1_sel:WORD_0
    s_lshl_b32 s66, s64, 4
    s_add_u32 s66, s66, s52
    s_add_u32 s66, s66, 17648
    v_mov_b32 v132, s66
    v_mbcnt_lo_u32_b32 v132, s68, v132
    v_mbcnt_hi_u32_b32 v132, s69, v132
    v_mbcnt_lo_u32_b32 v132, s70, v132
    v_mbcnt_hi_u32_b32 v132, s71, v132
    v_mbcnt_lo_u32_b32 v132, s72, v132
    v_mbcnt_hi_u32_b32 v132, s73, v132
    v_mbcnt_lo_u32_b32 v132, s74, v132
    v_mbcnt_hi_u32_b32 v132, s75, v132
    v_addc_co_u32 v133, vcc, 0, v132, s[68:69]
    v_addc_co_u32 v134, vcc, 0, v133, s[70:71]
    v_addc_co_u32 v135, vcc, 0, v134, s[72:73]
    s_mov_b64 exec, s[68:69]
    ds_write_b8 v132, v136
    s_mov_b64 exec, s[70:71]
    ds_write_b8_d16_hi v133, v136
    s_mov_b64 exec, s[72:73]
    ds_write_b8 v134, v137
    s_mov_b64 exec, s[74:75]
    ds_write_b8_d16_hi v135, v137
    s_mov_b64 exec, -1
    v_cmp_eq_u16_sdwa s[76:77], v106, v138 src0_sel:WORD_0 src1_sel:WORD_0
    v_cmp_eq_u16_sdwa s[78:79], v106, v138 src0_sel:WORD_1 src1_sel:WORD_0
    v_cmp_eq_u16_sdwa s[80:81], v107, v138 src0_sel:WORD_0 src1_sel:WORD_0
    v_cmp_eq_u16_sdwa s[82:83], v107, v138 src0_sel:WORD_1 src1_sel:WORD_0
    s_bcnt1_i32_b64 s66, s[68:69]
    s_bcnt1_i32_b64 s67, s[70:71]
    s_add_u32 s66, s66, s67
    s_bcnt1_i32_b64 s67, s[72:73]
    s_add_u32 s66, s66, s67
    s_bcnt1_i32_b64 s67, s[74:75]
    s_add_u32 s66, s66, s67
    s_add_u32 s66, s66, 15
    s_lshr_b32 s66, s66, 4
    s_max_u32 s66, s66, 1
    s_add_u32 s64, s64, s66
    s_lshl_b64 s[86:87], 1, s64
    s_cmp_lt_u32 s64, 64
    s_cselect_b64 s[88:89], s[86:87], 0
    s_cselect_b64 s[90:91], 0, s[86:87]
    s_or_b64 s[56:57], s[56:57], s[88:89]
    s_or_b64 s[58:59], s[58:59], s[90:91]
    s_andn2_b64 s[86:87], s[68:69], s[76:77]
    s_or_b64 s[84:85], s[84:85], s[86:87]
    s_andn2_b64 s[86:87], s[70:71], s[78:79]
    s_or_b64 s[84:85], s[84:85], s[86:87]
    s_andn2_b64 s[86:87], s[72:73], s[80:81]
    s_or_b64 s[84:85], s[84:85], s[86:87]
    s_andn2_b64 s[86:87], s[74:75], s[82:83]
    s_or_b64 s[84:85], s[84:85], s[86:87]
    v_cmp_neq_f16_sdwa s[68:69], v108, 0 src0_sel:WORD_0 src1_sel:WORD_0
    v_cmp_neq_f16_sdwa s[70:71], v108, 0 src0_sel:WORD_1 src1_sel:WORD_0
    v_cmp_neq_f16_sdwa s[72:73], v109, 0 src0_sel:WORD_0 src1_sel:WORD_0
    v_cmp_neq_f16_sdwa s[74:75], v109, 0 src0_sel:WORD_1 src1_sel:WORD_0
    s_lshl_b32 s66, s64, 4
    s_add_u32 s66, s66, s52
    s_add_u32 s66, s66, 17648
    v_mov_b32 v132, s66
    v_mbcnt_lo_u32_b32 v132, s68, v132
    v_mbcnt_hi_u32_b32 v132, s69, v132
    v_mbcnt_lo_u32_b32 v132, s70, v132
    v_mbcnt_hi_u32_b32 v132, s71, v132
    v_mbcnt_lo_u32_b32 v132, s72, v132
    v_mbcnt_hi_u32_b32 v132, s73, v132
    v_mbcnt_lo_u32_b32 v132, s74, v132
    v_mbcnt_hi_u32_b32 v132, s75, v132
    v_addc_co_u32 v133, vcc, 0, v132, s[68:69]
    v_addc_co_u32 v134, vcc, 0, v133, s[70:71]
    v_addc_co_u32 v135, vcc, 0, v134, s[72:73]
    s_mov_b64 exec, s[68:69]
    ds_write_b8 v132, v136
    s_mov_b64 exec, s[70:71]
    ds_write_b8_d16_hi v133, v136
    s_mov_b64 exec, s[72:73]
    ds_write_b8 v134, v137
    s_mov_b64 exec, s[74:75]
    ds_write_b8_d16_hi v135, v137
    s_mov_b64 exec, -1
    v_cmp_eq_u16_sdwa s[76:77], v108, v138 src0_sel:WORD_0 src1_sel:WORD_0
    v_cmp_eq_u16_sdwa s[78:79], v108, v138 src0_sel:WORD_1 src1_sel:WORD_0
    v_cmp_eq_u16_sdwa s[80:81], v109, v138 src0_sel:WORD_0 src1_sel:WORD_0
    v_cmp_eq_u16_sdwa s[82:83], v109, v138 src0_sel:WORD_1 src1_sel:WORD_0
    s_bcnt1_i32_b64 s66, s[68:69]
    s_bcnt1_i32_b64 s67, s[70:71]
    s_add_u32 s66, s66, s67
    s_bcnt1_i32_b64 s67, s[72:73]
    s_add_u32 s66, s66, s67
    s_bcnt1_i32_b64 s67, s[74:75]
    s_add_u32 s66, s66, s67
    s_add_u32 s66, s66, 15
    s_lshr_b32 s66, s66, 4
    s_max_u32 s66, s66, 1
    s_add_u32 s64, s64, s66
    s_lshl_b64 s[86:87], 1, s64
    s_cmp_lt_u32 s64, 64
    s_cselect_b64 s[88:89], s[86:87], 0
    s_cselect_b64 s[90:91], 0, s[86:87]
    s_or_b64 s[56:57], s[56:57], s[88:89]
    s_or_b64 s[58:59], s[58:59], s[90:91]
    s_andn2_b64 s[86:87], s[68:69], s[76:77]
    s_or_b64 s[84:85], s[84:85], s[86:87]
    s_andn2_b64 s[86:87], s[70:71], s[78:79]
    s_or_b64 s[84:85], s[84:85], s[86:87]
    s_andn2_b64 s[86:87], s[72:73], s[80:81]
    s_or_b64 s[84:85], s[84:85], s[86:87]
    s_andn2_b64 s[86:87], s[74:75], s[82:83]
    s_or_b64 s[84:85], s[84:85], s[86:87]
    v_cmp_neq_f16_sdwa s[68:69], v110, 0 src0_sel:WORD_0 src1_sel:WORD_0
    v_cmp_neq_f16_sdwa s[70:71], v110, 0 src0_sel:WORD_1 src1_sel:WORD_0
    v_cmp_neq_f16_sdwa s[72:73], v111, 0 src0_sel:WORD_0 src1_sel:WORD_0
    v_cmp_neq_f16_sdwa s[74:75], v111, 0 src0_sel:WORD_1 src1_sel:WORD_0
    s_lshl_b32 s66, s64, 4
    s_add_u32 s66, s66, s52
    s_add_u32 s66, s66, 17648
    v_mov_b32 v132, s66
    v_mbcnt_lo_u32_b32 v132, s68, v132
    v_mbcnt_hi_u32_b32 v132, s69, v132
    v_mbcnt_lo_u32_b32 v132, s70, v132
    v_mbcnt_hi_u32_b32 v132, s71, v132
    v_mbcnt_lo_u32_b32 v132, s72, v132
    v_mbcnt_hi_u32_b32 v132, s73, v132
    v_mbcnt_lo_u32_b32 v132, s74, v132
    v_mbcnt_hi_u32_b32 v132, s75, v132
    v_addc_co_u32 v133, vcc, 0, v132, s[68:69]
    v_addc_co_u32 v134, vcc, 0, v133, s[70:71]
    v_addc_co_u32 v135, vcc, 0, v134, s[72:73]
    s_mov_b64 exec, s[68:69]
    ds_write_b8 v132, v136
    s_mov_b64 exec, s[70:71]
    ds_write_b8_d16_hi v133, v136
    s_mov_b64 exec, s[72:73]
    ds_write_b8 v134, v137
    s_mov_b64 exec, s[74:75]
    ds_write_b8_d16_hi v135, v137
    s_mov_b64 exec, -1
    v_cmp_eq_u16_sdwa s[76:77], v110, v138 src0_sel:WORD_0 src1_sel:WORD_0
    v_cmp_eq_u16_sdwa s[78:79], v110, v138 src0_sel:WORD_1 src1_sel:WORD_0
    v_cmp_eq_u16_sdwa s[80:81], v111, v138 src0_sel:WORD_0 src1_sel:WORD_0
    v_cmp_eq_u16_sdwa s[82:83], v111, v138 src0_sel:WORD_1 src1_sel:WORD_0
    s_bcnt1_i32_b64 s66, s[68:69]
    s_bcnt1_i32_b64 s67, s[70:71]
    s_add_u32 s66, s66, s67
    s_bcnt1_i32_b64 s67, s[72:73]
    s_add_u32 s66, s66, s67
    s_bcnt1_i32_b64 s67, s[74:75]
    s_add_u32 s66, s66, s67
    s_add_u32 s66, s66, 15
    s_lshr_b32 s66, s66, 4
    s_max_u32 s66, s66, 1
    s_add_u32 s64, s64, s66
    s_lshl_b64 s[86:87], 1, s64
    s_cmp_lt_u32 s64, 64
    s_cselect_b64 s[88:89], s[86:87], 0
    s_cselect_b64 s[90:91], 0, s[86:87]
    s_or_b64 s[56:57], s[56:57], s[88:89]
    s_or_b64 s[58:59], s[58:59], s[90:91]
    s_andn2_b64 s[86:87], s[68:69], s[76:77]
    s_or_b64 s[84:85], s[84:85], s[86:87]
    s_andn2_b64 s[86:87], s[70:71], s[78:79]
    s_or_b64 s[84:85], s[84:85], s[86:87]
    s_andn2_b64 s[86:87], s[72:73], s[80:81]
    s_or_b64 s[84:85], s[84:85], s[86:87]
    s_andn2_b64 s[86:87], s[74:75], s[82:83]
    s_or_b64 s[84:85], s[84:85], s[86:87]
    v_cmp_neq_f16_sdwa s[68:69], v112, 0 src0_sel:WORD_0 src1_sel:WORD_0
    v_cmp_neq_f16_sdwa s[70:71], v112, 0 src0_sel:WORD_1 src1_sel:WORD_0
    v_cmp_neq_f16_sdwa s[72:73], v113, 0 src0_sel:WORD_0 src1_sel:WORD_0
    v_cmp_neq_f16_sdwa s[74:75], v113, 0 src0_sel:WORD_1 src1_sel:WORD_0
    s_lshl_b32 s66, s64, 4
    s_add_u32 s66, s66, s52
    s_add_u32 s66, s66, 17648
    v_mov_b32 v132, s66
    v_mbcnt_lo_u32_b32 v132, s68, v132
    v_mbcnt_hi_u32_b32 v132, s69, v132
    v_mbcnt_lo_u32_b32 v132, s70, v132
    v_mbcnt_hi_u32_b32 v132, s71, v132
    v_mbcnt_lo_u32_b32 v132, s72, v132
    v_mbcnt_hi_u32_b32 v132, s73, v132
    v_mbcnt_lo_u32_b32 v132, s74, v132
    v_mbcnt_hi_u32_b32 v132, s75, v132
    v_addc_co_u32 v133, vcc, 0, v132, s[68:69]
    v_addc_co_u32 v134, vcc, 0, v133, s[70:71]
    v_addc_co_u32 v135, vcc, 0, v134, s[72:73]
    s_mov_b64 exec, s[68:69]
    ds_write_b8 v132, v136
    s_mov_b64 exec, s[70:71]
    ds_write_b8_d16_hi v133, v136
    s_mov_b64 exec, s[72:73]
    ds_write_b8 v134, v137
    s_mov_b64 exec, s[74:75]
    ds_write_b8_d16_hi v135, v137
    s_mov_b64 exec, -1
    v_cmp_eq_u16_sdwa s[76:77], v112, v138 src0_sel:WORD_0 src1_sel:WORD_0
    v_cmp_eq_u16_sdwa s[78:79], v112, v138 src0_sel:WORD_1 src1_sel:WORD_0
    v_cmp_eq_u16_sdwa s[80:81], v113, v138 src0_sel:WORD_0 src1_sel:WORD_0
    v_cmp_eq_u16_sdwa s[82:83], v113, v138 src0_sel:WORD_1 src1_sel:WORD_0
    s_bcnt1_i32_b64 s66, s[68:69]
    s_bcnt1_i32_b64 s67, s[70:71]
    s_add_u32 s66, s66, s67
    s_bcnt1_i32_b64 s67, s[72:73]
    s_add_u32 s66, s66, s67
    s_bcnt1_i32_b64 s67, s[74:75]
    s_add_u32 s66, s66, s67
    s_add_u32 s66, s66, 15
    s_lshr_b32 s66, s66, 4
    s_max_u32 s66, s66, 1
    s_add_u32 s64, s64, s66
    s_lshl_b64 s[86:87], 1, s64
    s_cmp_lt_u32 s64, 64
    s_cselect_b64 s[88:89], s[86:87], 0
    s_cselect_b64 s[90:91], 0, s[86:87]
    s_or_b64 s[56:57], s[56:57], s[88:89]
    s_or_b64 s[58:59], s[58:59], s[90:91]
    s_andn2_b64 s[86:87], s[68:69], s[76:77]
    s_or_b64 s[84:85], s[84:85], s[86:87]
    s_andn2_b64 s[86:87], s[70:71], s[78:79]
    s_or_b64 s[84:85], s[84:85], s[86:87]
    s_andn2_b64 s[86:87], s[72:73], s[80:81]
    s_or_b64 s[84:85], s[84:85], s[86:87]
    s_andn2_b64 s[86:87], s[74:75], s[82:83]
    s_or_b64 s[84:85], s[84:85], s[86:87]
    v_cmp_neq_f16_sdwa s[68:69], v114, 0 src0_sel:WORD_0 src1_sel:WORD_0
    v_cmp_neq_f16_sdwa s[70:71], v114, 0 src0_sel:WORD_1 src1_sel:WORD_0
    v_cmp_neq_f16_sdwa s[72:73], v115, 0 src0_sel:WORD_0 src1_sel:WORD_0
    v_cmp_neq_f16_sdwa s[74:75], v115, 0 src0_sel:WORD_1 src1_sel:WORD_0
    s_lshl_b32 s66, s64, 4
    s_add_u32 s66, s66, s52
    s_add_u32 s66, s66, 17648
    v_mov_b32 v132, s66
    v_mbcnt_lo_u32_b32 v132, s68, v132
    v_mbcnt_hi_u32_b32 v132, s69, v132
    v_mbcnt_lo_u32_b32 v132, s70, v132
    v_mbcnt_hi_u32_b32 v132, s71, v132
    v_mbcnt_lo_u32_b32 v132, s72, v132
    v_mbcnt_hi_u32_b32 v132, s73, v132
    v_mbcnt_lo_u32_b32 v132, s74, v132
    v_mbcnt_hi_u32_b32 v132, s75, v132
    v_addc_co_u32 v133, vcc, 0, v132, s[68:69]
    v_addc_co_u32 v134, vcc, 0, v133, s[70:71]
    v_addc_co_u32 v135, vcc, 0, v134, s[72:73]
    s_mov_b64 exec, s[68:69]
    ds_write_b8 v132, v136
    s_mov_b64 exec, s[70:71]
    ds_write_b8_d16_hi v133, v136
    s_mov_b64 exec, s[72:73]
    ds_write_b8 v134, v137
    s_mov_b64 exec, s[74:75]
    ds_write_b8_d16_hi v135, v137
    s_mov_b64 exec, -1
    v_cmp_eq_u16_sdwa s[76:77], v114, v138 src0_sel:WORD_0 src1_sel:WORD_0
    v_cmp_eq_u16_sdwa s[78:79], v114, v138 src0_sel:WORD_1 src1_sel:WORD_0
    v_cmp_eq_u16_sdwa s[80:81], v115, v138 src0_sel:WORD_0 src1_sel:WORD_0
    v_cmp_eq_u16_sdwa s[82:83], v115, v138 src0_sel:WORD_1 src1_sel:WORD_0
    s_bcnt1_i32_b64 s66, s[68:69]
    s_bcnt1_i32_b64 s67, s[70:71]
    s_add_u32 s66, s66, s67
    s_bcnt1_i32_b64 s67, s[72:73]
    s_add_u32 s66, s66, s67
    s_bcnt1_i32_b64 s67, s[74:75]
    s_add_u32 s66, s66, s67
    s_add_u32 s66, s66, 15
    s_lshr_b32 s66, s66, 4
    s_max_u32 s66, s66, 1
    s_add_u32 s64, s64, s66
    s_mov_b64 s[60:61], s[56:57]
    s_mov_b64 s[62:63], s[58:59]
    s_lshl_b64 s[86:87], 1, s64
    s_cmp_lt_u32 s64, 64
    s_cselect_b64 s[88:89], s[86:87], 0
    s_cselect_b64 s[90:91], 0, s[86:87]
    s_or_b64 s[56:57], s[56:57], s[88:89]
    s_or_b64 s[58:59], s[58:59], s[90:91]
    s_andn2_b64 s[86:87], s[68:69], s[76:77]
    s_or_b64 s[84:85], s[84:85], s[86:87]
    s_andn2_b64 s[86:87], s[70:71], s[78:79]
    s_or_b64 s[84:85], s[84:85], s[86:87]
    s_andn2_b64 s[86:87], s[72:73], s[80:81]
    s_or_b64 s[84:85], s[84:85], s[86:87]
    s_andn2_b64 s[86:87], s[74:75], s[82:83]
    s_or_b64 s[84:85], s[84:85], s[86:87]
    s_cmp_ge_u32 s94, 5
    s_cbranch_scc1 L_nolate
    ds_read_u8 v148, v237 offset:0
    ds_read_u8 v149, v237 offset:8
    ds_read_u8 v150, v237 offset:16
    ds_read_u8 v151, v237 offset:24
    ds_read_u8 v152, v237 offset:32
    ds_read_u8 v153, v237 offset:40
    ds_read_u8 v154, v237 offset:48
    ds_read_u8 v155, v237 offset:56
    ds_read_u8 v156, v237 offset:64
    ds_read_u8 v157, v237 offset:72
    s_waitcnt lgkmcnt(8)
    v_mov_b32 v230, v148
    v_mov_b32 v232, v149
    s_add_u32 m0, s52, 0
    s_nop 0
    buffer_load_dwordx4 v[230:231], s[20:23], 0 idxen offen nt lds
    s_add_u32 m0, s52, 1056
    s_nop 0
    buffer_load_dwordx4 v[232:233], s[20:23], 0 idxen offen nt lds
    s_bitcmp0_b64 s[60:61], 1
    s_cbranch_scc1 L_noadv1
    s_add_u32 s20, s20, 52428800
    s_addc_u32 s21, s21, 0
L_noadv1:
    s_waitcnt lgkmcnt(6)
    v_mov_b32 v230, v150
    v_mov_b32 v232, v151
    s_add_u32 m0, s52, 2080
    s_nop 0
    buffer_load_dwordx4 v[230:231], s[20:23], 0 idxen offen nt lds
    s_add_u32 m0, s52, 3136
    s_nop 0
    buffer_load_dwordx4 v[232:233], s[20:23], 0 idxen offen nt lds
    s_bitcmp0_b64 s[60:61], 2
    s_cbranch_scc1 L_noadv2
    s_add_u32 s20, s20, 52428800
    s_addc_u32 s21, s21, 0
L_noadv2:
    s_waitcnt lgkmcnt(4)
    v_mov_b32 v230, v152
    v_mov_b32 v232, v153
    s_add_u32 m0, s52, 4160
    s_nop 0
    buffer_load_dwordx4 v[230:231], s[20:23], 0 idxen offen nt lds
    s_add_u32 m0, s52, 5216
    s_nop 0
    buffer_load_dwordx4 v[232:233], s[20:23], 0 idxen offen nt lds
    s_bitcmp0_b64 s[60:61], 3
    s_cbranch_scc1 L_noadv3
    s_add_u32 s20, s20, 52428800
    s_addc_u32 s21, s21, 0
L_noadv3:
    s_waitcnt lgkmcnt(2)
    v_mov_b32 v230, v154
    v_mov_b32 v232, v155
    s_add_u32 m0, s52, 6240
    s_nop 0
    buffer_load_dwordx4 v[230:231], s[20:23], 0 idxen offen nt lds
    s_add_u32 m0, s52, 7296
    s_nop 0
    buffer_load_dwordx4 v[232:233], s[20:23], 0 idxen offen nt lds
    s_bitcmp0_b64 s[60:61], 4
    s_cbranch_scc1 L_noadv4
    s_add_u32 s20, s20, 52428800
    s_addc_u32 s21, s21, 0
L_noadv4:
    s_waitcnt lgkmcnt(0)
    v_mov_b32 v230, v156
    v_mov_b32 v232, v157
    s_add_u32 m0, s52, 8320
    s_nop 0
    buffer_load_dwordx4 v[230:231], s[20:23], 0 idxen offen nt lds
    s_add_u32 m0, s52, 9376
    s_nop 0
    buffer_load_dwordx4 v[232:233], s[20:23], 0 idxen offen nt lds
L_nolate:
    s_waitcnt vmcnt(10)
    s_barrier
    ds_read_b64_tr_b16 v[164:165], v216 offset:40960
    ds_read_b64_tr_b16 v[166:167], v216 offset:41472
    ds_read_b64_tr_b16 v[168:169], v216 offset:61440
    ds_read_b64_tr_b16 v[170:171], v216 offset:61952
    ds_read_b64_tr_b16 v[172:173], v217 offset:40960
    ds_read_b64_tr_b16 v[174:175], v217 offset:41472
    ds_read_b64_tr_b16 v[176:177], v217 offset:61440
    ds_read_b64_tr_b16 v[178:179], v217 offset:61952
    ds_read_b64_tr_b16 v[180:181], v218 offset:40960
    ds_read_b64_tr_b16 v[182:183], v218 offset:41472
    ds_read_b64_tr_b16 v[184:185], v218 offset:61440
    ds_read_b64_tr_b16 v[186:187], v218 offset:61952
    ds_read_b64_tr_b16 v[188:189], v219 offset:40960
    ds_read_b64_tr_b16 v[190:191], v219 offset:41472
    ds_read_b64_tr_b16 v[192:193], v219 offset:61440
    ds_read_b64_tr_b16 v[194:195], v219 offset:61952
    ds_read_b64_tr_b16 v[132:133], v220 offset:0
    ds_read_b64_tr_b16 v[134:135], v220 offset:512
    ds_read_b64_tr_b16 v[136:137], v220 offset:20480
    ds_read_b64_tr_b16 v[138:139], v220 offset:20992
    ds_read_b64_tr_b16 v[140:141], v221 offset:0
    ds_read_b64_tr_b16 v[142:143], v221 offset:512
    ds_read_b64_tr_b16 v[144:145], v221 offset:20480
    ds_read_b64_tr_b16 v[146:147], v221 offset:20992
    ds_read_b64_tr_b16 v[148:149], v222 offset:0
    ds_read_b64_tr_b16 v[150:151], v222 offset:512
    ds_read_b64_tr_b16 v[152:153], v222 offset:20480
    ds_read_b64_tr_b16 v[154:155], v222 offset:20992
    ds_read_b64_tr_b16 v[156:157], v223 offset:0
    ds_read_b64_tr_b16 v[158:159], v223 offset:512
    ds_read_b64_tr_b16 v[160:161], v223 offset:20480
    ds_read_b64_tr_b16 v[162:163], v223 offset:20992
    ds_read_b64_tr_b16 v[100:101], v216 offset:0
    ds_read_b64_tr_b16 v[102:103], v216 offset:512
    ds_read_b64_tr_b16 v[104:105], v216 offset:20480
    ds_read_b64_tr_b16 v[106:107], v216 offset:20992
    ds_read_b64_tr_b16 v[108:109], v217 offset:0
    ds_read_b64_tr_b16 v[110:111], v217 offset:512
    ds_read_b64_tr_b16 v[112:113], v217 offset:20480
    ds_read_b64_tr_b16 v[114:115], v217 offset:20992
    ds_read_b64_tr_b16 v[116:117], v218 offset:0
    ds_read_b64_tr_b16 v[118:119], v218 offset:512
    ds_read_b64_tr_b16 v[120:121], v218 offset:20480
    ds_read_b64_tr_b16 v[122:123], v218 offset:20992
    ds_read_b64_tr_b16 v[124:125], v219 offset:0
    ds_read_b64_tr_b16 v[126:127], v219 offset:512
    ds_read_b64_tr_b16 v[128:129], v219 offset:20480
    ds_read_b64_tr_b16 v[130:131], v219 offset:20992
    ds_read_b64_tr_b16 v[68:69], v220 offset:40960
    ds_read_b64_tr_b16 v[70:71], v220 offset:41472
    ds_read_b64_tr_b16 v[72:73], v220 offset:61440
    ds_read_b64_tr_b16 v[74:75], v220 offset:61952
    ds_read_b64_tr_b16 v[76:77], v221 offset:40960
    ds_read_b64_tr_b16 v[78:79], v221 offset:41472
    ds_read_b64_tr_b16 v[80:81], v221 offset:61440
    ds_read_b64_tr_b16 v[82:83], v221 offset:61952
    ds_read_b64_tr_b16 v[84:85], v222 offset:40960
    ds_read_b64_tr_b16 v[86:87], v222 offset:41472
    ds_read_b64_tr_b16 v[88:89], v222 offset:61440
    ds_read_b64_tr_b16 v[90:91], v222 offset:61952
    ds_read_b64_tr_b16 v[92:93], v223 offset:40960
    ds_read_b64_tr_b16 v[94:95], v223 offset:41472
    ds_read_b64_tr_b16 v[96:97], v223 offset:61440
    ds_read_b64_tr_b16 v[98:99], v223 offset:61952
    v_and_b32 v246, 7, v0
    v_lshlrev_b32 v246, 7, v246
    v_lshl_add_u32 v246, v1, 4, v246
    s_add_u32 s66, s52, 14560
    v_add_u32 v246, s66, v246
    ds_read_b128 v[28:31], v246
    ds_read_b128 v[32:35], v246 offset:64
    ds_read_u16 v224, v238 offset:0
    ds_read_u16 v225, v238 offset:8
    ds_read_u16 v226, v238 offset:64
    ds_read_u16 v227, v238 offset:72
    v_lshlrev_b32 v4, 16, v20
    v_and_b32 v5, 0xffff0000, v20
    v_lshlrev_b32 v6, 16, v21
    v_and_b32 v7, 0xffff0000, v21
    v_lshlrev_b32 v8, 16, v22
    v_and_b32 v9, 0xffff0000, v22
    v_lshlrev_b32 v10, 16, v23
    v_and_b32 v11, 0xffff0000, v23
    v_lshlrev_b32 v12, 16, v24
    v_and_b32 v13, 0xffff0000, v24
    v_lshlrev_b32 v14, 16, v25
    v_and_b32 v15, 0xffff0000, v25
    v_lshlrev_b32 v16, 16, v26
    v_and_b32 v17, 0xffff0000, v26
    v_lshlrev_b32 v18, 16, v27
    v_and_b32 v19, 0xffff0000, v27
    v_lshlrev_b32 v204, 16, v204
    v_mov_b32 v205, v204
    v_mov_b32 v206, v204
    v_mov_b32 v207, v204
    s_waitcnt lgkmcnt(0)
    s_barrier
    ds_read_u8 v246, v237 offset:80
    ds_read_u8 v247, v237 offset:88
    ds_read_u8 v248, v237 offset:96
    ds_read_u8 v249, v237 offset:104
    v_xor_b32 v36, 0x80008000, v28
    v_xor_b32 v37, 0x80008000, v29
    v_xor_b32 v38, 0x80008000, v30
    v_xor_b32 v39, 0x80008000, v31
    v_xor_b32 v40, 0x80008000, v32
    v_xor_b32 v41, 0x80008000, v33
    v_xor_b32 v42, 0x80008000, v34
    v_xor_b32 v43, 0x80008000, v35
    s_bitcmp0_b64 s[60:61], 5
    s_cbranch_scc1 L_noadvb5
    s_add_u32 s20, s20, 52428800
    s_addc_u32 s21, s21, 0
L_noadvb5:
    s_waitcnt lgkmcnt(2)
    v_mov_b32 v230, v246
    v_mov_b32 v232, v247
    s_add_u32 m0, s52, 10400
    s_nop 0
    buffer_load_dwordx4 v[230:231], s[20:23], 0 idxen offen nt lds
    s_add_u32 m0, s52, 11456
    s_nop 0
    buffer_load_dwordx4 v[232:233], s[20:23], 0 idxen offen nt lds
    s_bitcmp0_b64 s[60:61], 6
    s_cbranch_scc1 L_noadvb6
    s_add_u32 s20, s20, 52428800
    s_addc_u32 s21, s21, 0
L_noadvb6:
    s_waitcnt lgkmcnt(0)
    v_mov_b32 v230, v248
    v_mov_b32 v232, v249
    s_add_u32 m0, s52, 12480
    s_nop 0
    buffer_load_dwordx4 v[230:231], s[20:23], 0 idxen offen nt lds
    s_add_u32 m0, s52, 13536
    s_nop 0
    buffer_load_dwordx4 v[232:233], s[20:23], 0 idxen offen nt lds
    v_mfma_f32_16x16x32_bf16 v[4:7], v[164:167], v[28:31], v[4:7]
    v_mfma_f32_16x16x32_bf16 v[8:11], v[172:175], v[28:31], v[8:11]
    v_mfma_f32_16x16x32_bf16 v[12:15], v[180:183], v[28:31], v[12:15]
    v_mfma_f32_16x16x32_bf16 v[16:19], v[188:191], v[28:31], v[16:19]
    v_mfma_f32_16x16x32_bf16 v[4:7], v[132:135], v[36:39], v[4:7]
    v_mfma_f32_16x16x32_bf16 v[8:11], v[140:143], v[36:39], v[8:11]
    v_mfma_f32_16x16x32_bf16 v[12:15], v[148:151], v[36:39], v[12:15]
    v_mfma_f32_16x16x32_bf16 v[16:19], v[156:159], v[36:39], v[16:19]
    v_mfma_f32_16x16x32_bf16 v[4:7], v[168:171], v[32:35], v[4:7]
    v_mfma_f32_16x16x32_bf16 v[8:11], v[176:179], v[32:35], v[8:11]
    v_mfma_f32_16x16x32_bf16 v[12:15], v[184:187], v[32:35], v[12:15]
    v_mfma_f32_16x16x32_bf16 v[16:19], v[192:195], v[32:35], v[16:19]
    v_mfma_f32_16x16x32_bf16 v[4:7], v[136:139], v[40:43], v[4:7]
    v_mfma_f32_16x16x32_bf16 v[8:11], v[144:147], v[40:43], v[8:11]
    v_mfma_f32_16x16x32_bf16 v[12:15], v[152:155], v[40:43], v[12:15]
    v_mfma_f32_16x16x32_bf16 v[16:19], v[160:163], v[40:43], v[16:19]
    v_mul_u32_u24 v216, 0x3f80, v241
    v_mul_u32_u24 v217, 0x3f80, v242
    v_and_b32 v246, 15, v0
    v_cmp_gt_u32 vcc, 8, v246
    v_lshl_add_u32 v246, v246, 8, v239
    v_mul_f32 v4, s92, v4
    v_mul_f32 v5, s92, v5
    v_mul_f32 v6, s92, v6
    v_mul_f32 v7, s92, v7
    v_mul_f32 v8, s92, v8
    v_mul_f32 v9, s92, v9
    v_mul_f32 v10, s92, v10
    v_mul_f32 v11, s92, v11
    v_mul_f32 v12, s92, v12
    v_mul_f32 v13, s92, v13
    v_mul_f32 v14, s92, v14
    v_mul_f32 v15, s92, v15
    v_mul_f32 v16, s92, v16
    v_mul_f32 v17, s92, v17
    v_mul_f32 v18, s92, v18
    v_mul_f32 v19, s92, v19
    s_mov_b64 exec, vcc
    ds_write_b128 v246, v[4:7] offset:0
    ds_write_b128 v246, v[8:11] offset:64
    ds_write_b128 v246, v[12:15] offset:128
    ds_write_b128 v246, v[16:19] offset:192
    s_mov_b64 exec, -1
    s_waitcnt lgkmcnt(0)
    v_mfma_f32_16x16x16_bf16 v[4:7], v[216:217], v[100:101], 0
    v_mfma_f32_16x16x16_bf16 v[4:7], v[216:217], v[132:133], v[4:7]
    v_mfma_f32_16x16x16_bf16 v[8:11], v[216:217], v[102:103], 0
    v_mfma_f32_16x16x16_bf16 v[8:11], v[216:217], v[134:135], v[8:11]
    v_mfma_f32_16x16x16_bf16 v[12:15], v[216:217], v[104:105], 0
    v_mfma_f32_16x16x16_bf16 v[12:15], v[216:217], v[136:137], v[12:15]
    v_mfma_f32_16x16x16_bf16 v[16:19], v[216:217], v[106:107], 0
    v_mfma_f32_16x16x16_bf16 v[16:19], v[216:217], v[138:139], v[16:19]
    v_mfma_f32_16x16x16_bf16 v[20:23], v[216:217], v[108:109], 0
    v_mfma_f32_16x16x16_bf16 v[20:23], v[216:217], v[140:141], v[20:23]
    v_mfma_f32_16x16x16_bf16 v[24:27], v[216:217], v[110:111], 0
    v_mfma_f32_16x16x16_bf16 v[24:27], v[216:217], v[142:143], v[24:27]
    v_mfma_f32_16x16x16_bf16 v[28:31], v[216:217], v[112:113], 0
    v_mfma_f32_16x16x16_bf16 v[28:31], v[216:217], v[144:145], v[28:31]
    v_mfma_f32_16x16x16_bf16 v[32:35], v[216:217], v[114:115], 0
    v_mfma_f32_16x16x16_bf16 v[32:35], v[216:217], v[146:147], v[32:35]
    v_mfma_f32_16x16x16_bf16 v[36:39], v[216:217], v[116:117], 0
    v_mfma_f32_16x16x16_bf16 v[36:39], v[216:217], v[148:149], v[36:39]
    v_mfma_f32_16x16x16_bf16 v[40:43], v[216:217], v[118:119], 0
    v_mfma_f32_16x16x16_bf16 v[40:43], v[216:217], v[150:151], v[40:43]
    v_mfma_f32_16x16x16_bf16 v[44:47], v[216:217], v[120:121], 0
    v_mfma_f32_16x16x16_bf16 v[44:47], v[216:217], v[152:153], v[44:47]
    v_mfma_f32_16x16x16_bf16 v[48:51], v[216:217], v[122:123], 0
    v_mfma_f32_16x16x16_bf16 v[48:51], v[216:217], v[154:155], v[48:51]
    v_mfma_f32_16x16x16_bf16 v[52:55], v[216:217], v[124:125], 0
    v_mfma_f32_16x16x16_bf16 v[52:55], v[216:217], v[156:157], v[52:55]
    v_mfma_f32_16x16x16_bf16 v[56:59], v[216:217], v[126:127], 0
    v_mfma_f32_16x16x16_bf16 v[56:59], v[216:217], v[158:159], v[56:59]
    v_mfma_f32_16x16x16_bf16 v[60:63], v[216:217], v[128:129], 0
    v_mfma_f32_16x16x16_bf16 v[60:63], v[216:217], v[160:161], v[60:63]
    v_mfma_f32_16x16x16_bf16 v[64:67], v[216:217], v[130:131], 0
    v_mfma_f32_16x16x16_bf16 v[64:67], v[216:217], v[162:163], v[64:67]
    v_mfma_f32_16x16x16_bf16 v[164:167], v[216:217], v[68:69], 0
    v_mfma_f32_16x16x16_bf16 v[168:171], v[216:217], v[70:71], 0
    v_mfma_f32_16x16x16_bf16 v[172:175], v[216:217], v[72:73], 0
    v_mfma_f32_16x16x16_bf16 v[176:179], v[216:217], v[74:75], 0
    v_mfma_f32_16x16x16_bf16 v[180:183], v[216:217], v[76:77], 0
    v_mfma_f32_16x16x16_bf16 v[184:187], v[216:217], v[78:79], 0
    v_mfma_f32_16x16x16_bf16 v[188:191], v[216:217], v[80:81], 0
    v_mfma_f32_16x16x16_bf16 v[192:195], v[216:217], v[82:83], 0
    v_mul_f32 v4, s92, v4
    v_mul_f32 v5, s92, v5
    v_mul_f32 v6, s92, v6
    v_mul_f32 v7, s92, v7
    v_mul_f32 v8, s92, v8
    v_mul_f32 v9, s92, v9
    v_mul_f32 v10, s92, v10
    v_mul_f32 v11, s92, v11
    v_mul_f32 v12, s92, v12
    v_mul_f32 v13, s92, v13
    v_mul_f32 v14, s92, v14
    v_mul_f32 v15, s92, v15
    v_mul_f32 v16, s92, v16
    v_mul_f32 v17, s92, v17
    v_mul_f32 v18, s92, v18
    v_mul_f32 v19, s92, v19
    v_mul_f32 v20, s92, v20
    v_mul_f32 v21, s92, v21
    v_mul_f32 v22, s92, v22
    v_mul_f32 v23, s92, v23
    v_mul_f32 v24, s92, v24
    v_mul_f32 v25, s92, v25
    v_mul_f32 v26, s92, v26
    v_mul_f32 v27, s92, v27
    v_mul_f32 v28, s92, v28
    v_mul_f32 v29, s92, v29
    v_mul_f32 v30, s92, v30
    v_mul_f32 v31, s92, v31
    v_mul_f32 v32, s92, v32
    v_mul_f32 v33, s92, v33
    v_mul_f32 v34, s92, v34
    v_mul_f32 v35, s92, v35
    v_mul_f32 v164, s92, v164
    v_mul_f32 v165, s92, v165
    v_mul_f32 v166, s92, v166
    v_mul_f32 v167, s92, v167
    v_mul_f32 v168, s92, v168
    v_mul_f32 v169, s92, v169
    v_mul_f32 v170, s92, v170
    v_mul_f32 v171, s92, v171
    v_mul_f32 v172, s92, v172
    v_mul_f32 v173, s92, v173
    v_mul_f32 v174, s92, v174
    v_mul_f32 v175, s92, v175
    v_mul_f32 v176, s92, v176
    v_mul_f32 v177, s92, v177
    v_mul_f32 v178, s92, v178
    v_mul_f32 v179, s92, v179
    v_mul_f32 v180, s92, v180
    v_mul_f32 v181, s92, v181
    v_mul_f32 v182, s92, v182
    v_mul_f32 v183, s92, v183
    v_mul_f32 v184, s92, v184
    v_mul_f32 v185, s92, v185
    v_mul_f32 v186, s92, v186
    v_mul_f32 v187, s92, v187
    v_mul_f32 v188, s92, v188
    v_mul_f32 v189, s92, v189
    v_mul_f32 v190, s92, v190
    v_mul_f32 v191, s92, v191
    v_mul_f32 v192, s92, v192
    v_mul_f32 v193, s92, v193
    v_mul_f32 v194, s92, v194
    v_mul_f32 v195, s92, v195
    v_cvt_pk_bf16_f32 v68, v164, v165
    v_cvt_pk_bf16_f32 v69, v166, v167
    v_cvt_pk_bf16_f32 v70, v168, v169
    v_cvt_pk_bf16_f32 v71, v170, v171
    v_cvt_pk_bf16_f32 v72, v172, v173
    v_cvt_pk_bf16_f32 v73, v174, v175
    v_cvt_pk_bf16_f32 v74, v176, v177
    v_cvt_pk_bf16_f32 v75, v178, v179
    v_cvt_pk_bf16_f32 v76, v180, v181
    v_cvt_pk_bf16_f32 v77, v182, v183
    v_cvt_pk_bf16_f32 v78, v184, v185
    v_cvt_pk_bf16_f32 v79, v186, v187
    v_cvt_pk_bf16_f32 v80, v188, v189
    v_cvt_pk_bf16_f32 v81, v190, v191
    v_cvt_pk_bf16_f32 v82, v192, v193
    v_cvt_pk_bf16_f32 v83, v194, v195
    v_mfma_f32_16x16x16_bf16 v[164:167], v[216:217], v[84:85], 0
    v_mfma_f32_16x16x16_bf16 v[168:171], v[216:217], v[86:87], 0
    v_mfma_f32_16x16x16_bf16 v[172:175], v[216:217], v[88:89], 0
    v_mfma_f32_16x16x16_bf16 v[176:179], v[216:217], v[90:91], 0
    v_mfma_f32_16x16x16_bf16 v[180:183], v[216:217], v[92:93], 0
    v_mfma_f32_16x16x16_bf16 v[184:187], v[216:217], v[94:95], 0
    v_mfma_f32_16x16x16_bf16 v[188:191], v[216:217], v[96:97], 0
    v_mfma_f32_16x16x16_bf16 v[192:195], v[216:217], v[98:99], 0
    v_mul_f32 v36, s92, v36
    v_mul_f32 v37, s92, v37
    v_mul_f32 v38, s92, v38
    v_mul_f32 v39, s92, v39
    v_mul_f32 v40, s92, v40
    v_mul_f32 v41, s92, v41
    v_mul_f32 v42, s92, v42
    v_mul_f32 v43, s92, v43
    v_mul_f32 v44, s92, v44
    v_mul_f32 v45, s92, v45
    v_mul_f32 v46, s92, v46
    v_mul_f32 v47, s92, v47
    v_mul_f32 v48, s92, v48
    v_mul_f32 v49, s92, v49
    v_mul_f32 v50, s92, v50
    v_mul_f32 v51, s92, v51
    v_mul_f32 v52, s92, v52
    v_mul_f32 v53, s92, v53
    v_mul_f32 v54, s92, v54
    v_mul_f32 v55, s92, v55
    v_mul_f32 v56, s92, v56
    v_mul_f32 v57, s92, v57
    v_mul_f32 v58, s92, v58
    v_mul_f32 v59, s92, v59
    v_mul_f32 v60, s92, v60
    v_mul_f32 v61, s92, v61
    v_mul_f32 v62, s92, v62
    v_mul_f32 v63, s92, v63
    v_mul_f32 v64, s92, v64
    v_mul_f32 v65, s92, v65
    v_mul_f32 v66, s92, v66
    v_mul_f32 v67, s92, v67
    v_mul_f32 v164, s92, v164
    v_mul_f32 v165, s92, v165
    v_mul_f32 v166, s92, v166
    v_mul_f32 v167, s92, v167
    v_mul_f32 v168, s92, v168
    v_mul_f32 v169, s92, v169
    v_mul_f32 v170, s92, v170
    v_mul_f32 v171, s92, v171
    v_mul_f32 v172, s92, v172
    v_mul_f32 v173, s92, v173
    v_mul_f32 v174, s92, v174
    v_mul_f32 v175, s92, v175
    v_mul_f32 v176, s92, v176
    v_mul_f32 v177, s92, v177
    v_mul_f32 v178, s92, v178
    v_mul_f32 v179, s92, v179
    v_mul_f32 v180, s92, v180
    v_mul_f32 v181, s92, v181
    v_mul_f32 v182, s92, v182
    v_mul_f32 v183, s92, v183
    v_mul_f32 v184, s92, v184
    v_mul_f32 v185, s92, v185
    v_mul_f32 v186, s92, v186
    v_mul_f32 v187, s92, v187
    v_mul_f32 v188, s92, v188
    v_mul_f32 v189, s92, v189
    v_mul_f32 v190, s92, v190
    v_mul_f32 v191, s92, v191
    v_mul_f32 v192, s92, v192
    v_mul_f32 v193, s92, v193
    v_mul_f32 v194, s92, v194
    v_mul_f32 v195, s92, v195
    v_cvt_pk_bf16_f32 v84, v164, v165
    v_cvt_pk_bf16_f32 v85, v166, v167
    v_cvt_pk_bf16_f32 v86, v168, v169
    v_cvt_pk_bf16_f32 v87, v170, v171
    v_cvt_pk_bf16_f32 v88, v172, v173
    v_cvt_pk_bf16_f32 v89, v174, v175
    v_cvt_pk_bf16_f32 v90, v176, v177
    v_cvt_pk_bf16_f32 v91, v178, v179
    v_cvt_pk_bf16_f32 v92, v180, v181
    v_cvt_pk_bf16_f32 v93, v182, v183
    v_cvt_pk_bf16_f32 v94, v184, v185
    v_cvt_pk_bf16_f32 v95, v186, v187
    v_cvt_pk_bf16_f32 v96, v188, v189
    v_cvt_pk_bf16_f32 v97, v190, v191
    v_cvt_pk_bf16_f32 v98, v192, v193
    v_cvt_pk_bf16_f32 v99, v194, v195
    v_mul_u32_u24 v216, v224, v241
    v_mul_u32_u24 v217, v224, v242
    v_mul_u32_u24 v218, v225, v241
    v_mul_u32_u24 v219, v225, v242
    v_mul_u32_u24 v220, v226, v241
    v_mul_u32_u24 v221, v226, v242
    v_mul_u32_u24 v222, v227, v241
    v_mul_u32_u24 v223, v227, v242
    v_add_u32 v238, 128, v238
    ds_read_b128 v[164:167], v239
    v_mfma_f32_16x16x16_bf16 v[148:151], v[216:217], v[68:69], v[4:7]
    v_mfma_f32_16x16x16_bf16 v[152:155], v[218:219], v[70:71], v[8:11]
    ds_read_b128 v[168:171], v239 offset:64
    ds_read_b128 v[172:175], v239 offset:128
    ds_read_b128 v[176:179], v239 offset:192
    v_mfma_f32_16x16x16_bf16 v[156:159], v[220:221], v[72:73], v[12:15]
    v_mfma_f32_16x16x16_bf16 v[160:163], v[222:223], v[74:75], v[16:19]
    ds_read_u16 v224, v238 offset:0
    ds_read_u16 v225, v238 offset:8
    ds_read_u16 v226, v238 offset:64
    ds_read_u16 v227, v238 offset:72
    v_mfma_f32_16x16x16_bf16 v[246:249], v[216:217], v[76:77], v[20:23]
    v_mfma_f32_16x16x16_bf16 v[250:253], v[218:219], v[78:79], v[24:27]
    v_add_u32 v239, 256, v239
    v_cvt_pk_bf16_f32 v100, v148, v149
    v_cvt_pk_bf16_f32 v101, v150, v151
    v_cvt_pk_bf16_f32 v102, v152, v153
    v_cvt_pk_bf16_f32 v103, v154, v155
    v_mfma_f32_16x16x16_bf16 v[148:151], v[220:221], v[80:81], v[28:31]
    v_mfma_f32_16x16x16_bf16 v[152:155], v[222:223], v[82:83], v[32:35]
    v_cvt_pk_bf16_f32 v104, v156, v157
    v_cvt_pk_bf16_f32 v105, v158, v159
    v_cvt_pk_bf16_f32 v106, v160, v161
    v_cvt_pk_bf16_f32 v107, v162, v163
    v_mfma_f32_16x16x16_bf16 v[156:159], v[216:217], v[84:85], v[36:39]
    v_mfma_f32_16x16x16_bf16 v[160:163], v[218:219], v[86:87], v[40:43]
    v_cvt_pk_bf16_f32 v108, v246, v247
    v_cvt_pk_bf16_f32 v109, v248, v249
    v_cvt_pk_bf16_f32 v110, v250, v251
    v_cvt_pk_bf16_f32 v111, v252, v253
    v_mfma_f32_16x16x16_bf16 v[246:249], v[220:221], v[88:89], v[44:47]
    v_mfma_f32_16x16x16_bf16 v[250:253], v[222:223], v[90:91], v[48:51]
    v_cvt_pk_bf16_f32 v112, v148, v149
    v_cvt_pk_bf16_f32 v113, v150, v151
    v_cvt_pk_bf16_f32 v114, v152, v153
    v_cvt_pk_bf16_f32 v115, v154, v155
    v_mfma_f32_16x16x16_bf16 v[148:151], v[216:217], v[92:93], v[52:55]
    v_mfma_f32_16x16x16_bf16 v[152:155], v[218:219], v[94:95], v[56:59]
    v_cvt_pk_bf16_f32 v116, v156, v157
    v_cvt_pk_bf16_f32 v117, v158, v159
    v_cvt_pk_bf16_f32 v118, v160, v161
    v_cvt_pk_bf16_f32 v119, v162, v163
    v_mfma_f32_16x16x16_bf16 v[156:159], v[220:221], v[96:97], v[60:63]
    v_mfma_f32_16x16x16_bf16 v[160:163], v[222:223], v[98:99], v[64:67]
    v_cvt_pk_bf16_f32 v120, v246, v247
    v_cvt_pk_bf16_f32 v121, v248, v249
    v_cvt_pk_bf16_f32 v122, v250, v251
    v_cvt_pk_bf16_f32 v123, v252, v253
    v_cvt_pk_bf16_f32 v124, v148, v149
    v_cvt_pk_bf16_f32 v125, v150, v151
    v_cvt_pk_bf16_f32 v126, v152, v153
    v_cvt_pk_bf16_f32 v127, v154, v155
    v_cvt_pk_bf16_f32 v128, v156, v157
    v_cvt_pk_bf16_f32 v129, v158, v159
    v_cvt_pk_bf16_f32 v130, v160, v161
    v_cvt_pk_bf16_f32 v131, v162, v163
    s_waitcnt lgkmcnt(0)
    v_mov_b32 v188, 0
    v_mov_b32 v189, 0
    v_mov_b32 v190, 0
    v_mov_b32 v191, 0
    v_mov_b32 v192, 0
    v_mov_b32 v193, 0
    v_mov_b32 v194, 0
    v_mov_b32 v195, 0
    v_mov_b32 v208, 0
    v_mov_b32 v212, 0
    v_mov_b32 v209, 0
    v_mov_b32 v213, 0
    v_mov_b32 v210, 0
    v_mov_b32 v214, 0
    v_mov_b32 v211, 0
    v_mov_b32 v215, 0
    s_waitcnt vmcnt(12)
    ds_read_b128 v[180:183], v234 offset:0
    ds_read_b128 v[184:187], v235 offset:0
    s_waitcnt lgkmcnt(0)
    v_mfma_f32_16x16x32_bf16 v[148:151], v[100:103], v[180:183], v[164:167]
    v_mfma_f32_16x16x32_bf16 v[148:151], v[104:107], v[184:187], v[148:151]
    v_mfma_f32_16x16x32_bf16 v[152:155], v[108:111], v[180:183], v[168:171]
    v_mfma_f32_16x16x32_bf16 v[152:155], v[112:115], v[184:187], v[152:155]
    v_mfma_f32_16x16x32_bf16 v[156:159], v[116:119], v[180:183], v[172:175]
    v_mfma_f32_16x16x32_bf16 v[156:159], v[120:123], v[184:187], v[156:159]
    v_mfma_f32_16x16x32_bf16 v[160:163], v[124:127], v[180:183], v[176:179]
    v_mfma_f32_16x16x32_bf16 v[160:163], v[128:131], v[184:187], v[160:163]
    s_cmp_lg_u64 s[84:85], 0
    s_cbranch_scc1 L_slow
Lf_loop:
    s_waitcnt vmcnt(10)
    ds_read_b128 v[180:183], v234 offset:2080
    ds_read_b128 v[184:187], v235 offset:2080
    ds_read_u8 v230, v237 offset:112
    ds_read_u8 v232, v237 offset:120
    v_exp_f32 v132, v148
    v_exp_f32 v133, v149
    v_exp_f32 v134, v150
    v_exp_f32 v135, v151
    v_cvt_pk_bf16_f32 v208, v208, v209
    v_cvt_pk_bf16_f32 v209, v210, v211
    v_exp_f32 v136, v152
    v_exp_f32 v137, v153
    v_mfma_f32_4x4x4_16b_bf16 v[212:215], v[208:209], v[188:189], v[212:215] cbsz:4 abid:0
    v_exp_f32 v138, v154
    v_exp_f32 v139, v155
    v_mfma_f32_4x4x4_16b_bf16 v[212:215], v[208:209], v[190:191], v[212:215] cbsz:4 abid:4
    v_exp_f32 v140, v156
    v_exp_f32 v141, v157
    v_mfma_f32_4x4x4_16b_bf16 v[212:215], v[208:209], v[192:193], v[212:215] cbsz:4 abid:8
    v_exp_f32 v142, v158
    v_exp_f32 v143, v159
    v_mfma_f32_4x4x4_16b_bf16 v[212:215], v[208:209], v[194:195], v[212:215] cbsz:4 abid:12
    ds_read_b64_tr_b16 v[188:189], v236 offset:0
    ds_read_b64_tr_b16 v[190:191], v236 offset:512
    ds_read_b64_tr_b16 v[192:193], v236 offset:1056
    ds_read_b64_tr_b16 v[194:195], v236 offset:1568
    v_exp_f32 v144, v160
    v_exp_f32 v145, v161
    v_exp_f32 v146, v162
    v_exp_f32 v147, v163
    s_bitcmp1_b64 s[56:57], 0
    s_cbranch_scc1 Lf_flush0
Lf_flushed0:
    v_mfma_f32_32x32x8_bf16 v[132:147], v[228:229], v[228:229], v[132:147]
    s_bitcmp1_b64 s[60:61], 1
    s_cbranch_scc1 Lf_wb0
Lf_wbd0:
    s_bitcmp1_b64 s[60:61], 7
    s_cbranch_scc1 Lf_adv0
Lf_advd0:
    s_waitcnt lgkmcnt(4)
    v_mfma_f32_16x16x32_bf16 v[148:151], v[100:103], v[180:183], v[164:167]
    v_mfma_f32_16x16x32_bf16 v[148:151], v[104:107], v[184:187], v[148:151]
    s_waitcnt lgkmcnt(0)
    s_add_u32 m0, s52, 0
    v_mfma_f32_16x16x32_bf16 v[152:155], v[108:111], v[180:183], v[168:171]
    buffer_load_dwordx4 v[230:231], s[20:23], 0 idxen offen nt lds
    s_add_u32 m0, s52, 1056
    v_mfma_f32_16x16x32_bf16 v[152:155], v[112:115], v[184:187], v[152:155]
    buffer_load_dwordx4 v[232:233], s[20:23], 0 idxen offen nt lds
    v_rcp_f32 v132, v132
    v_rcp_f32 v133, v133
    v_rcp_f32 v134, v134
    v_cvt_pk_bf16_f32 v132, v132, v133
    v_mfma_f32_16x16x32_bf16 v[156:159], v[116:119], v[180:183], v[172:175]
    v_rcp_f32 v135, v135
    v_rcp_f32 v136, v136
    v_cvt_pk_bf16_f32 v133, v134, v135
    v_mfma_f32_16x16x32_bf16 v[156:159], v[120:123], v[184:187], v[156:159]
    v_rcp_f32 v137, v137
    v_rcp_f32 v138, v138
    v_cvt_pk_bf16_f32 v134, v136, v137
    v_mfma_f32_16x16x32_bf16 v[160:163], v[124:127], v[180:183], v[176:179]
    v_rcp_f32 v139, v139
    v_rcp_f32 v140, v140
    v_cvt_pk_bf16_f32 v135, v138, v139
    v_mfma_f32_16x16x32_bf16 v[160:163], v[128:131], v[184:187], v[160:163]
    v_rcp_f32 v141, v141
    v_rcp_f32 v142, v142
    v_cvt_pk_bf16_f32 v136, v140, v141
    v_mfma_f32_16x16x32_bf16 v[208:211], v[132:135], v[196:199], v[204:207]
    v_rcp_f32 v143, v143
    v_rcp_f32 v144, v144
    v_cvt_pk_bf16_f32 v137, v142, v143
    v_rcp_f32 v145, v145
    v_rcp_f32 v146, v146
    v_cvt_pk_bf16_f32 v138, v144, v145
    v_rcp_f32 v147, v147
    s_nop 0
    v_cvt_pk_bf16_f32 v139, v146, v147
    s_nop 1
    v_mfma_f32_16x16x32_bf16 v[208:211], v[136:139], v[200:203], v[208:211]
    s_waitcnt vmcnt(10)
    ds_read_b128 v[180:183], v234 offset:4160
    ds_read_b128 v[184:187], v235 offset:4160
    ds_read_u8 v230, v237 offset:128
    ds_read_u8 v232, v237 offset:136
    v_exp_f32 v132, v148
    v_exp_f32 v133, v149
    v_exp_f32 v134, v150
    v_exp_f32 v135, v151
    v_cvt_pk_bf16_f32 v208, v208, v209
    v_cvt_pk_bf16_f32 v209, v210, v211
    v_exp_f32 v136, v152
    v_exp_f32 v137, v153
    v_mfma_f32_4x4x4_16b_bf16 v[212:215], v[208:209], v[188:189], v[212:215] cbsz:4 abid:0
    v_exp_f32 v138, v154
    v_exp_f32 v139, v155
    v_mfma_f32_4x4x4_16b_bf16 v[212:215], v[208:209], v[190:191], v[212:215] cbsz:4 abid:4
    v_exp_f32 v140, v156
    v_exp_f32 v141, v157
    v_mfma_f32_4x4x4_16b_bf16 v[212:215], v[208:209], v[192:193], v[212:215] cbsz:4 abid:8
    v_exp_f32 v142, v158
    v_exp_f32 v143, v159
    v_mfma_f32_4x4x4_16b_bf16 v[212:215], v[208:209], v[194:195], v[212:215] cbsz:4 abid:12
    ds_read_b64_tr_b16 v[188:189], v236 offset:2080
    ds_read_b64_tr_b16 v[190:191], v236 offset:2592
    ds_read_b64_tr_b16 v[192:193], v236 offset:3136
    ds_read_b64_tr_b16 v[194:195], v236 offset:3648
    v_exp_f32 v144, v160
    v_exp_f32 v145, v161
    v_exp_f32 v146, v162
    v_exp_f32 v147, v163
    s_bitcmp1_b64 s[56:57], 1
    s_cbranch_scc1 Lf_flush1
Lf_flushed1:
    v_mfma_f32_32x32x8_bf16 v[132:147], v[228:229], v[228:229], v[132:147]
    s_bitcmp1_b64 s[60:61], 2
    s_cbranch_scc1 Lf_wb1
Lf_wbd1:
    s_bitcmp1_b64 s[60:61], 8
    s_cbranch_scc1 Lf_adv1
Lf_advd1:
    s_waitcnt lgkmcnt(4)
    v_mfma_f32_16x16x32_bf16 v[148:151], v[100:103], v[180:183], v[164:167]
    v_mfma_f32_16x16x32_bf16 v[148:151], v[104:107], v[184:187], v[148:151]
    s_waitcnt lgkmcnt(0)
    s_add_u32 m0, s52, 2080
    v_mfma_f32_16x16x32_bf16 v[152:155], v[108:111], v[180:183], v[168:171]
    buffer_load_dwordx4 v[230:231], s[20:23], 0 idxen offen nt lds
    s_add_u32 m0, s52, 3136
    v_mfma_f32_16x16x32_bf16 v[152:155], v[112:115], v[184:187], v[152:155]
    buffer_load_dwordx4 v[232:233], s[20:23], 0 idxen offen nt lds
    v_rcp_f32 v132, v132
    v_rcp_f32 v133, v133
    v_rcp_f32 v134, v134
    v_cvt_pk_bf16_f32 v132, v132, v133
    v_mfma_f32_16x16x32_bf16 v[156:159], v[116:119], v[180:183], v[172:175]
    v_rcp_f32 v135, v135
    v_rcp_f32 v136, v136
    v_cvt_pk_bf16_f32 v133, v134, v135
    v_mfma_f32_16x16x32_bf16 v[156:159], v[120:123], v[184:187], v[156:159]
    v_rcp_f32 v137, v137
    v_rcp_f32 v138, v138
    v_cvt_pk_bf16_f32 v134, v136, v137
    v_mfma_f32_16x16x32_bf16 v[160:163], v[124:127], v[180:183], v[176:179]
    v_rcp_f32 v139, v139
    v_rcp_f32 v140, v140
    v_cvt_pk_bf16_f32 v135, v138, v139
    v_mfma_f32_16x16x32_bf16 v[160:163], v[128:131], v[184:187], v[160:163]
    v_rcp_f32 v141, v141
    v_rcp_f32 v142, v142
    v_cvt_pk_bf16_f32 v136, v140, v141
    v_mfma_f32_16x16x32_bf16 v[208:211], v[132:135], v[196:199], v[204:207]
    v_rcp_f32 v143, v143
    v_rcp_f32 v144, v144
    v_cvt_pk_bf16_f32 v137, v142, v143
    v_rcp_f32 v145, v145
    v_rcp_f32 v146, v146
    v_cvt_pk_bf16_f32 v138, v144, v145
    v_rcp_f32 v147, v147
    s_nop 0
    v_cvt_pk_bf16_f32 v139, v146, v147
    s_nop 1
    v_mfma_f32_16x16x32_bf16 v[208:211], v[136:139], v[200:203], v[208:211]
    s_waitcnt vmcnt(10)
    ds_read_b128 v[180:183], v234 offset:6240
    ds_read_b128 v[184:187], v235 offset:6240
    ds_read_u8 v230, v237 offset:144
    ds_read_u8 v232, v237 offset:152
    v_exp_f32 v132, v148
    v_exp_f32 v133, v149
    v_exp_f32 v134, v150
    v_exp_f32 v135, v151
    v_cvt_pk_bf16_f32 v208, v208, v209
    v_cvt_pk_bf16_f32 v209, v210, v211
    v_exp_f32 v136, v152
    v_exp_f32 v137, v153
    v_mfma_f32_4x4x4_16b_bf16 v[212:215], v[208:209], v[188:189], v[212:215] cbsz:4 abid:0
    v_exp_f32 v138, v154
    v_exp_f32 v139, v155
    v_mfma_f32_4x4x4_16b_bf16 v[212:215], v[208:209], v[190:191], v[212:215] cbsz:4 abid:4
    v_exp_f32 v140, v156
    v_exp_f32 v141, v157
    v_mfma_f32_4x4x4_16b_bf16 v[212:215], v[208:209], v[192:193], v[212:215] cbsz:4 abid:8
    v_exp_f32 v142, v158
    v_exp_f32 v143, v159
    v_mfma_f32_4x4x4_16b_bf16 v[212:215], v[208:209], v[194:195], v[212:215] cbsz:4 abid:12
    ds_read_b64_tr_b16 v[188:189], v236 offset:4160
    ds_read_b64_tr_b16 v[190:191], v236 offset:4672
    ds_read_b64_tr_b16 v[192:193], v236 offset:5216
    ds_read_b64_tr_b16 v[194:195], v236 offset:5728
    v_exp_f32 v144, v160
    v_exp_f32 v145, v161
    v_exp_f32 v146, v162
    v_exp_f32 v147, v163
    s_bitcmp1_b64 s[56:57], 2
    s_cbranch_scc1 Lf_flush2
Lf_flushed2:
    v_mfma_f32_32x32x8_bf16 v[132:147], v[228:229], v[228:229], v[132:147]
    s_bitcmp1_b64 s[60:61], 3
    s_cbranch_scc1 Lf_wb2
Lf_wbd2:
    s_bitcmp1_b64 s[60:61], 9
    s_cbranch_scc1 Lf_adv2
Lf_advd2:
    s_waitcnt lgkmcnt(4)
    v_mfma_f32_16x16x32_bf16 v[148:151], v[100:103], v[180:183], v[164:167]
    v_mfma_f32_16x16x32_bf16 v[148:151], v[104:107], v[184:187], v[148:151]
    s_waitcnt lgkmcnt(0)
    s_add_u32 m0, s52, 4160
    v_mfma_f32_16x16x32_bf16 v[152:155], v[108:111], v[180:183], v[168:171]
    buffer_load_dwordx4 v[230:231], s[20:23], 0 idxen offen nt lds
    s_add_u32 m0, s52, 5216
    v_mfma_f32_16x16x32_bf16 v[152:155], v[112:115], v[184:187], v[152:155]
    buffer_load_dwordx4 v[232:233], s[20:23], 0 idxen offen nt lds
    v_rcp_f32 v132, v132
    v_rcp_f32 v133, v133
    v_rcp_f32 v134, v134
    v_cvt_pk_bf16_f32 v132, v132, v133
    v_mfma_f32_16x16x32_bf16 v[156:159], v[116:119], v[180:183], v[172:175]
    v_rcp_f32 v135, v135
    v_rcp_f32 v136, v136
    v_cvt_pk_bf16_f32 v133, v134, v135
    v_mfma_f32_16x16x32_bf16 v[156:159], v[120:123], v[184:187], v[156:159]
    v_rcp_f32 v137, v137
    v_rcp_f32 v138, v138
    v_cvt_pk_bf16_f32 v134, v136, v137
    v_mfma_f32_16x16x32_bf16 v[160:163], v[124:127], v[180:183], v[176:179]
    v_rcp_f32 v139, v139
    v_rcp_f32 v140, v140
    v_cvt_pk_bf16_f32 v135, v138, v139
    v_mfma_f32_16x16x32_bf16 v[160:163], v[128:131], v[184:187], v[160:163]
    v_rcp_f32 v141, v141
    v_rcp_f32 v142, v142
    v_cvt_pk_bf16_f32 v136, v140, v141
    v_mfma_f32_16x16x32_bf16 v[208:211], v[132:135], v[196:199], v[204:207]
    v_rcp_f32 v143, v143
    v_rcp_f32 v144, v144
    v_cvt_pk_bf16_f32 v137, v142, v143
    v_rcp_f32 v145, v145
    v_rcp_f32 v146, v146
    v_cvt_pk_bf16_f32 v138, v144, v145
    v_rcp_f32 v147, v147
    s_nop 0
    v_cvt_pk_bf16_f32 v139, v146, v147
    s_nop 1
    v_mfma_f32_16x16x32_bf16 v[208:211], v[136:139], v[200:203], v[208:211]
    s_waitcnt vmcnt(10)
    ds_read_b128 v[180:183], v234 offset:8320
    ds_read_b128 v[184:187], v235 offset:8320
    ds_read_u8 v230, v237 offset:160
    ds_read_u8 v232, v237 offset:168
    v_exp_f32 v132, v148
    v_exp_f32 v133, v149
    v_exp_f32 v134, v150
    v_exp_f32 v135, v151
    v_cvt_pk_bf16_f32 v208, v208, v209
    v_cvt_pk_bf16_f32 v209, v210, v211
    v_exp_f32 v136, v152
    v_exp_f32 v137, v153
    v_mfma_f32_4x4x4_16b_bf16 v[212:215], v[208:209], v[188:189], v[212:215] cbsz:4 abid:0
    v_exp_f32 v138, v154
    v_exp_f32 v139, v155
    v_mfma_f32_4x4x4_16b_bf16 v[212:215], v[208:209], v[190:191], v[212:215] cbsz:4 abid:4
    v_exp_f32 v140, v156
    v_exp_f32 v141, v157
    v_mfma_f32_4x4x4_16b_bf16 v[212:215], v[208:209], v[192:193], v[212:215] cbsz:4 abid:8
    v_exp_f32 v142, v158
    v_exp_f32 v143, v159
    v_mfma_f32_4x4x4_16b_bf16 v[212:215], v[208:209], v[194:195], v[212:215] cbsz:4 abid:12
    ds_read_b64_tr_b16 v[188:189], v236 offset:6240
    ds_read_b64_tr_b16 v[190:191], v236 offset:6752
    ds_read_b64_tr_b16 v[192:193], v236 offset:7296
    ds_read_b64_tr_b16 v[194:195], v236 offset:7808
    v_exp_f32 v144, v160
    v_exp_f32 v145, v161
    v_exp_f32 v146, v162
    v_exp_f32 v147, v163
    s_bitcmp1_b64 s[56:57], 3
    s_cbranch_scc1 Lf_flush3
Lf_flushed3:
    v_mfma_f32_32x32x8_bf16 v[132:147], v[228:229], v[228:229], v[132:147]
    s_bitcmp1_b64 s[60:61], 4
    s_cbranch_scc1 Lf_wb3
Lf_wbd3:
    s_bitcmp1_b64 s[60:61], 10
    s_cbranch_scc1 Lf_adv3
Lf_advd3:
    s_waitcnt lgkmcnt(4)
    v_mfma_f32_16x16x32_bf16 v[148:151], v[100:103], v[180:183], v[164:167]
    v_mfma_f32_16x16x32_bf16 v[148:151], v[104:107], v[184:187], v[148:151]
    s_waitcnt lgkmcnt(0)
    s_add_u32 m0, s52, 6240
    v_mfma_f32_16x16x32_bf16 v[152:155], v[108:111], v[180:183], v[168:171]
    buffer_load_dwordx4 v[230:231], s[20:23], 0 idxen offen nt lds
    s_add_u32 m0, s52, 7296
    v_mfma_f32_16x16x32_bf16 v[152:155], v[112:115], v[184:187], v[152:155]
    buffer_load_dwordx4 v[232:233], s[20:23], 0 idxen offen nt lds
    v_rcp_f32 v132, v132
    v_rcp_f32 v133, v133
    v_rcp_f32 v134, v134
    v_cvt_pk_bf16_f32 v132, v132, v133
    v_mfma_f32_16x16x32_bf16 v[156:159], v[116:119], v[180:183], v[172:175]
    v_rcp_f32 v135, v135
    v_rcp_f32 v136, v136
    v_cvt_pk_bf16_f32 v133, v134, v135
    v_mfma_f32_16x16x32_bf16 v[156:159], v[120:123], v[184:187], v[156:159]
    v_rcp_f32 v137, v137
    v_rcp_f32 v138, v138
    v_cvt_pk_bf16_f32 v134, v136, v137
    v_mfma_f32_16x16x32_bf16 v[160:163], v[124:127], v[180:183], v[176:179]
    v_rcp_f32 v139, v139
    v_rcp_f32 v140, v140
    v_cvt_pk_bf16_f32 v135, v138, v139
    v_mfma_f32_16x16x32_bf16 v[160:163], v[128:131], v[184:187], v[160:163]
    v_rcp_f32 v141, v141
    v_rcp_f32 v142, v142
    v_cvt_pk_bf16_f32 v136, v140, v141
    v_mfma_f32_16x16x32_bf16 v[208:211], v[132:135], v[196:199], v[204:207]
    v_rcp_f32 v143, v143
    v_rcp_f32 v144, v144
    v_cvt_pk_bf16_f32 v137, v142, v143
    v_rcp_f32 v145, v145
    v_rcp_f32 v146, v146
    v_cvt_pk_bf16_f32 v138, v144, v145
    v_rcp_f32 v147, v147
    s_nop 0
    v_cvt_pk_bf16_f32 v139, v146, v147
    s_nop 1
    v_mfma_f32_16x16x32_bf16 v[208:211], v[136:139], v[200:203], v[208:211]
    s_waitcnt vmcnt(10)
    ds_read_b128 v[180:183], v234 offset:10400
    ds_read_b128 v[184:187], v235 offset:10400
    ds_read_u8 v230, v237 offset:176
    ds_read_u8 v232, v237 offset:184
    v_exp_f32 v132, v148
    v_exp_f32 v133, v149
    v_exp_f32 v134, v150
    v_exp_f32 v135, v151
    v_cvt_pk_bf16_f32 v208, v208, v209
    v_cvt_pk_bf16_f32 v209, v210, v211
    v_exp_f32 v136, v152
    v_exp_f32 v137, v153
    v_mfma_f32_4x4x4_16b_bf16 v[212:215], v[208:209], v[188:189], v[212:215] cbsz:4 abid:0
    v_exp_f32 v138, v154
    v_exp_f32 v139, v155
    v_mfma_f32_4x4x4_16b_bf16 v[212:215], v[208:209], v[190:191], v[212:215] cbsz:4 abid:4
    v_exp_f32 v140, v156
    v_exp_f32 v141, v157
    v_mfma_f32_4x4x4_16b_bf16 v[212:215], v[208:209], v[192:193], v[212:215] cbsz:4 abid:8
    v_exp_f32 v142, v158
    v_exp_f32 v143, v159
    v_mfma_f32_4x4x4_16b_bf16 v[212:215], v[208:209], v[194:195], v[212:215] cbsz:4 abid:12
    ds_read_b64_tr_b16 v[188:189], v236 offset:8320
    ds_read_b64_tr_b16 v[190:191], v236 offset:8832
    ds_read_b64_tr_b16 v[192:193], v236 offset:9376
    ds_read_b64_tr_b16 v[194:195], v236 offset:9888
    v_exp_f32 v144, v160
    v_exp_f32 v145, v161
    v_exp_f32 v146, v162
    v_exp_f32 v147, v163
    s_bitcmp1_b64 s[56:57], 4
    s_cbranch_scc1 Lf_flush4
Lf_flushed4:
    v_mfma_f32_32x32x8_bf16 v[132:147], v[228:229], v[228:229], v[132:147]
    s_bitcmp1_b64 s[60:61], 5
    s_cbranch_scc1 Lf_wb4
Lf_wbd4:
    s_bitcmp1_b64 s[60:61], 11
    s_cbranch_scc1 Lf_adv4
Lf_advd4:
    s_waitcnt lgkmcnt(4)
    v_mfma_f32_16x16x32_bf16 v[148:151], v[100:103], v[180:183], v[164:167]
    v_mfma_f32_16x16x32_bf16 v[148:151], v[104:107], v[184:187], v[148:151]
    s_waitcnt lgkmcnt(0)
    s_add_u32 m0, s52, 8320
    v_mfma_f32_16x16x32_bf16 v[152:155], v[108:111], v[180:183], v[168:171]
    buffer_load_dwordx4 v[230:231], s[20:23], 0 idxen offen nt lds
    s_add_u32 m0, s52, 9376
    v_mfma_f32_16x16x32_bf16 v[152:155], v[112:115], v[184:187], v[152:155]
    buffer_load_dwordx4 v[232:233], s[20:23], 0 idxen offen nt lds
    v_rcp_f32 v132, v132
    v_rcp_f32 v133, v133
    v_rcp_f32 v134, v134
    v_cvt_pk_bf16_f32 v132, v132, v133
    v_mfma_f32_16x16x32_bf16 v[156:159], v[116:119], v[180:183], v[172:175]
    v_rcp_f32 v135, v135
    v_rcp_f32 v136, v136
    v_cvt_pk_bf16_f32 v133, v134, v135
    v_mfma_f32_16x16x32_bf16 v[156:159], v[120:123], v[184:187], v[156:159]
    v_rcp_f32 v137, v137
    v_rcp_f32 v138, v138
    v_cvt_pk_bf16_f32 v134, v136, v137
    v_mfma_f32_16x16x32_bf16 v[160:163], v[124:127], v[180:183], v[176:179]
    v_rcp_f32 v139, v139
    v_rcp_f32 v140, v140
    v_cvt_pk_bf16_f32 v135, v138, v139
    v_mfma_f32_16x16x32_bf16 v[160:163], v[128:131], v[184:187], v[160:163]
    v_rcp_f32 v141, v141
    v_rcp_f32 v142, v142
    v_cvt_pk_bf16_f32 v136, v140, v141
    v_mfma_f32_16x16x32_bf16 v[208:211], v[132:135], v[196:199], v[204:207]
    v_rcp_f32 v143, v143
    v_rcp_f32 v144, v144
    v_cvt_pk_bf16_f32 v137, v142, v143
    v_rcp_f32 v145, v145
    v_rcp_f32 v146, v146
    v_cvt_pk_bf16_f32 v138, v144, v145
    v_rcp_f32 v147, v147
    s_nop 0
    v_cvt_pk_bf16_f32 v139, v146, v147
    s_nop 1
    v_mfma_f32_16x16x32_bf16 v[208:211], v[136:139], v[200:203], v[208:211]
    s_waitcnt vmcnt(10)
    ds_read_b128 v[180:183], v234 offset:12480
    ds_read_b128 v[184:187], v235 offset:12480
    ds_read_u8 v230, v237 offset:192
    ds_read_u8 v232, v237 offset:200
    v_exp_f32 v132, v148
    v_exp_f32 v133, v149
    v_exp_f32 v134, v150
    v_exp_f32 v135, v151
    v_cvt_pk_bf16_f32 v208, v208, v209
    v_cvt_pk_bf16_f32 v209, v210, v211
    v_exp_f32 v136, v152
    v_exp_f32 v137, v153
    v_mfma_f32_4x4x4_16b_bf16 v[212:215], v[208:209], v[188:189], v[212:215] cbsz:4 abid:0
    v_exp_f32 v138, v154
    v_exp_f32 v139, v155
    v_mfma_f32_4x4x4_16b_bf16 v[212:215], v[208:209], v[190:191], v[212:215] cbsz:4 abid:4
    v_exp_f32 v140, v156
    v_exp_f32 v141, v157
    v_mfma_f32_4x4x4_16b_bf16 v[212:215], v[208:209], v[192:193], v[212:215] cbsz:4 abid:8
    v_exp_f32 v142, v158
    v_exp_f32 v143, v159
    v_mfma_f32_4x4x4_16b_bf16 v[212:215], v[208:209], v[194:195], v[212:215] cbsz:4 abid:12
    ds_read_b64_tr_b16 v[188:189], v236 offset:10400
    ds_read_b64_tr_b16 v[190:191], v236 offset:10912
    ds_read_b64_tr_b16 v[192:193], v236 offset:11456
    ds_read_b64_tr_b16 v[194:195], v236 offset:11968
    v_exp_f32 v144, v160
    v_exp_f32 v145, v161
    v_exp_f32 v146, v162
    v_exp_f32 v147, v163
    s_bitcmp1_b64 s[56:57], 5
    s_cbranch_scc1 Lf_flush5
Lf_flushed5:
    v_mfma_f32_32x32x8_bf16 v[132:147], v[228:229], v[228:229], v[132:147]
    s_bitcmp1_b64 s[60:61], 6
    s_cbranch_scc1 Lf_wb5
Lf_wbd5:
    s_bitcmp1_b64 s[60:61], 12
    s_cbranch_scc1 Lf_adv5
Lf_advd5:
    s_waitcnt lgkmcnt(4)
    v_mfma_f32_16x16x32_bf16 v[148:151], v[100:103], v[180:183], v[164:167]
    v_mfma_f32_16x16x32_bf16 v[148:151], v[104:107], v[184:187], v[148:151]
    s_waitcnt lgkmcnt(0)
    s_add_u32 m0, s52, 10400
    v_mfma_f32_16x16x32_bf16 v[152:155], v[108:111], v[180:183], v[168:171]
    buffer_load_dwordx4 v[230:231], s[20:23], 0 idxen offen nt lds
    s_add_u32 m0, s52, 11456
    v_mfma_f32_16x16x32_bf16 v[152:155], v[112:115], v[184:187], v[152:155]
    buffer_load_dwordx4 v[232:233], s[20:23], 0 idxen offen nt lds
    v_rcp_f32 v132, v132
    v_rcp_f32 v133, v133
    v_rcp_f32 v134, v134
    v_cvt_pk_bf16_f32 v132, v132, v133
    v_mfma_f32_16x16x32_bf16 v[156:159], v[116:119], v[180:183], v[172:175]
    v_rcp_f32 v135, v135
    v_rcp_f32 v136, v136
    v_cvt_pk_bf16_f32 v133, v134, v135
    v_mfma_f32_16x16x32_bf16 v[156:159], v[120:123], v[184:187], v[156:159]
    v_rcp_f32 v137, v137
    v_rcp_f32 v138, v138
    v_cvt_pk_bf16_f32 v134, v136, v137
    v_mfma_f32_16x16x32_bf16 v[160:163], v[124:127], v[180:183], v[176:179]
    v_rcp_f32 v139, v139
    v_rcp_f32 v140, v140
    v_cvt_pk_bf16_f32 v135, v138, v139
    v_mfma_f32_16x16x32_bf16 v[160:163], v[128:131], v[184:187], v[160:163]
    v_rcp_f32 v141, v141
    v_rcp_f32 v142, v142
    v_cvt_pk_bf16_f32 v136, v140, v141
    v_mfma_f32_16x16x32_bf16 v[208:211], v[132:135], v[196:199], v[204:207]
    v_rcp_f32 v143, v143
    v_rcp_f32 v144, v144
    v_cvt_pk_bf16_f32 v137, v142, v143
    v_rcp_f32 v145, v145
    v_rcp_f32 v146, v146
    v_cvt_pk_bf16_f32 v138, v144, v145
    v_rcp_f32 v147, v147
    s_nop 0
    v_cvt_pk_bf16_f32 v139, v146, v147
    s_nop 1
    v_mfma_f32_16x16x32_bf16 v[208:211], v[136:139], v[200:203], v[208:211]
    s_waitcnt vmcnt(10)
    ds_read_b128 v[180:183], v234 offset:0
    ds_read_b128 v[184:187], v235 offset:0
    ds_read_u8 v230, v237 offset:208
    ds_read_u8 v232, v237 offset:216
    v_exp_f32 v132, v148
    v_exp_f32 v133, v149
    v_exp_f32 v134, v150
    v_exp_f32 v135, v151
    v_cvt_pk_bf16_f32 v208, v208, v209
    v_cvt_pk_bf16_f32 v209, v210, v211
    v_exp_f32 v136, v152
    v_exp_f32 v137, v153
    v_mfma_f32_4x4x4_16b_bf16 v[212:215], v[208:209], v[188:189], v[212:215] cbsz:4 abid:0
    v_exp_f32 v138, v154
    v_exp_f32 v139, v155
    v_mfma_f32_4x4x4_16b_bf16 v[212:215], v[208:209], v[190:191], v[212:215] cbsz:4 abid:4
    v_exp_f32 v140, v156
    v_exp_f32 v141, v157
    v_mfma_f32_4x4x4_16b_bf16 v[212:215], v[208:209], v[192:193], v[212:215] cbsz:4 abid:8
    v_exp_f32 v142, v158
    v_exp_f32 v143, v159
    v_mfma_f32_4x4x4_16b_bf16 v[212:215], v[208:209], v[194:195], v[212:215] cbsz:4 abid:12
    ds_read_b64_tr_b16 v[188:189], v236 offset:12480
    ds_read_b64_tr_b16 v[190:191], v236 offset:12992
    ds_read_b64_tr_b16 v[192:193], v236 offset:13536
    ds_read_b64_tr_b16 v[194:195], v236 offset:14048
    v_exp_f32 v144, v160
    v_exp_f32 v145, v161
    v_exp_f32 v146, v162
    v_exp_f32 v147, v163
    s_bitcmp1_b64 s[56:57], 6
    s_cbranch_scc1 Lf_flush6
Lf_flushed6:
    v_mfma_f32_32x32x8_bf16 v[132:147], v[228:229], v[228:229], v[132:147]
    s_bitcmp1_b64 s[60:61], 7
    s_cbranch_scc1 Lf_wb6
Lf_wbd6:
    s_bitcmp1_b64 s[60:61], 13
    s_cbranch_scc1 Lf_adv6
Lf_advd6:
    s_waitcnt lgkmcnt(4)
    v_mfma_f32_16x16x32_bf16 v[148:151], v[100:103], v[180:183], v[164:167]
    v_mfma_f32_16x16x32_bf16 v[148:151], v[104:107], v[184:187], v[148:151]
    s_waitcnt lgkmcnt(0)
    s_add_u32 m0, s52, 12480
    v_mfma_f32_16x16x32_bf16 v[152:155], v[108:111], v[180:183], v[168:171]
    buffer_load_dwordx4 v[230:231], s[20:23], 0 idxen offen nt lds
    s_add_u32 m0, s52, 13536
    v_mfma_f32_16x16x32_bf16 v[152:155], v[112:115], v[184:187], v[152:155]
    buffer_load_dwordx4 v[232:233], s[20:23], 0 idxen offen nt lds
    v_rcp_f32 v132, v132
    v_rcp_f32 v133, v133
    v_rcp_f32 v134, v134
    v_cvt_pk_bf16_f32 v132, v132, v133
    v_mfma_f32_16x16x32_bf16 v[156:159], v[116:119], v[180:183], v[172:175]
    v_rcp_f32 v135, v135
    v_rcp_f32 v136, v136
    v_cvt_pk_bf16_f32 v133, v134, v135
    v_mfma_f32_16x16x32_bf16 v[156:159], v[120:123], v[184:187], v[156:159]
    v_rcp_f32 v137, v137
    v_rcp_f32 v138, v138
    v_cvt_pk_bf16_f32 v134, v136, v137
    v_mfma_f32_16x16x32_bf16 v[160:163], v[124:127], v[180:183], v[176:179]
    v_rcp_f32 v139, v139
    v_rcp_f32 v140, v140
    v_cvt_pk_bf16_f32 v135, v138, v139
    v_mfma_f32_16x16x32_bf16 v[160:163], v[128:131], v[184:187], v[160:163]
    v_rcp_f32 v141, v141
    v_rcp_f32 v142, v142
    v_cvt_pk_bf16_f32 v136, v140, v141
    v_mfma_f32_16x16x32_bf16 v[208:211], v[132:135], v[196:199], v[204:207]
    v_rcp_f32 v143, v143
    v_rcp_f32 v144, v144
    v_cvt_pk_bf16_f32 v137, v142, v143
    v_rcp_f32 v145, v145
    v_rcp_f32 v146, v146
    v_cvt_pk_bf16_f32 v138, v144, v145
    v_rcp_f32 v147, v147
    s_lshr_b64 s[56:57], s[56:57], 7
    v_cvt_pk_bf16_f32 v139, v146, v147
    s_lshl_b64 s[86:87], s[58:59], 57
    s_or_b64 s[56:57], s[56:57], s[86:87]
    v_mfma_f32_16x16x32_bf16 v[208:211], v[136:139], v[200:203], v[208:211]
    s_lshr_b64 s[58:59], s[58:59], 7
    s_lshr_b64 s[60:61], s[60:61], 7
    s_lshl_b64 s[86:87], s[62:63], 57
    s_or_b64 s[60:61], s[60:61], s[86:87]
    s_lshr_b64 s[62:63], s[62:63], 7
    v_add_u32 v237, 112, v237
    s_branch Lf_loop
Lf_flush0:
    v_cvt_pk_bf16_f32 v246, v212, v212
    v_mov_b32 v212, 0
    s_sub_u32 s65, s65, 1
    ds_write_b16 v240, v246
    s_cbranch_scc1 L_store
    v_add_u32 v240, 128, v240
    s_branch Lf_flushed0
Lf_wb0:
    v_mul_u32_u24 v216, v224, v241
    v_mul_u32_u24 v217, v224, v242
    v_mul_u32_u24 v218, v225, v241
    v_mul_u32_u24 v219, v225, v242
    v_mul_u32_u24 v220, v226, v241
    v_mul_u32_u24 v221, v226, v242
    v_mul_u32_u24 v222, v227, v241
    v_mul_u32_u24 v223, v227, v242
    v_add_u32 v238, 128, v238
    ds_read_b128 v[164:167], v239
    v_mfma_f32_16x16x16_bf16 v[148:151], v[216:217], v[68:69], v[4:7]
    v_mfma_f32_16x16x16_bf16 v[152:155], v[218:219], v[70:71], v[8:11]
    ds_read_b128 v[168:171], v239 offset:64
    ds_read_b128 v[172:175], v239 offset:128
    ds_read_b128 v[176:179], v239 offset:192
    v_mfma_f32_16x16x16_bf16 v[156:159], v[220:221], v[72:73], v[12:15]
    v_mfma_f32_16x16x16_bf16 v[160:163], v[222:223], v[74:75], v[16:19]
    ds_read_u16 v224, v238 offset:0
    ds_read_u16 v225, v238 offset:8
    ds_read_u16 v226, v238 offset:64
    ds_read_u16 v227, v238 offset:72
    v_mfma_f32_16x16x16_bf16 v[246:249], v[216:217], v[76:77], v[20:23]
    v_mfma_f32_16x16x16_bf16 v[250:253], v[218:219], v[78:79], v[24:27]
    v_add_u32 v239, 256, v239
    v_cvt_pk_bf16_f32 v100, v148, v149
    v_cvt_pk_bf16_f32 v101, v150, v151
    v_cvt_pk_bf16_f32 v102, v152, v153
    v_cvt_pk_bf16_f32 v103, v154, v155
    v_mfma_f32_16x16x16_bf16 v[148:151], v[220:221], v[80:81], v[28:31]
    v_mfma_f32_16x16x16_bf16 v[152:155], v[222:223], v[82:83], v[32:35]
    v_cvt_pk_bf16_f32 v104, v156, v157
    v_cvt_pk_bf16_f32 v105, v158, v159
    v_cvt_pk_bf16_f32 v106, v160, v161
    v_cvt_pk_bf16_f32 v107, v162, v163
    v_mfma_f32_16x16x16_bf16 v[156:159], v[216:217], v[84:85], v[36:39]
    v_mfma_f32_16x16x16_bf16 v[160:163], v[218:219], v[86:87], v[40:43]
    v_cvt_pk_bf16_f32 v108, v246, v247
    v_cvt_pk_bf16_f32 v109, v248, v249
    v_cvt_pk_bf16_f32 v110, v250, v251
    v_cvt_pk_bf16_f32 v111, v252, v253
    v_mfma_f32_16x16x16_bf16 v[246:249], v[220:221], v[88:89], v[44:47]
    v_mfma_f32_16x16x16_bf16 v[250:253], v[222:223], v[90:91], v[48:51]
    v_cvt_pk_bf16_f32 v112, v148, v149
    v_cvt_pk_bf16_f32 v113, v150, v151
    v_cvt_pk_bf16_f32 v114, v152, v153
    v_cvt_pk_bf16_f32 v115, v154, v155
    v_mfma_f32_16x16x16_bf16 v[148:151], v[216:217], v[92:93], v[52:55]
    v_mfma_f32_16x16x16_bf16 v[152:155], v[218:219], v[94:95], v[56:59]
    v_cvt_pk_bf16_f32 v116, v156, v157
    v_cvt_pk_bf16_f32 v117, v158, v159
    v_cvt_pk_bf16_f32 v118, v160, v161
    v_cvt_pk_bf16_f32 v119, v162, v163
    v_mfma_f32_16x16x16_bf16 v[156:159], v[220:221], v[96:97], v[60:63]
    v_mfma_f32_16x16x16_bf16 v[160:163], v[222:223], v[98:99], v[64:67]
    v_cvt_pk_bf16_f32 v120, v246, v247
    v_cvt_pk_bf16_f32 v121, v248, v249
    v_cvt_pk_bf16_f32 v122, v250, v251
    v_cvt_pk_bf16_f32 v123, v252, v253
    v_cvt_pk_bf16_f32 v124, v148, v149
    v_cvt_pk_bf16_f32 v125, v150, v151
    v_cvt_pk_bf16_f32 v126, v152, v153
    v_cvt_pk_bf16_f32 v127, v154, v155
    v_cvt_pk_bf16_f32 v128, v156, v157
    v_cvt_pk_bf16_f32 v129, v158, v159
    v_cvt_pk_bf16_f32 v130, v160, v161
    v_cvt_pk_bf16_f32 v131, v162, v163
    s_waitcnt lgkmcnt(0)
    s_branch Lf_wbd0
Lf_adv0:
    s_add_u32 s20, s20, 52428800
    s_addc_u32 s21, s21, 0
    s_branch Lf_advd0
Lf_flush1:
    v_cvt_pk_bf16_f32 v246, v212, v212
    v_mov_b32 v212, 0
    s_sub_u32 s65, s65, 1
    ds_write_b16 v240, v246
    s_cbranch_scc1 L_store
    v_add_u32 v240, 128, v240
    s_branch Lf_flushed1
Lf_wb1:
    v_mul_u32_u24 v216, v224, v241
    v_mul_u32_u24 v217, v224, v242
    v_mul_u32_u24 v218, v225, v241
    v_mul_u32_u24 v219, v225, v242
    v_mul_u32_u24 v220, v226, v241
    v_mul_u32_u24 v221, v226, v242
    v_mul_u32_u24 v222, v227, v241
    v_mul_u32_u24 v223, v227, v242
    v_add_u32 v238, 128, v238
    ds_read_b128 v[164:167], v239
    v_mfma_f32_16x16x16_bf16 v[148:151], v[216:217], v[68:69], v[4:7]
    v_mfma_f32_16x16x16_bf16 v[152:155], v[218:219], v[70:71], v[8:11]
    ds_read_b128 v[168:171], v239 offset:64
    ds_read_b128 v[172:175], v239 offset:128
    ds_read_b128 v[176:179], v239 offset:192
    v_mfma_f32_16x16x16_bf16 v[156:159], v[220:221], v[72:73], v[12:15]
    v_mfma_f32_16x16x16_bf16 v[160:163], v[222:223], v[74:75], v[16:19]
    ds_read_u16 v224, v238 offset:0
    ds_read_u16 v225, v238 offset:8
    ds_read_u16 v226, v238 offset:64
    ds_read_u16 v227, v238 offset:72
    v_mfma_f32_16x16x16_bf16 v[246:249], v[216:217], v[76:77], v[20:23]
    v_mfma_f32_16x16x16_bf16 v[250:253], v[218:219], v[78:79], v[24:27]
    v_add_u32 v239, 256, v239
    v_cvt_pk_bf16_f32 v100, v148, v149
    v_cvt_pk_bf16_f32 v101, v150, v151
    v_cvt_pk_bf16_f32 v102, v152, v153
    v_cvt_pk_bf16_f32 v103, v154, v155
    v_mfma_f32_16x16x16_bf16 v[148:151], v[220:221], v[80:81], v[28:31]
    v_mfma_f32_16x16x16_bf16 v[152:155], v[222:223], v[82:83], v[32:35]
    v_cvt_pk_bf16_f32 v104, v156, v157
    v_cvt_pk_bf16_f32 v105, v158, v159
    v_cvt_pk_bf16_f32 v106, v160, v161
    v_cvt_pk_bf16_f32 v107, v162, v163
    v_mfma_f32_16x16x16_bf16 v[156:159], v[216:217], v[84:85], v[36:39]
    v_mfma_f32_16x16x16_bf16 v[160:163], v[218:219], v[86:87], v[40:43]
    v_cvt_pk_bf16_f32 v108, v246, v247
    v_cvt_pk_bf16_f32 v109, v248, v249
    v_cvt_pk_bf16_f32 v110, v250, v251
    v_cvt_pk_bf16_f32 v111, v252, v253
    v_mfma_f32_16x16x16_bf16 v[246:249], v[220:221], v[88:89], v[44:47]
    v_mfma_f32_16x16x16_bf16 v[250:253], v[222:223], v[90:91], v[48:51]
    v_cvt_pk_bf16_f32 v112, v148, v149
    v_cvt_pk_bf16_f32 v113, v150, v151
    v_cvt_pk_bf16_f32 v114, v152, v153
    v_cvt_pk_bf16_f32 v115, v154, v155
    v_mfma_f32_16x16x16_bf16 v[148:151], v[216:217], v[92:93], v[52:55]
    v_mfma_f32_16x16x16_bf16 v[152:155], v[218:219], v[94:95], v[56:59]
    v_cvt_pk_bf16_f32 v116, v156, v157
    v_cvt_pk_bf16_f32 v117, v158, v159
    v_cvt_pk_bf16_f32 v118, v160, v161
    v_cvt_pk_bf16_f32 v119, v162, v163
    v_mfma_f32_16x16x16_bf16 v[156:159], v[220:221], v[96:97], v[60:63]
    v_mfma_f32_16x16x16_bf16 v[160:163], v[222:223], v[98:99], v[64:67]
    v_cvt_pk_bf16_f32 v120, v246, v247
    v_cvt_pk_bf16_f32 v121, v248, v249
    v_cvt_pk_bf16_f32 v122, v250, v251
    v_cvt_pk_bf16_f32 v123, v252, v253
    v_cvt_pk_bf16_f32 v124, v148, v149
    v_cvt_pk_bf16_f32 v125, v150, v151
    v_cvt_pk_bf16_f32 v126, v152, v153
    v_cvt_pk_bf16_f32 v127, v154, v155
    v_cvt_pk_bf16_f32 v128, v156, v157
    v_cvt_pk_bf16_f32 v129, v158, v159
    v_cvt_pk_bf16_f32 v130, v160, v161
    v_cvt_pk_bf16_f32 v131, v162, v163
    s_waitcnt lgkmcnt(0)
    s_branch Lf_wbd1
Lf_adv1:
    s_add_u32 s20, s20, 52428800
    s_addc_u32 s21, s21, 0
    s_branch Lf_advd1
Lf_flush2:
    v_cvt_pk_bf16_f32 v246, v212, v212
    v_mov_b32 v212, 0
    s_sub_u32 s65, s65, 1
    ds_write_b16 v240, v246
    s_cbranch_scc1 L_store
    v_add_u32 v240, 128, v240
    s_branch Lf_flushed2
Lf_wb2:
    v_mul_u32_u24 v216, v224, v241
    v_mul_u32_u24 v217, v224, v242
    v_mul_u32_u24 v218, v225, v241
    v_mul_u32_u24 v219, v225, v242
    v_mul_u32_u24 v220, v226, v241
    v_mul_u32_u24 v221, v226, v242
    v_mul_u32_u24 v222, v227, v241
    v_mul_u32_u24 v223, v227, v242
    v_add_u32 v238, 128, v238
    ds_read_b128 v[164:167], v239
    v_mfma_f32_16x16x16_bf16 v[148:151], v[216:217], v[68:69], v[4:7]
    v_mfma_f32_16x16x16_bf16 v[152:155], v[218:219], v[70:71], v[8:11]
    ds_read_b128 v[168:171], v239 offset:64
    ds_read_b128 v[172:175], v239 offset:128
    ds_read_b128 v[176:179], v239 offset:192
    v_mfma_f32_16x16x16_bf16 v[156:159], v[220:221], v[72:73], v[12:15]
    v_mfma_f32_16x16x16_bf16 v[160:163], v[222:223], v[74:75], v[16:19]
    ds_read_u16 v224, v238 offset:0
    ds_read_u16 v225, v238 offset:8
    ds_read_u16 v226, v238 offset:64
    ds_read_u16 v227, v238 offset:72
    v_mfma_f32_16x16x16_bf16 v[246:249], v[216:217], v[76:77], v[20:23]
    v_mfma_f32_16x16x16_bf16 v[250:253], v[218:219], v[78:79], v[24:27]
    v_add_u32 v239, 256, v239
    v_cvt_pk_bf16_f32 v100, v148, v149
    v_cvt_pk_bf16_f32 v101, v150, v151
    v_cvt_pk_bf16_f32 v102, v152, v153
    v_cvt_pk_bf16_f32 v103, v154, v155
    v_mfma_f32_16x16x16_bf16 v[148:151], v[220:221], v[80:81], v[28:31]
    v_mfma_f32_16x16x16_bf16 v[152:155], v[222:223], v[82:83], v[32:35]
    v_cvt_pk_bf16_f32 v104, v156, v157
    v_cvt_pk_bf16_f32 v105, v158, v159
    v_cvt_pk_bf16_f32 v106, v160, v161
    v_cvt_pk_bf16_f32 v107, v162, v163
    v_mfma_f32_16x16x16_bf16 v[156:159], v[216:217], v[84:85], v[36:39]
    v_mfma_f32_16x16x16_bf16 v[160:163], v[218:219], v[86:87], v[40:43]
    v_cvt_pk_bf16_f32 v108, v246, v247
    v_cvt_pk_bf16_f32 v109, v248, v249
    v_cvt_pk_bf16_f32 v110, v250, v251
    v_cvt_pk_bf16_f32 v111, v252, v253
    v_mfma_f32_16x16x16_bf16 v[246:249], v[220:221], v[88:89], v[44:47]
    v_mfma_f32_16x16x16_bf16 v[250:253], v[222:223], v[90:91], v[48:51]
    v_cvt_pk_bf16_f32 v112, v148, v149
    v_cvt_pk_bf16_f32 v113, v150, v151
    v_cvt_pk_bf16_f32 v114, v152, v153
    v_cvt_pk_bf16_f32 v115, v154, v155
    v_mfma_f32_16x16x16_bf16 v[148:151], v[216:217], v[92:93], v[52:55]
    v_mfma_f32_16x16x16_bf16 v[152:155], v[218:219], v[94:95], v[56:59]
    v_cvt_pk_bf16_f32 v116, v156, v157
    v_cvt_pk_bf16_f32 v117, v158, v159
    v_cvt_pk_bf16_f32 v118, v160, v161
    v_cvt_pk_bf16_f32 v119, v162, v163
    v_mfma_f32_16x16x16_bf16 v[156:159], v[220:221], v[96:97], v[60:63]
    v_mfma_f32_16x16x16_bf16 v[160:163], v[222:223], v[98:99], v[64:67]
    v_cvt_pk_bf16_f32 v120, v246, v247
    v_cvt_pk_bf16_f32 v121, v248, v249
    v_cvt_pk_bf16_f32 v122, v250, v251
    v_cvt_pk_bf16_f32 v123, v252, v253
    v_cvt_pk_bf16_f32 v124, v148, v149
    v_cvt_pk_bf16_f32 v125, v150, v151
    v_cvt_pk_bf16_f32 v126, v152, v153
    v_cvt_pk_bf16_f32 v127, v154, v155
    v_cvt_pk_bf16_f32 v128, v156, v157
    v_cvt_pk_bf16_f32 v129, v158, v159
    v_cvt_pk_bf16_f32 v130, v160, v161
    v_cvt_pk_bf16_f32 v131, v162, v163
    s_waitcnt lgkmcnt(0)
    s_branch Lf_wbd2
Lf_adv2:
    s_add_u32 s20, s20, 52428800
    s_addc_u32 s21, s21, 0
    s_branch Lf_advd2
Lf_flush3:
    v_cvt_pk_bf16_f32 v246, v212, v212
    v_mov_b32 v212, 0
    s_sub_u32 s65, s65, 1
    ds_write_b16 v240, v246
    s_cbranch_scc1 L_store
    v_add_u32 v240, 128, v240
    s_branch Lf_flushed3
Lf_wb3:
    v_mul_u32_u24 v216, v224, v241
    v_mul_u32_u24 v217, v224, v242
    v_mul_u32_u24 v218, v225, v241
    v_mul_u32_u24 v219, v225, v242
    v_mul_u32_u24 v220, v226, v241
    v_mul_u32_u24 v221, v226, v242
    v_mul_u32_u24 v222, v227, v241
    v_mul_u32_u24 v223, v227, v242
    v_add_u32 v238, 128, v238
    ds_read_b128 v[164:167], v239
    v_mfma_f32_16x16x16_bf16 v[148:151], v[216:217], v[68:69], v[4:7]
    v_mfma_f32_16x16x16_bf16 v[152:155], v[218:219], v[70:71], v[8:11]
    ds_read_b128 v[168:171], v239 offset:64
    ds_read_b128 v[172:175], v239 offset:128
    ds_read_b128 v[176:179], v239 offset:192
    v_mfma_f32_16x16x16_bf16 v[156:159], v[220:221], v[72:73], v[12:15]
    v_mfma_f32_16x16x16_bf16 v[160:163], v[222:223], v[74:75], v[16:19]
    ds_read_u16 v224, v238 offset:0
    ds_read_u16 v225, v238 offset:8
    ds_read_u16 v226, v238 offset:64
    ds_read_u16 v227, v238 offset:72
    v_mfma_f32_16x16x16_bf16 v[246:249], v[216:217], v[76:77], v[20:23]
    v_mfma_f32_16x16x16_bf16 v[250:253], v[218:219], v[78:79], v[24:27]
    v_add_u32 v239, 256, v239
    v_cvt_pk_bf16_f32 v100, v148, v149
    v_cvt_pk_bf16_f32 v101, v150, v151
    v_cvt_pk_bf16_f32 v102, v152, v153
    v_cvt_pk_bf16_f32 v103, v154, v155
    v_mfma_f32_16x16x16_bf16 v[148:151], v[220:221], v[80:81], v[28:31]
    v_mfma_f32_16x16x16_bf16 v[152:155], v[222:223], v[82:83], v[32:35]
    v_cvt_pk_bf16_f32 v104, v156, v157
    v_cvt_pk_bf16_f32 v105, v158, v159
    v_cvt_pk_bf16_f32 v106, v160, v161
    v_cvt_pk_bf16_f32 v107, v162, v163
    v_mfma_f32_16x16x16_bf16 v[156:159], v[216:217], v[84:85], v[36:39]
    v_mfma_f32_16x16x16_bf16 v[160:163], v[218:219], v[86:87], v[40:43]
    v_cvt_pk_bf16_f32 v108, v246, v247
    v_cvt_pk_bf16_f32 v109, v248, v249
    v_cvt_pk_bf16_f32 v110, v250, v251
    v_cvt_pk_bf16_f32 v111, v252, v253
    v_mfma_f32_16x16x16_bf16 v[246:249], v[220:221], v[88:89], v[44:47]
    v_mfma_f32_16x16x16_bf16 v[250:253], v[222:223], v[90:91], v[48:51]
    v_cvt_pk_bf16_f32 v112, v148, v149
    v_cvt_pk_bf16_f32 v113, v150, v151
    v_cvt_pk_bf16_f32 v114, v152, v153
    v_cvt_pk_bf16_f32 v115, v154, v155
    v_mfma_f32_16x16x16_bf16 v[148:151], v[216:217], v[92:93], v[52:55]
    v_mfma_f32_16x16x16_bf16 v[152:155], v[218:219], v[94:95], v[56:59]
    v_cvt_pk_bf16_f32 v116, v156, v157
    v_cvt_pk_bf16_f32 v117, v158, v159
    v_cvt_pk_bf16_f32 v118, v160, v161
    v_cvt_pk_bf16_f32 v119, v162, v163
    v_mfma_f32_16x16x16_bf16 v[156:159], v[220:221], v[96:97], v[60:63]
    v_mfma_f32_16x16x16_bf16 v[160:163], v[222:223], v[98:99], v[64:67]
    v_cvt_pk_bf16_f32 v120, v246, v247
    v_cvt_pk_bf16_f32 v121, v248, v249
    v_cvt_pk_bf16_f32 v122, v250, v251
    v_cvt_pk_bf16_f32 v123, v252, v253
    v_cvt_pk_bf16_f32 v124, v148, v149
    v_cvt_pk_bf16_f32 v125, v150, v151
    v_cvt_pk_bf16_f32 v126, v152, v153
    v_cvt_pk_bf16_f32 v127, v154, v155
    v_cvt_pk_bf16_f32 v128, v156, v157
    v_cvt_pk_bf16_f32 v129, v158, v159
    v_cvt_pk_bf16_f32 v130, v160, v161
    v_cvt_pk_bf16_f32 v131, v162, v163
    s_waitcnt lgkmcnt(0)
    s_branch Lf_wbd3
Lf_adv3:
    s_add_u32 s20, s20, 52428800
    s_addc_u32 s21, s21, 0
    s_branch Lf_advd3
Lf_flush4:
    v_cvt_pk_bf16_f32 v246, v212, v212
    v_mov_b32 v212, 0
    s_sub_u32 s65, s65, 1
    ds_write_b16 v240, v246
    s_cbranch_scc1 L_store
    v_add_u32 v240, 128, v240
    s_branch Lf_flushed4
Lf_wb4:
    v_mul_u32_u24 v216, v224, v241
    v_mul_u32_u24 v217, v224, v242
    v_mul_u32_u24 v218, v225, v241
    v_mul_u32_u24 v219, v225, v242
    v_mul_u32_u24 v220, v226, v241
    v_mul_u32_u24 v221, v226, v242
    v_mul_u32_u24 v222, v227, v241
    v_mul_u32_u24 v223, v227, v242
    v_add_u32 v238, 128, v238
    ds_read_b128 v[164:167], v239
    v_mfma_f32_16x16x16_bf16 v[148:151], v[216:217], v[68:69], v[4:7]
    v_mfma_f32_16x16x16_bf16 v[152:155], v[218:219], v[70:71], v[8:11]
    ds_read_b128 v[168:171], v239 offset:64
    ds_read_b128 v[172:175], v239 offset:128
    ds_read_b128 v[176:179], v239 offset:192
    v_mfma_f32_16x16x16_bf16 v[156:159], v[220:221], v[72:73], v[12:15]
    v_mfma_f32_16x16x16_bf16 v[160:163], v[222:223], v[74:75], v[16:19]
    ds_read_u16 v224, v238 offset:0
    ds_read_u16 v225, v238 offset:8
    ds_read_u16 v226, v238 offset:64
    ds_read_u16 v227, v238 offset:72
    v_mfma_f32_16x16x16_bf16 v[246:249], v[216:217], v[76:77], v[20:23]
    v_mfma_f32_16x16x16_bf16 v[250:253], v[218:219], v[78:79], v[24:27]
    v_add_u32 v239, 256, v239
    v_cvt_pk_bf16_f32 v100, v148, v149
    v_cvt_pk_bf16_f32 v101, v150, v151
    v_cvt_pk_bf16_f32 v102, v152, v153
    v_cvt_pk_bf16_f32 v103, v154, v155
    v_mfma_f32_16x16x16_bf16 v[148:151], v[220:221], v[80:81], v[28:31]
    v_mfma_f32_16x16x16_bf16 v[152:155], v[222:223], v[82:83], v[32:35]
    v_cvt_pk_bf16_f32 v104, v156, v157
    v_cvt_pk_bf16_f32 v105, v158, v159
    v_cvt_pk_bf16_f32 v106, v160, v161
    v_cvt_pk_bf16_f32 v107, v162, v163
    v_mfma_f32_16x16x16_bf16 v[156:159], v[216:217], v[84:85], v[36:39]
    v_mfma_f32_16x16x16_bf16 v[160:163], v[218:219], v[86:87], v[40:43]
    v_cvt_pk_bf16_f32 v108, v246, v247
    v_cvt_pk_bf16_f32 v109, v248, v249
    v_cvt_pk_bf16_f32 v110, v250, v251
    v_cvt_pk_bf16_f32 v111, v252, v253
    v_mfma_f32_16x16x16_bf16 v[246:249], v[220:221], v[88:89], v[44:47]
    v_mfma_f32_16x16x16_bf16 v[250:253], v[222:223], v[90:91], v[48:51]
    v_cvt_pk_bf16_f32 v112, v148, v149
    v_cvt_pk_bf16_f32 v113, v150, v151
    v_cvt_pk_bf16_f32 v114, v152, v153
    v_cvt_pk_bf16_f32 v115, v154, v155
    v_mfma_f32_16x16x16_bf16 v[148:151], v[216:217], v[92:93], v[52:55]
    v_mfma_f32_16x16x16_bf16 v[152:155], v[218:219], v[94:95], v[56:59]
    v_cvt_pk_bf16_f32 v116, v156, v157
    v_cvt_pk_bf16_f32 v117, v158, v159
    v_cvt_pk_bf16_f32 v118, v160, v161
    v_cvt_pk_bf16_f32 v119, v162, v163
    v_mfma_f32_16x16x16_bf16 v[156:159], v[220:221], v[96:97], v[60:63]
    v_mfma_f32_16x16x16_bf16 v[160:163], v[222:223], v[98:99], v[64:67]
    v_cvt_pk_bf16_f32 v120, v246, v247
    v_cvt_pk_bf16_f32 v121, v248, v249
    v_cvt_pk_bf16_f32 v122, v250, v251
    v_cvt_pk_bf16_f32 v123, v252, v253
    v_cvt_pk_bf16_f32 v124, v148, v149
    v_cvt_pk_bf16_f32 v125, v150, v151
    v_cvt_pk_bf16_f32 v126, v152, v153
    v_cvt_pk_bf16_f32 v127, v154, v155
    v_cvt_pk_bf16_f32 v128, v156, v157
    v_cvt_pk_bf16_f32 v129, v158, v159
    v_cvt_pk_bf16_f32 v130, v160, v161
    v_cvt_pk_bf16_f32 v131, v162, v163
    s_waitcnt lgkmcnt(0)
    s_branch Lf_wbd4
Lf_adv4:
    s_add_u32 s20, s20, 52428800
    s_addc_u32 s21, s21, 0
    s_branch Lf_advd4
Lf_flush5:
    v_cvt_pk_bf16_f32 v246, v212, v212
    v_mov_b32 v212, 0
    s_sub_u32 s65, s65, 1
    ds_write_b16 v240, v246
    s_cbranch_scc1 L_store
    v_add_u32 v240, 128, v240
    s_branch Lf_flushed5
Lf_wb5:
    v_mul_u32_u24 v216, v224, v241
    v_mul_u32_u24 v217, v224, v242
    v_mul_u32_u24 v218, v225, v241
    v_mul_u32_u24 v219, v225, v242
    v_mul_u32_u24 v220, v226, v241
    v_mul_u32_u24 v221, v226, v242
    v_mul_u32_u24 v222, v227, v241
    v_mul_u32_u24 v223, v227, v242
    v_add_u32 v238, 128, v238
    ds_read_b128 v[164:167], v239
    v_mfma_f32_16x16x16_bf16 v[148:151], v[216:217], v[68:69], v[4:7]
    v_mfma_f32_16x16x16_bf16 v[152:155], v[218:219], v[70:71], v[8:11]
    ds_read_b128 v[168:171], v239 offset:64
    ds_read_b128 v[172:175], v239 offset:128
    ds_read_b128 v[176:179], v239 offset:192
    v_mfma_f32_16x16x16_bf16 v[156:159], v[220:221], v[72:73], v[12:15]
    v_mfma_f32_16x16x16_bf16 v[160:163], v[222:223], v[74:75], v[16:19]
    ds_read_u16 v224, v238 offset:0
    ds_read_u16 v225, v238 offset:8
    ds_read_u16 v226, v238 offset:64
    ds_read_u16 v227, v238 offset:72
    v_mfma_f32_16x16x16_bf16 v[246:249], v[216:217], v[76:77], v[20:23]
    v_mfma_f32_16x16x16_bf16 v[250:253], v[218:219], v[78:79], v[24:27]
    v_add_u32 v239, 256, v239
    v_cvt_pk_bf16_f32 v100, v148, v149
    v_cvt_pk_bf16_f32 v101, v150, v151
    v_cvt_pk_bf16_f32 v102, v152, v153
    v_cvt_pk_bf16_f32 v103, v154, v155
    v_mfma_f32_16x16x16_bf16 v[148:151], v[220:221], v[80:81], v[28:31]
    v_mfma_f32_16x16x16_bf16 v[152:155], v[222:223], v[82:83], v[32:35]
    v_cvt_pk_bf16_f32 v104, v156, v157
    v_cvt_pk_bf16_f32 v105, v158, v159
    v_cvt_pk_bf16_f32 v106, v160, v161
    v_cvt_pk_bf16_f32 v107, v162, v163
    v_mfma_f32_16x16x16_bf16 v[156:159], v[216:217], v[84:85], v[36:39]
    v_mfma_f32_16x16x16_bf16 v[160:163], v[218:219], v[86:87], v[40:43]
    v_cvt_pk_bf16_f32 v108, v246, v247
    v_cvt_pk_bf16_f32 v109, v248, v249
    v_cvt_pk_bf16_f32 v110, v250, v251
    v_cvt_pk_bf16_f32 v111, v252, v253
    v_mfma_f32_16x16x16_bf16 v[246:249], v[220:221], v[88:89], v[44:47]
    v_mfma_f32_16x16x16_bf16 v[250:253], v[222:223], v[90:91], v[48:51]
    v_cvt_pk_bf16_f32 v112, v148, v149
    v_cvt_pk_bf16_f32 v113, v150, v151
    v_cvt_pk_bf16_f32 v114, v152, v153
    v_cvt_pk_bf16_f32 v115, v154, v155
    v_mfma_f32_16x16x16_bf16 v[148:151], v[216:217], v[92:93], v[52:55]
    v_mfma_f32_16x16x16_bf16 v[152:155], v[218:219], v[94:95], v[56:59]
    v_cvt_pk_bf16_f32 v116, v156, v157
    v_cvt_pk_bf16_f32 v117, v158, v159
    v_cvt_pk_bf16_f32 v118, v160, v161
    v_cvt_pk_bf16_f32 v119, v162, v163
    v_mfma_f32_16x16x16_bf16 v[156:159], v[220:221], v[96:97], v[60:63]
    v_mfma_f32_16x16x16_bf16 v[160:163], v[222:223], v[98:99], v[64:67]
    v_cvt_pk_bf16_f32 v120, v246, v247
    v_cvt_pk_bf16_f32 v121, v248, v249
    v_cvt_pk_bf16_f32 v122, v250, v251
    v_cvt_pk_bf16_f32 v123, v252, v253
    v_cvt_pk_bf16_f32 v124, v148, v149
    v_cvt_pk_bf16_f32 v125, v150, v151
    v_cvt_pk_bf16_f32 v126, v152, v153
    v_cvt_pk_bf16_f32 v127, v154, v155
    v_cvt_pk_bf16_f32 v128, v156, v157
    v_cvt_pk_bf16_f32 v129, v158, v159
    v_cvt_pk_bf16_f32 v130, v160, v161
    v_cvt_pk_bf16_f32 v131, v162, v163
    s_waitcnt lgkmcnt(0)
    s_branch Lf_wbd5
Lf_adv5:
    s_add_u32 s20, s20, 52428800
    s_addc_u32 s21, s21, 0
    s_branch Lf_advd5
Lf_flush6:
    v_cvt_pk_bf16_f32 v246, v212, v212
    v_mov_b32 v212, 0
    s_sub_u32 s65, s65, 1
    ds_write_b16 v240, v246
    s_cbranch_scc1 L_store
    v_add_u32 v240, 128, v240
    s_branch Lf_flushed6
Lf_wb6:
    v_mul_u32_u24 v216, v224, v241
    v_mul_u32_u24 v217, v224, v242
    v_mul_u32_u24 v218, v225, v241
    v_mul_u32_u24 v219, v225, v242
    v_mul_u32_u24 v220, v226, v241
    v_mul_u32_u24 v221, v226, v242
    v_mul_u32_u24 v222, v227, v241
    v_mul_u32_u24 v223, v227, v242
    v_add_u32 v238, 128, v238
    ds_read_b128 v[164:167], v239
    v_mfma_f32_16x16x16_bf16 v[148:151], v[216:217], v[68:69], v[4:7]
    v_mfma_f32_16x16x16_bf16 v[152:155], v[218:219], v[70:71], v[8:11]
    ds_read_b128 v[168:171], v239 offset:64
    ds_read_b128 v[172:175], v239 offset:128
    ds_read_b128 v[176:179], v239 offset:192
    v_mfma_f32_16x16x16_bf16 v[156:159], v[220:221], v[72:73], v[12:15]
    v_mfma_f32_16x16x16_bf16 v[160:163], v[222:223], v[74:75], v[16:19]
    ds_read_u16 v224, v238 offset:0
    ds_read_u16 v225, v238 offset:8
    ds_read_u16 v226, v238 offset:64
    ds_read_u16 v227, v238 offset:72
    v_mfma_f32_16x16x16_bf16 v[246:249], v[216:217], v[76:77], v[20:23]
    v_mfma_f32_16x16x16_bf16 v[250:253], v[218:219], v[78:79], v[24:27]
    v_add_u32 v239, 256, v239
    v_cvt_pk_bf16_f32 v100, v148, v149
    v_cvt_pk_bf16_f32 v101, v150, v151
    v_cvt_pk_bf16_f32 v102, v152, v153
    v_cvt_pk_bf16_f32 v103, v154, v155
    v_mfma_f32_16x16x16_bf16 v[148:151], v[220:221], v[80:81], v[28:31]
    v_mfma_f32_16x16x16_bf16 v[152:155], v[222:223], v[82:83], v[32:35]
    v_cvt_pk_bf16_f32 v104, v156, v157
    v_cvt_pk_bf16_f32 v105, v158, v159
    v_cvt_pk_bf16_f32 v106, v160, v161
    v_cvt_pk_bf16_f32 v107, v162, v163
    v_mfma_f32_16x16x16_bf16 v[156:159], v[216:217], v[84:85], v[36:39]
    v_mfma_f32_16x16x16_bf16 v[160:163], v[218:219], v[86:87], v[40:43]
    v_cvt_pk_bf16_f32 v108, v246, v247
    v_cvt_pk_bf16_f32 v109, v248, v249
    v_cvt_pk_bf16_f32 v110, v250, v251
    v_cvt_pk_bf16_f32 v111, v252, v253
    v_mfma_f32_16x16x16_bf16 v[246:249], v[220:221], v[88:89], v[44:47]
    v_mfma_f32_16x16x16_bf16 v[250:253], v[222:223], v[90:91], v[48:51]
    v_cvt_pk_bf16_f32 v112, v148, v149
    v_cvt_pk_bf16_f32 v113, v150, v151
    v_cvt_pk_bf16_f32 v114, v152, v153
    v_cvt_pk_bf16_f32 v115, v154, v155
    v_mfma_f32_16x16x16_bf16 v[148:151], v[216:217], v[92:93], v[52:55]
    v_mfma_f32_16x16x16_bf16 v[152:155], v[218:219], v[94:95], v[56:59]
    v_cvt_pk_bf16_f32 v116, v156, v157
    v_cvt_pk_bf16_f32 v117, v158, v159
    v_cvt_pk_bf16_f32 v118, v160, v161
    v_cvt_pk_bf16_f32 v119, v162, v163
    v_mfma_f32_16x16x16_bf16 v[156:159], v[220:221], v[96:97], v[60:63]
    v_mfma_f32_16x16x16_bf16 v[160:163], v[222:223], v[98:99], v[64:67]
    v_cvt_pk_bf16_f32 v120, v246, v247
    v_cvt_pk_bf16_f32 v121, v248, v249
    v_cvt_pk_bf16_f32 v122, v250, v251
    v_cvt_pk_bf16_f32 v123, v252, v253
    v_cvt_pk_bf16_f32 v124, v148, v149
    v_cvt_pk_bf16_f32 v125, v150, v151
    v_cvt_pk_bf16_f32 v126, v152, v153
    v_cvt_pk_bf16_f32 v127, v154, v155
    v_cvt_pk_bf16_f32 v128, v156, v157
    v_cvt_pk_bf16_f32 v129, v158, v159
    v_cvt_pk_bf16_f32 v130, v160, v161
    v_cvt_pk_bf16_f32 v131, v162, v163
    s_waitcnt lgkmcnt(0)
    s_branch Lf_wbd6
Lf_adv6:
    s_add_u32 s20, s20, 52428800
    s_addc_u32 s21, s21, 0
    s_branch Lf_advd6
L_slow:
    s_mul_i32 s66, s53, 400
    s_add_u32 s8, s8, s66
    s_addc_u32 s9, s9, 0
    s_mov_b32 s24, s8
    s_and_b32 s25, s9, 0xffff
    s_mov_b32 s26, 400
    s_mov_b32 s27, 0x20000
Ls_loop:
    ds_read_b32 v246, v244 offset:0
    s_waitcnt lgkmcnt(0)
    v_bfe_u32 v247, v246, 0, 8
    v_lshlrev_b32 v247, 1, v247
    v_bfe_u32 v248, v246, 8, 8
    v_lshlrev_b32 v248, 1, v248
    v_bfe_u32 v249, v246, 16, 8
    v_lshlrev_b32 v249, 1, v249
    v_bfe_u32 v250, v246, 24, 8
    v_lshlrev_b32 v250, 1, v250
    buffer_load_ushort v247, v247, s[24:27], 0 offen
    buffer_load_ushort v248, v248, s[24:27], 0 offen
    buffer_load_ushort v249, v249, s[24:27], 0 offen
    buffer_load_ushort v250, v250, s[24:27], 0 offen
    s_waitcnt vmcnt(0)
    v_lshlrev_b32 v247, 16, v247
    v_mul_f32 v208, v208, v247
    v_lshlrev_b32 v248, 16, v248
    v_mul_f32 v209, v209, v248
    v_lshlrev_b32 v249, 16, v249
    v_mul_f32 v210, v210, v249
    v_lshlrev_b32 v250, 16, v250
    v_mul_f32 v211, v211, v250
    s_waitcnt vmcnt(10)
    ds_read_b128 v[180:183], v234 offset:2080
    ds_read_b128 v[184:187], v235 offset:2080
    ds_read_u8 v230, v237 offset:112
    ds_read_u8 v232, v237 offset:120
    v_exp_f32 v132, v148
    v_exp_f32 v133, v149
    v_exp_f32 v134, v150
    v_exp_f32 v135, v151
    v_cvt_pk_bf16_f32 v208, v208, v209
    v_cvt_pk_bf16_f32 v209, v210, v211
    v_exp_f32 v136, v152
    v_exp_f32 v137, v153
    v_mfma_f32_4x4x4_16b_bf16 v[212:215], v[208:209], v[188:189], v[212:215] cbsz:4 abid:0
    v_exp_f32 v138, v154
    v_exp_f32 v139, v155
    v_mfma_f32_4x4x4_16b_bf16 v[212:215], v[208:209], v[190:191], v[212:215] cbsz:4 abid:4
    v_exp_f32 v140, v156
    v_exp_f32 v141, v157
    v_mfma_f32_4x4x4_16b_bf16 v[212:215], v[208:209], v[192:193], v[212:215] cbsz:4 abid:8
    v_exp_f32 v142, v158
    v_exp_f32 v143, v159
    v_mfma_f32_4x4x4_16b_bf16 v[212:215], v[208:209], v[194:195], v[212:215] cbsz:4 abid:12
    ds_read_b64_tr_b16 v[188:189], v236 offset:0
    ds_read_b64_tr_b16 v[190:191], v236 offset:512
    ds_read_b64_tr_b16 v[192:193], v236 offset:1056
    ds_read_b64_tr_b16 v[194:195], v236 offset:1568
    v_exp_f32 v144, v160
    v_exp_f32 v145, v161
    v_exp_f32 v146, v162
    v_exp_f32 v147, v163
    s_bitcmp1_b64 s[56:57], 0
    s_cbranch_scc1 Ls_flush0
Ls_flushed0:
    v_mfma_f32_32x32x8_bf16 v[132:147], v[228:229], v[228:229], v[132:147]
    s_bitcmp1_b64 s[60:61], 1
    s_cbranch_scc1 Ls_wb0
Ls_wbd0:
    s_bitcmp1_b64 s[60:61], 7
    s_cbranch_scc1 Ls_adv0
Ls_advd0:
    s_waitcnt lgkmcnt(4)
    v_mfma_f32_16x16x32_bf16 v[148:151], v[100:103], v[180:183], v[164:167]
    v_mfma_f32_16x16x32_bf16 v[148:151], v[104:107], v[184:187], v[148:151]
    s_waitcnt lgkmcnt(0)
    s_add_u32 m0, s52, 0
    v_mfma_f32_16x16x32_bf16 v[152:155], v[108:111], v[180:183], v[168:171]
    buffer_load_dwordx4 v[230:231], s[20:23], 0 idxen offen nt lds
    s_add_u32 m0, s52, 1056
    v_mfma_f32_16x16x32_bf16 v[152:155], v[112:115], v[184:187], v[152:155]
    buffer_load_dwordx4 v[232:233], s[20:23], 0 idxen offen nt lds
    v_rcp_f32 v132, v132
    v_rcp_f32 v133, v133
    v_rcp_f32 v134, v134
    v_cvt_pk_bf16_f32 v132, v132, v133
    v_mfma_f32_16x16x32_bf16 v[156:159], v[116:119], v[180:183], v[172:175]
    v_rcp_f32 v135, v135
    v_rcp_f32 v136, v136
    v_cvt_pk_bf16_f32 v133, v134, v135
    v_mfma_f32_16x16x32_bf16 v[156:159], v[120:123], v[184:187], v[156:159]
    v_rcp_f32 v137, v137
    v_rcp_f32 v138, v138
    v_cvt_pk_bf16_f32 v134, v136, v137
    v_mfma_f32_16x16x32_bf16 v[160:163], v[124:127], v[180:183], v[176:179]
    v_rcp_f32 v139, v139
    v_rcp_f32 v140, v140
    v_cvt_pk_bf16_f32 v135, v138, v139
    v_mfma_f32_16x16x32_bf16 v[160:163], v[128:131], v[184:187], v[160:163]
    v_rcp_f32 v141, v141
    v_rcp_f32 v142, v142
    v_cvt_pk_bf16_f32 v136, v140, v141
    v_mfma_f32_16x16x32_bf16 v[208:211], v[132:135], v[196:199], v[204:207]
    v_rcp_f32 v143, v143
    v_rcp_f32 v144, v144
    v_cvt_pk_bf16_f32 v137, v142, v143
    v_rcp_f32 v145, v145
    v_rcp_f32 v146, v146
    v_cvt_pk_bf16_f32 v138, v144, v145
    v_rcp_f32 v147, v147
    s_nop 0
    v_cvt_pk_bf16_f32 v139, v146, v147
    s_nop 1
    v_mfma_f32_16x16x32_bf16 v[208:211], v[136:139], v[200:203], v[208:211]
    ds_read_b32 v246, v244 offset:16
    s_waitcnt lgkmcnt(0)
    v_bfe_u32 v247, v246, 0, 8
    v_lshlrev_b32 v247, 1, v247
    v_bfe_u32 v248, v246, 8, 8
    v_lshlrev_b32 v248, 1, v248
    v_bfe_u32 v249, v246, 16, 8
    v_lshlrev_b32 v249, 1, v249
    v_bfe_u32 v250, v246, 24, 8
    v_lshlrev_b32 v250, 1, v250
    buffer_load_ushort v247, v247, s[24:27], 0 offen
    buffer_load_ushort v248, v248, s[24:27], 0 offen
    buffer_load_ushort v249, v249, s[24:27], 0 offen
    buffer_load_ushort v250, v250, s[24:27], 0 offen
    s_waitcnt vmcnt(0)
    v_lshlrev_b32 v247, 16, v247
    v_mul_f32 v208, v208, v247
    v_lshlrev_b32 v248, 16, v248
    v_mul_f32 v209, v209, v248
    v_lshlrev_b32 v249, 16, v249
    v_mul_f32 v210, v210, v249
    v_lshlrev_b32 v250, 16, v250
    v_mul_f32 v211, v211, v250
    s_waitcnt vmcnt(10)
    ds_read_b128 v[180:183], v234 offset:4160
    ds_read_b128 v[184:187], v235 offset:4160
    ds_read_u8 v230, v237 offset:128
    ds_read_u8 v232, v237 offset:136
    v_exp_f32 v132, v148
    v_exp_f32 v133, v149
    v_exp_f32 v134, v150
    v_exp_f32 v135, v151
    v_cvt_pk_bf16_f32 v208, v208, v209
    v_cvt_pk_bf16_f32 v209, v210, v211
    v_exp_f32 v136, v152
    v_exp_f32 v137, v153
    v_mfma_f32_4x4x4_16b_bf16 v[212:215], v[208:209], v[188:189], v[212:215] cbsz:4 abid:0
    v_exp_f32 v138, v154
    v_exp_f32 v139, v155
    v_mfma_f32_4x4x4_16b_bf16 v[212:215], v[208:209], v[190:191], v[212:215] cbsz:4 abid:4
    v_exp_f32 v140, v156
    v_exp_f32 v141, v157
    v_mfma_f32_4x4x4_16b_bf16 v[212:215], v[208:209], v[192:193], v[212:215] cbsz:4 abid:8
    v_exp_f32 v142, v158
    v_exp_f32 v143, v159
    v_mfma_f32_4x4x4_16b_bf16 v[212:215], v[208:209], v[194:195], v[212:215] cbsz:4 abid:12
    ds_read_b64_tr_b16 v[188:189], v236 offset:2080
    ds_read_b64_tr_b16 v[190:191], v236 offset:2592
    ds_read_b64_tr_b16 v[192:193], v236 offset:3136
    ds_read_b64_tr_b16 v[194:195], v236 offset:3648
    v_exp_f32 v144, v160
    v_exp_f32 v145, v161
    v_exp_f32 v146, v162
    v_exp_f32 v147, v163
    s_bitcmp1_b64 s[56:57], 1
    s_cbranch_scc1 Ls_flush1
Ls_flushed1:
    v_mfma_f32_32x32x8_bf16 v[132:147], v[228:229], v[228:229], v[132:147]
    s_bitcmp1_b64 s[60:61], 2
    s_cbranch_scc1 Ls_wb1
Ls_wbd1:
    s_bitcmp1_b64 s[60:61], 8
    s_cbranch_scc1 Ls_adv1
Ls_advd1:
    s_waitcnt lgkmcnt(4)
    v_mfma_f32_16x16x32_bf16 v[148:151], v[100:103], v[180:183], v[164:167]
    v_mfma_f32_16x16x32_bf16 v[148:151], v[104:107], v[184:187], v[148:151]
    s_waitcnt lgkmcnt(0)
    s_add_u32 m0, s52, 2080
    v_mfma_f32_16x16x32_bf16 v[152:155], v[108:111], v[180:183], v[168:171]
    buffer_load_dwordx4 v[230:231], s[20:23], 0 idxen offen nt lds
    s_add_u32 m0, s52, 3136
    v_mfma_f32_16x16x32_bf16 v[152:155], v[112:115], v[184:187], v[152:155]
    buffer_load_dwordx4 v[232:233], s[20:23], 0 idxen offen nt lds
    v_rcp_f32 v132, v132
    v_rcp_f32 v133, v133
    v_rcp_f32 v134, v134
    v_cvt_pk_bf16_f32 v132, v132, v133
    v_mfma_f32_16x16x32_bf16 v[156:159], v[116:119], v[180:183], v[172:175]
    v_rcp_f32 v135, v135
    v_rcp_f32 v136, v136
    v_cvt_pk_bf16_f32 v133, v134, v135
    v_mfma_f32_16x16x32_bf16 v[156:159], v[120:123], v[184:187], v[156:159]
    v_rcp_f32 v137, v137
    v_rcp_f32 v138, v138
    v_cvt_pk_bf16_f32 v134, v136, v137
    v_mfma_f32_16x16x32_bf16 v[160:163], v[124:127], v[180:183], v[176:179]
    v_rcp_f32 v139, v139
    v_rcp_f32 v140, v140
    v_cvt_pk_bf16_f32 v135, v138, v139
    v_mfma_f32_16x16x32_bf16 v[160:163], v[128:131], v[184:187], v[160:163]
    v_rcp_f32 v141, v141
    v_rcp_f32 v142, v142
    v_cvt_pk_bf16_f32 v136, v140, v141
    v_mfma_f32_16x16x32_bf16 v[208:211], v[132:135], v[196:199], v[204:207]
    v_rcp_f32 v143, v143
    v_rcp_f32 v144, v144
    v_cvt_pk_bf16_f32 v137, v142, v143
    v_rcp_f32 v145, v145
    v_rcp_f32 v146, v146
    v_cvt_pk_bf16_f32 v138, v144, v145
    v_rcp_f32 v147, v147
    s_nop 0
    v_cvt_pk_bf16_f32 v139, v146, v147
    s_nop 1
    v_mfma_f32_16x16x32_bf16 v[208:211], v[136:139], v[200:203], v[208:211]
    ds_read_b32 v246, v244 offset:32
    s_waitcnt lgkmcnt(0)
    v_bfe_u32 v247, v246, 0, 8
    v_lshlrev_b32 v247, 1, v247
    v_bfe_u32 v248, v246, 8, 8
    v_lshlrev_b32 v248, 1, v248
    v_bfe_u32 v249, v246, 16, 8
    v_lshlrev_b32 v249, 1, v249
    v_bfe_u32 v250, v246, 24, 8
    v_lshlrev_b32 v250, 1, v250
    buffer_load_ushort v247, v247, s[24:27], 0 offen
    buffer_load_ushort v248, v248, s[24:27], 0 offen
    buffer_load_ushort v249, v249, s[24:27], 0 offen
    buffer_load_ushort v250, v250, s[24:27], 0 offen
    s_waitcnt vmcnt(0)
    v_lshlrev_b32 v247, 16, v247
    v_mul_f32 v208, v208, v247
    v_lshlrev_b32 v248, 16, v248
    v_mul_f32 v209, v209, v248
    v_lshlrev_b32 v249, 16, v249
    v_mul_f32 v210, v210, v249
    v_lshlrev_b32 v250, 16, v250
    v_mul_f32 v211, v211, v250
    s_waitcnt vmcnt(10)
    ds_read_b128 v[180:183], v234 offset:6240
    ds_read_b128 v[184:187], v235 offset:6240
    ds_read_u8 v230, v237 offset:144
    ds_read_u8 v232, v237 offset:152
    v_exp_f32 v132, v148
    v_exp_f32 v133, v149
    v_exp_f32 v134, v150
    v_exp_f32 v135, v151
    v_cvt_pk_bf16_f32 v208, v208, v209
    v_cvt_pk_bf16_f32 v209, v210, v211
    v_exp_f32 v136, v152
    v_exp_f32 v137, v153
    v_mfma_f32_4x4x4_16b_bf16 v[212:215], v[208:209], v[188:189], v[212:215] cbsz:4 abid:0
    v_exp_f32 v138, v154
    v_exp_f32 v139, v155
    v_mfma_f32_4x4x4_16b_bf16 v[212:215], v[208:209], v[190:191], v[212:215] cbsz:4 abid:4
    v_exp_f32 v140, v156
    v_exp_f32 v141, v157
    v_mfma_f32_4x4x4_16b_bf16 v[212:215], v[208:209], v[192:193], v[212:215] cbsz:4 abid:8
    v_exp_f32 v142, v158
    v_exp_f32 v143, v159
    v_mfma_f32_4x4x4_16b_bf16 v[212:215], v[208:209], v[194:195], v[212:215] cbsz:4 abid:12
    ds_read_b64_tr_b16 v[188:189], v236 offset:4160
    ds_read_b64_tr_b16 v[190:191], v236 offset:4672
    ds_read_b64_tr_b16 v[192:193], v236 offset:5216
    ds_read_b64_tr_b16 v[194:195], v236 offset:5728
    v_exp_f32 v144, v160
    v_exp_f32 v145, v161
    v_exp_f32 v146, v162
    v_exp_f32 v147, v163
    s_bitcmp1_b64 s[56:57], 2
    s_cbranch_scc1 Ls_flush2
Ls_flushed2:
    v_mfma_f32_32x32x8_bf16 v[132:147], v[228:229], v[228:229], v[132:147]
    s_bitcmp1_b64 s[60:61], 3
    s_cbranch_scc1 Ls_wb2
Ls_wbd2:
    s_bitcmp1_b64 s[60:61], 9
    s_cbranch_scc1 Ls_adv2
Ls_advd2:
    s_waitcnt lgkmcnt(4)
    v_mfma_f32_16x16x32_bf16 v[148:151], v[100:103], v[180:183], v[164:167]
    v_mfma_f32_16x16x32_bf16 v[148:151], v[104:107], v[184:187], v[148:151]
    s_waitcnt lgkmcnt(0)
    s_add_u32 m0, s52, 4160
    v_mfma_f32_16x16x32_bf16 v[152:155], v[108:111], v[180:183], v[168:171]
    buffer_load_dwordx4 v[230:231], s[20:23], 0 idxen offen nt lds
    s_add_u32 m0, s52, 5216
    v_mfma_f32_16x16x32_bf16 v[152:155], v[112:115], v[184:187], v[152:155]
    buffer_load_dwordx4 v[232:233], s[20:23], 0 idxen offen nt lds
    v_rcp_f32 v132, v132
    v_rcp_f32 v133, v133
    v_rcp_f32 v134, v134
    v_cvt_pk_bf16_f32 v132, v132, v133
    v_mfma_f32_16x16x32_bf16 v[156:159], v[116:119], v[180:183], v[172:175]
    v_rcp_f32 v135, v135
    v_rcp_f32 v136, v136
    v_cvt_pk_bf16_f32 v133, v134, v135
    v_mfma_f32_16x16x32_bf16 v[156:159], v[120:123], v[184:187], v[156:159]
    v_rcp_f32 v137, v137
    v_rcp_f32 v138, v138
    v_cvt_pk_bf16_f32 v134, v136, v137
    v_mfma_f32_16x16x32_bf16 v[160:163], v[124:127], v[180:183], v[176:179]
    v_rcp_f32 v139, v139
    v_rcp_f32 v140, v140
    v_cvt_pk_bf16_f32 v135, v138, v139
    v_mfma_f32_16x16x32_bf16 v[160:163], v[128:131], v[184:187], v[160:163]
    v_rcp_f32 v141, v141
    v_rcp_f32 v142, v142
    v_cvt_pk_bf16_f32 v136, v140, v141
    v_mfma_f32_16x16x32_bf16 v[208:211], v[132:135], v[196:199], v[204:207]
    v_rcp_f32 v143, v143
    v_rcp_f32 v144, v144
    v_cvt_pk_bf16_f32 v137, v142, v143
    v_rcp_f32 v145, v145
    v_rcp_f32 v146, v146
    v_cvt_pk_bf16_f32 v138, v144, v145
    v_rcp_f32 v147, v147
    s_nop 0
    v_cvt_pk_bf16_f32 v139, v146, v147
    s_nop 1
    v_mfma_f32_16x16x32_bf16 v[208:211], v[136:139], v[200:203], v[208:211]
    ds_read_b32 v246, v244 offset:48
    s_waitcnt lgkmcnt(0)
    v_bfe_u32 v247, v246, 0, 8
    v_lshlrev_b32 v247, 1, v247
    v_bfe_u32 v248, v246, 8, 8
    v_lshlrev_b32 v248, 1, v248
    v_bfe_u32 v249, v246, 16, 8
    v_lshlrev_b32 v249, 1, v249
    v_bfe_u32 v250, v246, 24, 8
    v_lshlrev_b32 v250, 1, v250
    buffer_load_ushort v247, v247, s[24:27], 0 offen
    buffer_load_ushort v248, v248, s[24:27], 0 offen
    buffer_load_ushort v249, v249, s[24:27], 0 offen
    buffer_load_ushort v250, v250, s[24:27], 0 offen
    s_waitcnt vmcnt(0)
    v_lshlrev_b32 v247, 16, v247
    v_mul_f32 v208, v208, v247
    v_lshlrev_b32 v248, 16, v248
    v_mul_f32 v209, v209, v248
    v_lshlrev_b32 v249, 16, v249
    v_mul_f32 v210, v210, v249
    v_lshlrev_b32 v250, 16, v250
    v_mul_f32 v211, v211, v250
    s_waitcnt vmcnt(10)
    ds_read_b128 v[180:183], v234 offset:8320
    ds_read_b128 v[184:187], v235 offset:8320
    ds_read_u8 v230, v237 offset:160
    ds_read_u8 v232, v237 offset:168
    v_exp_f32 v132, v148
    v_exp_f32 v133, v149
    v_exp_f32 v134, v150
    v_exp_f32 v135, v151
    v_cvt_pk_bf16_f32 v208, v208, v209
    v_cvt_pk_bf16_f32 v209, v210, v211
    v_exp_f32 v136, v152
    v_exp_f32 v137, v153
    v_mfma_f32_4x4x4_16b_bf16 v[212:215], v[208:209], v[188:189], v[212:215] cbsz:4 abid:0
    v_exp_f32 v138, v154
    v_exp_f32 v139, v155
    v_mfma_f32_4x4x4_16b_bf16 v[212:215], v[208:209], v[190:191], v[212:215] cbsz:4 abid:4
    v_exp_f32 v140, v156
    v_exp_f32 v141, v157
    v_mfma_f32_4x4x4_16b_bf16 v[212:215], v[208:209], v[192:193], v[212:215] cbsz:4 abid:8
    v_exp_f32 v142, v158
    v_exp_f32 v143, v159
    v_mfma_f32_4x4x4_16b_bf16 v[212:215], v[208:209], v[194:195], v[212:215] cbsz:4 abid:12
    ds_read_b64_tr_b16 v[188:189], v236 offset:6240
    ds_read_b64_tr_b16 v[190:191], v236 offset:6752
    ds_read_b64_tr_b16 v[192:193], v236 offset:7296
    ds_read_b64_tr_b16 v[194:195], v236 offset:7808
    v_exp_f32 v144, v160
    v_exp_f32 v145, v161
    v_exp_f32 v146, v162
    v_exp_f32 v147, v163
    s_bitcmp1_b64 s[56:57], 3
    s_cbranch_scc1 Ls_flush3
Ls_flushed3:
    v_mfma_f32_32x32x8_bf16 v[132:147], v[228:229], v[228:229], v[132:147]
    s_bitcmp1_b64 s[60:61], 4
    s_cbranch_scc1 Ls_wb3
Ls_wbd3:
    s_bitcmp1_b64 s[60:61], 10
    s_cbranch_scc1 Ls_adv3
Ls_advd3:
    s_waitcnt lgkmcnt(4)
    v_mfma_f32_16x16x32_bf16 v[148:151], v[100:103], v[180:183], v[164:167]
    v_mfma_f32_16x16x32_bf16 v[148:151], v[104:107], v[184:187], v[148:151]
    s_waitcnt lgkmcnt(0)
    s_add_u32 m0, s52, 6240
    v_mfma_f32_16x16x32_bf16 v[152:155], v[108:111], v[180:183], v[168:171]
    buffer_load_dwordx4 v[230:231], s[20:23], 0 idxen offen nt lds
    s_add_u32 m0, s52, 7296
    v_mfma_f32_16x16x32_bf16 v[152:155], v[112:115], v[184:187], v[152:155]
    buffer_load_dwordx4 v[232:233], s[20:23], 0 idxen offen nt lds
    v_rcp_f32 v132, v132
    v_rcp_f32 v133, v133
    v_rcp_f32 v134, v134
    v_cvt_pk_bf16_f32 v132, v132, v133
    v_mfma_f32_16x16x32_bf16 v[156:159], v[116:119], v[180:183], v[172:175]
    v_rcp_f32 v135, v135
    v_rcp_f32 v136, v136
    v_cvt_pk_bf16_f32 v133, v134, v135
    v_mfma_f32_16x16x32_bf16 v[156:159], v[120:123], v[184:187], v[156:159]
    v_rcp_f32 v137, v137
    v_rcp_f32 v138, v138
    v_cvt_pk_bf16_f32 v134, v136, v137
    v_mfma_f32_16x16x32_bf16 v[160:163], v[124:127], v[180:183], v[176:179]
    v_rcp_f32 v139, v139
    v_rcp_f32 v140, v140
    v_cvt_pk_bf16_f32 v135, v138, v139
    v_mfma_f32_16x16x32_bf16 v[160:163], v[128:131], v[184:187], v[160:163]
    v_rcp_f32 v141, v141
    v_rcp_f32 v142, v142
    v_cvt_pk_bf16_f32 v136, v140, v141
    v_mfma_f32_16x16x32_bf16 v[208:211], v[132:135], v[196:199], v[204:207]
    v_rcp_f32 v143, v143
    v_rcp_f32 v144, v144
    v_cvt_pk_bf16_f32 v137, v142, v143
    v_rcp_f32 v145, v145
    v_rcp_f32 v146, v146
    v_cvt_pk_bf16_f32 v138, v144, v145
    v_rcp_f32 v147, v147
    s_nop 0
    v_cvt_pk_bf16_f32 v139, v146, v147
    s_nop 1
    v_mfma_f32_16x16x32_bf16 v[208:211], v[136:139], v[200:203], v[208:211]
    ds_read_b32 v246, v244 offset:64
    s_waitcnt lgkmcnt(0)
    v_bfe_u32 v247, v246, 0, 8
    v_lshlrev_b32 v247, 1, v247
    v_bfe_u32 v248, v246, 8, 8
    v_lshlrev_b32 v248, 1, v248
    v_bfe_u32 v249, v246, 16, 8
    v_lshlrev_b32 v249, 1, v249
    v_bfe_u32 v250, v246, 24, 8
    v_lshlrev_b32 v250, 1, v250
    buffer_load_ushort v247, v247, s[24:27], 0 offen
    buffer_load_ushort v248, v248, s[24:27], 0 offen
    buffer_load_ushort v249, v249, s[24:27], 0 offen
    buffer_load_ushort v250, v250, s[24:27], 0 offen
    s_waitcnt vmcnt(0)
    v_lshlrev_b32 v247, 16, v247
    v_mul_f32 v208, v208, v247
    v_lshlrev_b32 v248, 16, v248
    v_mul_f32 v209, v209, v248
    v_lshlrev_b32 v249, 16, v249
    v_mul_f32 v210, v210, v249
    v_lshlrev_b32 v250, 16, v250
    v_mul_f32 v211, v211, v250
    s_waitcnt vmcnt(10)
    ds_read_b128 v[180:183], v234 offset:10400
    ds_read_b128 v[184:187], v235 offset:10400
    ds_read_u8 v230, v237 offset:176
    ds_read_u8 v232, v237 offset:184
    v_exp_f32 v132, v148
    v_exp_f32 v133, v149
    v_exp_f32 v134, v150
    v_exp_f32 v135, v151
    v_cvt_pk_bf16_f32 v208, v208, v209
    v_cvt_pk_bf16_f32 v209, v210, v211
    v_exp_f32 v136, v152
    v_exp_f32 v137, v153
    v_mfma_f32_4x4x4_16b_bf16 v[212:215], v[208:209], v[188:189], v[212:215] cbsz:4 abid:0
    v_exp_f32 v138, v154
    v_exp_f32 v139, v155
    v_mfma_f32_4x4x4_16b_bf16 v[212:215], v[208:209], v[190:191], v[212:215] cbsz:4 abid:4
    v_exp_f32 v140, v156
    v_exp_f32 v141, v157
    v_mfma_f32_4x4x4_16b_bf16 v[212:215], v[208:209], v[192:193], v[212:215] cbsz:4 abid:8
    v_exp_f32 v142, v158
    v_exp_f32 v143, v159
    v_mfma_f32_4x4x4_16b_bf16 v[212:215], v[208:209], v[194:195], v[212:215] cbsz:4 abid:12
    ds_read_b64_tr_b16 v[188:189], v236 offset:8320
    ds_read_b64_tr_b16 v[190:191], v236 offset:8832
    ds_read_b64_tr_b16 v[192:193], v236 offset:9376
    ds_read_b64_tr_b16 v[194:195], v236 offset:9888
    v_exp_f32 v144, v160
    v_exp_f32 v145, v161
    v_exp_f32 v146, v162
    v_exp_f32 v147, v163
    s_bitcmp1_b64 s[56:57], 4
    s_cbranch_scc1 Ls_flush4
Ls_flushed4:
    v_mfma_f32_32x32x8_bf16 v[132:147], v[228:229], v[228:229], v[132:147]
    s_bitcmp1_b64 s[60:61], 5
    s_cbranch_scc1 Ls_wb4
Ls_wbd4:
    s_bitcmp1_b64 s[60:61], 11
    s_cbranch_scc1 Ls_adv4
Ls_advd4:
    s_waitcnt lgkmcnt(4)
    v_mfma_f32_16x16x32_bf16 v[148:151], v[100:103], v[180:183], v[164:167]
    v_mfma_f32_16x16x32_bf16 v[148:151], v[104:107], v[184:187], v[148:151]
    s_waitcnt lgkmcnt(0)
    s_add_u32 m0, s52, 8320
    v_mfma_f32_16x16x32_bf16 v[152:155], v[108:111], v[180:183], v[168:171]
    buffer_load_dwordx4 v[230:231], s[20:23], 0 idxen offen nt lds
    s_add_u32 m0, s52, 9376
    v_mfma_f32_16x16x32_bf16 v[152:155], v[112:115], v[184:187], v[152:155]
    buffer_load_dwordx4 v[232:233], s[20:23], 0 idxen offen nt lds
    v_rcp_f32 v132, v132
    v_rcp_f32 v133, v133
    v_rcp_f32 v134, v134
    v_cvt_pk_bf16_f32 v132, v132, v133
    v_mfma_f32_16x16x32_bf16 v[156:159], v[116:119], v[180:183], v[172:175]
    v_rcp_f32 v135, v135
    v_rcp_f32 v136, v136
    v_cvt_pk_bf16_f32 v133, v134, v135
    v_mfma_f32_16x16x32_bf16 v[156:159], v[120:123], v[184:187], v[156:159]
    v_rcp_f32 v137, v137
    v_rcp_f32 v138, v138
    v_cvt_pk_bf16_f32 v134, v136, v137
    v_mfma_f32_16x16x32_bf16 v[160:163], v[124:127], v[180:183], v[176:179]
    v_rcp_f32 v139, v139
    v_rcp_f32 v140, v140
    v_cvt_pk_bf16_f32 v135, v138, v139
    v_mfma_f32_16x16x32_bf16 v[160:163], v[128:131], v[184:187], v[160:163]
    v_rcp_f32 v141, v141
    v_rcp_f32 v142, v142
    v_cvt_pk_bf16_f32 v136, v140, v141
    v_mfma_f32_16x16x32_bf16 v[208:211], v[132:135], v[196:199], v[204:207]
    v_rcp_f32 v143, v143
    v_rcp_f32 v144, v144
    v_cvt_pk_bf16_f32 v137, v142, v143
    v_rcp_f32 v145, v145
    v_rcp_f32 v146, v146
    v_cvt_pk_bf16_f32 v138, v144, v145
    v_rcp_f32 v147, v147
    s_nop 0
    v_cvt_pk_bf16_f32 v139, v146, v147
    s_nop 1
    v_mfma_f32_16x16x32_bf16 v[208:211], v[136:139], v[200:203], v[208:211]
    ds_read_b32 v246, v244 offset:80
    s_waitcnt lgkmcnt(0)
    v_bfe_u32 v247, v246, 0, 8
    v_lshlrev_b32 v247, 1, v247
    v_bfe_u32 v248, v246, 8, 8
    v_lshlrev_b32 v248, 1, v248
    v_bfe_u32 v249, v246, 16, 8
    v_lshlrev_b32 v249, 1, v249
    v_bfe_u32 v250, v246, 24, 8
    v_lshlrev_b32 v250, 1, v250
    buffer_load_ushort v247, v247, s[24:27], 0 offen
    buffer_load_ushort v248, v248, s[24:27], 0 offen
    buffer_load_ushort v249, v249, s[24:27], 0 offen
    buffer_load_ushort v250, v250, s[24:27], 0 offen
    s_waitcnt vmcnt(0)
    v_lshlrev_b32 v247, 16, v247
    v_mul_f32 v208, v208, v247
    v_lshlrev_b32 v248, 16, v248
    v_mul_f32 v209, v209, v248
    v_lshlrev_b32 v249, 16, v249
    v_mul_f32 v210, v210, v249
    v_lshlrev_b32 v250, 16, v250
    v_mul_f32 v211, v211, v250
    s_waitcnt vmcnt(10)
    ds_read_b128 v[180:183], v234 offset:12480
    ds_read_b128 v[184:187], v235 offset:12480
    ds_read_u8 v230, v237 offset:192
    ds_read_u8 v232, v237 offset:200
    v_exp_f32 v132, v148
    v_exp_f32 v133, v149
    v_exp_f32 v134, v150
    v_exp_f32 v135, v151
    v_cvt_pk_bf16_f32 v208, v208, v209
    v_cvt_pk_bf16_f32 v209, v210, v211
    v_exp_f32 v136, v152
    v_exp_f32 v137, v153
    v_mfma_f32_4x4x4_16b_bf16 v[212:215], v[208:209], v[188:189], v[212:215] cbsz:4 abid:0
    v_exp_f32 v138, v154
    v_exp_f32 v139, v155
    v_mfma_f32_4x4x4_16b_bf16 v[212:215], v[208:209], v[190:191], v[212:215] cbsz:4 abid:4
    v_exp_f32 v140, v156
    v_exp_f32 v141, v157
    v_mfma_f32_4x4x4_16b_bf16 v[212:215], v[208:209], v[192:193], v[212:215] cbsz:4 abid:8
    v_exp_f32 v142, v158
    v_exp_f32 v143, v159
    v_mfma_f32_4x4x4_16b_bf16 v[212:215], v[208:209], v[194:195], v[212:215] cbsz:4 abid:12
    ds_read_b64_tr_b16 v[188:189], v236 offset:10400
    ds_read_b64_tr_b16 v[190:191], v236 offset:10912
    ds_read_b64_tr_b16 v[192:193], v236 offset:11456
    ds_read_b64_tr_b16 v[194:195], v236 offset:11968
    v_exp_f32 v144, v160
    v_exp_f32 v145, v161
    v_exp_f32 v146, v162
    v_exp_f32 v147, v163
    s_bitcmp1_b64 s[56:57], 5
    s_cbranch_scc1 Ls_flush5
Ls_flushed5:
    v_mfma_f32_32x32x8_bf16 v[132:147], v[228:229], v[228:229], v[132:147]
    s_bitcmp1_b64 s[60:61], 6
    s_cbranch_scc1 Ls_wb5
Ls_wbd5:
    s_bitcmp1_b64 s[60:61], 12
    s_cbranch_scc1 Ls_adv5
Ls_advd5:
    s_waitcnt lgkmcnt(4)
    v_mfma_f32_16x16x32_bf16 v[148:151], v[100:103], v[180:183], v[164:167]
    v_mfma_f32_16x16x32_bf16 v[148:151], v[104:107], v[184:187], v[148:151]
    s_waitcnt lgkmcnt(0)
    s_add_u32 m0, s52, 10400
    v_mfma_f32_16x16x32_bf16 v[152:155], v[108:111], v[180:183], v[168:171]
    buffer_load_dwordx4 v[230:231], s[20:23], 0 idxen offen nt lds
    s_add_u32 m0, s52, 11456
    v_mfma_f32_16x16x32_bf16 v[152:155], v[112:115], v[184:187], v[152:155]
    buffer_load_dwordx4 v[232:233], s[20:23], 0 idxen offen nt lds
    v_rcp_f32 v132, v132
    v_rcp_f32 v133, v133
    v_rcp_f32 v134, v134
    v_cvt_pk_bf16_f32 v132, v132, v133
    v_mfma_f32_16x16x32_bf16 v[156:159], v[116:119], v[180:183], v[172:175]
    v_rcp_f32 v135, v135
    v_rcp_f32 v136, v136
    v_cvt_pk_bf16_f32 v133, v134, v135
    v_mfma_f32_16x16x32_bf16 v[156:159], v[120:123], v[184:187], v[156:159]
    v_rcp_f32 v137, v137
    v_rcp_f32 v138, v138
    v_cvt_pk_bf16_f32 v134, v136, v137
    v_mfma_f32_16x16x32_bf16 v[160:163], v[124:127], v[180:183], v[176:179]
    v_rcp_f32 v139, v139
    v_rcp_f32 v140, v140
    v_cvt_pk_bf16_f32 v135, v138, v139
    v_mfma_f32_16x16x32_bf16 v[160:163], v[128:131], v[184:187], v[160:163]
    v_rcp_f32 v141, v141
    v_rcp_f32 v142, v142
    v_cvt_pk_bf16_f32 v136, v140, v141
    v_mfma_f32_16x16x32_bf16 v[208:211], v[132:135], v[196:199], v[204:207]
    v_rcp_f32 v143, v143
    v_rcp_f32 v144, v144
    v_cvt_pk_bf16_f32 v137, v142, v143
    v_rcp_f32 v145, v145
    v_rcp_f32 v146, v146
    v_cvt_pk_bf16_f32 v138, v144, v145
    v_rcp_f32 v147, v147
    s_nop 0
    v_cvt_pk_bf16_f32 v139, v146, v147
    s_nop 1
    v_mfma_f32_16x16x32_bf16 v[208:211], v[136:139], v[200:203], v[208:211]
    ds_read_b32 v246, v244 offset:96
    s_waitcnt lgkmcnt(0)
    v_bfe_u32 v247, v246, 0, 8
    v_lshlrev_b32 v247, 1, v247
    v_bfe_u32 v248, v246, 8, 8
    v_lshlrev_b32 v248, 1, v248
    v_bfe_u32 v249, v246, 16, 8
    v_lshlrev_b32 v249, 1, v249
    v_bfe_u32 v250, v246, 24, 8
    v_lshlrev_b32 v250, 1, v250
    buffer_load_ushort v247, v247, s[24:27], 0 offen
    buffer_load_ushort v248, v248, s[24:27], 0 offen
    buffer_load_ushort v249, v249, s[24:27], 0 offen
    buffer_load_ushort v250, v250, s[24:27], 0 offen
    s_waitcnt vmcnt(0)
    v_lshlrev_b32 v247, 16, v247
    v_mul_f32 v208, v208, v247
    v_lshlrev_b32 v248, 16, v248
    v_mul_f32 v209, v209, v248
    v_lshlrev_b32 v249, 16, v249
    v_mul_f32 v210, v210, v249
    v_lshlrev_b32 v250, 16, v250
    v_mul_f32 v211, v211, v250
    s_waitcnt vmcnt(10)
    ds_read_b128 v[180:183], v234 offset:0
    ds_read_b128 v[184:187], v235 offset:0
    ds_read_u8 v230, v237 offset:208
    ds_read_u8 v232, v237 offset:216
    v_exp_f32 v132, v148
    v_exp_f32 v133, v149
    v_exp_f32 v134, v150
    v_exp_f32 v135, v151
    v_cvt_pk_bf16_f32 v208, v208, v209
    v_cvt_pk_bf16_f32 v209, v210, v211
    v_exp_f32 v136, v152
    v_exp_f32 v137, v153
    v_mfma_f32_4x4x4_16b_bf16 v[212:215], v[208:209], v[188:189], v[212:215] cbsz:4 abid:0
    v_exp_f32 v138, v154
    v_exp_f32 v139, v155
    v_mfma_f32_4x4x4_16b_bf16 v[212:215], v[208:209], v[190:191], v[212:215] cbsz:4 abid:4
    v_exp_f32 v140, v156
    v_exp_f32 v141, v157
    v_mfma_f32_4x4x4_16b_bf16 v[212:215], v[208:209], v[192:193], v[212:215] cbsz:4 abid:8
    v_exp_f32 v142, v158
    v_exp_f32 v143, v159
    v_mfma_f32_4x4x4_16b_bf16 v[212:215], v[208:209], v[194:195], v[212:215] cbsz:4 abid:12
    ds_read_b64_tr_b16 v[188:189], v236 offset:12480
    ds_read_b64_tr_b16 v[190:191], v236 offset:12992
    ds_read_b64_tr_b16 v[192:193], v236 offset:13536
    ds_read_b64_tr_b16 v[194:195], v236 offset:14048
    v_exp_f32 v144, v160
    v_exp_f32 v145, v161
    v_exp_f32 v146, v162
    v_exp_f32 v147, v163
    s_bitcmp1_b64 s[56:57], 6
    s_cbranch_scc1 Ls_flush6
Ls_flushed6:
    v_mfma_f32_32x32x8_bf16 v[132:147], v[228:229], v[228:229], v[132:147]
    s_bitcmp1_b64 s[60:61], 7
    s_cbranch_scc1 Ls_wb6
Ls_wbd6:
    s_bitcmp1_b64 s[60:61], 13
    s_cbranch_scc1 Ls_adv6
Ls_advd6:
    s_waitcnt lgkmcnt(4)
    v_mfma_f32_16x16x32_bf16 v[148:151], v[100:103], v[180:183], v[164:167]
    v_mfma_f32_16x16x32_bf16 v[148:151], v[104:107], v[184:187], v[148:151]
    s_waitcnt lgkmcnt(0)
    s_add_u32 m0, s52, 12480
    v_mfma_f32_16x16x32_bf16 v[152:155], v[108:111], v[180:183], v[168:171]
    buffer_load_dwordx4 v[230:231], s[20:23], 0 idxen offen nt lds
    s_add_u32 m0, s52, 13536
    v_mfma_f32_16x16x32_bf16 v[152:155], v[112:115], v[184:187], v[152:155]
    buffer_load_dwordx4 v[232:233], s[20:23], 0 idxen offen nt lds
    v_rcp_f32 v132, v132
    v_rcp_f32 v133, v133
    v_rcp_f32 v134, v134
    v_cvt_pk_bf16_f32 v132, v132, v133
    v_mfma_f32_16x16x32_bf16 v[156:159], v[116:119], v[180:183], v[172:175]
    v_rcp_f32 v135, v135
    v_rcp_f32 v136, v136
    v_cvt_pk_bf16_f32 v133, v134, v135
    v_mfma_f32_16x16x32_bf16 v[156:159], v[120:123], v[184:187], v[156:159]
    v_rcp_f32 v137, v137
    v_rcp_f32 v138, v138
    v_cvt_pk_bf16_f32 v134, v136, v137
    v_mfma_f32_16x16x32_bf16 v[160:163], v[124:127], v[180:183], v[176:179]
    v_rcp_f32 v139, v139
    v_rcp_f32 v140, v140
    v_cvt_pk_bf16_f32 v135, v138, v139
    v_mfma_f32_16x16x32_bf16 v[160:163], v[128:131], v[184:187], v[160:163]
    v_rcp_f32 v141, v141
    v_rcp_f32 v142, v142
    v_cvt_pk_bf16_f32 v136, v140, v141
    v_mfma_f32_16x16x32_bf16 v[208:211], v[132:135], v[196:199], v[204:207]
    v_rcp_f32 v143, v143
    v_rcp_f32 v144, v144
    v_cvt_pk_bf16_f32 v137, v142, v143
    v_rcp_f32 v145, v145
    v_rcp_f32 v146, v146
    v_cvt_pk_bf16_f32 v138, v144, v145
    v_rcp_f32 v147, v147
    s_lshr_b64 s[56:57], s[56:57], 7
    v_cvt_pk_bf16_f32 v139, v146, v147
    s_lshl_b64 s[86:87], s[58:59], 57
    s_or_b64 s[56:57], s[56:57], s[86:87]
    v_mfma_f32_16x16x32_bf16 v[208:211], v[136:139], v[200:203], v[208:211]
    s_lshr_b64 s[58:59], s[58:59], 7
    s_lshr_b64 s[60:61], s[60:61], 7
    s_lshl_b64 s[86:87], s[62:63], 57
    s_or_b64 s[60:61], s[60:61], s[86:87]
    s_lshr_b64 s[62:63], s[62:63], 7
    v_add_u32 v237, 112, v237
    v_add_u32 v244, 112, v244
    s_branch Ls_loop
Ls_flush0:
    v_cvt_pk_bf16_f32 v246, v212, v212
    v_mov_b32 v212, 0
    s_sub_u32 s65, s65, 1
    ds_write_b16 v240, v246
    s_cbranch_scc1 L_store
    v_add_u32 v240, 128, v240
    s_add_u32 s24, s24, 819200
    s_addc_u32 s25, s25, 0
    s_branch Ls_flushed0
Ls_wb0:
    v_mul_u32_u24 v216, v224, v241
    v_mul_u32_u24 v217, v224, v242
    v_mul_u32_u24 v218, v225, v241
    v_mul_u32_u24 v219, v225, v242
    v_mul_u32_u24 v220, v226, v241
    v_mul_u32_u24 v221, v226, v242
    v_mul_u32_u24 v222, v227, v241
    v_mul_u32_u24 v223, v227, v242
    v_add_u32 v238, 128, v238
    ds_read_b128 v[164:167], v239
    v_mfma_f32_16x16x16_bf16 v[148:151], v[216:217], v[68:69], v[4:7]
    v_mfma_f32_16x16x16_bf16 v[152:155], v[218:219], v[70:71], v[8:11]
    ds_read_b128 v[168:171], v239 offset:64
    ds_read_b128 v[172:175], v239 offset:128
    ds_read_b128 v[176:179], v239 offset:192
    v_mfma_f32_16x16x16_bf16 v[156:159], v[220:221], v[72:73], v[12:15]
    v_mfma_f32_16x16x16_bf16 v[160:163], v[222:223], v[74:75], v[16:19]
    ds_read_u16 v224, v238 offset:0
    ds_read_u16 v225, v238 offset:8
    ds_read_u16 v226, v238 offset:64
    ds_read_u16 v227, v238 offset:72
    v_mfma_f32_16x16x16_bf16 v[246:249], v[216:217], v[76:77], v[20:23]
    v_mfma_f32_16x16x16_bf16 v[250:253], v[218:219], v[78:79], v[24:27]
    v_add_u32 v239, 256, v239
    v_cvt_pk_bf16_f32 v100, v148, v149
    v_cvt_pk_bf16_f32 v101, v150, v151
    v_cvt_pk_bf16_f32 v102, v152, v153
    v_cvt_pk_bf16_f32 v103, v154, v155
    v_mfma_f32_16x16x16_bf16 v[148:151], v[220:221], v[80:81], v[28:31]
    v_mfma_f32_16x16x16_bf16 v[152:155], v[222:223], v[82:83], v[32:35]
    v_cvt_pk_bf16_f32 v104, v156, v157
    v_cvt_pk_bf16_f32 v105, v158, v159
    v_cvt_pk_bf16_f32 v106, v160, v161
    v_cvt_pk_bf16_f32 v107, v162, v163
    v_mfma_f32_16x16x16_bf16 v[156:159], v[216:217], v[84:85], v[36:39]
    v_mfma_f32_16x16x16_bf16 v[160:163], v[218:219], v[86:87], v[40:43]
    v_cvt_pk_bf16_f32 v108, v246, v247
    v_cvt_pk_bf16_f32 v109, v248, v249
    v_cvt_pk_bf16_f32 v110, v250, v251
    v_cvt_pk_bf16_f32 v111, v252, v253
    v_mfma_f32_16x16x16_bf16 v[246:249], v[220:221], v[88:89], v[44:47]
    v_mfma_f32_16x16x16_bf16 v[250:253], v[222:223], v[90:91], v[48:51]
    v_cvt_pk_bf16_f32 v112, v148, v149
    v_cvt_pk_bf16_f32 v113, v150, v151
    v_cvt_pk_bf16_f32 v114, v152, v153
    v_cvt_pk_bf16_f32 v115, v154, v155
    v_mfma_f32_16x16x16_bf16 v[148:151], v[216:217], v[92:93], v[52:55]
    v_mfma_f32_16x16x16_bf16 v[152:155], v[218:219], v[94:95], v[56:59]
    v_cvt_pk_bf16_f32 v116, v156, v157
    v_cvt_pk_bf16_f32 v117, v158, v159
    v_cvt_pk_bf16_f32 v118, v160, v161
    v_cvt_pk_bf16_f32 v119, v162, v163
    v_mfma_f32_16x16x16_bf16 v[156:159], v[220:221], v[96:97], v[60:63]
    v_mfma_f32_16x16x16_bf16 v[160:163], v[222:223], v[98:99], v[64:67]
    v_cvt_pk_bf16_f32 v120, v246, v247
    v_cvt_pk_bf16_f32 v121, v248, v249
    v_cvt_pk_bf16_f32 v122, v250, v251
    v_cvt_pk_bf16_f32 v123, v252, v253
    v_cvt_pk_bf16_f32 v124, v148, v149
    v_cvt_pk_bf16_f32 v125, v150, v151
    v_cvt_pk_bf16_f32 v126, v152, v153
    v_cvt_pk_bf16_f32 v127, v154, v155
    v_cvt_pk_bf16_f32 v128, v156, v157
    v_cvt_pk_bf16_f32 v129, v158, v159
    v_cvt_pk_bf16_f32 v130, v160, v161
    v_cvt_pk_bf16_f32 v131, v162, v163
    s_waitcnt lgkmcnt(0)
    s_branch Ls_wbd0
Ls_adv0:
    s_add_u32 s20, s20, 52428800
    s_addc_u32 s21, s21, 0
    s_branch Ls_advd0
Ls_flush1:
    v_cvt_pk_bf16_f32 v246, v212, v212
    v_mov_b32 v212, 0
    s_sub_u32 s65, s65, 1
    ds_write_b16 v240, v246
    s_cbranch_scc1 L_store
    v_add_u32 v240, 128, v240
    s_add_u32 s24, s24, 819200
    s_addc_u32 s25, s25, 0
    s_branch Ls_flushed1
Ls_wb1:
    v_mul_u32_u24 v216, v224, v241
    v_mul_u32_u24 v217, v224, v242
    v_mul_u32_u24 v218, v225, v241
    v_mul_u32_u24 v219, v225, v242
    v_mul_u32_u24 v220, v226, v241
    v_mul_u32_u24 v221, v226, v242
    v_mul_u32_u24 v222, v227, v241
    v_mul_u32_u24 v223, v227, v242
    v_add_u32 v238, 128, v238
    ds_read_b128 v[164:167], v239
    v_mfma_f32_16x16x16_bf16 v[148:151], v[216:217], v[68:69], v[4:7]
    v_mfma_f32_16x16x16_bf16 v[152:155], v[218:219], v[70:71], v[8:11]
    ds_read_b128 v[168:171], v239 offset:64
    ds_read_b128 v[172:175], v239 offset:128
    ds_read_b128 v[176:179], v239 offset:192
    v_mfma_f32_16x16x16_bf16 v[156:159], v[220:221], v[72:73], v[12:15]
    v_mfma_f32_16x16x16_bf16 v[160:163], v[222:223], v[74:75], v[16:19]
    ds_read_u16 v224, v238 offset:0
    ds_read_u16 v225, v238 offset:8
    ds_read_u16 v226, v238 offset:64
    ds_read_u16 v227, v238 offset:72
    v_mfma_f32_16x16x16_bf16 v[246:249], v[216:217], v[76:77], v[20:23]
    v_mfma_f32_16x16x16_bf16 v[250:253], v[218:219], v[78:79], v[24:27]
    v_add_u32 v239, 256, v239
    v_cvt_pk_bf16_f32 v100, v148, v149
    v_cvt_pk_bf16_f32 v101, v150, v151
    v_cvt_pk_bf16_f32 v102, v152, v153
    v_cvt_pk_bf16_f32 v103, v154, v155
    v_mfma_f32_16x16x16_bf16 v[148:151], v[220:221], v[80:81], v[28:31]
    v_mfma_f32_16x16x16_bf16 v[152:155], v[222:223], v[82:83], v[32:35]
    v_cvt_pk_bf16_f32 v104, v156, v157
    v_cvt_pk_bf16_f32 v105, v158, v159
    v_cvt_pk_bf16_f32 v106, v160, v161
    v_cvt_pk_bf16_f32 v107, v162, v163
    v_mfma_f32_16x16x16_bf16 v[156:159], v[216:217], v[84:85], v[36:39]
    v_mfma_f32_16x16x16_bf16 v[160:163], v[218:219], v[86:87], v[40:43]
    v_cvt_pk_bf16_f32 v108, v246, v247
    v_cvt_pk_bf16_f32 v109, v248, v249
    v_cvt_pk_bf16_f32 v110, v250, v251
    v_cvt_pk_bf16_f32 v111, v252, v253
    v_mfma_f32_16x16x16_bf16 v[246:249], v[220:221], v[88:89], v[44:47]
    v_mfma_f32_16x16x16_bf16 v[250:253], v[222:223], v[90:91], v[48:51]
    v_cvt_pk_bf16_f32 v112, v148, v149
    v_cvt_pk_bf16_f32 v113, v150, v151
    v_cvt_pk_bf16_f32 v114, v152, v153
    v_cvt_pk_bf16_f32 v115, v154, v155
    v_mfma_f32_16x16x16_bf16 v[148:151], v[216:217], v[92:93], v[52:55]
    v_mfma_f32_16x16x16_bf16 v[152:155], v[218:219], v[94:95], v[56:59]
    v_cvt_pk_bf16_f32 v116, v156, v157
    v_cvt_pk_bf16_f32 v117, v158, v159
    v_cvt_pk_bf16_f32 v118, v160, v161
    v_cvt_pk_bf16_f32 v119, v162, v163
    v_mfma_f32_16x16x16_bf16 v[156:159], v[220:221], v[96:97], v[60:63]
    v_mfma_f32_16x16x16_bf16 v[160:163], v[222:223], v[98:99], v[64:67]
    v_cvt_pk_bf16_f32 v120, v246, v247
    v_cvt_pk_bf16_f32 v121, v248, v249
    v_cvt_pk_bf16_f32 v122, v250, v251
    v_cvt_pk_bf16_f32 v123, v252, v253
    v_cvt_pk_bf16_f32 v124, v148, v149
    v_cvt_pk_bf16_f32 v125, v150, v151
    v_cvt_pk_bf16_f32 v126, v152, v153
    v_cvt_pk_bf16_f32 v127, v154, v155
    v_cvt_pk_bf16_f32 v128, v156, v157
    v_cvt_pk_bf16_f32 v129, v158, v159
    v_cvt_pk_bf16_f32 v130, v160, v161
    v_cvt_pk_bf16_f32 v131, v162, v163
    s_waitcnt lgkmcnt(0)
    s_branch Ls_wbd1
Ls_adv1:
    s_add_u32 s20, s20, 52428800
    s_addc_u32 s21, s21, 0
    s_branch Ls_advd1
Ls_flush2:
    v_cvt_pk_bf16_f32 v246, v212, v212
    v_mov_b32 v212, 0
    s_sub_u32 s65, s65, 1
    ds_write_b16 v240, v246
    s_cbranch_scc1 L_store
    v_add_u32 v240, 128, v240
    s_add_u32 s24, s24, 819200
    s_addc_u32 s25, s25, 0
    s_branch Ls_flushed2
Ls_wb2:
    v_mul_u32_u24 v216, v224, v241
    v_mul_u32_u24 v217, v224, v242
    v_mul_u32_u24 v218, v225, v241
    v_mul_u32_u24 v219, v225, v242
    v_mul_u32_u24 v220, v226, v241
    v_mul_u32_u24 v221, v226, v242
    v_mul_u32_u24 v222, v227, v241
    v_mul_u32_u24 v223, v227, v242
    v_add_u32 v238, 128, v238
    ds_read_b128 v[164:167], v239
    v_mfma_f32_16x16x16_bf16 v[148:151], v[216:217], v[68:69], v[4:7]
    v_mfma_f32_16x16x16_bf16 v[152:155], v[218:219], v[70:71], v[8:11]
    ds_read_b128 v[168:171], v239 offset:64
    ds_read_b128 v[172:175], v239 offset:128
    ds_read_b128 v[176:179], v239 offset:192
    v_mfma_f32_16x16x16_bf16 v[156:159], v[220:221], v[72:73], v[12:15]
    v_mfma_f32_16x16x16_bf16 v[160:163], v[222:223], v[74:75], v[16:19]
    ds_read_u16 v224, v238 offset:0
    ds_read_u16 v225, v238 offset:8
    ds_read_u16 v226, v238 offset:64
    ds_read_u16 v227, v238 offset:72
    v_mfma_f32_16x16x16_bf16 v[246:249], v[216:217], v[76:77], v[20:23]
    v_mfma_f32_16x16x16_bf16 v[250:253], v[218:219], v[78:79], v[24:27]
    v_add_u32 v239, 256, v239
    v_cvt_pk_bf16_f32 v100, v148, v149
    v_cvt_pk_bf16_f32 v101, v150, v151
    v_cvt_pk_bf16_f32 v102, v152, v153
    v_cvt_pk_bf16_f32 v103, v154, v155
    v_mfma_f32_16x16x16_bf16 v[148:151], v[220:221], v[80:81], v[28:31]
    v_mfma_f32_16x16x16_bf16 v[152:155], v[222:223], v[82:83], v[32:35]
    v_cvt_pk_bf16_f32 v104, v156, v157
    v_cvt_pk_bf16_f32 v105, v158, v159
    v_cvt_pk_bf16_f32 v106, v160, v161
    v_cvt_pk_bf16_f32 v107, v162, v163
    v_mfma_f32_16x16x16_bf16 v[156:159], v[216:217], v[84:85], v[36:39]
    v_mfma_f32_16x16x16_bf16 v[160:163], v[218:219], v[86:87], v[40:43]
    v_cvt_pk_bf16_f32 v108, v246, v247
    v_cvt_pk_bf16_f32 v109, v248, v249
    v_cvt_pk_bf16_f32 v110, v250, v251
    v_cvt_pk_bf16_f32 v111, v252, v253
    v_mfma_f32_16x16x16_bf16 v[246:249], v[220:221], v[88:89], v[44:47]
    v_mfma_f32_16x16x16_bf16 v[250:253], v[222:223], v[90:91], v[48:51]
    v_cvt_pk_bf16_f32 v112, v148, v149
    v_cvt_pk_bf16_f32 v113, v150, v151
    v_cvt_pk_bf16_f32 v114, v152, v153
    v_cvt_pk_bf16_f32 v115, v154, v155
    v_mfma_f32_16x16x16_bf16 v[148:151], v[216:217], v[92:93], v[52:55]
    v_mfma_f32_16x16x16_bf16 v[152:155], v[218:219], v[94:95], v[56:59]
    v_cvt_pk_bf16_f32 v116, v156, v157
    v_cvt_pk_bf16_f32 v117, v158, v159
    v_cvt_pk_bf16_f32 v118, v160, v161
    v_cvt_pk_bf16_f32 v119, v162, v163
    v_mfma_f32_16x16x16_bf16 v[156:159], v[220:221], v[96:97], v[60:63]
    v_mfma_f32_16x16x16_bf16 v[160:163], v[222:223], v[98:99], v[64:67]
    v_cvt_pk_bf16_f32 v120, v246, v247
    v_cvt_pk_bf16_f32 v121, v248, v249
    v_cvt_pk_bf16_f32 v122, v250, v251
    v_cvt_pk_bf16_f32 v123, v252, v253
    v_cvt_pk_bf16_f32 v124, v148, v149
    v_cvt_pk_bf16_f32 v125, v150, v151
    v_cvt_pk_bf16_f32 v126, v152, v153
    v_cvt_pk_bf16_f32 v127, v154, v155
    v_cvt_pk_bf16_f32 v128, v156, v157
    v_cvt_pk_bf16_f32 v129, v158, v159
    v_cvt_pk_bf16_f32 v130, v160, v161
    v_cvt_pk_bf16_f32 v131, v162, v163
    s_waitcnt lgkmcnt(0)
    s_branch Ls_wbd2
Ls_adv2:
    s_add_u32 s20, s20, 52428800
    s_addc_u32 s21, s21, 0
    s_branch Ls_advd2
Ls_flush3:
    v_cvt_pk_bf16_f32 v246, v212, v212
    v_mov_b32 v212, 0
    s_sub_u32 s65, s65, 1
    ds_write_b16 v240, v246
    s_cbranch_scc1 L_store
    v_add_u32 v240, 128, v240
    s_add_u32 s24, s24, 819200
    s_addc_u32 s25, s25, 0
    s_branch Ls_flushed3
Ls_wb3:
    v_mul_u32_u24 v216, v224, v241
    v_mul_u32_u24 v217, v224, v242
    v_mul_u32_u24 v218, v225, v241
    v_mul_u32_u24 v219, v225, v242
    v_mul_u32_u24 v220, v226, v241
    v_mul_u32_u24 v221, v226, v242
    v_mul_u32_u24 v222, v227, v241
    v_mul_u32_u24 v223, v227, v242
    v_add_u32 v238, 128, v238
    ds_read_b128 v[164:167], v239
    v_mfma_f32_16x16x16_bf16 v[148:151], v[216:217], v[68:69], v[4:7]
    v_mfma_f32_16x16x16_bf16 v[152:155], v[218:219], v[70:71], v[8:11]
    ds_read_b128 v[168:171], v239 offset:64
    ds_read_b128 v[172:175], v239 offset:128
    ds_read_b128 v[176:179], v239 offset:192
    v_mfma_f32_16x16x16_bf16 v[156:159], v[220:221], v[72:73], v[12:15]
    v_mfma_f32_16x16x16_bf16 v[160:163], v[222:223], v[74:75], v[16:19]
    ds_read_u16 v224, v238 offset:0
    ds_read_u16 v225, v238 offset:8
    ds_read_u16 v226, v238 offset:64
    ds_read_u16 v227, v238 offset:72
    v_mfma_f32_16x16x16_bf16 v[246:249], v[216:217], v[76:77], v[20:23]
    v_mfma_f32_16x16x16_bf16 v[250:253], v[218:219], v[78:79], v[24:27]
    v_add_u32 v239, 256, v239
    v_cvt_pk_bf16_f32 v100, v148, v149
    v_cvt_pk_bf16_f32 v101, v150, v151
    v_cvt_pk_bf16_f32 v102, v152, v153
    v_cvt_pk_bf16_f32 v103, v154, v155
    v_mfma_f32_16x16x16_bf16 v[148:151], v[220:221], v[80:81], v[28:31]
    v_mfma_f32_16x16x16_bf16 v[152:155], v[222:223], v[82:83], v[32:35]
    v_cvt_pk_bf16_f32 v104, v156, v157
    v_cvt_pk_bf16_f32 v105, v158, v159
    v_cvt_pk_bf16_f32 v106, v160, v161
    v_cvt_pk_bf16_f32 v107, v162, v163
    v_mfma_f32_16x16x16_bf16 v[156:159], v[216:217], v[84:85], v[36:39]
    v_mfma_f32_16x16x16_bf16 v[160:163], v[218:219], v[86:87], v[40:43]
    v_cvt_pk_bf16_f32 v108, v246, v247
    v_cvt_pk_bf16_f32 v109, v248, v249
    v_cvt_pk_bf16_f32 v110, v250, v251
    v_cvt_pk_bf16_f32 v111, v252, v253
    v_mfma_f32_16x16x16_bf16 v[246:249], v[220:221], v[88:89], v[44:47]
    v_mfma_f32_16x16x16_bf16 v[250:253], v[222:223], v[90:91], v[48:51]
    v_cvt_pk_bf16_f32 v112, v148, v149
    v_cvt_pk_bf16_f32 v113, v150, v151
    v_cvt_pk_bf16_f32 v114, v152, v153
    v_cvt_pk_bf16_f32 v115, v154, v155
    v_mfma_f32_16x16x16_bf16 v[148:151], v[216:217], v[92:93], v[52:55]
    v_mfma_f32_16x16x16_bf16 v[152:155], v[218:219], v[94:95], v[56:59]
    v_cvt_pk_bf16_f32 v116, v156, v157
    v_cvt_pk_bf16_f32 v117, v158, v159
    v_cvt_pk_bf16_f32 v118, v160, v161
    v_cvt_pk_bf16_f32 v119, v162, v163
    v_mfma_f32_16x16x16_bf16 v[156:159], v[220:221], v[96:97], v[60:63]
    v_mfma_f32_16x16x16_bf16 v[160:163], v[222:223], v[98:99], v[64:67]
    v_cvt_pk_bf16_f32 v120, v246, v247
    v_cvt_pk_bf16_f32 v121, v248, v249
    v_cvt_pk_bf16_f32 v122, v250, v251
    v_cvt_pk_bf16_f32 v123, v252, v253
    v_cvt_pk_bf16_f32 v124, v148, v149
    v_cvt_pk_bf16_f32 v125, v150, v151
    v_cvt_pk_bf16_f32 v126, v152, v153
    v_cvt_pk_bf16_f32 v127, v154, v155
    v_cvt_pk_bf16_f32 v128, v156, v157
    v_cvt_pk_bf16_f32 v129, v158, v159
    v_cvt_pk_bf16_f32 v130, v160, v161
    v_cvt_pk_bf16_f32 v131, v162, v163
    s_waitcnt lgkmcnt(0)
    s_branch Ls_wbd3
Ls_adv3:
    s_add_u32 s20, s20, 52428800
    s_addc_u32 s21, s21, 0
    s_branch Ls_advd3
Ls_flush4:
    v_cvt_pk_bf16_f32 v246, v212, v212
    v_mov_b32 v212, 0
    s_sub_u32 s65, s65, 1
    ds_write_b16 v240, v246
    s_cbranch_scc1 L_store
    v_add_u32 v240, 128, v240
    s_add_u32 s24, s24, 819200
    s_addc_u32 s25, s25, 0
    s_branch Ls_flushed4
Ls_wb4:
    v_mul_u32_u24 v216, v224, v241
    v_mul_u32_u24 v217, v224, v242
    v_mul_u32_u24 v218, v225, v241
    v_mul_u32_u24 v219, v225, v242
    v_mul_u32_u24 v220, v226, v241
    v_mul_u32_u24 v221, v226, v242
    v_mul_u32_u24 v222, v227, v241
    v_mul_u32_u24 v223, v227, v242
    v_add_u32 v238, 128, v238
    ds_read_b128 v[164:167], v239
    v_mfma_f32_16x16x16_bf16 v[148:151], v[216:217], v[68:69], v[4:7]
    v_mfma_f32_16x16x16_bf16 v[152:155], v[218:219], v[70:71], v[8:11]
    ds_read_b128 v[168:171], v239 offset:64
    ds_read_b128 v[172:175], v239 offset:128
    ds_read_b128 v[176:179], v239 offset:192
    v_mfma_f32_16x16x16_bf16 v[156:159], v[220:221], v[72:73], v[12:15]
    v_mfma_f32_16x16x16_bf16 v[160:163], v[222:223], v[74:75], v[16:19]
    ds_read_u16 v224, v238 offset:0
    ds_read_u16 v225, v238 offset:8
    ds_read_u16 v226, v238 offset:64
    ds_read_u16 v227, v238 offset:72
    v_mfma_f32_16x16x16_bf16 v[246:249], v[216:217], v[76:77], v[20:23]
    v_mfma_f32_16x16x16_bf16 v[250:253], v[218:219], v[78:79], v[24:27]
    v_add_u32 v239, 256, v239
    v_cvt_pk_bf16_f32 v100, v148, v149
    v_cvt_pk_bf16_f32 v101, v150, v151
    v_cvt_pk_bf16_f32 v102, v152, v153
    v_cvt_pk_bf16_f32 v103, v154, v155
    v_mfma_f32_16x16x16_bf16 v[148:151], v[220:221], v[80:81], v[28:31]
    v_mfma_f32_16x16x16_bf16 v[152:155], v[222:223], v[82:83], v[32:35]
    v_cvt_pk_bf16_f32 v104, v156, v157
    v_cvt_pk_bf16_f32 v105, v158, v159
    v_cvt_pk_bf16_f32 v106, v160, v161
    v_cvt_pk_bf16_f32 v107, v162, v163
    v_mfma_f32_16x16x16_bf16 v[156:159], v[216:217], v[84:85], v[36:39]
    v_mfma_f32_16x16x16_bf16 v[160:163], v[218:219], v[86:87], v[40:43]
    v_cvt_pk_bf16_f32 v108, v246, v247
    v_cvt_pk_bf16_f32 v109, v248, v249
    v_cvt_pk_bf16_f32 v110, v250, v251
    v_cvt_pk_bf16_f32 v111, v252, v253
    v_mfma_f32_16x16x16_bf16 v[246:249], v[220:221], v[88:89], v[44:47]
    v_mfma_f32_16x16x16_bf16 v[250:253], v[222:223], v[90:91], v[48:51]
    v_cvt_pk_bf16_f32 v112, v148, v149
    v_cvt_pk_bf16_f32 v113, v150, v151
    v_cvt_pk_bf16_f32 v114, v152, v153
    v_cvt_pk_bf16_f32 v115, v154, v155
    v_mfma_f32_16x16x16_bf16 v[148:151], v[216:217], v[92:93], v[52:55]
    v_mfma_f32_16x16x16_bf16 v[152:155], v[218:219], v[94:95], v[56:59]
    v_cvt_pk_bf16_f32 v116, v156, v157
    v_cvt_pk_bf16_f32 v117, v158, v159
    v_cvt_pk_bf16_f32 v118, v160, v161
    v_cvt_pk_bf16_f32 v119, v162, v163
    v_mfma_f32_16x16x16_bf16 v[156:159], v[220:221], v[96:97], v[60:63]
    v_mfma_f32_16x16x16_bf16 v[160:163], v[222:223], v[98:99], v[64:67]
    v_cvt_pk_bf16_f32 v120, v246, v247
    v_cvt_pk_bf16_f32 v121, v248, v249
    v_cvt_pk_bf16_f32 v122, v250, v251
    v_cvt_pk_bf16_f32 v123, v252, v253
    v_cvt_pk_bf16_f32 v124, v148, v149
    v_cvt_pk_bf16_f32 v125, v150, v151
    v_cvt_pk_bf16_f32 v126, v152, v153
    v_cvt_pk_bf16_f32 v127, v154, v155
    v_cvt_pk_bf16_f32 v128, v156, v157
    v_cvt_pk_bf16_f32 v129, v158, v159
    v_cvt_pk_bf16_f32 v130, v160, v161
    v_cvt_pk_bf16_f32 v131, v162, v163
    s_waitcnt lgkmcnt(0)
    s_branch Ls_wbd4
Ls_adv4:
    s_add_u32 s20, s20, 52428800
    s_addc_u32 s21, s21, 0
    s_branch Ls_advd4
Ls_flush5:
    v_cvt_pk_bf16_f32 v246, v212, v212
    v_mov_b32 v212, 0
    s_sub_u32 s65, s65, 1
    ds_write_b16 v240, v246
    s_cbranch_scc1 L_store
    v_add_u32 v240, 128, v240
    s_add_u32 s24, s24, 819200
    s_addc_u32 s25, s25, 0
    s_branch Ls_flushed5
Ls_wb5:
    v_mul_u32_u24 v216, v224, v241
    v_mul_u32_u24 v217, v224, v242
    v_mul_u32_u24 v218, v225, v241
    v_mul_u32_u24 v219, v225, v242
    v_mul_u32_u24 v220, v226, v241
    v_mul_u32_u24 v221, v226, v242
    v_mul_u32_u24 v222, v227, v241
    v_mul_u32_u24 v223, v227, v242
    v_add_u32 v238, 128, v238
    ds_read_b128 v[164:167], v239
    v_mfma_f32_16x16x16_bf16 v[148:151], v[216:217], v[68:69], v[4:7]
    v_mfma_f32_16x16x16_bf16 v[152:155], v[218:219], v[70:71], v[8:11]
    ds_read_b128 v[168:171], v239 offset:64
    ds_read_b128 v[172:175], v239 offset:128
    ds_read_b128 v[176:179], v239 offset:192
    v_mfma_f32_16x16x16_bf16 v[156:159], v[220:221], v[72:73], v[12:15]
    v_mfma_f32_16x16x16_bf16 v[160:163], v[222:223], v[74:75], v[16:19]
    ds_read_u16 v224, v238 offset:0
    ds_read_u16 v225, v238 offset:8
    ds_read_u16 v226, v238 offset:64
    ds_read_u16 v227, v238 offset:72
    v_mfma_f32_16x16x16_bf16 v[246:249], v[216:217], v[76:77], v[20:23]
    v_mfma_f32_16x16x16_bf16 v[250:253], v[218:219], v[78:79], v[24:27]
    v_add_u32 v239, 256, v239
    v_cvt_pk_bf16_f32 v100, v148, v149
    v_cvt_pk_bf16_f32 v101, v150, v151
    v_cvt_pk_bf16_f32 v102, v152, v153
    v_cvt_pk_bf16_f32 v103, v154, v155
    v_mfma_f32_16x16x16_bf16 v[148:151], v[220:221], v[80:81], v[28:31]
    v_mfma_f32_16x16x16_bf16 v[152:155], v[222:223], v[82:83], v[32:35]
    v_cvt_pk_bf16_f32 v104, v156, v157
    v_cvt_pk_bf16_f32 v105, v158, v159
    v_cvt_pk_bf16_f32 v106, v160, v161
    v_cvt_pk_bf16_f32 v107, v162, v163
    v_mfma_f32_16x16x16_bf16 v[156:159], v[216:217], v[84:85], v[36:39]
    v_mfma_f32_16x16x16_bf16 v[160:163], v[218:219], v[86:87], v[40:43]
    v_cvt_pk_bf16_f32 v108, v246, v247
    v_cvt_pk_bf16_f32 v109, v248, v249
    v_cvt_pk_bf16_f32 v110, v250, v251
    v_cvt_pk_bf16_f32 v111, v252, v253
    v_mfma_f32_16x16x16_bf16 v[246:249], v[220:221], v[88:89], v[44:47]
    v_mfma_f32_16x16x16_bf16 v[250:253], v[222:223], v[90:91], v[48:51]
    v_cvt_pk_bf16_f32 v112, v148, v149
    v_cvt_pk_bf16_f32 v113, v150, v151
    v_cvt_pk_bf16_f32 v114, v152, v153
    v_cvt_pk_bf16_f32 v115, v154, v155
    v_mfma_f32_16x16x16_bf16 v[148:151], v[216:217], v[92:93], v[52:55]
    v_mfma_f32_16x16x16_bf16 v[152:155], v[218:219], v[94:95], v[56:59]
    v_cvt_pk_bf16_f32 v116, v156, v157
    v_cvt_pk_bf16_f32 v117, v158, v159
    v_cvt_pk_bf16_f32 v118, v160, v161
    v_cvt_pk_bf16_f32 v119, v162, v163
    v_mfma_f32_16x16x16_bf16 v[156:159], v[220:221], v[96:97], v[60:63]
    v_mfma_f32_16x16x16_bf16 v[160:163], v[222:223], v[98:99], v[64:67]
    v_cvt_pk_bf16_f32 v120, v246, v247
    v_cvt_pk_bf16_f32 v121, v248, v249
    v_cvt_pk_bf16_f32 v122, v250, v251
    v_cvt_pk_bf16_f32 v123, v252, v253
    v_cvt_pk_bf16_f32 v124, v148, v149
    v_cvt_pk_bf16_f32 v125, v150, v151
    v_cvt_pk_bf16_f32 v126, v152, v153
    v_cvt_pk_bf16_f32 v127, v154, v155
    v_cvt_pk_bf16_f32 v128, v156, v157
    v_cvt_pk_bf16_f32 v129, v158, v159
    v_cvt_pk_bf16_f32 v130, v160, v161
    v_cvt_pk_bf16_f32 v131, v162, v163
    s_waitcnt lgkmcnt(0)
    s_branch Ls_wbd5
Ls_adv5:
    s_add_u32 s20, s20, 52428800
    s_addc_u32 s21, s21, 0
    s_branch Ls_advd5
Ls_flush6:
    v_cvt_pk_bf16_f32 v246, v212, v212
    v_mov_b32 v212, 0
    s_sub_u32 s65, s65, 1
    ds_write_b16 v240, v246
    s_cbranch_scc1 L_store
    v_add_u32 v240, 128, v240
    s_add_u32 s24, s24, 819200
    s_addc_u32 s25, s25, 0
    s_branch Ls_flushed6
Ls_wb6:
    v_mul_u32_u24 v216, v224, v241
    v_mul_u32_u24 v217, v224, v242
    v_mul_u32_u24 v218, v225, v241
    v_mul_u32_u24 v219, v225, v242
    v_mul_u32_u24 v220, v226, v241
    v_mul_u32_u24 v221, v226, v242
    v_mul_u32_u24 v222, v227, v241
    v_mul_u32_u24 v223, v227, v242
    v_add_u32 v238, 128, v238
    ds_read_b128 v[164:167], v239
    v_mfma_f32_16x16x16_bf16 v[148:151], v[216:217], v[68:69], v[4:7]
    v_mfma_f32_16x16x16_bf16 v[152:155], v[218:219], v[70:71], v[8:11]
    ds_read_b128 v[168:171], v239 offset:64
    ds_read_b128 v[172:175], v239 offset:128
    ds_read_b128 v[176:179], v239 offset:192
    v_mfma_f32_16x16x16_bf16 v[156:159], v[220:221], v[72:73], v[12:15]
    v_mfma_f32_16x16x16_bf16 v[160:163], v[222:223], v[74:75], v[16:19]
    ds_read_u16 v224, v238 offset:0
    ds_read_u16 v225, v238 offset:8
    ds_read_u16 v226, v238 offset:64
    ds_read_u16 v227, v238 offset:72
    v_mfma_f32_16x16x16_bf16 v[246:249], v[216:217], v[76:77], v[20:23]
    v_mfma_f32_16x16x16_bf16 v[250:253], v[218:219], v[78:79], v[24:27]
    v_add_u32 v239, 256, v239
    v_cvt_pk_bf16_f32 v100, v148, v149
    v_cvt_pk_bf16_f32 v101, v150, v151
    v_cvt_pk_bf16_f32 v102, v152, v153
    v_cvt_pk_bf16_f32 v103, v154, v155
    v_mfma_f32_16x16x16_bf16 v[148:151], v[220:221], v[80:81], v[28:31]
    v_mfma_f32_16x16x16_bf16 v[152:155], v[222:223], v[82:83], v[32:35]
    v_cvt_pk_bf16_f32 v104, v156, v157
    v_cvt_pk_bf16_f32 v105, v158, v159
    v_cvt_pk_bf16_f32 v106, v160, v161
    v_cvt_pk_bf16_f32 v107, v162, v163
    v_mfma_f32_16x16x16_bf16 v[156:159], v[216:217], v[84:85], v[36:39]
    v_mfma_f32_16x16x16_bf16 v[160:163], v[218:219], v[86:87], v[40:43]
    v_cvt_pk_bf16_f32 v108, v246, v247
    v_cvt_pk_bf16_f32 v109, v248, v249
    v_cvt_pk_bf16_f32 v110, v250, v251
    v_cvt_pk_bf16_f32 v111, v252, v253
    v_mfma_f32_16x16x16_bf16 v[246:249], v[220:221], v[88:89], v[44:47]
    v_mfma_f32_16x16x16_bf16 v[250:253], v[222:223], v[90:91], v[48:51]
    v_cvt_pk_bf16_f32 v112, v148, v149
    v_cvt_pk_bf16_f32 v113, v150, v151
    v_cvt_pk_bf16_f32 v114, v152, v153
    v_cvt_pk_bf16_f32 v115, v154, v155
    v_mfma_f32_16x16x16_bf16 v[148:151], v[216:217], v[92:93], v[52:55]
    v_mfma_f32_16x16x16_bf16 v[152:155], v[218:219], v[94:95], v[56:59]
    v_cvt_pk_bf16_f32 v116, v156, v157
    v_cvt_pk_bf16_f32 v117, v158, v159
    v_cvt_pk_bf16_f32 v118, v160, v161
    v_cvt_pk_bf16_f32 v119, v162, v163
    v_mfma_f32_16x16x16_bf16 v[156:159], v[220:221], v[96:97], v[60:63]
    v_mfma_f32_16x16x16_bf16 v[160:163], v[222:223], v[98:99], v[64:67]
    v_cvt_pk_bf16_f32 v120, v246, v247
    v_cvt_pk_bf16_f32 v121, v248, v249
    v_cvt_pk_bf16_f32 v122, v250, v251
    v_cvt_pk_bf16_f32 v123, v252, v253
    v_cvt_pk_bf16_f32 v124, v148, v149
    v_cvt_pk_bf16_f32 v125, v150, v151
    v_cvt_pk_bf16_f32 v126, v152, v153
    v_cvt_pk_bf16_f32 v127, v154, v155
    v_cvt_pk_bf16_f32 v128, v156, v157
    v_cvt_pk_bf16_f32 v129, v158, v159
    v_cvt_pk_bf16_f32 v130, v160, v161
    v_cvt_pk_bf16_f32 v131, v162, v163
    s_waitcnt lgkmcnt(0)
    s_branch Ls_wbd6
Ls_adv6:
    s_add_u32 s20, s20, 52428800
    s_addc_u32 s21, s21, 0
    s_branch Ls_advd6
L_store:
    s_add_u32 s66, s52, 14560
    v_lshl_add_u32 v1, v0, 4, s66
    s_waitcnt lgkmcnt(0)
    ds_read_b128 v[148:151], v1
    s_waitcnt lgkmcnt(0)
    buffer_store_dwordx4 v[148:151], v243, s[48:51], 0 offen
L_end:
    s_endpgm
.section .rodata,"a"
.p2align 6
.amdhsa_kernel standalone__sequential_behavior_din__recsys_kernel
  .amdhsa_next_free_vgpr 256
  .amdhsa_next_free_sgpr 102
  .amdhsa_accum_offset 256
  .amdhsa_group_segment_fixed_size 0
  .amdhsa_kernarg_size 80
  .amdhsa_user_sgpr_count 2
  .amdhsa_user_sgpr_kernarg_segment_ptr 1
  .amdhsa_system_sgpr_workgroup_id_x 1
.end_amdhsa_kernel
```

```asm
; @launch grid=(256,1,1) block=(512,1,1) lds=163840
.amdgcn_target "amdgcn-amd-amdhsa--gfx950"
.text
.globl standalone__sequential_behavior_din__recsys_kernel
.p2align 8
.type standalone__sequential_behavior_din__recsys_kernel,@function
standalone__sequential_behavior_din__recsys_kernel:
    s_load_dwordx16 s[4:19], s[0:1], 0
    s_cmp_ge_u32 s2, 256
    s_cbranch_scc1 L_end
    v_lshrrev_b32 v1, 6, v0
    v_and_b32 v0, 63, v0
    v_readfirstlane_b32 s54, v1
    s_lshl_b32 s53, s2, 3
    v_lshlrev_b32 v2, 4, v0
    s_bfm_b64 s[28:29], 50, 0
    s_add_u32 s53, s53, s54
    s_mul_i32 s66, s53, 800
    s_mul_i32 s52, s54, 20480
    v_add_u32 v3, s66, v2
    v_and_b32 v248, 16, v0
    v_lshlrev_b32 v246, 1, v248
    v_xor_b32 v246, v246, v2
    s_lshl_b32 s67, s54, 12
    s_add_u32 m0, s52, 4160
    s_mov_b64 exec, s[28:29]
    s_waitcnt lgkmcnt(0)
    global_load_dwordx4 v[100:103], v3, s[8:9] nt
    s_mov_b64 exec, -1
    s_add_u32 s10, s10, s67
    s_addc_u32 s11, s11, 0
    v_xor_b32 v247, 64, v246
    global_load_lds_dwordx4 v246, s[10:11] offset:0
    global_load_lds_dwordx4 v247, s[10:11] offset:1024
    global_load_lds_dwordx4 v246, s[10:11] offset:2048
    global_load_lds_dwordx4 v247, s[10:11] offset:3072
    s_load_dword s30, s[16:17], 0
    v_lshrrev_b32 v1, 4, v0
    v_and_b32 v243, 0xf0, v2
    v_lshl_add_u32 v243, v1, 19, v243
    s_lshl_b32 s66, s53, 8
    s_add_u32 m0, s52, 8320
    v_add_u32 v243, s66, v243
    s_and_b32 s67, s54, 3
    global_load_lds_dwordx4 v243, s[4:5] nt
    s_lshl_b32 s66, s67, 5
    v_lshl_add_u32 v249, v1, 3, s66
    global_load_dwordx2 v[96:97], v249, s[12:13]
    s_mov_b64 exec, s[28:29]
    v_add_u32 v3, 1638400, v3
    global_load_dwordx4 v[104:107], v3, s[8:9] nt
    v_add_u32 v3, 1638400, v3
    global_load_dwordx4 v[108:111], v3, s[8:9] nt
    v_add_u32 v3, 1638400, v3
    global_load_dwordx4 v[112:115], v3, s[8:9] nt
    s_mov_b64 exec, -1
    v_and_b32 v250, 3, v0
    v_lshlrev_b32 v249, 3, v1
    v_lshl_add_u32 v249, v250, 5, v249
    global_load_dwordx2 v[216:217], v249, s[14:15]
    s_mul_i32 s66, s53, 51200
    s_add_u32 s6, s6, s66
    s_addc_u32 s7, s7, 0
    s_mov_b32 s20, s6
    s_and_b32 s21, s7, 0xffff
    s_or_b32 s21, s21, 0x800000
    s_mov_b32 s22, 200
    s_mov_b32 s23, 0x20000
    s_movk_i32 s31, 25600
    v_mov_b32 v148, -1
    v_mov_b32 v149, -1
    v_mov_b32 v150, -1
    v_mov_b32 v151, -1
    s_add_u32 s66, s52, 18416
    v_add_u32 v152, s66, v2
    ds_write_b128 v152, v[148:151]
    ds_write_b128 v152, v[148:151] offset:1024
    s_add_u32 s64, s52, 18432
    v_lshrrev_b32 v237, 3, v0
    v_add_u32 v237, s64, v237
    v_lshl_add_u32 v244, v1, 2, s66
    v_and_b32 v231, 0x70, v2
    v_lshlrev_b32 v248, 2, v248
    v_xor_b32 v231, v231, v248
    v_mov_b32 v233, v231
    v_cmp_lt_u32 vcc, 24, v0
    v_mov_b32 v146, 0
    v_mov_b32 v147, 0
    v_cndmask_b32 v145, 0, 1, vcc
    v_mul_u32_u24 v142, 25, v145
    v_sub_u32 v142, v0, v142
    v_mul_u32_u24 v142, 0x80008, v142
    v_add_u32 v141, 0x10000, v142
    v_add_u32 v143, 0x50004, v142
    v_add_u32 v144, 0x70006, v142
    v_add_u32 v142, 0x30002, v142
    s_mov_b64 s[56:57], 0
    s_mov_b64 s[58:59], 0
    s_mov_b32 s65, 7
    s_mov_b32 s92, 0xbfb8aa3b
    v_and_b32 v251, 15, v0
    v_bfe_u32 v252, v0, 2, 2
    v_and_b32 v246, 8, v0
    v_lshlrev_b32 v246, 2, v246
    v_lshl_add_u32 v246, v251, 7, v246
    v_add_u32 v246, s52, v246
    v_and_b32 v247, 2, v0
    v_lshlrev_b32 v248, 1, v247
    v_xor_b32 v248, v248, v1
    v_lshl_add_u32 v234, v248, 4, v246
    v_xor_b32 v248, 4, v248
    v_lshl_add_u32 v235, v248, 4, v246
    v_lshlrev_b32 v253, 3, v250
    v_lshl_add_u32 v253, v252, 7, v253
    v_and_b32 v246, 8, v0
    v_lshlrev_b32 v247, 3, v246
    v_lshl_add_u32 v248, v1, 5, v253
    v_xor_b32 v248, v248, v247
    v_add_u32 v236, s52, v248
    v_lshlrev_b32 v246, 2, v246
    v_xor_b32 v253, v253, v246
    v_and_b32 v246, 16, v0
    v_lshlrev_b32 v246, 2, v246
    v_xor_b32 v253, v253, v246
    v_lshl_add_u32 v253, v1, 10, v253
    s_lshl_b32 s66, s67, 5
    v_xor_b32 v66, s66, v253
    v_add_u32 v66, 45120, v66
    s_lshr_b32 s66, s54, 1
    s_lshl_b32 s66, s66, 5
    v_xor_b32 v64, s66, v253
    s_and_b32 s66, s54, 1
    s_mul_i32 s66, s66, 20480
    s_add_u32 s66, s66, 4160
    v_add_u32 v64, s66, v64
    v_add_u32 v65, 81920, v64
    s_add_u32 s66, s52, 8320
    v_lshl_add_u32 v238, v250, 1, s66
    v_lshl_add_u32 v238, v252, 4, v238
    v_lshl_add_u32 v240, v0, 1, s66
    s_add_u32 s66, s52, 9344
    v_lshl_add_u32 v239, v1, 4, s66
    s_and_b32 s66, s54, 4
    v_lshrrev_b32 v246, 3, v251
    v_add_u32 v246, s66, v246
    v_mul_u32_u24 v246, 20480, v246
    v_lshl_add_u32 v246, v1, 4, v246
    v_and_b32 v247, 7, v0
    v_lshl_add_u32 v67, v247, 7, v246
    v_lshl_add_u32 v98, v247, 8, v246
    s_lshl_b32 s66, s67, 6
    s_add_u32 s66, s66, 9344
    v_add_u32 v98, s66, v98
    v_cmp_eq_u32 vcc, v252, v1
    v_and_b32 v246, 1, v0
    v_lshlrev_b32 v246, 4, v246
    v_lshlrev_b32 v246, v246, 1
    v_cndmask_b32 v246, 0, v246, vcc
    v_cmp_gt_u32 vcc, 2, v250
    v_mov_b32 v229, 0
    v_mov_b32 v228, 0x3f80
    v_cndmask_b32 v241, 0, v246, vcc
    v_cmp_eq_u32 vcc, 0, v251
    v_sub_u32 v242, v246, v241
    v_mul_u32_u24 v218, 0x3f80, v241
    v_cndmask_b32 v220, 0, -1, vcc
    v_mul_u32_u24 v219, 0x3f80, v242
    s_and_b32 s66, s54, 3
    s_mul_i32 s66, s66, 20480
    s_add_u32 s66, s66, 11392
    v_mov_b32 v221, s66
    s_cmp_ge_u32 s54, 4
    s_cselect_b32 s33, -1, 0
    ds_write_b32 v221, v229
    s_waitcnt vmcnt(10) lgkmcnt(0)
    s_mov_b64 exec, s[28:29]
    v_cmp_neq_f16_sdwa s[68:69], v100, 0 src0_sel:WORD_0 src1_sel:WORD_0
    v_cmp_neq_f16_sdwa s[70:71], v100, 0 src0_sel:WORD_1 src1_sel:WORD_0
    v_cmp_neq_f16_sdwa s[72:73], v101, 0 src0_sel:WORD_0 src1_sel:WORD_0
    v_cmp_neq_f16_sdwa s[74:75], v101, 0 src0_sel:WORD_1 src1_sel:WORD_0
    v_cmp_neq_f16_sdwa s[76:77], v102, 0 src0_sel:WORD_0 src1_sel:WORD_0
    v_cmp_neq_f16_sdwa s[78:79], v102, 0 src0_sel:WORD_1 src1_sel:WORD_0
    v_cmp_neq_f16_sdwa s[80:81], v103, 0 src0_sel:WORD_0 src1_sel:WORD_0
    v_cmp_neq_f16_sdwa s[82:83], v103, 0 src0_sel:WORD_1 src1_sel:WORD_0
    v_sad_u16 v147, v100, 0, v147
    v_sad_u16 v147, v101, 0, v147
    v_sad_u16 v147, v102, 0, v147
    v_sad_u16 v147, v103, 0, v147
    v_or3_b32 v146, v100, v101, v146
    v_or3_b32 v146, v102, v103, v146
    s_mov_b64 exec, -1
    v_mov_b32 v132, s64
    v_mbcnt_lo_u32_b32 v132, s68, v132
    v_mbcnt_hi_u32_b32 v132, s69, v132
    v_mbcnt_lo_u32_b32 v132, s70, v132
    v_mbcnt_hi_u32_b32 v132, s71, v132
    v_mbcnt_lo_u32_b32 v132, s72, v132
    v_mbcnt_hi_u32_b32 v132, s73, v132
    v_mbcnt_lo_u32_b32 v132, s74, v132
    v_mbcnt_hi_u32_b32 v132, s75, v132
    v_mbcnt_lo_u32_b32 v132, s76, v132
    v_mbcnt_hi_u32_b32 v132, s77, v132
    v_mbcnt_lo_u32_b32 v132, s78, v132
    v_mbcnt_hi_u32_b32 v132, s79, v132
    v_mbcnt_lo_u32_b32 v132, s80, v132
    v_mbcnt_hi_u32_b32 v132, s81, v132
    v_mbcnt_lo_u32_b32 v132, s82, v132
    v_mbcnt_hi_u32_b32 v132, s83, v132
    s_add_u32 s34, s64, 16
    v_readlane_b32 s66, v132, 25
    v_readlane_b32 s67, v132, 63
    s_add_u32 s64, s66, 15
    s_and_b32 s64, s64, -16
    s_max_u32 s64, s64, s34
    s_sub_u32 s66, s64, s66
    v_mad_u32_u24 v132, v145, s66, v132
    s_lshr_b32 s35, s64, 4
    s_bitset1_b64 s[56:57], s35
    v_addc_co_u32 v133, vcc, 0, v132, s[68:69]
    v_addc_co_u32 v134, vcc, 0, v133, s[70:71]
    v_addc_co_u32 v135, vcc, 0, v134, s[72:73]
    v_addc_co_u32 v136, vcc, 0, v135, s[74:75]
    v_addc_co_u32 v137, vcc, 0, v136, s[76:77]
    v_addc_co_u32 v138, vcc, 0, v137, s[78:79]
    v_addc_co_u32 v139, vcc, 0, v138, s[80:81]
    v_addc_co_u32 v140, vcc, 0, v139, s[82:83]
    s_add_u32 s67, s67, s66
    s_add_u32 s67, s67, 15
    s_and_b32 s67, s67, -16
    s_add_u32 s64, s64, 16
    s_max_u32 s64, s64, s67
    s_mov_b64 exec, s[68:69]
    ds_write_b8 v132, v141
    s_mov_b64 exec, s[70:71]
    ds_write_b8_d16_hi v133, v141
    s_mov_b64 exec, s[72:73]
    ds_write_b8 v134, v142
    s_mov_b64 exec, s[74:75]
    ds_write_b8_d16_hi v135, v142
    s_mov_b64 exec, s[76:77]
    ds_write_b8 v136, v143
    s_mov_b64 exec, s[78:79]
    ds_write_b8_d16_hi v137, v143
    s_mov_b64 exec, s[80:81]
    ds_write_b8 v138, v144
    s_mov_b64 exec, s[82:83]
    ds_write_b8_d16_hi v139, v144
    s_mov_b64 exec, -1
    v_sub_u32 v140, v132, v140
    s_movk_i32 s66, 0x3f80
    v_mad_i32_i24 v147, v140, s66, v147
    s_lshr_b32 s35, s64, 4
    s_bitset1_b64 s[56:57], s35
    s_add_u32 s66, s52, 18496
    s_cmp_ge_u32 s64, s66
    s_cselect_b32 s94, 1, 0
    s_cbranch_scc1 L_early
    s_waitcnt vmcnt(0)
L_early:
    ds_read_u8 v148, v237 offset:0
    ds_read_u8 v149, v237 offset:8
    ds_read_u8 v150, v237 offset:16
    ds_read_u8 v151, v237 offset:24
    ds_read_u8 v152, v237 offset:32
    ds_read_u8 v153, v237 offset:40
    ds_read_u8 v154, v237 offset:48
    ds_read_u8 v155, v237 offset:56
    s_waitcnt lgkmcnt(0)
    s_cmp_eq_u32 s94, 0
    s_cbranch_scc1 L_skip0
    s_add_u32 m0, s52, 0
    v_mov_b32 v230, v148
    v_mov_b32 v232, v149
    buffer_load_dwordx4 v[230:231], s[20:23], 0 idxen offen nt lds
    s_add_u32 m0, s52, 1056
    s_nop 0
    buffer_load_dwordx4 v[232:233], s[20:23], 0 idxen offen nt lds
    s_bitcmp0_b64 s[56:57], 1
    s_cbranch_scc1 L_noadve1
    s_add_u32 s20, s20, s31
    s_addc_u32 s21, s21, 0
    s_xor_b32 s31, s31, 0x63ff800
L_noadve1:
    s_add_u32 m0, s52, 2080
    v_mov_b32 v230, v150
    v_mov_b32 v232, v151
    buffer_load_dwordx4 v[230:231], s[20:23], 0 idxen offen nt lds
    s_add_u32 m0, s52, 3136
    s_nop 0
    buffer_load_dwordx4 v[232:233], s[20:23], 0 idxen offen nt lds
L_skip0:
    s_waitcnt vmcnt(8)
    s_barrier
    ds_read_b64_tr_b16 v[16:17], v66 offset:0
    ds_read_b64_tr_b16 v[18:19], v66 offset:512
    ds_read_b64_tr_b16 v[20:21], v66 offset:20480
    ds_read_b64_tr_b16 v[22:23], v66 offset:20992
    ds_read_b64_tr_b16 v[24:25], v66 offset:40960
    ds_read_b64_tr_b16 v[26:27], v66 offset:41472
    ds_read_b64_tr_b16 v[28:29], v66 offset:61440
    ds_read_b64_tr_b16 v[30:31], v66 offset:61952
    ds_read_b128 v[32:35], v67 offset:8320
    ds_read_b128 v[36:39], v67 offset:8384
    ds_read_b128 v[40:43], v67 offset:49280
    ds_read_b128 v[44:47], v67 offset:49344
    ds_read_b64_tr_b16 v[4:5], v64 offset:0
    ds_read_b64_tr_b16 v[8:9], v65 offset:0
    ds_read_b64_tr_b16 v[12:13], v65 offset:40960
    ds_read_b64_tr_b16 v[6:7], v64 offset:512
    ds_read_b64_tr_b16 v[10:11], v65 offset:512
    ds_read_b64_tr_b16 v[14:15], v65 offset:41472
    v_lshlrev_b32 v48, 16, v96
    v_and_b32 v49, 0xffff0000, v96
    v_lshlrev_b32 v50, 16, v97
    v_and_b32 v51, 0xffff0000, v97
    s_waitcnt vmcnt(7)
    s_mov_b64 exec, s[28:29]
    v_cmp_neq_f16_sdwa s[68:69], v104, 0 src0_sel:WORD_0 src1_sel:WORD_0
    v_cmp_neq_f16_sdwa s[70:71], v104, 0 src0_sel:WORD_1 src1_sel:WORD_0
    v_cmp_neq_f16_sdwa s[72:73], v105, 0 src0_sel:WORD_0 src1_sel:WORD_0
    v_cmp_neq_f16_sdwa s[74:75], v105, 0 src0_sel:WORD_1 src1_sel:WORD_0
    v_cmp_neq_f16_sdwa s[76:77], v106, 0 src0_sel:WORD_0 src1_sel:WORD_0
    v_cmp_neq_f16_sdwa s[78:79], v106, 0 src0_sel:WORD_1 src1_sel:WORD_0
    v_cmp_neq_f16_sdwa s[80:81], v107, 0 src0_sel:WORD_0 src1_sel:WORD_0
    v_cmp_neq_f16_sdwa s[82:83], v107, 0 src0_sel:WORD_1 src1_sel:WORD_0
    v_sad_u16 v147, v104, 0, v147
    v_sad_u16 v147, v105, 0, v147
    v_sad_u16 v147, v106, 0, v147
    v_sad_u16 v147, v107, 0, v147
    v_or3_b32 v146, v104, v105, v146
    v_or3_b32 v146, v106, v107, v146
    s_mov_b64 exec, -1
    v_mov_b32 v132, s64
    v_mbcnt_lo_u32_b32 v132, s68, v132
    v_mbcnt_hi_u32_b32 v132, s69, v132
    v_mbcnt_lo_u32_b32 v132, s70, v132
    v_mbcnt_hi_u32_b32 v132, s71, v132
    v_mbcnt_lo_u32_b32 v132, s72, v132
    v_mbcnt_hi_u32_b32 v132, s73, v132
    v_mbcnt_lo_u32_b32 v132, s74, v132
    v_mbcnt_hi_u32_b32 v132, s75, v132
    v_mbcnt_lo_u32_b32 v132, s76, v132
    v_mbcnt_hi_u32_b32 v132, s77, v132
    v_mbcnt_lo_u32_b32 v132, s78, v132
    v_mbcnt_hi_u32_b32 v132, s79, v132
    v_mbcnt_lo_u32_b32 v132, s80, v132
    v_mbcnt_hi_u32_b32 v132, s81, v132
    v_mbcnt_lo_u32_b32 v132, s82, v132
    v_mbcnt_hi_u32_b32 v132, s83, v132
    s_add_u32 s34, s64, 16
    v_readlane_b32 s66, v132, 25
    v_readlane_b32 s67, v132, 63
    s_add_u32 s64, s66, 15
    s_and_b32 s64, s64, -16
    s_max_u32 s64, s64, s34
    s_sub_u32 s66, s64, s66
    v_mad_u32_u24 v132, v145, s66, v132
    s_lshr_b32 s35, s64, 4
    s_bitset1_b64 s[56:57], s35
    v_addc_co_u32 v133, vcc, 0, v132, s[68:69]
    v_addc_co_u32 v134, vcc, 0, v133, s[70:71]
    v_addc_co_u32 v135, vcc, 0, v134, s[72:73]
    v_addc_co_u32 v136, vcc, 0, v135, s[74:75]
    v_addc_co_u32 v137, vcc, 0, v136, s[76:77]
    v_addc_co_u32 v138, vcc, 0, v137, s[78:79]
    v_addc_co_u32 v139, vcc, 0, v138, s[80:81]
    v_addc_co_u32 v140, vcc, 0, v139, s[82:83]
    s_add_u32 s67, s67, s66
    s_add_u32 s67, s67, 15
    s_and_b32 s67, s67, -16
    s_add_u32 s64, s64, 16
    s_max_u32 s64, s64, s67
    s_mov_b64 exec, s[68:69]
    ds_write_b8 v132, v141
    s_mov_b64 exec, s[70:71]
    ds_write_b8_d16_hi v133, v141
    s_mov_b64 exec, s[72:73]
    ds_write_b8 v134, v142
    s_mov_b64 exec, s[74:75]
    ds_write_b8_d16_hi v135, v142
    s_mov_b64 exec, s[76:77]
    ds_write_b8 v136, v143
    s_mov_b64 exec, s[78:79]
    ds_write_b8_d16_hi v137, v143
    s_mov_b64 exec, s[80:81]
    ds_write_b8 v138, v144
    s_mov_b64 exec, s[82:83]
    ds_write_b8_d16_hi v139, v144
    s_mov_b64 exec, -1
    v_sub_u32 v140, v132, v140
    s_movk_i32 s66, 0x3f80
    v_mad_i32_i24 v147, v140, s66, v147
    s_lshr_b32 s35, s64, 4
    s_bitset1_b64 s[56:57], s35
    s_waitcnt lgkmcnt(0)
    v_xor_b32 v24, 0x80008000, v24
    v_xor_b32 v25, 0x80008000, v25
    v_xor_b32 v26, 0x80008000, v26
    v_xor_b32 v27, 0x80008000, v27
    v_xor_b32 v28, 0x80008000, v28
    v_xor_b32 v29, 0x80008000, v29
    v_xor_b32 v30, 0x80008000, v30
    v_xor_b32 v31, 0x80008000, v31
    v_mfma_f32_16x16x16_bf16 v[56:59], v[218:219], v[4:5], 0
    v_mfma_f32_16x16x16_bf16 v[56:59], v[218:219], v[8:9], v[56:59]
    v_mfma_f32_16x16x16_bf16 v[68:71], v[218:219], v[12:13], 0
    v_mfma_f32_16x16x16_bf16 v[60:63], v[218:219], v[6:7], 0
    v_mfma_f32_16x16x16_bf16 v[60:63], v[218:219], v[10:11], v[60:63]
    v_mfma_f32_16x16x16_bf16 v[72:75], v[218:219], v[14:15], 0
    v_mfma_f32_16x16x32_bf16 v[52:55], v[16:19], v[40:43], v[48:51]
    v_mfma_f32_16x16x32_bf16 v[52:55], v[20:23], v[44:47], v[52:55]
    v_mfma_f32_16x16x32_bf16 v[52:55], v[24:27], v[40:43], v[52:55]
    v_mfma_f32_16x16x32_bf16 v[52:55], v[28:31], v[44:47], v[52:55]
    v_mfma_f32_16x16x32_bf16 v[48:51], v[16:19], v[32:35], v[48:51]
    v_mfma_f32_16x16x32_bf16 v[48:51], v[20:23], v[36:39], v[48:51]
    v_mfma_f32_16x16x32_bf16 v[48:51], v[24:27], v[32:35], v[48:51]
    v_mfma_f32_16x16x32_bf16 v[48:51], v[28:31], v[36:39], v[48:51]
    v_mul_f32 v56, s92, v56
    v_mul_f32 v57, s92, v57
    v_mul_f32 v58, s92, v58
    v_mul_f32 v59, s92, v59
    v_mul_f32 v60, s92, v60
    v_mul_f32 v61, s92, v61
    v_mul_f32 v62, s92, v62
    v_mul_f32 v63, s92, v63
    v_mul_f32 v68, s92, v68
    v_mul_f32 v69, s92, v69
    v_mul_f32 v70, s92, v70
    v_mul_f32 v71, s92, v71
    v_mul_f32 v72, s92, v72
    v_mul_f32 v73, s92, v73
    v_mul_f32 v74, s92, v74
    v_mul_f32 v75, s92, v75
    s_add_u32 s66, s52, 4160
    v_add_u32 v3, s66, v2
    v_cvt_pk_bf16_f32 v68, v68, v69
    v_cvt_pk_bf16_f32 v69, v70, v71
    v_cvt_pk_bf16_f32 v70, v72, v73
    v_cvt_pk_bf16_f32 v71, v74, v75
    v_mul_f32 v48, s92, v48
    v_mul_f32 v49, s92, v49
    v_mul_f32 v50, s92, v50
    v_mul_f32 v51, s92, v51
    v_mul_f32 v52, s92, v52
    v_mul_f32 v53, s92, v53
    v_mul_f32 v54, s92, v54
    v_mul_f32 v55, s92, v55
    s_barrier
    ds_write_b128 v3, v[56:59]
    ds_write_b128 v3, v[60:63] offset:1024
    ds_write_b128 v3, v[68:71] offset:2048
    ds_write_b128 v98, v[48:51]
    ds_write_b128 v98, v[52:55] offset:40960
    v_add_u32 v3, 4160, v2
    v_add_u32 v246, 81920, v3
    s_waitcnt lgkmcnt(0)
    s_barrier
    ds_read_b128 v[4:7], v3 offset:0
    ds_read_b128 v[8:11], v3 offset:1024
    ds_read_b128 v[68:71], v3 offset:2048
    ds_read_b128 v[12:15], v3 offset:20480
    ds_read_b128 v[16:19], v3 offset:21504
    ds_read_b128 v[72:75], v3 offset:22528
    ds_read_b128 v[20:23], v3 offset:40960
    ds_read_b128 v[24:27], v3 offset:41984
    ds_read_b128 v[76:79], v3 offset:43008
    ds_read_b128 v[28:31], v3 offset:61440
    ds_read_b128 v[32:35], v3 offset:62464
    ds_read_b128 v[80:83], v3 offset:63488
    ds_read_b128 v[36:39], v246 offset:0
    ds_read_b128 v[40:43], v246 offset:1024
    ds_read_b128 v[84:87], v246 offset:2048
    ds_read_b128 v[44:47], v246 offset:20480
    ds_read_b128 v[48:51], v246 offset:21504
    ds_read_b128 v[88:91], v246 offset:22528
    ds_read_b128 v[52:55], v246 offset:40960
    ds_read_b128 v[56:59], v246 offset:41984
    ds_read_b128 v[92:95], v246 offset:43008
    ds_read_b128 v[60:63], v246 offset:61440
    ds_read_b128 v[64:67], v246 offset:62464
    ds_read_b128 v[96:99], v246 offset:63488
    ds_read_u16 v224, v238 offset:0
    ds_read_u16 v225, v238 offset:8
    ds_read_u16 v226, v238 offset:64
    ds_read_u16 v227, v238 offset:72
    s_waitcnt vmcnt(4)
    s_mov_b64 exec, s[28:29]
    v_cmp_neq_f16_sdwa s[68:69], v108, 0 src0_sel:WORD_0 src1_sel:WORD_0
    v_cmp_neq_f16_sdwa s[70:71], v108, 0 src0_sel:WORD_1 src1_sel:WORD_0
    v_cmp_neq_f16_sdwa s[72:73], v109, 0 src0_sel:WORD_0 src1_sel:WORD_0
    v_cmp_neq_f16_sdwa s[74:75], v109, 0 src0_sel:WORD_1 src1_sel:WORD_0
    v_cmp_neq_f16_sdwa s[76:77], v110, 0 src0_sel:WORD_0 src1_sel:WORD_0
    v_cmp_neq_f16_sdwa s[78:79], v110, 0 src0_sel:WORD_1 src1_sel:WORD_0
    v_cmp_neq_f16_sdwa s[80:81], v111, 0 src0_sel:WORD_0 src1_sel:WORD_0
    v_cmp_neq_f16_sdwa s[82:83], v111, 0 src0_sel:WORD_1 src1_sel:WORD_0
    v_sad_u16 v147, v108, 0, v147
    v_sad_u16 v147, v109, 0, v147
    v_sad_u16 v147, v110, 0, v147
    v_sad_u16 v147, v111, 0, v147
    v_or3_b32 v146, v108, v109, v146
    v_or3_b32 v146, v110, v111, v146
    s_mov_b64 exec, -1
    v_mov_b32 v132, s64
    v_mbcnt_lo_u32_b32 v132, s68, v132
    v_mbcnt_hi_u32_b32 v132, s69, v132
    v_mbcnt_lo_u32_b32 v132, s70, v132
    v_mbcnt_hi_u32_b32 v132, s71, v132
    v_mbcnt_lo_u32_b32 v132, s72, v132
    v_mbcnt_hi_u32_b32 v132, s73, v132
    v_mbcnt_lo_u32_b32 v132, s74, v132
    v_mbcnt_hi_u32_b32 v132, s75, v132
    v_mbcnt_lo_u32_b32 v132, s76, v132
    v_mbcnt_hi_u32_b32 v132, s77, v132
    v_mbcnt_lo_u32_b32 v132, s78, v132
    v_mbcnt_hi_u32_b32 v132, s79, v132
    v_mbcnt_lo_u32_b32 v132, s80, v132
    v_mbcnt_hi_u32_b32 v132, s81, v132
    v_mbcnt_lo_u32_b32 v132, s82, v132
    v_mbcnt_hi_u32_b32 v132, s83, v132
    s_add_u32 s34, s64, 16
    v_readlane_b32 s66, v132, 25
    v_readlane_b32 s67, v132, 63
    s_add_u32 s64, s66, 15
    s_and_b32 s64, s64, -16
    s_max_u32 s64, s64, s34
    s_sub_u32 s66, s64, s66
    v_mad_u32_u24 v132, v145, s66, v132
    s_lshr_b32 s35, s64, 4
    s_lshl_b64 s[86:87], 1, s35
    s_bitcmp1_b32 s64, 10
    s_cselect_b64 s[88:89], 0, s[86:87]
    s_cselect_b64 s[90:91], s[86:87], 0
    s_or_b64 s[56:57], s[56:57], s[88:89]
    s_or_b64 s[58:59], s[58:59], s[90:91]
    v_addc_co_u32 v133, vcc, 0, v132, s[68:69]
    v_addc_co_u32 v134, vcc, 0, v133, s[70:71]
    v_addc_co_u32 v135, vcc, 0, v134, s[72:73]
    v_addc_co_u32 v136, vcc, 0, v135, s[74:75]
    v_addc_co_u32 v137, vcc, 0, v136, s[76:77]
    v_addc_co_u32 v138, vcc, 0, v137, s[78:79]
    v_addc_co_u32 v139, vcc, 0, v138, s[80:81]
    v_addc_co_u32 v140, vcc, 0, v139, s[82:83]
    s_add_u32 s67, s67, s66
    s_add_u32 s67, s67, 15
    s_and_b32 s67, s67, -16
    s_add_u32 s64, s64, 16
    s_max_u32 s64, s64, s67
    s_mov_b64 exec, s[68:69]
    ds_write_b8 v132, v141
    s_mov_b64 exec, s[70:71]
    ds_write_b8_d16_hi v133, v141
    s_mov_b64 exec, s[72:73]
    ds_write_b8 v134, v142
    s_mov_b64 exec, s[74:75]
    ds_write_b8_d16_hi v135, v142
    s_mov_b64 exec, s[76:77]
    ds_write_b8 v136, v143
    s_mov_b64 exec, s[78:79]
    ds_write_b8_d16_hi v137, v143
    s_mov_b64 exec, s[80:81]
    ds_write_b8 v138, v144
    s_mov_b64 exec, s[82:83]
    ds_write_b8_d16_hi v139, v144
    s_mov_b64 exec, -1
    v_sub_u32 v140, v132, v140
    s_movk_i32 s66, 0x3f80
    v_mad_i32_i24 v147, v140, s66, v147
    s_lshr_b32 s35, s64, 4
    s_lshl_b64 s[86:87], 1, s35
    s_bitcmp1_b32 s64, 10
    s_cselect_b64 s[88:89], 0, s[86:87]
    s_cselect_b64 s[90:91], s[86:87], 0
    s_or_b64 s[56:57], s[56:57], s[88:89]
    s_or_b64 s[58:59], s[58:59], s[90:91]
    s_waitcnt lgkmcnt(0)
    s_barrier
    s_cmp_eq_u32 s94, 0
    s_cbranch_scc1 L_skip2
    s_bitcmp0_b64 s[56:57], 2
    s_cbranch_scc1 L_noadve2
    s_add_u32 s20, s20, s31
    s_addc_u32 s21, s21, 0
    s_xor_b32 s31, s31, 0x63ff800
L_noadve2:
    s_add_u32 m0, s52, 4160
    v_mov_b32 v230, v152
    v_mov_b32 v232, v153
    buffer_load_dwordx4 v[230:231], s[20:23], 0 idxen offen nt lds
    s_add_u32 m0, s52, 5216
    s_nop 0
    buffer_load_dwordx4 v[232:233], s[20:23], 0 idxen offen nt lds
    s_bitcmp0_b64 s[56:57], 3
    s_cbranch_scc1 L_noadve3
    s_add_u32 s20, s20, s31
    s_addc_u32 s21, s21, 0
    s_xor_b32 s31, s31, 0x63ff800
L_noadve3:
    s_add_u32 m0, s52, 6240
    v_mov_b32 v230, v154
    v_mov_b32 v232, v155
    buffer_load_dwordx4 v[230:231], s[20:23], 0 idxen offen nt lds
    s_add_u32 m0, s52, 7296
    s_nop 0
    buffer_load_dwordx4 v[232:233], s[20:23], 0 idxen offen nt lds
L_skip2:
    s_mov_b64 exec, s[28:29]
    v_cmp_neq_f16_sdwa s[68:69], v112, 0 src0_sel:WORD_0 src1_sel:WORD_0
    v_cmp_neq_f16_sdwa s[70:71], v112, 0 src0_sel:WORD_1 src1_sel:WORD_0
    v_cmp_neq_f16_sdwa s[72:73], v113, 0 src0_sel:WORD_0 src1_sel:WORD_0
    v_cmp_neq_f16_sdwa s[74:75], v113, 0 src0_sel:WORD_1 src1_sel:WORD_0
    v_cmp_neq_f16_sdwa s[76:77], v114, 0 src0_sel:WORD_0 src1_sel:WORD_0
    v_cmp_neq_f16_sdwa s[78:79], v114, 0 src0_sel:WORD_1 src1_sel:WORD_0
    v_cmp_neq_f16_sdwa s[80:81], v115, 0 src0_sel:WORD_0 src1_sel:WORD_0
    v_cmp_neq_f16_sdwa s[82:83], v115, 0 src0_sel:WORD_1 src1_sel:WORD_0
    v_sad_u16 v147, v112, 0, v147
    v_sad_u16 v147, v113, 0, v147
    v_sad_u16 v147, v114, 0, v147
    v_sad_u16 v147, v115, 0, v147
    v_or3_b32 v146, v112, v113, v146
    v_or3_b32 v146, v114, v115, v146
    s_mov_b64 exec, -1
    v_mov_b32 v132, s64
    v_mbcnt_lo_u32_b32 v132, s68, v132
    v_mbcnt_hi_u32_b32 v132, s69, v132
    v_mbcnt_lo_u32_b32 v132, s70, v132
    v_mbcnt_hi_u32_b32 v132, s71, v132
    v_mbcnt_lo_u32_b32 v132, s72, v132
    v_mbcnt_hi_u32_b32 v132, s73, v132
    v_mbcnt_lo_u32_b32 v132, s74, v132
    v_mbcnt_hi_u32_b32 v132, s75, v132
    v_mbcnt_lo_u32_b32 v132, s76, v132
    v_mbcnt_hi_u32_b32 v132, s77, v132
    v_mbcnt_lo_u32_b32 v132, s78, v132
    v_mbcnt_hi_u32_b32 v132, s79, v132
    v_mbcnt_lo_u32_b32 v132, s80, v132
    v_mbcnt_hi_u32_b32 v132, s81, v132
    v_mbcnt_lo_u32_b32 v132, s82, v132
    v_mbcnt_hi_u32_b32 v132, s83, v132
    s_add_u32 s34, s64, 16
    v_readlane_b32 s66, v132, 25
    v_readlane_b32 s67, v132, 63
    s_add_u32 s64, s66, 15
    s_and_b32 s64, s64, -16
    s_max_u32 s64, s64, s34
    s_sub_u32 s66, s64, s66
    v_mad_u32_u24 v132, v145, s66, v132
    s_lshr_b32 s35, s64, 4
    s_lshl_b64 s[86:87], 1, s35
    s_bitcmp1_b32 s64, 10
    s_cselect_b64 s[88:89], 0, s[86:87]
    s_cselect_b64 s[90:91], s[86:87], 0
    s_or_b64 s[56:57], s[56:57], s[88:89]
    s_or_b64 s[58:59], s[58:59], s[90:91]
    v_addc_co_u32 v133, vcc, 0, v132, s[68:69]
    v_addc_co_u32 v134, vcc, 0, v133, s[70:71]
    v_addc_co_u32 v135, vcc, 0, v134, s[72:73]
    v_addc_co_u32 v136, vcc, 0, v135, s[74:75]
    v_addc_co_u32 v137, vcc, 0, v136, s[76:77]
    v_addc_co_u32 v138, vcc, 0, v137, s[78:79]
    v_addc_co_u32 v139, vcc, 0, v138, s[80:81]
    v_addc_co_u32 v140, vcc, 0, v139, s[82:83]
    s_add_u32 s67, s67, s66
    s_add_u32 s67, s67, 15
    s_and_b32 s67, s67, -16
    s_add_u32 s64, s64, 16
    s_max_u32 s64, s64, s67
    s_mov_b64 exec, s[68:69]
    ds_write_b8 v132, v141
    s_mov_b64 exec, s[70:71]
    ds_write_b8_d16_hi v133, v141
    s_mov_b64 exec, s[72:73]
    ds_write_b8 v134, v142
    s_mov_b64 exec, s[74:75]
    ds_write_b8_d16_hi v135, v142
    s_mov_b64 exec, s[76:77]
    ds_write_b8 v136, v143
    s_mov_b64 exec, s[78:79]
    ds_write_b8_d16_hi v137, v143
    s_mov_b64 exec, s[80:81]
    ds_write_b8 v138, v144
    s_mov_b64 exec, s[82:83]
    ds_write_b8_d16_hi v139, v144
    s_mov_b64 exec, -1
    v_sub_u32 v140, v132, v140
    s_movk_i32 s66, 0x3f80
    s_mov_b64 s[60:61], s[56:57]
    s_mov_b64 s[62:63], s[58:59]
    v_mad_i32_i24 v147, v140, s66, v147
    s_lshr_b32 s35, s64, 4
    s_lshl_b64 s[86:87], 1, s35
    s_bitcmp1_b32 s64, 10
    s_cselect_b64 s[88:89], 0, s[86:87]
    s_cselect_b64 s[90:91], s[86:87], 0
    s_or_b64 s[56:57], s[56:57], s[88:89]
    s_or_b64 s[58:59], s[58:59], s[90:91]
    s_mov_b32 s66, 0xc07fc07f
    v_and_or_b32 v146, v146, s66, v147
    v_cmp_ne_u32 s[84:85], 0, v146
    s_sub_u32 s66, s64, s52
    s_sub_u32 s66, s66, 18432
    s_lshr_b32 s66, s66, 3
    s_xor_b32 s66, s66, s33
    s_sub_u32 s66, s66, s33
    s_xor_b32 s67, 0xfffffffc, s33
    s_sub_u32 s67, s67, s33
    v_mov_b32 v2, v221
    v_mov_b32 v1, s66
    v_mov_b32 v3, s67
    s_mov_b64 exec, 1
    ds_add_u32 v2, v1
    s_mov_b64 exec, -1
    s_cmp_eq_u32 s94, 1
    s_cbranch_scc1 L_nolate
    ds_read_u8 v148, v237 offset:0
    ds_read_u8 v149, v237 offset:8
    ds_read_u8 v150, v237 offset:16
    ds_read_u8 v151, v237 offset:24
    ds_read_u8 v152, v237 offset:32
    ds_read_u8 v153, v237 offset:40
    ds_read_u8 v154, v237 offset:48
    ds_read_u8 v155, v237 offset:56
    s_waitcnt lgkmcnt(0)
    s_add_u32 m0, s52, 0
    v_mov_b32 v230, v148
    v_mov_b32 v232, v149
    buffer_load_dwordx4 v[230:231], s[20:23], 0 idxen offen nt lds
    s_add_u32 m0, s52, 1056
    s_nop 0
    buffer_load_dwordx4 v[232:233], s[20:23], 0 idxen offen nt lds
    s_bitcmp0_b64 s[60:61], 1
    s_cbranch_scc1 L_noadvl1
    s_add_u32 s20, s20, s31
    s_addc_u32 s21, s21, 0
    s_xor_b32 s31, s31, 0x63ff800
L_noadvl1:
    s_add_u32 m0, s52, 2080
    v_mov_b32 v230, v150
    v_mov_b32 v232, v151
    buffer_load_dwordx4 v[230:231], s[20:23], 0 idxen offen nt lds
    s_add_u32 m0, s52, 3136
    s_nop 0
    buffer_load_dwordx4 v[232:233], s[20:23], 0 idxen offen nt lds
    s_bitcmp0_b64 s[60:61], 2
    s_cbranch_scc1 L_noadvl2
    s_add_u32 s20, s20, s31
    s_addc_u32 s21, s21, 0
    s_xor_b32 s31, s31, 0x63ff800
L_noadvl2:
    s_add_u32 m0, s52, 4160
    v_mov_b32 v230, v152
    v_mov_b32 v232, v153
    buffer_load_dwordx4 v[230:231], s[20:23], 0 idxen offen nt lds
    s_add_u32 m0, s52, 5216
    s_nop 0
    buffer_load_dwordx4 v[232:233], s[20:23], 0 idxen offen nt lds
    s_bitcmp0_b64 s[60:61], 3
    s_cbranch_scc1 L_noadvl3
    s_add_u32 s20, s20, s31
    s_addc_u32 s21, s21, 0
    s_xor_b32 s31, s31, 0x63ff800
L_noadvl3:
    s_add_u32 m0, s52, 6240
    v_mov_b32 v230, v154
    v_mov_b32 v232, v155
    buffer_load_dwordx4 v[230:231], s[20:23], 0 idxen offen nt lds
    s_add_u32 m0, s52, 7296
    s_nop 0
    buffer_load_dwordx4 v[232:233], s[20:23], 0 idxen offen nt lds
L_nolate:
    v_and_b32_dpp v196, v216, v220 quad_perm:[0,0,0,0] row_mask:0xf bank_mask:0xf
    v_and_b32_dpp v197, v217, v220 quad_perm:[0,0,0,0] row_mask:0xf bank_mask:0xf
    v_and_b32_dpp v198, v216, v220 quad_perm:[1,1,1,1] row_mask:0xf bank_mask:0xf
    v_and_b32_dpp v199, v217, v220 quad_perm:[1,1,1,1] row_mask:0xf bank_mask:0xf
    v_and_b32_dpp v200, v216, v220 quad_perm:[2,2,2,2] row_mask:0xf bank_mask:0xf
    v_and_b32_dpp v201, v217, v220 quad_perm:[2,2,2,2] row_mask:0xf bank_mask:0xf
    v_and_b32_dpp v202, v216, v220 quad_perm:[3,3,3,3] row_mask:0xf bank_mask:0xf
    v_and_b32_dpp v203, v217, v220 quad_perm:[3,3,3,3] row_mask:0xf bank_mask:0xf
    s_lshl_b32 s30, s30, 16
    v_and_b32 v204, s30, v220
    v_and_b32 v205, s30, v220
    v_and_b32 v206, s30, v220
    v_and_b32 v207, s30, v220
    v_mul_u32_u24 v216, v224, v241
    v_mul_u32_u24 v217, v224, v242
    v_mul_u32_u24 v218, v225, v241
    v_mul_u32_u24 v219, v225, v242
    v_mul_u32_u24 v220, v226, v241
    v_mul_u32_u24 v221, v226, v242
    v_mul_u32_u24 v222, v227, v241
    v_mul_u32_u24 v223, v227, v242
    v_add_u32 v238, 128, v238
    ds_read_b128 v[164:167], v239
    v_mfma_f32_16x16x16_bf16 v[132:135], v[216:217], v[68:69], v[4:7]
    ds_read_b128 v[168:171], v239 offset:64
    ds_read_b128 v[172:175], v239 offset:128
    v_mfma_f32_16x16x16_bf16 v[136:139], v[218:219], v[70:71], v[8:11]
    ds_read_b128 v[176:179], v239 offset:192
    ds_read_u16 v224, v238
    v_mfma_f32_16x16x16_bf16 v[140:143], v[220:221], v[72:73], v[12:15]
    ds_read_u16 v225, v238 offset:8
    ds_read_u16 v226, v238 offset:64
    v_mfma_f32_16x16x16_bf16 v[144:147], v[222:223], v[74:75], v[16:19]
    ds_read_u16 v227, v238 offset:72
    v_add_u32 v239, 256, v239
    v_mfma_f32_16x16x16_bf16 v[246:249], v[216:217], v[76:77], v[20:23]
    v_cvt_pk_bf16_f32 v100, v132, v133
    v_cvt_pk_bf16_f32 v101, v134, v135
    v_mfma_f32_16x16x16_bf16 v[250:253], v[218:219], v[78:79], v[24:27]
    v_cvt_pk_bf16_f32 v102, v136, v137
    v_cvt_pk_bf16_f32 v103, v138, v139
    v_mfma_f32_16x16x16_bf16 v[132:135], v[220:221], v[80:81], v[28:31]
    v_cvt_pk_bf16_f32 v104, v140, v141
    v_cvt_pk_bf16_f32 v105, v142, v143
    v_mfma_f32_16x16x16_bf16 v[136:139], v[222:223], v[82:83], v[32:35]
    v_cvt_pk_bf16_f32 v106, v144, v145
    v_cvt_pk_bf16_f32 v107, v146, v147
    v_mfma_f32_16x16x16_bf16 v[140:143], v[216:217], v[84:85], v[36:39]
    v_cvt_pk_bf16_f32 v108, v246, v247
    v_cvt_pk_bf16_f32 v109, v248, v249
    v_mfma_f32_16x16x16_bf16 v[144:147], v[218:219], v[86:87], v[40:43]
    v_cvt_pk_bf16_f32 v110, v250, v251
    v_cvt_pk_bf16_f32 v111, v252, v253
    v_mfma_f32_16x16x16_bf16 v[246:249], v[220:221], v[88:89], v[44:47]
    v_cvt_pk_bf16_f32 v112, v132, v133
    v_cvt_pk_bf16_f32 v113, v134, v135
    v_mfma_f32_16x16x16_bf16 v[250:253], v[222:223], v[90:91], v[48:51]
    v_cvt_pk_bf16_f32 v114, v136, v137
    v_cvt_pk_bf16_f32 v115, v138, v139
    v_mfma_f32_16x16x16_bf16 v[132:135], v[216:217], v[92:93], v[52:55]
    v_cvt_pk_bf16_f32 v116, v140, v141
    v_cvt_pk_bf16_f32 v117, v142, v143
    v_mfma_f32_16x16x16_bf16 v[136:139], v[218:219], v[94:95], v[56:59]
    v_cvt_pk_bf16_f32 v118, v144, v145
    v_cvt_pk_bf16_f32 v119, v146, v147
    v_mfma_f32_16x16x16_bf16 v[140:143], v[220:221], v[96:97], v[60:63]
    v_cvt_pk_bf16_f32 v120, v246, v247
    v_cvt_pk_bf16_f32 v121, v248, v249
    v_mfma_f32_16x16x16_bf16 v[144:147], v[222:223], v[98:99], v[64:67]
    v_cvt_pk_bf16_f32 v122, v250, v251
    v_cvt_pk_bf16_f32 v123, v252, v253
    v_cvt_pk_bf16_f32 v124, v132, v133
    v_cvt_pk_bf16_f32 v125, v134, v135
    v_cvt_pk_bf16_f32 v126, v136, v137
    v_cvt_pk_bf16_f32 v127, v138, v139
    v_cvt_pk_bf16_f32 v128, v140, v141
    v_cvt_pk_bf16_f32 v129, v142, v143
    v_cvt_pk_bf16_f32 v130, v144, v145
    v_cvt_pk_bf16_f32 v131, v146, v147
    s_waitcnt lgkmcnt(0)
    v_mov_b32 v188, 0
    v_mov_b32 v189, 0
    v_mov_b32 v190, 0
    v_mov_b32 v191, 0
    v_mov_b32 v192, 0
    v_mov_b32 v193, 0
    v_mov_b32 v194, 0
    v_mov_b32 v195, 0
    v_mov_b32 v208, 0
    v_mov_b32 v212, 0
    v_mov_b32 v209, 0
    v_mov_b32 v213, 0
    v_mov_b32 v210, 0
    v_mov_b32 v214, 0
    v_mov_b32 v211, 0
    v_mov_b32 v215, 0
    s_waitcnt vmcnt(6)
    ds_read_b128 v[180:183], v234 offset:0
    ds_read_b128 v[184:187], v235 offset:0
    s_waitcnt lgkmcnt(0)
    v_mfma_f32_16x16x32_bf16 v[148:151], v[100:103], v[180:183], v[164:167]
    v_mfma_f32_16x16x32_bf16 v[148:151], v[104:107], v[184:187], v[148:151]
    v_mfma_f32_16x16x32_bf16 v[152:155], v[108:111], v[180:183], v[168:171]
    v_mfma_f32_16x16x32_bf16 v[152:155], v[112:115], v[184:187], v[152:155]
    v_mfma_f32_16x16x32_bf16 v[156:159], v[116:119], v[180:183], v[172:175]
    v_mfma_f32_16x16x32_bf16 v[156:159], v[120:123], v[184:187], v[156:159]
    v_mfma_f32_16x16x32_bf16 v[160:163], v[124:127], v[180:183], v[176:179]
    v_mfma_f32_16x16x32_bf16 v[160:163], v[128:131], v[184:187], v[160:163]
    s_waitcnt vmcnt(4)
    ds_read_b128 v[180:183], v234 offset:2080
    ds_read_b128 v[184:187], v235 offset:2080
    s_cmp_lg_u64 s[84:85], 0
    s_cbranch_scc0 Lf_mid
    s_mul_i32 s66, s53, 800
    s_add_u32 s8, s8, s66
    s_addc_u32 s9, s9, 0
    s_mov_b32 s24, s8
    s_and_b32 s25, s9, 0xffff
    s_mov_b32 s26, 400
    s_mov_b32 s27, 0x20000
    s_movk_i32 s32, 400
    s_branch Ls_mid
Lf_loop:
    s_waitcnt vmcnt(4)
    v_cvt_pk_bf16_f32 v139, v146, v147
    ds_read_b128 v[180:183], v234 offset:2080
    ds_read_b128 v[184:187], v235 offset:2080
    v_mfma_f32_16x16x32_bf16 v[208:211], v[136:139], v[200:203], v[208:211]
Lf_mid:
    ds_read_u8 v230, v237 offset:64
    ds_read_u8 v232, v237 offset:72
    s_bitcmp1_b64 s[60:61], 1
    s_cbranch_scc1 Lf_wb0
Lf_wbd0:
    s_mov_b64 exec, 1
    ds_add_rtn_u32 v1, v2, v3
    s_mov_b64 exec, -1
    v_exp_f32 v132, v148
    v_exp_f32 v133, v149
    v_exp_f32 v134, v150
    v_exp_f32 v135, v151
    v_cvt_pk_bf16_f32 v208, v208, v209
    v_cvt_pk_bf16_f32 v209, v210, v211
    v_mfma_f32_4x4x4_16b_bf16 v[132:135], v[228:229], v[228:229], v[132:135]
    v_exp_f32 v136, v152
    v_mfma_f32_4x4x4_16b_bf16 v[212:215], v[208:209], v[188:189], v[212:215] cbsz:4 abid:0
    ds_read_b64_tr_b16 v[188:189], v236 offset:0
    v_exp_f32 v137, v153
    v_exp_f32 v138, v154
    v_mfma_f32_4x4x4_16b_bf16 v[212:215], v[208:209], v[190:191], v[212:215] cbsz:4 abid:4
    ds_read_b64_tr_b16 v[190:191], v236 offset:512
    v_exp_f32 v139, v155
    s_waitcnt lgkmcnt(2)
    v_mfma_f32_16x16x32_bf16 v[148:151], v[100:103], v[180:183], v[164:167]
    v_exp_f32 v140, v156
    v_mfma_f32_4x4x4_16b_bf16 v[136:139], v[228:229], v[228:229], v[136:139]
    v_rcp_f32 v132, v132
    v_mfma_f32_4x4x4_16b_bf16 v[212:215], v[208:209], v[192:193], v[212:215] cbsz:4 abid:8
    ds_read_b64_tr_b16 v[192:193], v236 offset:1056
    v_rcp_f32 v133, v133
    v_mfma_f32_16x16x32_bf16 v[148:151], v[104:107], v[184:187], v[148:151]
    v_exp_f32 v141, v157
    v_mfma_f32_4x4x4_16b_bf16 v[212:215], v[208:209], v[194:195], v[212:215] cbsz:4 abid:12
    ds_read_b64_tr_b16 v[194:195], v236 offset:1568
    v_exp_f32 v142, v158
    v_mfma_f32_16x16x32_bf16 v[152:155], v[108:111], v[180:183], v[168:171]
    v_rcp_f32 v134, v134
    v_exp_f32 v143, v159
    v_mfma_f32_16x16x32_bf16 v[152:155], v[112:115], v[184:187], v[152:155]
    v_rcp_f32 v135, v135
    v_cvt_pk_bf16_f32 v132, v132, v133
    v_mfma_f32_4x4x4_16b_bf16 v[140:143], v[228:229], v[228:229], v[140:143]
    v_exp_f32 v144, v160
    v_cvt_pk_bf16_f32 v133, v134, v135
    v_mfma_f32_16x16x32_bf16 v[156:159], v[116:119], v[180:183], v[172:175]
    v_rcp_f32 v136, v136
    s_bitcmp1_b64 s[56:57], 0
    s_cbranch_scc1 Lf_flush0
Lf_flushed0:
    v_exp_f32 v145, v161
    v_mfma_f32_16x16x32_bf16 v[156:159], v[120:123], v[184:187], v[156:159]
    v_rcp_f32 v137, v137
    s_waitcnt lgkmcnt(0)
    s_bitcmp1_b64 s[60:61], 4
    s_cbranch_scc1 Lf_adv0
Lf_advd0:
    s_add_u32 m0, s52, 0
    v_exp_f32 v146, v162
    buffer_load_dwordx4 v[230:231], s[20:23], 0 idxen offen nt lds
    s_add_u32 m0, s52, 1056
    v_cvt_pk_bf16_f32 v134, v136, v137
    buffer_load_dwordx4 v[232:233], s[20:23], 0 idxen offen nt lds
    v_readfirstlane_b32 s66, v1
    s_nop 0
    s_xor_b32 s66, s66, s33
    s_cmp_gt_i32 s66, 0
    s_setprio 0
    s_cbranch_scc0 Lf_lo0
    s_setprio 1
Lf_lo0:
    v_exp_f32 v147, v163
    v_mfma_f32_16x16x32_bf16 v[160:163], v[124:127], v[180:183], v[176:179]
    v_rcp_f32 v138, v138
    v_mfma_f32_4x4x4_16b_bf16 v[144:147], v[228:229], v[228:229], v[144:147]
    v_rcp_f32 v139, v139
    v_mfma_f32_16x16x32_bf16 v[160:163], v[128:131], v[184:187], v[160:163]
    v_rcp_f32 v140, v140
    v_cvt_pk_bf16_f32 v135, v138, v139
    v_rcp_f32 v141, v141
    v_rcp_f32 v142, v142
    v_mfma_f32_16x16x32_bf16 v[208:211], v[132:135], v[196:199], v[204:207]
    v_rcp_f32 v143, v143
    v_cvt_pk_bf16_f32 v136, v140, v141
    v_rcp_f32 v144, v144
    v_cvt_pk_bf16_f32 v137, v142, v143
    v_rcp_f32 v145, v145
    v_rcp_f32 v146, v146
    v_cvt_pk_bf16_f32 v138, v144, v145
    v_rcp_f32 v147, v147
    s_waitcnt vmcnt(4)
    v_cvt_pk_bf16_f32 v139, v146, v147
    ds_read_b128 v[180:183], v234 offset:4160
    ds_read_b128 v[184:187], v235 offset:4160
    v_mfma_f32_16x16x32_bf16 v[208:211], v[136:139], v[200:203], v[208:211]
    ds_read_u8 v230, v237 offset:80
    ds_read_u8 v232, v237 offset:88
    s_bitcmp1_b64 s[60:61], 2
    s_cbranch_scc1 Lf_wb1
Lf_wbd1:
    v_exp_f32 v132, v148
    v_exp_f32 v133, v149
    v_exp_f32 v134, v150
    v_exp_f32 v135, v151
    v_cvt_pk_bf16_f32 v208, v208, v209
    v_cvt_pk_bf16_f32 v209, v210, v211
    v_mfma_f32_4x4x4_16b_bf16 v[132:135], v[228:229], v[228:229], v[132:135]
    v_exp_f32 v136, v152
    v_mfma_f32_4x4x4_16b_bf16 v[212:215], v[208:209], v[188:189], v[212:215] cbsz:4 abid:0
    ds_read_b64_tr_b16 v[188:189], v236 offset:2080
    v_exp_f32 v137, v153
    v_exp_f32 v138, v154
    v_mfma_f32_4x4x4_16b_bf16 v[212:215], v[208:209], v[190:191], v[212:215] cbsz:4 abid:4
    ds_read_b64_tr_b16 v[190:191], v236 offset:2592
    v_exp_f32 v139, v155
    s_waitcnt lgkmcnt(2)
    v_mfma_f32_16x16x32_bf16 v[148:151], v[100:103], v[180:183], v[164:167]
    v_exp_f32 v140, v156
    v_mfma_f32_4x4x4_16b_bf16 v[136:139], v[228:229], v[228:229], v[136:139]
    v_rcp_f32 v132, v132
    v_mfma_f32_4x4x4_16b_bf16 v[212:215], v[208:209], v[192:193], v[212:215] cbsz:4 abid:8
    ds_read_b64_tr_b16 v[192:193], v236 offset:3136
    v_rcp_f32 v133, v133
    v_mfma_f32_16x16x32_bf16 v[148:151], v[104:107], v[184:187], v[148:151]
    v_exp_f32 v141, v157
    v_mfma_f32_4x4x4_16b_bf16 v[212:215], v[208:209], v[194:195], v[212:215] cbsz:4 abid:12
    ds_read_b64_tr_b16 v[194:195], v236 offset:3648
    v_exp_f32 v142, v158
    v_mfma_f32_16x16x32_bf16 v[152:155], v[108:111], v[180:183], v[168:171]
    v_rcp_f32 v134, v134
    v_exp_f32 v143, v159
    v_mfma_f32_16x16x32_bf16 v[152:155], v[112:115], v[184:187], v[152:155]
    v_rcp_f32 v135, v135
    v_cvt_pk_bf16_f32 v132, v132, v133
    v_mfma_f32_4x4x4_16b_bf16 v[140:143], v[228:229], v[228:229], v[140:143]
    v_exp_f32 v144, v160
    v_cvt_pk_bf16_f32 v133, v134, v135
    v_mfma_f32_16x16x32_bf16 v[156:159], v[116:119], v[180:183], v[172:175]
    v_rcp_f32 v136, v136
    s_bitcmp1_b64 s[56:57], 1
    s_cbranch_scc1 Lf_flush1
Lf_flushed1:
    v_exp_f32 v145, v161
    v_mfma_f32_16x16x32_bf16 v[156:159], v[120:123], v[184:187], v[156:159]
    v_rcp_f32 v137, v137
    s_waitcnt lgkmcnt(0)
    s_bitcmp1_b64 s[60:61], 5
    s_cbranch_scc1 Lf_adv1
Lf_advd1:
    s_add_u32 m0, s52, 2080
    v_exp_f32 v146, v162
    buffer_load_dwordx4 v[230:231], s[20:23], 0 idxen offen nt lds
    s_add_u32 m0, s52, 3136
    v_cvt_pk_bf16_f32 v134, v136, v137
    buffer_load_dwordx4 v[232:233], s[20:23], 0 idxen offen nt lds
    v_exp_f32 v147, v163
    v_mfma_f32_16x16x32_bf16 v[160:163], v[124:127], v[180:183], v[176:179]
    v_rcp_f32 v138, v138
    v_mfma_f32_4x4x4_16b_bf16 v[144:147], v[228:229], v[228:229], v[144:147]
    v_rcp_f32 v139, v139
    v_mfma_f32_16x16x32_bf16 v[160:163], v[128:131], v[184:187], v[160:163]
    v_rcp_f32 v140, v140
    v_cvt_pk_bf16_f32 v135, v138, v139
    v_rcp_f32 v141, v141
    v_rcp_f32 v142, v142
    v_mfma_f32_16x16x32_bf16 v[208:211], v[132:135], v[196:199], v[204:207]
    v_rcp_f32 v143, v143
    v_cvt_pk_bf16_f32 v136, v140, v141
    v_rcp_f32 v144, v144
    v_cvt_pk_bf16_f32 v137, v142, v143
    v_rcp_f32 v145, v145
    v_rcp_f32 v146, v146
    v_cvt_pk_bf16_f32 v138, v144, v145
    v_rcp_f32 v147, v147
    s_waitcnt vmcnt(4)
    v_cvt_pk_bf16_f32 v139, v146, v147
    ds_read_b128 v[180:183], v234 offset:6240
    ds_read_b128 v[184:187], v235 offset:6240
    v_mfma_f32_16x16x32_bf16 v[208:211], v[136:139], v[200:203], v[208:211]
    ds_read_u8 v230, v237 offset:96
    ds_read_u8 v232, v237 offset:104
    s_bitcmp1_b64 s[60:61], 3
    s_cbranch_scc1 Lf_wb2
Lf_wbd2:
    s_mov_b64 exec, 1
    ds_add_rtn_u32 v1, v2, v3
    s_mov_b64 exec, -1
    v_exp_f32 v132, v148
    v_exp_f32 v133, v149
    v_exp_f32 v134, v150
    v_exp_f32 v135, v151
    v_cvt_pk_bf16_f32 v208, v208, v209
    v_cvt_pk_bf16_f32 v209, v210, v211
    v_mfma_f32_4x4x4_16b_bf16 v[132:135], v[228:229], v[228:229], v[132:135]
    v_exp_f32 v136, v152
    v_mfma_f32_4x4x4_16b_bf16 v[212:215], v[208:209], v[188:189], v[212:215] cbsz:4 abid:0
    ds_read_b64_tr_b16 v[188:189], v236 offset:4160
    v_exp_f32 v137, v153
    v_exp_f32 v138, v154
    v_mfma_f32_4x4x4_16b_bf16 v[212:215], v[208:209], v[190:191], v[212:215] cbsz:4 abid:4
    ds_read_b64_tr_b16 v[190:191], v236 offset:4672
    v_exp_f32 v139, v155
    s_waitcnt lgkmcnt(2)
    v_mfma_f32_16x16x32_bf16 v[148:151], v[100:103], v[180:183], v[164:167]
    v_exp_f32 v140, v156
    v_mfma_f32_4x4x4_16b_bf16 v[136:139], v[228:229], v[228:229], v[136:139]
    v_rcp_f32 v132, v132
    v_mfma_f32_4x4x4_16b_bf16 v[212:215], v[208:209], v[192:193], v[212:215] cbsz:4 abid:8
    ds_read_b64_tr_b16 v[192:193], v236 offset:5216
    v_rcp_f32 v133, v133
    v_mfma_f32_16x16x32_bf16 v[148:151], v[104:107], v[184:187], v[148:151]
    v_exp_f32 v141, v157
    v_mfma_f32_4x4x4_16b_bf16 v[212:215], v[208:209], v[194:195], v[212:215] cbsz:4 abid:12
    ds_read_b64_tr_b16 v[194:195], v236 offset:5728
    v_exp_f32 v142, v158
    v_mfma_f32_16x16x32_bf16 v[152:155], v[108:111], v[180:183], v[168:171]
    v_rcp_f32 v134, v134
    v_exp_f32 v143, v159
    v_mfma_f32_16x16x32_bf16 v[152:155], v[112:115], v[184:187], v[152:155]
    v_rcp_f32 v135, v135
    v_cvt_pk_bf16_f32 v132, v132, v133
    v_mfma_f32_4x4x4_16b_bf16 v[140:143], v[228:229], v[228:229], v[140:143]
    v_exp_f32 v144, v160
    v_cvt_pk_bf16_f32 v133, v134, v135
    v_mfma_f32_16x16x32_bf16 v[156:159], v[116:119], v[180:183], v[172:175]
    v_rcp_f32 v136, v136
    s_bitcmp1_b64 s[56:57], 2
    s_cbranch_scc1 Lf_flush2
Lf_flushed2:
    v_exp_f32 v145, v161
    v_mfma_f32_16x16x32_bf16 v[156:159], v[120:123], v[184:187], v[156:159]
    v_rcp_f32 v137, v137
    s_waitcnt lgkmcnt(0)
    s_bitcmp1_b64 s[60:61], 6
    s_cbranch_scc1 Lf_adv2
Lf_advd2:
    s_add_u32 m0, s52, 4160
    v_exp_f32 v146, v162
    buffer_load_dwordx4 v[230:231], s[20:23], 0 idxen offen nt lds
    s_add_u32 m0, s52, 5216
    v_cvt_pk_bf16_f32 v134, v136, v137
    buffer_load_dwordx4 v[232:233], s[20:23], 0 idxen offen nt lds
    v_readfirstlane_b32 s66, v1
    s_nop 0
    s_xor_b32 s66, s66, s33
    s_cmp_gt_i32 s66, 0
    s_setprio 0
    s_cbranch_scc0 Lf_lo2
    s_setprio 1
Lf_lo2:
    v_exp_f32 v147, v163
    v_mfma_f32_16x16x32_bf16 v[160:163], v[124:127], v[180:183], v[176:179]
    v_rcp_f32 v138, v138
    v_mfma_f32_4x4x4_16b_bf16 v[144:147], v[228:229], v[228:229], v[144:147]
    v_rcp_f32 v139, v139
    v_mfma_f32_16x16x32_bf16 v[160:163], v[128:131], v[184:187], v[160:163]
    v_rcp_f32 v140, v140
    v_cvt_pk_bf16_f32 v135, v138, v139
    v_rcp_f32 v141, v141
    v_rcp_f32 v142, v142
    v_mfma_f32_16x16x32_bf16 v[208:211], v[132:135], v[196:199], v[204:207]
    v_rcp_f32 v143, v143
    v_cvt_pk_bf16_f32 v136, v140, v141
    v_rcp_f32 v144, v144
    v_cvt_pk_bf16_f32 v137, v142, v143
    v_rcp_f32 v145, v145
    v_rcp_f32 v146, v146
    v_cvt_pk_bf16_f32 v138, v144, v145
    v_rcp_f32 v147, v147
    s_waitcnt vmcnt(4)
    v_cvt_pk_bf16_f32 v139, v146, v147
    ds_read_b128 v[180:183], v234 offset:0
    ds_read_b128 v[184:187], v235 offset:0
    v_mfma_f32_16x16x32_bf16 v[208:211], v[136:139], v[200:203], v[208:211]
    ds_read_u8 v230, v237 offset:112
    ds_read_u8 v232, v237 offset:120
    s_bitcmp1_b64 s[60:61], 4
    s_cbranch_scc1 Lf_wb3
Lf_wbd3:
    v_exp_f32 v132, v148
    v_exp_f32 v133, v149
    v_exp_f32 v134, v150
    v_exp_f32 v135, v151
    v_cvt_pk_bf16_f32 v208, v208, v209
    v_cvt_pk_bf16_f32 v209, v210, v211
    v_mfma_f32_4x4x4_16b_bf16 v[132:135], v[228:229], v[228:229], v[132:135]
    v_exp_f32 v136, v152
    v_mfma_f32_4x4x4_16b_bf16 v[212:215], v[208:209], v[188:189], v[212:215] cbsz:4 abid:0
    ds_read_b64_tr_b16 v[188:189], v236 offset:6240
    v_exp_f32 v137, v153
    v_exp_f32 v138, v154
    v_mfma_f32_4x4x4_16b_bf16 v[212:215], v[208:209], v[190:191], v[212:215] cbsz:4 abid:4
    ds_read_b64_tr_b16 v[190:191], v236 offset:6752
    v_exp_f32 v139, v155
    s_waitcnt lgkmcnt(2)
    v_mfma_f32_16x16x32_bf16 v[148:151], v[100:103], v[180:183], v[164:167]
    v_exp_f32 v140, v156
    v_mfma_f32_4x4x4_16b_bf16 v[136:139], v[228:229], v[228:229], v[136:139]
    v_rcp_f32 v132, v132
    v_mfma_f32_4x4x4_16b_bf16 v[212:215], v[208:209], v[192:193], v[212:215] cbsz:4 abid:8
    ds_read_b64_tr_b16 v[192:193], v236 offset:7296
    v_rcp_f32 v133, v133
    v_mfma_f32_16x16x32_bf16 v[148:151], v[104:107], v[184:187], v[148:151]
    v_exp_f32 v141, v157
    v_mfma_f32_4x4x4_16b_bf16 v[212:215], v[208:209], v[194:195], v[212:215] cbsz:4 abid:12
    ds_read_b64_tr_b16 v[194:195], v236 offset:7808
    v_exp_f32 v142, v158
    v_mfma_f32_16x16x32_bf16 v[152:155], v[108:111], v[180:183], v[168:171]
    v_rcp_f32 v134, v134
    v_exp_f32 v143, v159
    v_mfma_f32_16x16x32_bf16 v[152:155], v[112:115], v[184:187], v[152:155]
    v_rcp_f32 v135, v135
    v_cvt_pk_bf16_f32 v132, v132, v133
    v_mfma_f32_4x4x4_16b_bf16 v[140:143], v[228:229], v[228:229], v[140:143]
    v_exp_f32 v144, v160
    v_cvt_pk_bf16_f32 v133, v134, v135
    v_mfma_f32_16x16x32_bf16 v[156:159], v[116:119], v[180:183], v[172:175]
    v_rcp_f32 v136, v136
    s_bitcmp1_b64 s[56:57], 3
    s_cbranch_scc1 Lf_flush3
Lf_flushed3:
    v_exp_f32 v145, v161
    v_mfma_f32_16x16x32_bf16 v[156:159], v[120:123], v[184:187], v[156:159]
    v_rcp_f32 v137, v137
    s_waitcnt lgkmcnt(0)
    s_bitcmp1_b64 s[60:61], 7
    s_cbranch_scc1 Lf_adv3
Lf_advd3:
    s_add_u32 m0, s52, 6240
    v_exp_f32 v146, v162
    buffer_load_dwordx4 v[230:231], s[20:23], 0 idxen offen nt lds
    s_add_u32 m0, s52, 7296
    v_cvt_pk_bf16_f32 v134, v136, v137
    buffer_load_dwordx4 v[232:233], s[20:23], 0 idxen offen nt lds
    v_exp_f32 v147, v163
    v_mfma_f32_16x16x32_bf16 v[160:163], v[124:127], v[180:183], v[176:179]
    v_rcp_f32 v138, v138
    v_mfma_f32_4x4x4_16b_bf16 v[144:147], v[228:229], v[228:229], v[144:147]
    v_rcp_f32 v139, v139
    v_mfma_f32_16x16x32_bf16 v[160:163], v[128:131], v[184:187], v[160:163]
    v_rcp_f32 v140, v140
    v_cvt_pk_bf16_f32 v135, v138, v139
    v_rcp_f32 v141, v141
    s_lshr_b64 s[56:57], s[56:57], 4
    s_lshl_b64 s[86:87], s[58:59], 60
    s_or_b64 s[56:57], s[56:57], s[86:87]
    s_lshr_b64 s[58:59], s[58:59], 4
    s_lshr_b64 s[60:61], s[60:61], 4
    s_lshl_b64 s[86:87], s[62:63], 60
    s_or_b64 s[60:61], s[60:61], s[86:87]
    s_lshr_b64 s[62:63], s[62:63], 4
    v_add_u32 v237, 64, v237
    v_rcp_f32 v142, v142
    v_mfma_f32_16x16x32_bf16 v[208:211], v[132:135], v[196:199], v[204:207]
    v_rcp_f32 v143, v143
    v_cvt_pk_bf16_f32 v136, v140, v141
    v_rcp_f32 v144, v144
    v_cvt_pk_bf16_f32 v137, v142, v143
    v_rcp_f32 v145, v145
    v_rcp_f32 v146, v146
    v_cvt_pk_bf16_f32 v138, v144, v145
    v_rcp_f32 v147, v147
    s_branch Lf_loop
Lf_flush0:
    v_cvt_pk_bf16_f32 v246, v212, v212
    v_mov_b32 v212, 0
    s_sub_u32 s65, s65, 1
    ds_write_b16 v240, v246
    s_cbranch_scc1 L_store
    v_add_u32 v240, 128, v240
    s_branch Lf_flushed0
Lf_wb0:
    v_mul_u32_u24 v216, v224, v241
    v_mul_u32_u24 v217, v224, v242
    v_mul_u32_u24 v218, v225, v241
    v_mul_u32_u24 v219, v225, v242
    v_mul_u32_u24 v220, v226, v241
    v_mul_u32_u24 v221, v226, v242
    v_mul_u32_u24 v222, v227, v241
    v_mul_u32_u24 v223, v227, v242
    v_add_u32 v238, 128, v238
    ds_read_b128 v[164:167], v239
    v_mfma_f32_16x16x16_bf16 v[132:135], v[216:217], v[68:69], v[4:7]
    ds_read_b128 v[168:171], v239 offset:64
    ds_read_b128 v[172:175], v239 offset:128
    v_mfma_f32_16x16x16_bf16 v[136:139], v[218:219], v[70:71], v[8:11]
    ds_read_b128 v[176:179], v239 offset:192
    ds_read_u16 v224, v238
    v_mfma_f32_16x16x16_bf16 v[140:143], v[220:221], v[72:73], v[12:15]
    ds_read_u16 v225, v238 offset:8
    ds_read_u16 v226, v238 offset:64
    v_mfma_f32_16x16x16_bf16 v[144:147], v[222:223], v[74:75], v[16:19]
    ds_read_u16 v227, v238 offset:72
    v_add_u32 v239, 256, v239
    v_mfma_f32_16x16x16_bf16 v[246:249], v[216:217], v[76:77], v[20:23]
    v_cvt_pk_bf16_f32 v100, v132, v133
    v_cvt_pk_bf16_f32 v101, v134, v135
    v_mfma_f32_16x16x16_bf16 v[250:253], v[218:219], v[78:79], v[24:27]
    v_cvt_pk_bf16_f32 v102, v136, v137
    v_cvt_pk_bf16_f32 v103, v138, v139
    v_mfma_f32_16x16x16_bf16 v[132:135], v[220:221], v[80:81], v[28:31]
    v_cvt_pk_bf16_f32 v104, v140, v141
    v_cvt_pk_bf16_f32 v105, v142, v143
    v_mfma_f32_16x16x16_bf16 v[136:139], v[222:223], v[82:83], v[32:35]
    v_cvt_pk_bf16_f32 v106, v144, v145
    v_cvt_pk_bf16_f32 v107, v146, v147
    v_mfma_f32_16x16x16_bf16 v[140:143], v[216:217], v[84:85], v[36:39]
    v_cvt_pk_bf16_f32 v108, v246, v247
    v_cvt_pk_bf16_f32 v109, v248, v249
    v_mfma_f32_16x16x16_bf16 v[144:147], v[218:219], v[86:87], v[40:43]
    v_cvt_pk_bf16_f32 v110, v250, v251
    v_cvt_pk_bf16_f32 v111, v252, v253
    v_mfma_f32_16x16x16_bf16 v[246:249], v[220:221], v[88:89], v[44:47]
    v_cvt_pk_bf16_f32 v112, v132, v133
    v_cvt_pk_bf16_f32 v113, v134, v135
    v_mfma_f32_16x16x16_bf16 v[250:253], v[222:223], v[90:91], v[48:51]
    v_cvt_pk_bf16_f32 v114, v136, v137
    v_cvt_pk_bf16_f32 v115, v138, v139
    v_mfma_f32_16x16x16_bf16 v[132:135], v[216:217], v[92:93], v[52:55]
    v_cvt_pk_bf16_f32 v116, v140, v141
    v_cvt_pk_bf16_f32 v117, v142, v143
    v_mfma_f32_16x16x16_bf16 v[136:139], v[218:219], v[94:95], v[56:59]
    v_cvt_pk_bf16_f32 v118, v144, v145
    v_cvt_pk_bf16_f32 v119, v146, v147
    v_mfma_f32_16x16x16_bf16 v[140:143], v[220:221], v[96:97], v[60:63]
    v_cvt_pk_bf16_f32 v120, v246, v247
    v_cvt_pk_bf16_f32 v121, v248, v249
    v_mfma_f32_16x16x16_bf16 v[144:147], v[222:223], v[98:99], v[64:67]
    v_cvt_pk_bf16_f32 v122, v250, v251
    v_cvt_pk_bf16_f32 v123, v252, v253
    v_cvt_pk_bf16_f32 v124, v132, v133
    v_cvt_pk_bf16_f32 v125, v134, v135
    v_cvt_pk_bf16_f32 v126, v136, v137
    v_cvt_pk_bf16_f32 v127, v138, v139
    v_cvt_pk_bf16_f32 v128, v140, v141
    v_cvt_pk_bf16_f32 v129, v142, v143
    v_cvt_pk_bf16_f32 v130, v144, v145
    v_cvt_pk_bf16_f32 v131, v146, v147
    s_waitcnt lgkmcnt(0)
    s_branch Lf_wbd0
Lf_adv0:
    s_add_u32 s20, s20, s31
    s_addc_u32 s21, s21, 0
    s_xor_b32 s31, s31, 0x63ff800
    s_branch Lf_advd0
Lf_flush1:
    v_cvt_pk_bf16_f32 v246, v212, v212
    v_mov_b32 v212, 0
    s_sub_u32 s65, s65, 1
    ds_write_b16 v240, v246
    s_cbranch_scc1 L_store
    v_add_u32 v240, 128, v240
    s_branch Lf_flushed1
Lf_wb1:
    v_mul_u32_u24 v216, v224, v241
    v_mul_u32_u24 v217, v224, v242
    v_mul_u32_u24 v218, v225, v241
    v_mul_u32_u24 v219, v225, v242
    v_mul_u32_u24 v220, v226, v241
    v_mul_u32_u24 v221, v226, v242
    v_mul_u32_u24 v222, v227, v241
    v_mul_u32_u24 v223, v227, v242
    v_add_u32 v238, 128, v238
    ds_read_b128 v[164:167], v239
    v_mfma_f32_16x16x16_bf16 v[132:135], v[216:217], v[68:69], v[4:7]
    ds_read_b128 v[168:171], v239 offset:64
    ds_read_b128 v[172:175], v239 offset:128
    v_mfma_f32_16x16x16_bf16 v[136:139], v[218:219], v[70:71], v[8:11]
    ds_read_b128 v[176:179], v239 offset:192
    ds_read_u16 v224, v238
    v_mfma_f32_16x16x16_bf16 v[140:143], v[220:221], v[72:73], v[12:15]
    ds_read_u16 v225, v238 offset:8
    ds_read_u16 v226, v238 offset:64
    v_mfma_f32_16x16x16_bf16 v[144:147], v[222:223], v[74:75], v[16:19]
    ds_read_u16 v227, v238 offset:72
    v_add_u32 v239, 256, v239
    v_mfma_f32_16x16x16_bf16 v[246:249], v[216:217], v[76:77], v[20:23]
    v_cvt_pk_bf16_f32 v100, v132, v133
    v_cvt_pk_bf16_f32 v101, v134, v135
    v_mfma_f32_16x16x16_bf16 v[250:253], v[218:219], v[78:79], v[24:27]
    v_cvt_pk_bf16_f32 v102, v136, v137
    v_cvt_pk_bf16_f32 v103, v138, v139
    v_mfma_f32_16x16x16_bf16 v[132:135], v[220:221], v[80:81], v[28:31]
    v_cvt_pk_bf16_f32 v104, v140, v141
    v_cvt_pk_bf16_f32 v105, v142, v143
    v_mfma_f32_16x16x16_bf16 v[136:139], v[222:223], v[82:83], v[32:35]
    v_cvt_pk_bf16_f32 v106, v144, v145
    v_cvt_pk_bf16_f32 v107, v146, v147
    v_mfma_f32_16x16x16_bf16 v[140:143], v[216:217], v[84:85], v[36:39]
    v_cvt_pk_bf16_f32 v108, v246, v247
    v_cvt_pk_bf16_f32 v109, v248, v249
    v_mfma_f32_16x16x16_bf16 v[144:147], v[218:219], v[86:87], v[40:43]
    v_cvt_pk_bf16_f32 v110, v250, v251
    v_cvt_pk_bf16_f32 v111, v252, v253
    v_mfma_f32_16x16x16_bf16 v[246:249], v[220:221], v[88:89], v[44:47]
    v_cvt_pk_bf16_f32 v112, v132, v133
    v_cvt_pk_bf16_f32 v113, v134, v135
    v_mfma_f32_16x16x16_bf16 v[250:253], v[222:223], v[90:91], v[48:51]
    v_cvt_pk_bf16_f32 v114, v136, v137
    v_cvt_pk_bf16_f32 v115, v138, v139
    v_mfma_f32_16x16x16_bf16 v[132:135], v[216:217], v[92:93], v[52:55]
    v_cvt_pk_bf16_f32 v116, v140, v141
    v_cvt_pk_bf16_f32 v117, v142, v143
    v_mfma_f32_16x16x16_bf16 v[136:139], v[218:219], v[94:95], v[56:59]
    v_cvt_pk_bf16_f32 v118, v144, v145
    v_cvt_pk_bf16_f32 v119, v146, v147
    v_mfma_f32_16x16x16_bf16 v[140:143], v[220:221], v[96:97], v[60:63]
    v_cvt_pk_bf16_f32 v120, v246, v247
    v_cvt_pk_bf16_f32 v121, v248, v249
    v_mfma_f32_16x16x16_bf16 v[144:147], v[222:223], v[98:99], v[64:67]
    v_cvt_pk_bf16_f32 v122, v250, v251
    v_cvt_pk_bf16_f32 v123, v252, v253
    v_cvt_pk_bf16_f32 v124, v132, v133
    v_cvt_pk_bf16_f32 v125, v134, v135
    v_cvt_pk_bf16_f32 v126, v136, v137
    v_cvt_pk_bf16_f32 v127, v138, v139
    v_cvt_pk_bf16_f32 v128, v140, v141
    v_cvt_pk_bf16_f32 v129, v142, v143
    v_cvt_pk_bf16_f32 v130, v144, v145
    v_cvt_pk_bf16_f32 v131, v146, v147
    s_waitcnt lgkmcnt(0)
    s_branch Lf_wbd1
Lf_adv1:
    s_add_u32 s20, s20, s31
    s_addc_u32 s21, s21, 0
    s_xor_b32 s31, s31, 0x63ff800
    s_branch Lf_advd1
Lf_flush2:
    v_cvt_pk_bf16_f32 v246, v212, v212
    v_mov_b32 v212, 0
    s_sub_u32 s65, s65, 1
    ds_write_b16 v240, v246
    s_cbranch_scc1 L_store
    v_add_u32 v240, 128, v240
    s_branch Lf_flushed2
Lf_wb2:
    v_mul_u32_u24 v216, v224, v241
    v_mul_u32_u24 v217, v224, v242
    v_mul_u32_u24 v218, v225, v241
    v_mul_u32_u24 v219, v225, v242
    v_mul_u32_u24 v220, v226, v241
    v_mul_u32_u24 v221, v226, v242
    v_mul_u32_u24 v222, v227, v241
    v_mul_u32_u24 v223, v227, v242
    v_add_u32 v238, 128, v238
    ds_read_b128 v[164:167], v239
    v_mfma_f32_16x16x16_bf16 v[132:135], v[216:217], v[68:69], v[4:7]
    ds_read_b128 v[168:171], v239 offset:64
    ds_read_b128 v[172:175], v239 offset:128
    v_mfma_f32_16x16x16_bf16 v[136:139], v[218:219], v[70:71], v[8:11]
    ds_read_b128 v[176:179], v239 offset:192
    ds_read_u16 v224, v238
    v_mfma_f32_16x16x16_bf16 v[140:143], v[220:221], v[72:73], v[12:15]
    ds_read_u16 v225, v238 offset:8
    ds_read_u16 v226, v238 offset:64
    v_mfma_f32_16x16x16_bf16 v[144:147], v[222:223], v[74:75], v[16:19]
    ds_read_u16 v227, v238 offset:72
    v_add_u32 v239, 256, v239
    v_mfma_f32_16x16x16_bf16 v[246:249], v[216:217], v[76:77], v[20:23]
    v_cvt_pk_bf16_f32 v100, v132, v133
    v_cvt_pk_bf16_f32 v101, v134, v135
    v_mfma_f32_16x16x16_bf16 v[250:253], v[218:219], v[78:79], v[24:27]
    v_cvt_pk_bf16_f32 v102, v136, v137
    v_cvt_pk_bf16_f32 v103, v138, v139
    v_mfma_f32_16x16x16_bf16 v[132:135], v[220:221], v[80:81], v[28:31]
    v_cvt_pk_bf16_f32 v104, v140, v141
    v_cvt_pk_bf16_f32 v105, v142, v143
    v_mfma_f32_16x16x16_bf16 v[136:139], v[222:223], v[82:83], v[32:35]
    v_cvt_pk_bf16_f32 v106, v144, v145
    v_cvt_pk_bf16_f32 v107, v146, v147
    v_mfma_f32_16x16x16_bf16 v[140:143], v[216:217], v[84:85], v[36:39]
    v_cvt_pk_bf16_f32 v108, v246, v247
    v_cvt_pk_bf16_f32 v109, v248, v249
    v_mfma_f32_16x16x16_bf16 v[144:147], v[218:219], v[86:87], v[40:43]
    v_cvt_pk_bf16_f32 v110, v250, v251
    v_cvt_pk_bf16_f32 v111, v252, v253
    v_mfma_f32_16x16x16_bf16 v[246:249], v[220:221], v[88:89], v[44:47]
    v_cvt_pk_bf16_f32 v112, v132, v133
    v_cvt_pk_bf16_f32 v113, v134, v135
    v_mfma_f32_16x16x16_bf16 v[250:253], v[222:223], v[90:91], v[48:51]
    v_cvt_pk_bf16_f32 v114, v136, v137
    v_cvt_pk_bf16_f32 v115, v138, v139
    v_mfma_f32_16x16x16_bf16 v[132:135], v[216:217], v[92:93], v[52:55]
    v_cvt_pk_bf16_f32 v116, v140, v141
    v_cvt_pk_bf16_f32 v117, v142, v143
    v_mfma_f32_16x16x16_bf16 v[136:139], v[218:219], v[94:95], v[56:59]
    v_cvt_pk_bf16_f32 v118, v144, v145
    v_cvt_pk_bf16_f32 v119, v146, v147
    v_mfma_f32_16x16x16_bf16 v[140:143], v[220:221], v[96:97], v[60:63]
    v_cvt_pk_bf16_f32 v120, v246, v247
    v_cvt_pk_bf16_f32 v121, v248, v249
    v_mfma_f32_16x16x16_bf16 v[144:147], v[222:223], v[98:99], v[64:67]
    v_cvt_pk_bf16_f32 v122, v250, v251
    v_cvt_pk_bf16_f32 v123, v252, v253
    v_cvt_pk_bf16_f32 v124, v132, v133
    v_cvt_pk_bf16_f32 v125, v134, v135
    v_cvt_pk_bf16_f32 v126, v136, v137
    v_cvt_pk_bf16_f32 v127, v138, v139
    v_cvt_pk_bf16_f32 v128, v140, v141
    v_cvt_pk_bf16_f32 v129, v142, v143
    v_cvt_pk_bf16_f32 v130, v144, v145
    v_cvt_pk_bf16_f32 v131, v146, v147
    s_waitcnt lgkmcnt(0)
    s_branch Lf_wbd2
Lf_adv2:
    s_add_u32 s20, s20, s31
    s_addc_u32 s21, s21, 0
    s_xor_b32 s31, s31, 0x63ff800
    s_branch Lf_advd2
Lf_flush3:
    v_cvt_pk_bf16_f32 v246, v212, v212
    v_mov_b32 v212, 0
    s_sub_u32 s65, s65, 1
    ds_write_b16 v240, v246
    s_cbranch_scc1 L_store
    v_add_u32 v240, 128, v240
    s_branch Lf_flushed3
Lf_wb3:
    v_mul_u32_u24 v216, v224, v241
    v_mul_u32_u24 v217, v224, v242
    v_mul_u32_u24 v218, v225, v241
    v_mul_u32_u24 v219, v225, v242
    v_mul_u32_u24 v220, v226, v241
    v_mul_u32_u24 v221, v226, v242
    v_mul_u32_u24 v222, v227, v241
    v_mul_u32_u24 v223, v227, v242
    v_add_u32 v238, 128, v238
    ds_read_b128 v[164:167], v239
    v_mfma_f32_16x16x16_bf16 v[132:135], v[216:217], v[68:69], v[4:7]
    ds_read_b128 v[168:171], v239 offset:64
    ds_read_b128 v[172:175], v239 offset:128
    v_mfma_f32_16x16x16_bf16 v[136:139], v[218:219], v[70:71], v[8:11]
    ds_read_b128 v[176:179], v239 offset:192
    ds_read_u16 v224, v238
    v_mfma_f32_16x16x16_bf16 v[140:143], v[220:221], v[72:73], v[12:15]
    ds_read_u16 v225, v238 offset:8
    ds_read_u16 v226, v238 offset:64
    v_mfma_f32_16x16x16_bf16 v[144:147], v[222:223], v[74:75], v[16:19]
    ds_read_u16 v227, v238 offset:72
    v_add_u32 v239, 256, v239
    v_mfma_f32_16x16x16_bf16 v[246:249], v[216:217], v[76:77], v[20:23]
    v_cvt_pk_bf16_f32 v100, v132, v133
    v_cvt_pk_bf16_f32 v101, v134, v135
    v_mfma_f32_16x16x16_bf16 v[250:253], v[218:219], v[78:79], v[24:27]
    v_cvt_pk_bf16_f32 v102, v136, v137
    v_cvt_pk_bf16_f32 v103, v138, v139
    v_mfma_f32_16x16x16_bf16 v[132:135], v[220:221], v[80:81], v[28:31]
    v_cvt_pk_bf16_f32 v104, v140, v141
    v_cvt_pk_bf16_f32 v105, v142, v143
    v_mfma_f32_16x16x16_bf16 v[136:139], v[222:223], v[82:83], v[32:35]
    v_cvt_pk_bf16_f32 v106, v144, v145
    v_cvt_pk_bf16_f32 v107, v146, v147
    v_mfma_f32_16x16x16_bf16 v[140:143], v[216:217], v[84:85], v[36:39]
    v_cvt_pk_bf16_f32 v108, v246, v247
    v_cvt_pk_bf16_f32 v109, v248, v249
    v_mfma_f32_16x16x16_bf16 v[144:147], v[218:219], v[86:87], v[40:43]
    v_cvt_pk_bf16_f32 v110, v250, v251
    v_cvt_pk_bf16_f32 v111, v252, v253
    v_mfma_f32_16x16x16_bf16 v[246:249], v[220:221], v[88:89], v[44:47]
    v_cvt_pk_bf16_f32 v112, v132, v133
    v_cvt_pk_bf16_f32 v113, v134, v135
    v_mfma_f32_16x16x16_bf16 v[250:253], v[222:223], v[90:91], v[48:51]
    v_cvt_pk_bf16_f32 v114, v136, v137
    v_cvt_pk_bf16_f32 v115, v138, v139
    v_mfma_f32_16x16x16_bf16 v[132:135], v[216:217], v[92:93], v[52:55]
    v_cvt_pk_bf16_f32 v116, v140, v141
    v_cvt_pk_bf16_f32 v117, v142, v143
    v_mfma_f32_16x16x16_bf16 v[136:139], v[218:219], v[94:95], v[56:59]
    v_cvt_pk_bf16_f32 v118, v144, v145
    v_cvt_pk_bf16_f32 v119, v146, v147
    v_mfma_f32_16x16x16_bf16 v[140:143], v[220:221], v[96:97], v[60:63]
    v_cvt_pk_bf16_f32 v120, v246, v247
    v_cvt_pk_bf16_f32 v121, v248, v249
    v_mfma_f32_16x16x16_bf16 v[144:147], v[222:223], v[98:99], v[64:67]
    v_cvt_pk_bf16_f32 v122, v250, v251
    v_cvt_pk_bf16_f32 v123, v252, v253
    v_cvt_pk_bf16_f32 v124, v132, v133
    v_cvt_pk_bf16_f32 v125, v134, v135
    v_cvt_pk_bf16_f32 v126, v136, v137
    v_cvt_pk_bf16_f32 v127, v138, v139
    v_cvt_pk_bf16_f32 v128, v140, v141
    v_cvt_pk_bf16_f32 v129, v142, v143
    v_cvt_pk_bf16_f32 v130, v144, v145
    v_cvt_pk_bf16_f32 v131, v146, v147
    s_waitcnt lgkmcnt(0)
    s_branch Lf_wbd3
Lf_adv3:
    s_add_u32 s20, s20, s31
    s_addc_u32 s21, s21, 0
    s_xor_b32 s31, s31, 0x63ff800
    s_branch Lf_advd3
L_store:
    s_add_u32 s66, s52, 8320
    v_lshl_add_u32 v1, v0, 4, s66
    s_waitcnt lgkmcnt(0)
    ds_read_b128 v[148:151], v1
    s_waitcnt lgkmcnt(0)
    global_store_dwordx4 v243, v[148:151], s[18:19]
L_end:
    s_endpgm
Ls_loop:
    s_waitcnt vmcnt(4)
    v_cvt_pk_bf16_f32 v139, v146, v147
    ds_read_b128 v[180:183], v234 offset:2080
    ds_read_b128 v[184:187], v235 offset:2080
    v_mfma_f32_16x16x32_bf16 v[208:211], v[136:139], v[200:203], v[208:211]
Ls_mid:
    ds_read_b32 v246, v244 offset:0
    s_waitcnt lgkmcnt(0)
    v_bfe_u32 v247, v246, 0, 8
    v_lshlrev_b32 v247, 1, v247
    v_bfe_u32 v248, v246, 8, 8
    v_lshlrev_b32 v248, 1, v248
    v_bfe_u32 v249, v246, 16, 8
    v_lshlrev_b32 v249, 1, v249
    v_bfe_u32 v250, v246, 24, 8
    v_lshlrev_b32 v250, 1, v250
    buffer_load_ushort v247, v247, s[24:27], 0 offen
    buffer_load_ushort v248, v248, s[24:27], 0 offen
    buffer_load_ushort v249, v249, s[24:27], 0 offen
    buffer_load_ushort v250, v250, s[24:27], 0 offen
    s_waitcnt vmcnt(0)
    v_lshlrev_b32 v247, 16, v247
    v_mul_f32 v208, v208, v247
    v_lshlrev_b32 v248, 16, v248
    v_mul_f32 v209, v209, v248
    v_lshlrev_b32 v249, 16, v249
    v_mul_f32 v210, v210, v249
    v_lshlrev_b32 v250, 16, v250
    v_mul_f32 v211, v211, v250
    ds_read_u8 v230, v237 offset:64
    ds_read_u8 v232, v237 offset:72
    s_bitcmp1_b64 s[60:61], 1
    s_cbranch_scc1 Ls_wb0
Ls_wbd0:
    s_mov_b64 exec, 1
    ds_add_rtn_u32 v1, v2, v3
    s_mov_b64 exec, -1
    v_exp_f32 v132, v148
    v_exp_f32 v133, v149
    v_exp_f32 v134, v150
    v_exp_f32 v135, v151
    v_cvt_pk_bf16_f32 v208, v208, v209
    v_cvt_pk_bf16_f32 v209, v210, v211
    v_mfma_f32_4x4x4_16b_bf16 v[132:135], v[228:229], v[228:229], v[132:135]
    v_exp_f32 v136, v152
    v_mfma_f32_4x4x4_16b_bf16 v[212:215], v[208:209], v[188:189], v[212:215] cbsz:4 abid:0
    ds_read_b64_tr_b16 v[188:189], v236 offset:0
    v_exp_f32 v137, v153
    v_exp_f32 v138, v154
    v_mfma_f32_4x4x4_16b_bf16 v[212:215], v[208:209], v[190:191], v[212:215] cbsz:4 abid:4
    ds_read_b64_tr_b16 v[190:191], v236 offset:512
    v_exp_f32 v139, v155
    s_waitcnt lgkmcnt(2)
    v_mfma_f32_16x16x32_bf16 v[148:151], v[100:103], v[180:183], v[164:167]
    v_exp_f32 v140, v156
    v_mfma_f32_4x4x4_16b_bf16 v[136:139], v[228:229], v[228:229], v[136:139]
    v_rcp_f32 v132, v132
    v_mfma_f32_4x4x4_16b_bf16 v[212:215], v[208:209], v[192:193], v[212:215] cbsz:4 abid:8
    ds_read_b64_tr_b16 v[192:193], v236 offset:1056
    v_rcp_f32 v133, v133
    v_mfma_f32_16x16x32_bf16 v[148:151], v[104:107], v[184:187], v[148:151]
    v_exp_f32 v141, v157
    v_mfma_f32_4x4x4_16b_bf16 v[212:215], v[208:209], v[194:195], v[212:215] cbsz:4 abid:12
    ds_read_b64_tr_b16 v[194:195], v236 offset:1568
    v_exp_f32 v142, v158
    v_mfma_f32_16x16x32_bf16 v[152:155], v[108:111], v[180:183], v[168:171]
    v_rcp_f32 v134, v134
    v_exp_f32 v143, v159
    v_mfma_f32_16x16x32_bf16 v[152:155], v[112:115], v[184:187], v[152:155]
    v_rcp_f32 v135, v135
    v_cvt_pk_bf16_f32 v132, v132, v133
    v_mfma_f32_4x4x4_16b_bf16 v[140:143], v[228:229], v[228:229], v[140:143]
    v_exp_f32 v144, v160
    v_cvt_pk_bf16_f32 v133, v134, v135
    v_mfma_f32_16x16x32_bf16 v[156:159], v[116:119], v[180:183], v[172:175]
    v_rcp_f32 v136, v136
    s_bitcmp1_b64 s[56:57], 0
    s_cbranch_scc1 Ls_flush0
Ls_flushed0:
    v_exp_f32 v145, v161
    v_mfma_f32_16x16x32_bf16 v[156:159], v[120:123], v[184:187], v[156:159]
    v_rcp_f32 v137, v137
    s_waitcnt lgkmcnt(0)
    s_bitcmp1_b64 s[60:61], 4
    s_cbranch_scc1 Ls_adv0
Ls_advd0:
    s_add_u32 m0, s52, 0
    v_exp_f32 v146, v162
    buffer_load_dwordx4 v[230:231], s[20:23], 0 idxen offen nt lds
    s_add_u32 m0, s52, 1056
    v_cvt_pk_bf16_f32 v134, v136, v137
    buffer_load_dwordx4 v[232:233], s[20:23], 0 idxen offen nt lds
    v_readfirstlane_b32 s66, v1
    s_nop 0
    s_xor_b32 s66, s66, s33
    s_cmp_gt_i32 s66, 0
    s_setprio 0
    s_cbranch_scc0 Ls_lo0
    s_setprio 1
Ls_lo0:
    v_exp_f32 v147, v163
    v_mfma_f32_16x16x32_bf16 v[160:163], v[124:127], v[180:183], v[176:179]
    v_rcp_f32 v138, v138
    v_mfma_f32_4x4x4_16b_bf16 v[144:147], v[228:229], v[228:229], v[144:147]
    v_rcp_f32 v139, v139
    v_mfma_f32_16x16x32_bf16 v[160:163], v[128:131], v[184:187], v[160:163]
    v_rcp_f32 v140, v140
    v_cvt_pk_bf16_f32 v135, v138, v139
    v_rcp_f32 v141, v141
    v_rcp_f32 v142, v142
    v_mfma_f32_16x16x32_bf16 v[208:211], v[132:135], v[196:199], v[204:207]
    v_rcp_f32 v143, v143
    v_cvt_pk_bf16_f32 v136, v140, v141
    v_rcp_f32 v144, v144
    v_cvt_pk_bf16_f32 v137, v142, v143
    v_rcp_f32 v145, v145
    v_rcp_f32 v146, v146
    v_cvt_pk_bf16_f32 v138, v144, v145
    v_rcp_f32 v147, v147
    s_waitcnt vmcnt(4)
    v_cvt_pk_bf16_f32 v139, v146, v147
    ds_read_b128 v[180:183], v234 offset:4160
    ds_read_b128 v[184:187], v235 offset:4160
    v_mfma_f32_16x16x32_bf16 v[208:211], v[136:139], v[200:203], v[208:211]
    ds_read_b32 v246, v244 offset:16
    s_waitcnt lgkmcnt(0)
    v_bfe_u32 v247, v246, 0, 8
    v_lshlrev_b32 v247, 1, v247
    v_bfe_u32 v248, v246, 8, 8
    v_lshlrev_b32 v248, 1, v248
    v_bfe_u32 v249, v246, 16, 8
    v_lshlrev_b32 v249, 1, v249
    v_bfe_u32 v250, v246, 24, 8
    v_lshlrev_b32 v250, 1, v250
    buffer_load_ushort v247, v247, s[24:27], 0 offen
    buffer_load_ushort v248, v248, s[24:27], 0 offen
    buffer_load_ushort v249, v249, s[24:27], 0 offen
    buffer_load_ushort v250, v250, s[24:27], 0 offen
    s_waitcnt vmcnt(0)
    v_lshlrev_b32 v247, 16, v247
    v_mul_f32 v208, v208, v247
    v_lshlrev_b32 v248, 16, v248
    v_mul_f32 v209, v209, v248
    v_lshlrev_b32 v249, 16, v249
    v_mul_f32 v210, v210, v249
    v_lshlrev_b32 v250, 16, v250
    v_mul_f32 v211, v211, v250
    ds_read_u8 v230, v237 offset:80
    ds_read_u8 v232, v237 offset:88
    s_bitcmp1_b64 s[60:61], 2
    s_cbranch_scc1 Ls_wb1
Ls_wbd1:
    v_exp_f32 v132, v148
    v_exp_f32 v133, v149
    v_exp_f32 v134, v150
    v_exp_f32 v135, v151
    v_cvt_pk_bf16_f32 v208, v208, v209
    v_cvt_pk_bf16_f32 v209, v210, v211
    v_mfma_f32_4x4x4_16b_bf16 v[132:135], v[228:229], v[228:229], v[132:135]
    v_exp_f32 v136, v152
    v_mfma_f32_4x4x4_16b_bf16 v[212:215], v[208:209], v[188:189], v[212:215] cbsz:4 abid:0
    ds_read_b64_tr_b16 v[188:189], v236 offset:2080
    v_exp_f32 v137, v153
    v_exp_f32 v138, v154
    v_mfma_f32_4x4x4_16b_bf16 v[212:215], v[208:209], v[190:191], v[212:215] cbsz:4 abid:4
    ds_read_b64_tr_b16 v[190:191], v236 offset:2592
    v_exp_f32 v139, v155
    s_waitcnt lgkmcnt(2)
    v_mfma_f32_16x16x32_bf16 v[148:151], v[100:103], v[180:183], v[164:167]
    v_exp_f32 v140, v156
    v_mfma_f32_4x4x4_16b_bf16 v[136:139], v[228:229], v[228:229], v[136:139]
    v_rcp_f32 v132, v132
    v_mfma_f32_4x4x4_16b_bf16 v[212:215], v[208:209], v[192:193], v[212:215] cbsz:4 abid:8
    ds_read_b64_tr_b16 v[192:193], v236 offset:3136
    v_rcp_f32 v133, v133
    v_mfma_f32_16x16x32_bf16 v[148:151], v[104:107], v[184:187], v[148:151]
    v_exp_f32 v141, v157
    v_mfma_f32_4x4x4_16b_bf16 v[212:215], v[208:209], v[194:195], v[212:215] cbsz:4 abid:12
    ds_read_b64_tr_b16 v[194:195], v236 offset:3648
    v_exp_f32 v142, v158
    v_mfma_f32_16x16x32_bf16 v[152:155], v[108:111], v[180:183], v[168:171]
    v_rcp_f32 v134, v134
    v_exp_f32 v143, v159
    v_mfma_f32_16x16x32_bf16 v[152:155], v[112:115], v[184:187], v[152:155]
    v_rcp_f32 v135, v135
    v_cvt_pk_bf16_f32 v132, v132, v133
    v_mfma_f32_4x4x4_16b_bf16 v[140:143], v[228:229], v[228:229], v[140:143]
    v_exp_f32 v144, v160
    v_cvt_pk_bf16_f32 v133, v134, v135
    v_mfma_f32_16x16x32_bf16 v[156:159], v[116:119], v[180:183], v[172:175]
    v_rcp_f32 v136, v136
    s_bitcmp1_b64 s[56:57], 1
    s_cbranch_scc1 Ls_flush1
Ls_flushed1:
    v_exp_f32 v145, v161
    v_mfma_f32_16x16x32_bf16 v[156:159], v[120:123], v[184:187], v[156:159]
    v_rcp_f32 v137, v137
    s_waitcnt lgkmcnt(0)
    s_bitcmp1_b64 s[60:61], 5
    s_cbranch_scc1 Ls_adv1
Ls_advd1:
    s_add_u32 m0, s52, 2080
    v_exp_f32 v146, v162
    buffer_load_dwordx4 v[230:231], s[20:23], 0 idxen offen nt lds
    s_add_u32 m0, s52, 3136
    v_cvt_pk_bf16_f32 v134, v136, v137
    buffer_load_dwordx4 v[232:233], s[20:23], 0 idxen offen nt lds
    v_exp_f32 v147, v163
    v_mfma_f32_16x16x32_bf16 v[160:163], v[124:127], v[180:183], v[176:179]
    v_rcp_f32 v138, v138
    v_mfma_f32_4x4x4_16b_bf16 v[144:147], v[228:229], v[228:229], v[144:147]
    v_rcp_f32 v139, v139
    v_mfma_f32_16x16x32_bf16 v[160:163], v[128:131], v[184:187], v[160:163]
    v_rcp_f32 v140, v140
    v_cvt_pk_bf16_f32 v135, v138, v139
    v_rcp_f32 v141, v141
    v_rcp_f32 v142, v142
    v_mfma_f32_16x16x32_bf16 v[208:211], v[132:135], v[196:199], v[204:207]
    v_rcp_f32 v143, v143
    v_cvt_pk_bf16_f32 v136, v140, v141
    v_rcp_f32 v144, v144
    v_cvt_pk_bf16_f32 v137, v142, v143
    v_rcp_f32 v145, v145
    v_rcp_f32 v146, v146
    v_cvt_pk_bf16_f32 v138, v144, v145
    v_rcp_f32 v147, v147
    s_waitcnt vmcnt(4)
    v_cvt_pk_bf16_f32 v139, v146, v147
    ds_read_b128 v[180:183], v234 offset:6240
    ds_read_b128 v[184:187], v235 offset:6240
    v_mfma_f32_16x16x32_bf16 v[208:211], v[136:139], v[200:203], v[208:211]
    ds_read_b32 v246, v244 offset:32
    s_waitcnt lgkmcnt(0)
    v_bfe_u32 v247, v246, 0, 8
    v_lshlrev_b32 v247, 1, v247
    v_bfe_u32 v248, v246, 8, 8
    v_lshlrev_b32 v248, 1, v248
    v_bfe_u32 v249, v246, 16, 8
    v_lshlrev_b32 v249, 1, v249
    v_bfe_u32 v250, v246, 24, 8
    v_lshlrev_b32 v250, 1, v250
    buffer_load_ushort v247, v247, s[24:27], 0 offen
    buffer_load_ushort v248, v248, s[24:27], 0 offen
    buffer_load_ushort v249, v249, s[24:27], 0 offen
    buffer_load_ushort v250, v250, s[24:27], 0 offen
    s_waitcnt vmcnt(0)
    v_lshlrev_b32 v247, 16, v247
    v_mul_f32 v208, v208, v247
    v_lshlrev_b32 v248, 16, v248
    v_mul_f32 v209, v209, v248
    v_lshlrev_b32 v249, 16, v249
    v_mul_f32 v210, v210, v249
    v_lshlrev_b32 v250, 16, v250
    v_mul_f32 v211, v211, v250
    ds_read_u8 v230, v237 offset:96
    ds_read_u8 v232, v237 offset:104
    s_bitcmp1_b64 s[60:61], 3
    s_cbranch_scc1 Ls_wb2
Ls_wbd2:
    s_mov_b64 exec, 1
    ds_add_rtn_u32 v1, v2, v3
    s_mov_b64 exec, -1
    v_exp_f32 v132, v148
    v_exp_f32 v133, v149
    v_exp_f32 v134, v150
    v_exp_f32 v135, v151
    v_cvt_pk_bf16_f32 v208, v208, v209
    v_cvt_pk_bf16_f32 v209, v210, v211
    v_mfma_f32_4x4x4_16b_bf16 v[132:135], v[228:229], v[228:229], v[132:135]
    v_exp_f32 v136, v152
    v_mfma_f32_4x4x4_16b_bf16 v[212:215], v[208:209], v[188:189], v[212:215] cbsz:4 abid:0
    ds_read_b64_tr_b16 v[188:189], v236 offset:4160
    v_exp_f32 v137, v153
    v_exp_f32 v138, v154
    v_mfma_f32_4x4x4_16b_bf16 v[212:215], v[208:209], v[190:191], v[212:215] cbsz:4 abid:4
    ds_read_b64_tr_b16 v[190:191], v236 offset:4672
    v_exp_f32 v139, v155
    s_waitcnt lgkmcnt(2)
    v_mfma_f32_16x16x32_bf16 v[148:151], v[100:103], v[180:183], v[164:167]
    v_exp_f32 v140, v156
    v_mfma_f32_4x4x4_16b_bf16 v[136:139], v[228:229], v[228:229], v[136:139]
    v_rcp_f32 v132, v132
    v_mfma_f32_4x4x4_16b_bf16 v[212:215], v[208:209], v[192:193], v[212:215] cbsz:4 abid:8
    ds_read_b64_tr_b16 v[192:193], v236 offset:5216
    v_rcp_f32 v133, v133
    v_mfma_f32_16x16x32_bf16 v[148:151], v[104:107], v[184:187], v[148:151]
    v_exp_f32 v141, v157
    v_mfma_f32_4x4x4_16b_bf16 v[212:215], v[208:209], v[194:195], v[212:215] cbsz:4 abid:12
    ds_read_b64_tr_b16 v[194:195], v236 offset:5728
    v_exp_f32 v142, v158
    v_mfma_f32_16x16x32_bf16 v[152:155], v[108:111], v[180:183], v[168:171]
    v_rcp_f32 v134, v134
    v_exp_f32 v143, v159
    v_mfma_f32_16x16x32_bf16 v[152:155], v[112:115], v[184:187], v[152:155]
    v_rcp_f32 v135, v135
    v_cvt_pk_bf16_f32 v132, v132, v133
    v_mfma_f32_4x4x4_16b_bf16 v[140:143], v[228:229], v[228:229], v[140:143]
    v_exp_f32 v144, v160
    v_cvt_pk_bf16_f32 v133, v134, v135
    v_mfma_f32_16x16x32_bf16 v[156:159], v[116:119], v[180:183], v[172:175]
    v_rcp_f32 v136, v136
    s_bitcmp1_b64 s[56:57], 2
    s_cbranch_scc1 Ls_flush2
Ls_flushed2:
    v_exp_f32 v145, v161
    v_mfma_f32_16x16x32_bf16 v[156:159], v[120:123], v[184:187], v[156:159]
    v_rcp_f32 v137, v137
    s_waitcnt lgkmcnt(0)
    s_bitcmp1_b64 s[60:61], 6
    s_cbranch_scc1 Ls_adv2
Ls_advd2:
    s_add_u32 m0, s52, 4160
    v_exp_f32 v146, v162
    buffer_load_dwordx4 v[230:231], s[20:23], 0 idxen offen nt lds
    s_add_u32 m0, s52, 5216
    v_cvt_pk_bf16_f32 v134, v136, v137
    buffer_load_dwordx4 v[232:233], s[20:23], 0 idxen offen nt lds
    v_readfirstlane_b32 s66, v1
    s_nop 0
    s_xor_b32 s66, s66, s33
    s_cmp_gt_i32 s66, 0
    s_setprio 0
    s_cbranch_scc0 Ls_lo2
    s_setprio 1
Ls_lo2:
    v_exp_f32 v147, v163
    v_mfma_f32_16x16x32_bf16 v[160:163], v[124:127], v[180:183], v[176:179]
    v_rcp_f32 v138, v138
    v_mfma_f32_4x4x4_16b_bf16 v[144:147], v[228:229], v[228:229], v[144:147]
    v_rcp_f32 v139, v139
    v_mfma_f32_16x16x32_bf16 v[160:163], v[128:131], v[184:187], v[160:163]
    v_rcp_f32 v140, v140
    v_cvt_pk_bf16_f32 v135, v138, v139
    v_rcp_f32 v141, v141
    v_rcp_f32 v142, v142
    v_mfma_f32_16x16x32_bf16 v[208:211], v[132:135], v[196:199], v[204:207]
    v_rcp_f32 v143, v143
    v_cvt_pk_bf16_f32 v136, v140, v141
    v_rcp_f32 v144, v144
    v_cvt_pk_bf16_f32 v137, v142, v143
    v_rcp_f32 v145, v145
    v_rcp_f32 v146, v146
    v_cvt_pk_bf16_f32 v138, v144, v145
    v_rcp_f32 v147, v147
    s_waitcnt vmcnt(4)
    v_cvt_pk_bf16_f32 v139, v146, v147
    ds_read_b128 v[180:183], v234 offset:0
    ds_read_b128 v[184:187], v235 offset:0
    v_mfma_f32_16x16x32_bf16 v[208:211], v[136:139], v[200:203], v[208:211]
    ds_read_b32 v246, v244 offset:48
    s_waitcnt lgkmcnt(0)
    v_bfe_u32 v247, v246, 0, 8
    v_lshlrev_b32 v247, 1, v247
    v_bfe_u32 v248, v246, 8, 8
    v_lshlrev_b32 v248, 1, v248
    v_bfe_u32 v249, v246, 16, 8
    v_lshlrev_b32 v249, 1, v249
    v_bfe_u32 v250, v246, 24, 8
    v_lshlrev_b32 v250, 1, v250
    buffer_load_ushort v247, v247, s[24:27], 0 offen
    buffer_load_ushort v248, v248, s[24:27], 0 offen
    buffer_load_ushort v249, v249, s[24:27], 0 offen
    buffer_load_ushort v250, v250, s[24:27], 0 offen
    s_waitcnt vmcnt(0)
    v_lshlrev_b32 v247, 16, v247
    v_mul_f32 v208, v208, v247
    v_lshlrev_b32 v248, 16, v248
    v_mul_f32 v209, v209, v248
    v_lshlrev_b32 v249, 16, v249
    v_mul_f32 v210, v210, v249
    v_lshlrev_b32 v250, 16, v250
    v_mul_f32 v211, v211, v250
    ds_read_u8 v230, v237 offset:112
    ds_read_u8 v232, v237 offset:120
    s_bitcmp1_b64 s[60:61], 4
    s_cbranch_scc1 Ls_wb3
Ls_wbd3:
    v_exp_f32 v132, v148
    v_exp_f32 v133, v149
    v_exp_f32 v134, v150
    v_exp_f32 v135, v151
    v_cvt_pk_bf16_f32 v208, v208, v209
    v_cvt_pk_bf16_f32 v209, v210, v211
    v_mfma_f32_4x4x4_16b_bf16 v[132:135], v[228:229], v[228:229], v[132:135]
    v_exp_f32 v136, v152
    v_mfma_f32_4x4x4_16b_bf16 v[212:215], v[208:209], v[188:189], v[212:215] cbsz:4 abid:0
    ds_read_b64_tr_b16 v[188:189], v236 offset:6240
    v_exp_f32 v137, v153
    v_exp_f32 v138, v154
    v_mfma_f32_4x4x4_16b_bf16 v[212:215], v[208:209], v[190:191], v[212:215] cbsz:4 abid:4
    ds_read_b64_tr_b16 v[190:191], v236 offset:6752
    v_exp_f32 v139, v155
    s_waitcnt lgkmcnt(2)
    v_mfma_f32_16x16x32_bf16 v[148:151], v[100:103], v[180:183], v[164:167]
    v_exp_f32 v140, v156
    v_mfma_f32_4x4x4_16b_bf16 v[136:139], v[228:229], v[228:229], v[136:139]
    v_rcp_f32 v132, v132
    v_mfma_f32_4x4x4_16b_bf16 v[212:215], v[208:209], v[192:193], v[212:215] cbsz:4 abid:8
    ds_read_b64_tr_b16 v[192:193], v236 offset:7296
    v_rcp_f32 v133, v133
    v_mfma_f32_16x16x32_bf16 v[148:151], v[104:107], v[184:187], v[148:151]
    v_exp_f32 v141, v157
    v_mfma_f32_4x4x4_16b_bf16 v[212:215], v[208:209], v[194:195], v[212:215] cbsz:4 abid:12
    ds_read_b64_tr_b16 v[194:195], v236 offset:7808
    v_exp_f32 v142, v158
    v_mfma_f32_16x16x32_bf16 v[152:155], v[108:111], v[180:183], v[168:171]
    v_rcp_f32 v134, v134
    v_exp_f32 v143, v159
    v_mfma_f32_16x16x32_bf16 v[152:155], v[112:115], v[184:187], v[152:155]
    v_rcp_f32 v135, v135
    v_cvt_pk_bf16_f32 v132, v132, v133
    v_mfma_f32_4x4x4_16b_bf16 v[140:143], v[228:229], v[228:229], v[140:143]
    v_exp_f32 v144, v160
    v_cvt_pk_bf16_f32 v133, v134, v135
    v_mfma_f32_16x16x32_bf16 v[156:159], v[116:119], v[180:183], v[172:175]
    v_rcp_f32 v136, v136
    s_bitcmp1_b64 s[56:57], 3
    s_cbranch_scc1 Ls_flush3
Ls_flushed3:
    v_exp_f32 v145, v161
    v_mfma_f32_16x16x32_bf16 v[156:159], v[120:123], v[184:187], v[156:159]
    v_rcp_f32 v137, v137
    s_waitcnt lgkmcnt(0)
    s_bitcmp1_b64 s[60:61], 7
    s_cbranch_scc1 Ls_adv3
Ls_advd3:
    s_add_u32 m0, s52, 6240
    v_exp_f32 v146, v162
    buffer_load_dwordx4 v[230:231], s[20:23], 0 idxen offen nt lds
    s_add_u32 m0, s52, 7296
    v_cvt_pk_bf16_f32 v134, v136, v137
    buffer_load_dwordx4 v[232:233], s[20:23], 0 idxen offen nt lds
    v_exp_f32 v147, v163
    v_mfma_f32_16x16x32_bf16 v[160:163], v[124:127], v[180:183], v[176:179]
    v_rcp_f32 v138, v138
    v_mfma_f32_4x4x4_16b_bf16 v[144:147], v[228:229], v[228:229], v[144:147]
    v_rcp_f32 v139, v139
    v_mfma_f32_16x16x32_bf16 v[160:163], v[128:131], v[184:187], v[160:163]
    v_rcp_f32 v140, v140
    v_cvt_pk_bf16_f32 v135, v138, v139
    v_rcp_f32 v141, v141
    s_lshr_b64 s[56:57], s[56:57], 4
    s_lshl_b64 s[86:87], s[58:59], 60
    s_or_b64 s[56:57], s[56:57], s[86:87]
    s_lshr_b64 s[58:59], s[58:59], 4
    s_lshr_b64 s[60:61], s[60:61], 4
    s_lshl_b64 s[86:87], s[62:63], 60
    s_or_b64 s[60:61], s[60:61], s[86:87]
    s_lshr_b64 s[62:63], s[62:63], 4
    v_add_u32 v237, 64, v237
    v_add_u32 v244, 64, v244
    v_rcp_f32 v142, v142
    v_mfma_f32_16x16x32_bf16 v[208:211], v[132:135], v[196:199], v[204:207]
    v_rcp_f32 v143, v143
    v_cvt_pk_bf16_f32 v136, v140, v141
    v_rcp_f32 v144, v144
    v_cvt_pk_bf16_f32 v137, v142, v143
    v_rcp_f32 v145, v145
    v_rcp_f32 v146, v146
    v_cvt_pk_bf16_f32 v138, v144, v145
    v_rcp_f32 v147, v147
    s_branch Ls_loop
Ls_flush0:
    v_cvt_pk_bf16_f32 v246, v212, v212
    v_mov_b32 v212, 0
    s_sub_u32 s65, s65, 1
    ds_write_b16 v240, v246
    s_cbranch_scc1 L_store
    v_add_u32 v240, 128, v240
    s_add_u32 s24, s24, s32
    s_addc_u32 s25, s25, 0
    s_xor_b32 s32, s32, 0x18ffe0
    s_branch Ls_flushed0
Ls_wb0:
    v_mul_u32_u24 v216, v224, v241
    v_mul_u32_u24 v217, v224, v242
    v_mul_u32_u24 v218, v225, v241
    v_mul_u32_u24 v219, v225, v242
    v_mul_u32_u24 v220, v226, v241
    v_mul_u32_u24 v221, v226, v242
    v_mul_u32_u24 v222, v227, v241
    v_mul_u32_u24 v223, v227, v242
    v_add_u32 v238, 128, v238
    ds_read_b128 v[164:167], v239
    v_mfma_f32_16x16x16_bf16 v[132:135], v[216:217], v[68:69], v[4:7]
    ds_read_b128 v[168:171], v239 offset:64
    ds_read_b128 v[172:175], v239 offset:128
    v_mfma_f32_16x16x16_bf16 v[136:139], v[218:219], v[70:71], v[8:11]
    ds_read_b128 v[176:179], v239 offset:192
    ds_read_u16 v224, v238
    v_mfma_f32_16x16x16_bf16 v[140:143], v[220:221], v[72:73], v[12:15]
    ds_read_u16 v225, v238 offset:8
    ds_read_u16 v226, v238 offset:64
    v_mfma_f32_16x16x16_bf16 v[144:147], v[222:223], v[74:75], v[16:19]
    ds_read_u16 v227, v238 offset:72
    v_add_u32 v239, 256, v239
    v_mfma_f32_16x16x16_bf16 v[246:249], v[216:217], v[76:77], v[20:23]
    v_cvt_pk_bf16_f32 v100, v132, v133
    v_cvt_pk_bf16_f32 v101, v134, v135
    v_mfma_f32_16x16x16_bf16 v[250:253], v[218:219], v[78:79], v[24:27]
    v_cvt_pk_bf16_f32 v102, v136, v137
    v_cvt_pk_bf16_f32 v103, v138, v139
    v_mfma_f32_16x16x16_bf16 v[132:135], v[220:221], v[80:81], v[28:31]
    v_cvt_pk_bf16_f32 v104, v140, v141
    v_cvt_pk_bf16_f32 v105, v142, v143
    v_mfma_f32_16x16x16_bf16 v[136:139], v[222:223], v[82:83], v[32:35]
    v_cvt_pk_bf16_f32 v106, v144, v145
    v_cvt_pk_bf16_f32 v107, v146, v147
    v_mfma_f32_16x16x16_bf16 v[140:143], v[216:217], v[84:85], v[36:39]
    v_cvt_pk_bf16_f32 v108, v246, v247
    v_cvt_pk_bf16_f32 v109, v248, v249
    v_mfma_f32_16x16x16_bf16 v[144:147], v[218:219], v[86:87], v[40:43]
    v_cvt_pk_bf16_f32 v110, v250, v251
    v_cvt_pk_bf16_f32 v111, v252, v253
    v_mfma_f32_16x16x16_bf16 v[246:249], v[220:221], v[88:89], v[44:47]
    v_cvt_pk_bf16_f32 v112, v132, v133
    v_cvt_pk_bf16_f32 v113, v134, v135
    v_mfma_f32_16x16x16_bf16 v[250:253], v[222:223], v[90:91], v[48:51]
    v_cvt_pk_bf16_f32 v114, v136, v137
    v_cvt_pk_bf16_f32 v115, v138, v139
    v_mfma_f32_16x16x16_bf16 v[132:135], v[216:217], v[92:93], v[52:55]
    v_cvt_pk_bf16_f32 v116, v140, v141
    v_cvt_pk_bf16_f32 v117, v142, v143
    v_mfma_f32_16x16x16_bf16 v[136:139], v[218:219], v[94:95], v[56:59]
    v_cvt_pk_bf16_f32 v118, v144, v145
    v_cvt_pk_bf16_f32 v119, v146, v147
    v_mfma_f32_16x16x16_bf16 v[140:143], v[220:221], v[96:97], v[60:63]
    v_cvt_pk_bf16_f32 v120, v246, v247
    v_cvt_pk_bf16_f32 v121, v248, v249
    v_mfma_f32_16x16x16_bf16 v[144:147], v[222:223], v[98:99], v[64:67]
    v_cvt_pk_bf16_f32 v122, v250, v251
    v_cvt_pk_bf16_f32 v123, v252, v253
    v_cvt_pk_bf16_f32 v124, v132, v133
    v_cvt_pk_bf16_f32 v125, v134, v135
    v_cvt_pk_bf16_f32 v126, v136, v137
    v_cvt_pk_bf16_f32 v127, v138, v139
    v_cvt_pk_bf16_f32 v128, v140, v141
    v_cvt_pk_bf16_f32 v129, v142, v143
    v_cvt_pk_bf16_f32 v130, v144, v145
    v_cvt_pk_bf16_f32 v131, v146, v147
    s_waitcnt lgkmcnt(0)
    s_branch Ls_wbd0
Ls_adv0:
    s_add_u32 s20, s20, s31
    s_addc_u32 s21, s21, 0
    s_xor_b32 s31, s31, 0x63ff800
    s_branch Ls_advd0
Ls_flush1:
    v_cvt_pk_bf16_f32 v246, v212, v212
    v_mov_b32 v212, 0
    s_sub_u32 s65, s65, 1
    ds_write_b16 v240, v246
    s_cbranch_scc1 L_store
    v_add_u32 v240, 128, v240
    s_add_u32 s24, s24, s32
    s_addc_u32 s25, s25, 0
    s_xor_b32 s32, s32, 0x18ffe0
    s_branch Ls_flushed1
Ls_wb1:
    v_mul_u32_u24 v216, v224, v241
    v_mul_u32_u24 v217, v224, v242
    v_mul_u32_u24 v218, v225, v241
    v_mul_u32_u24 v219, v225, v242
    v_mul_u32_u24 v220, v226, v241
    v_mul_u32_u24 v221, v226, v242
    v_mul_u32_u24 v222, v227, v241
    v_mul_u32_u24 v223, v227, v242
    v_add_u32 v238, 128, v238
    ds_read_b128 v[164:167], v239
    v_mfma_f32_16x16x16_bf16 v[132:135], v[216:217], v[68:69], v[4:7]
    ds_read_b128 v[168:171], v239 offset:64
    ds_read_b128 v[172:175], v239 offset:128
    v_mfma_f32_16x16x16_bf16 v[136:139], v[218:219], v[70:71], v[8:11]
    ds_read_b128 v[176:179], v239 offset:192
    ds_read_u16 v224, v238
    v_mfma_f32_16x16x16_bf16 v[140:143], v[220:221], v[72:73], v[12:15]
    ds_read_u16 v225, v238 offset:8
    ds_read_u16 v226, v238 offset:64
    v_mfma_f32_16x16x16_bf16 v[144:147], v[222:223], v[74:75], v[16:19]
    ds_read_u16 v227, v238 offset:72
    v_add_u32 v239, 256, v239
    v_mfma_f32_16x16x16_bf16 v[246:249], v[216:217], v[76:77], v[20:23]
    v_cvt_pk_bf16_f32 v100, v132, v133
    v_cvt_pk_bf16_f32 v101, v134, v135
    v_mfma_f32_16x16x16_bf16 v[250:253], v[218:219], v[78:79], v[24:27]
    v_cvt_pk_bf16_f32 v102, v136, v137
    v_cvt_pk_bf16_f32 v103, v138, v139
    v_mfma_f32_16x16x16_bf16 v[132:135], v[220:221], v[80:81], v[28:31]
    v_cvt_pk_bf16_f32 v104, v140, v141
    v_cvt_pk_bf16_f32 v105, v142, v143
    v_mfma_f32_16x16x16_bf16 v[136:139], v[222:223], v[82:83], v[32:35]
    v_cvt_pk_bf16_f32 v106, v144, v145
    v_cvt_pk_bf16_f32 v107, v146, v147
    v_mfma_f32_16x16x16_bf16 v[140:143], v[216:217], v[84:85], v[36:39]
    v_cvt_pk_bf16_f32 v108, v246, v247
    v_cvt_pk_bf16_f32 v109, v248, v249
    v_mfma_f32_16x16x16_bf16 v[144:147], v[218:219], v[86:87], v[40:43]
    v_cvt_pk_bf16_f32 v110, v250, v251
    v_cvt_pk_bf16_f32 v111, v252, v253
    v_mfma_f32_16x16x16_bf16 v[246:249], v[220:221], v[88:89], v[44:47]
    v_cvt_pk_bf16_f32 v112, v132, v133
    v_cvt_pk_bf16_f32 v113, v134, v135
    v_mfma_f32_16x16x16_bf16 v[250:253], v[222:223], v[90:91], v[48:51]
    v_cvt_pk_bf16_f32 v114, v136, v137
    v_cvt_pk_bf16_f32 v115, v138, v139
    v_mfma_f32_16x16x16_bf16 v[132:135], v[216:217], v[92:93], v[52:55]
    v_cvt_pk_bf16_f32 v116, v140, v141
    v_cvt_pk_bf16_f32 v117, v142, v143
    v_mfma_f32_16x16x16_bf16 v[136:139], v[218:219], v[94:95], v[56:59]
    v_cvt_pk_bf16_f32 v118, v144, v145
    v_cvt_pk_bf16_f32 v119, v146, v147
    v_mfma_f32_16x16x16_bf16 v[140:143], v[220:221], v[96:97], v[60:63]
    v_cvt_pk_bf16_f32 v120, v246, v247
    v_cvt_pk_bf16_f32 v121, v248, v249
    v_mfma_f32_16x16x16_bf16 v[144:147], v[222:223], v[98:99], v[64:67]
    v_cvt_pk_bf16_f32 v122, v250, v251
    v_cvt_pk_bf16_f32 v123, v252, v253
    v_cvt_pk_bf16_f32 v124, v132, v133
    v_cvt_pk_bf16_f32 v125, v134, v135
    v_cvt_pk_bf16_f32 v126, v136, v137
    v_cvt_pk_bf16_f32 v127, v138, v139
    v_cvt_pk_bf16_f32 v128, v140, v141
    v_cvt_pk_bf16_f32 v129, v142, v143
    v_cvt_pk_bf16_f32 v130, v144, v145
    v_cvt_pk_bf16_f32 v131, v146, v147
    s_waitcnt lgkmcnt(0)
    s_branch Ls_wbd1
Ls_adv1:
    s_add_u32 s20, s20, s31
    s_addc_u32 s21, s21, 0
    s_xor_b32 s31, s31, 0x63ff800
    s_branch Ls_advd1
Ls_flush2:
    v_cvt_pk_bf16_f32 v246, v212, v212
    v_mov_b32 v212, 0
    s_sub_u32 s65, s65, 1
    ds_write_b16 v240, v246
    s_cbranch_scc1 L_store
    v_add_u32 v240, 128, v240
    s_add_u32 s24, s24, s32
    s_addc_u32 s25, s25, 0
    s_xor_b32 s32, s32, 0x18ffe0
    s_branch Ls_flushed2
Ls_wb2:
    v_mul_u32_u24 v216, v224, v241
    v_mul_u32_u24 v217, v224, v242
    v_mul_u32_u24 v218, v225, v241
    v_mul_u32_u24 v219, v225, v242
    v_mul_u32_u24 v220, v226, v241
    v_mul_u32_u24 v221, v226, v242
    v_mul_u32_u24 v222, v227, v241
    v_mul_u32_u24 v223, v227, v242
    v_add_u32 v238, 128, v238
    ds_read_b128 v[164:167], v239
    v_mfma_f32_16x16x16_bf16 v[132:135], v[216:217], v[68:69], v[4:7]
    ds_read_b128 v[168:171], v239 offset:64
    ds_read_b128 v[172:175], v239 offset:128
    v_mfma_f32_16x16x16_bf16 v[136:139], v[218:219], v[70:71], v[8:11]
    ds_read_b128 v[176:179], v239 offset:192
    ds_read_u16 v224, v238
    v_mfma_f32_16x16x16_bf16 v[140:143], v[220:221], v[72:73], v[12:15]
    ds_read_u16 v225, v238 offset:8
    ds_read_u16 v226, v238 offset:64
    v_mfma_f32_16x16x16_bf16 v[144:147], v[222:223], v[74:75], v[16:19]
    ds_read_u16 v227, v238 offset:72
    v_add_u32 v239, 256, v239
    v_mfma_f32_16x16x16_bf16 v[246:249], v[216:217], v[76:77], v[20:23]
    v_cvt_pk_bf16_f32 v100, v132, v133
    v_cvt_pk_bf16_f32 v101, v134, v135
    v_mfma_f32_16x16x16_bf16 v[250:253], v[218:219], v[78:79], v[24:27]
    v_cvt_pk_bf16_f32 v102, v136, v137
    v_cvt_pk_bf16_f32 v103, v138, v139
    v_mfma_f32_16x16x16_bf16 v[132:135], v[220:221], v[80:81], v[28:31]
    v_cvt_pk_bf16_f32 v104, v140, v141
    v_cvt_pk_bf16_f32 v105, v142, v143
    v_mfma_f32_16x16x16_bf16 v[136:139], v[222:223], v[82:83], v[32:35]
    v_cvt_pk_bf16_f32 v106, v144, v145
    v_cvt_pk_bf16_f32 v107, v146, v147
    v_mfma_f32_16x16x16_bf16 v[140:143], v[216:217], v[84:85], v[36:39]
    v_cvt_pk_bf16_f32 v108, v246, v247
    v_cvt_pk_bf16_f32 v109, v248, v249
    v_mfma_f32_16x16x16_bf16 v[144:147], v[218:219], v[86:87], v[40:43]
    v_cvt_pk_bf16_f32 v110, v250, v251
    v_cvt_pk_bf16_f32 v111, v252, v253
    v_mfma_f32_16x16x16_bf16 v[246:249], v[220:221], v[88:89], v[44:47]
    v_cvt_pk_bf16_f32 v112, v132, v133
    v_cvt_pk_bf16_f32 v113, v134, v135
    v_mfma_f32_16x16x16_bf16 v[250:253], v[222:223], v[90:91], v[48:51]
    v_cvt_pk_bf16_f32 v114, v136, v137
    v_cvt_pk_bf16_f32 v115, v138, v139
    v_mfma_f32_16x16x16_bf16 v[132:135], v[216:217], v[92:93], v[52:55]
    v_cvt_pk_bf16_f32 v116, v140, v141
    v_cvt_pk_bf16_f32 v117, v142, v143
    v_mfma_f32_16x16x16_bf16 v[136:139], v[218:219], v[94:95], v[56:59]
    v_cvt_pk_bf16_f32 v118, v144, v145
    v_cvt_pk_bf16_f32 v119, v146, v147
    v_mfma_f32_16x16x16_bf16 v[140:143], v[220:221], v[96:97], v[60:63]
    v_cvt_pk_bf16_f32 v120, v246, v247
    v_cvt_pk_bf16_f32 v121, v248, v249
    v_mfma_f32_16x16x16_bf16 v[144:147], v[222:223], v[98:99], v[64:67]
    v_cvt_pk_bf16_f32 v122, v250, v251
    v_cvt_pk_bf16_f32 v123, v252, v253
    v_cvt_pk_bf16_f32 v124, v132, v133
    v_cvt_pk_bf16_f32 v125, v134, v135
    v_cvt_pk_bf16_f32 v126, v136, v137
    v_cvt_pk_bf16_f32 v127, v138, v139
    v_cvt_pk_bf16_f32 v128, v140, v141
    v_cvt_pk_bf16_f32 v129, v142, v143
    v_cvt_pk_bf16_f32 v130, v144, v145
    v_cvt_pk_bf16_f32 v131, v146, v147
    s_waitcnt lgkmcnt(0)
    s_branch Ls_wbd2
Ls_adv2:
    s_add_u32 s20, s20, s31
    s_addc_u32 s21, s21, 0
    s_xor_b32 s31, s31, 0x63ff800
    s_branch Ls_advd2
Ls_flush3:
    v_cvt_pk_bf16_f32 v246, v212, v212
    v_mov_b32 v212, 0
    s_sub_u32 s65, s65, 1
    ds_write_b16 v240, v246
    s_cbranch_scc1 L_store
    v_add_u32 v240, 128, v240
    s_add_u32 s24, s24, s32
    s_addc_u32 s25, s25, 0
    s_xor_b32 s32, s32, 0x18ffe0
    s_branch Ls_flushed3
Ls_wb3:
    v_mul_u32_u24 v216, v224, v241
    v_mul_u32_u24 v217, v224, v242
    v_mul_u32_u24 v218, v225, v241
    v_mul_u32_u24 v219, v225, v242
    v_mul_u32_u24 v220, v226, v241
    v_mul_u32_u24 v221, v226, v242
    v_mul_u32_u24 v222, v227, v241
    v_mul_u32_u24 v223, v227, v242
    v_add_u32 v238, 128, v238
    ds_read_b128 v[164:167], v239
    v_mfma_f32_16x16x16_bf16 v[132:135], v[216:217], v[68:69], v[4:7]
    ds_read_b128 v[168:171], v239 offset:64
    ds_read_b128 v[172:175], v239 offset:128
    v_mfma_f32_16x16x16_bf16 v[136:139], v[218:219], v[70:71], v[8:11]
    ds_read_b128 v[176:179], v239 offset:192
    ds_read_u16 v224, v238
    v_mfma_f32_16x16x16_bf16 v[140:143], v[220:221], v[72:73], v[12:15]
    ds_read_u16 v225, v238 offset:8
    ds_read_u16 v226, v238 offset:64
    v_mfma_f32_16x16x16_bf16 v[144:147], v[222:223], v[74:75], v[16:19]
    ds_read_u16 v227, v238 offset:72
    v_add_u32 v239, 256, v239
    v_mfma_f32_16x16x16_bf16 v[246:249], v[216:217], v[76:77], v[20:23]
    v_cvt_pk_bf16_f32 v100, v132, v133
    v_cvt_pk_bf16_f32 v101, v134, v135
    v_mfma_f32_16x16x16_bf16 v[250:253], v[218:219], v[78:79], v[24:27]
    v_cvt_pk_bf16_f32 v102, v136, v137
    v_cvt_pk_bf16_f32 v103, v138, v139
    v_mfma_f32_16x16x16_bf16 v[132:135], v[220:221], v[80:81], v[28:31]
    v_cvt_pk_bf16_f32 v104, v140, v141
    v_cvt_pk_bf16_f32 v105, v142, v143
    v_mfma_f32_16x16x16_bf16 v[136:139], v[222:223], v[82:83], v[32:35]
    v_cvt_pk_bf16_f32 v106, v144, v145
    v_cvt_pk_bf16_f32 v107, v146, v147
    v_mfma_f32_16x16x16_bf16 v[140:143], v[216:217], v[84:85], v[36:39]
    v_cvt_pk_bf16_f32 v108, v246, v247
    v_cvt_pk_bf16_f32 v109, v248, v249
    v_mfma_f32_16x16x16_bf16 v[144:147], v[218:219], v[86:87], v[40:43]
    v_cvt_pk_bf16_f32 v110, v250, v251
    v_cvt_pk_bf16_f32 v111, v252, v253
    v_mfma_f32_16x16x16_bf16 v[246:249], v[220:221], v[88:89], v[44:47]
    v_cvt_pk_bf16_f32 v112, v132, v133
    v_cvt_pk_bf16_f32 v113, v134, v135
    v_mfma_f32_16x16x16_bf16 v[250:253], v[222:223], v[90:91], v[48:51]
    v_cvt_pk_bf16_f32 v114, v136, v137
    v_cvt_pk_bf16_f32 v115, v138, v139
    v_mfma_f32_16x16x16_bf16 v[132:135], v[216:217], v[92:93], v[52:55]
    v_cvt_pk_bf16_f32 v116, v140, v141
    v_cvt_pk_bf16_f32 v117, v142, v143
    v_mfma_f32_16x16x16_bf16 v[136:139], v[218:219], v[94:95], v[56:59]
    v_cvt_pk_bf16_f32 v118, v144, v145
    v_cvt_pk_bf16_f32 v119, v146, v147
    v_mfma_f32_16x16x16_bf16 v[140:143], v[220:221], v[96:97], v[60:63]
    v_cvt_pk_bf16_f32 v120, v246, v247
    v_cvt_pk_bf16_f32 v121, v248, v249
    v_mfma_f32_16x16x16_bf16 v[144:147], v[222:223], v[98:99], v[64:67]
    v_cvt_pk_bf16_f32 v122, v250, v251
    v_cvt_pk_bf16_f32 v123, v252, v253
    v_cvt_pk_bf16_f32 v124, v132, v133
    v_cvt_pk_bf16_f32 v125, v134, v135
    v_cvt_pk_bf16_f32 v126, v136, v137
    v_cvt_pk_bf16_f32 v127, v138, v139
    v_cvt_pk_bf16_f32 v128, v140, v141
    v_cvt_pk_bf16_f32 v129, v142, v143
    v_cvt_pk_bf16_f32 v130, v144, v145
    v_cvt_pk_bf16_f32 v131, v146, v147
    s_waitcnt lgkmcnt(0)
    s_branch Ls_wbd3
Ls_adv3:
    s_add_u32 s20, s20, s31
    s_addc_u32 s21, s21, 0
    s_xor_b32 s31, s31, 0x63ff800
    s_branch Ls_advd3
.section .rodata,"a"
.p2align 6
.amdhsa_kernel standalone__sequential_behavior_din__recsys_kernel
  .amdhsa_next_free_vgpr 256
  .amdhsa_next_free_sgpr 102
  .amdhsa_accum_offset 256
  .amdhsa_group_segment_fixed_size 0
  .amdhsa_kernarg_size 80
  .amdhsa_user_sgpr_count 2
  .amdhsa_user_sgpr_kernarg_segment_ptr 1
  .amdhsa_system_sgpr_workgroup_id_x 1
.end_amdhsa_kernel
```

```asm
; @launch grid=(256,1,1) block=(512,1,1) lds=163840
.amdgcn_target "amdgcn-amd-amdhsa--gfx950"
.text
.globl standalone__sequential_behavior_din__recsys_kernel
.p2align 8
.type standalone__sequential_behavior_din__recsys_kernel,@function
standalone__sequential_behavior_din__recsys_kernel:
    s_load_dwordx16 s[4:19], s[0:1], 0
    s_cmp_ge_u32 s2, 256
    s_cbranch_scc1 L_end
    v_lshrrev_b32 v1, 6, v0
    v_and_b32 v0, 63, v0
    v_readfirstlane_b32 s54, v1
    s_lshl_b32 s53, s2, 3
    v_lshlrev_b32 v2, 4, v0
    s_bfm_b64 s[28:29], 50, 0
    s_add_u32 s53, s53, s54
    s_mul_i32 s66, s53, 800
    s_mul_i32 s52, s54, 20480
    v_add_u32 v3, s66, v2
    v_and_b32 v248, 16, v0
    v_lshlrev_b32 v246, 1, v248
    v_xor_b32 v246, v246, v2
    s_lshl_b32 s67, s54, 12
    s_add_u32 m0, s52, 4160
    s_mov_b64 exec, s[28:29]
    s_waitcnt lgkmcnt(0)
    global_load_dwordx4 v[100:103], v3, s[8:9] nt
    s_mov_b64 exec, -1
    s_add_u32 s10, s10, s67
    s_addc_u32 s11, s11, 0
    v_xor_b32 v247, 64, v246
    global_load_lds_dwordx4 v246, s[10:11] offset:0
    global_load_lds_dwordx4 v247, s[10:11] offset:1024
    global_load_lds_dwordx4 v246, s[10:11] offset:2048
    global_load_lds_dwordx4 v247, s[10:11] offset:3072
    s_load_dword s30, s[16:17], 0
    v_lshrrev_b32 v1, 4, v0
    v_and_b32 v243, 0xf0, v2
    v_lshl_add_u32 v243, v1, 19, v243
    s_lshl_b32 s66, s53, 8
    s_add_u32 m0, s52, 8320
    v_add_u32 v243, s66, v243
    s_and_b32 s67, s54, 3
    global_load_lds_dwordx4 v243, s[4:5] nt
    s_lshl_b32 s66, s67, 5
    v_lshl_add_u32 v249, v1, 3, s66
    global_load_dwordx2 v[96:97], v249, s[12:13]
    v_and_b32 v250, 3, v0
    s_mul_i32 s66, s53, 51200
    s_add_u32 s6, s6, s66
    s_addc_u32 s7, s7, 0
    s_mov_b32 s20, s6
    s_and_b32 s21, s7, 0xffff
    s_or_b32 s21, s21, 0x800000
    s_mov_b32 s22, 200
    s_mov_b32 s23, 0x20000
    s_movk_i32 s31, 25600
    v_mov_b32 v148, -1
    v_mov_b32 v149, -1
    v_mov_b32 v150, -1
    v_mov_b32 v151, -1
    s_add_u32 s66, s52, 18416
    v_add_u32 v152, s66, v2
    ds_write_b128 v152, v[148:151]
    ds_write_b128 v152, v[148:151] offset:1024
    s_add_u32 s64, s52, 18432
    v_lshrrev_b32 v237, 3, v0
    v_add_u32 v237, s64, v237
    v_lshl_add_u32 v244, v1, 2, s66
    v_and_b32 v231, 0x70, v2
    v_lshlrev_b32 v248, 2, v248
    v_xor_b32 v231, v231, v248
    v_mov_b32 v233, v231
    v_cmp_lt_u32 vcc, 24, v0
    v_mov_b32 v146, 0
    v_mov_b32 v147, 0
    v_cndmask_b32 v145, 0, 1, vcc
    v_mul_u32_u24 v142, 25, v145
    v_sub_u32 v142, v0, v142
    v_mul_u32_u24 v142, 0x80008, v142
    v_add_u32 v141, 0x10000, v142
    v_add_u32 v143, 0x50004, v142
    v_add_u32 v144, 0x70006, v142
    v_add_u32 v142, 0x30002, v142
    s_mov_b64 s[56:57], 0
    s_mov_b64 s[58:59], 0
    s_mov_b32 s65, 7
    s_mov_b32 s92, 0xbfb8aa3b
    v_and_b32 v251, 15, v0
    v_bfe_u32 v252, v0, 2, 2
    v_and_b32 v246, 8, v0
    v_lshlrev_b32 v246, 2, v246
    v_lshl_add_u32 v246, v251, 7, v246
    v_add_u32 v246, s52, v246
    v_and_b32 v247, 2, v0
    v_lshlrev_b32 v248, 1, v247
    v_xor_b32 v248, v248, v1
    v_lshl_add_u32 v234, v248, 4, v246
    v_xor_b32 v248, 4, v248
    v_lshl_add_u32 v235, v248, 4, v246
    v_lshlrev_b32 v253, 3, v250
    v_lshl_add_u32 v253, v252, 7, v253
    v_and_b32 v246, 8, v0
    v_lshlrev_b32 v247, 3, v246
    v_lshl_add_u32 v248, v1, 5, v253
    v_xor_b32 v248, v248, v247
    v_add_u32 v236, s52, v248
    v_lshlrev_b32 v246, 2, v246
    v_xor_b32 v253, v253, v246
    v_and_b32 v246, 16, v0
    v_lshlrev_b32 v246, 2, v246
    v_xor_b32 v253, v253, v246
    v_lshl_add_u32 v253, v1, 10, v253
    s_lshl_b32 s66, s67, 5
    v_xor_b32 v66, s66, v253
    v_add_u32 v66, 45120, v66
    s_lshr_b32 s66, s54, 1
    s_lshl_b32 s66, s66, 5
    v_xor_b32 v64, s66, v253
    s_and_b32 s66, s54, 1
    s_mul_i32 s66, s66, 20480
    s_add_u32 s66, s66, 4160
    v_add_u32 v64, s66, v64
    v_add_u32 v65, 81920, v64
    s_add_u32 s66, s52, 8320
    v_lshl_add_u32 v238, v250, 1, s66
    v_lshl_add_u32 v238, v1, 4, v238
    v_lshl_add_u32 v240, v0, 1, s66
    s_add_u32 s66, s52, 9344
    v_lshl_add_u32 v239, v1, 4, s66
    s_and_b32 s66, s54, 4
    v_lshrrev_b32 v246, 3, v251
    v_add_u32 v246, s66, v246
    v_mul_u32_u24 v246, 20480, v246
    v_lshl_add_u32 v246, v1, 4, v246
    v_and_b32 v247, 7, v0
    v_lshl_add_u32 v67, v247, 7, v246
    v_lshl_add_u32 v98, v247, 8, v246
    s_lshl_b32 s66, s67, 6
    s_add_u32 s66, s66, 9344
    v_add_u32 v98, s66, v98
    v_and_b32 v246, 1, v0
    v_lshlrev_b32 v246, 4, v246
    v_lshlrev_b32 v246, v246, 1
    v_cmp_gt_u32 vcc, 2, v250
    v_mov_b32 v229, 0
    v_mov_b32 v228, 0x3f80
    v_cndmask_b32 v241, 0, v246, vcc
    v_cmp_eq_u32 vcc, 0, v251
    v_sub_u32 v242, v246, v241
    v_mul_u32_u24 v218, 0x3f80, v241
    v_cndmask_b32 v220, 0, -1, vcc
    v_mul_u32_u24 v219, 0x3f80, v242
    s_and_b32 s66, s54, 3
    s_mul_i32 s66, s66, 20480
    s_add_u32 s66, s66, 14464
    v_mov_b32 v221, s66
    s_cmp_ge_u32 s54, 4
    s_cselect_b32 s33, -1, 0
    ds_write_b32 v221, v229
    s_mov_b64 exec, s[28:29]
    v_add_u32 v3, 1638400, v3
    global_load_dwordx4 v[104:107], v3, s[8:9] nt
    v_add_u32 v3, 1638400, v3
    global_load_dwordx4 v[108:111], v3, s[8:9] nt
    v_add_u32 v3, 1638400, v3
    global_load_dwordx4 v[112:115], v3, s[8:9] nt
    s_mov_b64 exec, -1
    v_lshlrev_b32 v249, 3, v1
    v_lshl_add_u32 v249, v250, 5, v249
    global_load_dwordx2 v[216:217], v249, s[14:15]
    s_waitcnt vmcnt(10) lgkmcnt(0)
    s_mov_b64 exec, s[28:29]
    v_cmp_neq_f16_sdwa s[68:69], v100, 0 src0_sel:WORD_0 src1_sel:WORD_0
    v_cmp_neq_f16_sdwa s[70:71], v100, 0 src0_sel:WORD_1 src1_sel:WORD_0
    v_cmp_neq_f16_sdwa s[72:73], v101, 0 src0_sel:WORD_0 src1_sel:WORD_0
    v_cmp_neq_f16_sdwa s[74:75], v101, 0 src0_sel:WORD_1 src1_sel:WORD_0
    v_cmp_neq_f16_sdwa s[76:77], v102, 0 src0_sel:WORD_0 src1_sel:WORD_0
    v_cmp_neq_f16_sdwa s[78:79], v102, 0 src0_sel:WORD_1 src1_sel:WORD_0
    v_cmp_neq_f16_sdwa s[80:81], v103, 0 src0_sel:WORD_0 src1_sel:WORD_0
    v_cmp_neq_f16_sdwa s[82:83], v103, 0 src0_sel:WORD_1 src1_sel:WORD_0
    v_sad_u16 v147, v100, 0, v147
    v_sad_u16 v147, v101, 0, v147
    v_sad_u16 v147, v102, 0, v147
    v_sad_u16 v147, v103, 0, v147
    v_or3_b32 v146, v100, v101, v146
    v_or3_b32 v146, v102, v103, v146
    s_mov_b64 exec, -1
    v_mov_b32 v132, s64
    v_mbcnt_lo_u32_b32 v132, s68, v132
    v_mbcnt_hi_u32_b32 v132, s69, v132
    v_mbcnt_lo_u32_b32 v132, s70, v132
    v_mbcnt_hi_u32_b32 v132, s71, v132
    v_mbcnt_lo_u32_b32 v132, s72, v132
    v_mbcnt_hi_u32_b32 v132, s73, v132
    v_mbcnt_lo_u32_b32 v132, s74, v132
    v_mbcnt_hi_u32_b32 v132, s75, v132
    v_mbcnt_lo_u32_b32 v132, s76, v132
    v_mbcnt_hi_u32_b32 v132, s77, v132
    v_mbcnt_lo_u32_b32 v132, s78, v132
    v_mbcnt_hi_u32_b32 v132, s79, v132
    v_mbcnt_lo_u32_b32 v132, s80, v132
    v_mbcnt_hi_u32_b32 v132, s81, v132
    v_mbcnt_lo_u32_b32 v132, s82, v132
    v_mbcnt_hi_u32_b32 v132, s83, v132
    s_add_u32 s34, s64, 16
    v_readlane_b32 s66, v132, 25
    v_readlane_b32 s67, v132, 63
    s_add_u32 s64, s66, 15
    s_and_b32 s64, s64, -16
    s_max_u32 s64, s64, s34
    s_sub_u32 s66, s64, s66
    v_mad_u32_u24 v132, v145, s66, v132
    s_lshr_b32 s35, s64, 4
    s_bitset1_b64 s[56:57], s35
    v_addc_co_u32 v133, vcc, 0, v132, s[68:69]
    v_addc_co_u32 v134, vcc, 0, v133, s[70:71]
    v_addc_co_u32 v135, vcc, 0, v134, s[72:73]
    v_addc_co_u32 v136, vcc, 0, v135, s[74:75]
    v_addc_co_u32 v137, vcc, 0, v136, s[76:77]
    v_addc_co_u32 v138, vcc, 0, v137, s[78:79]
    v_addc_co_u32 v139, vcc, 0, v138, s[80:81]
    v_addc_co_u32 v140, vcc, 0, v139, s[82:83]
    s_add_u32 s67, s67, s66
    s_add_u32 s67, s67, 15
    s_and_b32 s67, s67, -16
    s_add_u32 s64, s64, 16
    s_max_u32 s64, s64, s67
    s_mov_b64 exec, s[68:69]
    ds_write_b8 v132, v141
    s_mov_b64 exec, s[70:71]
    ds_write_b8_d16_hi v133, v141
    s_mov_b64 exec, s[72:73]
    ds_write_b8 v134, v142
    s_mov_b64 exec, s[74:75]
    ds_write_b8_d16_hi v135, v142
    s_mov_b64 exec, s[76:77]
    ds_write_b8 v136, v143
    s_mov_b64 exec, s[78:79]
    ds_write_b8_d16_hi v137, v143
    s_mov_b64 exec, s[80:81]
    ds_write_b8 v138, v144
    s_mov_b64 exec, s[82:83]
    ds_write_b8_d16_hi v139, v144
    s_mov_b64 exec, -1
    v_sub_u32 v140, v132, v140
    s_movk_i32 s66, 0x3f80
    v_mad_i32_i24 v147, v140, s66, v147
    s_lshr_b32 s35, s64, 4
    s_bitset1_b64 s[56:57], s35
    s_add_u32 s66, s52, 18496
    s_cmp_ge_u32 s64, s66
    s_cselect_b32 s94, 1, 0
    s_cbranch_scc1 L_early
    s_waitcnt vmcnt(0)
L_early:
    ds_read_u8 v148, v237 offset:0
    ds_read_u8 v149, v237 offset:8
    ds_read_u8 v150, v237 offset:16
    ds_read_u8 v151, v237 offset:24
    ds_read_u8 v152, v237 offset:32
    ds_read_u8 v153, v237 offset:40
    ds_read_u8 v154, v237 offset:48
    ds_read_u8 v155, v237 offset:56
    s_waitcnt lgkmcnt(0)
    s_cmp_eq_u32 s94, 0
    s_cbranch_scc1 L_skip0
    s_add_u32 m0, s52, 0
    v_mov_b32 v230, v148
    v_mov_b32 v232, v149
    buffer_load_dwordx4 v[230:231], s[20:23], 0 idxen offen nt lds
    s_add_u32 m0, s52, 1056
    s_nop 0
    buffer_load_dwordx4 v[232:233], s[20:23], 0 idxen offen nt lds
    s_bitcmp0_b64 s[56:57], 1
    s_cbranch_scc1 L_noadve1
    s_add_u32 s20, s20, s31
    s_addc_u32 s21, s21, 0
    s_xor_b32 s31, s31, 0x63ff800
L_noadve1:
    s_add_u32 m0, s52, 2080
    v_mov_b32 v230, v150
    v_mov_b32 v232, v151
    buffer_load_dwordx4 v[230:231], s[20:23], 0 idxen offen nt lds
    s_add_u32 m0, s52, 3136
    s_nop 0
    buffer_load_dwordx4 v[232:233], s[20:23], 0 idxen offen nt lds
L_skip0:
    s_waitcnt vmcnt(8)
    s_barrier
    ds_read_b64_tr_b16 v[16:17], v66 offset:0
    ds_read_b64_tr_b16 v[18:19], v66 offset:512
    ds_read_b64_tr_b16 v[20:21], v66 offset:20480
    ds_read_b64_tr_b16 v[22:23], v66 offset:20992
    ds_read_b64_tr_b16 v[24:25], v66 offset:40960
    ds_read_b64_tr_b16 v[26:27], v66 offset:41472
    ds_read_b64_tr_b16 v[28:29], v66 offset:61440
    ds_read_b64_tr_b16 v[30:31], v66 offset:61952
    ds_read_b128 v[32:35], v67 offset:8320
    ds_read_b128 v[36:39], v67 offset:8384
    ds_read_b128 v[40:43], v67 offset:49280
    ds_read_b128 v[44:47], v67 offset:49344
    ds_read_b64_tr_b16 v[4:5], v64 offset:0
    ds_read_b64_tr_b16 v[8:9], v65 offset:0
    ds_read_b64_tr_b16 v[12:13], v65 offset:40960
    ds_read_b64_tr_b16 v[6:7], v64 offset:512
    ds_read_b64_tr_b16 v[10:11], v65 offset:512
    ds_read_b64_tr_b16 v[14:15], v65 offset:41472
    v_lshlrev_b32 v48, 16, v96
    v_and_b32 v49, 0xffff0000, v96
    v_lshlrev_b32 v50, 16, v97
    v_and_b32 v51, 0xffff0000, v97
    s_waitcnt lgkmcnt(0)
    v_xor_b32 v24, 0x80008000, v24
    v_xor_b32 v25, 0x80008000, v25
    v_xor_b32 v26, 0x80008000, v26
    v_xor_b32 v27, 0x80008000, v27
    v_xor_b32 v28, 0x80008000, v28
    v_xor_b32 v29, 0x80008000, v29
    v_xor_b32 v30, 0x80008000, v30
    v_xor_b32 v31, 0x80008000, v31
    v_mfma_f32_4x4x4_16b_bf16 v[56:59], v[218:219], v[4:5], 0
    v_mfma_f32_4x4x4_16b_bf16 v[68:71], v[218:219], v[12:13], 0
    v_mfma_f32_4x4x4_16b_bf16 v[60:63], v[218:219], v[6:7], 0
    v_mfma_f32_4x4x4_16b_bf16 v[72:75], v[218:219], v[14:15], 0
    v_mfma_f32_4x4x4_16b_bf16 v[56:59], v[218:219], v[8:9], v[56:59]
    v_mfma_f32_4x4x4_16b_bf16 v[60:63], v[218:219], v[10:11], v[60:63]
    v_mfma_f32_16x16x32_bf16 v[52:55], v[16:19], v[40:43], v[48:51]
    v_mfma_f32_16x16x32_bf16 v[52:55], v[20:23], v[44:47], v[52:55]
    v_mfma_f32_16x16x32_bf16 v[52:55], v[24:27], v[40:43], v[52:55]
    v_mfma_f32_16x16x32_bf16 v[52:55], v[28:31], v[44:47], v[52:55]
    v_mfma_f32_16x16x32_bf16 v[48:51], v[16:19], v[32:35], v[48:51]
    v_mfma_f32_16x16x32_bf16 v[48:51], v[20:23], v[36:39], v[48:51]
    v_mfma_f32_16x16x32_bf16 v[48:51], v[24:27], v[32:35], v[48:51]
    v_mfma_f32_16x16x32_bf16 v[48:51], v[28:31], v[36:39], v[48:51]
    v_mul_f32 v56, s92, v56
    v_mul_f32 v57, s92, v57
    v_mul_f32 v58, s92, v58
    v_mul_f32 v59, s92, v59
    v_mul_f32 v60, s92, v60
    v_mul_f32 v61, s92, v61
    v_mul_f32 v62, s92, v62
    v_mul_f32 v63, s92, v63
    v_mul_f32 v68, s92, v68
    v_mul_f32 v69, s92, v69
    v_mul_f32 v70, s92, v70
    v_mul_f32 v71, s92, v71
    v_mul_f32 v72, s92, v72
    v_mul_f32 v73, s92, v73
    v_mul_f32 v74, s92, v74
    v_mul_f32 v75, s92, v75
    s_add_u32 s66, s52, 11392
    v_add_u32 v3, s66, v2
    v_cvt_pk_bf16_f32 v68, v68, v69
    v_cvt_pk_bf16_f32 v69, v70, v71
    v_cvt_pk_bf16_f32 v70, v72, v73
    v_cvt_pk_bf16_f32 v71, v74, v75
    v_mul_f32 v48, s92, v48
    v_mul_f32 v49, s92, v49
    v_mul_f32 v50, s92, v50
    v_mul_f32 v51, s92, v51
    v_mul_f32 v52, s92, v52
    v_mul_f32 v53, s92, v53
    v_mul_f32 v54, s92, v54
    v_mul_f32 v55, s92, v55
    ds_write_b128 v3, v[56:59]
    ds_write_b128 v3, v[60:63] offset:1024
    ds_write_b128 v3, v[68:71] offset:2048
    ds_write_b128 v98, v[48:51]
    ds_write_b128 v98, v[52:55] offset:40960
    v_add_u32 v3, 11392, v2
    v_add_u32 v246, 81920, v3
    s_waitcnt lgkmcnt(0)
    s_barrier
    ds_read_b128 v[4:7], v3 offset:0
    ds_read_b128 v[8:11], v3 offset:1024
    ds_read_b128 v[68:71], v3 offset:2048
    ds_read_b128 v[12:15], v3 offset:20480
    ds_read_b128 v[16:19], v3 offset:21504
    ds_read_b128 v[72:75], v3 offset:22528
    ds_read_b128 v[20:23], v3 offset:40960
    ds_read_b128 v[24:27], v3 offset:41984
    ds_read_b128 v[76:79], v3 offset:43008
    ds_read_b128 v[28:31], v3 offset:61440
    ds_read_b128 v[32:35], v3 offset:62464
    ds_read_b128 v[80:83], v3 offset:63488
    ds_read_b128 v[36:39], v246 offset:0
    ds_read_b128 v[40:43], v246 offset:1024
    ds_read_b128 v[84:87], v246 offset:2048
    ds_read_b128 v[44:47], v246 offset:20480
    ds_read_b128 v[48:51], v246 offset:21504
    ds_read_b128 v[88:91], v246 offset:22528
    ds_read_b128 v[52:55], v246 offset:40960
    ds_read_b128 v[56:59], v246 offset:41984
    ds_read_b128 v[92:95], v246 offset:43008
    ds_read_b128 v[60:63], v246 offset:61440
    ds_read_b128 v[64:67], v246 offset:62464
    ds_read_b128 v[96:99], v246 offset:63488
    ds_read_u16 v224, v238 offset:0
    ds_read_u16 v225, v238 offset:8
    ds_read_u16 v226, v238 offset:64
    ds_read_u16 v227, v238 offset:72
    s_cmp_eq_u32 s94, 0
    s_cbranch_scc1 L_skip2
    s_bitcmp0_b64 s[56:57], 2
    s_cbranch_scc1 L_noadve2
    s_add_u32 s20, s20, s31
    s_addc_u32 s21, s21, 0
    s_xor_b32 s31, s31, 0x63ff800
L_noadve2:
    s_add_u32 m0, s52, 4160
    v_mov_b32 v230, v152
    v_mov_b32 v232, v153
    buffer_load_dwordx4 v[230:231], s[20:23], 0 idxen offen nt lds
    s_add_u32 m0, s52, 5216
    s_nop 0
    buffer_load_dwordx4 v[232:233], s[20:23], 0 idxen offen nt lds
    s_bitcmp0_b64 s[56:57], 3
    s_cbranch_scc1 L_noadve3
    s_add_u32 s20, s20, s31
    s_addc_u32 s21, s21, 0
    s_xor_b32 s31, s31, 0x63ff800
L_noadve3:
    s_add_u32 m0, s52, 6240
    v_mov_b32 v230, v154
    v_mov_b32 v232, v155
    buffer_load_dwordx4 v[230:231], s[20:23], 0 idxen offen nt lds
    s_add_u32 m0, s52, 7296
    s_nop 0
    buffer_load_dwordx4 v[232:233], s[20:23], 0 idxen offen nt lds
L_skip2:
    s_waitcnt vmcnt(8)
    s_mov_b64 exec, s[28:29]
    v_cmp_neq_f16_sdwa s[68:69], v104, 0 src0_sel:WORD_0 src1_sel:WORD_0
    v_cmp_neq_f16_sdwa s[70:71], v104, 0 src0_sel:WORD_1 src1_sel:WORD_0
    v_cmp_neq_f16_sdwa s[72:73], v105, 0 src0_sel:WORD_0 src1_sel:WORD_0
    v_cmp_neq_f16_sdwa s[74:75], v105, 0 src0_sel:WORD_1 src1_sel:WORD_0
    v_cmp_neq_f16_sdwa s[76:77], v106, 0 src0_sel:WORD_0 src1_sel:WORD_0
    v_cmp_neq_f16_sdwa s[78:79], v106, 0 src0_sel:WORD_1 src1_sel:WORD_0
    v_cmp_neq_f16_sdwa s[80:81], v107, 0 src0_sel:WORD_0 src1_sel:WORD_0
    v_cmp_neq_f16_sdwa s[82:83], v107, 0 src0_sel:WORD_1 src1_sel:WORD_0
    v_sad_u16 v147, v104, 0, v147
    v_sad_u16 v147, v105, 0, v147
    v_sad_u16 v147, v106, 0, v147
    v_sad_u16 v147, v107, 0, v147
    v_or3_b32 v146, v104, v105, v146
    v_or3_b32 v146, v106, v107, v146
    s_mov_b64 exec, -1
    v_mov_b32 v132, s64
    v_mbcnt_lo_u32_b32 v132, s68, v132
    v_mbcnt_hi_u32_b32 v132, s69, v132
    v_mbcnt_lo_u32_b32 v132, s70, v132
    v_mbcnt_hi_u32_b32 v132, s71, v132
    v_mbcnt_lo_u32_b32 v132, s72, v132
    v_mbcnt_hi_u32_b32 v132, s73, v132
    v_mbcnt_lo_u32_b32 v132, s74, v132
    v_mbcnt_hi_u32_b32 v132, s75, v132
    v_mbcnt_lo_u32_b32 v132, s76, v132
    v_mbcnt_hi_u32_b32 v132, s77, v132
    v_mbcnt_lo_u32_b32 v132, s78, v132
    v_mbcnt_hi_u32_b32 v132, s79, v132
    v_mbcnt_lo_u32_b32 v132, s80, v132
    v_mbcnt_hi_u32_b32 v132, s81, v132
    v_mbcnt_lo_u32_b32 v132, s82, v132
    v_mbcnt_hi_u32_b32 v132, s83, v132
    s_add_u32 s34, s64, 16
    v_readlane_b32 s66, v132, 25
    v_readlane_b32 s67, v132, 63
    s_add_u32 s64, s66, 15
    s_and_b32 s64, s64, -16
    s_max_u32 s64, s64, s34
    s_sub_u32 s66, s64, s66
    v_mad_u32_u24 v132, v145, s66, v132
    s_lshr_b32 s35, s64, 4
    s_bitset1_b64 s[56:57], s35
    v_addc_co_u32 v133, vcc, 0, v132, s[68:69]
    v_addc_co_u32 v134, vcc, 0, v133, s[70:71]
    v_addc_co_u32 v135, vcc, 0, v134, s[72:73]
    v_addc_co_u32 v136, vcc, 0, v135, s[74:75]
    v_addc_co_u32 v137, vcc, 0, v136, s[76:77]
    v_addc_co_u32 v138, vcc, 0, v137, s[78:79]
    v_addc_co_u32 v139, vcc, 0, v138, s[80:81]
    v_addc_co_u32 v140, vcc, 0, v139, s[82:83]
    s_add_u32 s67, s67, s66
    s_add_u32 s67, s67, 15
    s_and_b32 s67, s67, -16
    s_add_u32 s64, s64, 16
    s_max_u32 s64, s64, s67
    s_mov_b64 exec, s[68:69]
    ds_write_b8 v132, v141
    s_mov_b64 exec, s[70:71]
    ds_write_b8_d16_hi v133, v141
    s_mov_b64 exec, s[72:73]
    ds_write_b8 v134, v142
    s_mov_b64 exec, s[74:75]
    ds_write_b8_d16_hi v135, v142
    s_mov_b64 exec, s[76:77]
    ds_write_b8 v136, v143
    s_mov_b64 exec, s[78:79]
    ds_write_b8_d16_hi v137, v143
    s_mov_b64 exec, s[80:81]
    ds_write_b8 v138, v144
    s_mov_b64 exec, s[82:83]
    ds_write_b8_d16_hi v139, v144
    s_mov_b64 exec, -1
    v_sub_u32 v140, v132, v140
    s_movk_i32 s66, 0x3f80
    v_mad_i32_i24 v147, v140, s66, v147
    s_lshr_b32 s35, s64, 4
    s_bitset1_b64 s[56:57], s35
    s_mov_b64 exec, s[28:29]
    v_cmp_neq_f16_sdwa s[68:69], v108, 0 src0_sel:WORD_0 src1_sel:WORD_0
    v_cmp_neq_f16_sdwa s[70:71], v108, 0 src0_sel:WORD_1 src1_sel:WORD_0
    v_cmp_neq_f16_sdwa s[72:73], v109, 0 src0_sel:WORD_0 src1_sel:WORD_0
    v_cmp_neq_f16_sdwa s[74:75], v109, 0 src0_sel:WORD_1 src1_sel:WORD_0
    v_cmp_neq_f16_sdwa s[76:77], v110, 0 src0_sel:WORD_0 src1_sel:WORD_0
    v_cmp_neq_f16_sdwa s[78:79], v110, 0 src0_sel:WORD_1 src1_sel:WORD_0
    v_cmp_neq_f16_sdwa s[80:81], v111, 0 src0_sel:WORD_0 src1_sel:WORD_0
    v_cmp_neq_f16_sdwa s[82:83], v111, 0 src0_sel:WORD_1 src1_sel:WORD_0
    v_sad_u16 v147, v108, 0, v147
    v_sad_u16 v147, v109, 0, v147
    v_sad_u16 v147, v110, 0, v147
    v_sad_u16 v147, v111, 0, v147
    v_or3_b32 v146, v108, v109, v146
    v_or3_b32 v146, v110, v111, v146
    s_mov_b64 exec, -1
    v_mov_b32 v132, s64
    v_mbcnt_lo_u32_b32 v132, s68, v132
    v_mbcnt_hi_u32_b32 v132, s69, v132
    v_mbcnt_lo_u32_b32 v132, s70, v132
    v_mbcnt_hi_u32_b32 v132, s71, v132
    v_mbcnt_lo_u32_b32 v132, s72, v132
    v_mbcnt_hi_u32_b32 v132, s73, v132
    v_mbcnt_lo_u32_b32 v132, s74, v132
    v_mbcnt_hi_u32_b32 v132, s75, v132
    v_mbcnt_lo_u32_b32 v132, s76, v132
    v_mbcnt_hi_u32_b32 v132, s77, v132
    v_mbcnt_lo_u32_b32 v132, s78, v132
    v_mbcnt_hi_u32_b32 v132, s79, v132
    v_mbcnt_lo_u32_b32 v132, s80, v132
    v_mbcnt_hi_u32_b32 v132, s81, v132
    v_mbcnt_lo_u32_b32 v132, s82, v132
    v_mbcnt_hi_u32_b32 v132, s83, v132
    s_add_u32 s34, s64, 16
    v_readlane_b32 s66, v132, 25
    v_readlane_b32 s67, v132, 63
    s_add_u32 s64, s66, 15
    s_and_b32 s64, s64, -16
    s_max_u32 s64, s64, s34
    s_sub_u32 s66, s64, s66
    v_mad_u32_u24 v132, v145, s66, v132
    s_lshr_b32 s35, s64, 4
    s_lshl_b64 s[86:87], 1, s35
    s_bitcmp1_b32 s64, 10
    s_cselect_b64 s[88:89], 0, s[86:87]
    s_cselect_b64 s[90:91], s[86:87], 0
    s_or_b64 s[56:57], s[56:57], s[88:89]
    s_or_b64 s[58:59], s[58:59], s[90:91]
    v_addc_co_u32 v133, vcc, 0, v132, s[68:69]
    v_addc_co_u32 v134, vcc, 0, v133, s[70:71]
    v_addc_co_u32 v135, vcc, 0, v134, s[72:73]
    v_addc_co_u32 v136, vcc, 0, v135, s[74:75]
    v_addc_co_u32 v137, vcc, 0, v136, s[76:77]
    v_addc_co_u32 v138, vcc, 0, v137, s[78:79]
    v_addc_co_u32 v139, vcc, 0, v138, s[80:81]
    v_addc_co_u32 v140, vcc, 0, v139, s[82:83]
    s_add_u32 s67, s67, s66
    s_add_u32 s67, s67, 15
    s_and_b32 s67, s67, -16
    s_add_u32 s64, s64, 16
    s_max_u32 s64, s64, s67
    s_mov_b64 exec, s[68:69]
    ds_write_b8 v132, v141
    s_mov_b64 exec, s[70:71]
    ds_write_b8_d16_hi v133, v141
    s_mov_b64 exec, s[72:73]
    ds_write_b8 v134, v142
    s_mov_b64 exec, s[74:75]
    ds_write_b8_d16_hi v135, v142
    s_mov_b64 exec, s[76:77]
    ds_write_b8 v136, v143
    s_mov_b64 exec, s[78:79]
    ds_write_b8_d16_hi v137, v143
    s_mov_b64 exec, s[80:81]
    ds_write_b8 v138, v144
    s_mov_b64 exec, s[82:83]
    ds_write_b8_d16_hi v139, v144
    s_mov_b64 exec, -1
    v_sub_u32 v140, v132, v140
    s_movk_i32 s66, 0x3f80
    v_mad_i32_i24 v147, v140, s66, v147
    s_lshr_b32 s35, s64, 4
    s_lshl_b64 s[86:87], 1, s35
    s_bitcmp1_b32 s64, 10
    s_cselect_b64 s[88:89], 0, s[86:87]
    s_cselect_b64 s[90:91], s[86:87], 0
    s_or_b64 s[56:57], s[56:57], s[88:89]
    s_or_b64 s[58:59], s[58:59], s[90:91]
    s_mov_b64 exec, s[28:29]
    v_cmp_neq_f16_sdwa s[68:69], v112, 0 src0_sel:WORD_0 src1_sel:WORD_0
    v_cmp_neq_f16_sdwa s[70:71], v112, 0 src0_sel:WORD_1 src1_sel:WORD_0
    v_cmp_neq_f16_sdwa s[72:73], v113, 0 src0_sel:WORD_0 src1_sel:WORD_0
    v_cmp_neq_f16_sdwa s[74:75], v113, 0 src0_sel:WORD_1 src1_sel:WORD_0
    v_cmp_neq_f16_sdwa s[76:77], v114, 0 src0_sel:WORD_0 src1_sel:WORD_0
    v_cmp_neq_f16_sdwa s[78:79], v114, 0 src0_sel:WORD_1 src1_sel:WORD_0
    v_cmp_neq_f16_sdwa s[80:81], v115, 0 src0_sel:WORD_0 src1_sel:WORD_0
    v_cmp_neq_f16_sdwa s[82:83], v115, 0 src0_sel:WORD_1 src1_sel:WORD_0
    v_sad_u16 v147, v112, 0, v147
    v_sad_u16 v147, v113, 0, v147
    v_sad_u16 v147, v114, 0, v147
    v_sad_u16 v147, v115, 0, v147
    v_or3_b32 v146, v112, v113, v146
    v_or3_b32 v146, v114, v115, v146
    s_mov_b64 exec, -1
    v_mov_b32 v132, s64
    v_mbcnt_lo_u32_b32 v132, s68, v132
    v_mbcnt_hi_u32_b32 v132, s69, v132
    v_mbcnt_lo_u32_b32 v132, s70, v132
    v_mbcnt_hi_u32_b32 v132, s71, v132
    v_mbcnt_lo_u32_b32 v132, s72, v132
    v_mbcnt_hi_u32_b32 v132, s73, v132
    v_mbcnt_lo_u32_b32 v132, s74, v132
    v_mbcnt_hi_u32_b32 v132, s75, v132
    v_mbcnt_lo_u32_b32 v132, s76, v132
    v_mbcnt_hi_u32_b32 v132, s77, v132
    v_mbcnt_lo_u32_b32 v132, s78, v132
    v_mbcnt_hi_u32_b32 v132, s79, v132
    v_mbcnt_lo_u32_b32 v132, s80, v132
    v_mbcnt_hi_u32_b32 v132, s81, v132
    v_mbcnt_lo_u32_b32 v132, s82, v132
    v_mbcnt_hi_u32_b32 v132, s83, v132
    s_add_u32 s34, s64, 16
    v_readlane_b32 s66, v132, 25
    v_readlane_b32 s67, v132, 63
    s_add_u32 s64, s66, 15
    s_and_b32 s64, s64, -16
    s_max_u32 s64, s64, s34
    s_sub_u32 s66, s64, s66
    v_mad_u32_u24 v132, v145, s66, v132
    s_lshr_b32 s35, s64, 4
    s_lshl_b64 s[86:87], 1, s35
    s_bitcmp1_b32 s64, 10
    s_cselect_b64 s[88:89], 0, s[86:87]
    s_cselect_b64 s[90:91], s[86:87], 0
    s_or_b64 s[56:57], s[56:57], s[88:89]
    s_or_b64 s[58:59], s[58:59], s[90:91]
    v_addc_co_u32 v133, vcc, 0, v132, s[68:69]
    v_addc_co_u32 v134, vcc, 0, v133, s[70:71]
    v_addc_co_u32 v135, vcc, 0, v134, s[72:73]
    v_addc_co_u32 v136, vcc, 0, v135, s[74:75]
    v_addc_co_u32 v137, vcc, 0, v136, s[76:77]
    v_addc_co_u32 v138, vcc, 0, v137, s[78:79]
    v_addc_co_u32 v139, vcc, 0, v138, s[80:81]
    v_addc_co_u32 v140, vcc, 0, v139, s[82:83]
    s_add_u32 s67, s67, s66
    s_add_u32 s67, s67, 15
    s_and_b32 s67, s67, -16
    s_add_u32 s64, s64, 16
    s_max_u32 s64, s64, s67
    s_mov_b64 exec, s[68:69]
    ds_write_b8 v132, v141
    s_mov_b64 exec, s[70:71]
    ds_write_b8_d16_hi v133, v141
    s_mov_b64 exec, s[72:73]
    ds_write_b8 v134, v142
    s_mov_b64 exec, s[74:75]
    ds_write_b8_d16_hi v135, v142
    s_mov_b64 exec, s[76:77]
    ds_write_b8 v136, v143
    s_mov_b64 exec, s[78:79]
    ds_write_b8_d16_hi v137, v143
    s_mov_b64 exec, s[80:81]
    ds_write_b8 v138, v144
    s_mov_b64 exec, s[82:83]
    ds_write_b8_d16_hi v139, v144
    s_mov_b64 exec, -1
    v_sub_u32 v140, v132, v140
    s_movk_i32 s66, 0x3f80
    s_mov_b64 s[60:61], s[56:57]
    s_mov_b64 s[62:63], s[58:59]
    v_mad_i32_i24 v147, v140, s66, v147
    s_lshr_b32 s35, s64, 4
    s_lshl_b64 s[86:87], 1, s35
    s_bitcmp1_b32 s64, 10
    s_cselect_b64 s[88:89], 0, s[86:87]
    s_cselect_b64 s[90:91], s[86:87], 0
    s_or_b64 s[56:57], s[56:57], s[88:89]
    s_or_b64 s[58:59], s[58:59], s[90:91]
    s_mov_b32 s66, 0xc07fc07f
    v_and_or_b32 v146, v146, s66, v147
    v_cmp_ne_u32 s[84:85], 0, v146
    s_sub_u32 s66, s64, s52
    s_sub_u32 s66, s66, 18432
    s_lshr_b32 s66, s66, 3
    s_xor_b32 s66, s66, s33
    s_sub_u32 s66, s66, s33
    s_xor_b32 s67, 0xfffffffc, s33
    s_sub_u32 s67, s67, s33
    v_mov_b32 v2, v221
    v_mov_b32 v1, s66
    v_mov_b32 v3, s67
    s_mov_b64 exec, 1
    ds_add_u32 v2, v1
    s_mov_b64 exec, -1
    s_cmp_eq_u32 s94, 1
    s_cbranch_scc1 L_nolate
    ds_read_u8 v148, v237 offset:0
    ds_read_u8 v149, v237 offset:8
    ds_read_u8 v150, v237 offset:16
    ds_read_u8 v151, v237 offset:24
    ds_read_u8 v152, v237 offset:32
    ds_read_u8 v153, v237 offset:40
    ds_read_u8 v154, v237 offset:48
    ds_read_u8 v155, v237 offset:56
    s_waitcnt lgkmcnt(0)
    s_add_u32 m0, s52, 0
    v_mov_b32 v230, v148
    v_mov_b32 v232, v149
    buffer_load_dwordx4 v[230:231], s[20:23], 0 idxen offen nt lds
    s_add_u32 m0, s52, 1056
    s_nop 0
    buffer_load_dwordx4 v[232:233], s[20:23], 0 idxen offen nt lds
    s_bitcmp0_b64 s[60:61], 1
    s_cbranch_scc1 L_noadvl1
    s_add_u32 s20, s20, s31
    s_addc_u32 s21, s21, 0
    s_xor_b32 s31, s31, 0x63ff800
L_noadvl1:
    s_add_u32 m0, s52, 2080
    v_mov_b32 v230, v150
    v_mov_b32 v232, v151
    buffer_load_dwordx4 v[230:231], s[20:23], 0 idxen offen nt lds
    s_add_u32 m0, s52, 3136
    s_nop 0
    buffer_load_dwordx4 v[232:233], s[20:23], 0 idxen offen nt lds
    s_bitcmp0_b64 s[60:61], 2
    s_cbranch_scc1 L_noadvl2
    s_add_u32 s20, s20, s31
    s_addc_u32 s21, s21, 0
    s_xor_b32 s31, s31, 0x63ff800
L_noadvl2:
    s_add_u32 m0, s52, 4160
    v_mov_b32 v230, v152
    v_mov_b32 v232, v153
    buffer_load_dwordx4 v[230:231], s[20:23], 0 idxen offen nt lds
    s_add_u32 m0, s52, 5216
    s_nop 0
    buffer_load_dwordx4 v[232:233], s[20:23], 0 idxen offen nt lds
    s_bitcmp0_b64 s[60:61], 3
    s_cbranch_scc1 L_noadvl3
    s_add_u32 s20, s20, s31
    s_addc_u32 s21, s21, 0
    s_xor_b32 s31, s31, 0x63ff800
L_noadvl3:
    s_add_u32 m0, s52, 6240
    v_mov_b32 v230, v154
    v_mov_b32 v232, v155
    buffer_load_dwordx4 v[230:231], s[20:23], 0 idxen offen nt lds
    s_add_u32 m0, s52, 7296
    s_nop 0
    buffer_load_dwordx4 v[232:233], s[20:23], 0 idxen offen nt lds
L_nolate:
    v_and_b32_dpp v196, v216, v220 quad_perm:[0,0,0,0] row_mask:0xf bank_mask:0xf
    v_and_b32_dpp v197, v217, v220 quad_perm:[0,0,0,0] row_mask:0xf bank_mask:0xf
    v_and_b32_dpp v198, v216, v220 quad_perm:[1,1,1,1] row_mask:0xf bank_mask:0xf
    v_and_b32_dpp v199, v217, v220 quad_perm:[1,1,1,1] row_mask:0xf bank_mask:0xf
    v_and_b32_dpp v200, v216, v220 quad_perm:[2,2,2,2] row_mask:0xf bank_mask:0xf
    v_and_b32_dpp v201, v217, v220 quad_perm:[2,2,2,2] row_mask:0xf bank_mask:0xf
    v_and_b32_dpp v202, v216, v220 quad_perm:[3,3,3,3] row_mask:0xf bank_mask:0xf
    v_and_b32_dpp v203, v217, v220 quad_perm:[3,3,3,3] row_mask:0xf bank_mask:0xf
    s_lshl_b32 s30, s30, 16
    v_and_b32 v204, s30, v220
    v_and_b32 v205, s30, v220
    v_and_b32 v206, s30, v220
    v_and_b32 v207, s30, v220
    s_waitcnt lgkmcnt(0)
    v_mul_u32_u24 v216, v224, v241
    v_mul_u32_u24 v217, v224, v242
    v_mul_u32_u24 v218, v225, v241
    v_mul_u32_u24 v219, v225, v242
    v_mul_u32_u24 v220, v226, v241
    v_mul_u32_u24 v221, v226, v242
    v_mul_u32_u24 v222, v227, v241
    v_mul_u32_u24 v223, v227, v242
    v_add_u32 v238, 128, v238
    ds_read_b128 v[164:167], v239
    v_mfma_f32_4x4x4_16b_bf16 v[132:135], v[216:217], v[68:69], v[4:7]
    ds_read_b128 v[168:171], v239 offset:64
    ds_read_b128 v[172:175], v239 offset:128
    v_mfma_f32_4x4x4_16b_bf16 v[136:139], v[218:219], v[70:71], v[8:11]
    ds_read_b128 v[176:179], v239 offset:192
    ds_read_u16 v224, v238
    v_mfma_f32_4x4x4_16b_bf16 v[140:143], v[220:221], v[72:73], v[12:15]
    ds_read_u16 v225, v238 offset:8
    ds_read_u16 v226, v238 offset:64
    v_mfma_f32_4x4x4_16b_bf16 v[144:147], v[222:223], v[74:75], v[16:19]
    ds_read_u16 v227, v238 offset:72
    v_add_u32 v239, 256, v239
    v_mfma_f32_4x4x4_16b_bf16 v[246:249], v[216:217], v[76:77], v[20:23]
    v_cvt_pk_bf16_f32 v100, v132, v133
    v_cvt_pk_bf16_f32 v101, v134, v135
    v_mfma_f32_4x4x4_16b_bf16 v[250:253], v[218:219], v[78:79], v[24:27]
    v_cvt_pk_bf16_f32 v102, v136, v137
    v_cvt_pk_bf16_f32 v103, v138, v139
    v_mfma_f32_4x4x4_16b_bf16 v[132:135], v[220:221], v[80:81], v[28:31]
    v_cvt_pk_bf16_f32 v104, v140, v141
    v_cvt_pk_bf16_f32 v105, v142, v143
    v_mfma_f32_4x4x4_16b_bf16 v[136:139], v[222:223], v[82:83], v[32:35]
    v_cvt_pk_bf16_f32 v106, v144, v145
    v_cvt_pk_bf16_f32 v107, v146, v147
    v_mfma_f32_4x4x4_16b_bf16 v[140:143], v[216:217], v[84:85], v[36:39]
    v_cvt_pk_bf16_f32 v108, v246, v247
    v_cvt_pk_bf16_f32 v109, v248, v249
    v_mfma_f32_4x4x4_16b_bf16 v[144:147], v[218:219], v[86:87], v[40:43]
    v_cvt_pk_bf16_f32 v110, v250, v251
    v_cvt_pk_bf16_f32 v111, v252, v253
    v_mfma_f32_4x4x4_16b_bf16 v[246:249], v[220:221], v[88:89], v[44:47]
    v_cvt_pk_bf16_f32 v112, v132, v133
    v_cvt_pk_bf16_f32 v113, v134, v135
    v_mfma_f32_4x4x4_16b_bf16 v[250:253], v[222:223], v[90:91], v[48:51]
    v_cvt_pk_bf16_f32 v114, v136, v137
    v_cvt_pk_bf16_f32 v115, v138, v139
    v_mfma_f32_4x4x4_16b_bf16 v[132:135], v[216:217], v[92:93], v[52:55]
    v_cvt_pk_bf16_f32 v116, v140, v141
    v_cvt_pk_bf16_f32 v117, v142, v143
    v_mfma_f32_4x4x4_16b_bf16 v[136:139], v[218:219], v[94:95], v[56:59]
    v_cvt_pk_bf16_f32 v118, v144, v145
    v_cvt_pk_bf16_f32 v119, v146, v147
    v_mfma_f32_4x4x4_16b_bf16 v[140:143], v[220:221], v[96:97], v[60:63]
    v_cvt_pk_bf16_f32 v120, v246, v247
    v_cvt_pk_bf16_f32 v121, v248, v249
    v_mfma_f32_4x4x4_16b_bf16 v[144:147], v[222:223], v[98:99], v[64:67]
    v_cvt_pk_bf16_f32 v122, v250, v251
    v_cvt_pk_bf16_f32 v123, v252, v253
    v_cvt_pk_bf16_f32 v124, v132, v133
    v_cvt_pk_bf16_f32 v125, v134, v135
    v_cvt_pk_bf16_f32 v126, v136, v137
    v_cvt_pk_bf16_f32 v127, v138, v139
    v_cvt_pk_bf16_f32 v128, v140, v141
    v_cvt_pk_bf16_f32 v129, v142, v143
    v_cvt_pk_bf16_f32 v130, v144, v145
    v_cvt_pk_bf16_f32 v131, v146, v147
    s_waitcnt lgkmcnt(0)
    v_mov_b32 v188, 0
    v_mov_b32 v189, 0
    v_mov_b32 v190, 0
    v_mov_b32 v191, 0
    v_mov_b32 v192, 0
    v_mov_b32 v193, 0
    v_mov_b32 v194, 0
    v_mov_b32 v195, 0
    v_mov_b32 v208, 0
    v_mov_b32 v212, 0
    v_mov_b32 v209, 0
    v_mov_b32 v213, 0
    v_mov_b32 v210, 0
    v_mov_b32 v214, 0
    v_mov_b32 v211, 0
    v_mov_b32 v215, 0
    s_waitcnt vmcnt(6)
    ds_read_b128 v[180:183], v234 offset:0
    ds_read_b128 v[184:187], v235 offset:0
    s_waitcnt lgkmcnt(0)
    v_mfma_f32_16x16x32_bf16 v[148:151], v[100:103], v[180:183], v[164:167]
    v_mfma_f32_16x16x32_bf16 v[148:151], v[104:107], v[184:187], v[148:151]
    v_mfma_f32_16x16x32_bf16 v[152:155], v[108:111], v[180:183], v[168:171]
    v_mfma_f32_16x16x32_bf16 v[152:155], v[112:115], v[184:187], v[152:155]
    v_mfma_f32_16x16x32_bf16 v[156:159], v[116:119], v[180:183], v[172:175]
    v_mfma_f32_16x16x32_bf16 v[156:159], v[120:123], v[184:187], v[156:159]
    v_mfma_f32_16x16x32_bf16 v[160:163], v[124:127], v[180:183], v[176:179]
    v_mfma_f32_16x16x32_bf16 v[160:163], v[128:131], v[184:187], v[160:163]
    s_waitcnt vmcnt(4)
    ds_read_b128 v[180:183], v234 offset:2080
    ds_read_b128 v[184:187], v235 offset:2080
    ds_read_u8 v230, v237 offset:64
    ds_read_u8 v232, v237 offset:72
    s_cmp_lg_u64 s[84:85], 0
    s_cbranch_scc0 Lf_mid
    s_mul_i32 s66, s53, 800
    s_add_u32 s8, s8, s66
    s_addc_u32 s9, s9, 0
    s_mov_b32 s24, s8
    s_and_b32 s25, s9, 0xffff
    s_mov_b32 s26, 400
    s_mov_b32 s27, 0x20000
    s_movk_i32 s32, 400
    s_branch Ls_mid
Lf_loop:
    ds_read_u8 v230, v237 offset:64
    ds_read_u8 v232, v237 offset:72
    v_mfma_f32_16x16x32_bf16 v[208:211], v[136:139], v[200:203], v[208:211]
Lf_mid:
    s_bitcmp1_b64 s[60:61], 1
    s_cbranch_scc1 Lf_wb0
Lf_wbd0:
    s_mov_b64 exec, 1
    ds_add_rtn_u32 v1, v2, v3
    s_mov_b64 exec, -1
    v_exp_f32 v132, v148
    v_exp_f32 v133, v149
    v_exp_f32 v134, v150
    v_exp_f32 v135, v151
    v_exp_f32 v136, v152
    v_exp_f32 v137, v153
    v_mfma_f32_4x4x4_16b_bf16 v[132:135], v[228:229], v[228:229], v[132:135]
    v_cvt_pk_bf16_f32 v208, v208, v209
    v_cvt_pk_bf16_f32 v209, v210, v211
    s_waitcnt lgkmcnt(2)
    v_mfma_f32_16x16x32_bf16 v[148:151], v[100:103], v[180:183], v[164:167]
    v_exp_f32 v138, v154
    v_mfma_f32_4x4x4_16b_bf16 v[212:215], v[208:209], v[188:189], v[212:215] cbsz:4 abid:0
    ds_read_b64_tr_b16 v[188:189], v236 offset:0
    v_exp_f32 v139, v155
    v_mfma_f32_16x16x32_bf16 v[152:155], v[108:111], v[180:183], v[168:171]
    v_exp_f32 v140, v156
    v_mfma_f32_4x4x4_16b_bf16 v[212:215], v[208:209], v[190:191], v[212:215] cbsz:4 abid:4
    ds_read_b64_tr_b16 v[190:191], v236 offset:512
    v_mfma_f32_4x4x4_16b_bf16 v[136:139], v[228:229], v[228:229], v[136:139]
    v_rcp_f32 v132, v132
    v_mfma_f32_4x4x4_16b_bf16 v[212:215], v[208:209], v[192:193], v[212:215] cbsz:4 abid:8
    ds_read_b64_tr_b16 v[192:193], v236 offset:1056
    v_exp_f32 v141, v157
    v_mfma_f32_16x16x32_bf16 v[148:151], v[104:107], v[184:187], v[148:151]
    v_rcp_f32 v133, v133
    v_mfma_f32_4x4x4_16b_bf16 v[212:215], v[208:209], v[194:195], v[212:215] cbsz:4 abid:12
    ds_read_b64_tr_b16 v[194:195], v236 offset:1568
    v_exp_f32 v142, v158
    v_mfma_f32_16x16x32_bf16 v[152:155], v[112:115], v[184:187], v[152:155]
    v_rcp_f32 v134, v134
    v_exp_f32 v143, v159
    v_rcp_f32 v135, v135
    v_cvt_pk_bf16_f32 v132, v132, v133
    v_mfma_f32_4x4x4_16b_bf16 v[140:143], v[228:229], v[228:229], v[140:143]
    v_exp_f32 v144, v160
    v_mfma_f32_16x16x32_bf16 v[156:159], v[116:119], v[180:183], v[172:175]
    v_rcp_f32 v136, v136
    v_cvt_pk_bf16_f32 v133, v134, v135
    s_bitcmp1_b64 s[56:57], 0
    s_cbranch_scc1 Lf_flush0
Lf_flushed0:
    v_exp_f32 v145, v161
    v_rcp_f32 v137, v137
    v_exp_f32 v146, v162
    s_bitcmp1_b64 s[60:61], 4
    s_cbranch_scc1 Lf_adv0
Lf_advd0:
    v_rcp_f32 v138, v138
    v_cvt_pk_bf16_f32 v134, v136, v137
    v_exp_f32 v147, v163
    v_mfma_f32_16x16x32_bf16 v[160:163], v[124:127], v[180:183], v[176:179]
    s_waitcnt lgkmcnt(0)
    s_add_u32 m0, s52, 0
    v_rcp_f32 v139, v139
    buffer_load_dwordx4 v[230:231], s[20:23], 0 idxen offen nt lds
    v_mfma_f32_4x4x4_16b_bf16 v[144:147], v[228:229], v[228:229], v[144:147]
    v_mfma_f32_16x16x32_bf16 v[156:159], v[120:123], v[184:187], v[156:159]
    s_add_u32 m0, s52, 1056
    v_rcp_f32 v140, v140
    buffer_load_dwordx4 v[232:233], s[20:23], 0 idxen offen nt lds
    v_mfma_f32_16x16x32_bf16 v[160:163], v[128:131], v[184:187], v[160:163]
    v_readfirstlane_b32 s66, v1
    s_nop 0
    s_xor_b32 s66, s66, s33
    s_cmp_gt_i32 s66, 0
    s_setprio 0
    s_cbranch_scc0 Lf_lo0
    s_setprio 1
Lf_lo0:
    v_rcp_f32 v141, v141
    v_cvt_pk_bf16_f32 v135, v138, v139
    s_waitcnt vmcnt(4)
    ds_read_b128 v[180:183], v234 offset:4160
    ds_read_b128 v[184:187], v235 offset:4160
    v_rcp_f32 v142, v142
    v_cvt_pk_bf16_f32 v136, v140, v141
    v_mfma_f32_16x16x32_bf16 v[208:211], v[132:135], v[196:199], v[204:207]
    v_rcp_f32 v143, v143
    v_rcp_f32 v144, v144
    v_cvt_pk_bf16_f32 v137, v142, v143
    v_rcp_f32 v145, v145
    v_rcp_f32 v146, v146
    v_rcp_f32 v147, v147
    v_cvt_pk_bf16_f32 v138, v144, v145
    v_cvt_pk_bf16_f32 v139, v146, v147
    ds_read_u8 v230, v237 offset:80
    ds_read_u8 v232, v237 offset:88
    v_mfma_f32_16x16x32_bf16 v[208:211], v[136:139], v[200:203], v[208:211]
    s_bitcmp1_b64 s[60:61], 2
    s_cbranch_scc1 Lf_wb1
Lf_wbd1:
    v_exp_f32 v132, v148
    v_exp_f32 v133, v149
    v_exp_f32 v134, v150
    v_exp_f32 v135, v151
    v_exp_f32 v136, v152
    v_exp_f32 v137, v153
    v_mfma_f32_4x4x4_16b_bf16 v[132:135], v[228:229], v[228:229], v[132:135]
    v_cvt_pk_bf16_f32 v208, v208, v209
    v_cvt_pk_bf16_f32 v209, v210, v211
    s_waitcnt lgkmcnt(2)
    v_mfma_f32_16x16x32_bf16 v[148:151], v[100:103], v[180:183], v[164:167]
    v_exp_f32 v138, v154
    v_mfma_f32_4x4x4_16b_bf16 v[212:215], v[208:209], v[188:189], v[212:215] cbsz:4 abid:0
    ds_read_b64_tr_b16 v[188:189], v236 offset:2080
    v_exp_f32 v139, v155
    v_mfma_f32_16x16x32_bf16 v[152:155], v[108:111], v[180:183], v[168:171]
    v_exp_f32 v140, v156
    v_mfma_f32_4x4x4_16b_bf16 v[212:215], v[208:209], v[190:191], v[212:215] cbsz:4 abid:4
    ds_read_b64_tr_b16 v[190:191], v236 offset:2592
    v_mfma_f32_4x4x4_16b_bf16 v[136:139], v[228:229], v[228:229], v[136:139]
    v_rcp_f32 v132, v132
    v_mfma_f32_4x4x4_16b_bf16 v[212:215], v[208:209], v[192:193], v[212:215] cbsz:4 abid:8
    ds_read_b64_tr_b16 v[192:193], v236 offset:3136
    v_exp_f32 v141, v157
    v_mfma_f32_16x16x32_bf16 v[148:151], v[104:107], v[184:187], v[148:151]
    v_rcp_f32 v133, v133
    v_mfma_f32_4x4x4_16b_bf16 v[212:215], v[208:209], v[194:195], v[212:215] cbsz:4 abid:12
    ds_read_b64_tr_b16 v[194:195], v236 offset:3648
    v_exp_f32 v142, v158
    v_mfma_f32_16x16x32_bf16 v[152:155], v[112:115], v[184:187], v[152:155]
    v_rcp_f32 v134, v134
    v_exp_f32 v143, v159
    v_rcp_f32 v135, v135
    v_cvt_pk_bf16_f32 v132, v132, v133
    v_mfma_f32_4x4x4_16b_bf16 v[140:143], v[228:229], v[228:229], v[140:143]
    v_exp_f32 v144, v160
    v_mfma_f32_16x16x32_bf16 v[156:159], v[116:119], v[180:183], v[172:175]
    v_rcp_f32 v136, v136
    v_cvt_pk_bf16_f32 v133, v134, v135
    s_bitcmp1_b64 s[56:57], 1
    s_cbranch_scc1 Lf_flush1
Lf_flushed1:
    v_exp_f32 v145, v161
    v_rcp_f32 v137, v137
    v_exp_f32 v146, v162
    s_bitcmp1_b64 s[60:61], 5
    s_cbranch_scc1 Lf_adv1
Lf_advd1:
    v_rcp_f32 v138, v138
    v_cvt_pk_bf16_f32 v134, v136, v137
    v_exp_f32 v147, v163
    v_mfma_f32_16x16x32_bf16 v[160:163], v[124:127], v[180:183], v[176:179]
    s_waitcnt lgkmcnt(0)
    s_add_u32 m0, s52, 2080
    v_rcp_f32 v139, v139
    buffer_load_dwordx4 v[230:231], s[20:23], 0 idxen offen nt lds
    v_mfma_f32_4x4x4_16b_bf16 v[144:147], v[228:229], v[228:229], v[144:147]
    v_mfma_f32_16x16x32_bf16 v[156:159], v[120:123], v[184:187], v[156:159]
    s_add_u32 m0, s52, 3136
    v_rcp_f32 v140, v140
    buffer_load_dwordx4 v[232:233], s[20:23], 0 idxen offen nt lds
    v_mfma_f32_16x16x32_bf16 v[160:163], v[128:131], v[184:187], v[160:163]
    v_rcp_f32 v141, v141
    v_cvt_pk_bf16_f32 v135, v138, v139
    s_waitcnt vmcnt(4)
    ds_read_b128 v[180:183], v234 offset:6240
    ds_read_b128 v[184:187], v235 offset:6240
    v_rcp_f32 v142, v142
    v_cvt_pk_bf16_f32 v136, v140, v141
    v_mfma_f32_16x16x32_bf16 v[208:211], v[132:135], v[196:199], v[204:207]
    v_rcp_f32 v143, v143
    v_rcp_f32 v144, v144
    v_cvt_pk_bf16_f32 v137, v142, v143
    v_rcp_f32 v145, v145
    v_rcp_f32 v146, v146
    v_rcp_f32 v147, v147
    v_cvt_pk_bf16_f32 v138, v144, v145
    v_cvt_pk_bf16_f32 v139, v146, v147
    ds_read_u8 v230, v237 offset:96
    ds_read_u8 v232, v237 offset:104
    v_mfma_f32_16x16x32_bf16 v[208:211], v[136:139], v[200:203], v[208:211]
    s_bitcmp1_b64 s[60:61], 3
    s_cbranch_scc1 Lf_wb2
Lf_wbd2:
    s_mov_b64 exec, 1
    ds_add_rtn_u32 v1, v2, v3
    s_mov_b64 exec, -1
    v_exp_f32 v132, v148
    v_exp_f32 v133, v149
    v_exp_f32 v134, v150
    v_exp_f32 v135, v151
    v_exp_f32 v136, v152
    v_exp_f32 v137, v153
    v_mfma_f32_4x4x4_16b_bf16 v[132:135], v[228:229], v[228:229], v[132:135]
    v_cvt_pk_bf16_f32 v208, v208, v209
    v_cvt_pk_bf16_f32 v209, v210, v211
    s_waitcnt lgkmcnt(2)
    v_mfma_f32_16x16x32_bf16 v[148:151], v[100:103], v[180:183], v[164:167]
    v_exp_f32 v138, v154
    v_mfma_f32_4x4x4_16b_bf16 v[212:215], v[208:209], v[188:189], v[212:215] cbsz:4 abid:0
    ds_read_b64_tr_b16 v[188:189], v236 offset:4160
    v_exp_f32 v139, v155
    v_mfma_f32_16x16x32_bf16 v[152:155], v[108:111], v[180:183], v[168:171]
    v_exp_f32 v140, v156
    v_mfma_f32_4x4x4_16b_bf16 v[212:215], v[208:209], v[190:191], v[212:215] cbsz:4 abid:4
    ds_read_b64_tr_b16 v[190:191], v236 offset:4672
    v_mfma_f32_4x4x4_16b_bf16 v[136:139], v[228:229], v[228:229], v[136:139]
    v_rcp_f32 v132, v132
    v_mfma_f32_4x4x4_16b_bf16 v[212:215], v[208:209], v[192:193], v[212:215] cbsz:4 abid:8
    ds_read_b64_tr_b16 v[192:193], v236 offset:5216
    v_exp_f32 v141, v157
    v_mfma_f32_16x16x32_bf16 v[148:151], v[104:107], v[184:187], v[148:151]
    v_rcp_f32 v133, v133
    v_mfma_f32_4x4x4_16b_bf16 v[212:215], v[208:209], v[194:195], v[212:215] cbsz:4 abid:12
    ds_read_b64_tr_b16 v[194:195], v236 offset:5728
    v_exp_f32 v142, v158
    v_mfma_f32_16x16x32_bf16 v[152:155], v[112:115], v[184:187], v[152:155]
    v_rcp_f32 v134, v134
    v_exp_f32 v143, v159
    v_rcp_f32 v135, v135
    v_cvt_pk_bf16_f32 v132, v132, v133
    v_mfma_f32_4x4x4_16b_bf16 v[140:143], v[228:229], v[228:229], v[140:143]
    v_exp_f32 v144, v160
    v_mfma_f32_16x16x32_bf16 v[156:159], v[116:119], v[180:183], v[172:175]
    v_rcp_f32 v136, v136
    v_cvt_pk_bf16_f32 v133, v134, v135
    s_bitcmp1_b64 s[56:57], 2
    s_cbranch_scc1 Lf_flush2
Lf_flushed2:
    v_exp_f32 v145, v161
    v_rcp_f32 v137, v137
    v_exp_f32 v146, v162
    s_bitcmp1_b64 s[60:61], 6
    s_cbranch_scc1 Lf_adv2
Lf_advd2:
    v_rcp_f32 v138, v138
    v_cvt_pk_bf16_f32 v134, v136, v137
    v_exp_f32 v147, v163
    v_mfma_f32_16x16x32_bf16 v[160:163], v[124:127], v[180:183], v[176:179]
    s_waitcnt lgkmcnt(0)
    s_add_u32 m0, s52, 4160
    v_rcp_f32 v139, v139
    buffer_load_dwordx4 v[230:231], s[20:23], 0 idxen offen nt lds
    v_mfma_f32_4x4x4_16b_bf16 v[144:147], v[228:229], v[228:229], v[144:147]
    v_mfma_f32_16x16x32_bf16 v[156:159], v[120:123], v[184:187], v[156:159]
    s_add_u32 m0, s52, 5216
    v_rcp_f32 v140, v140
    buffer_load_dwordx4 v[232:233], s[20:23], 0 idxen offen nt lds
    v_mfma_f32_16x16x32_bf16 v[160:163], v[128:131], v[184:187], v[160:163]
    v_readfirstlane_b32 s66, v1
    s_nop 0
    s_xor_b32 s66, s66, s33
    s_cmp_gt_i32 s66, 0
    s_setprio 0
    s_cbranch_scc0 Lf_lo2
    s_setprio 1
Lf_lo2:
    v_rcp_f32 v141, v141
    v_cvt_pk_bf16_f32 v135, v138, v139
    s_waitcnt vmcnt(4)
    ds_read_b128 v[180:183], v234 offset:0
    ds_read_b128 v[184:187], v235 offset:0
    v_rcp_f32 v142, v142
    v_cvt_pk_bf16_f32 v136, v140, v141
    v_mfma_f32_16x16x32_bf16 v[208:211], v[132:135], v[196:199], v[204:207]
    v_rcp_f32 v143, v143
    v_rcp_f32 v144, v144
    v_cvt_pk_bf16_f32 v137, v142, v143
    v_rcp_f32 v145, v145
    v_rcp_f32 v146, v146
    v_rcp_f32 v147, v147
    v_cvt_pk_bf16_f32 v138, v144, v145
    v_cvt_pk_bf16_f32 v139, v146, v147
    ds_read_u8 v230, v237 offset:112
    ds_read_u8 v232, v237 offset:120
    v_mfma_f32_16x16x32_bf16 v[208:211], v[136:139], v[200:203], v[208:211]
    s_bitcmp1_b64 s[60:61], 4
    s_cbranch_scc1 Lf_wb3
Lf_wbd3:
    v_exp_f32 v132, v148
    v_exp_f32 v133, v149
    v_exp_f32 v134, v150
    v_exp_f32 v135, v151
    v_exp_f32 v136, v152
    v_exp_f32 v137, v153
    v_mfma_f32_4x4x4_16b_bf16 v[132:135], v[228:229], v[228:229], v[132:135]
    v_cvt_pk_bf16_f32 v208, v208, v209
    v_cvt_pk_bf16_f32 v209, v210, v211
    s_waitcnt lgkmcnt(2)
    v_mfma_f32_16x16x32_bf16 v[148:151], v[100:103], v[180:183], v[164:167]
    v_exp_f32 v138, v154
    v_mfma_f32_4x4x4_16b_bf16 v[212:215], v[208:209], v[188:189], v[212:215] cbsz:4 abid:0
    ds_read_b64_tr_b16 v[188:189], v236 offset:6240
    v_exp_f32 v139, v155
    v_mfma_f32_16x16x32_bf16 v[152:155], v[108:111], v[180:183], v[168:171]
    v_exp_f32 v140, v156
    v_mfma_f32_4x4x4_16b_bf16 v[212:215], v[208:209], v[190:191], v[212:215] cbsz:4 abid:4
    ds_read_b64_tr_b16 v[190:191], v236 offset:6752
    v_mfma_f32_4x4x4_16b_bf16 v[136:139], v[228:229], v[228:229], v[136:139]
    v_rcp_f32 v132, v132
    v_mfma_f32_4x4x4_16b_bf16 v[212:215], v[208:209], v[192:193], v[212:215] cbsz:4 abid:8
    ds_read_b64_tr_b16 v[192:193], v236 offset:7296
    v_exp_f32 v141, v157
    v_mfma_f32_16x16x32_bf16 v[148:151], v[104:107], v[184:187], v[148:151]
    v_rcp_f32 v133, v133
    v_mfma_f32_4x4x4_16b_bf16 v[212:215], v[208:209], v[194:195], v[212:215] cbsz:4 abid:12
    ds_read_b64_tr_b16 v[194:195], v236 offset:7808
    v_exp_f32 v142, v158
    v_mfma_f32_16x16x32_bf16 v[152:155], v[112:115], v[184:187], v[152:155]
    v_rcp_f32 v134, v134
    v_exp_f32 v143, v159
    v_rcp_f32 v135, v135
    v_cvt_pk_bf16_f32 v132, v132, v133
    v_mfma_f32_4x4x4_16b_bf16 v[140:143], v[228:229], v[228:229], v[140:143]
    v_exp_f32 v144, v160
    v_mfma_f32_16x16x32_bf16 v[156:159], v[116:119], v[180:183], v[172:175]
    v_rcp_f32 v136, v136
    v_cvt_pk_bf16_f32 v133, v134, v135
    s_bitcmp1_b64 s[56:57], 3
    s_cbranch_scc1 Lf_flush3
Lf_flushed3:
    v_exp_f32 v145, v161
    v_rcp_f32 v137, v137
    v_exp_f32 v146, v162
    s_bitcmp1_b64 s[60:61], 7
    s_cbranch_scc1 Lf_adv3
Lf_advd3:
    v_rcp_f32 v138, v138
    v_cvt_pk_bf16_f32 v134, v136, v137
    v_exp_f32 v147, v163
    v_mfma_f32_16x16x32_bf16 v[160:163], v[124:127], v[180:183], v[176:179]
    s_waitcnt lgkmcnt(0)
    s_add_u32 m0, s52, 6240
    v_rcp_f32 v139, v139
    buffer_load_dwordx4 v[230:231], s[20:23], 0 idxen offen nt lds
    v_mfma_f32_4x4x4_16b_bf16 v[144:147], v[228:229], v[228:229], v[144:147]
    v_mfma_f32_16x16x32_bf16 v[156:159], v[120:123], v[184:187], v[156:159]
    s_add_u32 m0, s52, 7296
    v_rcp_f32 v140, v140
    buffer_load_dwordx4 v[232:233], s[20:23], 0 idxen offen nt lds
    v_mfma_f32_16x16x32_bf16 v[160:163], v[128:131], v[184:187], v[160:163]
    v_rcp_f32 v141, v141
    v_cvt_pk_bf16_f32 v135, v138, v139
    s_waitcnt vmcnt(4)
    ds_read_b128 v[180:183], v234 offset:2080
    ds_read_b128 v[184:187], v235 offset:2080
    v_rcp_f32 v142, v142
    v_cvt_pk_bf16_f32 v136, v140, v141
    v_mfma_f32_16x16x32_bf16 v[208:211], v[132:135], v[196:199], v[204:207]
    v_rcp_f32 v143, v143
    s_lshr_b64 s[56:57], s[56:57], 4
    s_lshl_b64 s[86:87], s[58:59], 60
    s_or_b64 s[56:57], s[56:57], s[86:87]
    s_lshr_b64 s[58:59], s[58:59], 4
    s_lshr_b64 s[60:61], s[60:61], 4
    s_lshl_b64 s[86:87], s[62:63], 60
    s_or_b64 s[60:61], s[60:61], s[86:87]
    s_lshr_b64 s[62:63], s[62:63], 4
    v_add_u32 v237, 64, v237
    v_rcp_f32 v144, v144
    v_cvt_pk_bf16_f32 v137, v142, v143
    v_rcp_f32 v145, v145
    v_rcp_f32 v146, v146
    v_rcp_f32 v147, v147
    v_cvt_pk_bf16_f32 v138, v144, v145
    v_cvt_pk_bf16_f32 v139, v146, v147
    s_branch Lf_loop
Lf_flush0:
    v_cvt_pk_bf16_f32 v246, v212, v212
    v_mov_b32 v212, 0
    s_sub_u32 s65, s65, 1
    ds_write_b16 v240, v246
    s_cbranch_scc1 L_store
    v_add_u32 v240, 128, v240
    s_branch Lf_flushed0
Lf_wb0:
    v_mul_u32_u24 v216, v224, v241
    v_mul_u32_u24 v217, v224, v242
    v_mul_u32_u24 v218, v225, v241
    v_mul_u32_u24 v219, v225, v242
    v_mul_u32_u24 v220, v226, v241
    v_mul_u32_u24 v221, v226, v242
    v_mul_u32_u24 v222, v227, v241
    v_mul_u32_u24 v223, v227, v242
    v_add_u32 v238, 128, v238
    ds_read_b128 v[164:167], v239
    v_mfma_f32_4x4x4_16b_bf16 v[132:135], v[216:217], v[68:69], v[4:7]
    ds_read_b128 v[168:171], v239 offset:64
    ds_read_b128 v[172:175], v239 offset:128
    v_mfma_f32_4x4x4_16b_bf16 v[136:139], v[218:219], v[70:71], v[8:11]
    ds_read_b128 v[176:179], v239 offset:192
    ds_read_u16 v224, v238
    v_mfma_f32_4x4x4_16b_bf16 v[140:143], v[220:221], v[72:73], v[12:15]
    ds_read_u16 v225, v238 offset:8
    ds_read_u16 v226, v238 offset:64
    v_mfma_f32_4x4x4_16b_bf16 v[144:147], v[222:223], v[74:75], v[16:19]
    ds_read_u16 v227, v238 offset:72
    v_add_u32 v239, 256, v239
    v_mfma_f32_4x4x4_16b_bf16 v[246:249], v[216:217], v[76:77], v[20:23]
    v_cvt_pk_bf16_f32 v100, v132, v133
    v_cvt_pk_bf16_f32 v101, v134, v135
    v_mfma_f32_4x4x4_16b_bf16 v[250:253], v[218:219], v[78:79], v[24:27]
    v_cvt_pk_bf16_f32 v102, v136, v137
    v_cvt_pk_bf16_f32 v103, v138, v139
    v_mfma_f32_4x4x4_16b_bf16 v[132:135], v[220:221], v[80:81], v[28:31]
    v_cvt_pk_bf16_f32 v104, v140, v141
    v_cvt_pk_bf16_f32 v105, v142, v143
    v_mfma_f32_4x4x4_16b_bf16 v[136:139], v[222:223], v[82:83], v[32:35]
    v_cvt_pk_bf16_f32 v106, v144, v145
    v_cvt_pk_bf16_f32 v107, v146, v147
    v_mfma_f32_4x4x4_16b_bf16 v[140:143], v[216:217], v[84:85], v[36:39]
    v_cvt_pk_bf16_f32 v108, v246, v247
    v_cvt_pk_bf16_f32 v109, v248, v249
    v_mfma_f32_4x4x4_16b_bf16 v[144:147], v[218:219], v[86:87], v[40:43]
    v_cvt_pk_bf16_f32 v110, v250, v251
    v_cvt_pk_bf16_f32 v111, v252, v253
    v_mfma_f32_4x4x4_16b_bf16 v[246:249], v[220:221], v[88:89], v[44:47]
    v_cvt_pk_bf16_f32 v112, v132, v133
    v_cvt_pk_bf16_f32 v113, v134, v135
    v_mfma_f32_4x4x4_16b_bf16 v[250:253], v[222:223], v[90:91], v[48:51]
    v_cvt_pk_bf16_f32 v114, v136, v137
    v_cvt_pk_bf16_f32 v115, v138, v139
    v_mfma_f32_4x4x4_16b_bf16 v[132:135], v[216:217], v[92:93], v[52:55]
    v_cvt_pk_bf16_f32 v116, v140, v141
    v_cvt_pk_bf16_f32 v117, v142, v143
    v_mfma_f32_4x4x4_16b_bf16 v[136:139], v[218:219], v[94:95], v[56:59]
    v_cvt_pk_bf16_f32 v118, v144, v145
    v_cvt_pk_bf16_f32 v119, v146, v147
    v_mfma_f32_4x4x4_16b_bf16 v[140:143], v[220:221], v[96:97], v[60:63]
    v_cvt_pk_bf16_f32 v120, v246, v247
    v_cvt_pk_bf16_f32 v121, v248, v249
    v_mfma_f32_4x4x4_16b_bf16 v[144:147], v[222:223], v[98:99], v[64:67]
    v_cvt_pk_bf16_f32 v122, v250, v251
    v_cvt_pk_bf16_f32 v123, v252, v253
    v_cvt_pk_bf16_f32 v124, v132, v133
    v_cvt_pk_bf16_f32 v125, v134, v135
    v_cvt_pk_bf16_f32 v126, v136, v137
    v_cvt_pk_bf16_f32 v127, v138, v139
    v_cvt_pk_bf16_f32 v128, v140, v141
    v_cvt_pk_bf16_f32 v129, v142, v143
    v_cvt_pk_bf16_f32 v130, v144, v145
    v_cvt_pk_bf16_f32 v131, v146, v147
    s_waitcnt lgkmcnt(0)
    s_branch Lf_wbd0
Lf_adv0:
    s_add_u32 s20, s20, s31
    s_addc_u32 s21, s21, 0
    s_xor_b32 s31, s31, 0x63ff800
    s_branch Lf_advd0
Lf_flush1:
    v_cvt_pk_bf16_f32 v246, v212, v212
    v_mov_b32 v212, 0
    s_sub_u32 s65, s65, 1
    ds_write_b16 v240, v246
    s_cbranch_scc1 L_store
    v_add_u32 v240, 128, v240
    s_branch Lf_flushed1
Lf_wb1:
    v_mul_u32_u24 v216, v224, v241
    v_mul_u32_u24 v217, v224, v242
    v_mul_u32_u24 v218, v225, v241
    v_mul_u32_u24 v219, v225, v242
    v_mul_u32_u24 v220, v226, v241
    v_mul_u32_u24 v221, v226, v242
    v_mul_u32_u24 v222, v227, v241
    v_mul_u32_u24 v223, v227, v242
    v_add_u32 v238, 128, v238
    ds_read_b128 v[164:167], v239
    v_mfma_f32_4x4x4_16b_bf16 v[132:135], v[216:217], v[68:69], v[4:7]
    ds_read_b128 v[168:171], v239 offset:64
    ds_read_b128 v[172:175], v239 offset:128
    v_mfma_f32_4x4x4_16b_bf16 v[136:139], v[218:219], v[70:71], v[8:11]
    ds_read_b128 v[176:179], v239 offset:192
    ds_read_u16 v224, v238
    v_mfma_f32_4x4x4_16b_bf16 v[140:143], v[220:221], v[72:73], v[12:15]
    ds_read_u16 v225, v238 offset:8
    ds_read_u16 v226, v238 offset:64
    v_mfma_f32_4x4x4_16b_bf16 v[144:147], v[222:223], v[74:75], v[16:19]
    ds_read_u16 v227, v238 offset:72
    v_add_u32 v239, 256, v239
    v_mfma_f32_4x4x4_16b_bf16 v[246:249], v[216:217], v[76:77], v[20:23]
    v_cvt_pk_bf16_f32 v100, v132, v133
    v_cvt_pk_bf16_f32 v101, v134, v135
    v_mfma_f32_4x4x4_16b_bf16 v[250:253], v[218:219], v[78:79], v[24:27]
    v_cvt_pk_bf16_f32 v102, v136, v137
    v_cvt_pk_bf16_f32 v103, v138, v139
    v_mfma_f32_4x4x4_16b_bf16 v[132:135], v[220:221], v[80:81], v[28:31]
    v_cvt_pk_bf16_f32 v104, v140, v141
    v_cvt_pk_bf16_f32 v105, v142, v143
    v_mfma_f32_4x4x4_16b_bf16 v[136:139], v[222:223], v[82:83], v[32:35]
    v_cvt_pk_bf16_f32 v106, v144, v145
    v_cvt_pk_bf16_f32 v107, v146, v147
    v_mfma_f32_4x4x4_16b_bf16 v[140:143], v[216:217], v[84:85], v[36:39]
    v_cvt_pk_bf16_f32 v108, v246, v247
    v_cvt_pk_bf16_f32 v109, v248, v249
    v_mfma_f32_4x4x4_16b_bf16 v[144:147], v[218:219], v[86:87], v[40:43]
    v_cvt_pk_bf16_f32 v110, v250, v251
    v_cvt_pk_bf16_f32 v111, v252, v253
    v_mfma_f32_4x4x4_16b_bf16 v[246:249], v[220:221], v[88:89], v[44:47]
    v_cvt_pk_bf16_f32 v112, v132, v133
    v_cvt_pk_bf16_f32 v113, v134, v135
    v_mfma_f32_4x4x4_16b_bf16 v[250:253], v[222:223], v[90:91], v[48:51]
    v_cvt_pk_bf16_f32 v114, v136, v137
    v_cvt_pk_bf16_f32 v115, v138, v139
    v_mfma_f32_4x4x4_16b_bf16 v[132:135], v[216:217], v[92:93], v[52:55]
    v_cvt_pk_bf16_f32 v116, v140, v141
    v_cvt_pk_bf16_f32 v117, v142, v143
    v_mfma_f32_4x4x4_16b_bf16 v[136:139], v[218:219], v[94:95], v[56:59]
    v_cvt_pk_bf16_f32 v118, v144, v145
    v_cvt_pk_bf16_f32 v119, v146, v147
    v_mfma_f32_4x4x4_16b_bf16 v[140:143], v[220:221], v[96:97], v[60:63]
    v_cvt_pk_bf16_f32 v120, v246, v247
    v_cvt_pk_bf16_f32 v121, v248, v249
    v_mfma_f32_4x4x4_16b_bf16 v[144:147], v[222:223], v[98:99], v[64:67]
    v_cvt_pk_bf16_f32 v122, v250, v251
    v_cvt_pk_bf16_f32 v123, v252, v253
    v_cvt_pk_bf16_f32 v124, v132, v133
    v_cvt_pk_bf16_f32 v125, v134, v135
    v_cvt_pk_bf16_f32 v126, v136, v137
    v_cvt_pk_bf16_f32 v127, v138, v139
    v_cvt_pk_bf16_f32 v128, v140, v141
    v_cvt_pk_bf16_f32 v129, v142, v143
    v_cvt_pk_bf16_f32 v130, v144, v145
    v_cvt_pk_bf16_f32 v131, v146, v147
    s_waitcnt lgkmcnt(0)
    s_branch Lf_wbd1
Lf_adv1:
    s_add_u32 s20, s20, s31
    s_addc_u32 s21, s21, 0
    s_xor_b32 s31, s31, 0x63ff800
    s_branch Lf_advd1
Lf_flush2:
    v_cvt_pk_bf16_f32 v246, v212, v212
    v_mov_b32 v212, 0
    s_sub_u32 s65, s65, 1
    ds_write_b16 v240, v246
    s_cbranch_scc1 L_store
    v_add_u32 v240, 128, v240
    s_branch Lf_flushed2
Lf_wb2:
    v_mul_u32_u24 v216, v224, v241
    v_mul_u32_u24 v217, v224, v242
    v_mul_u32_u24 v218, v225, v241
    v_mul_u32_u24 v219, v225, v242
    v_mul_u32_u24 v220, v226, v241
    v_mul_u32_u24 v221, v226, v242
    v_mul_u32_u24 v222, v227, v241
    v_mul_u32_u24 v223, v227, v242
    v_add_u32 v238, 128, v238
    ds_read_b128 v[164:167], v239
    v_mfma_f32_4x4x4_16b_bf16 v[132:135], v[216:217], v[68:69], v[4:7]
    ds_read_b128 v[168:171], v239 offset:64
    ds_read_b128 v[172:175], v239 offset:128
    v_mfma_f32_4x4x4_16b_bf16 v[136:139], v[218:219], v[70:71], v[8:11]
    ds_read_b128 v[176:179], v239 offset:192
    ds_read_u16 v224, v238
    v_mfma_f32_4x4x4_16b_bf16 v[140:143], v[220:221], v[72:73], v[12:15]
    ds_read_u16 v225, v238 offset:8
    ds_read_u16 v226, v238 offset:64
    v_mfma_f32_4x4x4_16b_bf16 v[144:147], v[222:223], v[74:75], v[16:19]
    ds_read_u16 v227, v238 offset:72
    v_add_u32 v239, 256, v239
    v_mfma_f32_4x4x4_16b_bf16 v[246:249], v[216:217], v[76:77], v[20:23]
    v_cvt_pk_bf16_f32 v100, v132, v133
    v_cvt_pk_bf16_f32 v101, v134, v135
    v_mfma_f32_4x4x4_16b_bf16 v[250:253], v[218:219], v[78:79], v[24:27]
    v_cvt_pk_bf16_f32 v102, v136, v137
    v_cvt_pk_bf16_f32 v103, v138, v139
    v_mfma_f32_4x4x4_16b_bf16 v[132:135], v[220:221], v[80:81], v[28:31]
    v_cvt_pk_bf16_f32 v104, v140, v141
    v_cvt_pk_bf16_f32 v105, v142, v143
    v_mfma_f32_4x4x4_16b_bf16 v[136:139], v[222:223], v[82:83], v[32:35]
    v_cvt_pk_bf16_f32 v106, v144, v145
    v_cvt_pk_bf16_f32 v107, v146, v147
    v_mfma_f32_4x4x4_16b_bf16 v[140:143], v[216:217], v[84:85], v[36:39]
    v_cvt_pk_bf16_f32 v108, v246, v247
    v_cvt_pk_bf16_f32 v109, v248, v249
    v_mfma_f32_4x4x4_16b_bf16 v[144:147], v[218:219], v[86:87], v[40:43]
    v_cvt_pk_bf16_f32 v110, v250, v251
    v_cvt_pk_bf16_f32 v111, v252, v253
    v_mfma_f32_4x4x4_16b_bf16 v[246:249], v[220:221], v[88:89], v[44:47]
    v_cvt_pk_bf16_f32 v112, v132, v133
    v_cvt_pk_bf16_f32 v113, v134, v135
    v_mfma_f32_4x4x4_16b_bf16 v[250:253], v[222:223], v[90:91], v[48:51]
    v_cvt_pk_bf16_f32 v114, v136, v137
    v_cvt_pk_bf16_f32 v115, v138, v139
    v_mfma_f32_4x4x4_16b_bf16 v[132:135], v[216:217], v[92:93], v[52:55]
    v_cvt_pk_bf16_f32 v116, v140, v141
    v_cvt_pk_bf16_f32 v117, v142, v143
    v_mfma_f32_4x4x4_16b_bf16 v[136:139], v[218:219], v[94:95], v[56:59]
    v_cvt_pk_bf16_f32 v118, v144, v145
    v_cvt_pk_bf16_f32 v119, v146, v147
    v_mfma_f32_4x4x4_16b_bf16 v[140:143], v[220:221], v[96:97], v[60:63]
    v_cvt_pk_bf16_f32 v120, v246, v247
    v_cvt_pk_bf16_f32 v121, v248, v249
    v_mfma_f32_4x4x4_16b_bf16 v[144:147], v[222:223], v[98:99], v[64:67]
    v_cvt_pk_bf16_f32 v122, v250, v251
    v_cvt_pk_bf16_f32 v123, v252, v253
    v_cvt_pk_bf16_f32 v124, v132, v133
    v_cvt_pk_bf16_f32 v125, v134, v135
    v_cvt_pk_bf16_f32 v126, v136, v137
    v_cvt_pk_bf16_f32 v127, v138, v139
    v_cvt_pk_bf16_f32 v128, v140, v141
    v_cvt_pk_bf16_f32 v129, v142, v143
    v_cvt_pk_bf16_f32 v130, v144, v145
    v_cvt_pk_bf16_f32 v131, v146, v147
    s_waitcnt lgkmcnt(0)
    s_branch Lf_wbd2
Lf_adv2:
    s_add_u32 s20, s20, s31
    s_addc_u32 s21, s21, 0
    s_xor_b32 s31, s31, 0x63ff800
    s_branch Lf_advd2
Lf_flush3:
    v_cvt_pk_bf16_f32 v246, v212, v212
    v_mov_b32 v212, 0
    s_sub_u32 s65, s65, 1
    ds_write_b16 v240, v246
    s_cbranch_scc1 L_store
    v_add_u32 v240, 128, v240
    s_branch Lf_flushed3
Lf_wb3:
    v_mul_u32_u24 v216, v224, v241
    v_mul_u32_u24 v217, v224, v242
    v_mul_u32_u24 v218, v225, v241
    v_mul_u32_u24 v219, v225, v242
    v_mul_u32_u24 v220, v226, v241
    v_mul_u32_u24 v221, v226, v242
    v_mul_u32_u24 v222, v227, v241
    v_mul_u32_u24 v223, v227, v242
    v_add_u32 v238, 128, v238
    ds_read_b128 v[164:167], v239
    v_mfma_f32_4x4x4_16b_bf16 v[132:135], v[216:217], v[68:69], v[4:7]
    ds_read_b128 v[168:171], v239 offset:64
    ds_read_b128 v[172:175], v239 offset:128
    v_mfma_f32_4x4x4_16b_bf16 v[136:139], v[218:219], v[70:71], v[8:11]
    ds_read_b128 v[176:179], v239 offset:192
    ds_read_u16 v224, v238
    v_mfma_f32_4x4x4_16b_bf16 v[140:143], v[220:221], v[72:73], v[12:15]
    ds_read_u16 v225, v238 offset:8
    ds_read_u16 v226, v238 offset:64
    v_mfma_f32_4x4x4_16b_bf16 v[144:147], v[222:223], v[74:75], v[16:19]
    ds_read_u16 v227, v238 offset:72
    v_add_u32 v239, 256, v239
    v_mfma_f32_4x4x4_16b_bf16 v[246:249], v[216:217], v[76:77], v[20:23]
    v_cvt_pk_bf16_f32 v100, v132, v133
    v_cvt_pk_bf16_f32 v101, v134, v135
    v_mfma_f32_4x4x4_16b_bf16 v[250:253], v[218:219], v[78:79], v[24:27]
    v_cvt_pk_bf16_f32 v102, v136, v137
    v_cvt_pk_bf16_f32 v103, v138, v139
    v_mfma_f32_4x4x4_16b_bf16 v[132:135], v[220:221], v[80:81], v[28:31]
    v_cvt_pk_bf16_f32 v104, v140, v141
    v_cvt_pk_bf16_f32 v105, v142, v143
    v_mfma_f32_4x4x4_16b_bf16 v[136:139], v[222:223], v[82:83], v[32:35]
    v_cvt_pk_bf16_f32 v106, v144, v145
    v_cvt_pk_bf16_f32 v107, v146, v147
    v_mfma_f32_4x4x4_16b_bf16 v[140:143], v[216:217], v[84:85], v[36:39]
    v_cvt_pk_bf16_f32 v108, v246, v247
    v_cvt_pk_bf16_f32 v109, v248, v249
    v_mfma_f32_4x4x4_16b_bf16 v[144:147], v[218:219], v[86:87], v[40:43]
    v_cvt_pk_bf16_f32 v110, v250, v251
    v_cvt_pk_bf16_f32 v111, v252, v253
    v_mfma_f32_4x4x4_16b_bf16 v[246:249], v[220:221], v[88:89], v[44:47]
    v_cvt_pk_bf16_f32 v112, v132, v133
    v_cvt_pk_bf16_f32 v113, v134, v135
    v_mfma_f32_4x4x4_16b_bf16 v[250:253], v[222:223], v[90:91], v[48:51]
    v_cvt_pk_bf16_f32 v114, v136, v137
    v_cvt_pk_bf16_f32 v115, v138, v139
    v_mfma_f32_4x4x4_16b_bf16 v[132:135], v[216:217], v[92:93], v[52:55]
    v_cvt_pk_bf16_f32 v116, v140, v141
    v_cvt_pk_bf16_f32 v117, v142, v143
    v_mfma_f32_4x4x4_16b_bf16 v[136:139], v[218:219], v[94:95], v[56:59]
    v_cvt_pk_bf16_f32 v118, v144, v145
    v_cvt_pk_bf16_f32 v119, v146, v147
    v_mfma_f32_4x4x4_16b_bf16 v[140:143], v[220:221], v[96:97], v[60:63]
    v_cvt_pk_bf16_f32 v120, v246, v247
    v_cvt_pk_bf16_f32 v121, v248, v249
    v_mfma_f32_4x4x4_16b_bf16 v[144:147], v[222:223], v[98:99], v[64:67]
    v_cvt_pk_bf16_f32 v122, v250, v251
    v_cvt_pk_bf16_f32 v123, v252, v253
    v_cvt_pk_bf16_f32 v124, v132, v133
    v_cvt_pk_bf16_f32 v125, v134, v135
    v_cvt_pk_bf16_f32 v126, v136, v137
    v_cvt_pk_bf16_f32 v127, v138, v139
    v_cvt_pk_bf16_f32 v128, v140, v141
    v_cvt_pk_bf16_f32 v129, v142, v143
    v_cvt_pk_bf16_f32 v130, v144, v145
    v_cvt_pk_bf16_f32 v131, v146, v147
    s_waitcnt lgkmcnt(0)
    s_branch Lf_wbd3
Lf_adv3:
    s_add_u32 s20, s20, s31
    s_addc_u32 s21, s21, 0
    s_xor_b32 s31, s31, 0x63ff800
    s_branch Lf_advd3
L_store:
    s_add_u32 s66, s52, 8320
    v_lshl_add_u32 v247, v0, 4, s66
    s_waitcnt lgkmcnt(0)
    ds_read_b128 v[148:151], v247
    s_waitcnt lgkmcnt(0)
    global_store_dwordx4 v243, v[148:151], s[18:19]
L_end:
    s_endpgm
Ls_loop:
    ds_read_u8 v230, v237 offset:64
    ds_read_u8 v232, v237 offset:72
    v_mfma_f32_16x16x32_bf16 v[208:211], v[136:139], v[200:203], v[208:211]
Ls_mid:
    ds_read_b32 v246, v244 offset:0
    s_waitcnt lgkmcnt(0)
    v_bfe_u32 v247, v246, 0, 8
    v_lshlrev_b32 v247, 1, v247
    v_bfe_u32 v248, v246, 8, 8
    v_lshlrev_b32 v248, 1, v248
    v_bfe_u32 v249, v246, 16, 8
    v_lshlrev_b32 v249, 1, v249
    v_bfe_u32 v250, v246, 24, 8
    v_lshlrev_b32 v250, 1, v250
    buffer_load_ushort v247, v247, s[24:27], 0 offen
    buffer_load_ushort v248, v248, s[24:27], 0 offen
    buffer_load_ushort v249, v249, s[24:27], 0 offen
    buffer_load_ushort v250, v250, s[24:27], 0 offen
    s_waitcnt vmcnt(0)
    v_lshlrev_b32 v247, 16, v247
    v_mul_f32 v208, v208, v247
    v_lshlrev_b32 v248, 16, v248
    v_mul_f32 v209, v209, v248
    v_lshlrev_b32 v249, 16, v249
    v_mul_f32 v210, v210, v249
    v_lshlrev_b32 v250, 16, v250
    v_mul_f32 v211, v211, v250
    s_bitcmp1_b64 s[60:61], 1
    s_cbranch_scc1 Ls_wb0
Ls_wbd0:
    s_mov_b64 exec, 1
    ds_add_rtn_u32 v1, v2, v3
    s_mov_b64 exec, -1
    v_exp_f32 v132, v148
    v_exp_f32 v133, v149
    v_exp_f32 v134, v150
    v_exp_f32 v135, v151
    v_exp_f32 v136, v152
    v_exp_f32 v137, v153
    v_mfma_f32_4x4x4_16b_bf16 v[132:135], v[228:229], v[228:229], v[132:135]
    v_cvt_pk_bf16_f32 v208, v208, v209
    v_cvt_pk_bf16_f32 v209, v210, v211
    s_waitcnt lgkmcnt(2)
    v_mfma_f32_16x16x32_bf16 v[148:151], v[100:103], v[180:183], v[164:167]
    v_exp_f32 v138, v154
    v_mfma_f32_4x4x4_16b_bf16 v[212:215], v[208:209], v[188:189], v[212:215] cbsz:4 abid:0
    ds_read_b64_tr_b16 v[188:189], v236 offset:0
    v_exp_f32 v139, v155
    v_mfma_f32_16x16x32_bf16 v[152:155], v[108:111], v[180:183], v[168:171]
    v_exp_f32 v140, v156
    v_mfma_f32_4x4x4_16b_bf16 v[212:215], v[208:209], v[190:191], v[212:215] cbsz:4 abid:4
    ds_read_b64_tr_b16 v[190:191], v236 offset:512
    v_mfma_f32_4x4x4_16b_bf16 v[136:139], v[228:229], v[228:229], v[136:139]
    v_rcp_f32 v132, v132
    v_mfma_f32_4x4x4_16b_bf16 v[212:215], v[208:209], v[192:193], v[212:215] cbsz:4 abid:8
    ds_read_b64_tr_b16 v[192:193], v236 offset:1056
    v_exp_f32 v141, v157
    v_mfma_f32_16x16x32_bf16 v[148:151], v[104:107], v[184:187], v[148:151]
    v_rcp_f32 v133, v133
    v_mfma_f32_4x4x4_16b_bf16 v[212:215], v[208:209], v[194:195], v[212:215] cbsz:4 abid:12
    ds_read_b64_tr_b16 v[194:195], v236 offset:1568
    v_exp_f32 v142, v158
    v_mfma_f32_16x16x32_bf16 v[152:155], v[112:115], v[184:187], v[152:155]
    v_rcp_f32 v134, v134
    v_exp_f32 v143, v159
    v_rcp_f32 v135, v135
    v_cvt_pk_bf16_f32 v132, v132, v133
    v_mfma_f32_4x4x4_16b_bf16 v[140:143], v[228:229], v[228:229], v[140:143]
    v_exp_f32 v144, v160
    v_mfma_f32_16x16x32_bf16 v[156:159], v[116:119], v[180:183], v[172:175]
    v_rcp_f32 v136, v136
    v_cvt_pk_bf16_f32 v133, v134, v135
    s_bitcmp1_b64 s[56:57], 0
    s_cbranch_scc1 Ls_flush0
Ls_flushed0:
    v_exp_f32 v145, v161
    v_rcp_f32 v137, v137
    v_exp_f32 v146, v162
    s_bitcmp1_b64 s[60:61], 4
    s_cbranch_scc1 Ls_adv0
Ls_advd0:
    v_rcp_f32 v138, v138
    v_cvt_pk_bf16_f32 v134, v136, v137
    v_exp_f32 v147, v163
    v_mfma_f32_16x16x32_bf16 v[160:163], v[124:127], v[180:183], v[176:179]
    s_waitcnt lgkmcnt(0)
    s_add_u32 m0, s52, 0
    v_rcp_f32 v139, v139
    buffer_load_dwordx4 v[230:231], s[20:23], 0 idxen offen nt lds
    v_mfma_f32_4x4x4_16b_bf16 v[144:147], v[228:229], v[228:229], v[144:147]
    v_mfma_f32_16x16x32_bf16 v[156:159], v[120:123], v[184:187], v[156:159]
    s_add_u32 m0, s52, 1056
    v_rcp_f32 v140, v140
    buffer_load_dwordx4 v[232:233], s[20:23], 0 idxen offen nt lds
    v_mfma_f32_16x16x32_bf16 v[160:163], v[128:131], v[184:187], v[160:163]
    v_readfirstlane_b32 s66, v1
    s_nop 0
    s_xor_b32 s66, s66, s33
    s_cmp_gt_i32 s66, 0
    s_setprio 0
    s_cbranch_scc0 Ls_lo0
    s_setprio 1
Ls_lo0:
    v_rcp_f32 v141, v141
    v_cvt_pk_bf16_f32 v135, v138, v139
    s_waitcnt vmcnt(4)
    ds_read_b128 v[180:183], v234 offset:4160
    ds_read_b128 v[184:187], v235 offset:4160
    v_rcp_f32 v142, v142
    v_cvt_pk_bf16_f32 v136, v140, v141
    v_mfma_f32_16x16x32_bf16 v[208:211], v[132:135], v[196:199], v[204:207]
    v_rcp_f32 v143, v143
    v_rcp_f32 v144, v144
    v_cvt_pk_bf16_f32 v137, v142, v143
    v_rcp_f32 v145, v145
    v_rcp_f32 v146, v146
    v_rcp_f32 v147, v147
    v_cvt_pk_bf16_f32 v138, v144, v145
    v_cvt_pk_bf16_f32 v139, v146, v147
    ds_read_u8 v230, v237 offset:80
    ds_read_u8 v232, v237 offset:88
    v_mfma_f32_16x16x32_bf16 v[208:211], v[136:139], v[200:203], v[208:211]
    ds_read_b32 v246, v244 offset:16
    s_waitcnt lgkmcnt(0)
    v_bfe_u32 v247, v246, 0, 8
    v_lshlrev_b32 v247, 1, v247
    v_bfe_u32 v248, v246, 8, 8
    v_lshlrev_b32 v248, 1, v248
    v_bfe_u32 v249, v246, 16, 8
    v_lshlrev_b32 v249, 1, v249
    v_bfe_u32 v250, v246, 24, 8
    v_lshlrev_b32 v250, 1, v250
    buffer_load_ushort v247, v247, s[24:27], 0 offen
    buffer_load_ushort v248, v248, s[24:27], 0 offen
    buffer_load_ushort v249, v249, s[24:27], 0 offen
    buffer_load_ushort v250, v250, s[24:27], 0 offen
    s_waitcnt vmcnt(0)
    v_lshlrev_b32 v247, 16, v247
    v_mul_f32 v208, v208, v247
    v_lshlrev_b32 v248, 16, v248
    v_mul_f32 v209, v209, v248
    v_lshlrev_b32 v249, 16, v249
    v_mul_f32 v210, v210, v249
    v_lshlrev_b32 v250, 16, v250
    v_mul_f32 v211, v211, v250
    s_bitcmp1_b64 s[60:61], 2
    s_cbranch_scc1 Ls_wb1
Ls_wbd1:
    v_exp_f32 v132, v148
    v_exp_f32 v133, v149
    v_exp_f32 v134, v150
    v_exp_f32 v135, v151
    v_exp_f32 v136, v152
    v_exp_f32 v137, v153
    v_mfma_f32_4x4x4_16b_bf16 v[132:135], v[228:229], v[228:229], v[132:135]
    v_cvt_pk_bf16_f32 v208, v208, v209
    v_cvt_pk_bf16_f32 v209, v210, v211
    s_waitcnt lgkmcnt(2)
    v_mfma_f32_16x16x32_bf16 v[148:151], v[100:103], v[180:183], v[164:167]
    v_exp_f32 v138, v154
    v_mfma_f32_4x4x4_16b_bf16 v[212:215], v[208:209], v[188:189], v[212:215] cbsz:4 abid:0
    ds_read_b64_tr_b16 v[188:189], v236 offset:2080
    v_exp_f32 v139, v155
    v_mfma_f32_16x16x32_bf16 v[152:155], v[108:111], v[180:183], v[168:171]
    v_exp_f32 v140, v156
    v_mfma_f32_4x4x4_16b_bf16 v[212:215], v[208:209], v[190:191], v[212:215] cbsz:4 abid:4
    ds_read_b64_tr_b16 v[190:191], v236 offset:2592
    v_mfma_f32_4x4x4_16b_bf16 v[136:139], v[228:229], v[228:229], v[136:139]
    v_rcp_f32 v132, v132
    v_mfma_f32_4x4x4_16b_bf16 v[212:215], v[208:209], v[192:193], v[212:215] cbsz:4 abid:8
    ds_read_b64_tr_b16 v[192:193], v236 offset:3136
    v_exp_f32 v141, v157
    v_mfma_f32_16x16x32_bf16 v[148:151], v[104:107], v[184:187], v[148:151]
    v_rcp_f32 v133, v133
    v_mfma_f32_4x4x4_16b_bf16 v[212:215], v[208:209], v[194:195], v[212:215] cbsz:4 abid:12
    ds_read_b64_tr_b16 v[194:195], v236 offset:3648
    v_exp_f32 v142, v158
    v_mfma_f32_16x16x32_bf16 v[152:155], v[112:115], v[184:187], v[152:155]
    v_rcp_f32 v134, v134
    v_exp_f32 v143, v159
    v_rcp_f32 v135, v135
    v_cvt_pk_bf16_f32 v132, v132, v133
    v_mfma_f32_4x4x4_16b_bf16 v[140:143], v[228:229], v[228:229], v[140:143]
    v_exp_f32 v144, v160
    v_mfma_f32_16x16x32_bf16 v[156:159], v[116:119], v[180:183], v[172:175]
    v_rcp_f32 v136, v136
    v_cvt_pk_bf16_f32 v133, v134, v135
    s_bitcmp1_b64 s[56:57], 1
    s_cbranch_scc1 Ls_flush1
Ls_flushed1:
    v_exp_f32 v145, v161
    v_rcp_f32 v137, v137
    v_exp_f32 v146, v162
    s_bitcmp1_b64 s[60:61], 5
    s_cbranch_scc1 Ls_adv1
Ls_advd1:
    v_rcp_f32 v138, v138
    v_cvt_pk_bf16_f32 v134, v136, v137
    v_exp_f32 v147, v163
    v_mfma_f32_16x16x32_bf16 v[160:163], v[124:127], v[180:183], v[176:179]
    s_waitcnt lgkmcnt(0)
    s_add_u32 m0, s52, 2080
    v_rcp_f32 v139, v139
    buffer_load_dwordx4 v[230:231], s[20:23], 0 idxen offen nt lds
    v_mfma_f32_4x4x4_16b_bf16 v[144:147], v[228:229], v[228:229], v[144:147]
    v_mfma_f32_16x16x32_bf16 v[156:159], v[120:123], v[184:187], v[156:159]
    s_add_u32 m0, s52, 3136
    v_rcp_f32 v140, v140
    buffer_load_dwordx4 v[232:233], s[20:23], 0 idxen offen nt lds
    v_mfma_f32_16x16x32_bf16 v[160:163], v[128:131], v[184:187], v[160:163]
    v_rcp_f32 v141, v141
    v_cvt_pk_bf16_f32 v135, v138, v139
    s_waitcnt vmcnt(4)
    ds_read_b128 v[180:183], v234 offset:6240
    ds_read_b128 v[184:187], v235 offset:6240
    v_rcp_f32 v142, v142
    v_cvt_pk_bf16_f32 v136, v140, v141
    v_mfma_f32_16x16x32_bf16 v[208:211], v[132:135], v[196:199], v[204:207]
    v_rcp_f32 v143, v143
    v_rcp_f32 v144, v144
    v_cvt_pk_bf16_f32 v137, v142, v143
    v_rcp_f32 v145, v145
    v_rcp_f32 v146, v146
    v_rcp_f32 v147, v147
    v_cvt_pk_bf16_f32 v138, v144, v145
    v_cvt_pk_bf16_f32 v139, v146, v147
    ds_read_u8 v230, v237 offset:96
    ds_read_u8 v232, v237 offset:104
    v_mfma_f32_16x16x32_bf16 v[208:211], v[136:139], v[200:203], v[208:211]
    ds_read_b32 v246, v244 offset:32
    s_waitcnt lgkmcnt(0)
    v_bfe_u32 v247, v246, 0, 8
    v_lshlrev_b32 v247, 1, v247
    v_bfe_u32 v248, v246, 8, 8
    v_lshlrev_b32 v248, 1, v248
    v_bfe_u32 v249, v246, 16, 8
    v_lshlrev_b32 v249, 1, v249
    v_bfe_u32 v250, v246, 24, 8
    v_lshlrev_b32 v250, 1, v250
    buffer_load_ushort v247, v247, s[24:27], 0 offen
    buffer_load_ushort v248, v248, s[24:27], 0 offen
    buffer_load_ushort v249, v249, s[24:27], 0 offen
    buffer_load_ushort v250, v250, s[24:27], 0 offen
    s_waitcnt vmcnt(0)
    v_lshlrev_b32 v247, 16, v247
    v_mul_f32 v208, v208, v247
    v_lshlrev_b32 v248, 16, v248
    v_mul_f32 v209, v209, v248
    v_lshlrev_b32 v249, 16, v249
    v_mul_f32 v210, v210, v249
    v_lshlrev_b32 v250, 16, v250
    v_mul_f32 v211, v211, v250
    s_bitcmp1_b64 s[60:61], 3
    s_cbranch_scc1 Ls_wb2
Ls_wbd2:
    s_mov_b64 exec, 1
    ds_add_rtn_u32 v1, v2, v3
    s_mov_b64 exec, -1
    v_exp_f32 v132, v148
    v_exp_f32 v133, v149
    v_exp_f32 v134, v150
    v_exp_f32 v135, v151
    v_exp_f32 v136, v152
    v_exp_f32 v137, v153
    v_mfma_f32_4x4x4_16b_bf16 v[132:135], v[228:229], v[228:229], v[132:135]
    v_cvt_pk_bf16_f32 v208, v208, v209
    v_cvt_pk_bf16_f32 v209, v210, v211
    s_waitcnt lgkmcnt(2)
    v_mfma_f32_16x16x32_bf16 v[148:151], v[100:103], v[180:183], v[164:167]
    v_exp_f32 v138, v154
    v_mfma_f32_4x4x4_16b_bf16 v[212:215], v[208:209], v[188:189], v[212:215] cbsz:4 abid:0
    ds_read_b64_tr_b16 v[188:189], v236 offset:4160
    v_exp_f32 v139, v155
    v_mfma_f32_16x16x32_bf16 v[152:155], v[108:111], v[180:183], v[168:171]
    v_exp_f32 v140, v156
    v_mfma_f32_4x4x4_16b_bf16 v[212:215], v[208:209], v[190:191], v[212:215] cbsz:4 abid:4
    ds_read_b64_tr_b16 v[190:191], v236 offset:4672
    v_mfma_f32_4x4x4_16b_bf16 v[136:139], v[228:229], v[228:229], v[136:139]
    v_rcp_f32 v132, v132
    v_mfma_f32_4x4x4_16b_bf16 v[212:215], v[208:209], v[192:193], v[212:215] cbsz:4 abid:8
    ds_read_b64_tr_b16 v[192:193], v236 offset:5216
    v_exp_f32 v141, v157
    v_mfma_f32_16x16x32_bf16 v[148:151], v[104:107], v[184:187], v[148:151]
    v_rcp_f32 v133, v133
    v_mfma_f32_4x4x4_16b_bf16 v[212:215], v[208:209], v[194:195], v[212:215] cbsz:4 abid:12
    ds_read_b64_tr_b16 v[194:195], v236 offset:5728
    v_exp_f32 v142, v158
    v_mfma_f32_16x16x32_bf16 v[152:155], v[112:115], v[184:187], v[152:155]
    v_rcp_f32 v134, v134
    v_exp_f32 v143, v159
    v_rcp_f32 v135, v135
    v_cvt_pk_bf16_f32 v132, v132, v133
    v_mfma_f32_4x4x4_16b_bf16 v[140:143], v[228:229], v[228:229], v[140:143]
    v_exp_f32 v144, v160
    v_mfma_f32_16x16x32_bf16 v[156:159], v[116:119], v[180:183], v[172:175]
    v_rcp_f32 v136, v136
    v_cvt_pk_bf16_f32 v133, v134, v135
    s_bitcmp1_b64 s[56:57], 2
    s_cbranch_scc1 Ls_flush2
Ls_flushed2:
    v_exp_f32 v145, v161
    v_rcp_f32 v137, v137
    v_exp_f32 v146, v162
    s_bitcmp1_b64 s[60:61], 6
    s_cbranch_scc1 Ls_adv2
Ls_advd2:
    v_rcp_f32 v138, v138
    v_cvt_pk_bf16_f32 v134, v136, v137
    v_exp_f32 v147, v163
    v_mfma_f32_16x16x32_bf16 v[160:163], v[124:127], v[180:183], v[176:179]
    s_waitcnt lgkmcnt(0)
    s_add_u32 m0, s52, 4160
    v_rcp_f32 v139, v139
    buffer_load_dwordx4 v[230:231], s[20:23], 0 idxen offen nt lds
    v_mfma_f32_4x4x4_16b_bf16 v[144:147], v[228:229], v[228:229], v[144:147]
    v_mfma_f32_16x16x32_bf16 v[156:159], v[120:123], v[184:187], v[156:159]
    s_add_u32 m0, s52, 5216
    v_rcp_f32 v140, v140
    buffer_load_dwordx4 v[232:233], s[20:23], 0 idxen offen nt lds
    v_mfma_f32_16x16x32_bf16 v[160:163], v[128:131], v[184:187], v[160:163]
    v_readfirstlane_b32 s66, v1
    s_nop 0
    s_xor_b32 s66, s66, s33
    s_cmp_gt_i32 s66, 0
    s_setprio 0
    s_cbranch_scc0 Ls_lo2
    s_setprio 1
Ls_lo2:
    v_rcp_f32 v141, v141
    v_cvt_pk_bf16_f32 v135, v138, v139
    s_waitcnt vmcnt(4)
    ds_read_b128 v[180:183], v234 offset:0
    ds_read_b128 v[184:187], v235 offset:0
    v_rcp_f32 v142, v142
    v_cvt_pk_bf16_f32 v136, v140, v141
    v_mfma_f32_16x16x32_bf16 v[208:211], v[132:135], v[196:199], v[204:207]
    v_rcp_f32 v143, v143
    v_rcp_f32 v144, v144
    v_cvt_pk_bf16_f32 v137, v142, v143
    v_rcp_f32 v145, v145
    v_rcp_f32 v146, v146
    v_rcp_f32 v147, v147
    v_cvt_pk_bf16_f32 v138, v144, v145
    v_cvt_pk_bf16_f32 v139, v146, v147
    ds_read_u8 v230, v237 offset:112
    ds_read_u8 v232, v237 offset:120
    v_mfma_f32_16x16x32_bf16 v[208:211], v[136:139], v[200:203], v[208:211]
    ds_read_b32 v246, v244 offset:48
    s_waitcnt lgkmcnt(0)
    v_bfe_u32 v247, v246, 0, 8
    v_lshlrev_b32 v247, 1, v247
    v_bfe_u32 v248, v246, 8, 8
    v_lshlrev_b32 v248, 1, v248
    v_bfe_u32 v249, v246, 16, 8
    v_lshlrev_b32 v249, 1, v249
    v_bfe_u32 v250, v246, 24, 8
    v_lshlrev_b32 v250, 1, v250
    buffer_load_ushort v247, v247, s[24:27], 0 offen
    buffer_load_ushort v248, v248, s[24:27], 0 offen
    buffer_load_ushort v249, v249, s[24:27], 0 offen
    buffer_load_ushort v250, v250, s[24:27], 0 offen
    s_waitcnt vmcnt(0)
    v_lshlrev_b32 v247, 16, v247
    v_mul_f32 v208, v208, v247
    v_lshlrev_b32 v248, 16, v248
    v_mul_f32 v209, v209, v248
    v_lshlrev_b32 v249, 16, v249
    v_mul_f32 v210, v210, v249
    v_lshlrev_b32 v250, 16, v250
    v_mul_f32 v211, v211, v250
    s_bitcmp1_b64 s[60:61], 4
    s_cbranch_scc1 Ls_wb3
Ls_wbd3:
    v_exp_f32 v132, v148
    v_exp_f32 v133, v149
    v_exp_f32 v134, v150
    v_exp_f32 v135, v151
    v_exp_f32 v136, v152
    v_exp_f32 v137, v153
    v_mfma_f32_4x4x4_16b_bf16 v[132:135], v[228:229], v[228:229], v[132:135]
    v_cvt_pk_bf16_f32 v208, v208, v209
    v_cvt_pk_bf16_f32 v209, v210, v211
    s_waitcnt lgkmcnt(2)
    v_mfma_f32_16x16x32_bf16 v[148:151], v[100:103], v[180:183], v[164:167]
    v_exp_f32 v138, v154
    v_mfma_f32_4x4x4_16b_bf16 v[212:215], v[208:209], v[188:189], v[212:215] cbsz:4 abid:0
    ds_read_b64_tr_b16 v[188:189], v236 offset:6240
    v_exp_f32 v139, v155
    v_mfma_f32_16x16x32_bf16 v[152:155], v[108:111], v[180:183], v[168:171]
    v_exp_f32 v140, v156
    v_mfma_f32_4x4x4_16b_bf16 v[212:215], v[208:209], v[190:191], v[212:215] cbsz:4 abid:4
    ds_read_b64_tr_b16 v[190:191], v236 offset:6752
    v_mfma_f32_4x4x4_16b_bf16 v[136:139], v[228:229], v[228:229], v[136:139]
    v_rcp_f32 v132, v132
    v_mfma_f32_4x4x4_16b_bf16 v[212:215], v[208:209], v[192:193], v[212:215] cbsz:4 abid:8
    ds_read_b64_tr_b16 v[192:193], v236 offset:7296
    v_exp_f32 v141, v157
    v_mfma_f32_16x16x32_bf16 v[148:151], v[104:107], v[184:187], v[148:151]
    v_rcp_f32 v133, v133
    v_mfma_f32_4x4x4_16b_bf16 v[212:215], v[208:209], v[194:195], v[212:215] cbsz:4 abid:12
    ds_read_b64_tr_b16 v[194:195], v236 offset:7808
    v_exp_f32 v142, v158
    v_mfma_f32_16x16x32_bf16 v[152:155], v[112:115], v[184:187], v[152:155]
    v_rcp_f32 v134, v134
    v_exp_f32 v143, v159
    v_rcp_f32 v135, v135
    v_cvt_pk_bf16_f32 v132, v132, v133
    v_mfma_f32_4x4x4_16b_bf16 v[140:143], v[228:229], v[228:229], v[140:143]
    v_exp_f32 v144, v160
    v_mfma_f32_16x16x32_bf16 v[156:159], v[116:119], v[180:183], v[172:175]
    v_rcp_f32 v136, v136
    v_cvt_pk_bf16_f32 v133, v134, v135
    s_bitcmp1_b64 s[56:57], 3
    s_cbranch_scc1 Ls_flush3
Ls_flushed3:
    v_exp_f32 v145, v161
    v_rcp_f32 v137, v137
    v_exp_f32 v146, v162
    s_bitcmp1_b64 s[60:61], 7
    s_cbranch_scc1 Ls_adv3
Ls_advd3:
    v_rcp_f32 v138, v138
    v_cvt_pk_bf16_f32 v134, v136, v137
    v_exp_f32 v147, v163
    v_mfma_f32_16x16x32_bf16 v[160:163], v[124:127], v[180:183], v[176:179]
    s_waitcnt lgkmcnt(0)
    s_add_u32 m0, s52, 6240
    v_rcp_f32 v139, v139
    buffer_load_dwordx4 v[230:231], s[20:23], 0 idxen offen nt lds
    v_mfma_f32_4x4x4_16b_bf16 v[144:147], v[228:229], v[228:229], v[144:147]
    v_mfma_f32_16x16x32_bf16 v[156:159], v[120:123], v[184:187], v[156:159]
    s_add_u32 m0, s52, 7296
    v_rcp_f32 v140, v140
    buffer_load_dwordx4 v[232:233], s[20:23], 0 idxen offen nt lds
    v_mfma_f32_16x16x32_bf16 v[160:163], v[128:131], v[184:187], v[160:163]
    v_rcp_f32 v141, v141
    v_cvt_pk_bf16_f32 v135, v138, v139
    s_waitcnt vmcnt(4)
    ds_read_b128 v[180:183], v234 offset:2080
    ds_read_b128 v[184:187], v235 offset:2080
    v_rcp_f32 v142, v142
    v_cvt_pk_bf16_f32 v136, v140, v141
    v_mfma_f32_16x16x32_bf16 v[208:211], v[132:135], v[196:199], v[204:207]
    v_rcp_f32 v143, v143
    s_lshr_b64 s[56:57], s[56:57], 4
    s_lshl_b64 s[86:87], s[58:59], 60
    s_or_b64 s[56:57], s[56:57], s[86:87]
    s_lshr_b64 s[58:59], s[58:59], 4
    s_lshr_b64 s[60:61], s[60:61], 4
    s_lshl_b64 s[86:87], s[62:63], 60
    s_or_b64 s[60:61], s[60:61], s[86:87]
    s_lshr_b64 s[62:63], s[62:63], 4
    v_add_u32 v237, 64, v237
    v_add_u32 v244, 64, v244
    v_rcp_f32 v144, v144
    v_cvt_pk_bf16_f32 v137, v142, v143
    v_rcp_f32 v145, v145
    v_rcp_f32 v146, v146
    v_rcp_f32 v147, v147
    v_cvt_pk_bf16_f32 v138, v144, v145
    v_cvt_pk_bf16_f32 v139, v146, v147
    s_branch Ls_loop
Ls_flush0:
    v_cvt_pk_bf16_f32 v246, v212, v212
    v_mov_b32 v212, 0
    s_sub_u32 s65, s65, 1
    ds_write_b16 v240, v246
    s_cbranch_scc1 L_store
    v_add_u32 v240, 128, v240
    s_add_u32 s24, s24, s32
    s_addc_u32 s25, s25, 0
    s_xor_b32 s32, s32, 0x18ffe0
    s_branch Ls_flushed0
Ls_wb0:
    v_mul_u32_u24 v216, v224, v241
    v_mul_u32_u24 v217, v224, v242
    v_mul_u32_u24 v218, v225, v241
    v_mul_u32_u24 v219, v225, v242
    v_mul_u32_u24 v220, v226, v241
    v_mul_u32_u24 v221, v226, v242
    v_mul_u32_u24 v222, v227, v241
    v_mul_u32_u24 v223, v227, v242
    v_add_u32 v238, 128, v238
    ds_read_b128 v[164:167], v239
    v_mfma_f32_4x4x4_16b_bf16 v[132:135], v[216:217], v[68:69], v[4:7]
    ds_read_b128 v[168:171], v239 offset:64
    ds_read_b128 v[172:175], v239 offset:128
    v_mfma_f32_4x4x4_16b_bf16 v[136:139], v[218:219], v[70:71], v[8:11]
    ds_read_b128 v[176:179], v239 offset:192
    ds_read_u16 v224, v238
    v_mfma_f32_4x4x4_16b_bf16 v[140:143], v[220:221], v[72:73], v[12:15]
    ds_read_u16 v225, v238 offset:8
    ds_read_u16 v226, v238 offset:64
    v_mfma_f32_4x4x4_16b_bf16 v[144:147], v[222:223], v[74:75], v[16:19]
    ds_read_u16 v227, v238 offset:72
    v_add_u32 v239, 256, v239
    v_mfma_f32_4x4x4_16b_bf16 v[246:249], v[216:217], v[76:77], v[20:23]
    v_cvt_pk_bf16_f32 v100, v132, v133
    v_cvt_pk_bf16_f32 v101, v134, v135
    v_mfma_f32_4x4x4_16b_bf16 v[250:253], v[218:219], v[78:79], v[24:27]
    v_cvt_pk_bf16_f32 v102, v136, v137
    v_cvt_pk_bf16_f32 v103, v138, v139
    v_mfma_f32_4x4x4_16b_bf16 v[132:135], v[220:221], v[80:81], v[28:31]
    v_cvt_pk_bf16_f32 v104, v140, v141
    v_cvt_pk_bf16_f32 v105, v142, v143
    v_mfma_f32_4x4x4_16b_bf16 v[136:139], v[222:223], v[82:83], v[32:35]
    v_cvt_pk_bf16_f32 v106, v144, v145
    v_cvt_pk_bf16_f32 v107, v146, v147
    v_mfma_f32_4x4x4_16b_bf16 v[140:143], v[216:217], v[84:85], v[36:39]
    v_cvt_pk_bf16_f32 v108, v246, v247
    v_cvt_pk_bf16_f32 v109, v248, v249
    v_mfma_f32_4x4x4_16b_bf16 v[144:147], v[218:219], v[86:87], v[40:43]
    v_cvt_pk_bf16_f32 v110, v250, v251
    v_cvt_pk_bf16_f32 v111, v252, v253
    v_mfma_f32_4x4x4_16b_bf16 v[246:249], v[220:221], v[88:89], v[44:47]
    v_cvt_pk_bf16_f32 v112, v132, v133
    v_cvt_pk_bf16_f32 v113, v134, v135
    v_mfma_f32_4x4x4_16b_bf16 v[250:253], v[222:223], v[90:91], v[48:51]
    v_cvt_pk_bf16_f32 v114, v136, v137
    v_cvt_pk_bf16_f32 v115, v138, v139
    v_mfma_f32_4x4x4_16b_bf16 v[132:135], v[216:217], v[92:93], v[52:55]
    v_cvt_pk_bf16_f32 v116, v140, v141
    v_cvt_pk_bf16_f32 v117, v142, v143
    v_mfma_f32_4x4x4_16b_bf16 v[136:139], v[218:219], v[94:95], v[56:59]
    v_cvt_pk_bf16_f32 v118, v144, v145
    v_cvt_pk_bf16_f32 v119, v146, v147
    v_mfma_f32_4x4x4_16b_bf16 v[140:143], v[220:221], v[96:97], v[60:63]
    v_cvt_pk_bf16_f32 v120, v246, v247
    v_cvt_pk_bf16_f32 v121, v248, v249
    v_mfma_f32_4x4x4_16b_bf16 v[144:147], v[222:223], v[98:99], v[64:67]
    v_cvt_pk_bf16_f32 v122, v250, v251
    v_cvt_pk_bf16_f32 v123, v252, v253
    v_cvt_pk_bf16_f32 v124, v132, v133
    v_cvt_pk_bf16_f32 v125, v134, v135
    v_cvt_pk_bf16_f32 v126, v136, v137
    v_cvt_pk_bf16_f32 v127, v138, v139
    v_cvt_pk_bf16_f32 v128, v140, v141
    v_cvt_pk_bf16_f32 v129, v142, v143
    v_cvt_pk_bf16_f32 v130, v144, v145
    v_cvt_pk_bf16_f32 v131, v146, v147
    s_waitcnt lgkmcnt(0)
    s_branch Ls_wbd0
Ls_adv0:
    s_add_u32 s20, s20, s31
    s_addc_u32 s21, s21, 0
    s_xor_b32 s31, s31, 0x63ff800
    s_branch Ls_advd0
Ls_flush1:
    v_cvt_pk_bf16_f32 v246, v212, v212
    v_mov_b32 v212, 0
    s_sub_u32 s65, s65, 1
    ds_write_b16 v240, v246
    s_cbranch_scc1 L_store
    v_add_u32 v240, 128, v240
    s_add_u32 s24, s24, s32
    s_addc_u32 s25, s25, 0
    s_xor_b32 s32, s32, 0x18ffe0
    s_branch Ls_flushed1
Ls_wb1:
    v_mul_u32_u24 v216, v224, v241
    v_mul_u32_u24 v217, v224, v242
    v_mul_u32_u24 v218, v225, v241
    v_mul_u32_u24 v219, v225, v242
    v_mul_u32_u24 v220, v226, v241
    v_mul_u32_u24 v221, v226, v242
    v_mul_u32_u24 v222, v227, v241
    v_mul_u32_u24 v223, v227, v242
    v_add_u32 v238, 128, v238
    ds_read_b128 v[164:167], v239
    v_mfma_f32_4x4x4_16b_bf16 v[132:135], v[216:217], v[68:69], v[4:7]
    ds_read_b128 v[168:171], v239 offset:64
    ds_read_b128 v[172:175], v239 offset:128
    v_mfma_f32_4x4x4_16b_bf16 v[136:139], v[218:219], v[70:71], v[8:11]
    ds_read_b128 v[176:179], v239 offset:192
    ds_read_u16 v224, v238
    v_mfma_f32_4x4x4_16b_bf16 v[140:143], v[220:221], v[72:73], v[12:15]
    ds_read_u16 v225, v238 offset:8
    ds_read_u16 v226, v238 offset:64
    v_mfma_f32_4x4x4_16b_bf16 v[144:147], v[222:223], v[74:75], v[16:19]
    ds_read_u16 v227, v238 offset:72
    v_add_u32 v239, 256, v239
    v_mfma_f32_4x4x4_16b_bf16 v[246:249], v[216:217], v[76:77], v[20:23]
    v_cvt_pk_bf16_f32 v100, v132, v133
    v_cvt_pk_bf16_f32 v101, v134, v135
    v_mfma_f32_4x4x4_16b_bf16 v[250:253], v[218:219], v[78:79], v[24:27]
    v_cvt_pk_bf16_f32 v102, v136, v137
    v_cvt_pk_bf16_f32 v103, v138, v139
    v_mfma_f32_4x4x4_16b_bf16 v[132:135], v[220:221], v[80:81], v[28:31]
    v_cvt_pk_bf16_f32 v104, v140, v141
    v_cvt_pk_bf16_f32 v105, v142, v143
    v_mfma_f32_4x4x4_16b_bf16 v[136:139], v[222:223], v[82:83], v[32:35]
    v_cvt_pk_bf16_f32 v106, v144, v145
    v_cvt_pk_bf16_f32 v107, v146, v147
    v_mfma_f32_4x4x4_16b_bf16 v[140:143], v[216:217], v[84:85], v[36:39]
    v_cvt_pk_bf16_f32 v108, v246, v247
    v_cvt_pk_bf16_f32 v109, v248, v249
    v_mfma_f32_4x4x4_16b_bf16 v[144:147], v[218:219], v[86:87], v[40:43]
    v_cvt_pk_bf16_f32 v110, v250, v251
    v_cvt_pk_bf16_f32 v111, v252, v253
    v_mfma_f32_4x4x4_16b_bf16 v[246:249], v[220:221], v[88:89], v[44:47]
    v_cvt_pk_bf16_f32 v112, v132, v133
    v_cvt_pk_bf16_f32 v113, v134, v135
    v_mfma_f32_4x4x4_16b_bf16 v[250:253], v[222:223], v[90:91], v[48:51]
    v_cvt_pk_bf16_f32 v114, v136, v137
    v_cvt_pk_bf16_f32 v115, v138, v139
    v_mfma_f32_4x4x4_16b_bf16 v[132:135], v[216:217], v[92:93], v[52:55]
    v_cvt_pk_bf16_f32 v116, v140, v141
    v_cvt_pk_bf16_f32 v117, v142, v143
    v_mfma_f32_4x4x4_16b_bf16 v[136:139], v[218:219], v[94:95], v[56:59]
    v_cvt_pk_bf16_f32 v118, v144, v145
    v_cvt_pk_bf16_f32 v119, v146, v147
    v_mfma_f32_4x4x4_16b_bf16 v[140:143], v[220:221], v[96:97], v[60:63]
    v_cvt_pk_bf16_f32 v120, v246, v247
    v_cvt_pk_bf16_f32 v121, v248, v249
    v_mfma_f32_4x4x4_16b_bf16 v[144:147], v[222:223], v[98:99], v[64:67]
    v_cvt_pk_bf16_f32 v122, v250, v251
    v_cvt_pk_bf16_f32 v123, v252, v253
    v_cvt_pk_bf16_f32 v124, v132, v133
    v_cvt_pk_bf16_f32 v125, v134, v135
    v_cvt_pk_bf16_f32 v126, v136, v137
    v_cvt_pk_bf16_f32 v127, v138, v139
    v_cvt_pk_bf16_f32 v128, v140, v141
    v_cvt_pk_bf16_f32 v129, v142, v143
    v_cvt_pk_bf16_f32 v130, v144, v145
    v_cvt_pk_bf16_f32 v131, v146, v147
    s_waitcnt lgkmcnt(0)
    s_branch Ls_wbd1
Ls_adv1:
    s_add_u32 s20, s20, s31
    s_addc_u32 s21, s21, 0
    s_xor_b32 s31, s31, 0x63ff800
    s_branch Ls_advd1
Ls_flush2:
    v_cvt_pk_bf16_f32 v246, v212, v212
    v_mov_b32 v212, 0
    s_sub_u32 s65, s65, 1
    ds_write_b16 v240, v246
    s_cbranch_scc1 L_store
    v_add_u32 v240, 128, v240
    s_add_u32 s24, s24, s32
    s_addc_u32 s25, s25, 0
    s_xor_b32 s32, s32, 0x18ffe0
    s_branch Ls_flushed2
Ls_wb2:
    v_mul_u32_u24 v216, v224, v241
    v_mul_u32_u24 v217, v224, v242
    v_mul_u32_u24 v218, v225, v241
    v_mul_u32_u24 v219, v225, v242
    v_mul_u32_u24 v220, v226, v241
    v_mul_u32_u24 v221, v226, v242
    v_mul_u32_u24 v222, v227, v241
    v_mul_u32_u24 v223, v227, v242
    v_add_u32 v238, 128, v238
    ds_read_b128 v[164:167], v239
    v_mfma_f32_4x4x4_16b_bf16 v[132:135], v[216:217], v[68:69], v[4:7]
    ds_read_b128 v[168:171], v239 offset:64
    ds_read_b128 v[172:175], v239 offset:128
    v_mfma_f32_4x4x4_16b_bf16 v[136:139], v[218:219], v[70:71], v[8:11]
    ds_read_b128 v[176:179], v239 offset:192
    ds_read_u16 v224, v238
    v_mfma_f32_4x4x4_16b_bf16 v[140:143], v[220:221], v[72:73], v[12:15]
    ds_read_u16 v225, v238 offset:8
    ds_read_u16 v226, v238 offset:64
    v_mfma_f32_4x4x4_16b_bf16 v[144:147], v[222:223], v[74:75], v[16:19]
    ds_read_u16 v227, v238 offset:72
    v_add_u32 v239, 256, v239
    v_mfma_f32_4x4x4_16b_bf16 v[246:249], v[216:217], v[76:77], v[20:23]
    v_cvt_pk_bf16_f32 v100, v132, v133
    v_cvt_pk_bf16_f32 v101, v134, v135
    v_mfma_f32_4x4x4_16b_bf16 v[250:253], v[218:219], v[78:79], v[24:27]
    v_cvt_pk_bf16_f32 v102, v136, v137
    v_cvt_pk_bf16_f32 v103, v138, v139
    v_mfma_f32_4x4x4_16b_bf16 v[132:135], v[220:221], v[80:81], v[28:31]
    v_cvt_pk_bf16_f32 v104, v140, v141
    v_cvt_pk_bf16_f32 v105, v142, v143
    v_mfma_f32_4x4x4_16b_bf16 v[136:139], v[222:223], v[82:83], v[32:35]
    v_cvt_pk_bf16_f32 v106, v144, v145
    v_cvt_pk_bf16_f32 v107, v146, v147
    v_mfma_f32_4x4x4_16b_bf16 v[140:143], v[216:217], v[84:85], v[36:39]
    v_cvt_pk_bf16_f32 v108, v246, v247
    v_cvt_pk_bf16_f32 v109, v248, v249
    v_mfma_f32_4x4x4_16b_bf16 v[144:147], v[218:219], v[86:87], v[40:43]
    v_cvt_pk_bf16_f32 v110, v250, v251
    v_cvt_pk_bf16_f32 v111, v252, v253
    v_mfma_f32_4x4x4_16b_bf16 v[246:249], v[220:221], v[88:89], v[44:47]
    v_cvt_pk_bf16_f32 v112, v132, v133
    v_cvt_pk_bf16_f32 v113, v134, v135
    v_mfma_f32_4x4x4_16b_bf16 v[250:253], v[222:223], v[90:91], v[48:51]
    v_cvt_pk_bf16_f32 v114, v136, v137
    v_cvt_pk_bf16_f32 v115, v138, v139
    v_mfma_f32_4x4x4_16b_bf16 v[132:135], v[216:217], v[92:93], v[52:55]
    v_cvt_pk_bf16_f32 v116, v140, v141
    v_cvt_pk_bf16_f32 v117, v142, v143
    v_mfma_f32_4x4x4_16b_bf16 v[136:139], v[218:219], v[94:95], v[56:59]
    v_cvt_pk_bf16_f32 v118, v144, v145
    v_cvt_pk_bf16_f32 v119, v146, v147
    v_mfma_f32_4x4x4_16b_bf16 v[140:143], v[220:221], v[96:97], v[60:63]
    v_cvt_pk_bf16_f32 v120, v246, v247
    v_cvt_pk_bf16_f32 v121, v248, v249
    v_mfma_f32_4x4x4_16b_bf16 v[144:147], v[222:223], v[98:99], v[64:67]
    v_cvt_pk_bf16_f32 v122, v250, v251
    v_cvt_pk_bf16_f32 v123, v252, v253
    v_cvt_pk_bf16_f32 v124, v132, v133
    v_cvt_pk_bf16_f32 v125, v134, v135
    v_cvt_pk_bf16_f32 v126, v136, v137
    v_cvt_pk_bf16_f32 v127, v138, v139
    v_cvt_pk_bf16_f32 v128, v140, v141
    v_cvt_pk_bf16_f32 v129, v142, v143
    v_cvt_pk_bf16_f32 v130, v144, v145
    v_cvt_pk_bf16_f32 v131, v146, v147
    s_waitcnt lgkmcnt(0)
    s_branch Ls_wbd2
Ls_adv2:
    s_add_u32 s20, s20, s31
    s_addc_u32 s21, s21, 0
    s_xor_b32 s31, s31, 0x63ff800
    s_branch Ls_advd2
Ls_flush3:
    v_cvt_pk_bf16_f32 v246, v212, v212
    v_mov_b32 v212, 0
    s_sub_u32 s65, s65, 1
    ds_write_b16 v240, v246
    s_cbranch_scc1 L_store
    v_add_u32 v240, 128, v240
    s_add_u32 s24, s24, s32
    s_addc_u32 s25, s25, 0
    s_xor_b32 s32, s32, 0x18ffe0
    s_branch Ls_flushed3
Ls_wb3:
    v_mul_u32_u24 v216, v224, v241
    v_mul_u32_u24 v217, v224, v242
    v_mul_u32_u24 v218, v225, v241
    v_mul_u32_u24 v219, v225, v242
    v_mul_u32_u24 v220, v226, v241
    v_mul_u32_u24 v221, v226, v242
    v_mul_u32_u24 v222, v227, v241
    v_mul_u32_u24 v223, v227, v242
    v_add_u32 v238, 128, v238
    ds_read_b128 v[164:167], v239
    v_mfma_f32_4x4x4_16b_bf16 v[132:135], v[216:217], v[68:69], v[4:7]
    ds_read_b128 v[168:171], v239 offset:64
    ds_read_b128 v[172:175], v239 offset:128
    v_mfma_f32_4x4x4_16b_bf16 v[136:139], v[218:219], v[70:71], v[8:11]
    ds_read_b128 v[176:179], v239 offset:192
    ds_read_u16 v224, v238
    v_mfma_f32_4x4x4_16b_bf16 v[140:143], v[220:221], v[72:73], v[12:15]
    ds_read_u16 v225, v238 offset:8
    ds_read_u16 v226, v238 offset:64
    v_mfma_f32_4x4x4_16b_bf16 v[144:147], v[222:223], v[74:75], v[16:19]
    ds_read_u16 v227, v238 offset:72
    v_add_u32 v239, 256, v239
    v_mfma_f32_4x4x4_16b_bf16 v[246:249], v[216:217], v[76:77], v[20:23]
    v_cvt_pk_bf16_f32 v100, v132, v133
    v_cvt_pk_bf16_f32 v101, v134, v135
    v_mfma_f32_4x4x4_16b_bf16 v[250:253], v[218:219], v[78:79], v[24:27]
    v_cvt_pk_bf16_f32 v102, v136, v137
    v_cvt_pk_bf16_f32 v103, v138, v139
    v_mfma_f32_4x4x4_16b_bf16 v[132:135], v[220:221], v[80:81], v[28:31]
    v_cvt_pk_bf16_f32 v104, v140, v141
    v_cvt_pk_bf16_f32 v105, v142, v143
    v_mfma_f32_4x4x4_16b_bf16 v[136:139], v[222:223], v[82:83], v[32:35]
    v_cvt_pk_bf16_f32 v106, v144, v145
    v_cvt_pk_bf16_f32 v107, v146, v147
    v_mfma_f32_4x4x4_16b_bf16 v[140:143], v[216:217], v[84:85], v[36:39]
    v_cvt_pk_bf16_f32 v108, v246, v247
    v_cvt_pk_bf16_f32 v109, v248, v249
    v_mfma_f32_4x4x4_16b_bf16 v[144:147], v[218:219], v[86:87], v[40:43]
    v_cvt_pk_bf16_f32 v110, v250, v251
    v_cvt_pk_bf16_f32 v111, v252, v253
    v_mfma_f32_4x4x4_16b_bf16 v[246:249], v[220:221], v[88:89], v[44:47]
    v_cvt_pk_bf16_f32 v112, v132, v133
    v_cvt_pk_bf16_f32 v113, v134, v135
    v_mfma_f32_4x4x4_16b_bf16 v[250:253], v[222:223], v[90:91], v[48:51]
    v_cvt_pk_bf16_f32 v114, v136, v137
    v_cvt_pk_bf16_f32 v115, v138, v139
    v_mfma_f32_4x4x4_16b_bf16 v[132:135], v[216:217], v[92:93], v[52:55]
    v_cvt_pk_bf16_f32 v116, v140, v141
    v_cvt_pk_bf16_f32 v117, v142, v143
    v_mfma_f32_4x4x4_16b_bf16 v[136:139], v[218:219], v[94:95], v[56:59]
    v_cvt_pk_bf16_f32 v118, v144, v145
    v_cvt_pk_bf16_f32 v119, v146, v147
    v_mfma_f32_4x4x4_16b_bf16 v[140:143], v[220:221], v[96:97], v[60:63]
    v_cvt_pk_bf16_f32 v120, v246, v247
    v_cvt_pk_bf16_f32 v121, v248, v249
    v_mfma_f32_4x4x4_16b_bf16 v[144:147], v[222:223], v[98:99], v[64:67]
    v_cvt_pk_bf16_f32 v122, v250, v251
    v_cvt_pk_bf16_f32 v123, v252, v253
    v_cvt_pk_bf16_f32 v124, v132, v133
    v_cvt_pk_bf16_f32 v125, v134, v135
    v_cvt_pk_bf16_f32 v126, v136, v137
    v_cvt_pk_bf16_f32 v127, v138, v139
    v_cvt_pk_bf16_f32 v128, v140, v141
    v_cvt_pk_bf16_f32 v129, v142, v143
    v_cvt_pk_bf16_f32 v130, v144, v145
    v_cvt_pk_bf16_f32 v131, v146, v147
    s_waitcnt lgkmcnt(0)
    s_branch Ls_wbd3
Ls_adv3:
    s_add_u32 s20, s20, s31
    s_addc_u32 s21, s21, 0
    s_xor_b32 s31, s31, 0x63ff800
    s_branch Ls_advd3
.section .rodata,"a"
.p2align 6
.amdhsa_kernel standalone__sequential_behavior_din__recsys_kernel
  .amdhsa_next_free_vgpr 256
  .amdhsa_next_free_sgpr 102
  .amdhsa_accum_offset 256
  .amdhsa_group_segment_fixed_size 0
  .amdhsa_kernarg_size 80
  .amdhsa_user_sgpr_count 2
  .amdhsa_user_sgpr_kernarg_segment_ptr 1
  .amdhsa_system_sgpr_workgroup_id_x 1
.end_amdhsa_kernel
```

```asm
; @launch grid=(256,1,1) block=(512,1,1) lds=163840
.amdgcn_target "amdgcn-amd-amdhsa--gfx950"
.text
.globl standalone__sequential_behavior_din__recsys_kernel
.p2align 8
.type standalone__sequential_behavior_din__recsys_kernel,@function
standalone__sequential_behavior_din__recsys_kernel:
    s_load_dwordx16 s[4:19], s[0:1], 0
    s_cmp_ge_u32 s2, 256
    s_cbranch_scc1 L_end
    v_lshrrev_b32 v1, 6, v0
    v_and_b32 v0, 63, v0
    v_readfirstlane_b32 s54, v1
    s_lshl_b32 s53, s2, 3
    v_lshlrev_b32 v2, 4, v0
    s_bfm_b64 s[28:29], 50, 0
    s_add_u32 s53, s53, s54
    s_mul_i32 s66, s53, 800
    s_mul_i32 s52, s54, 20480
    v_add_u32 v3, s66, v2
    v_and_b32 v248, 16, v0
    v_lshlrev_b32 v246, 1, v248
    v_xor_b32 v246, v246, v2
    s_lshl_b32 s67, s54, 12
    s_add_u32 m0, s52, 4160
    s_mov_b64 exec, s[28:29]
    s_waitcnt lgkmcnt(0)
    global_load_dwordx4 v[100:103], v3, s[8:9] nt
    s_mov_b64 exec, -1
    s_add_u32 s10, s10, s67
    s_addc_u32 s11, s11, 0
    v_xor_b32 v247, 64, v246
    global_load_lds_dwordx4 v246, s[10:11] offset:0
    global_load_lds_dwordx4 v247, s[10:11] offset:1024
    global_load_lds_dwordx4 v246, s[10:11] offset:2048
    global_load_lds_dwordx4 v247, s[10:11] offset:3072
    s_load_dword s30, s[16:17], 0
    v_lshrrev_b32 v1, 4, v0
    v_and_b32 v243, 0xf0, v2
    v_lshl_add_u32 v243, v1, 19, v243
    s_lshl_b32 s66, s53, 8
    s_add_u32 m0, s52, 8320
    v_add_u32 v243, s66, v243
    s_and_b32 s67, s54, 3
    global_load_lds_dwordx4 v243, s[4:5] nt
    s_lshl_b32 s66, s67, 5
    v_lshl_add_u32 v249, v1, 3, s66
    global_load_dwordx2 v[96:97], v249, s[12:13]
    v_and_b32 v250, 3, v0
    s_mul_i32 s66, s53, 51200
    s_add_u32 s6, s6, s66
    s_addc_u32 s7, s7, 0
    s_mov_b32 s20, s6
    s_and_b32 s21, s7, 0xffff
    s_or_b32 s21, s21, 0x800000
    s_mov_b32 s22, 200
    s_mov_b32 s23, 0x20000
    s_movk_i32 s31, 25600
    v_mov_b32 v148, -1
    v_mov_b32 v149, -1
    v_mov_b32 v150, -1
    v_mov_b32 v151, -1
    s_add_u32 s66, s52, 18416
    v_add_u32 v152, s66, v2
    ds_write_b128 v152, v[148:151]
    ds_write_b128 v152, v[148:151] offset:1024
    s_add_u32 s64, s52, 18432
    v_lshrrev_b32 v237, 3, v0
    v_add_u32 v237, s64, v237
    v_lshl_add_u32 v244, v1, 2, s66
    v_and_b32 v231, 0x70, v2
    v_lshlrev_b32 v248, 2, v248
    v_xor_b32 v231, v231, v248
    v_mov_b32 v233, v231
    v_cmp_lt_u32 vcc, 24, v0
    v_mov_b32 v146, 0
    v_mov_b32 v147, 0
    v_cndmask_b32 v145, 0, 1, vcc
    v_mul_u32_u24 v142, 25, v145
    v_sub_u32 v142, v0, v142
    v_mul_u32_u24 v142, 0x80008, v142
    v_add_u32 v141, 0x10000, v142
    v_add_u32 v143, 0x50004, v142
    v_add_u32 v144, 0x70006, v142
    v_add_u32 v142, 0x30002, v142
    s_mov_b64 s[56:57], 0
    s_mov_b64 s[58:59], 0
    s_mov_b32 s60, 7
    s_mov_b32 s61, 7
    s_mov_b32 s92, 0xbfb8aa3b
    v_and_b32 v251, 15, v0
    v_bfe_u32 v252, v0, 2, 2
    v_and_b32 v246, 8, v0
    v_lshlrev_b32 v246, 2, v246
    v_lshl_add_u32 v246, v251, 7, v246
    v_add_u32 v246, s52, v246
    v_and_b32 v247, 2, v0
    v_lshlrev_b32 v248, 1, v247
    v_xor_b32 v248, v248, v1
    v_lshl_add_u32 v234, v248, 4, v246
    v_xor_b32 v248, 4, v248
    v_lshl_add_u32 v235, v248, 4, v246
    v_lshlrev_b32 v253, 3, v250
    v_lshl_add_u32 v253, v252, 7, v253
    v_and_b32 v246, 8, v0
    v_lshlrev_b32 v247, 3, v246
    v_lshl_add_u32 v248, v1, 5, v253
    v_xor_b32 v248, v248, v247
    v_add_u32 v236, s52, v248
    v_lshlrev_b32 v246, 2, v246
    v_xor_b32 v253, v253, v246
    v_and_b32 v246, 16, v0
    v_lshlrev_b32 v246, 2, v246
    v_xor_b32 v253, v253, v246
    v_lshl_add_u32 v253, v1, 10, v253
    s_lshl_b32 s66, s67, 5
    v_xor_b32 v66, s66, v253
    v_add_u32 v66, 45120, v66
    s_lshr_b32 s66, s54, 1
    s_lshl_b32 s66, s66, 5
    v_xor_b32 v64, s66, v253
    s_and_b32 s66, s54, 1
    s_mul_i32 s66, s66, 20480
    s_add_u32 s66, s66, 4160
    v_add_u32 v64, s66, v64
    v_add_u32 v65, 81920, v64
    s_add_u32 s66, s52, 8320
    v_lshl_add_u32 v238, v250, 1, s66
    v_lshl_add_u32 v238, v1, 4, v238
    v_lshl_add_u32 v240, v0, 1, s66
    s_add_u32 s66, s52, 9344
    v_lshl_add_u32 v239, v1, 4, s66
    s_and_b32 s66, s54, 4
    v_lshrrev_b32 v246, 3, v251
    v_add_u32 v246, s66, v246
    v_mul_u32_u24 v246, 20480, v246
    v_lshl_add_u32 v246, v1, 4, v246
    v_and_b32 v247, 7, v0
    v_lshl_add_u32 v67, v247, 7, v246
    v_lshl_add_u32 v98, v247, 8, v246
    s_lshl_b32 s66, s67, 6
    s_add_u32 s66, s66, 9344
    v_add_u32 v98, s66, v98
    v_and_b32 v246, 1, v0
    v_lshlrev_b32 v246, 4, v246
    v_lshlrev_b32 v246, v246, 1
    v_cmp_gt_u32 vcc, 2, v250
    v_mov_b32 v229, 0
    v_mov_b32 v228, 0x3f80
    v_cndmask_b32 v241, 0, v246, vcc
    v_cmp_eq_u32 vcc, 0, v251
    v_sub_u32 v242, v246, v241
    v_mul_u32_u24 v218, 0x3f80, v241
    v_cndmask_b32 v220, 0, -1, vcc
    v_mul_u32_u24 v219, 0x3f80, v242
    s_and_b32 s66, s54, 3
    s_mul_i32 s66, s66, 20480
    s_add_u32 s66, s66, 14464
    v_mov_b32 v221, s66
    s_cmp_ge_u32 s54, 4
    s_cselect_b32 s33, -1, 0
    ds_write_b32 v221, v229
    s_mov_b64 exec, s[28:29]
    v_add_u32 v3, 1638400, v3
    global_load_dwordx4 v[104:107], v3, s[8:9] nt
    v_add_u32 v3, 1638400, v3
    global_load_dwordx4 v[108:111], v3, s[8:9] nt
    v_add_u32 v3, 1638400, v3
    global_load_dwordx4 v[112:115], v3, s[8:9] nt
    s_mov_b64 exec, -1
    v_lshlrev_b32 v249, 3, v1
    v_lshl_add_u32 v249, v250, 5, v249
    global_load_dwordx2 v[216:217], v249, s[14:15]
    s_waitcnt vmcnt(4) lgkmcnt(0)
    s_barrier
    ds_read_b64_tr_b16 v[16:17], v66 offset:0
    ds_read_b64_tr_b16 v[18:19], v66 offset:512
    ds_read_b64_tr_b16 v[20:21], v66 offset:20480
    ds_read_b64_tr_b16 v[22:23], v66 offset:20992
    ds_read_b64_tr_b16 v[24:25], v66 offset:40960
    ds_read_b64_tr_b16 v[26:27], v66 offset:41472
    ds_read_b64_tr_b16 v[28:29], v66 offset:61440
    ds_read_b64_tr_b16 v[30:31], v66 offset:61952
    ds_read_b128 v[32:35], v67 offset:8320
    ds_read_b128 v[36:39], v67 offset:8384
    ds_read_b128 v[40:43], v67 offset:49280
    ds_read_b128 v[44:47], v67 offset:49344
    ds_read_b64_tr_b16 v[4:5], v64 offset:0
    ds_read_b64_tr_b16 v[8:9], v65 offset:0
    ds_read_b64_tr_b16 v[12:13], v65 offset:40960
    ds_read_b64_tr_b16 v[6:7], v64 offset:512
    ds_read_b64_tr_b16 v[10:11], v65 offset:512
    ds_read_b64_tr_b16 v[14:15], v65 offset:41472
    v_lshlrev_b32 v48, 16, v96
    v_and_b32 v49, 0xffff0000, v96
    v_lshlrev_b32 v50, 16, v97
    v_and_b32 v51, 0xffff0000, v97
    s_mov_b64 exec, s[28:29]
    v_cmp_neq_f16_sdwa s[68:69], v100, 0 src0_sel:WORD_0 src1_sel:WORD_0
    v_cmp_neq_f16_sdwa s[70:71], v100, 0 src0_sel:WORD_1 src1_sel:WORD_0
    v_cmp_neq_f16_sdwa s[72:73], v101, 0 src0_sel:WORD_0 src1_sel:WORD_0
    v_cmp_neq_f16_sdwa s[74:75], v101, 0 src0_sel:WORD_1 src1_sel:WORD_0
    v_cmp_neq_f16_sdwa s[76:77], v102, 0 src0_sel:WORD_0 src1_sel:WORD_0
    v_cmp_neq_f16_sdwa s[78:79], v102, 0 src0_sel:WORD_1 src1_sel:WORD_0
    v_cmp_neq_f16_sdwa s[80:81], v103, 0 src0_sel:WORD_0 src1_sel:WORD_0
    v_cmp_neq_f16_sdwa s[82:83], v103, 0 src0_sel:WORD_1 src1_sel:WORD_0
    v_sad_u16 v147, v100, 0, v147
    v_sad_u16 v147, v101, 0, v147
    v_sad_u16 v147, v102, 0, v147
    v_sad_u16 v147, v103, 0, v147
    v_or3_b32 v146, v100, v101, v146
    v_or3_b32 v146, v102, v103, v146
    s_mov_b64 exec, -1
    v_mov_b32 v132, s64
    v_mbcnt_lo_u32_b32 v132, s68, v132
    v_mbcnt_hi_u32_b32 v132, s69, v132
    v_mbcnt_lo_u32_b32 v132, s70, v132
    v_mbcnt_hi_u32_b32 v132, s71, v132
    v_mbcnt_lo_u32_b32 v132, s72, v132
    v_mbcnt_hi_u32_b32 v132, s73, v132
    v_mbcnt_lo_u32_b32 v132, s74, v132
    v_mbcnt_hi_u32_b32 v132, s75, v132
    v_mbcnt_lo_u32_b32 v132, s76, v132
    v_mbcnt_hi_u32_b32 v132, s77, v132
    v_mbcnt_lo_u32_b32 v132, s78, v132
    v_mbcnt_hi_u32_b32 v132, s79, v132
    v_mbcnt_lo_u32_b32 v132, s80, v132
    v_mbcnt_hi_u32_b32 v132, s81, v132
    v_mbcnt_lo_u32_b32 v132, s82, v132
    v_mbcnt_hi_u32_b32 v132, s83, v132
    s_add_u32 s34, s64, 16
    v_readlane_b32 s66, v132, 25
    v_readlane_b32 s67, v132, 63
    s_add_u32 s64, s66, 15
    s_and_b32 s64, s64, -16
    s_max_u32 s64, s64, s34
    s_sub_u32 s66, s64, s66
    v_mad_u32_u24 v132, v145, s66, v132
    s_lshr_b32 s35, s64, 4
    s_bitset1_b64 s[56:57], s35
    v_addc_co_u32 v133, vcc, 0, v132, s[68:69]
    v_addc_co_u32 v134, vcc, 0, v133, s[70:71]
    v_addc_co_u32 v135, vcc, 0, v134, s[72:73]
    v_addc_co_u32 v136, vcc, 0, v135, s[74:75]
    v_addc_co_u32 v137, vcc, 0, v136, s[76:77]
    v_addc_co_u32 v138, vcc, 0, v137, s[78:79]
    v_addc_co_u32 v139, vcc, 0, v138, s[80:81]
    v_addc_co_u32 v140, vcc, 0, v139, s[82:83]
    s_add_u32 s67, s67, s66
    s_add_u32 s67, s67, 15
    s_and_b32 s67, s67, -16
    s_add_u32 s64, s64, 16
    s_max_u32 s64, s64, s67
    s_mov_b64 exec, s[68:69]
    ds_write_b8 v132, v141
    s_mov_b64 exec, s[70:71]
    ds_write_b8_d16_hi v133, v141
    s_mov_b64 exec, s[72:73]
    ds_write_b8 v134, v142
    s_mov_b64 exec, s[74:75]
    ds_write_b8_d16_hi v135, v142
    s_mov_b64 exec, s[76:77]
    ds_write_b8 v136, v143
    s_mov_b64 exec, s[78:79]
    ds_write_b8_d16_hi v137, v143
    s_mov_b64 exec, s[80:81]
    ds_write_b8 v138, v144
    s_mov_b64 exec, s[82:83]
    ds_write_b8_d16_hi v139, v144
    s_mov_b64 exec, -1
    v_sub_u32 v140, v132, v140
    s_movk_i32 s66, 0x3f80
    v_mad_i32_i24 v147, v140, s66, v147
    s_lshr_b32 s35, s64, 4
    s_bitset1_b64 s[56:57], s35
    s_add_u32 s66, s52, 18496
    s_cmp_ge_u32 s64, s66
    s_cselect_b32 s94, 1, 0
    s_cbranch_scc1 L_early
    s_waitcnt vmcnt(0)
L_early:
    ds_read_u8 v148, v237 offset:0
    ds_read_u8 v149, v237 offset:8
    ds_read_u8 v150, v237 offset:16
    ds_read_u8 v151, v237 offset:24
    ds_read_u8 v152, v237 offset:32
    ds_read_u8 v153, v237 offset:40
    ds_read_u8 v154, v237 offset:48
    ds_read_u8 v155, v237 offset:56
    s_waitcnt lgkmcnt(0)
    s_cmp_eq_u32 s94, 0
    s_cbranch_scc1 L_skip0
    s_add_u32 m0, s52, 0
    v_mov_b32 v230, v148
    v_mov_b32 v232, v149
    buffer_load_dwordx4 v[230:231], s[20:23], 0 idxen offen nt lds
    s_add_u32 m0, s52, 1056
    s_nop 0
    buffer_load_dwordx4 v[232:233], s[20:23], 0 idxen offen nt lds
    s_bitcmp0_b64 s[56:57], 1
    s_cbranch_scc1 L_noadve1
    s_sub_u32 s60, s60, 1
    s_cselect_b32 s31, 0, s31
    s_add_u32 s20, s20, s31
    s_addc_u32 s21, s21, 0
    s_xor_b32 s31, s31, 0x63ff800
L_noadve1:
    s_add_u32 m0, s52, 2080
    v_mov_b32 v230, v150
    v_mov_b32 v232, v151
    buffer_load_dwordx4 v[230:231], s[20:23], 0 idxen offen nt lds
    s_add_u32 m0, s52, 3136
    s_nop 0
    buffer_load_dwordx4 v[232:233], s[20:23], 0 idxen offen nt lds
L_skip0:
    s_waitcnt lgkmcnt(0)
    v_xor_b32 v24, 0x80008000, v24
    v_xor_b32 v25, 0x80008000, v25
    v_xor_b32 v26, 0x80008000, v26
    v_xor_b32 v27, 0x80008000, v27
    v_xor_b32 v28, 0x80008000, v28
    v_xor_b32 v29, 0x80008000, v29
    v_xor_b32 v30, 0x80008000, v30
    v_xor_b32 v31, 0x80008000, v31
    v_mfma_f32_4x4x4_16b_bf16 v[56:59], v[218:219], v[4:5], 0
    v_mfma_f32_4x4x4_16b_bf16 v[68:71], v[218:219], v[12:13], 0
    v_mfma_f32_4x4x4_16b_bf16 v[60:63], v[218:219], v[6:7], 0
    v_mfma_f32_4x4x4_16b_bf16 v[72:75], v[218:219], v[14:15], 0
    v_mfma_f32_4x4x4_16b_bf16 v[56:59], v[218:219], v[8:9], v[56:59]
    v_mfma_f32_4x4x4_16b_bf16 v[60:63], v[218:219], v[10:11], v[60:63]
    v_mfma_f32_16x16x32_bf16 v[52:55], v[16:19], v[40:43], v[48:51]
    v_mfma_f32_16x16x32_bf16 v[52:55], v[20:23], v[44:47], v[52:55]
    v_mfma_f32_16x16x32_bf16 v[52:55], v[24:27], v[40:43], v[52:55]
    v_mfma_f32_16x16x32_bf16 v[52:55], v[28:31], v[44:47], v[52:55]
    v_mfma_f32_16x16x32_bf16 v[48:51], v[16:19], v[32:35], v[48:51]
    v_mfma_f32_16x16x32_bf16 v[48:51], v[20:23], v[36:39], v[48:51]
    v_mfma_f32_16x16x32_bf16 v[48:51], v[24:27], v[32:35], v[48:51]
    v_mfma_f32_16x16x32_bf16 v[48:51], v[28:31], v[36:39], v[48:51]
    v_mul_f32 v56, s92, v56
    v_mul_f32 v57, s92, v57
    v_mul_f32 v58, s92, v58
    v_mul_f32 v59, s92, v59
    v_mul_f32 v60, s92, v60
    v_mul_f32 v61, s92, v61
    v_mul_f32 v62, s92, v62
    v_mul_f32 v63, s92, v63
    v_mul_f32 v68, s92, v68
    v_mul_f32 v69, s92, v69
    v_mul_f32 v70, s92, v70
    v_mul_f32 v71, s92, v71
    v_mul_f32 v72, s92, v72
    v_mul_f32 v73, s92, v73
    v_mul_f32 v74, s92, v74
    v_mul_f32 v75, s92, v75
    s_add_u32 s66, s52, 11392
    v_add_u32 v3, s66, v2
    v_cvt_pk_bf16_f32 v68, v68, v69
    v_cvt_pk_bf16_f32 v69, v70, v71
    v_cvt_pk_bf16_f32 v70, v72, v73
    v_cvt_pk_bf16_f32 v71, v74, v75
    v_mul_f32 v48, s92, v48
    v_mul_f32 v49, s92, v49
    v_mul_f32 v50, s92, v50
    v_mul_f32 v51, s92, v51
    v_mul_f32 v52, s92, v52
    v_mul_f32 v53, s92, v53
    v_mul_f32 v54, s92, v54
    v_mul_f32 v55, s92, v55
    ds_write_b128 v3, v[56:59]
    ds_write_b128 v3, v[60:63] offset:1024
    ds_write_b128 v3, v[68:71] offset:2048
    ds_write_b128 v98, v[48:51]
    ds_write_b128 v98, v[52:55] offset:40960
    v_add_u32 v3, 11392, v2
    v_add_u32 v246, 81920, v3
    s_waitcnt lgkmcnt(0)
    s_barrier
    ds_read_b128 v[4:7], v3 offset:0
    ds_read_b128 v[8:11], v3 offset:1024
    ds_read_b128 v[68:71], v3 offset:2048
    ds_read_b128 v[12:15], v3 offset:20480
    ds_read_b128 v[16:19], v3 offset:21504
    ds_read_b128 v[72:75], v3 offset:22528
    ds_read_b128 v[20:23], v3 offset:40960
    ds_read_b128 v[24:27], v3 offset:41984
    ds_read_b128 v[76:79], v3 offset:43008
    ds_read_b128 v[28:31], v3 offset:61440
    ds_read_b128 v[32:35], v3 offset:62464
    ds_read_b128 v[80:83], v3 offset:63488
    ds_read_b128 v[36:39], v246 offset:0
    ds_read_b128 v[40:43], v246 offset:1024
    ds_read_b128 v[84:87], v246 offset:2048
    ds_read_b128 v[44:47], v246 offset:20480
    ds_read_b128 v[48:51], v246 offset:21504
    ds_read_b128 v[88:91], v246 offset:22528
    ds_read_b128 v[52:55], v246 offset:40960
    ds_read_b128 v[56:59], v246 offset:41984
    ds_read_b128 v[92:95], v246 offset:43008
    ds_read_b128 v[60:63], v246 offset:61440
    ds_read_b128 v[64:67], v246 offset:62464
    ds_read_b128 v[96:99], v246 offset:63488
    ds_read_u16 v224, v238 offset:0
    ds_read_u16 v225, v238 offset:8
    ds_read_u16 v226, v238 offset:64
    ds_read_u16 v227, v238 offset:72
    s_cmp_eq_u32 s94, 0
    s_cbranch_scc1 L_skip2
    s_bitcmp0_b64 s[56:57], 2
    s_cbranch_scc1 L_noadve2
    s_sub_u32 s60, s60, 1
    s_cselect_b32 s31, 0, s31
    s_add_u32 s20, s20, s31
    s_addc_u32 s21, s21, 0
    s_xor_b32 s31, s31, 0x63ff800
L_noadve2:
    s_add_u32 m0, s52, 4160
    v_mov_b32 v230, v152
    v_mov_b32 v232, v153
    buffer_load_dwordx4 v[230:231], s[20:23], 0 idxen offen nt lds
    s_add_u32 m0, s52, 5216
    s_nop 0
    buffer_load_dwordx4 v[232:233], s[20:23], 0 idxen offen nt lds
    s_bitcmp0_b64 s[56:57], 3
    s_cbranch_scc1 L_noadve3
    s_sub_u32 s60, s60, 1
    s_cselect_b32 s31, 0, s31
    s_add_u32 s20, s20, s31
    s_addc_u32 s21, s21, 0
    s_xor_b32 s31, s31, 0x63ff800
L_noadve3:
    s_add_u32 m0, s52, 6240
    v_mov_b32 v230, v154
    v_mov_b32 v232, v155
    buffer_load_dwordx4 v[230:231], s[20:23], 0 idxen offen nt lds
    s_add_u32 m0, s52, 7296
    s_nop 0
    buffer_load_dwordx4 v[232:233], s[20:23], 0 idxen offen nt lds
L_skip2:
    s_waitcnt vmcnt(8)
    s_mov_b64 exec, s[28:29]
    v_cmp_neq_f16_sdwa s[68:69], v104, 0 src0_sel:WORD_0 src1_sel:WORD_0
    v_cmp_neq_f16_sdwa s[70:71], v104, 0 src0_sel:WORD_1 src1_sel:WORD_0
    v_cmp_neq_f16_sdwa s[72:73], v105, 0 src0_sel:WORD_0 src1_sel:WORD_0
    v_cmp_neq_f16_sdwa s[74:75], v105, 0 src0_sel:WORD_1 src1_sel:WORD_0
    v_cmp_neq_f16_sdwa s[76:77], v106, 0 src0_sel:WORD_0 src1_sel:WORD_0
    v_cmp_neq_f16_sdwa s[78:79], v106, 0 src0_sel:WORD_1 src1_sel:WORD_0
    v_cmp_neq_f16_sdwa s[80:81], v107, 0 src0_sel:WORD_0 src1_sel:WORD_0
    v_cmp_neq_f16_sdwa s[82:83], v107, 0 src0_sel:WORD_1 src1_sel:WORD_0
    v_sad_u16 v147, v104, 0, v147
    v_sad_u16 v147, v105, 0, v147
    v_sad_u16 v147, v106, 0, v147
    v_sad_u16 v147, v107, 0, v147
    v_or3_b32 v146, v104, v105, v146
    v_or3_b32 v146, v106, v107, v146
    s_mov_b64 exec, -1
    v_mov_b32 v132, s64
    v_mbcnt_lo_u32_b32 v132, s68, v132
    v_mbcnt_hi_u32_b32 v132, s69, v132
    v_mbcnt_lo_u32_b32 v132, s70, v132
    v_mbcnt_hi_u32_b32 v132, s71, v132
    v_mbcnt_lo_u32_b32 v132, s72, v132
    v_mbcnt_hi_u32_b32 v132, s73, v132
    v_mbcnt_lo_u32_b32 v132, s74, v132
    v_mbcnt_hi_u32_b32 v132, s75, v132
    v_mbcnt_lo_u32_b32 v132, s76, v132
    v_mbcnt_hi_u32_b32 v132, s77, v132
    v_mbcnt_lo_u32_b32 v132, s78, v132
    v_mbcnt_hi_u32_b32 v132, s79, v132
    v_mbcnt_lo_u32_b32 v132, s80, v132
    v_mbcnt_hi_u32_b32 v132, s81, v132
    v_mbcnt_lo_u32_b32 v132, s82, v132
    v_mbcnt_hi_u32_b32 v132, s83, v132
    s_add_u32 s34, s64, 16
    v_readlane_b32 s66, v132, 25
    v_readlane_b32 s67, v132, 63
    s_add_u32 s64, s66, 15
    s_and_b32 s64, s64, -16
    s_max_u32 s64, s64, s34
    s_sub_u32 s66, s64, s66
    v_mad_u32_u24 v132, v145, s66, v132
    s_lshr_b32 s35, s64, 4
    s_bitset1_b64 s[56:57], s35
    v_addc_co_u32 v133, vcc, 0, v132, s[68:69]
    v_addc_co_u32 v134, vcc, 0, v133, s[70:71]
    v_addc_co_u32 v135, vcc, 0, v134, s[72:73]
    v_addc_co_u32 v136, vcc, 0, v135, s[74:75]
    v_addc_co_u32 v137, vcc, 0, v136, s[76:77]
    v_addc_co_u32 v138, vcc, 0, v137, s[78:79]
    v_addc_co_u32 v139, vcc, 0, v138, s[80:81]
    v_addc_co_u32 v140, vcc, 0, v139, s[82:83]
    s_add_u32 s67, s67, s66
    s_add_u32 s67, s67, 15
    s_and_b32 s67, s67, -16
    s_add_u32 s64, s64, 16
    s_max_u32 s64, s64, s67
    s_mov_b64 exec, s[68:69]
    ds_write_b8 v132, v141
    s_mov_b64 exec, s[70:71]
    ds_write_b8_d16_hi v133, v141
    s_mov_b64 exec, s[72:73]
    ds_write_b8 v134, v142
    s_mov_b64 exec, s[74:75]
    ds_write_b8_d16_hi v135, v142
    s_mov_b64 exec, s[76:77]
    ds_write_b8 v136, v143
    s_mov_b64 exec, s[78:79]
    ds_write_b8_d16_hi v137, v143
    s_mov_b64 exec, s[80:81]
    ds_write_b8 v138, v144
    s_mov_b64 exec, s[82:83]
    ds_write_b8_d16_hi v139, v144
    s_mov_b64 exec, -1
    v_sub_u32 v140, v132, v140
    s_movk_i32 s66, 0x3f80
    v_mad_i32_i24 v147, v140, s66, v147
    s_lshr_b32 s35, s64, 4
    s_bitset1_b64 s[56:57], s35
    s_mov_b64 exec, s[28:29]
    v_cmp_neq_f16_sdwa s[68:69], v108, 0 src0_sel:WORD_0 src1_sel:WORD_0
    v_cmp_neq_f16_sdwa s[70:71], v108, 0 src0_sel:WORD_1 src1_sel:WORD_0
    v_cmp_neq_f16_sdwa s[72:73], v109, 0 src0_sel:WORD_0 src1_sel:WORD_0
    v_cmp_neq_f16_sdwa s[74:75], v109, 0 src0_sel:WORD_1 src1_sel:WORD_0
    v_cmp_neq_f16_sdwa s[76:77], v110, 0 src0_sel:WORD_0 src1_sel:WORD_0
    v_cmp_neq_f16_sdwa s[78:79], v110, 0 src0_sel:WORD_1 src1_sel:WORD_0
    v_cmp_neq_f16_sdwa s[80:81], v111, 0 src0_sel:WORD_0 src1_sel:WORD_0
    v_cmp_neq_f16_sdwa s[82:83], v111, 0 src0_sel:WORD_1 src1_sel:WORD_0
    v_sad_u16 v147, v108, 0, v147
    v_sad_u16 v147, v109, 0, v147
    v_sad_u16 v147, v110, 0, v147
    v_sad_u16 v147, v111, 0, v147
    v_or3_b32 v146, v108, v109, v146
    v_or3_b32 v146, v110, v111, v146
    s_mov_b64 exec, -1
    v_mov_b32 v132, s64
    v_mbcnt_lo_u32_b32 v132, s68, v132
    v_mbcnt_hi_u32_b32 v132, s69, v132
    v_mbcnt_lo_u32_b32 v132, s70, v132
    v_mbcnt_hi_u32_b32 v132, s71, v132
    v_mbcnt_lo_u32_b32 v132, s72, v132
    v_mbcnt_hi_u32_b32 v132, s73, v132
    v_mbcnt_lo_u32_b32 v132, s74, v132
    v_mbcnt_hi_u32_b32 v132, s75, v132
    v_mbcnt_lo_u32_b32 v132, s76, v132
    v_mbcnt_hi_u32_b32 v132, s77, v132
    v_mbcnt_lo_u32_b32 v132, s78, v132
    v_mbcnt_hi_u32_b32 v132, s79, v132
    v_mbcnt_lo_u32_b32 v132, s80, v132
    v_mbcnt_hi_u32_b32 v132, s81, v132
    v_mbcnt_lo_u32_b32 v132, s82, v132
    v_mbcnt_hi_u32_b32 v132, s83, v132
    s_add_u32 s34, s64, 16
    v_readlane_b32 s66, v132, 25
    v_readlane_b32 s67, v132, 63
    s_add_u32 s64, s66, 15
    s_and_b32 s64, s64, -16
    s_max_u32 s64, s64, s34
    s_sub_u32 s66, s64, s66
    v_mad_u32_u24 v132, v145, s66, v132
    s_lshr_b32 s35, s64, 4
    s_lshl_b64 s[86:87], 1, s35
    s_bitcmp1_b32 s64, 10
    s_cselect_b64 s[88:89], 0, s[86:87]
    s_cselect_b64 s[90:91], s[86:87], 0
    s_or_b64 s[56:57], s[56:57], s[88:89]
    s_or_b64 s[58:59], s[58:59], s[90:91]
    v_addc_co_u32 v133, vcc, 0, v132, s[68:69]
    v_addc_co_u32 v134, vcc, 0, v133, s[70:71]
    v_addc_co_u32 v135, vcc, 0, v134, s[72:73]
    v_addc_co_u32 v136, vcc, 0, v135, s[74:75]
    v_addc_co_u32 v137, vcc, 0, v136, s[76:77]
    v_addc_co_u32 v138, vcc, 0, v137, s[78:79]
    v_addc_co_u32 v139, vcc, 0, v138, s[80:81]
    v_addc_co_u32 v140, vcc, 0, v139, s[82:83]
    s_add_u32 s67, s67, s66
    s_add_u32 s67, s67, 15
    s_and_b32 s67, s67, -16
    s_add_u32 s64, s64, 16
    s_max_u32 s64, s64, s67
    s_mov_b64 exec, s[68:69]
    ds_write_b8 v132, v141
    s_mov_b64 exec, s[70:71]
    ds_write_b8_d16_hi v133, v141
    s_mov_b64 exec, s[72:73]
    ds_write_b8 v134, v142
    s_mov_b64 exec, s[74:75]
    ds_write_b8_d16_hi v135, v142
    s_mov_b64 exec, s[76:77]
    ds_write_b8 v136, v143
    s_mov_b64 exec, s[78:79]
    ds_write_b8_d16_hi v137, v143
    s_mov_b64 exec, s[80:81]
    ds_write_b8 v138, v144
    s_mov_b64 exec, s[82:83]
    ds_write_b8_d16_hi v139, v144
    s_mov_b64 exec, -1
    v_sub_u32 v140, v132, v140
    s_movk_i32 s66, 0x3f80
    v_mad_i32_i24 v147, v140, s66, v147
    s_lshr_b32 s35, s64, 4
    s_lshl_b64 s[86:87], 1, s35
    s_bitcmp1_b32 s64, 10
    s_cselect_b64 s[88:89], 0, s[86:87]
    s_cselect_b64 s[90:91], s[86:87], 0
    s_or_b64 s[56:57], s[56:57], s[88:89]
    s_or_b64 s[58:59], s[58:59], s[90:91]
    s_mov_b64 exec, s[28:29]
    v_cmp_neq_f16_sdwa s[68:69], v112, 0 src0_sel:WORD_0 src1_sel:WORD_0
    v_cmp_neq_f16_sdwa s[70:71], v112, 0 src0_sel:WORD_1 src1_sel:WORD_0
    v_cmp_neq_f16_sdwa s[72:73], v113, 0 src0_sel:WORD_0 src1_sel:WORD_0
    v_cmp_neq_f16_sdwa s[74:75], v113, 0 src0_sel:WORD_1 src1_sel:WORD_0
    v_cmp_neq_f16_sdwa s[76:77], v114, 0 src0_sel:WORD_0 src1_sel:WORD_0
    v_cmp_neq_f16_sdwa s[78:79], v114, 0 src0_sel:WORD_1 src1_sel:WORD_0
    v_cmp_neq_f16_sdwa s[80:81], v115, 0 src0_sel:WORD_0 src1_sel:WORD_0
    v_cmp_neq_f16_sdwa s[82:83], v115, 0 src0_sel:WORD_1 src1_sel:WORD_0
    v_sad_u16 v147, v112, 0, v147
    v_sad_u16 v147, v113, 0, v147
    v_sad_u16 v147, v114, 0, v147
    v_sad_u16 v147, v115, 0, v147
    v_or3_b32 v146, v112, v113, v146
    v_or3_b32 v146, v114, v115, v146
    s_mov_b64 exec, -1
    v_mov_b32 v132, s64
    v_mbcnt_lo_u32_b32 v132, s68, v132
    v_mbcnt_hi_u32_b32 v132, s69, v132
    v_mbcnt_lo_u32_b32 v132, s70, v132
    v_mbcnt_hi_u32_b32 v132, s71, v132
    v_mbcnt_lo_u32_b32 v132, s72, v132
    v_mbcnt_hi_u32_b32 v132, s73, v132
    v_mbcnt_lo_u32_b32 v132, s74, v132
    v_mbcnt_hi_u32_b32 v132, s75, v132
    v_mbcnt_lo_u32_b32 v132, s76, v132
    v_mbcnt_hi_u32_b32 v132, s77, v132
    v_mbcnt_lo_u32_b32 v132, s78, v132
    v_mbcnt_hi_u32_b32 v132, s79, v132
    v_mbcnt_lo_u32_b32 v132, s80, v132
    v_mbcnt_hi_u32_b32 v132, s81, v132
    v_mbcnt_lo_u32_b32 v132, s82, v132
    v_mbcnt_hi_u32_b32 v132, s83, v132
    s_add_u32 s34, s64, 16
    v_readlane_b32 s66, v132, 25
    v_readlane_b32 s67, v132, 63
    s_add_u32 s64, s66, 15
    s_and_b32 s64, s64, -16
    s_max_u32 s64, s64, s34
    s_sub_u32 s66, s64, s66
    v_mad_u32_u24 v132, v145, s66, v132
    s_lshr_b32 s35, s64, 4
    s_lshl_b64 s[86:87], 1, s35
    s_bitcmp1_b32 s64, 10
    s_cselect_b64 s[88:89], 0, s[86:87]
    s_cselect_b64 s[90:91], s[86:87], 0
    s_or_b64 s[56:57], s[56:57], s[88:89]
    s_or_b64 s[58:59], s[58:59], s[90:91]
    v_addc_co_u32 v133, vcc, 0, v132, s[68:69]
    v_addc_co_u32 v134, vcc, 0, v133, s[70:71]
    v_addc_co_u32 v135, vcc, 0, v134, s[72:73]
    v_addc_co_u32 v136, vcc, 0, v135, s[74:75]
    v_addc_co_u32 v137, vcc, 0, v136, s[76:77]
    v_addc_co_u32 v138, vcc, 0, v137, s[78:79]
    v_addc_co_u32 v139, vcc, 0, v138, s[80:81]
    v_addc_co_u32 v140, vcc, 0, v139, s[82:83]
    s_add_u32 s67, s67, s66
    s_add_u32 s67, s67, 15
    s_and_b32 s67, s67, -16
    s_add_u32 s64, s64, 16
    s_max_u32 s64, s64, s67
    s_mov_b64 exec, s[68:69]
    ds_write_b8 v132, v141
    s_mov_b64 exec, s[70:71]
    ds_write_b8_d16_hi v133, v141
    s_mov_b64 exec, s[72:73]
    ds_write_b8 v134, v142
    s_mov_b64 exec, s[74:75]
    ds_write_b8_d16_hi v135, v142
    s_mov_b64 exec, s[76:77]
    ds_write_b8 v136, v143
    s_mov_b64 exec, s[78:79]
    ds_write_b8_d16_hi v137, v143
    s_mov_b64 exec, s[80:81]
    ds_write_b8 v138, v144
    s_mov_b64 exec, s[82:83]
    ds_write_b8_d16_hi v139, v144
    s_mov_b64 exec, -1
    v_sub_u32 v140, v132, v140
    s_movk_i32 s66, 0x3f80
    v_mad_i32_i24 v147, v140, s66, v147
    s_lshr_b32 s35, s64, 4
    s_lshl_b64 s[86:87], 1, s35
    s_bitcmp1_b32 s64, 10
    s_cselect_b64 s[88:89], 0, s[86:87]
    s_cselect_b64 s[90:91], s[86:87], 0
    s_or_b64 s[56:57], s[56:57], s[88:89]
    s_or_b64 s[58:59], s[58:59], s[90:91]
    s_mov_b32 s66, 0xc07fc07f
    v_and_or_b32 v146, v146, s66, v147
    v_cmp_ne_u32 s[84:85], 0, v146
    s_sub_u32 s66, s64, s52
    s_sub_u32 s66, s66, 18432
    s_lshr_b32 s66, s66, 3
    s_xor_b32 s66, s66, s33
    s_sub_u32 s66, s66, s33
    s_xor_b32 s67, 0xfffffffc, s33
    s_sub_u32 s67, s67, s33
    v_mov_b32 v2, v221
    v_mov_b32 v1, s66
    v_mov_b32 v3, s67
    s_mov_b64 exec, 1
    ds_add_u32 v2, v1
    s_mov_b64 exec, -1
    s_cmp_eq_u32 s94, 1
    s_cbranch_scc1 L_nolate
    ds_read_u8 v148, v237 offset:0
    ds_read_u8 v149, v237 offset:8
    ds_read_u8 v150, v237 offset:16
    ds_read_u8 v151, v237 offset:24
    ds_read_u8 v152, v237 offset:32
    ds_read_u8 v153, v237 offset:40
    ds_read_u8 v154, v237 offset:48
    ds_read_u8 v155, v237 offset:56
    s_waitcnt lgkmcnt(0)
    s_add_u32 m0, s52, 0
    v_mov_b32 v230, v148
    v_mov_b32 v232, v149
    buffer_load_dwordx4 v[230:231], s[20:23], 0 idxen offen nt lds
    s_add_u32 m0, s52, 1056
    s_nop 0
    buffer_load_dwordx4 v[232:233], s[20:23], 0 idxen offen nt lds
    s_bitcmp0_b64 s[56:57], 1
    s_cbranch_scc1 L_noadvl1
    s_sub_u32 s60, s60, 1
    s_cselect_b32 s31, 0, s31
    s_add_u32 s20, s20, s31
    s_addc_u32 s21, s21, 0
    s_xor_b32 s31, s31, 0x63ff800
L_noadvl1:
    s_add_u32 m0, s52, 2080
    v_mov_b32 v230, v150
    v_mov_b32 v232, v151
    buffer_load_dwordx4 v[230:231], s[20:23], 0 idxen offen nt lds
    s_add_u32 m0, s52, 3136
    s_nop 0
    buffer_load_dwordx4 v[232:233], s[20:23], 0 idxen offen nt lds
    s_bitcmp0_b64 s[56:57], 2
    s_cbranch_scc1 L_noadvl2
    s_sub_u32 s60, s60, 1
    s_cselect_b32 s31, 0, s31
    s_add_u32 s20, s20, s31
    s_addc_u32 s21, s21, 0
    s_xor_b32 s31, s31, 0x63ff800
L_noadvl2:
    s_add_u32 m0, s52, 4160
    v_mov_b32 v230, v152
    v_mov_b32 v232, v153
    buffer_load_dwordx4 v[230:231], s[20:23], 0 idxen offen nt lds
    s_add_u32 m0, s52, 5216
    s_nop 0
    buffer_load_dwordx4 v[232:233], s[20:23], 0 idxen offen nt lds
    s_bitcmp0_b64 s[56:57], 3
    s_cbranch_scc1 L_noadvl3
    s_sub_u32 s60, s60, 1
    s_cselect_b32 s31, 0, s31
    s_add_u32 s20, s20, s31
    s_addc_u32 s21, s21, 0
    s_xor_b32 s31, s31, 0x63ff800
L_noadvl3:
    s_add_u32 m0, s52, 6240
    v_mov_b32 v230, v154
    v_mov_b32 v232, v155
    buffer_load_dwordx4 v[230:231], s[20:23], 0 idxen offen nt lds
    s_add_u32 m0, s52, 7296
    s_nop 0
    buffer_load_dwordx4 v[232:233], s[20:23], 0 idxen offen nt lds
L_nolate:
    v_and_b32_dpp v196, v216, v220 quad_perm:[0,0,0,0] row_mask:0xf bank_mask:0xf
    v_and_b32_dpp v197, v217, v220 quad_perm:[0,0,0,0] row_mask:0xf bank_mask:0xf
    v_and_b32_dpp v198, v216, v220 quad_perm:[1,1,1,1] row_mask:0xf bank_mask:0xf
    v_and_b32_dpp v199, v217, v220 quad_perm:[1,1,1,1] row_mask:0xf bank_mask:0xf
    v_and_b32_dpp v200, v216, v220 quad_perm:[2,2,2,2] row_mask:0xf bank_mask:0xf
    v_and_b32_dpp v201, v217, v220 quad_perm:[2,2,2,2] row_mask:0xf bank_mask:0xf
    v_and_b32_dpp v202, v216, v220 quad_perm:[3,3,3,3] row_mask:0xf bank_mask:0xf
    v_and_b32_dpp v203, v217, v220 quad_perm:[3,3,3,3] row_mask:0xf bank_mask:0xf
    s_lshl_b32 s30, s30, 16
    v_and_b32 v204, s30, v220
    v_and_b32 v205, s30, v220
    v_and_b32 v206, s30, v220
    v_and_b32 v207, s30, v220
    s_waitcnt lgkmcnt(0)
    v_mul_u32_u24 v216, v224, v241
    v_mul_u32_u24 v217, v224, v242
    v_mul_u32_u24 v218, v225, v241
    v_mul_u32_u24 v219, v225, v242
    v_mul_u32_u24 v220, v226, v241
    v_mul_u32_u24 v221, v226, v242
    v_mul_u32_u24 v222, v227, v241
    v_mul_u32_u24 v223, v227, v242
    v_add_u32 v238, 128, v238
    ds_read_b128 v[164:167], v239
    v_mfma_f32_4x4x4_16b_bf16 v[132:135], v[216:217], v[68:69], v[4:7]
    ds_read_b128 v[168:171], v239 offset:64
    ds_read_b128 v[172:175], v239 offset:128
    v_mfma_f32_4x4x4_16b_bf16 v[136:139], v[218:219], v[70:71], v[8:11]
    ds_read_b128 v[176:179], v239 offset:192
    ds_read_u16 v224, v238
    v_mfma_f32_4x4x4_16b_bf16 v[140:143], v[220:221], v[72:73], v[12:15]
    ds_read_u16 v225, v238 offset:8
    ds_read_u16 v226, v238 offset:64
    v_mfma_f32_4x4x4_16b_bf16 v[144:147], v[222:223], v[74:75], v[16:19]
    ds_read_u16 v227, v238 offset:72
    v_add_u32 v239, 256, v239
    v_mfma_f32_4x4x4_16b_bf16 v[246:249], v[216:217], v[76:77], v[20:23]
    v_cvt_pk_bf16_f32 v100, v132, v133
    v_cvt_pk_bf16_f32 v101, v134, v135
    v_mfma_f32_4x4x4_16b_bf16 v[250:253], v[218:219], v[78:79], v[24:27]
    v_cvt_pk_bf16_f32 v102, v136, v137
    v_cvt_pk_bf16_f32 v103, v138, v139
    v_mfma_f32_4x4x4_16b_bf16 v[132:135], v[220:221], v[80:81], v[28:31]
    v_cvt_pk_bf16_f32 v104, v140, v141
    v_cvt_pk_bf16_f32 v105, v142, v143
    v_mfma_f32_4x4x4_16b_bf16 v[136:139], v[222:223], v[82:83], v[32:35]
    v_cvt_pk_bf16_f32 v106, v144, v145
    v_cvt_pk_bf16_f32 v107, v146, v147
    v_mfma_f32_4x4x4_16b_bf16 v[140:143], v[216:217], v[84:85], v[36:39]
    v_cvt_pk_bf16_f32 v108, v246, v247
    v_cvt_pk_bf16_f32 v109, v248, v249
    v_mfma_f32_4x4x4_16b_bf16 v[144:147], v[218:219], v[86:87], v[40:43]
    v_cvt_pk_bf16_f32 v110, v250, v251
    v_cvt_pk_bf16_f32 v111, v252, v253
    v_mfma_f32_4x4x4_16b_bf16 v[246:249], v[220:221], v[88:89], v[44:47]
    v_cvt_pk_bf16_f32 v112, v132, v133
    v_cvt_pk_bf16_f32 v113, v134, v135
    v_mfma_f32_4x4x4_16b_bf16 v[250:253], v[222:223], v[90:91], v[48:51]
    v_cvt_pk_bf16_f32 v114, v136, v137
    v_cvt_pk_bf16_f32 v115, v138, v139
    v_mfma_f32_4x4x4_16b_bf16 v[132:135], v[216:217], v[92:93], v[52:55]
    v_cvt_pk_bf16_f32 v116, v140, v141
    v_cvt_pk_bf16_f32 v117, v142, v143
    v_mfma_f32_4x4x4_16b_bf16 v[136:139], v[218:219], v[94:95], v[56:59]
    v_cvt_pk_bf16_f32 v118, v144, v145
    v_cvt_pk_bf16_f32 v119, v146, v147
    v_mfma_f32_4x4x4_16b_bf16 v[140:143], v[220:221], v[96:97], v[60:63]
    v_cvt_pk_bf16_f32 v120, v246, v247
    v_cvt_pk_bf16_f32 v121, v248, v249
    v_mfma_f32_4x4x4_16b_bf16 v[144:147], v[222:223], v[98:99], v[64:67]
    v_cvt_pk_bf16_f32 v122, v250, v251
    v_cvt_pk_bf16_f32 v123, v252, v253
    v_cvt_pk_bf16_f32 v124, v132, v133
    v_cvt_pk_bf16_f32 v125, v134, v135
    v_cvt_pk_bf16_f32 v126, v136, v137
    v_cvt_pk_bf16_f32 v127, v138, v139
    v_cvt_pk_bf16_f32 v128, v140, v141
    v_cvt_pk_bf16_f32 v129, v142, v143
    v_cvt_pk_bf16_f32 v130, v144, v145
    v_cvt_pk_bf16_f32 v131, v146, v147
    s_waitcnt lgkmcnt(0)
    v_mov_b32 v188, 0
    v_mov_b32 v189, 0
    v_mov_b32 v190, 0
    v_mov_b32 v191, 0
    v_mov_b32 v192, 0
    v_mov_b32 v193, 0
    v_mov_b32 v194, 0
    v_mov_b32 v195, 0
    v_mov_b32 v208, 0
    v_mov_b32 v212, 0
    v_mov_b32 v209, 0
    v_mov_b32 v213, 0
    v_mov_b32 v210, 0
    v_mov_b32 v214, 0
    v_mov_b32 v211, 0
    v_mov_b32 v215, 0
    s_waitcnt vmcnt(6)
    ds_read_b128 v[180:183], v234 offset:0
    ds_read_b128 v[184:187], v235 offset:0
    s_waitcnt lgkmcnt(0)
    v_mfma_f32_16x16x32_bf16 v[148:151], v[100:103], v[180:183], v[164:167]
    v_mfma_f32_16x16x32_bf16 v[148:151], v[104:107], v[184:187], v[148:151]
    v_mfma_f32_16x16x32_bf16 v[152:155], v[108:111], v[180:183], v[168:171]
    v_mfma_f32_16x16x32_bf16 v[152:155], v[112:115], v[184:187], v[152:155]
    v_mfma_f32_16x16x32_bf16 v[156:159], v[116:119], v[180:183], v[172:175]
    v_mfma_f32_16x16x32_bf16 v[156:159], v[120:123], v[184:187], v[156:159]
    v_mfma_f32_16x16x32_bf16 v[160:163], v[124:127], v[180:183], v[176:179]
    v_mfma_f32_16x16x32_bf16 v[160:163], v[128:131], v[184:187], v[160:163]
    s_waitcnt vmcnt(4)
    ds_read_b128 v[180:183], v234 offset:2080
    ds_read_b128 v[184:187], v235 offset:2080
    ds_read_u8 v230, v237 offset:64
    ds_read_u8 v232, v237 offset:72
    s_cmp_lg_u64 s[84:85], 0
    s_cbranch_scc0 Lf_mid
    s_mul_i32 s66, s53, 800
    s_add_u32 s8, s8, s66
    s_addc_u32 s9, s9, 0
    s_mov_b32 s24, s8
    s_and_b32 s25, s9, 0xffff
    s_mov_b32 s26, 400
    s_mov_b32 s27, 0x20000
    s_movk_i32 s32, 400
    s_branch Ls_mid
Lf_loop:
    ds_read_u8 v230, v237 offset:64
    ds_read_u8 v232, v237 offset:72
    v_mfma_f32_16x16x32_bf16 v[208:211], v[136:139], v[200:203], v[208:211]
Lf_mid:
    s_bitcmp1_b64 s[56:57], 1
    s_cbranch_scc1 Lf_wb0
Lf_wbd0:
    s_mov_b64 exec, 1
    ds_add_rtn_u32 v1, v2, v3
    s_mov_b64 exec, -1
    v_exp_f32 v132, v148
    v_exp_f32 v133, v149
    v_exp_f32 v134, v150
    v_exp_f32 v135, v151
    v_exp_f32 v136, v152
    v_exp_f32 v137, v153
    v_mfma_f32_4x4x4_16b_bf16 v[132:135], v[228:229], v[228:229], v[132:135]
    v_cvt_pk_bf16_f32 v208, v208, v209
    v_cvt_pk_bf16_f32 v209, v210, v211
    s_waitcnt lgkmcnt(2)
    v_mfma_f32_16x16x32_bf16 v[148:151], v[100:103], v[180:183], v[164:167]
    v_exp_f32 v138, v154
    v_mfma_f32_4x4x4_16b_bf16 v[212:215], v[208:209], v[188:189], v[212:215] cbsz:4 abid:0
    ds_read_b64_tr_b16 v[188:189], v236 offset:0
    v_exp_f32 v139, v155
    v_mfma_f32_16x16x32_bf16 v[152:155], v[108:111], v[180:183], v[168:171]
    v_exp_f32 v140, v156
    v_mfma_f32_4x4x4_16b_bf16 v[212:215], v[208:209], v[190:191], v[212:215] cbsz:4 abid:4
    ds_read_b64_tr_b16 v[190:191], v236 offset:512
    v_mfma_f32_4x4x4_16b_bf16 v[136:139], v[228:229], v[228:229], v[136:139]
    v_rcp_f32 v132, v132
    v_mfma_f32_4x4x4_16b_bf16 v[212:215], v[208:209], v[192:193], v[212:215] cbsz:4 abid:8
    ds_read_b64_tr_b16 v[192:193], v236 offset:1056
    v_exp_f32 v141, v157
    v_mfma_f32_16x16x32_bf16 v[148:151], v[104:107], v[184:187], v[148:151]
    v_rcp_f32 v133, v133
    v_mfma_f32_4x4x4_16b_bf16 v[212:215], v[208:209], v[194:195], v[212:215] cbsz:4 abid:12
    ds_read_b64_tr_b16 v[194:195], v236 offset:1568
    v_exp_f32 v142, v158
    v_mfma_f32_16x16x32_bf16 v[152:155], v[112:115], v[184:187], v[152:155]
    v_rcp_f32 v134, v134
    v_exp_f32 v143, v159
    v_rcp_f32 v135, v135
    v_cvt_pk_bf16_f32 v132, v132, v133
    v_mfma_f32_4x4x4_16b_bf16 v[140:143], v[228:229], v[228:229], v[140:143]
    v_exp_f32 v144, v160
    v_mfma_f32_16x16x32_bf16 v[156:159], v[116:119], v[180:183], v[172:175]
    v_rcp_f32 v136, v136
    v_cvt_pk_bf16_f32 v133, v134, v135
    s_bitcmp1_b64 s[56:57], 0
    s_cbranch_scc1 Lf_flush0
Lf_flushed0:
    v_exp_f32 v145, v161
    v_rcp_f32 v137, v137
    v_exp_f32 v146, v162
    s_bitcmp1_b64 s[56:57], 4
    s_cbranch_scc1 Lf_adv0
Lf_advd0:
    v_rcp_f32 v138, v138
    v_cvt_pk_bf16_f32 v134, v136, v137
    v_exp_f32 v147, v163
    v_mfma_f32_16x16x32_bf16 v[160:163], v[124:127], v[180:183], v[176:179]
    s_waitcnt lgkmcnt(0)
    s_add_u32 m0, s52, 0
    v_rcp_f32 v139, v139
    buffer_load_dwordx4 v[230:231], s[20:23], 0 idxen offen nt lds
    v_mfma_f32_4x4x4_16b_bf16 v[144:147], v[228:229], v[228:229], v[144:147]
    v_mfma_f32_16x16x32_bf16 v[156:159], v[120:123], v[184:187], v[156:159]
    s_add_u32 m0, s52, 1056
    v_rcp_f32 v140, v140
    buffer_load_dwordx4 v[232:233], s[20:23], 0 idxen offen nt lds
    v_mfma_f32_16x16x32_bf16 v[160:163], v[128:131], v[184:187], v[160:163]
    v_readfirstlane_b32 s66, v1
    s_nop 0
    s_xor_b32 s66, s66, s33
    s_cmp_gt_i32 s66, 0
    s_setprio 0
    s_cbranch_scc0 Lf_lo0
    s_setprio 1
Lf_lo0:
    v_rcp_f32 v141, v141
    v_cvt_pk_bf16_f32 v135, v138, v139
    s_waitcnt vmcnt(4)
    ds_read_b128 v[180:183], v234 offset:4160
    ds_read_b128 v[184:187], v235 offset:4160
    v_rcp_f32 v142, v142
    v_cvt_pk_bf16_f32 v136, v140, v141
    v_mfma_f32_16x16x32_bf16 v[208:211], v[132:135], v[196:199], v[204:207]
    v_rcp_f32 v143, v143
    v_rcp_f32 v144, v144
    v_cvt_pk_bf16_f32 v137, v142, v143
    v_rcp_f32 v145, v145
    v_rcp_f32 v146, v146
    v_rcp_f32 v147, v147
    v_cvt_pk_bf16_f32 v138, v144, v145
    v_cvt_pk_bf16_f32 v139, v146, v147
    ds_read_u8 v230, v237 offset:80
    ds_read_u8 v232, v237 offset:88
    v_mfma_f32_16x16x32_bf16 v[208:211], v[136:139], v[200:203], v[208:211]
    s_bitcmp1_b64 s[56:57], 2
    s_cbranch_scc1 Lf_wb1
Lf_wbd1:
    v_exp_f32 v132, v148
    v_exp_f32 v133, v149
    v_exp_f32 v134, v150
    v_exp_f32 v135, v151
    v_exp_f32 v136, v152
    v_exp_f32 v137, v153
    v_mfma_f32_4x4x4_16b_bf16 v[132:135], v[228:229], v[228:229], v[132:135]
    v_cvt_pk_bf16_f32 v208, v208, v209
    v_cvt_pk_bf16_f32 v209, v210, v211
    s_waitcnt lgkmcnt(2)
    v_mfma_f32_16x16x32_bf16 v[148:151], v[100:103], v[180:183], v[164:167]
    v_exp_f32 v138, v154
    v_mfma_f32_4x4x4_16b_bf16 v[212:215], v[208:209], v[188:189], v[212:215] cbsz:4 abid:0
    ds_read_b64_tr_b16 v[188:189], v236 offset:2080
    v_exp_f32 v139, v155
    v_mfma_f32_16x16x32_bf16 v[152:155], v[108:111], v[180:183], v[168:171]
    v_exp_f32 v140, v156
    v_mfma_f32_4x4x4_16b_bf16 v[212:215], v[208:209], v[190:191], v[212:215] cbsz:4 abid:4
    ds_read_b64_tr_b16 v[190:191], v236 offset:2592
    v_mfma_f32_4x4x4_16b_bf16 v[136:139], v[228:229], v[228:229], v[136:139]
    v_rcp_f32 v132, v132
    v_mfma_f32_4x4x4_16b_bf16 v[212:215], v[208:209], v[192:193], v[212:215] cbsz:4 abid:8
    ds_read_b64_tr_b16 v[192:193], v236 offset:3136
    v_exp_f32 v141, v157
    v_mfma_f32_16x16x32_bf16 v[148:151], v[104:107], v[184:187], v[148:151]
    v_rcp_f32 v133, v133
    v_mfma_f32_4x4x4_16b_bf16 v[212:215], v[208:209], v[194:195], v[212:215] cbsz:4 abid:12
    ds_read_b64_tr_b16 v[194:195], v236 offset:3648
    v_exp_f32 v142, v158
    v_mfma_f32_16x16x32_bf16 v[152:155], v[112:115], v[184:187], v[152:155]
    v_rcp_f32 v134, v134
    v_exp_f32 v143, v159
    v_rcp_f32 v135, v135
    v_cvt_pk_bf16_f32 v132, v132, v133
    v_mfma_f32_4x4x4_16b_bf16 v[140:143], v[228:229], v[228:229], v[140:143]
    v_exp_f32 v144, v160
    v_mfma_f32_16x16x32_bf16 v[156:159], v[116:119], v[180:183], v[172:175]
    v_rcp_f32 v136, v136
    v_cvt_pk_bf16_f32 v133, v134, v135
    s_bitcmp1_b64 s[56:57], 1
    s_cbranch_scc1 Lf_flush1
Lf_flushed1:
    v_exp_f32 v145, v161
    v_rcp_f32 v137, v137
    v_exp_f32 v146, v162
    s_bitcmp1_b64 s[56:57], 5
    s_cbranch_scc1 Lf_adv1
Lf_advd1:
    v_rcp_f32 v138, v138
    v_cvt_pk_bf16_f32 v134, v136, v137
    v_exp_f32 v147, v163
    v_mfma_f32_16x16x32_bf16 v[160:163], v[124:127], v[180:183], v[176:179]
    s_waitcnt lgkmcnt(0)
    s_add_u32 m0, s52, 2080
    v_rcp_f32 v139, v139
    buffer_load_dwordx4 v[230:231], s[20:23], 0 idxen offen nt lds
    v_mfma_f32_4x4x4_16b_bf16 v[144:147], v[228:229], v[228:229], v[144:147]
    v_mfma_f32_16x16x32_bf16 v[156:159], v[120:123], v[184:187], v[156:159]
    s_add_u32 m0, s52, 3136
    v_rcp_f32 v140, v140
    buffer_load_dwordx4 v[232:233], s[20:23], 0 idxen offen nt lds
    v_mfma_f32_16x16x32_bf16 v[160:163], v[128:131], v[184:187], v[160:163]
    v_rcp_f32 v141, v141
    v_cvt_pk_bf16_f32 v135, v138, v139
    s_waitcnt vmcnt(4)
    ds_read_b128 v[180:183], v234 offset:6240
    ds_read_b128 v[184:187], v235 offset:6240
    v_rcp_f32 v142, v142
    v_cvt_pk_bf16_f32 v136, v140, v141
    v_mfma_f32_16x16x32_bf16 v[208:211], v[132:135], v[196:199], v[204:207]
    v_rcp_f32 v143, v143
    v_rcp_f32 v144, v144
    v_cvt_pk_bf16_f32 v137, v142, v143
    v_rcp_f32 v145, v145
    v_rcp_f32 v146, v146
    v_rcp_f32 v147, v147
    v_cvt_pk_bf16_f32 v138, v144, v145
    v_cvt_pk_bf16_f32 v139, v146, v147
    ds_read_u8 v230, v237 offset:96
    ds_read_u8 v232, v237 offset:104
    v_mfma_f32_16x16x32_bf16 v[208:211], v[136:139], v[200:203], v[208:211]
    s_bitcmp1_b64 s[56:57], 3
    s_cbranch_scc1 Lf_wb2
Lf_wbd2:
    s_mov_b64 exec, 1
    ds_add_rtn_u32 v1, v2, v3
    s_mov_b64 exec, -1
    v_exp_f32 v132, v148
    v_exp_f32 v133, v149
    v_exp_f32 v134, v150
    v_exp_f32 v135, v151
    v_exp_f32 v136, v152
    v_exp_f32 v137, v153
    v_mfma_f32_4x4x4_16b_bf16 v[132:135], v[228:229], v[228:229], v[132:135]
    v_cvt_pk_bf16_f32 v208, v208, v209
    v_cvt_pk_bf16_f32 v209, v210, v211
    s_waitcnt lgkmcnt(2)
    v_mfma_f32_16x16x32_bf16 v[148:151], v[100:103], v[180:183], v[164:167]
    v_exp_f32 v138, v154
    v_mfma_f32_4x4x4_16b_bf16 v[212:215], v[208:209], v[188:189], v[212:215] cbsz:4 abid:0
    ds_read_b64_tr_b16 v[188:189], v236 offset:4160
    v_exp_f32 v139, v155
    v_mfma_f32_16x16x32_bf16 v[152:155], v[108:111], v[180:183], v[168:171]
    v_exp_f32 v140, v156
    v_mfma_f32_4x4x4_16b_bf16 v[212:215], v[208:209], v[190:191], v[212:215] cbsz:4 abid:4
    ds_read_b64_tr_b16 v[190:191], v236 offset:4672
    v_mfma_f32_4x4x4_16b_bf16 v[136:139], v[228:229], v[228:229], v[136:139]
    v_rcp_f32 v132, v132
    v_mfma_f32_4x4x4_16b_bf16 v[212:215], v[208:209], v[192:193], v[212:215] cbsz:4 abid:8
    ds_read_b64_tr_b16 v[192:193], v236 offset:5216
    v_exp_f32 v141, v157
    v_mfma_f32_16x16x32_bf16 v[148:151], v[104:107], v[184:187], v[148:151]
    v_rcp_f32 v133, v133
    v_mfma_f32_4x4x4_16b_bf16 v[212:215], v[208:209], v[194:195], v[212:215] cbsz:4 abid:12
    ds_read_b64_tr_b16 v[194:195], v236 offset:5728
    v_exp_f32 v142, v158
    v_mfma_f32_16x16x32_bf16 v[152:155], v[112:115], v[184:187], v[152:155]
    v_rcp_f32 v134, v134
    v_exp_f32 v143, v159
    v_rcp_f32 v135, v135
    v_cvt_pk_bf16_f32 v132, v132, v133
    v_mfma_f32_4x4x4_16b_bf16 v[140:143], v[228:229], v[228:229], v[140:143]
    v_exp_f32 v144, v160
    v_mfma_f32_16x16x32_bf16 v[156:159], v[116:119], v[180:183], v[172:175]
    v_rcp_f32 v136, v136
    v_cvt_pk_bf16_f32 v133, v134, v135
    s_bitcmp1_b64 s[56:57], 2
    s_cbranch_scc1 Lf_flush2
Lf_flushed2:
    v_exp_f32 v145, v161
    v_rcp_f32 v137, v137
    v_exp_f32 v146, v162
    s_bitcmp1_b64 s[56:57], 6
    s_cbranch_scc1 Lf_adv2
Lf_advd2:
    v_rcp_f32 v138, v138
    v_cvt_pk_bf16_f32 v134, v136, v137
    v_exp_f32 v147, v163
    v_mfma_f32_16x16x32_bf16 v[160:163], v[124:127], v[180:183], v[176:179]
    s_waitcnt lgkmcnt(0)
    s_add_u32 m0, s52, 4160
    v_rcp_f32 v139, v139
    buffer_load_dwordx4 v[230:231], s[20:23], 0 idxen offen nt lds
    v_mfma_f32_4x4x4_16b_bf16 v[144:147], v[228:229], v[228:229], v[144:147]
    v_mfma_f32_16x16x32_bf16 v[156:159], v[120:123], v[184:187], v[156:159]
    s_add_u32 m0, s52, 5216
    v_rcp_f32 v140, v140
    buffer_load_dwordx4 v[232:233], s[20:23], 0 idxen offen nt lds
    v_mfma_f32_16x16x32_bf16 v[160:163], v[128:131], v[184:187], v[160:163]
    v_readfirstlane_b32 s66, v1
    s_nop 0
    s_xor_b32 s66, s66, s33
    s_cmp_gt_i32 s66, 0
    s_setprio 0
    s_cbranch_scc0 Lf_lo2
    s_setprio 1
Lf_lo2:
    v_rcp_f32 v141, v141
    v_cvt_pk_bf16_f32 v135, v138, v139
    s_waitcnt vmcnt(4)
    ds_read_b128 v[180:183], v234 offset:0
    ds_read_b128 v[184:187], v235 offset:0
    v_rcp_f32 v142, v142
    v_cvt_pk_bf16_f32 v136, v140, v141
    v_mfma_f32_16x16x32_bf16 v[208:211], v[132:135], v[196:199], v[204:207]
    v_rcp_f32 v143, v143
    v_rcp_f32 v144, v144
    v_cvt_pk_bf16_f32 v137, v142, v143
    v_rcp_f32 v145, v145
    v_rcp_f32 v146, v146
    v_rcp_f32 v147, v147
    v_cvt_pk_bf16_f32 v138, v144, v145
    v_cvt_pk_bf16_f32 v139, v146, v147
    ds_read_u8 v230, v237 offset:112
    ds_read_u8 v232, v237 offset:120
    v_mfma_f32_16x16x32_bf16 v[208:211], v[136:139], v[200:203], v[208:211]
    s_bitcmp1_b64 s[56:57], 4
    s_cbranch_scc1 Lf_wb3
Lf_wbd3:
    v_exp_f32 v132, v148
    v_exp_f32 v133, v149
    v_exp_f32 v134, v150
    v_exp_f32 v135, v151
    v_exp_f32 v136, v152
    v_exp_f32 v137, v153
    v_mfma_f32_4x4x4_16b_bf16 v[132:135], v[228:229], v[228:229], v[132:135]
    v_cvt_pk_bf16_f32 v208, v208, v209
    v_cvt_pk_bf16_f32 v209, v210, v211
    s_waitcnt lgkmcnt(2)
    v_mfma_f32_16x16x32_bf16 v[148:151], v[100:103], v[180:183], v[164:167]
    v_exp_f32 v138, v154
    v_mfma_f32_4x4x4_16b_bf16 v[212:215], v[208:209], v[188:189], v[212:215] cbsz:4 abid:0
    ds_read_b64_tr_b16 v[188:189], v236 offset:6240
    v_exp_f32 v139, v155
    v_mfma_f32_16x16x32_bf16 v[152:155], v[108:111], v[180:183], v[168:171]
    v_exp_f32 v140, v156
    v_mfma_f32_4x4x4_16b_bf16 v[212:215], v[208:209], v[190:191], v[212:215] cbsz:4 abid:4
    ds_read_b64_tr_b16 v[190:191], v236 offset:6752
    v_mfma_f32_4x4x4_16b_bf16 v[136:139], v[228:229], v[228:229], v[136:139]
    v_rcp_f32 v132, v132
    v_mfma_f32_4x4x4_16b_bf16 v[212:215], v[208:209], v[192:193], v[212:215] cbsz:4 abid:8
    ds_read_b64_tr_b16 v[192:193], v236 offset:7296
    v_exp_f32 v141, v157
    v_mfma_f32_16x16x32_bf16 v[148:151], v[104:107], v[184:187], v[148:151]
    v_rcp_f32 v133, v133
    v_mfma_f32_4x4x4_16b_bf16 v[212:215], v[208:209], v[194:195], v[212:215] cbsz:4 abid:12
    ds_read_b64_tr_b16 v[194:195], v236 offset:7808
    v_exp_f32 v142, v158
    v_mfma_f32_16x16x32_bf16 v[152:155], v[112:115], v[184:187], v[152:155]
    v_rcp_f32 v134, v134
    v_exp_f32 v143, v159
    v_rcp_f32 v135, v135
    v_cvt_pk_bf16_f32 v132, v132, v133
    v_mfma_f32_4x4x4_16b_bf16 v[140:143], v[228:229], v[228:229], v[140:143]
    v_exp_f32 v144, v160
    v_mfma_f32_16x16x32_bf16 v[156:159], v[116:119], v[180:183], v[172:175]
    v_rcp_f32 v136, v136
    v_cvt_pk_bf16_f32 v133, v134, v135
    s_bitcmp1_b64 s[56:57], 3
    s_cbranch_scc1 Lf_flush3
Lf_flushed3:
    v_exp_f32 v145, v161
    v_rcp_f32 v137, v137
    v_exp_f32 v146, v162
    s_bitcmp1_b64 s[56:57], 7
    s_cbranch_scc1 Lf_adv3
Lf_advd3:
    v_rcp_f32 v138, v138
    v_cvt_pk_bf16_f32 v134, v136, v137
    v_exp_f32 v147, v163
    v_mfma_f32_16x16x32_bf16 v[160:163], v[124:127], v[180:183], v[176:179]
    s_waitcnt lgkmcnt(0)
    s_add_u32 m0, s52, 6240
    v_rcp_f32 v139, v139
    buffer_load_dwordx4 v[230:231], s[20:23], 0 idxen offen nt lds
    v_mfma_f32_4x4x4_16b_bf16 v[144:147], v[228:229], v[228:229], v[144:147]
    v_mfma_f32_16x16x32_bf16 v[156:159], v[120:123], v[184:187], v[156:159]
    s_add_u32 m0, s52, 7296
    v_rcp_f32 v140, v140
    buffer_load_dwordx4 v[232:233], s[20:23], 0 idxen offen nt lds
    v_mfma_f32_16x16x32_bf16 v[160:163], v[128:131], v[184:187], v[160:163]
    v_rcp_f32 v141, v141
    v_cvt_pk_bf16_f32 v135, v138, v139
    s_waitcnt vmcnt(4)
    ds_read_b128 v[180:183], v234 offset:2080
    ds_read_b128 v[184:187], v235 offset:2080
    v_rcp_f32 v142, v142
    v_cvt_pk_bf16_f32 v136, v140, v141
    v_mfma_f32_16x16x32_bf16 v[208:211], v[132:135], v[196:199], v[204:207]
    v_rcp_f32 v143, v143
    s_lshr_b64 s[56:57], s[56:57], 4
    s_lshl_b64 s[86:87], s[58:59], 60
    s_or_b64 s[56:57], s[56:57], s[86:87]
    s_lshr_b64 s[58:59], s[58:59], 4
    v_add_u32 v237, 64, v237
    v_rcp_f32 v144, v144
    v_cvt_pk_bf16_f32 v137, v142, v143
    v_rcp_f32 v145, v145
    v_rcp_f32 v146, v146
    v_rcp_f32 v147, v147
    v_cvt_pk_bf16_f32 v138, v144, v145
    v_cvt_pk_bf16_f32 v139, v146, v147
    s_branch Lf_loop
Lf_flush0:
    v_cvt_pk_bf16_f32 v246, v212, v212
    v_mov_b32 v212, 0
    ds_write_b16 v240, v246
    v_add_u32 v240, 128, v240
    s_branch Lf_flushed0
Lf_wb0:
    s_sub_u32 s61, s61, 1
    s_cbranch_scc1 Lf_last0
    v_mul_u32_u24 v216, v224, v241
    v_mul_u32_u24 v217, v224, v242
    v_mul_u32_u24 v218, v225, v241
    v_mul_u32_u24 v219, v225, v242
    v_mul_u32_u24 v220, v226, v241
    v_mul_u32_u24 v221, v226, v242
    v_mul_u32_u24 v222, v227, v241
    v_mul_u32_u24 v223, v227, v242
    v_add_u32 v238, 128, v238
    ds_read_b128 v[164:167], v239
    v_mfma_f32_4x4x4_16b_bf16 v[132:135], v[216:217], v[68:69], v[4:7]
    ds_read_b128 v[168:171], v239 offset:64
    ds_read_b128 v[172:175], v239 offset:128
    v_mfma_f32_4x4x4_16b_bf16 v[136:139], v[218:219], v[70:71], v[8:11]
    ds_read_b128 v[176:179], v239 offset:192
    ds_read_u16 v224, v238
    v_mfma_f32_4x4x4_16b_bf16 v[140:143], v[220:221], v[72:73], v[12:15]
    ds_read_u16 v225, v238 offset:8
    ds_read_u16 v226, v238 offset:64
    v_mfma_f32_4x4x4_16b_bf16 v[144:147], v[222:223], v[74:75], v[16:19]
    ds_read_u16 v227, v238 offset:72
    v_add_u32 v239, 256, v239
    v_mfma_f32_4x4x4_16b_bf16 v[246:249], v[216:217], v[76:77], v[20:23]
    v_cvt_pk_bf16_f32 v100, v132, v133
    v_cvt_pk_bf16_f32 v101, v134, v135
    v_mfma_f32_4x4x4_16b_bf16 v[250:253], v[218:219], v[78:79], v[24:27]
    v_cvt_pk_bf16_f32 v102, v136, v137
    v_cvt_pk_bf16_f32 v103, v138, v139
    v_mfma_f32_4x4x4_16b_bf16 v[132:135], v[220:221], v[80:81], v[28:31]
    v_cvt_pk_bf16_f32 v104, v140, v141
    v_cvt_pk_bf16_f32 v105, v142, v143
    v_mfma_f32_4x4x4_16b_bf16 v[136:139], v[222:223], v[82:83], v[32:35]
    v_cvt_pk_bf16_f32 v106, v144, v145
    v_cvt_pk_bf16_f32 v107, v146, v147
    v_mfma_f32_4x4x4_16b_bf16 v[140:143], v[216:217], v[84:85], v[36:39]
    v_cvt_pk_bf16_f32 v108, v246, v247
    v_cvt_pk_bf16_f32 v109, v248, v249
    v_mfma_f32_4x4x4_16b_bf16 v[144:147], v[218:219], v[86:87], v[40:43]
    v_cvt_pk_bf16_f32 v110, v250, v251
    v_cvt_pk_bf16_f32 v111, v252, v253
    v_mfma_f32_4x4x4_16b_bf16 v[246:249], v[220:221], v[88:89], v[44:47]
    v_cvt_pk_bf16_f32 v112, v132, v133
    v_cvt_pk_bf16_f32 v113, v134, v135
    v_mfma_f32_4x4x4_16b_bf16 v[250:253], v[222:223], v[90:91], v[48:51]
    v_cvt_pk_bf16_f32 v114, v136, v137
    v_cvt_pk_bf16_f32 v115, v138, v139
    v_mfma_f32_4x4x4_16b_bf16 v[132:135], v[216:217], v[92:93], v[52:55]
    v_cvt_pk_bf16_f32 v116, v140, v141
    v_cvt_pk_bf16_f32 v117, v142, v143
    v_mfma_f32_4x4x4_16b_bf16 v[136:139], v[218:219], v[94:95], v[56:59]
    v_cvt_pk_bf16_f32 v118, v144, v145
    v_cvt_pk_bf16_f32 v119, v146, v147
    v_mfma_f32_4x4x4_16b_bf16 v[140:143], v[220:221], v[96:97], v[60:63]
    v_cvt_pk_bf16_f32 v120, v246, v247
    v_cvt_pk_bf16_f32 v121, v248, v249
    v_mfma_f32_4x4x4_16b_bf16 v[144:147], v[222:223], v[98:99], v[64:67]
    v_cvt_pk_bf16_f32 v122, v250, v251
    v_cvt_pk_bf16_f32 v123, v252, v253
    v_cvt_pk_bf16_f32 v124, v132, v133
    v_cvt_pk_bf16_f32 v125, v134, v135
    v_cvt_pk_bf16_f32 v126, v136, v137
    v_cvt_pk_bf16_f32 v127, v138, v139
    v_cvt_pk_bf16_f32 v128, v140, v141
    v_cvt_pk_bf16_f32 v129, v142, v143
    v_cvt_pk_bf16_f32 v130, v144, v145
    v_cvt_pk_bf16_f32 v131, v146, v147
    s_waitcnt lgkmcnt(0)
    s_branch Lf_wbd0
Lf_adv0:
    s_sub_u32 s60, s60, 1
    s_cselect_b32 s31, 0, s31
    s_add_u32 s20, s20, s31
    s_addc_u32 s21, s21, 0
    s_xor_b32 s31, s31, 0x63ff800
    s_branch Lf_advd0
Lf_last0:
    s_branch Lf_tail
Lf_flush1:
    v_cvt_pk_bf16_f32 v246, v212, v212
    v_mov_b32 v212, 0
    ds_write_b16 v240, v246
    v_add_u32 v240, 128, v240
    s_branch Lf_flushed1
Lf_wb1:
    s_sub_u32 s61, s61, 1
    s_cbranch_scc1 Lf_last1
    v_mul_u32_u24 v216, v224, v241
    v_mul_u32_u24 v217, v224, v242
    v_mul_u32_u24 v218, v225, v241
    v_mul_u32_u24 v219, v225, v242
    v_mul_u32_u24 v220, v226, v241
    v_mul_u32_u24 v221, v226, v242
    v_mul_u32_u24 v222, v227, v241
    v_mul_u32_u24 v223, v227, v242
    v_add_u32 v238, 128, v238
    ds_read_b128 v[164:167], v239
    v_mfma_f32_4x4x4_16b_bf16 v[132:135], v[216:217], v[68:69], v[4:7]
    ds_read_b128 v[168:171], v239 offset:64
    ds_read_b128 v[172:175], v239 offset:128
    v_mfma_f32_4x4x4_16b_bf16 v[136:139], v[218:219], v[70:71], v[8:11]
    ds_read_b128 v[176:179], v239 offset:192
    ds_read_u16 v224, v238
    v_mfma_f32_4x4x4_16b_bf16 v[140:143], v[220:221], v[72:73], v[12:15]
    ds_read_u16 v225, v238 offset:8
    ds_read_u16 v226, v238 offset:64
    v_mfma_f32_4x4x4_16b_bf16 v[144:147], v[222:223], v[74:75], v[16:19]
    ds_read_u16 v227, v238 offset:72
    v_add_u32 v239, 256, v239
    v_mfma_f32_4x4x4_16b_bf16 v[246:249], v[216:217], v[76:77], v[20:23]
    v_cvt_pk_bf16_f32 v100, v132, v133
    v_cvt_pk_bf16_f32 v101, v134, v135
    v_mfma_f32_4x4x4_16b_bf16 v[250:253], v[218:219], v[78:79], v[24:27]
    v_cvt_pk_bf16_f32 v102, v136, v137
    v_cvt_pk_bf16_f32 v103, v138, v139
    v_mfma_f32_4x4x4_16b_bf16 v[132:135], v[220:221], v[80:81], v[28:31]
    v_cvt_pk_bf16_f32 v104, v140, v141
    v_cvt_pk_bf16_f32 v105, v142, v143
    v_mfma_f32_4x4x4_16b_bf16 v[136:139], v[222:223], v[82:83], v[32:35]
    v_cvt_pk_bf16_f32 v106, v144, v145
    v_cvt_pk_bf16_f32 v107, v146, v147
    v_mfma_f32_4x4x4_16b_bf16 v[140:143], v[216:217], v[84:85], v[36:39]
    v_cvt_pk_bf16_f32 v108, v246, v247
    v_cvt_pk_bf16_f32 v109, v248, v249
    v_mfma_f32_4x4x4_16b_bf16 v[144:147], v[218:219], v[86:87], v[40:43]
    v_cvt_pk_bf16_f32 v110, v250, v251
    v_cvt_pk_bf16_f32 v111, v252, v253
    v_mfma_f32_4x4x4_16b_bf16 v[246:249], v[220:221], v[88:89], v[44:47]
    v_cvt_pk_bf16_f32 v112, v132, v133
    v_cvt_pk_bf16_f32 v113, v134, v135
    v_mfma_f32_4x4x4_16b_bf16 v[250:253], v[222:223], v[90:91], v[48:51]
    v_cvt_pk_bf16_f32 v114, v136, v137
    v_cvt_pk_bf16_f32 v115, v138, v139
    v_mfma_f32_4x4x4_16b_bf16 v[132:135], v[216:217], v[92:93], v[52:55]
    v_cvt_pk_bf16_f32 v116, v140, v141
    v_cvt_pk_bf16_f32 v117, v142, v143
    v_mfma_f32_4x4x4_16b_bf16 v[136:139], v[218:219], v[94:95], v[56:59]
    v_cvt_pk_bf16_f32 v118, v144, v145
    v_cvt_pk_bf16_f32 v119, v146, v147
    v_mfma_f32_4x4x4_16b_bf16 v[140:143], v[220:221], v[96:97], v[60:63]
    v_cvt_pk_bf16_f32 v120, v246, v247
    v_cvt_pk_bf16_f32 v121, v248, v249
    v_mfma_f32_4x4x4_16b_bf16 v[144:147], v[222:223], v[98:99], v[64:67]
    v_cvt_pk_bf16_f32 v122, v250, v251
    v_cvt_pk_bf16_f32 v123, v252, v253
    v_cvt_pk_bf16_f32 v124, v132, v133
    v_cvt_pk_bf16_f32 v125, v134, v135
    v_cvt_pk_bf16_f32 v126, v136, v137
    v_cvt_pk_bf16_f32 v127, v138, v139
    v_cvt_pk_bf16_f32 v128, v140, v141
    v_cvt_pk_bf16_f32 v129, v142, v143
    v_cvt_pk_bf16_f32 v130, v144, v145
    v_cvt_pk_bf16_f32 v131, v146, v147
    s_waitcnt lgkmcnt(0)
    s_branch Lf_wbd1
Lf_adv1:
    s_sub_u32 s60, s60, 1
    s_cselect_b32 s31, 0, s31
    s_add_u32 s20, s20, s31
    s_addc_u32 s21, s21, 0
    s_xor_b32 s31, s31, 0x63ff800
    s_branch Lf_advd1
Lf_last1:
    v_add_u32 v236, 2080, v236
    s_lshr_b64 s[56:57], s[56:57], 1
    s_branch Lf_tail
Lf_flush2:
    v_cvt_pk_bf16_f32 v246, v212, v212
    v_mov_b32 v212, 0
    ds_write_b16 v240, v246
    v_add_u32 v240, 128, v240
    s_branch Lf_flushed2
Lf_wb2:
    s_sub_u32 s61, s61, 1
    s_cbranch_scc1 Lf_last2
    v_mul_u32_u24 v216, v224, v241
    v_mul_u32_u24 v217, v224, v242
    v_mul_u32_u24 v218, v225, v241
    v_mul_u32_u24 v219, v225, v242
    v_mul_u32_u24 v220, v226, v241
    v_mul_u32_u24 v221, v226, v242
    v_mul_u32_u24 v222, v227, v241
    v_mul_u32_u24 v223, v227, v242
    v_add_u32 v238, 128, v238
    ds_read_b128 v[164:167], v239
    v_mfma_f32_4x4x4_16b_bf16 v[132:135], v[216:217], v[68:69], v[4:7]
    ds_read_b128 v[168:171], v239 offset:64
    ds_read_b128 v[172:175], v239 offset:128
    v_mfma_f32_4x4x4_16b_bf16 v[136:139], v[218:219], v[70:71], v[8:11]
    ds_read_b128 v[176:179], v239 offset:192
    ds_read_u16 v224, v238
    v_mfma_f32_4x4x4_16b_bf16 v[140:143], v[220:221], v[72:73], v[12:15]
    ds_read_u16 v225, v238 offset:8
    ds_read_u16 v226, v238 offset:64
    v_mfma_f32_4x4x4_16b_bf16 v[144:147], v[222:223], v[74:75], v[16:19]
    ds_read_u16 v227, v238 offset:72
    v_add_u32 v239, 256, v239
    v_mfma_f32_4x4x4_16b_bf16 v[246:249], v[216:217], v[76:77], v[20:23]
    v_cvt_pk_bf16_f32 v100, v132, v133
    v_cvt_pk_bf16_f32 v101, v134, v135
    v_mfma_f32_4x4x4_16b_bf16 v[250:253], v[218:219], v[78:79], v[24:27]
    v_cvt_pk_bf16_f32 v102, v136, v137
    v_cvt_pk_bf16_f32 v103, v138, v139
    v_mfma_f32_4x4x4_16b_bf16 v[132:135], v[220:221], v[80:81], v[28:31]
    v_cvt_pk_bf16_f32 v104, v140, v141
    v_cvt_pk_bf16_f32 v105, v142, v143
    v_mfma_f32_4x4x4_16b_bf16 v[136:139], v[222:223], v[82:83], v[32:35]
    v_cvt_pk_bf16_f32 v106, v144, v145
    v_cvt_pk_bf16_f32 v107, v146, v147
    v_mfma_f32_4x4x4_16b_bf16 v[140:143], v[216:217], v[84:85], v[36:39]
    v_cvt_pk_bf16_f32 v108, v246, v247
    v_cvt_pk_bf16_f32 v109, v248, v249
    v_mfma_f32_4x4x4_16b_bf16 v[144:147], v[218:219], v[86:87], v[40:43]
    v_cvt_pk_bf16_f32 v110, v250, v251
    v_cvt_pk_bf16_f32 v111, v252, v253
    v_mfma_f32_4x4x4_16b_bf16 v[246:249], v[220:221], v[88:89], v[44:47]
    v_cvt_pk_bf16_f32 v112, v132, v133
    v_cvt_pk_bf16_f32 v113, v134, v135
    v_mfma_f32_4x4x4_16b_bf16 v[250:253], v[222:223], v[90:91], v[48:51]
    v_cvt_pk_bf16_f32 v114, v136, v137
    v_cvt_pk_bf16_f32 v115, v138, v139
    v_mfma_f32_4x4x4_16b_bf16 v[132:135], v[216:217], v[92:93], v[52:55]
    v_cvt_pk_bf16_f32 v116, v140, v141
    v_cvt_pk_bf16_f32 v117, v142, v143
    v_mfma_f32_4x4x4_16b_bf16 v[136:139], v[218:219], v[94:95], v[56:59]
    v_cvt_pk_bf16_f32 v118, v144, v145
    v_cvt_pk_bf16_f32 v119, v146, v147
    v_mfma_f32_4x4x4_16b_bf16 v[140:143], v[220:221], v[96:97], v[60:63]
    v_cvt_pk_bf16_f32 v120, v246, v247
    v_cvt_pk_bf16_f32 v121, v248, v249
    v_mfma_f32_4x4x4_16b_bf16 v[144:147], v[222:223], v[98:99], v[64:67]
    v_cvt_pk_bf16_f32 v122, v250, v251
    v_cvt_pk_bf16_f32 v123, v252, v253
    v_cvt_pk_bf16_f32 v124, v132, v133
    v_cvt_pk_bf16_f32 v125, v134, v135
    v_cvt_pk_bf16_f32 v126, v136, v137
    v_cvt_pk_bf16_f32 v127, v138, v139
    v_cvt_pk_bf16_f32 v128, v140, v141
    v_cvt_pk_bf16_f32 v129, v142, v143
    v_cvt_pk_bf16_f32 v130, v144, v145
    v_cvt_pk_bf16_f32 v131, v146, v147
    s_waitcnt lgkmcnt(0)
    s_branch Lf_wbd2
Lf_adv2:
    s_sub_u32 s60, s60, 1
    s_cselect_b32 s31, 0, s31
    s_add_u32 s20, s20, s31
    s_addc_u32 s21, s21, 0
    s_xor_b32 s31, s31, 0x63ff800
    s_branch Lf_advd2
Lf_last2:
    v_add_u32 v236, 4160, v236
    s_lshr_b64 s[56:57], s[56:57], 2
    s_branch Lf_tail
Lf_flush3:
    v_cvt_pk_bf16_f32 v246, v212, v212
    v_mov_b32 v212, 0
    ds_write_b16 v240, v246
    v_add_u32 v240, 128, v240
    s_branch Lf_flushed3
Lf_wb3:
    s_sub_u32 s61, s61, 1
    s_cbranch_scc1 Lf_last3
    v_mul_u32_u24 v216, v224, v241
    v_mul_u32_u24 v217, v224, v242
    v_mul_u32_u24 v218, v225, v241
    v_mul_u32_u24 v219, v225, v242
    v_mul_u32_u24 v220, v226, v241
    v_mul_u32_u24 v221, v226, v242
    v_mul_u32_u24 v222, v227, v241
    v_mul_u32_u24 v223, v227, v242
    v_add_u32 v238, 128, v238
    ds_read_b128 v[164:167], v239
    v_mfma_f32_4x4x4_16b_bf16 v[132:135], v[216:217], v[68:69], v[4:7]
    ds_read_b128 v[168:171], v239 offset:64
    ds_read_b128 v[172:175], v239 offset:128
    v_mfma_f32_4x4x4_16b_bf16 v[136:139], v[218:219], v[70:71], v[8:11]
    ds_read_b128 v[176:179], v239 offset:192
    ds_read_u16 v224, v238
    v_mfma_f32_4x4x4_16b_bf16 v[140:143], v[220:221], v[72:73], v[12:15]
    ds_read_u16 v225, v238 offset:8
    ds_read_u16 v226, v238 offset:64
    v_mfma_f32_4x4x4_16b_bf16 v[144:147], v[222:223], v[74:75], v[16:19]
    ds_read_u16 v227, v238 offset:72
    v_add_u32 v239, 256, v239
    v_mfma_f32_4x4x4_16b_bf16 v[246:249], v[216:217], v[76:77], v[20:23]
    v_cvt_pk_bf16_f32 v100, v132, v133
    v_cvt_pk_bf16_f32 v101, v134, v135
    v_mfma_f32_4x4x4_16b_bf16 v[250:253], v[218:219], v[78:79], v[24:27]
    v_cvt_pk_bf16_f32 v102, v136, v137
    v_cvt_pk_bf16_f32 v103, v138, v139
    v_mfma_f32_4x4x4_16b_bf16 v[132:135], v[220:221], v[80:81], v[28:31]
    v_cvt_pk_bf16_f32 v104, v140, v141
    v_cvt_pk_bf16_f32 v105, v142, v143
    v_mfma_f32_4x4x4_16b_bf16 v[136:139], v[222:223], v[82:83], v[32:35]
    v_cvt_pk_bf16_f32 v106, v144, v145
    v_cvt_pk_bf16_f32 v107, v146, v147
    v_mfma_f32_4x4x4_16b_bf16 v[140:143], v[216:217], v[84:85], v[36:39]
    v_cvt_pk_bf16_f32 v108, v246, v247
    v_cvt_pk_bf16_f32 v109, v248, v249
    v_mfma_f32_4x4x4_16b_bf16 v[144:147], v[218:219], v[86:87], v[40:43]
    v_cvt_pk_bf16_f32 v110, v250, v251
    v_cvt_pk_bf16_f32 v111, v252, v253
    v_mfma_f32_4x4x4_16b_bf16 v[246:249], v[220:221], v[88:89], v[44:47]
    v_cvt_pk_bf16_f32 v112, v132, v133
    v_cvt_pk_bf16_f32 v113, v134, v135
    v_mfma_f32_4x4x4_16b_bf16 v[250:253], v[222:223], v[90:91], v[48:51]
    v_cvt_pk_bf16_f32 v114, v136, v137
    v_cvt_pk_bf16_f32 v115, v138, v139
    v_mfma_f32_4x4x4_16b_bf16 v[132:135], v[216:217], v[92:93], v[52:55]
    v_cvt_pk_bf16_f32 v116, v140, v141
    v_cvt_pk_bf16_f32 v117, v142, v143
    v_mfma_f32_4x4x4_16b_bf16 v[136:139], v[218:219], v[94:95], v[56:59]
    v_cvt_pk_bf16_f32 v118, v144, v145
    v_cvt_pk_bf16_f32 v119, v146, v147
    v_mfma_f32_4x4x4_16b_bf16 v[140:143], v[220:221], v[96:97], v[60:63]
    v_cvt_pk_bf16_f32 v120, v246, v247
    v_cvt_pk_bf16_f32 v121, v248, v249
    v_mfma_f32_4x4x4_16b_bf16 v[144:147], v[222:223], v[98:99], v[64:67]
    v_cvt_pk_bf16_f32 v122, v250, v251
    v_cvt_pk_bf16_f32 v123, v252, v253
    v_cvt_pk_bf16_f32 v124, v132, v133
    v_cvt_pk_bf16_f32 v125, v134, v135
    v_cvt_pk_bf16_f32 v126, v136, v137
    v_cvt_pk_bf16_f32 v127, v138, v139
    v_cvt_pk_bf16_f32 v128, v140, v141
    v_cvt_pk_bf16_f32 v129, v142, v143
    v_cvt_pk_bf16_f32 v130, v144, v145
    v_cvt_pk_bf16_f32 v131, v146, v147
    s_waitcnt lgkmcnt(0)
    s_branch Lf_wbd3
Lf_adv3:
    s_sub_u32 s60, s60, 1
    s_cselect_b32 s31, 0, s31
    s_add_u32 s20, s20, s31
    s_addc_u32 s21, s21, 0
    s_xor_b32 s31, s31, 0x63ff800
    s_branch Lf_advd3
Lf_last3:
    v_add_u32 v236, 6240, v236
    s_lshr_b64 s[56:57], s[56:57], 3
Lf_tail:
    v_exp_f32 v132, v148
    v_exp_f32 v133, v149
    v_exp_f32 v134, v150
    v_exp_f32 v135, v151
    v_exp_f32 v136, v152
    v_exp_f32 v137, v153
    v_mfma_f32_4x4x4_16b_bf16 v[132:135], v[228:229], v[228:229], v[132:135]
    v_cvt_pk_bf16_f32 v208, v208, v209
    v_cvt_pk_bf16_f32 v209, v210, v211
    v_exp_f32 v138, v154
    s_nop 0
    v_mfma_f32_4x4x4_16b_bf16 v[212:215], v[208:209], v[188:189], v[212:215] cbsz:4 abid:0
    ds_read_b64_tr_b16 v[188:189], v236 offset:0
    v_exp_f32 v139, v155
    v_exp_f32 v140, v156
    v_mfma_f32_4x4x4_16b_bf16 v[212:215], v[208:209], v[190:191], v[212:215] cbsz:4 abid:4
    ds_read_b64_tr_b16 v[190:191], v236 offset:512
    v_mfma_f32_4x4x4_16b_bf16 v[136:139], v[228:229], v[228:229], v[136:139]
    v_rcp_f32 v132, v132
    v_mfma_f32_4x4x4_16b_bf16 v[212:215], v[208:209], v[192:193], v[212:215] cbsz:4 abid:8
    ds_read_b64_tr_b16 v[192:193], v236 offset:1056
    v_exp_f32 v141, v157
    v_rcp_f32 v133, v133
    v_mfma_f32_4x4x4_16b_bf16 v[212:215], v[208:209], v[194:195], v[212:215] cbsz:4 abid:12
    ds_read_b64_tr_b16 v[194:195], v236 offset:1568
    v_exp_f32 v142, v158
    v_rcp_f32 v134, v134
    v_exp_f32 v143, v159
    v_rcp_f32 v135, v135
    v_cvt_pk_bf16_f32 v132, v132, v133
    v_mfma_f32_4x4x4_16b_bf16 v[140:143], v[228:229], v[228:229], v[140:143]
    v_exp_f32 v144, v160
    v_rcp_f32 v136, v136
    v_cvt_pk_bf16_f32 v133, v134, v135
    s_bitcmp1_b64 s[56:57], 0
    s_cbranch_scc1 Lf_flusht0
Lf_flushedt0:
    v_exp_f32 v145, v161
    v_rcp_f32 v137, v137
    v_exp_f32 v146, v162
    v_rcp_f32 v138, v138
    v_cvt_pk_bf16_f32 v134, v136, v137
    v_exp_f32 v147, v163
    s_waitcnt lgkmcnt(0)
    v_rcp_f32 v139, v139
    v_mfma_f32_4x4x4_16b_bf16 v[144:147], v[228:229], v[228:229], v[144:147]
    v_rcp_f32 v140, v140
    v_rcp_f32 v141, v141
    v_cvt_pk_bf16_f32 v135, v138, v139
    v_rcp_f32 v142, v142
    v_cvt_pk_bf16_f32 v136, v140, v141
    v_mfma_f32_16x16x32_bf16 v[208:211], v[132:135], v[196:199], v[204:207]
    v_rcp_f32 v143, v143
    v_rcp_f32 v144, v144
    v_cvt_pk_bf16_f32 v137, v142, v143
    v_rcp_f32 v145, v145
    v_rcp_f32 v146, v146
    v_rcp_f32 v147, v147
    v_cvt_pk_bf16_f32 v138, v144, v145
    v_cvt_pk_bf16_f32 v139, v146, v147
    s_nop 1
    v_mfma_f32_16x16x32_bf16 v[208:211], v[136:139], v[200:203], v[208:211]
    s_nop 7
    v_cvt_pk_bf16_f32 v208, v208, v209
    v_cvt_pk_bf16_f32 v209, v210, v211
    s_nop 1
    v_mfma_f32_4x4x4_16b_bf16 v[212:215], v[208:209], v[188:189], v[212:215] cbsz:4 abid:0
    s_nop 1
    v_mfma_f32_4x4x4_16b_bf16 v[212:215], v[208:209], v[190:191], v[212:215] cbsz:4 abid:4
    s_nop 1
    v_mfma_f32_4x4x4_16b_bf16 v[212:215], v[208:209], v[192:193], v[212:215] cbsz:4 abid:8
    s_nop 1
    v_mfma_f32_4x4x4_16b_bf16 v[212:215], v[208:209], v[194:195], v[212:215] cbsz:4 abid:12
Lf_flushz:
    s_nop 4
    v_cvt_pk_bf16_f32 v246, v212, v212
    v_mov_b32 v212, 0
    ds_write_b16 v240, v246
    s_branch L_store
Lf_flusht0:
    v_cvt_pk_bf16_f32 v246, v212, v212
    v_mov_b32 v212, 0
    ds_write_b16 v240, v246
    v_add_u32 v240, 128, v240
    s_branch Lf_flushedt0
L_store:
    s_add_u32 s66, s52, 8320
    v_lshl_add_u32 v247, v0, 4, s66
    s_waitcnt lgkmcnt(0)
    ds_read_b128 v[148:151], v247
    s_waitcnt lgkmcnt(0)
    global_store_dwordx4 v243, v[148:151], s[18:19]
L_end:
    s_endpgm
Ls_loop:
    ds_read_u8 v230, v237 offset:64
    ds_read_u8 v232, v237 offset:72
    v_mfma_f32_16x16x32_bf16 v[208:211], v[136:139], v[200:203], v[208:211]
Ls_mid:
    ds_read_b32 v246, v244 offset:0
    s_waitcnt lgkmcnt(0)
    v_bfe_u32 v247, v246, 0, 8
    v_lshlrev_b32 v247, 1, v247
    v_bfe_u32 v248, v246, 8, 8
    v_lshlrev_b32 v248, 1, v248
    v_bfe_u32 v249, v246, 16, 8
    v_lshlrev_b32 v249, 1, v249
    v_bfe_u32 v250, v246, 24, 8
    v_lshlrev_b32 v250, 1, v250
    buffer_load_ushort v247, v247, s[24:27], 0 offen
    buffer_load_ushort v248, v248, s[24:27], 0 offen
    buffer_load_ushort v249, v249, s[24:27], 0 offen
    buffer_load_ushort v250, v250, s[24:27], 0 offen
    s_waitcnt vmcnt(0)
    v_lshlrev_b32 v247, 16, v247
    v_mul_f32 v208, v208, v247
    v_lshlrev_b32 v248, 16, v248
    v_mul_f32 v209, v209, v248
    v_lshlrev_b32 v249, 16, v249
    v_mul_f32 v210, v210, v249
    v_lshlrev_b32 v250, 16, v250
    v_mul_f32 v211, v211, v250
    s_bitcmp1_b64 s[56:57], 1
    s_cbranch_scc1 Ls_wb0
Ls_wbd0:
    s_mov_b64 exec, 1
    ds_add_rtn_u32 v1, v2, v3
    s_mov_b64 exec, -1
    v_exp_f32 v132, v148
    v_exp_f32 v133, v149
    v_exp_f32 v134, v150
    v_exp_f32 v135, v151
    v_exp_f32 v136, v152
    v_exp_f32 v137, v153
    v_mfma_f32_4x4x4_16b_bf16 v[132:135], v[228:229], v[228:229], v[132:135]
    v_cvt_pk_bf16_f32 v208, v208, v209
    v_cvt_pk_bf16_f32 v209, v210, v211
    s_waitcnt lgkmcnt(2)
    v_mfma_f32_16x16x32_bf16 v[148:151], v[100:103], v[180:183], v[164:167]
    v_exp_f32 v138, v154
    v_mfma_f32_4x4x4_16b_bf16 v[212:215], v[208:209], v[188:189], v[212:215] cbsz:4 abid:0
    ds_read_b64_tr_b16 v[188:189], v236 offset:0
    v_exp_f32 v139, v155
    v_mfma_f32_16x16x32_bf16 v[152:155], v[108:111], v[180:183], v[168:171]
    v_exp_f32 v140, v156
    v_mfma_f32_4x4x4_16b_bf16 v[212:215], v[208:209], v[190:191], v[212:215] cbsz:4 abid:4
    ds_read_b64_tr_b16 v[190:191], v236 offset:512
    v_mfma_f32_4x4x4_16b_bf16 v[136:139], v[228:229], v[228:229], v[136:139]
    v_rcp_f32 v132, v132
    v_mfma_f32_4x4x4_16b_bf16 v[212:215], v[208:209], v[192:193], v[212:215] cbsz:4 abid:8
    ds_read_b64_tr_b16 v[192:193], v236 offset:1056
    v_exp_f32 v141, v157
    v_mfma_f32_16x16x32_bf16 v[148:151], v[104:107], v[184:187], v[148:151]
    v_rcp_f32 v133, v133
    v_mfma_f32_4x4x4_16b_bf16 v[212:215], v[208:209], v[194:195], v[212:215] cbsz:4 abid:12
    ds_read_b64_tr_b16 v[194:195], v236 offset:1568
    v_exp_f32 v142, v158
    v_mfma_f32_16x16x32_bf16 v[152:155], v[112:115], v[184:187], v[152:155]
    v_rcp_f32 v134, v134
    v_exp_f32 v143, v159
    v_rcp_f32 v135, v135
    v_cvt_pk_bf16_f32 v132, v132, v133
    v_mfma_f32_4x4x4_16b_bf16 v[140:143], v[228:229], v[228:229], v[140:143]
    v_exp_f32 v144, v160
    v_mfma_f32_16x16x32_bf16 v[156:159], v[116:119], v[180:183], v[172:175]
    v_rcp_f32 v136, v136
    v_cvt_pk_bf16_f32 v133, v134, v135
    s_bitcmp1_b64 s[56:57], 0
    s_cbranch_scc1 Ls_flush0
Ls_flushed0:
    v_exp_f32 v145, v161
    v_rcp_f32 v137, v137
    v_exp_f32 v146, v162
    s_bitcmp1_b64 s[56:57], 4
    s_cbranch_scc1 Ls_adv0
Ls_advd0:
    v_rcp_f32 v138, v138
    v_cvt_pk_bf16_f32 v134, v136, v137
    v_exp_f32 v147, v163
    v_mfma_f32_16x16x32_bf16 v[160:163], v[124:127], v[180:183], v[176:179]
    s_waitcnt lgkmcnt(0)
    s_add_u32 m0, s52, 0
    v_rcp_f32 v139, v139
    buffer_load_dwordx4 v[230:231], s[20:23], 0 idxen offen nt lds
    v_mfma_f32_4x4x4_16b_bf16 v[144:147], v[228:229], v[228:229], v[144:147]
    v_mfma_f32_16x16x32_bf16 v[156:159], v[120:123], v[184:187], v[156:159]
    s_add_u32 m0, s52, 1056
    v_rcp_f32 v140, v140
    buffer_load_dwordx4 v[232:233], s[20:23], 0 idxen offen nt lds
    v_mfma_f32_16x16x32_bf16 v[160:163], v[128:131], v[184:187], v[160:163]
    v_readfirstlane_b32 s66, v1
    s_nop 0
    s_xor_b32 s66, s66, s33
    s_cmp_gt_i32 s66, 0
    s_setprio 0
    s_cbranch_scc0 Ls_lo0
    s_setprio 1
Ls_lo0:
    v_rcp_f32 v141, v141
    v_cvt_pk_bf16_f32 v135, v138, v139
    s_waitcnt vmcnt(4)
    ds_read_b128 v[180:183], v234 offset:4160
    ds_read_b128 v[184:187], v235 offset:4160
    v_rcp_f32 v142, v142
    v_cvt_pk_bf16_f32 v136, v140, v141
    v_mfma_f32_16x16x32_bf16 v[208:211], v[132:135], v[196:199], v[204:207]
    v_rcp_f32 v143, v143
    v_rcp_f32 v144, v144
    v_cvt_pk_bf16_f32 v137, v142, v143
    v_rcp_f32 v145, v145
    v_rcp_f32 v146, v146
    v_rcp_f32 v147, v147
    v_cvt_pk_bf16_f32 v138, v144, v145
    v_cvt_pk_bf16_f32 v139, v146, v147
    ds_read_u8 v230, v237 offset:80
    ds_read_u8 v232, v237 offset:88
    v_mfma_f32_16x16x32_bf16 v[208:211], v[136:139], v[200:203], v[208:211]
    ds_read_b32 v246, v244 offset:16
    s_waitcnt lgkmcnt(0)
    v_bfe_u32 v247, v246, 0, 8
    v_lshlrev_b32 v247, 1, v247
    v_bfe_u32 v248, v246, 8, 8
    v_lshlrev_b32 v248, 1, v248
    v_bfe_u32 v249, v246, 16, 8
    v_lshlrev_b32 v249, 1, v249
    v_bfe_u32 v250, v246, 24, 8
    v_lshlrev_b32 v250, 1, v250
    buffer_load_ushort v247, v247, s[24:27], 0 offen
    buffer_load_ushort v248, v248, s[24:27], 0 offen
    buffer_load_ushort v249, v249, s[24:27], 0 offen
    buffer_load_ushort v250, v250, s[24:27], 0 offen
    s_waitcnt vmcnt(0)
    v_lshlrev_b32 v247, 16, v247
    v_mul_f32 v208, v208, v247
    v_lshlrev_b32 v248, 16, v248
    v_mul_f32 v209, v209, v248
    v_lshlrev_b32 v249, 16, v249
    v_mul_f32 v210, v210, v249
    v_lshlrev_b32 v250, 16, v250
    v_mul_f32 v211, v211, v250
    s_bitcmp1_b64 s[56:57], 2
    s_cbranch_scc1 Ls_wb1
Ls_wbd1:
    v_exp_f32 v132, v148
    v_exp_f32 v133, v149
    v_exp_f32 v134, v150
    v_exp_f32 v135, v151
    v_exp_f32 v136, v152
    v_exp_f32 v137, v153
    v_mfma_f32_4x4x4_16b_bf16 v[132:135], v[228:229], v[228:229], v[132:135]
    v_cvt_pk_bf16_f32 v208, v208, v209
    v_cvt_pk_bf16_f32 v209, v210, v211
    s_waitcnt lgkmcnt(2)
    v_mfma_f32_16x16x32_bf16 v[148:151], v[100:103], v[180:183], v[164:167]
    v_exp_f32 v138, v154
    v_mfma_f32_4x4x4_16b_bf16 v[212:215], v[208:209], v[188:189], v[212:215] cbsz:4 abid:0
    ds_read_b64_tr_b16 v[188:189], v236 offset:2080
    v_exp_f32 v139, v155
    v_mfma_f32_16x16x32_bf16 v[152:155], v[108:111], v[180:183], v[168:171]
    v_exp_f32 v140, v156
    v_mfma_f32_4x4x4_16b_bf16 v[212:215], v[208:209], v[190:191], v[212:215] cbsz:4 abid:4
    ds_read_b64_tr_b16 v[190:191], v236 offset:2592
    v_mfma_f32_4x4x4_16b_bf16 v[136:139], v[228:229], v[228:229], v[136:139]
    v_rcp_f32 v132, v132
    v_mfma_f32_4x4x4_16b_bf16 v[212:215], v[208:209], v[192:193], v[212:215] cbsz:4 abid:8
    ds_read_b64_tr_b16 v[192:193], v236 offset:3136
    v_exp_f32 v141, v157
    v_mfma_f32_16x16x32_bf16 v[148:151], v[104:107], v[184:187], v[148:151]
    v_rcp_f32 v133, v133
    v_mfma_f32_4x4x4_16b_bf16 v[212:215], v[208:209], v[194:195], v[212:215] cbsz:4 abid:12
    ds_read_b64_tr_b16 v[194:195], v236 offset:3648
    v_exp_f32 v142, v158
    v_mfma_f32_16x16x32_bf16 v[152:155], v[112:115], v[184:187], v[152:155]
    v_rcp_f32 v134, v134
    v_exp_f32 v143, v159
    v_rcp_f32 v135, v135
    v_cvt_pk_bf16_f32 v132, v132, v133
    v_mfma_f32_4x4x4_16b_bf16 v[140:143], v[228:229], v[228:229], v[140:143]
    v_exp_f32 v144, v160
    v_mfma_f32_16x16x32_bf16 v[156:159], v[116:119], v[180:183], v[172:175]
    v_rcp_f32 v136, v136
    v_cvt_pk_bf16_f32 v133, v134, v135
    s_bitcmp1_b64 s[56:57], 1
    s_cbranch_scc1 Ls_flush1
Ls_flushed1:
    v_exp_f32 v145, v161
    v_rcp_f32 v137, v137
    v_exp_f32 v146, v162
    s_bitcmp1_b64 s[56:57], 5
    s_cbranch_scc1 Ls_adv1
Ls_advd1:
    v_rcp_f32 v138, v138
    v_cvt_pk_bf16_f32 v134, v136, v137
    v_exp_f32 v147, v163
    v_mfma_f32_16x16x32_bf16 v[160:163], v[124:127], v[180:183], v[176:179]
    s_waitcnt lgkmcnt(0)
    s_add_u32 m0, s52, 2080
    v_rcp_f32 v139, v139
    buffer_load_dwordx4 v[230:231], s[20:23], 0 idxen offen nt lds
    v_mfma_f32_4x4x4_16b_bf16 v[144:147], v[228:229], v[228:229], v[144:147]
    v_mfma_f32_16x16x32_bf16 v[156:159], v[120:123], v[184:187], v[156:159]
    s_add_u32 m0, s52, 3136
    v_rcp_f32 v140, v140
    buffer_load_dwordx4 v[232:233], s[20:23], 0 idxen offen nt lds
    v_mfma_f32_16x16x32_bf16 v[160:163], v[128:131], v[184:187], v[160:163]
    v_rcp_f32 v141, v141
    v_cvt_pk_bf16_f32 v135, v138, v139
    s_waitcnt vmcnt(4)
    ds_read_b128 v[180:183], v234 offset:6240
    ds_read_b128 v[184:187], v235 offset:6240
    v_rcp_f32 v142, v142
    v_cvt_pk_bf16_f32 v136, v140, v141
    v_mfma_f32_16x16x32_bf16 v[208:211], v[132:135], v[196:199], v[204:207]
    v_rcp_f32 v143, v143
    v_rcp_f32 v144, v144
    v_cvt_pk_bf16_f32 v137, v142, v143
    v_rcp_f32 v145, v145
    v_rcp_f32 v146, v146
    v_rcp_f32 v147, v147
    v_cvt_pk_bf16_f32 v138, v144, v145
    v_cvt_pk_bf16_f32 v139, v146, v147
    ds_read_u8 v230, v237 offset:96
    ds_read_u8 v232, v237 offset:104
    v_mfma_f32_16x16x32_bf16 v[208:211], v[136:139], v[200:203], v[208:211]
    ds_read_b32 v246, v244 offset:32
    s_waitcnt lgkmcnt(0)
    v_bfe_u32 v247, v246, 0, 8
    v_lshlrev_b32 v247, 1, v247
    v_bfe_u32 v248, v246, 8, 8
    v_lshlrev_b32 v248, 1, v248
    v_bfe_u32 v249, v246, 16, 8
    v_lshlrev_b32 v249, 1, v249
    v_bfe_u32 v250, v246, 24, 8
    v_lshlrev_b32 v250, 1, v250
    buffer_load_ushort v247, v247, s[24:27], 0 offen
    buffer_load_ushort v248, v248, s[24:27], 0 offen
    buffer_load_ushort v249, v249, s[24:27], 0 offen
    buffer_load_ushort v250, v250, s[24:27], 0 offen
    s_waitcnt vmcnt(0)
    v_lshlrev_b32 v247, 16, v247
    v_mul_f32 v208, v208, v247
    v_lshlrev_b32 v248, 16, v248
    v_mul_f32 v209, v209, v248
    v_lshlrev_b32 v249, 16, v249
    v_mul_f32 v210, v210, v249
    v_lshlrev_b32 v250, 16, v250
    v_mul_f32 v211, v211, v250
    s_bitcmp1_b64 s[56:57], 3
    s_cbranch_scc1 Ls_wb2
Ls_wbd2:
    s_mov_b64 exec, 1
    ds_add_rtn_u32 v1, v2, v3
    s_mov_b64 exec, -1
    v_exp_f32 v132, v148
    v_exp_f32 v133, v149
    v_exp_f32 v134, v150
    v_exp_f32 v135, v151
    v_exp_f32 v136, v152
    v_exp_f32 v137, v153
    v_mfma_f32_4x4x4_16b_bf16 v[132:135], v[228:229], v[228:229], v[132:135]
    v_cvt_pk_bf16_f32 v208, v208, v209
    v_cvt_pk_bf16_f32 v209, v210, v211
    s_waitcnt lgkmcnt(2)
    v_mfma_f32_16x16x32_bf16 v[148:151], v[100:103], v[180:183], v[164:167]
    v_exp_f32 v138, v154
    v_mfma_f32_4x4x4_16b_bf16 v[212:215], v[208:209], v[188:189], v[212:215] cbsz:4 abid:0
    ds_read_b64_tr_b16 v[188:189], v236 offset:4160
    v_exp_f32 v139, v155
    v_mfma_f32_16x16x32_bf16 v[152:155], v[108:111], v[180:183], v[168:171]
    v_exp_f32 v140, v156
    v_mfma_f32_4x4x4_16b_bf16 v[212:215], v[208:209], v[190:191], v[212:215] cbsz:4 abid:4
    ds_read_b64_tr_b16 v[190:191], v236 offset:4672
    v_mfma_f32_4x4x4_16b_bf16 v[136:139], v[228:229], v[228:229], v[136:139]
    v_rcp_f32 v132, v132
    v_mfma_f32_4x4x4_16b_bf16 v[212:215], v[208:209], v[192:193], v[212:215] cbsz:4 abid:8
    ds_read_b64_tr_b16 v[192:193], v236 offset:5216
    v_exp_f32 v141, v157
    v_mfma_f32_16x16x32_bf16 v[148:151], v[104:107], v[184:187], v[148:151]
    v_rcp_f32 v133, v133
    v_mfma_f32_4x4x4_16b_bf16 v[212:215], v[208:209], v[194:195], v[212:215] cbsz:4 abid:12
    ds_read_b64_tr_b16 v[194:195], v236 offset:5728
    v_exp_f32 v142, v158
    v_mfma_f32_16x16x32_bf16 v[152:155], v[112:115], v[184:187], v[152:155]
    v_rcp_f32 v134, v134
    v_exp_f32 v143, v159
    v_rcp_f32 v135, v135
    v_cvt_pk_bf16_f32 v132, v132, v133
    v_mfma_f32_4x4x4_16b_bf16 v[140:143], v[228:229], v[228:229], v[140:143]
    v_exp_f32 v144, v160
    v_mfma_f32_16x16x32_bf16 v[156:159], v[116:119], v[180:183], v[172:175]
    v_rcp_f32 v136, v136
    v_cvt_pk_bf16_f32 v133, v134, v135
    s_bitcmp1_b64 s[56:57], 2
    s_cbranch_scc1 Ls_flush2
Ls_flushed2:
    v_exp_f32 v145, v161
    v_rcp_f32 v137, v137
    v_exp_f32 v146, v162
    s_bitcmp1_b64 s[56:57], 6
    s_cbranch_scc1 Ls_adv2
Ls_advd2:
    v_rcp_f32 v138, v138
    v_cvt_pk_bf16_f32 v134, v136, v137
    v_exp_f32 v147, v163
    v_mfma_f32_16x16x32_bf16 v[160:163], v[124:127], v[180:183], v[176:179]
    s_waitcnt lgkmcnt(0)
    s_add_u32 m0, s52, 4160
    v_rcp_f32 v139, v139
    buffer_load_dwordx4 v[230:231], s[20:23], 0 idxen offen nt lds
    v_mfma_f32_4x4x4_16b_bf16 v[144:147], v[228:229], v[228:229], v[144:147]
    v_mfma_f32_16x16x32_bf16 v[156:159], v[120:123], v[184:187], v[156:159]
    s_add_u32 m0, s52, 5216
    v_rcp_f32 v140, v140
    buffer_load_dwordx4 v[232:233], s[20:23], 0 idxen offen nt lds
    v_mfma_f32_16x16x32_bf16 v[160:163], v[128:131], v[184:187], v[160:163]
    v_readfirstlane_b32 s66, v1
    s_nop 0
    s_xor_b32 s66, s66, s33
    s_cmp_gt_i32 s66, 0
    s_setprio 0
    s_cbranch_scc0 Ls_lo2
    s_setprio 1
Ls_lo2:
    v_rcp_f32 v141, v141
    v_cvt_pk_bf16_f32 v135, v138, v139
    s_waitcnt vmcnt(4)
    ds_read_b128 v[180:183], v234 offset:0
    ds_read_b128 v[184:187], v235 offset:0
    v_rcp_f32 v142, v142
    v_cvt_pk_bf16_f32 v136, v140, v141
    v_mfma_f32_16x16x32_bf16 v[208:211], v[132:135], v[196:199], v[204:207]
    v_rcp_f32 v143, v143
    v_rcp_f32 v144, v144
    v_cvt_pk_bf16_f32 v137, v142, v143
    v_rcp_f32 v145, v145
    v_rcp_f32 v146, v146
    v_rcp_f32 v147, v147
    v_cvt_pk_bf16_f32 v138, v144, v145
    v_cvt_pk_bf16_f32 v139, v146, v147
    ds_read_u8 v230, v237 offset:112
    ds_read_u8 v232, v237 offset:120
    v_mfma_f32_16x16x32_bf16 v[208:211], v[136:139], v[200:203], v[208:211]
    ds_read_b32 v246, v244 offset:48
    s_waitcnt lgkmcnt(0)
    v_bfe_u32 v247, v246, 0, 8
    v_lshlrev_b32 v247, 1, v247
    v_bfe_u32 v248, v246, 8, 8
    v_lshlrev_b32 v248, 1, v248
    v_bfe_u32 v249, v246, 16, 8
    v_lshlrev_b32 v249, 1, v249
    v_bfe_u32 v250, v246, 24, 8
    v_lshlrev_b32 v250, 1, v250
    buffer_load_ushort v247, v247, s[24:27], 0 offen
    buffer_load_ushort v248, v248, s[24:27], 0 offen
    buffer_load_ushort v249, v249, s[24:27], 0 offen
    buffer_load_ushort v250, v250, s[24:27], 0 offen
    s_waitcnt vmcnt(0)
    v_lshlrev_b32 v247, 16, v247
    v_mul_f32 v208, v208, v247
    v_lshlrev_b32 v248, 16, v248
    v_mul_f32 v209, v209, v248
    v_lshlrev_b32 v249, 16, v249
    v_mul_f32 v210, v210, v249
    v_lshlrev_b32 v250, 16, v250
    v_mul_f32 v211, v211, v250
    s_bitcmp1_b64 s[56:57], 4
    s_cbranch_scc1 Ls_wb3
Ls_wbd3:
    v_exp_f32 v132, v148
    v_exp_f32 v133, v149
    v_exp_f32 v134, v150
    v_exp_f32 v135, v151
    v_exp_f32 v136, v152
    v_exp_f32 v137, v153
    v_mfma_f32_4x4x4_16b_bf16 v[132:135], v[228:229], v[228:229], v[132:135]
    v_cvt_pk_bf16_f32 v208, v208, v209
    v_cvt_pk_bf16_f32 v209, v210, v211
    s_waitcnt lgkmcnt(2)
    v_mfma_f32_16x16x32_bf16 v[148:151], v[100:103], v[180:183], v[164:167]
    v_exp_f32 v138, v154
    v_mfma_f32_4x4x4_16b_bf16 v[212:215], v[208:209], v[188:189], v[212:215] cbsz:4 abid:0
    ds_read_b64_tr_b16 v[188:189], v236 offset:6240
    v_exp_f32 v139, v155
    v_mfma_f32_16x16x32_bf16 v[152:155], v[108:111], v[180:183], v[168:171]
    v_exp_f32 v140, v156
    v_mfma_f32_4x4x4_16b_bf16 v[212:215], v[208:209], v[190:191], v[212:215] cbsz:4 abid:4
    ds_read_b64_tr_b16 v[190:191], v236 offset:6752
    v_mfma_f32_4x4x4_16b_bf16 v[136:139], v[228:229], v[228:229], v[136:139]
    v_rcp_f32 v132, v132
    v_mfma_f32_4x4x4_16b_bf16 v[212:215], v[208:209], v[192:193], v[212:215] cbsz:4 abid:8
    ds_read_b64_tr_b16 v[192:193], v236 offset:7296
    v_exp_f32 v141, v157
    v_mfma_f32_16x16x32_bf16 v[148:151], v[104:107], v[184:187], v[148:151]
    v_rcp_f32 v133, v133
    v_mfma_f32_4x4x4_16b_bf16 v[212:215], v[208:209], v[194:195], v[212:215] cbsz:4 abid:12
    ds_read_b64_tr_b16 v[194:195], v236 offset:7808
    v_exp_f32 v142, v158
    v_mfma_f32_16x16x32_bf16 v[152:155], v[112:115], v[184:187], v[152:155]
    v_rcp_f32 v134, v134
    v_exp_f32 v143, v159
    v_rcp_f32 v135, v135
    v_cvt_pk_bf16_f32 v132, v132, v133
    v_mfma_f32_4x4x4_16b_bf16 v[140:143], v[228:229], v[228:229], v[140:143]
    v_exp_f32 v144, v160
    v_mfma_f32_16x16x32_bf16 v[156:159], v[116:119], v[180:183], v[172:175]
    v_rcp_f32 v136, v136
    v_cvt_pk_bf16_f32 v133, v134, v135
    s_bitcmp1_b64 s[56:57], 3
    s_cbranch_scc1 Ls_flush3
Ls_flushed3:
    v_exp_f32 v145, v161
    v_rcp_f32 v137, v137
    v_exp_f32 v146, v162
    s_bitcmp1_b64 s[56:57], 7
    s_cbranch_scc1 Ls_adv3
Ls_advd3:
    v_rcp_f32 v138, v138
    v_cvt_pk_bf16_f32 v134, v136, v137
    v_exp_f32 v147, v163
    v_mfma_f32_16x16x32_bf16 v[160:163], v[124:127], v[180:183], v[176:179]
    s_waitcnt lgkmcnt(0)
    s_add_u32 m0, s52, 6240
    v_rcp_f32 v139, v139
    buffer_load_dwordx4 v[230:231], s[20:23], 0 idxen offen nt lds
    v_mfma_f32_4x4x4_16b_bf16 v[144:147], v[228:229], v[228:229], v[144:147]
    v_mfma_f32_16x16x32_bf16 v[156:159], v[120:123], v[184:187], v[156:159]
    s_add_u32 m0, s52, 7296
    v_rcp_f32 v140, v140
    buffer_load_dwordx4 v[232:233], s[20:23], 0 idxen offen nt lds
    v_mfma_f32_16x16x32_bf16 v[160:163], v[128:131], v[184:187], v[160:163]
    v_rcp_f32 v141, v141
    v_cvt_pk_bf16_f32 v135, v138, v139
    s_waitcnt vmcnt(4)
    ds_read_b128 v[180:183], v234 offset:2080
    ds_read_b128 v[184:187], v235 offset:2080
    v_rcp_f32 v142, v142
    v_cvt_pk_bf16_f32 v136, v140, v141
    v_mfma_f32_16x16x32_bf16 v[208:211], v[132:135], v[196:199], v[204:207]
    v_rcp_f32 v143, v143
    s_lshr_b64 s[56:57], s[56:57], 4
    s_lshl_b64 s[86:87], s[58:59], 60
    s_or_b64 s[56:57], s[56:57], s[86:87]
    s_lshr_b64 s[58:59], s[58:59], 4
    v_add_u32 v237, 64, v237
    v_add_u32 v244, 64, v244
    v_rcp_f32 v144, v144
    v_cvt_pk_bf16_f32 v137, v142, v143
    v_rcp_f32 v145, v145
    v_rcp_f32 v146, v146
    v_rcp_f32 v147, v147
    v_cvt_pk_bf16_f32 v138, v144, v145
    v_cvt_pk_bf16_f32 v139, v146, v147
    s_branch Ls_loop
Ls_flush0:
    v_cvt_pk_bf16_f32 v246, v212, v212
    v_mov_b32 v212, 0
    ds_write_b16 v240, v246
    v_add_u32 v240, 128, v240
    s_add_u32 s24, s24, s32
    s_addc_u32 s25, s25, 0
    s_xor_b32 s32, s32, 0x18ffe0
    s_branch Ls_flushed0
Ls_wb0:
    s_sub_u32 s61, s61, 1
    s_cbranch_scc1 Ls_last0
    v_mul_u32_u24 v216, v224, v241
    v_mul_u32_u24 v217, v224, v242
    v_mul_u32_u24 v218, v225, v241
    v_mul_u32_u24 v219, v225, v242
    v_mul_u32_u24 v220, v226, v241
    v_mul_u32_u24 v221, v226, v242
    v_mul_u32_u24 v222, v227, v241
    v_mul_u32_u24 v223, v227, v242
    v_add_u32 v238, 128, v238
    ds_read_b128 v[164:167], v239
    v_mfma_f32_4x4x4_16b_bf16 v[132:135], v[216:217], v[68:69], v[4:7]
    ds_read_b128 v[168:171], v239 offset:64
    ds_read_b128 v[172:175], v239 offset:128
    v_mfma_f32_4x4x4_16b_bf16 v[136:139], v[218:219], v[70:71], v[8:11]
    ds_read_b128 v[176:179], v239 offset:192
    ds_read_u16 v224, v238
    v_mfma_f32_4x4x4_16b_bf16 v[140:143], v[220:221], v[72:73], v[12:15]
    ds_read_u16 v225, v238 offset:8
    ds_read_u16 v226, v238 offset:64
    v_mfma_f32_4x4x4_16b_bf16 v[144:147], v[222:223], v[74:75], v[16:19]
    ds_read_u16 v227, v238 offset:72
    v_add_u32 v239, 256, v239
    v_mfma_f32_4x4x4_16b_bf16 v[246:249], v[216:217], v[76:77], v[20:23]
    v_cvt_pk_bf16_f32 v100, v132, v133
    v_cvt_pk_bf16_f32 v101, v134, v135
    v_mfma_f32_4x4x4_16b_bf16 v[250:253], v[218:219], v[78:79], v[24:27]
    v_cvt_pk_bf16_f32 v102, v136, v137
    v_cvt_pk_bf16_f32 v103, v138, v139
    v_mfma_f32_4x4x4_16b_bf16 v[132:135], v[220:221], v[80:81], v[28:31]
    v_cvt_pk_bf16_f32 v104, v140, v141
    v_cvt_pk_bf16_f32 v105, v142, v143
    v_mfma_f32_4x4x4_16b_bf16 v[136:139], v[222:223], v[82:83], v[32:35]
    v_cvt_pk_bf16_f32 v106, v144, v145
    v_cvt_pk_bf16_f32 v107, v146, v147
    v_mfma_f32_4x4x4_16b_bf16 v[140:143], v[216:217], v[84:85], v[36:39]
    v_cvt_pk_bf16_f32 v108, v246, v247
    v_cvt_pk_bf16_f32 v109, v248, v249
    v_mfma_f32_4x4x4_16b_bf16 v[144:147], v[218:219], v[86:87], v[40:43]
    v_cvt_pk_bf16_f32 v110, v250, v251
    v_cvt_pk_bf16_f32 v111, v252, v253
    v_mfma_f32_4x4x4_16b_bf16 v[246:249], v[220:221], v[88:89], v[44:47]
    v_cvt_pk_bf16_f32 v112, v132, v133
    v_cvt_pk_bf16_f32 v113, v134, v135
    v_mfma_f32_4x4x4_16b_bf16 v[250:253], v[222:223], v[90:91], v[48:51]
    v_cvt_pk_bf16_f32 v114, v136, v137
    v_cvt_pk_bf16_f32 v115, v138, v139
    v_mfma_f32_4x4x4_16b_bf16 v[132:135], v[216:217], v[92:93], v[52:55]
    v_cvt_pk_bf16_f32 v116, v140, v141
    v_cvt_pk_bf16_f32 v117, v142, v143
    v_mfma_f32_4x4x4_16b_bf16 v[136:139], v[218:219], v[94:95], v[56:59]
    v_cvt_pk_bf16_f32 v118, v144, v145
    v_cvt_pk_bf16_f32 v119, v146, v147
    v_mfma_f32_4x4x4_16b_bf16 v[140:143], v[220:221], v[96:97], v[60:63]
    v_cvt_pk_bf16_f32 v120, v246, v247
    v_cvt_pk_bf16_f32 v121, v248, v249
    v_mfma_f32_4x4x4_16b_bf16 v[144:147], v[222:223], v[98:99], v[64:67]
    v_cvt_pk_bf16_f32 v122, v250, v251
    v_cvt_pk_bf16_f32 v123, v252, v253
    v_cvt_pk_bf16_f32 v124, v132, v133
    v_cvt_pk_bf16_f32 v125, v134, v135
    v_cvt_pk_bf16_f32 v126, v136, v137
    v_cvt_pk_bf16_f32 v127, v138, v139
    v_cvt_pk_bf16_f32 v128, v140, v141
    v_cvt_pk_bf16_f32 v129, v142, v143
    v_cvt_pk_bf16_f32 v130, v144, v145
    v_cvt_pk_bf16_f32 v131, v146, v147
    s_waitcnt lgkmcnt(0)
    s_branch Ls_wbd0
Ls_adv0:
    s_sub_u32 s60, s60, 1
    s_cselect_b32 s31, 0, s31
    s_add_u32 s20, s20, s31
    s_addc_u32 s21, s21, 0
    s_xor_b32 s31, s31, 0x63ff800
    s_branch Ls_advd0
Ls_last0:
    v_add_u32 v244, 16, v244
    s_branch Ls_tail
Ls_flush1:
    v_cvt_pk_bf16_f32 v246, v212, v212
    v_mov_b32 v212, 0
    ds_write_b16 v240, v246
    v_add_u32 v240, 128, v240
    s_add_u32 s24, s24, s32
    s_addc_u32 s25, s25, 0
    s_xor_b32 s32, s32, 0x18ffe0
    s_branch Ls_flushed1
Ls_wb1:
    s_sub_u32 s61, s61, 1
    s_cbranch_scc1 Ls_last1
    v_mul_u32_u24 v216, v224, v241
    v_mul_u32_u24 v217, v224, v242
    v_mul_u32_u24 v218, v225, v241
    v_mul_u32_u24 v219, v225, v242
    v_mul_u32_u24 v220, v226, v241
    v_mul_u32_u24 v221, v226, v242
    v_mul_u32_u24 v222, v227, v241
    v_mul_u32_u24 v223, v227, v242
    v_add_u32 v238, 128, v238
    ds_read_b128 v[164:167], v239
    v_mfma_f32_4x4x4_16b_bf16 v[132:135], v[216:217], v[68:69], v[4:7]
    ds_read_b128 v[168:171], v239 offset:64
    ds_read_b128 v[172:175], v239 offset:128
    v_mfma_f32_4x4x4_16b_bf16 v[136:139], v[218:219], v[70:71], v[8:11]
    ds_read_b128 v[176:179], v239 offset:192
    ds_read_u16 v224, v238
    v_mfma_f32_4x4x4_16b_bf16 v[140:143], v[220:221], v[72:73], v[12:15]
    ds_read_u16 v225, v238 offset:8
    ds_read_u16 v226, v238 offset:64
    v_mfma_f32_4x4x4_16b_bf16 v[144:147], v[222:223], v[74:75], v[16:19]
    ds_read_u16 v227, v238 offset:72
    v_add_u32 v239, 256, v239
    v_mfma_f32_4x4x4_16b_bf16 v[246:249], v[216:217], v[76:77], v[20:23]
    v_cvt_pk_bf16_f32 v100, v132, v133
    v_cvt_pk_bf16_f32 v101, v134, v135
    v_mfma_f32_4x4x4_16b_bf16 v[250:253], v[218:219], v[78:79], v[24:27]
    v_cvt_pk_bf16_f32 v102, v136, v137
    v_cvt_pk_bf16_f32 v103, v138, v139
    v_mfma_f32_4x4x4_16b_bf16 v[132:135], v[220:221], v[80:81], v[28:31]
    v_cvt_pk_bf16_f32 v104, v140, v141
    v_cvt_pk_bf16_f32 v105, v142, v143
    v_mfma_f32_4x4x4_16b_bf16 v[136:139], v[222:223], v[82:83], v[32:35]
    v_cvt_pk_bf16_f32 v106, v144, v145
    v_cvt_pk_bf16_f32 v107, v146, v147
    v_mfma_f32_4x4x4_16b_bf16 v[140:143], v[216:217], v[84:85], v[36:39]
    v_cvt_pk_bf16_f32 v108, v246, v247
    v_cvt_pk_bf16_f32 v109, v248, v249
    v_mfma_f32_4x4x4_16b_bf16 v[144:147], v[218:219], v[86:87], v[40:43]
    v_cvt_pk_bf16_f32 v110, v250, v251
    v_cvt_pk_bf16_f32 v111, v252, v253
    v_mfma_f32_4x4x4_16b_bf16 v[246:249], v[220:221], v[88:89], v[44:47]
    v_cvt_pk_bf16_f32 v112, v132, v133
    v_cvt_pk_bf16_f32 v113, v134, v135
    v_mfma_f32_4x4x4_16b_bf16 v[250:253], v[222:223], v[90:91], v[48:51]
    v_cvt_pk_bf16_f32 v114, v136, v137
    v_cvt_pk_bf16_f32 v115, v138, v139
    v_mfma_f32_4x4x4_16b_bf16 v[132:135], v[216:217], v[92:93], v[52:55]
    v_cvt_pk_bf16_f32 v116, v140, v141
    v_cvt_pk_bf16_f32 v117, v142, v143
    v_mfma_f32_4x4x4_16b_bf16 v[136:139], v[218:219], v[94:95], v[56:59]
    v_cvt_pk_bf16_f32 v118, v144, v145
    v_cvt_pk_bf16_f32 v119, v146, v147
    v_mfma_f32_4x4x4_16b_bf16 v[140:143], v[220:221], v[96:97], v[60:63]
    v_cvt_pk_bf16_f32 v120, v246, v247
    v_cvt_pk_bf16_f32 v121, v248, v249
    v_mfma_f32_4x4x4_16b_bf16 v[144:147], v[222:223], v[98:99], v[64:67]
    v_cvt_pk_bf16_f32 v122, v250, v251
    v_cvt_pk_bf16_f32 v123, v252, v253
    v_cvt_pk_bf16_f32 v124, v132, v133
    v_cvt_pk_bf16_f32 v125, v134, v135
    v_cvt_pk_bf16_f32 v126, v136, v137
    v_cvt_pk_bf16_f32 v127, v138, v139
    v_cvt_pk_bf16_f32 v128, v140, v141
    v_cvt_pk_bf16_f32 v129, v142, v143
    v_cvt_pk_bf16_f32 v130, v144, v145
    v_cvt_pk_bf16_f32 v131, v146, v147
    s_waitcnt lgkmcnt(0)
    s_branch Ls_wbd1
Ls_adv1:
    s_sub_u32 s60, s60, 1
    s_cselect_b32 s31, 0, s31
    s_add_u32 s20, s20, s31
    s_addc_u32 s21, s21, 0
    s_xor_b32 s31, s31, 0x63ff800
    s_branch Ls_advd1
Ls_last1:
    v_add_u32 v236, 2080, v236
    s_lshr_b64 s[56:57], s[56:57], 1
    v_add_u32 v244, 32, v244
    s_branch Ls_tail
Ls_flush2:
    v_cvt_pk_bf16_f32 v246, v212, v212
    v_mov_b32 v212, 0
    ds_write_b16 v240, v246
    v_add_u32 v240, 128, v240
    s_add_u32 s24, s24, s32
    s_addc_u32 s25, s25, 0
    s_xor_b32 s32, s32, 0x18ffe0
    s_branch Ls_flushed2
Ls_wb2:
    s_sub_u32 s61, s61, 1
    s_cbranch_scc1 Ls_last2
    v_mul_u32_u24 v216, v224, v241
    v_mul_u32_u24 v217, v224, v242
    v_mul_u32_u24 v218, v225, v241
    v_mul_u32_u24 v219, v225, v242
    v_mul_u32_u24 v220, v226, v241
    v_mul_u32_u24 v221, v226, v242
    v_mul_u32_u24 v222, v227, v241
    v_mul_u32_u24 v223, v227, v242
    v_add_u32 v238, 128, v238
    ds_read_b128 v[164:167], v239
    v_mfma_f32_4x4x4_16b_bf16 v[132:135], v[216:217], v[68:69], v[4:7]
    ds_read_b128 v[168:171], v239 offset:64
    ds_read_b128 v[172:175], v239 offset:128
    v_mfma_f32_4x4x4_16b_bf16 v[136:139], v[218:219], v[70:71], v[8:11]
    ds_read_b128 v[176:179], v239 offset:192
    ds_read_u16 v224, v238
    v_mfma_f32_4x4x4_16b_bf16 v[140:143], v[220:221], v[72:73], v[12:15]
    ds_read_u16 v225, v238 offset:8
    ds_read_u16 v226, v238 offset:64
    v_mfma_f32_4x4x4_16b_bf16 v[144:147], v[222:223], v[74:75], v[16:19]
    ds_read_u16 v227, v238 offset:72
    v_add_u32 v239, 256, v239
    v_mfma_f32_4x4x4_16b_bf16 v[246:249], v[216:217], v[76:77], v[20:23]
    v_cvt_pk_bf16_f32 v100, v132, v133
    v_cvt_pk_bf16_f32 v101, v134, v135
    v_mfma_f32_4x4x4_16b_bf16 v[250:253], v[218:219], v[78:79], v[24:27]
    v_cvt_pk_bf16_f32 v102, v136, v137
    v_cvt_pk_bf16_f32 v103, v138, v139
    v_mfma_f32_4x4x4_16b_bf16 v[132:135], v[220:221], v[80:81], v[28:31]
    v_cvt_pk_bf16_f32 v104, v140, v141
    v_cvt_pk_bf16_f32 v105, v142, v143
    v_mfma_f32_4x4x4_16b_bf16 v[136:139], v[222:223], v[82:83], v[32:35]
    v_cvt_pk_bf16_f32 v106, v144, v145
    v_cvt_pk_bf16_f32 v107, v146, v147
    v_mfma_f32_4x4x4_16b_bf16 v[140:143], v[216:217], v[84:85], v[36:39]
    v_cvt_pk_bf16_f32 v108, v246, v247
    v_cvt_pk_bf16_f32 v109, v248, v249
    v_mfma_f32_4x4x4_16b_bf16 v[144:147], v[218:219], v[86:87], v[40:43]
    v_cvt_pk_bf16_f32 v110, v250, v251
    v_cvt_pk_bf16_f32 v111, v252, v253
    v_mfma_f32_4x4x4_16b_bf16 v[246:249], v[220:221], v[88:89], v[44:47]
    v_cvt_pk_bf16_f32 v112, v132, v133
    v_cvt_pk_bf16_f32 v113, v134, v135
    v_mfma_f32_4x4x4_16b_bf16 v[250:253], v[222:223], v[90:91], v[48:51]
    v_cvt_pk_bf16_f32 v114, v136, v137
    v_cvt_pk_bf16_f32 v115, v138, v139
    v_mfma_f32_4x4x4_16b_bf16 v[132:135], v[216:217], v[92:93], v[52:55]
    v_cvt_pk_bf16_f32 v116, v140, v141
    v_cvt_pk_bf16_f32 v117, v142, v143
    v_mfma_f32_4x4x4_16b_bf16 v[136:139], v[218:219], v[94:95], v[56:59]
    v_cvt_pk_bf16_f32 v118, v144, v145
    v_cvt_pk_bf16_f32 v119, v146, v147
    v_mfma_f32_4x4x4_16b_bf16 v[140:143], v[220:221], v[96:97], v[60:63]
    v_cvt_pk_bf16_f32 v120, v246, v247
    v_cvt_pk_bf16_f32 v121, v248, v249
    v_mfma_f32_4x4x4_16b_bf16 v[144:147], v[222:223], v[98:99], v[64:67]
    v_cvt_pk_bf16_f32 v122, v250, v251
    v_cvt_pk_bf16_f32 v123, v252, v253
    v_cvt_pk_bf16_f32 v124, v132, v133
    v_cvt_pk_bf16_f32 v125, v134, v135
    v_cvt_pk_bf16_f32 v126, v136, v137
    v_cvt_pk_bf16_f32 v127, v138, v139
    v_cvt_pk_bf16_f32 v128, v140, v141
    v_cvt_pk_bf16_f32 v129, v142, v143
    v_cvt_pk_bf16_f32 v130, v144, v145
    v_cvt_pk_bf16_f32 v131, v146, v147
    s_waitcnt lgkmcnt(0)
    s_branch Ls_wbd2
Ls_adv2:
    s_sub_u32 s60, s60, 1
    s_cselect_b32 s31, 0, s31
    s_add_u32 s20, s20, s31
    s_addc_u32 s21, s21, 0
    s_xor_b32 s31, s31, 0x63ff800
    s_branch Ls_advd2
Ls_last2:
    v_add_u32 v236, 4160, v236
    s_lshr_b64 s[56:57], s[56:57], 2
    v_add_u32 v244, 48, v244
    s_branch Ls_tail
Ls_flush3:
    v_cvt_pk_bf16_f32 v246, v212, v212
    v_mov_b32 v212, 0
    ds_write_b16 v240, v246
    v_add_u32 v240, 128, v240
    s_add_u32 s24, s24, s32
    s_addc_u32 s25, s25, 0
    s_xor_b32 s32, s32, 0x18ffe0
    s_branch Ls_flushed3
Ls_wb3:
    s_sub_u32 s61, s61, 1
    s_cbranch_scc1 Ls_last3
    v_mul_u32_u24 v216, v224, v241
    v_mul_u32_u24 v217, v224, v242
    v_mul_u32_u24 v218, v225, v241
    v_mul_u32_u24 v219, v225, v242
    v_mul_u32_u24 v220, v226, v241
    v_mul_u32_u24 v221, v226, v242
    v_mul_u32_u24 v222, v227, v241
    v_mul_u32_u24 v223, v227, v242
    v_add_u32 v238, 128, v238
    ds_read_b128 v[164:167], v239
    v_mfma_f32_4x4x4_16b_bf16 v[132:135], v[216:217], v[68:69], v[4:7]
    ds_read_b128 v[168:171], v239 offset:64
    ds_read_b128 v[172:175], v239 offset:128
    v_mfma_f32_4x4x4_16b_bf16 v[136:139], v[218:219], v[70:71], v[8:11]
    ds_read_b128 v[176:179], v239 offset:192
    ds_read_u16 v224, v238
    v_mfma_f32_4x4x4_16b_bf16 v[140:143], v[220:221], v[72:73], v[12:15]
    ds_read_u16 v225, v238 offset:8
    ds_read_u16 v226, v238 offset:64
    v_mfma_f32_4x4x4_16b_bf16 v[144:147], v[222:223], v[74:75], v[16:19]
    ds_read_u16 v227, v238 offset:72
    v_add_u32 v239, 256, v239
    v_mfma_f32_4x4x4_16b_bf16 v[246:249], v[216:217], v[76:77], v[20:23]
    v_cvt_pk_bf16_f32 v100, v132, v133
    v_cvt_pk_bf16_f32 v101, v134, v135
    v_mfma_f32_4x4x4_16b_bf16 v[250:253], v[218:219], v[78:79], v[24:27]
    v_cvt_pk_bf16_f32 v102, v136, v137
    v_cvt_pk_bf16_f32 v103, v138, v139
    v_mfma_f32_4x4x4_16b_bf16 v[132:135], v[220:221], v[80:81], v[28:31]
    v_cvt_pk_bf16_f32 v104, v140, v141
    v_cvt_pk_bf16_f32 v105, v142, v143
    v_mfma_f32_4x4x4_16b_bf16 v[136:139], v[222:223], v[82:83], v[32:35]
    v_cvt_pk_bf16_f32 v106, v144, v145
    v_cvt_pk_bf16_f32 v107, v146, v147
    v_mfma_f32_4x4x4_16b_bf16 v[140:143], v[216:217], v[84:85], v[36:39]
    v_cvt_pk_bf16_f32 v108, v246, v247
    v_cvt_pk_bf16_f32 v109, v248, v249
    v_mfma_f32_4x4x4_16b_bf16 v[144:147], v[218:219], v[86:87], v[40:43]
    v_cvt_pk_bf16_f32 v110, v250, v251
    v_cvt_pk_bf16_f32 v111, v252, v253
    v_mfma_f32_4x4x4_16b_bf16 v[246:249], v[220:221], v[88:89], v[44:47]
    v_cvt_pk_bf16_f32 v112, v132, v133
    v_cvt_pk_bf16_f32 v113, v134, v135
    v_mfma_f32_4x4x4_16b_bf16 v[250:253], v[222:223], v[90:91], v[48:51]
    v_cvt_pk_bf16_f32 v114, v136, v137
    v_cvt_pk_bf16_f32 v115, v138, v139
    v_mfma_f32_4x4x4_16b_bf16 v[132:135], v[216:217], v[92:93], v[52:55]
    v_cvt_pk_bf16_f32 v116, v140, v141
    v_cvt_pk_bf16_f32 v117, v142, v143
    v_mfma_f32_4x4x4_16b_bf16 v[136:139], v[218:219], v[94:95], v[56:59]
    v_cvt_pk_bf16_f32 v118, v144, v145
    v_cvt_pk_bf16_f32 v119, v146, v147
    v_mfma_f32_4x4x4_16b_bf16 v[140:143], v[220:221], v[96:97], v[60:63]
    v_cvt_pk_bf16_f32 v120, v246, v247
    v_cvt_pk_bf16_f32 v121, v248, v249
    v_mfma_f32_4x4x4_16b_bf16 v[144:147], v[222:223], v[98:99], v[64:67]
    v_cvt_pk_bf16_f32 v122, v250, v251
    v_cvt_pk_bf16_f32 v123, v252, v253
    v_cvt_pk_bf16_f32 v124, v132, v133
    v_cvt_pk_bf16_f32 v125, v134, v135
    v_cvt_pk_bf16_f32 v126, v136, v137
    v_cvt_pk_bf16_f32 v127, v138, v139
    v_cvt_pk_bf16_f32 v128, v140, v141
    v_cvt_pk_bf16_f32 v129, v142, v143
    v_cvt_pk_bf16_f32 v130, v144, v145
    v_cvt_pk_bf16_f32 v131, v146, v147
    s_waitcnt lgkmcnt(0)
    s_branch Ls_wbd3
Ls_adv3:
    s_sub_u32 s60, s60, 1
    s_cselect_b32 s31, 0, s31
    s_add_u32 s20, s20, s31
    s_addc_u32 s21, s21, 0
    s_xor_b32 s31, s31, 0x63ff800
    s_branch Ls_advd3
Ls_last3:
    v_add_u32 v236, 6240, v236
    s_lshr_b64 s[56:57], s[56:57], 3
    v_add_u32 v244, 64, v244
Ls_tail:
    v_exp_f32 v132, v148
    v_exp_f32 v133, v149
    v_exp_f32 v134, v150
    v_exp_f32 v135, v151
    v_exp_f32 v136, v152
    v_exp_f32 v137, v153
    v_mfma_f32_4x4x4_16b_bf16 v[132:135], v[228:229], v[228:229], v[132:135]
    v_cvt_pk_bf16_f32 v208, v208, v209
    v_cvt_pk_bf16_f32 v209, v210, v211
    v_exp_f32 v138, v154
    s_nop 0
    v_mfma_f32_4x4x4_16b_bf16 v[212:215], v[208:209], v[188:189], v[212:215] cbsz:4 abid:0
    ds_read_b64_tr_b16 v[188:189], v236 offset:0
    v_exp_f32 v139, v155
    v_exp_f32 v140, v156
    v_mfma_f32_4x4x4_16b_bf16 v[212:215], v[208:209], v[190:191], v[212:215] cbsz:4 abid:4
    ds_read_b64_tr_b16 v[190:191], v236 offset:512
    v_mfma_f32_4x4x4_16b_bf16 v[136:139], v[228:229], v[228:229], v[136:139]
    v_rcp_f32 v132, v132
    v_mfma_f32_4x4x4_16b_bf16 v[212:215], v[208:209], v[192:193], v[212:215] cbsz:4 abid:8
    ds_read_b64_tr_b16 v[192:193], v236 offset:1056
    v_exp_f32 v141, v157
    v_rcp_f32 v133, v133
    v_mfma_f32_4x4x4_16b_bf16 v[212:215], v[208:209], v[194:195], v[212:215] cbsz:4 abid:12
    ds_read_b64_tr_b16 v[194:195], v236 offset:1568
    v_exp_f32 v142, v158
    v_rcp_f32 v134, v134
    v_exp_f32 v143, v159
    v_rcp_f32 v135, v135
    v_cvt_pk_bf16_f32 v132, v132, v133
    v_mfma_f32_4x4x4_16b_bf16 v[140:143], v[228:229], v[228:229], v[140:143]
    v_exp_f32 v144, v160
    v_rcp_f32 v136, v136
    v_cvt_pk_bf16_f32 v133, v134, v135
    s_bitcmp1_b64 s[56:57], 0
    s_cbranch_scc1 Ls_flusht0
Ls_flushedt0:
    v_exp_f32 v145, v161
    v_rcp_f32 v137, v137
    v_exp_f32 v146, v162
    v_rcp_f32 v138, v138
    v_cvt_pk_bf16_f32 v134, v136, v137
    v_exp_f32 v147, v163
    s_waitcnt lgkmcnt(0)
    v_rcp_f32 v139, v139
    v_mfma_f32_4x4x4_16b_bf16 v[144:147], v[228:229], v[228:229], v[144:147]
    v_rcp_f32 v140, v140
    v_rcp_f32 v141, v141
    v_cvt_pk_bf16_f32 v135, v138, v139
    v_rcp_f32 v142, v142
    v_cvt_pk_bf16_f32 v136, v140, v141
    v_mfma_f32_16x16x32_bf16 v[208:211], v[132:135], v[196:199], v[204:207]
    v_rcp_f32 v143, v143
    v_rcp_f32 v144, v144
    v_cvt_pk_bf16_f32 v137, v142, v143
    v_rcp_f32 v145, v145
    v_rcp_f32 v146, v146
    v_rcp_f32 v147, v147
    v_cvt_pk_bf16_f32 v138, v144, v145
    v_cvt_pk_bf16_f32 v139, v146, v147
    s_nop 1
    v_mfma_f32_16x16x32_bf16 v[208:211], v[136:139], v[200:203], v[208:211]
    ds_read_b32 v246, v244 offset:0
    s_waitcnt lgkmcnt(0)
    v_bfe_u32 v247, v246, 0, 8
    v_lshlrev_b32 v247, 1, v247
    v_bfe_u32 v248, v246, 8, 8
    v_lshlrev_b32 v248, 1, v248
    v_bfe_u32 v249, v246, 16, 8
    v_lshlrev_b32 v249, 1, v249
    v_bfe_u32 v250, v246, 24, 8
    v_lshlrev_b32 v250, 1, v250
    buffer_load_ushort v247, v247, s[24:27], 0 offen
    buffer_load_ushort v248, v248, s[24:27], 0 offen
    buffer_load_ushort v249, v249, s[24:27], 0 offen
    buffer_load_ushort v250, v250, s[24:27], 0 offen
    s_waitcnt vmcnt(0)
    v_lshlrev_b32 v247, 16, v247
    v_mul_f32 v208, v208, v247
    v_lshlrev_b32 v248, 16, v248
    v_mul_f32 v209, v209, v248
    v_lshlrev_b32 v249, 16, v249
    v_mul_f32 v210, v210, v249
    v_lshlrev_b32 v250, 16, v250
    v_mul_f32 v211, v211, v250
    v_cvt_pk_bf16_f32 v208, v208, v209
    v_cvt_pk_bf16_f32 v209, v210, v211
    s_nop 1
    v_mfma_f32_4x4x4_16b_bf16 v[212:215], v[208:209], v[188:189], v[212:215] cbsz:4 abid:0
    s_nop 1
    v_mfma_f32_4x4x4_16b_bf16 v[212:215], v[208:209], v[190:191], v[212:215] cbsz:4 abid:4
    s_nop 1
    v_mfma_f32_4x4x4_16b_bf16 v[212:215], v[208:209], v[192:193], v[212:215] cbsz:4 abid:8
    s_nop 1
    v_mfma_f32_4x4x4_16b_bf16 v[212:215], v[208:209], v[194:195], v[212:215] cbsz:4 abid:12
Ls_flushz:
    s_nop 4
    v_cvt_pk_bf16_f32 v246, v212, v212
    v_mov_b32 v212, 0
    ds_write_b16 v240, v246
    s_branch L_store
Ls_flusht0:
    v_cvt_pk_bf16_f32 v246, v212, v212
    v_mov_b32 v212, 0
    ds_write_b16 v240, v246
    v_add_u32 v240, 128, v240
    s_add_u32 s24, s24, s32
    s_addc_u32 s25, s25, 0
    s_xor_b32 s32, s32, 0x18ffe0
    s_branch Ls_flushedt0
.section .rodata,"a"
.p2align 6
.amdhsa_kernel standalone__sequential_behavior_din__recsys_kernel
  .amdhsa_next_free_vgpr 256
  .amdhsa_next_free_sgpr 102
  .amdhsa_accum_offset 256
  .amdhsa_group_segment_fixed_size 0
  .amdhsa_kernarg_size 80
  .amdhsa_user_sgpr_count 2
  .amdhsa_user_sgpr_kernarg_segment_ptr 1
  .amdhsa_system_sgpr_workgroup_id_x 1
.end_amdhsa_kernel
```

```asm
; @launch grid=(256,1,1) block=(512,1,1) lds=163840
.amdgcn_target "amdgcn-amd-amdhsa--gfx950"
.text
.globl standalone__sequential_behavior_din__recsys_kernel
.p2align 8
.type standalone__sequential_behavior_din__recsys_kernel,@function
standalone__sequential_behavior_din__recsys_kernel:
    s_load_dwordx16 s[4:19], s[0:1], 0
    s_cmp_ge_u32 s2, 256
    s_cbranch_scc1 L_end
    v_lshrrev_b32 v1, 6, v0
    v_and_b32 v0, 63, v0
    v_readfirstlane_b32 s54, v1
    s_lshl_b32 s53, s2, 3
    v_lshlrev_b32 v2, 4, v0
    s_bfm_b64 s[28:29], 50, 0
    s_add_u32 s53, s53, s54
    s_mul_i32 s66, s53, 800
    s_mul_i32 s52, s54, 20480
    v_add_u32 v3, s66, v2
    v_and_b32 v248, 16, v0
    v_lshlrev_b32 v246, 1, v248
    v_xor_b32 v246, v246, v2
    s_lshl_b32 s67, s54, 12
    s_add_u32 m0, s52, 4160
    s_mov_b64 exec, s[28:29]
    s_waitcnt lgkmcnt(0)
    global_load_dwordx4 v[100:103], v3, s[8:9] nt
    s_mov_b64 exec, -1
    s_add_u32 s10, s10, s67
    s_addc_u32 s11, s11, 0
    v_xor_b32 v247, 64, v246
    global_load_lds_dwordx4 v246, s[10:11] offset:0
    global_load_lds_dwordx4 v247, s[10:11] offset:1024
    global_load_lds_dwordx4 v246, s[10:11] offset:2048
    global_load_lds_dwordx4 v247, s[10:11] offset:3072
    s_load_dword s30, s[16:17], 0
    v_lshrrev_b32 v1, 4, v0
    v_and_b32 v243, 0xf0, v2
    v_lshl_add_u32 v243, v1, 19, v243
    s_lshl_b32 s66, s53, 8
    s_add_u32 m0, s52, 8320
    v_add_u32 v243, s66, v243
    s_and_b32 s67, s54, 3
    global_load_lds_dwordx4 v243, s[4:5] nt
    s_lshl_b32 s66, s67, 5
    v_lshl_add_u32 v249, v1, 3, s66
    global_load_dwordx2 v[96:97], v249, s[12:13]
    v_and_b32 v250, 3, v0
    s_mul_i32 s66, s53, 51200
    s_add_u32 s6, s6, s66
    s_addc_u32 s7, s7, 0
    s_mov_b32 s20, s6
    s_and_b32 s21, s7, 0xffff
    s_or_b32 s21, s21, 0x800000
    s_mov_b32 s22, 200
    s_mov_b32 s23, 0x20000
    s_movk_i32 s31, 25600
    v_mov_b32 v148, -1
    v_mov_b32 v149, -1
    v_mov_b32 v150, -1
    v_mov_b32 v151, -1
    s_add_u32 s66, s52, 18416
    v_add_u32 v152, s66, v2
    ds_write_b128 v152, v[148:151]
    ds_write_b128 v152, v[148:151] offset:1024
    s_add_u32 s64, s52, 18432
    v_lshrrev_b32 v237, 3, v0
    v_add_u32 v237, s64, v237
    v_lshl_add_u32 v244, v1, 2, s66
    v_and_b32 v231, 0x70, v2
    v_lshlrev_b32 v248, 2, v248
    v_xor_b32 v231, v231, v248
    v_mov_b32 v233, v231
    v_cmp_lt_u32 vcc, 24, v0
    v_mov_b32 v146, 0
    v_mov_b32 v147, 0
    v_cndmask_b32 v145, 0, 1, vcc
    v_mul_u32_u24 v142, 25, v145
    v_sub_u32 v142, v0, v142
    v_mul_u32_u24 v142, 0x80008, v142
    v_add_u32 v141, 0x10000, v142
    v_add_u32 v143, 0x50004, v142
    v_add_u32 v144, 0x70006, v142
    v_add_u32 v142, 0x30002, v142
    s_mov_b64 s[56:57], 0
    s_mov_b64 s[58:59], 0
    s_mov_b32 s60, 7
    s_mov_b32 s61, 7
    s_mov_b32 s92, 0xbfb8aa3b
    v_and_b32 v251, 15, v0
    v_bfe_u32 v252, v0, 2, 2
    v_lshlrev_b32 v253, 3, v250
    v_lshl_add_u32 v253, v252, 7, v253
    v_and_b32 v246, 24, v0
    v_lshlrev_b32 v246, 2, v246
    v_xor_b32 v246, v253, v246
    v_lshl_add_u32 v246, v1, 10, v246
    s_lshl_b32 s66, s67, 5
    v_xor_b32 v66, s66, v246
    v_add_u32 v66, 45120, v66
    s_lshr_b32 s66, s54, 1
    s_lshl_b32 s66, s66, 5
    v_xor_b32 v64, s66, v246
    s_and_b32 s66, s54, 1
    s_mul_i32 s66, s66, 20480
    s_add_u32 s66, s66, 4160
    v_add_u32 v64, s66, v64
    v_add_u32 v65, 81920, v64
    s_and_b32 s66, s54, 4
    v_lshrrev_b32 v246, 3, v251
    v_add_u32 v246, s66, v246
    v_mul_u32_u24 v246, 20480, v246
    v_lshl_add_u32 v246, v1, 4, v246
    v_and_b32 v247, 7, v0
    v_lshl_add_u32 v67, v247, 7, v246
    v_and_b32 v247, 1, v0
    v_lshlrev_b32 v247, 4, v247
    v_lshlrev_b32 v247, v247, 1
    v_cmp_gt_u32 vcc, 2, v250
    v_mov_b32 v229, 0
    v_mov_b32 v228, 0x3f80
    v_cndmask_b32 v241, 0, v247, vcc
    v_cmp_eq_u32 vcc, 0, v251
    v_sub_u32 v242, v247, v241
    v_mul_u32_u24 v218, 0x3f80, v241
    v_cndmask_b32 v220, 0, -1, vcc
    v_mul_u32_u24 v219, 0x3f80, v242
    s_and_b32 s66, s54, 3
    s_lshl_b32 s66, s66, 6
    s_add_u32 s66, s66, 9344
    v_and_b32 v247, 7, v0
    v_mul_u32_u24 v247, 144, v247
    v_add3_u32 v98, v67, v247, s66
    s_and_b32 s66, s54, 3
    s_mul_i32 s66, s66, 20480
    s_add_u32 s66, s66, 14592
    v_mov_b32 v221, s66
    s_cmp_ge_u32 s54, 4
    s_cselect_b32 s33, -1, 0
    ds_write_b32 v221, v229
    s_mov_b64 exec, s[28:29]
    v_add_u32 v3, 1638400, v3
    global_load_dwordx4 v[104:107], v3, s[8:9] nt
    v_add_u32 v3, 1638400, v3
    global_load_dwordx4 v[108:111], v3, s[8:9] nt
    v_add_u32 v3, 1638400, v3
    global_load_dwordx4 v[112:115], v3, s[8:9] nt
    s_mov_b64 exec, -1
    v_lshlrev_b32 v249, 3, v1
    v_lshl_add_u32 v249, v250, 5, v249
    global_load_dwordx2 v[216:217], v249, s[14:15]
    s_waitcnt vmcnt(10) lgkmcnt(0)
    s_mov_b64 exec, s[28:29]
    v_cmp_neq_f16_sdwa s[68:69], v100, 0 src0_sel:WORD_0 src1_sel:WORD_0
    v_cmp_neq_f16_sdwa s[70:71], v100, 0 src0_sel:WORD_1 src1_sel:WORD_0
    v_cmp_neq_f16_sdwa s[72:73], v101, 0 src0_sel:WORD_0 src1_sel:WORD_0
    v_cmp_neq_f16_sdwa s[74:75], v101, 0 src0_sel:WORD_1 src1_sel:WORD_0
    v_cmp_neq_f16_sdwa s[76:77], v102, 0 src0_sel:WORD_0 src1_sel:WORD_0
    v_cmp_neq_f16_sdwa s[78:79], v102, 0 src0_sel:WORD_1 src1_sel:WORD_0
    v_cmp_neq_f16_sdwa s[80:81], v103, 0 src0_sel:WORD_0 src1_sel:WORD_0
    v_cmp_neq_f16_sdwa s[82:83], v103, 0 src0_sel:WORD_1 src1_sel:WORD_0
    v_sad_u16 v147, v100, 0, v147
    v_sad_u16 v147, v101, 0, v147
    v_sad_u16 v147, v102, 0, v147
    v_sad_u16 v147, v103, 0, v147
    v_or3_b32 v146, v100, v101, v146
    v_or3_b32 v146, v102, v103, v146
    s_mov_b64 exec, -1
    v_mov_b32 v132, s64
    v_mbcnt_lo_u32_b32 v132, s68, v132
    v_mbcnt_hi_u32_b32 v132, s69, v132
    v_mbcnt_lo_u32_b32 v132, s70, v132
    v_mbcnt_hi_u32_b32 v132, s71, v132
    v_mbcnt_lo_u32_b32 v132, s72, v132
    v_mbcnt_hi_u32_b32 v132, s73, v132
    v_mbcnt_lo_u32_b32 v132, s74, v132
    v_mbcnt_hi_u32_b32 v132, s75, v132
    v_mbcnt_lo_u32_b32 v132, s76, v132
    v_mbcnt_hi_u32_b32 v132, s77, v132
    v_mbcnt_lo_u32_b32 v132, s78, v132
    v_mbcnt_hi_u32_b32 v132, s79, v132
    v_mbcnt_lo_u32_b32 v132, s80, v132
    v_mbcnt_hi_u32_b32 v132, s81, v132
    v_mbcnt_lo_u32_b32 v132, s82, v132
    v_mbcnt_hi_u32_b32 v132, s83, v132
    s_add_u32 s34, s64, 16
    v_readlane_b32 s66, v132, 25
    v_readlane_b32 s67, v132, 63
    s_add_u32 s64, s66, 15
    s_and_b32 s64, s64, -16
    s_max_u32 s64, s64, s34
    s_sub_u32 s66, s64, s66
    v_mad_u32_u24 v132, v145, s66, v132
    s_lshr_b32 s35, s64, 4
    s_bitset1_b64 s[56:57], s35
    v_addc_co_u32 v133, vcc, 0, v132, s[68:69]
    v_addc_co_u32 v134, vcc, 0, v133, s[70:71]
    v_addc_co_u32 v135, vcc, 0, v134, s[72:73]
    v_addc_co_u32 v136, vcc, 0, v135, s[74:75]
    v_addc_co_u32 v137, vcc, 0, v136, s[76:77]
    v_addc_co_u32 v138, vcc, 0, v137, s[78:79]
    v_addc_co_u32 v139, vcc, 0, v138, s[80:81]
    v_addc_co_u32 v140, vcc, 0, v139, s[82:83]
    s_add_u32 s67, s67, s66
    s_add_u32 s67, s67, 15
    s_and_b32 s67, s67, -16
    s_add_u32 s64, s64, 16
    s_max_u32 s64, s64, s67
    s_mov_b64 exec, s[68:69]
    ds_write_b8 v132, v141
    s_mov_b64 exec, s[70:71]
    ds_write_b8_d16_hi v133, v141
    s_mov_b64 exec, s[72:73]
    ds_write_b8 v134, v142
    s_mov_b64 exec, s[74:75]
    ds_write_b8_d16_hi v135, v142
    s_mov_b64 exec, s[76:77]
    ds_write_b8 v136, v143
    s_mov_b64 exec, s[78:79]
    ds_write_b8_d16_hi v137, v143
    s_mov_b64 exec, s[80:81]
    ds_write_b8 v138, v144
    s_mov_b64 exec, s[82:83]
    ds_write_b8_d16_hi v139, v144
    s_mov_b64 exec, -1
    v_sub_u32 v140, v132, v140
    s_movk_i32 s66, 0x3f80
    v_mad_i32_i24 v147, v140, s66, v147
    s_lshr_b32 s35, s64, 4
    s_bitset1_b64 s[56:57], s35
    s_add_u32 s66, s52, 18496
    s_cmp_ge_u32 s64, s66
    s_cselect_b32 s94, 1, 0
    s_cbranch_scc1 L_early
    s_waitcnt vmcnt(0)
L_early:
    ds_read_u8 v148, v237 offset:0
    ds_read_u8 v149, v237 offset:8
    ds_read_u8 v150, v237 offset:16
    ds_read_u8 v151, v237 offset:24
    ds_read_u8 v152, v237 offset:32
    ds_read_u8 v153, v237 offset:40
    ds_read_u8 v154, v237 offset:48
    ds_read_u8 v155, v237 offset:56
    s_waitcnt lgkmcnt(0)
    s_cmp_eq_u32 s94, 0
    s_cbranch_scc1 L_skip0
    s_add_u32 m0, s52, 0
    v_mov_b32 v230, v148
    v_mov_b32 v232, v149
    buffer_load_dwordx4 v[230:231], s[20:23], 0 idxen offen nt lds
    s_add_u32 m0, s52, 1056
    s_nop 0
    buffer_load_dwordx4 v[232:233], s[20:23], 0 idxen offen nt lds
    s_bitcmp0_b64 s[56:57], 1
    s_cbranch_scc1 L_noadve1
    s_sub_u32 s60, s60, 1
    s_cselect_b32 s31, 0, s31
    s_add_u32 s20, s20, s31
    s_addc_u32 s21, s21, 0
    s_xor_b32 s31, s31, 0x63ff800
L_noadve1:
    s_add_u32 m0, s52, 2080
    v_mov_b32 v230, v150
    v_mov_b32 v232, v151
    buffer_load_dwordx4 v[230:231], s[20:23], 0 idxen offen nt lds
    s_add_u32 m0, s52, 3136
    s_nop 0
    buffer_load_dwordx4 v[232:233], s[20:23], 0 idxen offen nt lds
L_skip0:
    s_waitcnt vmcnt(8) lgkmcnt(0)
    s_barrier
    ds_read_b64_tr_b16 v[16:17], v66 offset:0
    ds_read_b64_tr_b16 v[18:19], v66 offset:512
    ds_read_b64_tr_b16 v[20:21], v66 offset:20480
    ds_read_b64_tr_b16 v[22:23], v66 offset:20992
    ds_read_b64_tr_b16 v[24:25], v66 offset:40960
    ds_read_b64_tr_b16 v[26:27], v66 offset:41472
    ds_read_b64_tr_b16 v[28:29], v66 offset:61440
    ds_read_b64_tr_b16 v[30:31], v66 offset:61952
    ds_read_b128 v[32:35], v67 offset:8320
    ds_read_b128 v[36:39], v67 offset:8384
    ds_read_b128 v[40:43], v67 offset:49280
    ds_read_b128 v[44:47], v67 offset:49344
    ds_read_b64_tr_b16 v[4:5], v64 offset:0
    ds_read_b64_tr_b16 v[8:9], v65 offset:0
    ds_read_b64_tr_b16 v[12:13], v65 offset:40960
    ds_read_b64_tr_b16 v[6:7], v64 offset:512
    ds_read_b64_tr_b16 v[10:11], v65 offset:512
    ds_read_b64_tr_b16 v[14:15], v65 offset:41472
    v_lshlrev_b32 v48, 16, v96
    v_and_b32 v49, 0xffff0000, v96
    v_lshlrev_b32 v50, 16, v97
    v_and_b32 v51, 0xffff0000, v97
    s_waitcnt lgkmcnt(0)
    v_xor_b32 v24, 0x80008000, v24
    v_xor_b32 v25, 0x80008000, v25
    v_xor_b32 v26, 0x80008000, v26
    v_xor_b32 v27, 0x80008000, v27
    v_xor_b32 v28, 0x80008000, v28
    v_xor_b32 v29, 0x80008000, v29
    v_xor_b32 v30, 0x80008000, v30
    v_xor_b32 v31, 0x80008000, v31
    v_mfma_f32_4x4x4_16b_bf16 v[56:59], v[218:219], v[4:5], 0
    v_mfma_f32_4x4x4_16b_bf16 v[68:71], v[218:219], v[12:13], 0
    v_mfma_f32_4x4x4_16b_bf16 v[60:63], v[218:219], v[6:7], 0
    v_mfma_f32_4x4x4_16b_bf16 v[72:75], v[218:219], v[14:15], 0
    v_mfma_f32_4x4x4_16b_bf16 v[56:59], v[218:219], v[8:9], v[56:59]
    v_mfma_f32_4x4x4_16b_bf16 v[60:63], v[218:219], v[10:11], v[60:63]
    v_mfma_f32_16x16x32_bf16 v[52:55], v[16:19], v[40:43], v[48:51]
    v_mfma_f32_16x16x32_bf16 v[52:55], v[20:23], v[44:47], v[52:55]
    v_mfma_f32_16x16x32_bf16 v[52:55], v[24:27], v[40:43], v[52:55]
    v_mfma_f32_16x16x32_bf16 v[52:55], v[28:31], v[44:47], v[52:55]
    v_mfma_f32_16x16x32_bf16 v[48:51], v[16:19], v[32:35], v[48:51]
    v_mfma_f32_16x16x32_bf16 v[48:51], v[20:23], v[36:39], v[48:51]
    v_mfma_f32_16x16x32_bf16 v[48:51], v[24:27], v[32:35], v[48:51]
    v_mfma_f32_16x16x32_bf16 v[48:51], v[28:31], v[36:39], v[48:51]
    v_mul_f32 v56, s92, v56
    v_mul_f32 v57, s92, v57
    v_mul_f32 v58, s92, v58
    v_mul_f32 v59, s92, v59
    v_mul_f32 v60, s92, v60
    v_mul_f32 v61, s92, v61
    v_mul_f32 v62, s92, v62
    v_mul_f32 v63, s92, v63
    v_mul_f32 v68, s92, v68
    v_mul_f32 v69, s92, v69
    v_mul_f32 v70, s92, v70
    v_mul_f32 v71, s92, v71
    v_mul_f32 v72, s92, v72
    v_mul_f32 v73, s92, v73
    v_mul_f32 v74, s92, v74
    v_mul_f32 v75, s92, v75
    s_add_u32 s66, s52, 11520
    v_add_u32 v3, s66, v2
    v_cvt_pk_bf16_f32 v68, v68, v69
    v_cvt_pk_bf16_f32 v69, v70, v71
    v_cvt_pk_bf16_f32 v70, v72, v73
    v_cvt_pk_bf16_f32 v71, v74, v75
    v_mul_f32 v48, s92, v48
    v_mul_f32 v49, s92, v49
    v_mul_f32 v50, s92, v50
    v_mul_f32 v51, s92, v51
    v_mul_f32 v52, s92, v52
    v_mul_f32 v53, s92, v53
    v_mul_f32 v54, s92, v54
    v_mul_f32 v55, s92, v55
    ds_write_b128 v3, v[56:59]
    ds_write_b128 v3, v[60:63] offset:1024
    ds_write_b128 v3, v[68:71] offset:2048
    ds_write_b128 v98, v[48:51]
    ds_write_b128 v98, v[52:55] offset:40960
    v_add_u32 v3, 11520, v2
    v_add_u32 v246, 81920, v3
    s_waitcnt lgkmcnt(0)
    s_barrier
    s_cmp_eq_u32 s94, 0
    s_cbranch_scc1 L_skip2
    s_bitcmp0_b64 s[56:57], 2
    s_cbranch_scc1 L_noadve2
    s_sub_u32 s60, s60, 1
    s_cselect_b32 s31, 0, s31
    s_add_u32 s20, s20, s31
    s_addc_u32 s21, s21, 0
    s_xor_b32 s31, s31, 0x63ff800
L_noadve2:
    s_add_u32 m0, s52, 4160
    v_mov_b32 v230, v152
    v_mov_b32 v232, v153
    buffer_load_dwordx4 v[230:231], s[20:23], 0 idxen offen nt lds
    s_add_u32 m0, s52, 5216
    s_nop 0
    buffer_load_dwordx4 v[232:233], s[20:23], 0 idxen offen nt lds
    s_bitcmp0_b64 s[56:57], 3
    s_cbranch_scc1 L_noadve3
    s_sub_u32 s60, s60, 1
    s_cselect_b32 s31, 0, s31
    s_add_u32 s20, s20, s31
    s_addc_u32 s21, s21, 0
    s_xor_b32 s31, s31, 0x63ff800
L_noadve3:
    s_add_u32 m0, s52, 6240
    v_mov_b32 v230, v154
    v_mov_b32 v232, v155
    buffer_load_dwordx4 v[230:231], s[20:23], 0 idxen offen nt lds
    s_add_u32 m0, s52, 7296
    s_nop 0
    buffer_load_dwordx4 v[232:233], s[20:23], 0 idxen offen nt lds
L_skip2:
    ds_read_b128 v[4:7], v3 offset:0
    ds_read_b128 v[8:11], v3 offset:1024
    ds_read_b128 v[68:71], v3 offset:2048
    ds_read_b128 v[12:15], v3 offset:20480
    ds_read_b128 v[16:19], v3 offset:21504
    ds_read_b128 v[72:75], v3 offset:22528
    s_lshl_b32 s30, s30, 16
    v_and_b32 v204, s30, v220
    v_and_b32 v205, s30, v220
    v_and_b32 v206, s30, v220
    v_and_b32 v207, s30, v220
    v_and_b32 v247, 8, v0
    v_lshlrev_b32 v247, 2, v247
    v_lshl_add_u32 v247, v251, 7, v247
    v_add_u32 v247, s52, v247
    v_and_b32 v248, 2, v0
    v_lshlrev_b32 v248, 1, v248
    v_xor_b32 v248, v248, v1
    v_lshl_add_u32 v234, v248, 4, v247
    v_xor_b32 v248, 4, v248
    v_lshl_add_u32 v235, v248, 4, v247
    v_and_b32 v247, 8, v0
    v_lshlrev_b32 v247, 3, v247
    v_lshl_add_u32 v248, v1, 5, v253
    v_xor_b32 v248, v248, v247
    v_add_u32 v236, s52, v248
    s_add_u32 s66, s52, 8320
    v_lshl_add_u32 v238, v250, 1, s66
    v_lshl_add_u32 v238, v1, 4, v238
    v_lshl_add_u32 v240, v0, 1, s66
    s_add_u32 s66, s52, 9344
    v_lshl_add_u32 v239, v1, 4, s66
    v_mov_b32 v188, 0
    v_mov_b32 v189, 0
    v_mov_b32 v190, 0
    v_mov_b32 v191, 0
    v_mov_b32 v192, 0
    v_mov_b32 v193, 0
    v_mov_b32 v194, 0
    v_mov_b32 v195, 0
    v_mov_b32 v208, 0
    v_mov_b32 v212, 0
    v_mov_b32 v209, 0
    v_mov_b32 v213, 0
    v_mov_b32 v210, 0
    v_mov_b32 v214, 0
    v_mov_b32 v211, 0
    v_mov_b32 v215, 0
    s_waitcnt vmcnt(8)
    s_mov_b64 exec, s[28:29]
    v_cmp_neq_f16_sdwa s[68:69], v104, 0 src0_sel:WORD_0 src1_sel:WORD_0
    v_cmp_neq_f16_sdwa s[70:71], v104, 0 src0_sel:WORD_1 src1_sel:WORD_0
    v_cmp_neq_f16_sdwa s[72:73], v105, 0 src0_sel:WORD_0 src1_sel:WORD_0
    v_cmp_neq_f16_sdwa s[74:75], v105, 0 src0_sel:WORD_1 src1_sel:WORD_0
    v_cmp_neq_f16_sdwa s[76:77], v106, 0 src0_sel:WORD_0 src1_sel:WORD_0
    v_cmp_neq_f16_sdwa s[78:79], v106, 0 src0_sel:WORD_1 src1_sel:WORD_0
    v_cmp_neq_f16_sdwa s[80:81], v107, 0 src0_sel:WORD_0 src1_sel:WORD_0
    v_cmp_neq_f16_sdwa s[82:83], v107, 0 src0_sel:WORD_1 src1_sel:WORD_0
    v_sad_u16 v147, v104, 0, v147
    v_sad_u16 v147, v105, 0, v147
    v_sad_u16 v147, v106, 0, v147
    v_sad_u16 v147, v107, 0, v147
    v_or3_b32 v146, v104, v105, v146
    v_or3_b32 v146, v106, v107, v146
    s_mov_b64 exec, -1
    v_mov_b32 v132, s64
    v_mbcnt_lo_u32_b32 v132, s68, v132
    v_mbcnt_hi_u32_b32 v132, s69, v132
    v_mbcnt_lo_u32_b32 v132, s70, v132
    v_mbcnt_hi_u32_b32 v132, s71, v132
    v_mbcnt_lo_u32_b32 v132, s72, v132
    v_mbcnt_hi_u32_b32 v132, s73, v132
    v_mbcnt_lo_u32_b32 v132, s74, v132
    v_mbcnt_hi_u32_b32 v132, s75, v132
    v_mbcnt_lo_u32_b32 v132, s76, v132
    v_mbcnt_hi_u32_b32 v132, s77, v132
    v_mbcnt_lo_u32_b32 v132, s78, v132
    v_mbcnt_hi_u32_b32 v132, s79, v132
    v_mbcnt_lo_u32_b32 v132, s80, v132
    v_mbcnt_hi_u32_b32 v132, s81, v132
    v_mbcnt_lo_u32_b32 v132, s82, v132
    v_mbcnt_hi_u32_b32 v132, s83, v132
    s_add_u32 s34, s64, 16
    v_readlane_b32 s66, v132, 25
    v_readlane_b32 s67, v132, 63
    s_add_u32 s64, s66, 15
    s_and_b32 s64, s64, -16
    s_max_u32 s64, s64, s34
    s_sub_u32 s66, s64, s66
    v_mad_u32_u24 v132, v145, s66, v132
    s_lshr_b32 s35, s64, 4
    s_bitset1_b64 s[56:57], s35
    v_addc_co_u32 v133, vcc, 0, v132, s[68:69]
    v_addc_co_u32 v134, vcc, 0, v133, s[70:71]
    v_addc_co_u32 v135, vcc, 0, v134, s[72:73]
    v_addc_co_u32 v136, vcc, 0, v135, s[74:75]
    v_addc_co_u32 v137, vcc, 0, v136, s[76:77]
    v_addc_co_u32 v138, vcc, 0, v137, s[78:79]
    v_addc_co_u32 v139, vcc, 0, v138, s[80:81]
    v_addc_co_u32 v140, vcc, 0, v139, s[82:83]
    s_add_u32 s67, s67, s66
    s_add_u32 s67, s67, 15
    s_and_b32 s67, s67, -16
    s_add_u32 s64, s64, 16
    s_max_u32 s64, s64, s67
    s_mov_b64 exec, s[68:69]
    ds_write_b8 v132, v141
    s_mov_b64 exec, s[70:71]
    ds_write_b8_d16_hi v133, v141
    s_mov_b64 exec, s[72:73]
    ds_write_b8 v134, v142
    s_mov_b64 exec, s[74:75]
    ds_write_b8_d16_hi v135, v142
    s_mov_b64 exec, s[76:77]
    ds_write_b8 v136, v143
    s_mov_b64 exec, s[78:79]
    ds_write_b8_d16_hi v137, v143
    s_mov_b64 exec, s[80:81]
    ds_write_b8 v138, v144
    s_mov_b64 exec, s[82:83]
    ds_write_b8_d16_hi v139, v144
    s_mov_b64 exec, -1
    v_sub_u32 v140, v132, v140
    s_movk_i32 s66, 0x3f80
    v_mad_i32_i24 v147, v140, s66, v147
    s_lshr_b32 s35, s64, 4
    s_bitset1_b64 s[56:57], s35
    ds_read_b128 v[20:23], v3 offset:40960
    ds_read_b128 v[24:27], v3 offset:41984
    ds_read_b128 v[76:79], v3 offset:43008
    ds_read_b128 v[28:31], v3 offset:61440
    ds_read_b128 v[32:35], v3 offset:62464
    ds_read_b128 v[80:83], v3 offset:63488
    ds_read_b128 v[36:39], v246 offset:0
    ds_read_b128 v[40:43], v246 offset:1024
    ds_read_b128 v[84:87], v246 offset:2048
    s_mov_b64 exec, s[28:29]
    v_cmp_neq_f16_sdwa s[68:69], v108, 0 src0_sel:WORD_0 src1_sel:WORD_0
    v_cmp_neq_f16_sdwa s[70:71], v108, 0 src0_sel:WORD_1 src1_sel:WORD_0
    v_cmp_neq_f16_sdwa s[72:73], v109, 0 src0_sel:WORD_0 src1_sel:WORD_0
    v_cmp_neq_f16_sdwa s[74:75], v109, 0 src0_sel:WORD_1 src1_sel:WORD_0
    v_cmp_neq_f16_sdwa s[76:77], v110, 0 src0_sel:WORD_0 src1_sel:WORD_0
    v_cmp_neq_f16_sdwa s[78:79], v110, 0 src0_sel:WORD_1 src1_sel:WORD_0
    v_cmp_neq_f16_sdwa s[80:81], v111, 0 src0_sel:WORD_0 src1_sel:WORD_0
    v_cmp_neq_f16_sdwa s[82:83], v111, 0 src0_sel:WORD_1 src1_sel:WORD_0
    v_sad_u16 v147, v108, 0, v147
    v_sad_u16 v147, v109, 0, v147
    v_sad_u16 v147, v110, 0, v147
    v_sad_u16 v147, v111, 0, v147
    v_or3_b32 v146, v108, v109, v146
    v_or3_b32 v146, v110, v111, v146
    s_mov_b64 exec, -1
    v_mov_b32 v132, s64
    v_mbcnt_lo_u32_b32 v132, s68, v132
    v_mbcnt_hi_u32_b32 v132, s69, v132
    v_mbcnt_lo_u32_b32 v132, s70, v132
    v_mbcnt_hi_u32_b32 v132, s71, v132
    v_mbcnt_lo_u32_b32 v132, s72, v132
    v_mbcnt_hi_u32_b32 v132, s73, v132
    v_mbcnt_lo_u32_b32 v132, s74, v132
    v_mbcnt_hi_u32_b32 v132, s75, v132
    v_mbcnt_lo_u32_b32 v132, s76, v132
    v_mbcnt_hi_u32_b32 v132, s77, v132
    v_mbcnt_lo_u32_b32 v132, s78, v132
    v_mbcnt_hi_u32_b32 v132, s79, v132
    v_mbcnt_lo_u32_b32 v132, s80, v132
    v_mbcnt_hi_u32_b32 v132, s81, v132
    v_mbcnt_lo_u32_b32 v132, s82, v132
    v_mbcnt_hi_u32_b32 v132, s83, v132
    s_add_u32 s34, s64, 16
    v_readlane_b32 s66, v132, 25
    v_readlane_b32 s67, v132, 63
    s_add_u32 s64, s66, 15
    s_and_b32 s64, s64, -16
    s_max_u32 s64, s64, s34
    s_sub_u32 s66, s64, s66
    v_mad_u32_u24 v132, v145, s66, v132
    s_lshr_b32 s35, s64, 4
    s_lshl_b64 s[86:87], 1, s35
    s_bitcmp1_b32 s64, 10
    s_cselect_b64 s[88:89], 0, s[86:87]
    s_cselect_b64 s[90:91], s[86:87], 0
    s_or_b64 s[56:57], s[56:57], s[88:89]
    s_or_b64 s[58:59], s[58:59], s[90:91]
    v_addc_co_u32 v133, vcc, 0, v132, s[68:69]
    v_addc_co_u32 v134, vcc, 0, v133, s[70:71]
    v_addc_co_u32 v135, vcc, 0, v134, s[72:73]
    v_addc_co_u32 v136, vcc, 0, v135, s[74:75]
    v_addc_co_u32 v137, vcc, 0, v136, s[76:77]
    v_addc_co_u32 v138, vcc, 0, v137, s[78:79]
    v_addc_co_u32 v139, vcc, 0, v138, s[80:81]
    v_addc_co_u32 v140, vcc, 0, v139, s[82:83]
    s_add_u32 s67, s67, s66
    s_add_u32 s67, s67, 15
    s_and_b32 s67, s67, -16
    s_add_u32 s64, s64, 16
    s_max_u32 s64, s64, s67
    s_mov_b64 exec, s[68:69]
    ds_write_b8 v132, v141
    s_mov_b64 exec, s[70:71]
    ds_write_b8_d16_hi v133, v141
    s_mov_b64 exec, s[72:73]
    ds_write_b8 v134, v142
    s_mov_b64 exec, s[74:75]
    ds_write_b8_d16_hi v135, v142
    s_mov_b64 exec, s[76:77]
    ds_write_b8 v136, v143
    s_mov_b64 exec, s[78:79]
    ds_write_b8_d16_hi v137, v143
    s_mov_b64 exec, s[80:81]
    ds_write_b8 v138, v144
    s_mov_b64 exec, s[82:83]
    ds_write_b8_d16_hi v139, v144
    s_mov_b64 exec, -1
    v_sub_u32 v140, v132, v140
    s_movk_i32 s66, 0x3f80
    v_mad_i32_i24 v147, v140, s66, v147
    s_lshr_b32 s35, s64, 4
    s_lshl_b64 s[86:87], 1, s35
    s_bitcmp1_b32 s64, 10
    s_cselect_b64 s[88:89], 0, s[86:87]
    s_cselect_b64 s[90:91], s[86:87], 0
    s_or_b64 s[56:57], s[56:57], s[88:89]
    s_or_b64 s[58:59], s[58:59], s[90:91]
    ds_read_b128 v[44:47], v246 offset:20480
    ds_read_b128 v[48:51], v246 offset:21504
    ds_read_b128 v[88:91], v246 offset:22528
    ds_read_b128 v[52:55], v246 offset:40960
    ds_read_b128 v[56:59], v246 offset:41984
    ds_read_b128 v[92:95], v246 offset:43008
    ds_read_b128 v[60:63], v246 offset:61440
    ds_read_b128 v[64:67], v246 offset:62464
    ds_read_b128 v[96:99], v246 offset:63488
    ds_read_u16 v224, v238 offset:0
    ds_read_u16 v225, v238 offset:8
    ds_read_u16 v226, v238 offset:64
    ds_read_u16 v227, v238 offset:72
    s_mov_b64 exec, s[28:29]
    v_cmp_neq_f16_sdwa s[68:69], v112, 0 src0_sel:WORD_0 src1_sel:WORD_0
    v_cmp_neq_f16_sdwa s[70:71], v112, 0 src0_sel:WORD_1 src1_sel:WORD_0
    v_cmp_neq_f16_sdwa s[72:73], v113, 0 src0_sel:WORD_0 src1_sel:WORD_0
    v_cmp_neq_f16_sdwa s[74:75], v113, 0 src0_sel:WORD_1 src1_sel:WORD_0
    v_cmp_neq_f16_sdwa s[76:77], v114, 0 src0_sel:WORD_0 src1_sel:WORD_0
    v_cmp_neq_f16_sdwa s[78:79], v114, 0 src0_sel:WORD_1 src1_sel:WORD_0
    v_cmp_neq_f16_sdwa s[80:81], v115, 0 src0_sel:WORD_0 src1_sel:WORD_0
    v_cmp_neq_f16_sdwa s[82:83], v115, 0 src0_sel:WORD_1 src1_sel:WORD_0
    v_sad_u16 v147, v112, 0, v147
    v_sad_u16 v147, v113, 0, v147
    v_sad_u16 v147, v114, 0, v147
    v_sad_u16 v147, v115, 0, v147
    v_or3_b32 v146, v112, v113, v146
    v_or3_b32 v146, v114, v115, v146
    s_mov_b64 exec, -1
    v_mov_b32 v132, s64
    v_mbcnt_lo_u32_b32 v132, s68, v132
    v_mbcnt_hi_u32_b32 v132, s69, v132
    v_mbcnt_lo_u32_b32 v132, s70, v132
    v_mbcnt_hi_u32_b32 v132, s71, v132
    v_mbcnt_lo_u32_b32 v132, s72, v132
    v_mbcnt_hi_u32_b32 v132, s73, v132
    v_mbcnt_lo_u32_b32 v132, s74, v132
    v_mbcnt_hi_u32_b32 v132, s75, v132
    v_mbcnt_lo_u32_b32 v132, s76, v132
    v_mbcnt_hi_u32_b32 v132, s77, v132
    v_mbcnt_lo_u32_b32 v132, s78, v132
    v_mbcnt_hi_u32_b32 v132, s79, v132
    v_mbcnt_lo_u32_b32 v132, s80, v132
    v_mbcnt_hi_u32_b32 v132, s81, v132
    v_mbcnt_lo_u32_b32 v132, s82, v132
    v_mbcnt_hi_u32_b32 v132, s83, v132
    s_add_u32 s34, s64, 16
    v_readlane_b32 s66, v132, 25
    v_readlane_b32 s67, v132, 63
    s_add_u32 s64, s66, 15
    s_and_b32 s64, s64, -16
    s_max_u32 s64, s64, s34
    s_sub_u32 s66, s64, s66
    v_mad_u32_u24 v132, v145, s66, v132
    s_lshr_b32 s35, s64, 4
    s_lshl_b64 s[86:87], 1, s35
    s_bitcmp1_b32 s64, 10
    s_cselect_b64 s[88:89], 0, s[86:87]
    s_cselect_b64 s[90:91], s[86:87], 0
    s_or_b64 s[56:57], s[56:57], s[88:89]
    s_or_b64 s[58:59], s[58:59], s[90:91]
    v_addc_co_u32 v133, vcc, 0, v132, s[68:69]
    v_addc_co_u32 v134, vcc, 0, v133, s[70:71]
    v_addc_co_u32 v135, vcc, 0, v134, s[72:73]
    v_addc_co_u32 v136, vcc, 0, v135, s[74:75]
    v_addc_co_u32 v137, vcc, 0, v136, s[76:77]
    v_addc_co_u32 v138, vcc, 0, v137, s[78:79]
    v_addc_co_u32 v139, vcc, 0, v138, s[80:81]
    v_addc_co_u32 v140, vcc, 0, v139, s[82:83]
    s_add_u32 s67, s67, s66
    s_add_u32 s67, s67, 15
    s_and_b32 s67, s67, -16
    s_add_u32 s64, s64, 16
    s_max_u32 s64, s64, s67
    s_mov_b64 exec, s[68:69]
    ds_write_b8 v132, v141
    s_mov_b64 exec, s[70:71]
    ds_write_b8_d16_hi v133, v141
    s_mov_b64 exec, s[72:73]
    ds_write_b8 v134, v142
    s_mov_b64 exec, s[74:75]
    ds_write_b8_d16_hi v135, v142
    s_mov_b64 exec, s[76:77]
    ds_write_b8 v136, v143
    s_mov_b64 exec, s[78:79]
    ds_write_b8_d16_hi v137, v143
    s_mov_b64 exec, s[80:81]
    ds_write_b8 v138, v144
    s_mov_b64 exec, s[82:83]
    ds_write_b8_d16_hi v139, v144
    s_mov_b64 exec, -1
    v_sub_u32 v140, v132, v140
    s_movk_i32 s66, 0x3f80
    v_mad_i32_i24 v147, v140, s66, v147
    s_lshr_b32 s35, s64, 4
    s_lshl_b64 s[86:87], 1, s35
    s_bitcmp1_b32 s64, 10
    s_cselect_b64 s[88:89], 0, s[86:87]
    s_cselect_b64 s[90:91], s[86:87], 0
    s_or_b64 s[56:57], s[56:57], s[88:89]
    s_or_b64 s[58:59], s[58:59], s[90:91]
    s_mov_b32 s66, 0xc07fc07f
    v_and_or_b32 v146, v146, s66, v147
    v_cmp_ne_u32 s[84:85], 0, v146
    s_sub_u32 s66, s64, s52
    s_sub_u32 s66, s66, 18432
    s_lshr_b32 s66, s66, 3
    s_xor_b32 s66, s66, s33
    s_sub_u32 s66, s66, s33
    s_xor_b32 s67, 0xfffffffc, s33
    s_sub_u32 s67, s67, s33
    v_mov_b32 v2, v221
    v_mov_b32 v1, s66
    v_mov_b32 v3, s67
    s_mov_b64 exec, 1
    ds_add_u32 v2, v1
    s_mov_b64 exec, -1
    s_cmp_eq_u32 s94, 1
    s_cbranch_scc1 L_nolate
    ds_read_u8 v148, v237 offset:0
    ds_read_u8 v149, v237 offset:8
    ds_read_u8 v150, v237 offset:16
    ds_read_u8 v151, v237 offset:24
    ds_read_u8 v152, v237 offset:32
    ds_read_u8 v153, v237 offset:40
    ds_read_u8 v154, v237 offset:48
    ds_read_u8 v155, v237 offset:56
    s_waitcnt lgkmcnt(0)
    s_add_u32 m0, s52, 0
    v_mov_b32 v230, v148
    v_mov_b32 v232, v149
    buffer_load_dwordx4 v[230:231], s[20:23], 0 idxen offen nt lds
    s_add_u32 m0, s52, 1056
    s_nop 0
    buffer_load_dwordx4 v[232:233], s[20:23], 0 idxen offen nt lds
    s_bitcmp0_b64 s[56:57], 1
    s_cbranch_scc1 L_noadvl1
    s_sub_u32 s60, s60, 1
    s_cselect_b32 s31, 0, s31
    s_add_u32 s20, s20, s31
    s_addc_u32 s21, s21, 0
    s_xor_b32 s31, s31, 0x63ff800
L_noadvl1:
    s_add_u32 m0, s52, 2080
    v_mov_b32 v230, v150
    v_mov_b32 v232, v151
    buffer_load_dwordx4 v[230:231], s[20:23], 0 idxen offen nt lds
    s_add_u32 m0, s52, 3136
    s_nop 0
    buffer_load_dwordx4 v[232:233], s[20:23], 0 idxen offen nt lds
    s_bitcmp0_b64 s[56:57], 2
    s_cbranch_scc1 L_noadvl2
    s_sub_u32 s60, s60, 1
    s_cselect_b32 s31, 0, s31
    s_add_u32 s20, s20, s31
    s_addc_u32 s21, s21, 0
    s_xor_b32 s31, s31, 0x63ff800
L_noadvl2:
    s_add_u32 m0, s52, 4160
    v_mov_b32 v230, v152
    v_mov_b32 v232, v153
    buffer_load_dwordx4 v[230:231], s[20:23], 0 idxen offen nt lds
    s_add_u32 m0, s52, 5216
    s_nop 0
    buffer_load_dwordx4 v[232:233], s[20:23], 0 idxen offen nt lds
    s_bitcmp0_b64 s[56:57], 3
    s_cbranch_scc1 L_noadvl3
    s_sub_u32 s60, s60, 1
    s_cselect_b32 s31, 0, s31
    s_add_u32 s20, s20, s31
    s_addc_u32 s21, s21, 0
    s_xor_b32 s31, s31, 0x63ff800
L_noadvl3:
    s_add_u32 m0, s52, 6240
    v_mov_b32 v230, v154
    v_mov_b32 v232, v155
    buffer_load_dwordx4 v[230:231], s[20:23], 0 idxen offen nt lds
    s_add_u32 m0, s52, 7296
    s_nop 0
    buffer_load_dwordx4 v[232:233], s[20:23], 0 idxen offen nt lds
L_nolate:
    v_and_b32_dpp v196, v216, v220 quad_perm:[0,0,0,0] row_mask:0xf bank_mask:0xf
    v_and_b32_dpp v197, v217, v220 quad_perm:[0,0,0,0] row_mask:0xf bank_mask:0xf
    v_and_b32_dpp v198, v216, v220 quad_perm:[1,1,1,1] row_mask:0xf bank_mask:0xf
    v_and_b32_dpp v199, v217, v220 quad_perm:[1,1,1,1] row_mask:0xf bank_mask:0xf
    v_and_b32_dpp v200, v216, v220 quad_perm:[2,2,2,2] row_mask:0xf bank_mask:0xf
    v_and_b32_dpp v201, v217, v220 quad_perm:[2,2,2,2] row_mask:0xf bank_mask:0xf
    v_and_b32_dpp v202, v216, v220 quad_perm:[3,3,3,3] row_mask:0xf bank_mask:0xf
    v_and_b32_dpp v203, v217, v220 quad_perm:[3,3,3,3] row_mask:0xf bank_mask:0xf
    s_waitcnt vmcnt(6) lgkmcnt(0)
    ds_read_b128 v[180:183], v234 offset:0
    ds_read_b128 v[184:187], v235 offset:0
    v_mul_u32_u24 v216, v224, v241
    v_mul_u32_u24 v217, v224, v242
    v_mul_u32_u24 v218, v225, v241
    v_mul_u32_u24 v219, v225, v242
    v_mul_u32_u24 v220, v226, v241
    v_mul_u32_u24 v221, v226, v242
    v_mul_u32_u24 v222, v227, v241
    v_mul_u32_u24 v223, v227, v242
    v_add_u32 v238, 128, v238
    ds_read_b128 v[164:167], v239
    v_mfma_f32_4x4x4_16b_bf16 v[132:135], v[216:217], v[68:69], v[4:7]
    ds_read_b128 v[168:171], v239 offset:64
    ds_read_b128 v[172:175], v239 offset:128
    v_mfma_f32_4x4x4_16b_bf16 v[136:139], v[218:219], v[70:71], v[8:11]
    ds_read_b128 v[176:179], v239 offset:192
    ds_read_u16 v224, v238
    v_mfma_f32_4x4x4_16b_bf16 v[140:143], v[220:221], v[72:73], v[12:15]
    ds_read_u16 v225, v238 offset:8
    ds_read_u16 v226, v238 offset:64
    v_mfma_f32_4x4x4_16b_bf16 v[144:147], v[222:223], v[74:75], v[16:19]
    ds_read_u16 v227, v238 offset:72
    v_add_u32 v239, 272, v239
    v_mfma_f32_4x4x4_16b_bf16 v[246:249], v[216:217], v[76:77], v[20:23]
    v_cvt_pk_bf16_f32 v100, v132, v133
    v_cvt_pk_bf16_f32 v101, v134, v135
    v_mfma_f32_4x4x4_16b_bf16 v[250:253], v[218:219], v[78:79], v[24:27]
    v_cvt_pk_bf16_f32 v102, v136, v137
    v_cvt_pk_bf16_f32 v103, v138, v139
    v_mfma_f32_4x4x4_16b_bf16 v[132:135], v[220:221], v[80:81], v[28:31]
    v_cvt_pk_bf16_f32 v104, v140, v141
    v_cvt_pk_bf16_f32 v105, v142, v143
    v_mfma_f32_4x4x4_16b_bf16 v[136:139], v[222:223], v[82:83], v[32:35]
    v_cvt_pk_bf16_f32 v106, v144, v145
    v_cvt_pk_bf16_f32 v107, v146, v147
    v_mfma_f32_4x4x4_16b_bf16 v[140:143], v[216:217], v[84:85], v[36:39]
    v_cvt_pk_bf16_f32 v108, v246, v247
    v_cvt_pk_bf16_f32 v109, v248, v249
    v_mfma_f32_4x4x4_16b_bf16 v[144:147], v[218:219], v[86:87], v[40:43]
    v_cvt_pk_bf16_f32 v110, v250, v251
    v_cvt_pk_bf16_f32 v111, v252, v253
    v_mfma_f32_4x4x4_16b_bf16 v[246:249], v[220:221], v[88:89], v[44:47]
    v_cvt_pk_bf16_f32 v112, v132, v133
    v_cvt_pk_bf16_f32 v113, v134, v135
    v_mfma_f32_4x4x4_16b_bf16 v[250:253], v[222:223], v[90:91], v[48:51]
    v_cvt_pk_bf16_f32 v114, v136, v137
    v_cvt_pk_bf16_f32 v115, v138, v139
    v_mfma_f32_4x4x4_16b_bf16 v[132:135], v[216:217], v[92:93], v[52:55]
    v_cvt_pk_bf16_f32 v116, v140, v141
    v_cvt_pk_bf16_f32 v117, v142, v143
    v_mfma_f32_4x4x4_16b_bf16 v[136:139], v[218:219], v[94:95], v[56:59]
    v_cvt_pk_bf16_f32 v118, v144, v145
    v_cvt_pk_bf16_f32 v119, v146, v147
    v_mfma_f32_4x4x4_16b_bf16 v[140:143], v[220:221], v[96:97], v[60:63]
    v_cvt_pk_bf16_f32 v120, v246, v247
    v_cvt_pk_bf16_f32 v121, v248, v249
    v_mfma_f32_4x4x4_16b_bf16 v[144:147], v[222:223], v[98:99], v[64:67]
    v_cvt_pk_bf16_f32 v122, v250, v251
    v_cvt_pk_bf16_f32 v123, v252, v253
    v_cvt_pk_bf16_f32 v124, v132, v133
    v_cvt_pk_bf16_f32 v125, v134, v135
    v_cvt_pk_bf16_f32 v126, v136, v137
    v_cvt_pk_bf16_f32 v127, v138, v139
    v_cvt_pk_bf16_f32 v128, v140, v141
    v_cvt_pk_bf16_f32 v129, v142, v143
    v_cvt_pk_bf16_f32 v130, v144, v145
    v_cvt_pk_bf16_f32 v131, v146, v147
    s_waitcnt lgkmcnt(0)
    v_mfma_f32_16x16x32_bf16 v[148:151], v[100:103], v[180:183], v[164:167]
    v_mfma_f32_16x16x32_bf16 v[148:151], v[104:107], v[184:187], v[148:151]
    v_mfma_f32_16x16x32_bf16 v[152:155], v[108:111], v[180:183], v[168:171]
    v_mfma_f32_16x16x32_bf16 v[152:155], v[112:115], v[184:187], v[152:155]
    v_mfma_f32_16x16x32_bf16 v[156:159], v[116:119], v[180:183], v[172:175]
    v_mfma_f32_16x16x32_bf16 v[156:159], v[120:123], v[184:187], v[156:159]
    v_mfma_f32_16x16x32_bf16 v[160:163], v[124:127], v[180:183], v[176:179]
    v_mfma_f32_16x16x32_bf16 v[160:163], v[128:131], v[184:187], v[160:163]
    s_waitcnt vmcnt(4)
    ds_read_b128 v[180:183], v234 offset:2080
    ds_read_b128 v[184:187], v235 offset:2080
    ds_read_u8 v230, v237 offset:64
    ds_read_u8 v232, v237 offset:72
    s_cmp_lg_u64 s[84:85], 0
    s_cbranch_scc0 Lf_mid
    s_mul_i32 s66, s53, 800
    s_add_u32 s8, s8, s66
    s_addc_u32 s9, s9, 0
    s_mov_b32 s24, s8
    s_and_b32 s25, s9, 0xffff
    s_mov_b32 s26, 400
    s_mov_b32 s27, 0x20000
    s_movk_i32 s32, 400
    s_branch Ls_mid
Lf_loop:
    ds_read_u8 v230, v237 offset:64
    ds_read_u8 v232, v237 offset:72
    v_mfma_f32_16x16x32_bf16 v[208:211], v[136:139], v[200:203], v[208:211]
Lf_mid:
    s_bitcmp1_b64 s[56:57], 1
    s_cbranch_scc1 Lf_wb0
Lf_wbd0:
    s_mov_b64 exec, 1
    ds_add_rtn_u32 v1, v2, v3
    s_mov_b64 exec, -1
    v_exp_f32 v132, v148
    v_exp_f32 v133, v149
    v_exp_f32 v134, v150
    v_exp_f32 v135, v151
    v_exp_f32 v136, v152
    v_exp_f32 v137, v153
    v_mfma_f32_4x4x4_16b_bf16 v[132:135], v[228:229], v[228:229], v[132:135]
    v_cvt_pk_bf16_f32 v208, v208, v209
    v_cvt_pk_bf16_f32 v209, v210, v211
    s_waitcnt lgkmcnt(2)
    v_mfma_f32_16x16x32_bf16 v[148:151], v[100:103], v[180:183], v[164:167]
    v_exp_f32 v138, v154
    v_mfma_f32_4x4x4_16b_bf16 v[212:215], v[208:209], v[188:189], v[212:215] cbsz:4 abid:0
    ds_read_b64_tr_b16 v[188:189], v236 offset:0
    v_exp_f32 v139, v155
    v_mfma_f32_16x16x32_bf16 v[152:155], v[108:111], v[180:183], v[168:171]
    v_exp_f32 v140, v156
    v_mfma_f32_4x4x4_16b_bf16 v[212:215], v[208:209], v[190:191], v[212:215] cbsz:4 abid:4
    ds_read_b64_tr_b16 v[190:191], v236 offset:512
    v_mfma_f32_4x4x4_16b_bf16 v[136:139], v[228:229], v[228:229], v[136:139]
    v_rcp_f32 v132, v132
    v_mfma_f32_4x4x4_16b_bf16 v[212:215], v[208:209], v[192:193], v[212:215] cbsz:4 abid:8
    ds_read_b64_tr_b16 v[192:193], v236 offset:1056
    v_exp_f32 v141, v157
    v_mfma_f32_16x16x32_bf16 v[148:151], v[104:107], v[184:187], v[148:151]
    v_rcp_f32 v133, v133
    v_mfma_f32_4x4x4_16b_bf16 v[212:215], v[208:209], v[194:195], v[212:215] cbsz:4 abid:12
    ds_read_b64_tr_b16 v[194:195], v236 offset:1568
    v_exp_f32 v142, v158
    v_mfma_f32_16x16x32_bf16 v[152:155], v[112:115], v[184:187], v[152:155]
    v_rcp_f32 v134, v134
    v_exp_f32 v143, v159
    v_rcp_f32 v135, v135
    v_cvt_pk_bf16_f32 v132, v132, v133
    v_mfma_f32_4x4x4_16b_bf16 v[140:143], v[228:229], v[228:229], v[140:143]
    v_exp_f32 v144, v160
    v_mfma_f32_16x16x32_bf16 v[156:159], v[116:119], v[180:183], v[172:175]
    v_rcp_f32 v136, v136
    v_cvt_pk_bf16_f32 v133, v134, v135
    s_bitcmp1_b64 s[56:57], 0
    s_cbranch_scc1 Lf_flush0
Lf_flushed0:
    v_exp_f32 v145, v161
    v_rcp_f32 v137, v137
    v_exp_f32 v146, v162
    s_bitcmp1_b64 s[56:57], 4
    s_cbranch_scc1 Lf_adv0
Lf_advd0:
    v_rcp_f32 v138, v138
    v_cvt_pk_bf16_f32 v134, v136, v137
    v_exp_f32 v147, v163
    v_mfma_f32_16x16x32_bf16 v[160:163], v[124:127], v[180:183], v[176:179]
    s_waitcnt lgkmcnt(0)
    s_add_u32 m0, s52, 0
    v_rcp_f32 v139, v139
    buffer_load_dwordx4 v[230:231], s[20:23], 0 idxen offen nt lds
    v_mfma_f32_4x4x4_16b_bf16 v[144:147], v[228:229], v[228:229], v[144:147]
    v_mfma_f32_16x16x32_bf16 v[156:159], v[120:123], v[184:187], v[156:159]
    s_add_u32 m0, s52, 1056
    v_rcp_f32 v140, v140
    buffer_load_dwordx4 v[232:233], s[20:23], 0 idxen offen nt lds
    v_mfma_f32_16x16x32_bf16 v[160:163], v[128:131], v[184:187], v[160:163]
    v_readfirstlane_b32 s66, v1
    s_nop 0
    s_xor_b32 s66, s66, s33
    s_cmp_gt_i32 s66, 0
    s_setprio 0
    s_cbranch_scc0 Lf_lo0
    s_setprio 1
Lf_lo0:
    v_rcp_f32 v141, v141
    v_cvt_pk_bf16_f32 v135, v138, v139
    s_waitcnt vmcnt(4)
    ds_read_b128 v[180:183], v234 offset:4160
    ds_read_b128 v[184:187], v235 offset:4160
    v_rcp_f32 v142, v142
    v_cvt_pk_bf16_f32 v136, v140, v141
    v_mfma_f32_16x16x32_bf16 v[208:211], v[132:135], v[196:199], v[204:207]
    v_rcp_f32 v143, v143
    v_rcp_f32 v144, v144
    v_cvt_pk_bf16_f32 v137, v142, v143
    v_rcp_f32 v145, v145
    v_rcp_f32 v146, v146
    v_rcp_f32 v147, v147
    v_cvt_pk_bf16_f32 v138, v144, v145
    v_cvt_pk_bf16_f32 v139, v146, v147
    ds_read_u8 v230, v237 offset:80
    ds_read_u8 v232, v237 offset:88
    v_mfma_f32_16x16x32_bf16 v[208:211], v[136:139], v[200:203], v[208:211]
    s_bitcmp1_b64 s[56:57], 2
    s_cbranch_scc1 Lf_wb1
Lf_wbd1:
    v_exp_f32 v132, v148
    v_exp_f32 v133, v149
    v_exp_f32 v134, v150
    v_exp_f32 v135, v151
    v_exp_f32 v136, v152
    v_exp_f32 v137, v153
    v_mfma_f32_4x4x4_16b_bf16 v[132:135], v[228:229], v[228:229], v[132:135]
    v_cvt_pk_bf16_f32 v208, v208, v209
    v_cvt_pk_bf16_f32 v209, v210, v211
    s_waitcnt lgkmcnt(2)
    v_mfma_f32_16x16x32_bf16 v[148:151], v[100:103], v[180:183], v[164:167]
    v_exp_f32 v138, v154
    v_mfma_f32_4x4x4_16b_bf16 v[212:215], v[208:209], v[188:189], v[212:215] cbsz:4 abid:0
    ds_read_b64_tr_b16 v[188:189], v236 offset:2080
    v_exp_f32 v139, v155
    v_mfma_f32_16x16x32_bf16 v[152:155], v[108:111], v[180:183], v[168:171]
    v_exp_f32 v140, v156
    v_mfma_f32_4x4x4_16b_bf16 v[212:215], v[208:209], v[190:191], v[212:215] cbsz:4 abid:4
    ds_read_b64_tr_b16 v[190:191], v236 offset:2592
    v_mfma_f32_4x4x4_16b_bf16 v[136:139], v[228:229], v[228:229], v[136:139]
    v_rcp_f32 v132, v132
    v_mfma_f32_4x4x4_16b_bf16 v[212:215], v[208:209], v[192:193], v[212:215] cbsz:4 abid:8
    ds_read_b64_tr_b16 v[192:193], v236 offset:3136
    v_exp_f32 v141, v157
    v_mfma_f32_16x16x32_bf16 v[148:151], v[104:107], v[184:187], v[148:151]
    v_rcp_f32 v133, v133
    v_mfma_f32_4x4x4_16b_bf16 v[212:215], v[208:209], v[194:195], v[212:215] cbsz:4 abid:12
    ds_read_b64_tr_b16 v[194:195], v236 offset:3648
    v_exp_f32 v142, v158
    v_mfma_f32_16x16x32_bf16 v[152:155], v[112:115], v[184:187], v[152:155]
    v_rcp_f32 v134, v134
    v_exp_f32 v143, v159
    v_rcp_f32 v135, v135
    v_cvt_pk_bf16_f32 v132, v132, v133
    v_mfma_f32_4x4x4_16b_bf16 v[140:143], v[228:229], v[228:229], v[140:143]
    v_exp_f32 v144, v160
    v_mfma_f32_16x16x32_bf16 v[156:159], v[116:119], v[180:183], v[172:175]
    v_rcp_f32 v136, v136
    v_cvt_pk_bf16_f32 v133, v134, v135
    s_bitcmp1_b64 s[56:57], 1
    s_cbranch_scc1 Lf_flush1
Lf_flushed1:
    v_exp_f32 v145, v161
    v_rcp_f32 v137, v137
    v_exp_f32 v146, v162
    s_bitcmp1_b64 s[56:57], 5
    s_cbranch_scc1 Lf_adv1
Lf_advd1:
    v_rcp_f32 v138, v138
    v_cvt_pk_bf16_f32 v134, v136, v137
    v_exp_f32 v147, v163
    v_mfma_f32_16x16x32_bf16 v[160:163], v[124:127], v[180:183], v[176:179]
    s_waitcnt lgkmcnt(0)
    s_add_u32 m0, s52, 2080
    v_rcp_f32 v139, v139
    buffer_load_dwordx4 v[230:231], s[20:23], 0 idxen offen nt lds
    v_mfma_f32_4x4x4_16b_bf16 v[144:147], v[228:229], v[228:229], v[144:147]
    v_mfma_f32_16x16x32_bf16 v[156:159], v[120:123], v[184:187], v[156:159]
    s_add_u32 m0, s52, 3136
    v_rcp_f32 v140, v140
    buffer_load_dwordx4 v[232:233], s[20:23], 0 idxen offen nt lds
    v_mfma_f32_16x16x32_bf16 v[160:163], v[128:131], v[184:187], v[160:163]
    v_rcp_f32 v141, v141
    v_cvt_pk_bf16_f32 v135, v138, v139
    s_waitcnt vmcnt(4)
    ds_read_b128 v[180:183], v234 offset:6240
    ds_read_b128 v[184:187], v235 offset:6240
    v_rcp_f32 v142, v142
    v_cvt_pk_bf16_f32 v136, v140, v141
    v_mfma_f32_16x16x32_bf16 v[208:211], v[132:135], v[196:199], v[204:207]
    v_rcp_f32 v143, v143
    v_rcp_f32 v144, v144
    v_cvt_pk_bf16_f32 v137, v142, v143
    v_rcp_f32 v145, v145
    v_rcp_f32 v146, v146
    v_rcp_f32 v147, v147
    v_cvt_pk_bf16_f32 v138, v144, v145
    v_cvt_pk_bf16_f32 v139, v146, v147
    ds_read_u8 v230, v237 offset:96
    ds_read_u8 v232, v237 offset:104
    v_mfma_f32_16x16x32_bf16 v[208:211], v[136:139], v[200:203], v[208:211]
    s_bitcmp1_b64 s[56:57], 3
    s_cbranch_scc1 Lf_wb2
Lf_wbd2:
    s_mov_b64 exec, 1
    ds_add_rtn_u32 v1, v2, v3
    s_mov_b64 exec, -1
    v_exp_f32 v132, v148
    v_exp_f32 v133, v149
    v_exp_f32 v134, v150
    v_exp_f32 v135, v151
    v_exp_f32 v136, v152
    v_exp_f32 v137, v153
    v_mfma_f32_4x4x4_16b_bf16 v[132:135], v[228:229], v[228:229], v[132:135]
    v_cvt_pk_bf16_f32 v208, v208, v209
    v_cvt_pk_bf16_f32 v209, v210, v211
    s_waitcnt lgkmcnt(2)
    v_mfma_f32_16x16x32_bf16 v[148:151], v[100:103], v[180:183], v[164:167]
    v_exp_f32 v138, v154
    v_mfma_f32_4x4x4_16b_bf16 v[212:215], v[208:209], v[188:189], v[212:215] cbsz:4 abid:0
    ds_read_b64_tr_b16 v[188:189], v236 offset:4160
    v_exp_f32 v139, v155
    v_mfma_f32_16x16x32_bf16 v[152:155], v[108:111], v[180:183], v[168:171]
    v_exp_f32 v140, v156
    v_mfma_f32_4x4x4_16b_bf16 v[212:215], v[208:209], v[190:191], v[212:215] cbsz:4 abid:4
    ds_read_b64_tr_b16 v[190:191], v236 offset:4672
    v_mfma_f32_4x4x4_16b_bf16 v[136:139], v[228:229], v[228:229], v[136:139]
    v_rcp_f32 v132, v132
    v_mfma_f32_4x4x4_16b_bf16 v[212:215], v[208:209], v[192:193], v[212:215] cbsz:4 abid:8
    ds_read_b64_tr_b16 v[192:193], v236 offset:5216
    v_exp_f32 v141, v157
    v_mfma_f32_16x16x32_bf16 v[148:151], v[104:107], v[184:187], v[148:151]
    v_rcp_f32 v133, v133
    v_mfma_f32_4x4x4_16b_bf16 v[212:215], v[208:209], v[194:195], v[212:215] cbsz:4 abid:12
    ds_read_b64_tr_b16 v[194:195], v236 offset:5728
    v_exp_f32 v142, v158
    v_mfma_f32_16x16x32_bf16 v[152:155], v[112:115], v[184:187], v[152:155]
    v_rcp_f32 v134, v134
    v_exp_f32 v143, v159
    v_rcp_f32 v135, v135
    v_cvt_pk_bf16_f32 v132, v132, v133
    v_mfma_f32_4x4x4_16b_bf16 v[140:143], v[228:229], v[228:229], v[140:143]
    v_exp_f32 v144, v160
    v_mfma_f32_16x16x32_bf16 v[156:159], v[116:119], v[180:183], v[172:175]
    v_rcp_f32 v136, v136
    v_cvt_pk_bf16_f32 v133, v134, v135
    s_bitcmp1_b64 s[56:57], 2
    s_cbranch_scc1 Lf_flush2
Lf_flushed2:
    v_exp_f32 v145, v161
    v_rcp_f32 v137, v137
    v_exp_f32 v146, v162
    s_bitcmp1_b64 s[56:57], 6
    s_cbranch_scc1 Lf_adv2
Lf_advd2:
    v_rcp_f32 v138, v138
    v_cvt_pk_bf16_f32 v134, v136, v137
    v_exp_f32 v147, v163
    v_mfma_f32_16x16x32_bf16 v[160:163], v[124:127], v[180:183], v[176:179]
    s_waitcnt lgkmcnt(0)
    s_add_u32 m0, s52, 4160
    v_rcp_f32 v139, v139
    buffer_load_dwordx4 v[230:231], s[20:23], 0 idxen offen nt lds
    v_mfma_f32_4x4x4_16b_bf16 v[144:147], v[228:229], v[228:229], v[144:147]
    v_mfma_f32_16x16x32_bf16 v[156:159], v[120:123], v[184:187], v[156:159]
    s_add_u32 m0, s52, 5216
    v_rcp_f32 v140, v140
    buffer_load_dwordx4 v[232:233], s[20:23], 0 idxen offen nt lds
    v_mfma_f32_16x16x32_bf16 v[160:163], v[128:131], v[184:187], v[160:163]
    v_readfirstlane_b32 s66, v1
    s_nop 0
    s_xor_b32 s66, s66, s33
    s_cmp_gt_i32 s66, 0
    s_setprio 0
    s_cbranch_scc0 Lf_lo2
    s_setprio 1
Lf_lo2:
    v_rcp_f32 v141, v141
    v_cvt_pk_bf16_f32 v135, v138, v139
    s_waitcnt vmcnt(4)
    ds_read_b128 v[180:183], v234 offset:0
    ds_read_b128 v[184:187], v235 offset:0
    v_rcp_f32 v142, v142
    v_cvt_pk_bf16_f32 v136, v140, v141
    v_mfma_f32_16x16x32_bf16 v[208:211], v[132:135], v[196:199], v[204:207]
    v_rcp_f32 v143, v143
    v_rcp_f32 v144, v144
    v_cvt_pk_bf16_f32 v137, v142, v143
    v_rcp_f32 v145, v145
    v_rcp_f32 v146, v146
    v_rcp_f32 v147, v147
    v_cvt_pk_bf16_f32 v138, v144, v145
    v_cvt_pk_bf16_f32 v139, v146, v147
    ds_read_u8 v230, v237 offset:112
    ds_read_u8 v232, v237 offset:120
    v_mfma_f32_16x16x32_bf16 v[208:211], v[136:139], v[200:203], v[208:211]
    s_bitcmp1_b64 s[56:57], 4
    s_cbranch_scc1 Lf_wb3
Lf_wbd3:
    v_exp_f32 v132, v148
    v_exp_f32 v133, v149
    v_exp_f32 v134, v150
    v_exp_f32 v135, v151
    v_exp_f32 v136, v152
    v_exp_f32 v137, v153
    v_mfma_f32_4x4x4_16b_bf16 v[132:135], v[228:229], v[228:229], v[132:135]
    v_cvt_pk_bf16_f32 v208, v208, v209
    v_cvt_pk_bf16_f32 v209, v210, v211
    s_waitcnt lgkmcnt(2)
    v_mfma_f32_16x16x32_bf16 v[148:151], v[100:103], v[180:183], v[164:167]
    v_exp_f32 v138, v154
    v_mfma_f32_4x4x4_16b_bf16 v[212:215], v[208:209], v[188:189], v[212:215] cbsz:4 abid:0
    ds_read_b64_tr_b16 v[188:189], v236 offset:6240
    v_exp_f32 v139, v155
    v_mfma_f32_16x16x32_bf16 v[152:155], v[108:111], v[180:183], v[168:171]
    v_exp_f32 v140, v156
    v_mfma_f32_4x4x4_16b_bf16 v[212:215], v[208:209], v[190:191], v[212:215] cbsz:4 abid:4
    ds_read_b64_tr_b16 v[190:191], v236 offset:6752
    v_mfma_f32_4x4x4_16b_bf16 v[136:139], v[228:229], v[228:229], v[136:139]
    v_rcp_f32 v132, v132
    v_mfma_f32_4x4x4_16b_bf16 v[212:215], v[208:209], v[192:193], v[212:215] cbsz:4 abid:8
    ds_read_b64_tr_b16 v[192:193], v236 offset:7296
    v_exp_f32 v141, v157
    v_mfma_f32_16x16x32_bf16 v[148:151], v[104:107], v[184:187], v[148:151]
    v_rcp_f32 v133, v133
    v_mfma_f32_4x4x4_16b_bf16 v[212:215], v[208:209], v[194:195], v[212:215] cbsz:4 abid:12
    ds_read_b64_tr_b16 v[194:195], v236 offset:7808
    v_exp_f32 v142, v158
    v_mfma_f32_16x16x32_bf16 v[152:155], v[112:115], v[184:187], v[152:155]
    v_rcp_f32 v134, v134
    v_exp_f32 v143, v159
    v_rcp_f32 v135, v135
    v_cvt_pk_bf16_f32 v132, v132, v133
    v_mfma_f32_4x4x4_16b_bf16 v[140:143], v[228:229], v[228:229], v[140:143]
    v_exp_f32 v144, v160
    v_mfma_f32_16x16x32_bf16 v[156:159], v[116:119], v[180:183], v[172:175]
    v_rcp_f32 v136, v136
    v_cvt_pk_bf16_f32 v133, v134, v135
    s_bitcmp1_b64 s[56:57], 3
    s_cbranch_scc1 Lf_flush3
Lf_flushed3:
    v_exp_f32 v145, v161
    v_rcp_f32 v137, v137
    v_exp_f32 v146, v162
    s_bitcmp1_b64 s[56:57], 7
    s_cbranch_scc1 Lf_adv3
Lf_advd3:
    v_rcp_f32 v138, v138
    v_cvt_pk_bf16_f32 v134, v136, v137
    v_exp_f32 v147, v163
    v_mfma_f32_16x16x32_bf16 v[160:163], v[124:127], v[180:183], v[176:179]
    s_waitcnt lgkmcnt(0)
    s_add_u32 m0, s52, 6240
    v_rcp_f32 v139, v139
    buffer_load_dwordx4 v[230:231], s[20:23], 0 idxen offen nt lds
    v_mfma_f32_4x4x4_16b_bf16 v[144:147], v[228:229], v[228:229], v[144:147]
    v_mfma_f32_16x16x32_bf16 v[156:159], v[120:123], v[184:187], v[156:159]
    s_add_u32 m0, s52, 7296
    v_rcp_f32 v140, v140
    buffer_load_dwordx4 v[232:233], s[20:23], 0 idxen offen nt lds
    v_mfma_f32_16x16x32_bf16 v[160:163], v[128:131], v[184:187], v[160:163]
    v_rcp_f32 v141, v141
    v_cvt_pk_bf16_f32 v135, v138, v139
    s_waitcnt vmcnt(4)
    ds_read_b128 v[180:183], v234 offset:2080
    ds_read_b128 v[184:187], v235 offset:2080
    v_rcp_f32 v142, v142
    v_cvt_pk_bf16_f32 v136, v140, v141
    v_mfma_f32_16x16x32_bf16 v[208:211], v[132:135], v[196:199], v[204:207]
    v_rcp_f32 v143, v143
    s_lshr_b64 s[56:57], s[56:57], 4
    s_lshl_b64 s[86:87], s[58:59], 60
    s_or_b64 s[56:57], s[56:57], s[86:87]
    s_lshr_b64 s[58:59], s[58:59], 4
    v_add_u32 v237, 64, v237
    v_rcp_f32 v144, v144
    v_cvt_pk_bf16_f32 v137, v142, v143
    v_rcp_f32 v145, v145
    v_rcp_f32 v146, v146
    v_rcp_f32 v147, v147
    v_cvt_pk_bf16_f32 v138, v144, v145
    v_cvt_pk_bf16_f32 v139, v146, v147
    s_branch Lf_loop
Lf_flush0:
    v_cvt_pk_bf16_f32 v246, v212, v212
    v_mov_b32 v212, 0
    ds_write_b16 v240, v246
    v_add_u32 v240, 128, v240
    s_branch Lf_flushed0
Lf_wb0:
    s_sub_u32 s61, s61, 1
    s_cbranch_scc1 Lf_last0
    v_mul_u32_u24 v216, v224, v241
    v_mul_u32_u24 v217, v224, v242
    v_mul_u32_u24 v218, v225, v241
    v_mul_u32_u24 v219, v225, v242
    v_mul_u32_u24 v220, v226, v241
    v_mul_u32_u24 v221, v226, v242
    v_mul_u32_u24 v222, v227, v241
    v_mul_u32_u24 v223, v227, v242
    v_add_u32 v238, 128, v238
    ds_read_b128 v[164:167], v239
    v_mfma_f32_4x4x4_16b_bf16 v[132:135], v[216:217], v[68:69], v[4:7]
    ds_read_b128 v[168:171], v239 offset:64
    ds_read_b128 v[172:175], v239 offset:128
    v_mfma_f32_4x4x4_16b_bf16 v[136:139], v[218:219], v[70:71], v[8:11]
    ds_read_b128 v[176:179], v239 offset:192
    ds_read_u16 v224, v238
    v_mfma_f32_4x4x4_16b_bf16 v[140:143], v[220:221], v[72:73], v[12:15]
    ds_read_u16 v225, v238 offset:8
    ds_read_u16 v226, v238 offset:64
    v_mfma_f32_4x4x4_16b_bf16 v[144:147], v[222:223], v[74:75], v[16:19]
    ds_read_u16 v227, v238 offset:72
    v_add_u32 v239, 272, v239
    v_mfma_f32_4x4x4_16b_bf16 v[246:249], v[216:217], v[76:77], v[20:23]
    v_cvt_pk_bf16_f32 v100, v132, v133
    v_cvt_pk_bf16_f32 v101, v134, v135
    v_mfma_f32_4x4x4_16b_bf16 v[250:253], v[218:219], v[78:79], v[24:27]
    v_cvt_pk_bf16_f32 v102, v136, v137
    v_cvt_pk_bf16_f32 v103, v138, v139
    v_mfma_f32_4x4x4_16b_bf16 v[132:135], v[220:221], v[80:81], v[28:31]
    v_cvt_pk_bf16_f32 v104, v140, v141
    v_cvt_pk_bf16_f32 v105, v142, v143
    v_mfma_f32_4x4x4_16b_bf16 v[136:139], v[222:223], v[82:83], v[32:35]
    v_cvt_pk_bf16_f32 v106, v144, v145
    v_cvt_pk_bf16_f32 v107, v146, v147
    v_mfma_f32_4x4x4_16b_bf16 v[140:143], v[216:217], v[84:85], v[36:39]
    v_cvt_pk_bf16_f32 v108, v246, v247
    v_cvt_pk_bf16_f32 v109, v248, v249
    v_mfma_f32_4x4x4_16b_bf16 v[144:147], v[218:219], v[86:87], v[40:43]
    v_cvt_pk_bf16_f32 v110, v250, v251
    v_cvt_pk_bf16_f32 v111, v252, v253
    v_mfma_f32_4x4x4_16b_bf16 v[246:249], v[220:221], v[88:89], v[44:47]
    v_cvt_pk_bf16_f32 v112, v132, v133
    v_cvt_pk_bf16_f32 v113, v134, v135
    v_mfma_f32_4x4x4_16b_bf16 v[250:253], v[222:223], v[90:91], v[48:51]
    v_cvt_pk_bf16_f32 v114, v136, v137
    v_cvt_pk_bf16_f32 v115, v138, v139
    v_mfma_f32_4x4x4_16b_bf16 v[132:135], v[216:217], v[92:93], v[52:55]
    v_cvt_pk_bf16_f32 v116, v140, v141
    v_cvt_pk_bf16_f32 v117, v142, v143
    v_mfma_f32_4x4x4_16b_bf16 v[136:139], v[218:219], v[94:95], v[56:59]
    v_cvt_pk_bf16_f32 v118, v144, v145
    v_cvt_pk_bf16_f32 v119, v146, v147
    v_mfma_f32_4x4x4_16b_bf16 v[140:143], v[220:221], v[96:97], v[60:63]
    v_cvt_pk_bf16_f32 v120, v246, v247
    v_cvt_pk_bf16_f32 v121, v248, v249
    v_mfma_f32_4x4x4_16b_bf16 v[144:147], v[222:223], v[98:99], v[64:67]
    v_cvt_pk_bf16_f32 v122, v250, v251
    v_cvt_pk_bf16_f32 v123, v252, v253
    v_cvt_pk_bf16_f32 v124, v132, v133
    v_cvt_pk_bf16_f32 v125, v134, v135
    v_cvt_pk_bf16_f32 v126, v136, v137
    v_cvt_pk_bf16_f32 v127, v138, v139
    v_cvt_pk_bf16_f32 v128, v140, v141
    v_cvt_pk_bf16_f32 v129, v142, v143
    v_cvt_pk_bf16_f32 v130, v144, v145
    v_cvt_pk_bf16_f32 v131, v146, v147
    s_waitcnt lgkmcnt(0)
    s_branch Lf_wbd0
Lf_adv0:
    s_sub_u32 s60, s60, 1
    s_cselect_b32 s31, 0, s31
    s_add_u32 s20, s20, s31
    s_addc_u32 s21, s21, 0
    s_xor_b32 s31, s31, 0x63ff800
    s_branch Lf_advd0
Lf_last0:
    s_branch Lf_tail
Lf_flush1:
    v_cvt_pk_bf16_f32 v246, v212, v212
    v_mov_b32 v212, 0
    ds_write_b16 v240, v246
    v_add_u32 v240, 128, v240
    s_branch Lf_flushed1
Lf_wb1:
    s_sub_u32 s61, s61, 1
    s_cbranch_scc1 Lf_last1
    v_mul_u32_u24 v216, v224, v241
    v_mul_u32_u24 v217, v224, v242
    v_mul_u32_u24 v218, v225, v241
    v_mul_u32_u24 v219, v225, v242
    v_mul_u32_u24 v220, v226, v241
    v_mul_u32_u24 v221, v226, v242
    v_mul_u32_u24 v222, v227, v241
    v_mul_u32_u24 v223, v227, v242
    v_add_u32 v238, 128, v238
    ds_read_b128 v[164:167], v239
    v_mfma_f32_4x4x4_16b_bf16 v[132:135], v[216:217], v[68:69], v[4:7]
    ds_read_b128 v[168:171], v239 offset:64
    ds_read_b128 v[172:175], v239 offset:128
    v_mfma_f32_4x4x4_16b_bf16 v[136:139], v[218:219], v[70:71], v[8:11]
    ds_read_b128 v[176:179], v239 offset:192
    ds_read_u16 v224, v238
    v_mfma_f32_4x4x4_16b_bf16 v[140:143], v[220:221], v[72:73], v[12:15]
    ds_read_u16 v225, v238 offset:8
    ds_read_u16 v226, v238 offset:64
    v_mfma_f32_4x4x4_16b_bf16 v[144:147], v[222:223], v[74:75], v[16:19]
    ds_read_u16 v227, v238 offset:72
    v_add_u32 v239, 272, v239
    v_mfma_f32_4x4x4_16b_bf16 v[246:249], v[216:217], v[76:77], v[20:23]
    v_cvt_pk_bf16_f32 v100, v132, v133
    v_cvt_pk_bf16_f32 v101, v134, v135
    v_mfma_f32_4x4x4_16b_bf16 v[250:253], v[218:219], v[78:79], v[24:27]
    v_cvt_pk_bf16_f32 v102, v136, v137
    v_cvt_pk_bf16_f32 v103, v138, v139
    v_mfma_f32_4x4x4_16b_bf16 v[132:135], v[220:221], v[80:81], v[28:31]
    v_cvt_pk_bf16_f32 v104, v140, v141
    v_cvt_pk_bf16_f32 v105, v142, v143
    v_mfma_f32_4x4x4_16b_bf16 v[136:139], v[222:223], v[82:83], v[32:35]
    v_cvt_pk_bf16_f32 v106, v144, v145
    v_cvt_pk_bf16_f32 v107, v146, v147
    v_mfma_f32_4x4x4_16b_bf16 v[140:143], v[216:217], v[84:85], v[36:39]
    v_cvt_pk_bf16_f32 v108, v246, v247
    v_cvt_pk_bf16_f32 v109, v248, v249
    v_mfma_f32_4x4x4_16b_bf16 v[144:147], v[218:219], v[86:87], v[40:43]
    v_cvt_pk_bf16_f32 v110, v250, v251
    v_cvt_pk_bf16_f32 v111, v252, v253
    v_mfma_f32_4x4x4_16b_bf16 v[246:249], v[220:221], v[88:89], v[44:47]
    v_cvt_pk_bf16_f32 v112, v132, v133
    v_cvt_pk_bf16_f32 v113, v134, v135
    v_mfma_f32_4x4x4_16b_bf16 v[250:253], v[222:223], v[90:91], v[48:51]
    v_cvt_pk_bf16_f32 v114, v136, v137
    v_cvt_pk_bf16_f32 v115, v138, v139
    v_mfma_f32_4x4x4_16b_bf16 v[132:135], v[216:217], v[92:93], v[52:55]
    v_cvt_pk_bf16_f32 v116, v140, v141
    v_cvt_pk_bf16_f32 v117, v142, v143
    v_mfma_f32_4x4x4_16b_bf16 v[136:139], v[218:219], v[94:95], v[56:59]
    v_cvt_pk_bf16_f32 v118, v144, v145
    v_cvt_pk_bf16_f32 v119, v146, v147
    v_mfma_f32_4x4x4_16b_bf16 v[140:143], v[220:221], v[96:97], v[60:63]
    v_cvt_pk_bf16_f32 v120, v246, v247
    v_cvt_pk_bf16_f32 v121, v248, v249
    v_mfma_f32_4x4x4_16b_bf16 v[144:147], v[222:223], v[98:99], v[64:67]
    v_cvt_pk_bf16_f32 v122, v250, v251
    v_cvt_pk_bf16_f32 v123, v252, v253
    v_cvt_pk_bf16_f32 v124, v132, v133
    v_cvt_pk_bf16_f32 v125, v134, v135
    v_cvt_pk_bf16_f32 v126, v136, v137
    v_cvt_pk_bf16_f32 v127, v138, v139
    v_cvt_pk_bf16_f32 v128, v140, v141
    v_cvt_pk_bf16_f32 v129, v142, v143
    v_cvt_pk_bf16_f32 v130, v144, v145
    v_cvt_pk_bf16_f32 v131, v146, v147
    s_waitcnt lgkmcnt(0)
    s_branch Lf_wbd1
Lf_adv1:
    s_sub_u32 s60, s60, 1
    s_cselect_b32 s31, 0, s31
    s_add_u32 s20, s20, s31
    s_addc_u32 s21, s21, 0
    s_xor_b32 s31, s31, 0x63ff800
    s_branch Lf_advd1
Lf_last1:
    v_add_u32 v236, 2080, v236
    s_lshr_b64 s[56:57], s[56:57], 1
    s_branch Lf_tail
Lf_flush2:
    v_cvt_pk_bf16_f32 v246, v212, v212
    v_mov_b32 v212, 0
    ds_write_b16 v240, v246
    v_add_u32 v240, 128, v240
    s_branch Lf_flushed2
Lf_wb2:
    s_sub_u32 s61, s61, 1
    s_cbranch_scc1 Lf_last2
    v_mul_u32_u24 v216, v224, v241
    v_mul_u32_u24 v217, v224, v242
    v_mul_u32_u24 v218, v225, v241
    v_mul_u32_u24 v219, v225, v242
    v_mul_u32_u24 v220, v226, v241
    v_mul_u32_u24 v221, v226, v242
    v_mul_u32_u24 v222, v227, v241
    v_mul_u32_u24 v223, v227, v242
    v_add_u32 v238, 128, v238
    ds_read_b128 v[164:167], v239
    v_mfma_f32_4x4x4_16b_bf16 v[132:135], v[216:217], v[68:69], v[4:7]
    ds_read_b128 v[168:171], v239 offset:64
    ds_read_b128 v[172:175], v239 offset:128
    v_mfma_f32_4x4x4_16b_bf16 v[136:139], v[218:219], v[70:71], v[8:11]
    ds_read_b128 v[176:179], v239 offset:192
    ds_read_u16 v224, v238
    v_mfma_f32_4x4x4_16b_bf16 v[140:143], v[220:221], v[72:73], v[12:15]
    ds_read_u16 v225, v238 offset:8
    ds_read_u16 v226, v238 offset:64
    v_mfma_f32_4x4x4_16b_bf16 v[144:147], v[222:223], v[74:75], v[16:19]
    ds_read_u16 v227, v238 offset:72
    v_add_u32 v239, 272, v239
    v_mfma_f32_4x4x4_16b_bf16 v[246:249], v[216:217], v[76:77], v[20:23]
    v_cvt_pk_bf16_f32 v100, v132, v133
    v_cvt_pk_bf16_f32 v101, v134, v135
    v_mfma_f32_4x4x4_16b_bf16 v[250:253], v[218:219], v[78:79], v[24:27]
    v_cvt_pk_bf16_f32 v102, v136, v137
    v_cvt_pk_bf16_f32 v103, v138, v139
    v_mfma_f32_4x4x4_16b_bf16 v[132:135], v[220:221], v[80:81], v[28:31]
    v_cvt_pk_bf16_f32 v104, v140, v141
    v_cvt_pk_bf16_f32 v105, v142, v143
    v_mfma_f32_4x4x4_16b_bf16 v[136:139], v[222:223], v[82:83], v[32:35]
    v_cvt_pk_bf16_f32 v106, v144, v145
    v_cvt_pk_bf16_f32 v107, v146, v147
    v_mfma_f32_4x4x4_16b_bf16 v[140:143], v[216:217], v[84:85], v[36:39]
    v_cvt_pk_bf16_f32 v108, v246, v247
    v_cvt_pk_bf16_f32 v109, v248, v249
    v_mfma_f32_4x4x4_16b_bf16 v[144:147], v[218:219], v[86:87], v[40:43]
    v_cvt_pk_bf16_f32 v110, v250, v251
    v_cvt_pk_bf16_f32 v111, v252, v253
    v_mfma_f32_4x4x4_16b_bf16 v[246:249], v[220:221], v[88:89], v[44:47]
    v_cvt_pk_bf16_f32 v112, v132, v133
    v_cvt_pk_bf16_f32 v113, v134, v135
    v_mfma_f32_4x4x4_16b_bf16 v[250:253], v[222:223], v[90:91], v[48:51]
    v_cvt_pk_bf16_f32 v114, v136, v137
    v_cvt_pk_bf16_f32 v115, v138, v139
    v_mfma_f32_4x4x4_16b_bf16 v[132:135], v[216:217], v[92:93], v[52:55]
    v_cvt_pk_bf16_f32 v116, v140, v141
    v_cvt_pk_bf16_f32 v117, v142, v143
    v_mfma_f32_4x4x4_16b_bf16 v[136:139], v[218:219], v[94:95], v[56:59]
    v_cvt_pk_bf16_f32 v118, v144, v145
    v_cvt_pk_bf16_f32 v119, v146, v147
    v_mfma_f32_4x4x4_16b_bf16 v[140:143], v[220:221], v[96:97], v[60:63]
    v_cvt_pk_bf16_f32 v120, v246, v247
    v_cvt_pk_bf16_f32 v121, v248, v249
    v_mfma_f32_4x4x4_16b_bf16 v[144:147], v[222:223], v[98:99], v[64:67]
    v_cvt_pk_bf16_f32 v122, v250, v251
    v_cvt_pk_bf16_f32 v123, v252, v253
    v_cvt_pk_bf16_f32 v124, v132, v133
    v_cvt_pk_bf16_f32 v125, v134, v135
    v_cvt_pk_bf16_f32 v126, v136, v137
    v_cvt_pk_bf16_f32 v127, v138, v139
    v_cvt_pk_bf16_f32 v128, v140, v141
    v_cvt_pk_bf16_f32 v129, v142, v143
    v_cvt_pk_bf16_f32 v130, v144, v145
    v_cvt_pk_bf16_f32 v131, v146, v147
    s_waitcnt lgkmcnt(0)
    s_branch Lf_wbd2
Lf_adv2:
    s_sub_u32 s60, s60, 1
    s_cselect_b32 s31, 0, s31
    s_add_u32 s20, s20, s31
    s_addc_u32 s21, s21, 0
    s_xor_b32 s31, s31, 0x63ff800
    s_branch Lf_advd2
Lf_last2:
    v_add_u32 v236, 4160, v236
    s_lshr_b64 s[56:57], s[56:57], 2
    s_branch Lf_tail
Lf_flush3:
    v_cvt_pk_bf16_f32 v246, v212, v212
    v_mov_b32 v212, 0
    ds_write_b16 v240, v246
    v_add_u32 v240, 128, v240
    s_branch Lf_flushed3
Lf_wb3:
    s_sub_u32 s61, s61, 1
    s_cbranch_scc1 Lf_last3
    v_mul_u32_u24 v216, v224, v241
    v_mul_u32_u24 v217, v224, v242
    v_mul_u32_u24 v218, v225, v241
    v_mul_u32_u24 v219, v225, v242
    v_mul_u32_u24 v220, v226, v241
    v_mul_u32_u24 v221, v226, v242
    v_mul_u32_u24 v222, v227, v241
    v_mul_u32_u24 v223, v227, v242
    v_add_u32 v238, 128, v238
    ds_read_b128 v[164:167], v239
    v_mfma_f32_4x4x4_16b_bf16 v[132:135], v[216:217], v[68:69], v[4:7]
    ds_read_b128 v[168:171], v239 offset:64
    ds_read_b128 v[172:175], v239 offset:128
    v_mfma_f32_4x4x4_16b_bf16 v[136:139], v[218:219], v[70:71], v[8:11]
    ds_read_b128 v[176:179], v239 offset:192
    ds_read_u16 v224, v238
    v_mfma_f32_4x4x4_16b_bf16 v[140:143], v[220:221], v[72:73], v[12:15]
    ds_read_u16 v225, v238 offset:8
    ds_read_u16 v226, v238 offset:64
    v_mfma_f32_4x4x4_16b_bf16 v[144:147], v[222:223], v[74:75], v[16:19]
    ds_read_u16 v227, v238 offset:72
    v_add_u32 v239, 272, v239
    v_mfma_f32_4x4x4_16b_bf16 v[246:249], v[216:217], v[76:77], v[20:23]
    v_cvt_pk_bf16_f32 v100, v132, v133
    v_cvt_pk_bf16_f32 v101, v134, v135
    v_mfma_f32_4x4x4_16b_bf16 v[250:253], v[218:219], v[78:79], v[24:27]
    v_cvt_pk_bf16_f32 v102, v136, v137
    v_cvt_pk_bf16_f32 v103, v138, v139
    v_mfma_f32_4x4x4_16b_bf16 v[132:135], v[220:221], v[80:81], v[28:31]
    v_cvt_pk_bf16_f32 v104, v140, v141
    v_cvt_pk_bf16_f32 v105, v142, v143
    v_mfma_f32_4x4x4_16b_bf16 v[136:139], v[222:223], v[82:83], v[32:35]
    v_cvt_pk_bf16_f32 v106, v144, v145
    v_cvt_pk_bf16_f32 v107, v146, v147
    v_mfma_f32_4x4x4_16b_bf16 v[140:143], v[216:217], v[84:85], v[36:39]
    v_cvt_pk_bf16_f32 v108, v246, v247
    v_cvt_pk_bf16_f32 v109, v248, v249
    v_mfma_f32_4x4x4_16b_bf16 v[144:147], v[218:219], v[86:87], v[40:43]
    v_cvt_pk_bf16_f32 v110, v250, v251
    v_cvt_pk_bf16_f32 v111, v252, v253
    v_mfma_f32_4x4x4_16b_bf16 v[246:249], v[220:221], v[88:89], v[44:47]
    v_cvt_pk_bf16_f32 v112, v132, v133
    v_cvt_pk_bf16_f32 v113, v134, v135
    v_mfma_f32_4x4x4_16b_bf16 v[250:253], v[222:223], v[90:91], v[48:51]
    v_cvt_pk_bf16_f32 v114, v136, v137
    v_cvt_pk_bf16_f32 v115, v138, v139
    v_mfma_f32_4x4x4_16b_bf16 v[132:135], v[216:217], v[92:93], v[52:55]
    v_cvt_pk_bf16_f32 v116, v140, v141
    v_cvt_pk_bf16_f32 v117, v142, v143
    v_mfma_f32_4x4x4_16b_bf16 v[136:139], v[218:219], v[94:95], v[56:59]
    v_cvt_pk_bf16_f32 v118, v144, v145
    v_cvt_pk_bf16_f32 v119, v146, v147
    v_mfma_f32_4x4x4_16b_bf16 v[140:143], v[220:221], v[96:97], v[60:63]
    v_cvt_pk_bf16_f32 v120, v246, v247
    v_cvt_pk_bf16_f32 v121, v248, v249
    v_mfma_f32_4x4x4_16b_bf16 v[144:147], v[222:223], v[98:99], v[64:67]
    v_cvt_pk_bf16_f32 v122, v250, v251
    v_cvt_pk_bf16_f32 v123, v252, v253
    v_cvt_pk_bf16_f32 v124, v132, v133
    v_cvt_pk_bf16_f32 v125, v134, v135
    v_cvt_pk_bf16_f32 v126, v136, v137
    v_cvt_pk_bf16_f32 v127, v138, v139
    v_cvt_pk_bf16_f32 v128, v140, v141
    v_cvt_pk_bf16_f32 v129, v142, v143
    v_cvt_pk_bf16_f32 v130, v144, v145
    v_cvt_pk_bf16_f32 v131, v146, v147
    s_waitcnt lgkmcnt(0)
    s_branch Lf_wbd3
Lf_adv3:
    s_sub_u32 s60, s60, 1
    s_cselect_b32 s31, 0, s31
    s_add_u32 s20, s20, s31
    s_addc_u32 s21, s21, 0
    s_xor_b32 s31, s31, 0x63ff800
    s_branch Lf_advd3
Lf_last3:
    v_add_u32 v236, 6240, v236
    s_lshr_b64 s[56:57], s[56:57], 3
Lf_tail:
    v_exp_f32 v132, v148
    v_exp_f32 v133, v149
    v_exp_f32 v134, v150
    v_exp_f32 v135, v151
    v_exp_f32 v136, v152
    v_exp_f32 v137, v153
    v_mfma_f32_4x4x4_16b_bf16 v[132:135], v[228:229], v[228:229], v[132:135]
    v_cvt_pk_bf16_f32 v208, v208, v209
    v_cvt_pk_bf16_f32 v209, v210, v211
    v_exp_f32 v138, v154
    s_nop 0
    v_mfma_f32_4x4x4_16b_bf16 v[212:215], v[208:209], v[188:189], v[212:215] cbsz:4 abid:0
    ds_read_b64_tr_b16 v[188:189], v236 offset:0
    v_exp_f32 v139, v155
    v_exp_f32 v140, v156
    v_mfma_f32_4x4x4_16b_bf16 v[212:215], v[208:209], v[190:191], v[212:215] cbsz:4 abid:4
    ds_read_b64_tr_b16 v[190:191], v236 offset:512
    v_mfma_f32_4x4x4_16b_bf16 v[136:139], v[228:229], v[228:229], v[136:139]
    v_rcp_f32 v132, v132
    v_mfma_f32_4x4x4_16b_bf16 v[212:215], v[208:209], v[192:193], v[212:215] cbsz:4 abid:8
    ds_read_b64_tr_b16 v[192:193], v236 offset:1056
    v_exp_f32 v141, v157
    v_rcp_f32 v133, v133
    v_mfma_f32_4x4x4_16b_bf16 v[212:215], v[208:209], v[194:195], v[212:215] cbsz:4 abid:12
    ds_read_b64_tr_b16 v[194:195], v236 offset:1568
    v_exp_f32 v142, v158
    v_rcp_f32 v134, v134
    v_exp_f32 v143, v159
    v_rcp_f32 v135, v135
    v_cvt_pk_bf16_f32 v132, v132, v133
    v_mfma_f32_4x4x4_16b_bf16 v[140:143], v[228:229], v[228:229], v[140:143]
    v_exp_f32 v144, v160
    v_rcp_f32 v136, v136
    v_cvt_pk_bf16_f32 v133, v134, v135
    s_bitcmp1_b64 s[56:57], 0
    s_cbranch_scc1 Lf_flusht0
Lf_flushedt0:
    v_exp_f32 v145, v161
    v_rcp_f32 v137, v137
    v_exp_f32 v146, v162
    v_rcp_f32 v138, v138
    v_cvt_pk_bf16_f32 v134, v136, v137
    v_exp_f32 v147, v163
    s_waitcnt lgkmcnt(0)
    v_rcp_f32 v139, v139
    v_mfma_f32_4x4x4_16b_bf16 v[144:147], v[228:229], v[228:229], v[144:147]
    v_rcp_f32 v140, v140
    v_rcp_f32 v141, v141
    v_cvt_pk_bf16_f32 v135, v138, v139
    v_rcp_f32 v142, v142
    v_cvt_pk_bf16_f32 v136, v140, v141
    v_mfma_f32_16x16x32_bf16 v[208:211], v[132:135], v[196:199], v[204:207]
    v_rcp_f32 v143, v143
    v_rcp_f32 v144, v144
    v_cvt_pk_bf16_f32 v137, v142, v143
    v_rcp_f32 v145, v145
    v_rcp_f32 v146, v146
    v_rcp_f32 v147, v147
    v_cvt_pk_bf16_f32 v138, v144, v145
    v_cvt_pk_bf16_f32 v139, v146, v147
    s_nop 1
    v_mfma_f32_16x16x32_bf16 v[208:211], v[136:139], v[200:203], v[208:211]
    s_nop 7
    v_cvt_pk_bf16_f32 v208, v208, v209
    v_cvt_pk_bf16_f32 v209, v210, v211
    s_nop 1
    v_mfma_f32_4x4x4_16b_bf16 v[212:215], v[208:209], v[188:189], v[212:215] cbsz:4 abid:0
    s_nop 1
    v_mfma_f32_4x4x4_16b_bf16 v[212:215], v[208:209], v[190:191], v[212:215] cbsz:4 abid:4
    s_nop 1
    v_mfma_f32_4x4x4_16b_bf16 v[212:215], v[208:209], v[192:193], v[212:215] cbsz:4 abid:8
    s_nop 1
    v_mfma_f32_4x4x4_16b_bf16 v[212:215], v[208:209], v[194:195], v[212:215] cbsz:4 abid:12
Lf_flushz:
    s_nop 4
    v_cvt_pk_bf16_f32 v246, v212, v212
    v_mov_b32 v212, 0
    ds_write_b16 v240, v246
    s_branch L_store
Lf_flusht0:
    v_cvt_pk_bf16_f32 v246, v212, v212
    v_mov_b32 v212, 0
    ds_write_b16 v240, v246
    v_add_u32 v240, 128, v240
    s_branch Lf_flushedt0
L_store:
    s_add_u32 s66, s52, 8320
    v_lshl_add_u32 v247, v0, 4, s66
    s_waitcnt lgkmcnt(0)
    ds_read_b128 v[148:151], v247
    s_waitcnt lgkmcnt(0)
    global_store_dwordx4 v243, v[148:151], s[18:19]
L_end:
    s_endpgm
Ls_loop:
    ds_read_u8 v230, v237 offset:64
    ds_read_u8 v232, v237 offset:72
    v_mfma_f32_16x16x32_bf16 v[208:211], v[136:139], v[200:203], v[208:211]
Ls_mid:
    ds_read_b32 v246, v244 offset:0
    s_waitcnt lgkmcnt(0)
    v_bfe_u32 v247, v246, 0, 8
    v_lshlrev_b32 v247, 1, v247
    v_bfe_u32 v248, v246, 8, 8
    v_lshlrev_b32 v248, 1, v248
    v_bfe_u32 v249, v246, 16, 8
    v_lshlrev_b32 v249, 1, v249
    v_bfe_u32 v250, v246, 24, 8
    v_lshlrev_b32 v250, 1, v250
    buffer_load_ushort v247, v247, s[24:27], 0 offen
    buffer_load_ushort v248, v248, s[24:27], 0 offen
    buffer_load_ushort v249, v249, s[24:27], 0 offen
    buffer_load_ushort v250, v250, s[24:27], 0 offen
    s_waitcnt vmcnt(0)
    v_lshlrev_b32 v247, 16, v247
    v_mul_f32 v208, v208, v247
    v_lshlrev_b32 v248, 16, v248
    v_mul_f32 v209, v209, v248
    v_lshlrev_b32 v249, 16, v249
    v_mul_f32 v210, v210, v249
    v_lshlrev_b32 v250, 16, v250
    v_mul_f32 v211, v211, v250
    s_bitcmp1_b64 s[56:57], 1
    s_cbranch_scc1 Ls_wb0
Ls_wbd0:
    s_mov_b64 exec, 1
    ds_add_rtn_u32 v1, v2, v3
    s_mov_b64 exec, -1
    v_exp_f32 v132, v148
    v_exp_f32 v133, v149
    v_exp_f32 v134, v150
    v_exp_f32 v135, v151
    v_exp_f32 v136, v152
    v_exp_f32 v137, v153
    v_mfma_f32_4x4x4_16b_bf16 v[132:135], v[228:229], v[228:229], v[132:135]
    v_cvt_pk_bf16_f32 v208, v208, v209
    v_cvt_pk_bf16_f32 v209, v210, v211
    s_waitcnt lgkmcnt(2)
    v_mfma_f32_16x16x32_bf16 v[148:151], v[100:103], v[180:183], v[164:167]
    v_exp_f32 v138, v154
    v_mfma_f32_4x4x4_16b_bf16 v[212:215], v[208:209], v[188:189], v[212:215] cbsz:4 abid:0
    ds_read_b64_tr_b16 v[188:189], v236 offset:0
    v_exp_f32 v139, v155
    v_mfma_f32_16x16x32_bf16 v[152:155], v[108:111], v[180:183], v[168:171]
    v_exp_f32 v140, v156
    v_mfma_f32_4x4x4_16b_bf16 v[212:215], v[208:209], v[190:191], v[212:215] cbsz:4 abid:4
    ds_read_b64_tr_b16 v[190:191], v236 offset:512
    v_mfma_f32_4x4x4_16b_bf16 v[136:139], v[228:229], v[228:229], v[136:139]
    v_rcp_f32 v132, v132
    v_mfma_f32_4x4x4_16b_bf16 v[212:215], v[208:209], v[192:193], v[212:215] cbsz:4 abid:8
    ds_read_b64_tr_b16 v[192:193], v236 offset:1056
    v_exp_f32 v141, v157
    v_mfma_f32_16x16x32_bf16 v[148:151], v[104:107], v[184:187], v[148:151]
    v_rcp_f32 v133, v133
    v_mfma_f32_4x4x4_16b_bf16 v[212:215], v[208:209], v[194:195], v[212:215] cbsz:4 abid:12
    ds_read_b64_tr_b16 v[194:195], v236 offset:1568
    v_exp_f32 v142, v158
    v_mfma_f32_16x16x32_bf16 v[152:155], v[112:115], v[184:187], v[152:155]
    v_rcp_f32 v134, v134
    v_exp_f32 v143, v159
    v_rcp_f32 v135, v135
    v_cvt_pk_bf16_f32 v132, v132, v133
    v_mfma_f32_4x4x4_16b_bf16 v[140:143], v[228:229], v[228:229], v[140:143]
    v_exp_f32 v144, v160
    v_mfma_f32_16x16x32_bf16 v[156:159], v[116:119], v[180:183], v[172:175]
    v_rcp_f32 v136, v136
    v_cvt_pk_bf16_f32 v133, v134, v135
    s_bitcmp1_b64 s[56:57], 0
    s_cbranch_scc1 Ls_flush0
Ls_flushed0:
    v_exp_f32 v145, v161
    v_rcp_f32 v137, v137
    v_exp_f32 v146, v162
    s_bitcmp1_b64 s[56:57], 4
    s_cbranch_scc1 Ls_adv0
Ls_advd0:
    v_rcp_f32 v138, v138
    v_cvt_pk_bf16_f32 v134, v136, v137
    v_exp_f32 v147, v163
    v_mfma_f32_16x16x32_bf16 v[160:163], v[124:127], v[180:183], v[176:179]
    s_waitcnt lgkmcnt(0)
    s_add_u32 m0, s52, 0
    v_rcp_f32 v139, v139
    buffer_load_dwordx4 v[230:231], s[20:23], 0 idxen offen nt lds
    v_mfma_f32_4x4x4_16b_bf16 v[144:147], v[228:229], v[228:229], v[144:147]
    v_mfma_f32_16x16x32_bf16 v[156:159], v[120:123], v[184:187], v[156:159]
    s_add_u32 m0, s52, 1056
    v_rcp_f32 v140, v140
    buffer_load_dwordx4 v[232:233], s[20:23], 0 idxen offen nt lds
    v_mfma_f32_16x16x32_bf16 v[160:163], v[128:131], v[184:187], v[160:163]
    v_readfirstlane_b32 s66, v1
    s_nop 0
    s_xor_b32 s66, s66, s33
    s_cmp_gt_i32 s66, 0
    s_setprio 0
    s_cbranch_scc0 Ls_lo0
    s_setprio 1
Ls_lo0:
    v_rcp_f32 v141, v141
    v_cvt_pk_bf16_f32 v135, v138, v139
    s_waitcnt vmcnt(4)
    ds_read_b128 v[180:183], v234 offset:4160
    ds_read_b128 v[184:187], v235 offset:4160
    v_rcp_f32 v142, v142
    v_cvt_pk_bf16_f32 v136, v140, v141
    v_mfma_f32_16x16x32_bf16 v[208:211], v[132:135], v[196:199], v[204:207]
    v_rcp_f32 v143, v143
    v_rcp_f32 v144, v144
    v_cvt_pk_bf16_f32 v137, v142, v143
    v_rcp_f32 v145, v145
    v_rcp_f32 v146, v146
    v_rcp_f32 v147, v147
    v_cvt_pk_bf16_f32 v138, v144, v145
    v_cvt_pk_bf16_f32 v139, v146, v147
    ds_read_u8 v230, v237 offset:80
    ds_read_u8 v232, v237 offset:88
    v_mfma_f32_16x16x32_bf16 v[208:211], v[136:139], v[200:203], v[208:211]
    ds_read_b32 v246, v244 offset:16
    s_waitcnt lgkmcnt(0)
    v_bfe_u32 v247, v246, 0, 8
    v_lshlrev_b32 v247, 1, v247
    v_bfe_u32 v248, v246, 8, 8
    v_lshlrev_b32 v248, 1, v248
    v_bfe_u32 v249, v246, 16, 8
    v_lshlrev_b32 v249, 1, v249
    v_bfe_u32 v250, v246, 24, 8
    v_lshlrev_b32 v250, 1, v250
    buffer_load_ushort v247, v247, s[24:27], 0 offen
    buffer_load_ushort v248, v248, s[24:27], 0 offen
    buffer_load_ushort v249, v249, s[24:27], 0 offen
    buffer_load_ushort v250, v250, s[24:27], 0 offen
    s_waitcnt vmcnt(0)
    v_lshlrev_b32 v247, 16, v247
    v_mul_f32 v208, v208, v247
    v_lshlrev_b32 v248, 16, v248
    v_mul_f32 v209, v209, v248
    v_lshlrev_b32 v249, 16, v249
    v_mul_f32 v210, v210, v249
    v_lshlrev_b32 v250, 16, v250
    v_mul_f32 v211, v211, v250
    s_bitcmp1_b64 s[56:57], 2
    s_cbranch_scc1 Ls_wb1
Ls_wbd1:
    v_exp_f32 v132, v148
    v_exp_f32 v133, v149
    v_exp_f32 v134, v150
    v_exp_f32 v135, v151
    v_exp_f32 v136, v152
    v_exp_f32 v137, v153
    v_mfma_f32_4x4x4_16b_bf16 v[132:135], v[228:229], v[228:229], v[132:135]
    v_cvt_pk_bf16_f32 v208, v208, v209
    v_cvt_pk_bf16_f32 v209, v210, v211
    s_waitcnt lgkmcnt(2)
    v_mfma_f32_16x16x32_bf16 v[148:151], v[100:103], v[180:183], v[164:167]
    v_exp_f32 v138, v154
    v_mfma_f32_4x4x4_16b_bf16 v[212:215], v[208:209], v[188:189], v[212:215] cbsz:4 abid:0
    ds_read_b64_tr_b16 v[188:189], v236 offset:2080
    v_exp_f32 v139, v155
    v_mfma_f32_16x16x32_bf16 v[152:155], v[108:111], v[180:183], v[168:171]
    v_exp_f32 v140, v156
    v_mfma_f32_4x4x4_16b_bf16 v[212:215], v[208:209], v[190:191], v[212:215] cbsz:4 abid:4
    ds_read_b64_tr_b16 v[190:191], v236 offset:2592
    v_mfma_f32_4x4x4_16b_bf16 v[136:139], v[228:229], v[228:229], v[136:139]
    v_rcp_f32 v132, v132
    v_mfma_f32_4x4x4_16b_bf16 v[212:215], v[208:209], v[192:193], v[212:215] cbsz:4 abid:8
    ds_read_b64_tr_b16 v[192:193], v236 offset:3136
    v_exp_f32 v141, v157
    v_mfma_f32_16x16x32_bf16 v[148:151], v[104:107], v[184:187], v[148:151]
    v_rcp_f32 v133, v133
    v_mfma_f32_4x4x4_16b_bf16 v[212:215], v[208:209], v[194:195], v[212:215] cbsz:4 abid:12
    ds_read_b64_tr_b16 v[194:195], v236 offset:3648
    v_exp_f32 v142, v158
    v_mfma_f32_16x16x32_bf16 v[152:155], v[112:115], v[184:187], v[152:155]
    v_rcp_f32 v134, v134
    v_exp_f32 v143, v159
    v_rcp_f32 v135, v135
    v_cvt_pk_bf16_f32 v132, v132, v133
    v_mfma_f32_4x4x4_16b_bf16 v[140:143], v[228:229], v[228:229], v[140:143]
    v_exp_f32 v144, v160
    v_mfma_f32_16x16x32_bf16 v[156:159], v[116:119], v[180:183], v[172:175]
    v_rcp_f32 v136, v136
    v_cvt_pk_bf16_f32 v133, v134, v135
    s_bitcmp1_b64 s[56:57], 1
    s_cbranch_scc1 Ls_flush1
Ls_flushed1:
    v_exp_f32 v145, v161
    v_rcp_f32 v137, v137
    v_exp_f32 v146, v162
    s_bitcmp1_b64 s[56:57], 5
    s_cbranch_scc1 Ls_adv1
Ls_advd1:
    v_rcp_f32 v138, v138
    v_cvt_pk_bf16_f32 v134, v136, v137
    v_exp_f32 v147, v163
    v_mfma_f32_16x16x32_bf16 v[160:163], v[124:127], v[180:183], v[176:179]
    s_waitcnt lgkmcnt(0)
    s_add_u32 m0, s52, 2080
    v_rcp_f32 v139, v139
    buffer_load_dwordx4 v[230:231], s[20:23], 0 idxen offen nt lds
    v_mfma_f32_4x4x4_16b_bf16 v[144:147], v[228:229], v[228:229], v[144:147]
    v_mfma_f32_16x16x32_bf16 v[156:159], v[120:123], v[184:187], v[156:159]
    s_add_u32 m0, s52, 3136
    v_rcp_f32 v140, v140
    buffer_load_dwordx4 v[232:233], s[20:23], 0 idxen offen nt lds
    v_mfma_f32_16x16x32_bf16 v[160:163], v[128:131], v[184:187], v[160:163]
    v_rcp_f32 v141, v141
    v_cvt_pk_bf16_f32 v135, v138, v139
    s_waitcnt vmcnt(4)
    ds_read_b128 v[180:183], v234 offset:6240
    ds_read_b128 v[184:187], v235 offset:6240
    v_rcp_f32 v142, v142
    v_cvt_pk_bf16_f32 v136, v140, v141
    v_mfma_f32_16x16x32_bf16 v[208:211], v[132:135], v[196:199], v[204:207]
    v_rcp_f32 v143, v143
    v_rcp_f32 v144, v144
    v_cvt_pk_bf16_f32 v137, v142, v143
    v_rcp_f32 v145, v145
    v_rcp_f32 v146, v146
    v_rcp_f32 v147, v147
    v_cvt_pk_bf16_f32 v138, v144, v145
    v_cvt_pk_bf16_f32 v139, v146, v147
    ds_read_u8 v230, v237 offset:96
    ds_read_u8 v232, v237 offset:104
    v_mfma_f32_16x16x32_bf16 v[208:211], v[136:139], v[200:203], v[208:211]
    ds_read_b32 v246, v244 offset:32
    s_waitcnt lgkmcnt(0)
    v_bfe_u32 v247, v246, 0, 8
    v_lshlrev_b32 v247, 1, v247
    v_bfe_u32 v248, v246, 8, 8
    v_lshlrev_b32 v248, 1, v248
    v_bfe_u32 v249, v246, 16, 8
    v_lshlrev_b32 v249, 1, v249
    v_bfe_u32 v250, v246, 24, 8
    v_lshlrev_b32 v250, 1, v250
    buffer_load_ushort v247, v247, s[24:27], 0 offen
    buffer_load_ushort v248, v248, s[24:27], 0 offen
    buffer_load_ushort v249, v249, s[24:27], 0 offen
    buffer_load_ushort v250, v250, s[24:27], 0 offen
    s_waitcnt vmcnt(0)
    v_lshlrev_b32 v247, 16, v247
    v_mul_f32 v208, v208, v247
    v_lshlrev_b32 v248, 16, v248
    v_mul_f32 v209, v209, v248
    v_lshlrev_b32 v249, 16, v249
    v_mul_f32 v210, v210, v249
    v_lshlrev_b32 v250, 16, v250
    v_mul_f32 v211, v211, v250
    s_bitcmp1_b64 s[56:57], 3
    s_cbranch_scc1 Ls_wb2
Ls_wbd2:
    s_mov_b64 exec, 1
    ds_add_rtn_u32 v1, v2, v3
    s_mov_b64 exec, -1
    v_exp_f32 v132, v148
    v_exp_f32 v133, v149
    v_exp_f32 v134, v150
    v_exp_f32 v135, v151
    v_exp_f32 v136, v152
    v_exp_f32 v137, v153
    v_mfma_f32_4x4x4_16b_bf16 v[132:135], v[228:229], v[228:229], v[132:135]
    v_cvt_pk_bf16_f32 v208, v208, v209
    v_cvt_pk_bf16_f32 v209, v210, v211
    s_waitcnt lgkmcnt(2)
    v_mfma_f32_16x16x32_bf16 v[148:151], v[100:103], v[180:183], v[164:167]
    v_exp_f32 v138, v154
    v_mfma_f32_4x4x4_16b_bf16 v[212:215], v[208:209], v[188:189], v[212:215] cbsz:4 abid:0
    ds_read_b64_tr_b16 v[188:189], v236 offset:4160
    v_exp_f32 v139, v155
    v_mfma_f32_16x16x32_bf16 v[152:155], v[108:111], v[180:183], v[168:171]
    v_exp_f32 v140, v156
    v_mfma_f32_4x4x4_16b_bf16 v[212:215], v[208:209], v[190:191], v[212:215] cbsz:4 abid:4
    ds_read_b64_tr_b16 v[190:191], v236 offset:4672
    v_mfma_f32_4x4x4_16b_bf16 v[136:139], v[228:229], v[228:229], v[136:139]
    v_rcp_f32 v132, v132
    v_mfma_f32_4x4x4_16b_bf16 v[212:215], v[208:209], v[192:193], v[212:215] cbsz:4 abid:8
    ds_read_b64_tr_b16 v[192:193], v236 offset:5216
    v_exp_f32 v141, v157
    v_mfma_f32_16x16x32_bf16 v[148:151], v[104:107], v[184:187], v[148:151]
    v_rcp_f32 v133, v133
    v_mfma_f32_4x4x4_16b_bf16 v[212:215], v[208:209], v[194:195], v[212:215] cbsz:4 abid:12
    ds_read_b64_tr_b16 v[194:195], v236 offset:5728
    v_exp_f32 v142, v158
    v_mfma_f32_16x16x32_bf16 v[152:155], v[112:115], v[184:187], v[152:155]
    v_rcp_f32 v134, v134
    v_exp_f32 v143, v159
    v_rcp_f32 v135, v135
    v_cvt_pk_bf16_f32 v132, v132, v133
    v_mfma_f32_4x4x4_16b_bf16 v[140:143], v[228:229], v[228:229], v[140:143]
    v_exp_f32 v144, v160
    v_mfma_f32_16x16x32_bf16 v[156:159], v[116:119], v[180:183], v[172:175]
    v_rcp_f32 v136, v136
    v_cvt_pk_bf16_f32 v133, v134, v135
    s_bitcmp1_b64 s[56:57], 2
    s_cbranch_scc1 Ls_flush2
Ls_flushed2:
    v_exp_f32 v145, v161
    v_rcp_f32 v137, v137
    v_exp_f32 v146, v162
    s_bitcmp1_b64 s[56:57], 6
    s_cbranch_scc1 Ls_adv2
Ls_advd2:
    v_rcp_f32 v138, v138
    v_cvt_pk_bf16_f32 v134, v136, v137
    v_exp_f32 v147, v163
    v_mfma_f32_16x16x32_bf16 v[160:163], v[124:127], v[180:183], v[176:179]
    s_waitcnt lgkmcnt(0)
    s_add_u32 m0, s52, 4160
    v_rcp_f32 v139, v139
    buffer_load_dwordx4 v[230:231], s[20:23], 0 idxen offen nt lds
    v_mfma_f32_4x4x4_16b_bf16 v[144:147], v[228:229], v[228:229], v[144:147]
    v_mfma_f32_16x16x32_bf16 v[156:159], v[120:123], v[184:187], v[156:159]
    s_add_u32 m0, s52, 5216
    v_rcp_f32 v140, v140
    buffer_load_dwordx4 v[232:233], s[20:23], 0 idxen offen nt lds
    v_mfma_f32_16x16x32_bf16 v[160:163], v[128:131], v[184:187], v[160:163]
    v_readfirstlane_b32 s66, v1
    s_nop 0
    s_xor_b32 s66, s66, s33
    s_cmp_gt_i32 s66, 0
    s_setprio 0
    s_cbranch_scc0 Ls_lo2
    s_setprio 1
Ls_lo2:
    v_rcp_f32 v141, v141
    v_cvt_pk_bf16_f32 v135, v138, v139
    s_waitcnt vmcnt(4)
    ds_read_b128 v[180:183], v234 offset:0
    ds_read_b128 v[184:187], v235 offset:0
    v_rcp_f32 v142, v142
    v_cvt_pk_bf16_f32 v136, v140, v141
    v_mfma_f32_16x16x32_bf16 v[208:211], v[132:135], v[196:199], v[204:207]
    v_rcp_f32 v143, v143
    v_rcp_f32 v144, v144
    v_cvt_pk_bf16_f32 v137, v142, v143
    v_rcp_f32 v145, v145
    v_rcp_f32 v146, v146
    v_rcp_f32 v147, v147
    v_cvt_pk_bf16_f32 v138, v144, v145
    v_cvt_pk_bf16_f32 v139, v146, v147
    ds_read_u8 v230, v237 offset:112
    ds_read_u8 v232, v237 offset:120
    v_mfma_f32_16x16x32_bf16 v[208:211], v[136:139], v[200:203], v[208:211]
    ds_read_b32 v246, v244 offset:48
    s_waitcnt lgkmcnt(0)
    v_bfe_u32 v247, v246, 0, 8
    v_lshlrev_b32 v247, 1, v247
    v_bfe_u32 v248, v246, 8, 8
    v_lshlrev_b32 v248, 1, v248
    v_bfe_u32 v249, v246, 16, 8
    v_lshlrev_b32 v249, 1, v249
    v_bfe_u32 v250, v246, 24, 8
    v_lshlrev_b32 v250, 1, v250
    buffer_load_ushort v247, v247, s[24:27], 0 offen
    buffer_load_ushort v248, v248, s[24:27], 0 offen
    buffer_load_ushort v249, v249, s[24:27], 0 offen
    buffer_load_ushort v250, v250, s[24:27], 0 offen
    s_waitcnt vmcnt(0)
    v_lshlrev_b32 v247, 16, v247
    v_mul_f32 v208, v208, v247
    v_lshlrev_b32 v248, 16, v248
    v_mul_f32 v209, v209, v248
    v_lshlrev_b32 v249, 16, v249
    v_mul_f32 v210, v210, v249
    v_lshlrev_b32 v250, 16, v250
    v_mul_f32 v211, v211, v250
    s_bitcmp1_b64 s[56:57], 4
    s_cbranch_scc1 Ls_wb3
Ls_wbd3:
    v_exp_f32 v132, v148
    v_exp_f32 v133, v149
    v_exp_f32 v134, v150
    v_exp_f32 v135, v151
    v_exp_f32 v136, v152
    v_exp_f32 v137, v153
    v_mfma_f32_4x4x4_16b_bf16 v[132:135], v[228:229], v[228:229], v[132:135]
    v_cvt_pk_bf16_f32 v208, v208, v209
    v_cvt_pk_bf16_f32 v209, v210, v211
    s_waitcnt lgkmcnt(2)
    v_mfma_f32_16x16x32_bf16 v[148:151], v[100:103], v[180:183], v[164:167]
    v_exp_f32 v138, v154
    v_mfma_f32_4x4x4_16b_bf16 v[212:215], v[208:209], v[188:189], v[212:215] cbsz:4 abid:0
    ds_read_b64_tr_b16 v[188:189], v236 offset:6240
    v_exp_f32 v139, v155
    v_mfma_f32_16x16x32_bf16 v[152:155], v[108:111], v[180:183], v[168:171]
    v_exp_f32 v140, v156
    v_mfma_f32_4x4x4_16b_bf16 v[212:215], v[208:209], v[190:191], v[212:215] cbsz:4 abid:4
    ds_read_b64_tr_b16 v[190:191], v236 offset:6752
    v_mfma_f32_4x4x4_16b_bf16 v[136:139], v[228:229], v[228:229], v[136:139]
    v_rcp_f32 v132, v132
    v_mfma_f32_4x4x4_16b_bf16 v[212:215], v[208:209], v[192:193], v[212:215] cbsz:4 abid:8
    ds_read_b64_tr_b16 v[192:193], v236 offset:7296
    v_exp_f32 v141, v157
    v_mfma_f32_16x16x32_bf16 v[148:151], v[104:107], v[184:187], v[148:151]
    v_rcp_f32 v133, v133
    v_mfma_f32_4x4x4_16b_bf16 v[212:215], v[208:209], v[194:195], v[212:215] cbsz:4 abid:12
    ds_read_b64_tr_b16 v[194:195], v236 offset:7808
    v_exp_f32 v142, v158
    v_mfma_f32_16x16x32_bf16 v[152:155], v[112:115], v[184:187], v[152:155]
    v_rcp_f32 v134, v134
    v_exp_f32 v143, v159
    v_rcp_f32 v135, v135
    v_cvt_pk_bf16_f32 v132, v132, v133
    v_mfma_f32_4x4x4_16b_bf16 v[140:143], v[228:229], v[228:229], v[140:143]
    v_exp_f32 v144, v160
    v_mfma_f32_16x16x32_bf16 v[156:159], v[116:119], v[180:183], v[172:175]
    v_rcp_f32 v136, v136
    v_cvt_pk_bf16_f32 v133, v134, v135
    s_bitcmp1_b64 s[56:57], 3
    s_cbranch_scc1 Ls_flush3
Ls_flushed3:
    v_exp_f32 v145, v161
    v_rcp_f32 v137, v137
    v_exp_f32 v146, v162
    s_bitcmp1_b64 s[56:57], 7
    s_cbranch_scc1 Ls_adv3
Ls_advd3:
    v_rcp_f32 v138, v138
    v_cvt_pk_bf16_f32 v134, v136, v137
    v_exp_f32 v147, v163
    v_mfma_f32_16x16x32_bf16 v[160:163], v[124:127], v[180:183], v[176:179]
    s_waitcnt lgkmcnt(0)
    s_add_u32 m0, s52, 6240
    v_rcp_f32 v139, v139
    buffer_load_dwordx4 v[230:231], s[20:23], 0 idxen offen nt lds
    v_mfma_f32_4x4x4_16b_bf16 v[144:147], v[228:229], v[228:229], v[144:147]
    v_mfma_f32_16x16x32_bf16 v[156:159], v[120:123], v[184:187], v[156:159]
    s_add_u32 m0, s52, 7296
    v_rcp_f32 v140, v140
    buffer_load_dwordx4 v[232:233], s[20:23], 0 idxen offen nt lds
    v_mfma_f32_16x16x32_bf16 v[160:163], v[128:131], v[184:187], v[160:163]
    v_rcp_f32 v141, v141
    v_cvt_pk_bf16_f32 v135, v138, v139
    s_waitcnt vmcnt(4)
    ds_read_b128 v[180:183], v234 offset:2080
    ds_read_b128 v[184:187], v235 offset:2080
    v_rcp_f32 v142, v142
    v_cvt_pk_bf16_f32 v136, v140, v141
    v_mfma_f32_16x16x32_bf16 v[208:211], v[132:135], v[196:199], v[204:207]
    v_rcp_f32 v143, v143
    s_lshr_b64 s[56:57], s[56:57], 4
    s_lshl_b64 s[86:87], s[58:59], 60
    s_or_b64 s[56:57], s[56:57], s[86:87]
    s_lshr_b64 s[58:59], s[58:59], 4
    v_add_u32 v237, 64, v237
    v_add_u32 v244, 64, v244
    v_rcp_f32 v144, v144
    v_cvt_pk_bf16_f32 v137, v142, v143
    v_rcp_f32 v145, v145
    v_rcp_f32 v146, v146
    v_rcp_f32 v147, v147
    v_cvt_pk_bf16_f32 v138, v144, v145
    v_cvt_pk_bf16_f32 v139, v146, v147
    s_branch Ls_loop
Ls_flush0:
    v_cvt_pk_bf16_f32 v246, v212, v212
    v_mov_b32 v212, 0
    ds_write_b16 v240, v246
    v_add_u32 v240, 128, v240
    s_add_u32 s24, s24, s32
    s_addc_u32 s25, s25, 0
    s_xor_b32 s32, s32, 0x18ffe0
    s_branch Ls_flushed0
Ls_wb0:
    s_sub_u32 s61, s61, 1
    s_cbranch_scc1 Ls_last0
    v_mul_u32_u24 v216, v224, v241
    v_mul_u32_u24 v217, v224, v242
    v_mul_u32_u24 v218, v225, v241
    v_mul_u32_u24 v219, v225, v242
    v_mul_u32_u24 v220, v226, v241
    v_mul_u32_u24 v221, v226, v242
    v_mul_u32_u24 v222, v227, v241
    v_mul_u32_u24 v223, v227, v242
    v_add_u32 v238, 128, v238
    ds_read_b128 v[164:167], v239
    v_mfma_f32_4x4x4_16b_bf16 v[132:135], v[216:217], v[68:69], v[4:7]
    ds_read_b128 v[168:171], v239 offset:64
    ds_read_b128 v[172:175], v239 offset:128
    v_mfma_f32_4x4x4_16b_bf16 v[136:139], v[218:219], v[70:71], v[8:11]
    ds_read_b128 v[176:179], v239 offset:192
    ds_read_u16 v224, v238
    v_mfma_f32_4x4x4_16b_bf16 v[140:143], v[220:221], v[72:73], v[12:15]
    ds_read_u16 v225, v238 offset:8
    ds_read_u16 v226, v238 offset:64
    v_mfma_f32_4x4x4_16b_bf16 v[144:147], v[222:223], v[74:75], v[16:19]
    ds_read_u16 v227, v238 offset:72
    v_add_u32 v239, 272, v239
    v_mfma_f32_4x4x4_16b_bf16 v[246:249], v[216:217], v[76:77], v[20:23]
    v_cvt_pk_bf16_f32 v100, v132, v133
    v_cvt_pk_bf16_f32 v101, v134, v135
    v_mfma_f32_4x4x4_16b_bf16 v[250:253], v[218:219], v[78:79], v[24:27]
    v_cvt_pk_bf16_f32 v102, v136, v137
    v_cvt_pk_bf16_f32 v103, v138, v139
    v_mfma_f32_4x4x4_16b_bf16 v[132:135], v[220:221], v[80:81], v[28:31]
    v_cvt_pk_bf16_f32 v104, v140, v141
    v_cvt_pk_bf16_f32 v105, v142, v143
    v_mfma_f32_4x4x4_16b_bf16 v[136:139], v[222:223], v[82:83], v[32:35]
    v_cvt_pk_bf16_f32 v106, v144, v145
    v_cvt_pk_bf16_f32 v107, v146, v147
    v_mfma_f32_4x4x4_16b_bf16 v[140:143], v[216:217], v[84:85], v[36:39]
    v_cvt_pk_bf16_f32 v108, v246, v247
    v_cvt_pk_bf16_f32 v109, v248, v249
    v_mfma_f32_4x4x4_16b_bf16 v[144:147], v[218:219], v[86:87], v[40:43]
    v_cvt_pk_bf16_f32 v110, v250, v251
    v_cvt_pk_bf16_f32 v111, v252, v253
    v_mfma_f32_4x4x4_16b_bf16 v[246:249], v[220:221], v[88:89], v[44:47]
    v_cvt_pk_bf16_f32 v112, v132, v133
    v_cvt_pk_bf16_f32 v113, v134, v135
    v_mfma_f32_4x4x4_16b_bf16 v[250:253], v[222:223], v[90:91], v[48:51]
    v_cvt_pk_bf16_f32 v114, v136, v137
    v_cvt_pk_bf16_f32 v115, v138, v139
    v_mfma_f32_4x4x4_16b_bf16 v[132:135], v[216:217], v[92:93], v[52:55]
    v_cvt_pk_bf16_f32 v116, v140, v141
    v_cvt_pk_bf16_f32 v117, v142, v143
    v_mfma_f32_4x4x4_16b_bf16 v[136:139], v[218:219], v[94:95], v[56:59]
    v_cvt_pk_bf16_f32 v118, v144, v145
    v_cvt_pk_bf16_f32 v119, v146, v147
    v_mfma_f32_4x4x4_16b_bf16 v[140:143], v[220:221], v[96:97], v[60:63]
    v_cvt_pk_bf16_f32 v120, v246, v247
    v_cvt_pk_bf16_f32 v121, v248, v249
    v_mfma_f32_4x4x4_16b_bf16 v[144:147], v[222:223], v[98:99], v[64:67]
    v_cvt_pk_bf16_f32 v122, v250, v251
    v_cvt_pk_bf16_f32 v123, v252, v253
    v_cvt_pk_bf16_f32 v124, v132, v133
    v_cvt_pk_bf16_f32 v125, v134, v135
    v_cvt_pk_bf16_f32 v126, v136, v137
    v_cvt_pk_bf16_f32 v127, v138, v139
    v_cvt_pk_bf16_f32 v128, v140, v141
    v_cvt_pk_bf16_f32 v129, v142, v143
    v_cvt_pk_bf16_f32 v130, v144, v145
    v_cvt_pk_bf16_f32 v131, v146, v147
    s_waitcnt lgkmcnt(0)
    s_branch Ls_wbd0
Ls_adv0:
    s_sub_u32 s60, s60, 1
    s_cselect_b32 s31, 0, s31
    s_add_u32 s20, s20, s31
    s_addc_u32 s21, s21, 0
    s_xor_b32 s31, s31, 0x63ff800
    s_branch Ls_advd0
Ls_last0:
    v_add_u32 v244, 16, v244
    s_branch Ls_tail
Ls_flush1:
    v_cvt_pk_bf16_f32 v246, v212, v212
    v_mov_b32 v212, 0
    ds_write_b16 v240, v246
    v_add_u32 v240, 128, v240
    s_add_u32 s24, s24, s32
    s_addc_u32 s25, s25, 0
    s_xor_b32 s32, s32, 0x18ffe0
    s_branch Ls_flushed1
Ls_wb1:
    s_sub_u32 s61, s61, 1
    s_cbranch_scc1 Ls_last1
    v_mul_u32_u24 v216, v224, v241
    v_mul_u32_u24 v217, v224, v242
    v_mul_u32_u24 v218, v225, v241
    v_mul_u32_u24 v219, v225, v242
    v_mul_u32_u24 v220, v226, v241
    v_mul_u32_u24 v221, v226, v242
    v_mul_u32_u24 v222, v227, v241
    v_mul_u32_u24 v223, v227, v242
    v_add_u32 v238, 128, v238
    ds_read_b128 v[164:167], v239
    v_mfma_f32_4x4x4_16b_bf16 v[132:135], v[216:217], v[68:69], v[4:7]
    ds_read_b128 v[168:171], v239 offset:64
    ds_read_b128 v[172:175], v239 offset:128
    v_mfma_f32_4x4x4_16b_bf16 v[136:139], v[218:219], v[70:71], v[8:11]
    ds_read_b128 v[176:179], v239 offset:192
    ds_read_u16 v224, v238
    v_mfma_f32_4x4x4_16b_bf16 v[140:143], v[220:221], v[72:73], v[12:15]
    ds_read_u16 v225, v238 offset:8
    ds_read_u16 v226, v238 offset:64
    v_mfma_f32_4x4x4_16b_bf16 v[144:147], v[222:223], v[74:75], v[16:19]
    ds_read_u16 v227, v238 offset:72
    v_add_u32 v239, 272, v239
    v_mfma_f32_4x4x4_16b_bf16 v[246:249], v[216:217], v[76:77], v[20:23]
    v_cvt_pk_bf16_f32 v100, v132, v133
    v_cvt_pk_bf16_f32 v101, v134, v135
    v_mfma_f32_4x4x4_16b_bf16 v[250:253], v[218:219], v[78:79], v[24:27]
    v_cvt_pk_bf16_f32 v102, v136, v137
    v_cvt_pk_bf16_f32 v103, v138, v139
    v_mfma_f32_4x4x4_16b_bf16 v[132:135], v[220:221], v[80:81], v[28:31]
    v_cvt_pk_bf16_f32 v104, v140, v141
    v_cvt_pk_bf16_f32 v105, v142, v143
    v_mfma_f32_4x4x4_16b_bf16 v[136:139], v[222:223], v[82:83], v[32:35]
    v_cvt_pk_bf16_f32 v106, v144, v145
    v_cvt_pk_bf16_f32 v107, v146, v147
    v_mfma_f32_4x4x4_16b_bf16 v[140:143], v[216:217], v[84:85], v[36:39]
    v_cvt_pk_bf16_f32 v108, v246, v247
    v_cvt_pk_bf16_f32 v109, v248, v249
    v_mfma_f32_4x4x4_16b_bf16 v[144:147], v[218:219], v[86:87], v[40:43]
    v_cvt_pk_bf16_f32 v110, v250, v251
    v_cvt_pk_bf16_f32 v111, v252, v253
    v_mfma_f32_4x4x4_16b_bf16 v[246:249], v[220:221], v[88:89], v[44:47]
    v_cvt_pk_bf16_f32 v112, v132, v133
    v_cvt_pk_bf16_f32 v113, v134, v135
    v_mfma_f32_4x4x4_16b_bf16 v[250:253], v[222:223], v[90:91], v[48:51]
    v_cvt_pk_bf16_f32 v114, v136, v137
    v_cvt_pk_bf16_f32 v115, v138, v139
    v_mfma_f32_4x4x4_16b_bf16 v[132:135], v[216:217], v[92:93], v[52:55]
    v_cvt_pk_bf16_f32 v116, v140, v141
    v_cvt_pk_bf16_f32 v117, v142, v143
    v_mfma_f32_4x4x4_16b_bf16 v[136:139], v[218:219], v[94:95], v[56:59]
    v_cvt_pk_bf16_f32 v118, v144, v145
    v_cvt_pk_bf16_f32 v119, v146, v147
    v_mfma_f32_4x4x4_16b_bf16 v[140:143], v[220:221], v[96:97], v[60:63]
    v_cvt_pk_bf16_f32 v120, v246, v247
    v_cvt_pk_bf16_f32 v121, v248, v249
    v_mfma_f32_4x4x4_16b_bf16 v[144:147], v[222:223], v[98:99], v[64:67]
    v_cvt_pk_bf16_f32 v122, v250, v251
    v_cvt_pk_bf16_f32 v123, v252, v253
    v_cvt_pk_bf16_f32 v124, v132, v133
    v_cvt_pk_bf16_f32 v125, v134, v135
    v_cvt_pk_bf16_f32 v126, v136, v137
    v_cvt_pk_bf16_f32 v127, v138, v139
    v_cvt_pk_bf16_f32 v128, v140, v141
    v_cvt_pk_bf16_f32 v129, v142, v143
    v_cvt_pk_bf16_f32 v130, v144, v145
    v_cvt_pk_bf16_f32 v131, v146, v147
    s_waitcnt lgkmcnt(0)
    s_branch Ls_wbd1
Ls_adv1:
    s_sub_u32 s60, s60, 1
    s_cselect_b32 s31, 0, s31
    s_add_u32 s20, s20, s31
    s_addc_u32 s21, s21, 0
    s_xor_b32 s31, s31, 0x63ff800
    s_branch Ls_advd1
Ls_last1:
    v_add_u32 v236, 2080, v236
    s_lshr_b64 s[56:57], s[56:57], 1
    v_add_u32 v244, 32, v244
    s_branch Ls_tail
Ls_flush2:
    v_cvt_pk_bf16_f32 v246, v212, v212
    v_mov_b32 v212, 0
    ds_write_b16 v240, v246
    v_add_u32 v240, 128, v240
    s_add_u32 s24, s24, s32
    s_addc_u32 s25, s25, 0
    s_xor_b32 s32, s32, 0x18ffe0
    s_branch Ls_flushed2
Ls_wb2:
    s_sub_u32 s61, s61, 1
    s_cbranch_scc1 Ls_last2
    v_mul_u32_u24 v216, v224, v241
    v_mul_u32_u24 v217, v224, v242
    v_mul_u32_u24 v218, v225, v241
    v_mul_u32_u24 v219, v225, v242
    v_mul_u32_u24 v220, v226, v241
    v_mul_u32_u24 v221, v226, v242
    v_mul_u32_u24 v222, v227, v241
    v_mul_u32_u24 v223, v227, v242
    v_add_u32 v238, 128, v238
    ds_read_b128 v[164:167], v239
    v_mfma_f32_4x4x4_16b_bf16 v[132:135], v[216:217], v[68:69], v[4:7]
    ds_read_b128 v[168:171], v239 offset:64
    ds_read_b128 v[172:175], v239 offset:128
    v_mfma_f32_4x4x4_16b_bf16 v[136:139], v[218:219], v[70:71], v[8:11]
    ds_read_b128 v[176:179], v239 offset:192
    ds_read_u16 v224, v238
    v_mfma_f32_4x4x4_16b_bf16 v[140:143], v[220:221], v[72:73], v[12:15]
    ds_read_u16 v225, v238 offset:8
    ds_read_u16 v226, v238 offset:64
    v_mfma_f32_4x4x4_16b_bf16 v[144:147], v[222:223], v[74:75], v[16:19]
    ds_read_u16 v227, v238 offset:72
    v_add_u32 v239, 272, v239
    v_mfma_f32_4x4x4_16b_bf16 v[246:249], v[216:217], v[76:77], v[20:23]
    v_cvt_pk_bf16_f32 v100, v132, v133
    v_cvt_pk_bf16_f32 v101, v134, v135
    v_mfma_f32_4x4x4_16b_bf16 v[250:253], v[218:219], v[78:79], v[24:27]
    v_cvt_pk_bf16_f32 v102, v136, v137
    v_cvt_pk_bf16_f32 v103, v138, v139
    v_mfma_f32_4x4x4_16b_bf16 v[132:135], v[220:221], v[80:81], v[28:31]
    v_cvt_pk_bf16_f32 v104, v140, v141
    v_cvt_pk_bf16_f32 v105, v142, v143
    v_mfma_f32_4x4x4_16b_bf16 v[136:139], v[222:223], v[82:83], v[32:35]
    v_cvt_pk_bf16_f32 v106, v144, v145
    v_cvt_pk_bf16_f32 v107, v146, v147
    v_mfma_f32_4x4x4_16b_bf16 v[140:143], v[216:217], v[84:85], v[36:39]
    v_cvt_pk_bf16_f32 v108, v246, v247
    v_cvt_pk_bf16_f32 v109, v248, v249
    v_mfma_f32_4x4x4_16b_bf16 v[144:147], v[218:219], v[86:87], v[40:43]
    v_cvt_pk_bf16_f32 v110, v250, v251
    v_cvt_pk_bf16_f32 v111, v252, v253
    v_mfma_f32_4x4x4_16b_bf16 v[246:249], v[220:221], v[88:89], v[44:47]
    v_cvt_pk_bf16_f32 v112, v132, v133
    v_cvt_pk_bf16_f32 v113, v134, v135
    v_mfma_f32_4x4x4_16b_bf16 v[250:253], v[222:223], v[90:91], v[48:51]
    v_cvt_pk_bf16_f32 v114, v136, v137
    v_cvt_pk_bf16_f32 v115, v138, v139
    v_mfma_f32_4x4x4_16b_bf16 v[132:135], v[216:217], v[92:93], v[52:55]
    v_cvt_pk_bf16_f32 v116, v140, v141
    v_cvt_pk_bf16_f32 v117, v142, v143
    v_mfma_f32_4x4x4_16b_bf16 v[136:139], v[218:219], v[94:95], v[56:59]
    v_cvt_pk_bf16_f32 v118, v144, v145
    v_cvt_pk_bf16_f32 v119, v146, v147
    v_mfma_f32_4x4x4_16b_bf16 v[140:143], v[220:221], v[96:97], v[60:63]
    v_cvt_pk_bf16_f32 v120, v246, v247
    v_cvt_pk_bf16_f32 v121, v248, v249
    v_mfma_f32_4x4x4_16b_bf16 v[144:147], v[222:223], v[98:99], v[64:67]
    v_cvt_pk_bf16_f32 v122, v250, v251
    v_cvt_pk_bf16_f32 v123, v252, v253
    v_cvt_pk_bf16_f32 v124, v132, v133
    v_cvt_pk_bf16_f32 v125, v134, v135
    v_cvt_pk_bf16_f32 v126, v136, v137
    v_cvt_pk_bf16_f32 v127, v138, v139
    v_cvt_pk_bf16_f32 v128, v140, v141
    v_cvt_pk_bf16_f32 v129, v142, v143
    v_cvt_pk_bf16_f32 v130, v144, v145
    v_cvt_pk_bf16_f32 v131, v146, v147
    s_waitcnt lgkmcnt(0)
    s_branch Ls_wbd2
Ls_adv2:
    s_sub_u32 s60, s60, 1
    s_cselect_b32 s31, 0, s31
    s_add_u32 s20, s20, s31
    s_addc_u32 s21, s21, 0
    s_xor_b32 s31, s31, 0x63ff800
    s_branch Ls_advd2
Ls_last2:
    v_add_u32 v236, 4160, v236
    s_lshr_b64 s[56:57], s[56:57], 2
    v_add_u32 v244, 48, v244
    s_branch Ls_tail
Ls_flush3:
    v_cvt_pk_bf16_f32 v246, v212, v212
    v_mov_b32 v212, 0
    ds_write_b16 v240, v246
    v_add_u32 v240, 128, v240
    s_add_u32 s24, s24, s32
    s_addc_u32 s25, s25, 0
    s_xor_b32 s32, s32, 0x18ffe0
    s_branch Ls_flushed3
Ls_wb3:
    s_sub_u32 s61, s61, 1
    s_cbranch_scc1 Ls_last3
    v_mul_u32_u24 v216, v224, v241
    v_mul_u32_u24 v217, v224, v242
    v_mul_u32_u24 v218, v225, v241
    v_mul_u32_u24 v219, v225, v242
    v_mul_u32_u24 v220, v226, v241
    v_mul_u32_u24 v221, v226, v242
    v_mul_u32_u24 v222, v227, v241
    v_mul_u32_u24 v223, v227, v242
    v_add_u32 v238, 128, v238
    ds_read_b128 v[164:167], v239
    v_mfma_f32_4x4x4_16b_bf16 v[132:135], v[216:217], v[68:69], v[4:7]
    ds_read_b128 v[168:171], v239 offset:64
    ds_read_b128 v[172:175], v239 offset:128
    v_mfma_f32_4x4x4_16b_bf16 v[136:139], v[218:219], v[70:71], v[8:11]
    ds_read_b128 v[176:179], v239 offset:192
    ds_read_u16 v224, v238
    v_mfma_f32_4x4x4_16b_bf16 v[140:143], v[220:221], v[72:73], v[12:15]
    ds_read_u16 v225, v238 offset:8
    ds_read_u16 v226, v238 offset:64
    v_mfma_f32_4x4x4_16b_bf16 v[144:147], v[222:223], v[74:75], v[16:19]
    ds_read_u16 v227, v238 offset:72
    v_add_u32 v239, 272, v239
    v_mfma_f32_4x4x4_16b_bf16 v[246:249], v[216:217], v[76:77], v[20:23]
    v_cvt_pk_bf16_f32 v100, v132, v133
    v_cvt_pk_bf16_f32 v101, v134, v135
    v_mfma_f32_4x4x4_16b_bf16 v[250:253], v[218:219], v[78:79], v[24:27]
    v_cvt_pk_bf16_f32 v102, v136, v137
    v_cvt_pk_bf16_f32 v103, v138, v139
    v_mfma_f32_4x4x4_16b_bf16 v[132:135], v[220:221], v[80:81], v[28:31]
    v_cvt_pk_bf16_f32 v104, v140, v141
    v_cvt_pk_bf16_f32 v105, v142, v143
    v_mfma_f32_4x4x4_16b_bf16 v[136:139], v[222:223], v[82:83], v[32:35]
    v_cvt_pk_bf16_f32 v106, v144, v145
    v_cvt_pk_bf16_f32 v107, v146, v147
    v_mfma_f32_4x4x4_16b_bf16 v[140:143], v[216:217], v[84:85], v[36:39]
    v_cvt_pk_bf16_f32 v108, v246, v247
    v_cvt_pk_bf16_f32 v109, v248, v249
    v_mfma_f32_4x4x4_16b_bf16 v[144:147], v[218:219], v[86:87], v[40:43]
    v_cvt_pk_bf16_f32 v110, v250, v251
    v_cvt_pk_bf16_f32 v111, v252, v253
    v_mfma_f32_4x4x4_16b_bf16 v[246:249], v[220:221], v[88:89], v[44:47]
    v_cvt_pk_bf16_f32 v112, v132, v133
    v_cvt_pk_bf16_f32 v113, v134, v135
    v_mfma_f32_4x4x4_16b_bf16 v[250:253], v[222:223], v[90:91], v[48:51]
    v_cvt_pk_bf16_f32 v114, v136, v137
    v_cvt_pk_bf16_f32 v115, v138, v139
    v_mfma_f32_4x4x4_16b_bf16 v[132:135], v[216:217], v[92:93], v[52:55]
    v_cvt_pk_bf16_f32 v116, v140, v141
    v_cvt_pk_bf16_f32 v117, v142, v143
    v_mfma_f32_4x4x4_16b_bf16 v[136:139], v[218:219], v[94:95], v[56:59]
    v_cvt_pk_bf16_f32 v118, v144, v145
    v_cvt_pk_bf16_f32 v119, v146, v147
    v_mfma_f32_4x4x4_16b_bf16 v[140:143], v[220:221], v[96:97], v[60:63]
    v_cvt_pk_bf16_f32 v120, v246, v247
    v_cvt_pk_bf16_f32 v121, v248, v249
    v_mfma_f32_4x4x4_16b_bf16 v[144:147], v[222:223], v[98:99], v[64:67]
    v_cvt_pk_bf16_f32 v122, v250, v251
    v_cvt_pk_bf16_f32 v123, v252, v253
    v_cvt_pk_bf16_f32 v124, v132, v133
    v_cvt_pk_bf16_f32 v125, v134, v135
    v_cvt_pk_bf16_f32 v126, v136, v137
    v_cvt_pk_bf16_f32 v127, v138, v139
    v_cvt_pk_bf16_f32 v128, v140, v141
    v_cvt_pk_bf16_f32 v129, v142, v143
    v_cvt_pk_bf16_f32 v130, v144, v145
    v_cvt_pk_bf16_f32 v131, v146, v147
    s_waitcnt lgkmcnt(0)
    s_branch Ls_wbd3
Ls_adv3:
    s_sub_u32 s60, s60, 1
    s_cselect_b32 s31, 0, s31
    s_add_u32 s20, s20, s31
    s_addc_u32 s21, s21, 0
    s_xor_b32 s31, s31, 0x63ff800
    s_branch Ls_advd3
Ls_last3:
    v_add_u32 v236, 6240, v236
    s_lshr_b64 s[56:57], s[56:57], 3
    v_add_u32 v244, 64, v244
Ls_tail:
    v_exp_f32 v132, v148
    v_exp_f32 v133, v149
    v_exp_f32 v134, v150
    v_exp_f32 v135, v151
    v_exp_f32 v136, v152
    v_exp_f32 v137, v153
    v_mfma_f32_4x4x4_16b_bf16 v[132:135], v[228:229], v[228:229], v[132:135]
    v_cvt_pk_bf16_f32 v208, v208, v209
    v_cvt_pk_bf16_f32 v209, v210, v211
    v_exp_f32 v138, v154
    s_nop 0
    v_mfma_f32_4x4x4_16b_bf16 v[212:215], v[208:209], v[188:189], v[212:215] cbsz:4 abid:0
    ds_read_b64_tr_b16 v[188:189], v236 offset:0
    v_exp_f32 v139, v155
    v_exp_f32 v140, v156
    v_mfma_f32_4x4x4_16b_bf16 v[212:215], v[208:209], v[190:191], v[212:215] cbsz:4 abid:4
    ds_read_b64_tr_b16 v[190:191], v236 offset:512
    v_mfma_f32_4x4x4_16b_bf16 v[136:139], v[228:229], v[228:229], v[136:139]
    v_rcp_f32 v132, v132
    v_mfma_f32_4x4x4_16b_bf16 v[212:215], v[208:209], v[192:193], v[212:215] cbsz:4 abid:8
    ds_read_b64_tr_b16 v[192:193], v236 offset:1056
    v_exp_f32 v141, v157
    v_rcp_f32 v133, v133
    v_mfma_f32_4x4x4_16b_bf16 v[212:215], v[208:209], v[194:195], v[212:215] cbsz:4 abid:12
    ds_read_b64_tr_b16 v[194:195], v236 offset:1568
    v_exp_f32 v142, v158
    v_rcp_f32 v134, v134
    v_exp_f32 v143, v159
    v_rcp_f32 v135, v135
    v_cvt_pk_bf16_f32 v132, v132, v133
    v_mfma_f32_4x4x4_16b_bf16 v[140:143], v[228:229], v[228:229], v[140:143]
    v_exp_f32 v144, v160
    v_rcp_f32 v136, v136
    v_cvt_pk_bf16_f32 v133, v134, v135
    s_bitcmp1_b64 s[56:57], 0
    s_cbranch_scc1 Ls_flusht0
Ls_flushedt0:
    v_exp_f32 v145, v161
    v_rcp_f32 v137, v137
    v_exp_f32 v146, v162
    v_rcp_f32 v138, v138
    v_cvt_pk_bf16_f32 v134, v136, v137
    v_exp_f32 v147, v163
    s_waitcnt lgkmcnt(0)
    v_rcp_f32 v139, v139
    v_mfma_f32_4x4x4_16b_bf16 v[144:147], v[228:229], v[228:229], v[144:147]
    v_rcp_f32 v140, v140
    v_rcp_f32 v141, v141
    v_cvt_pk_bf16_f32 v135, v138, v139
    v_rcp_f32 v142, v142
    v_cvt_pk_bf16_f32 v136, v140, v141
    v_mfma_f32_16x16x32_bf16 v[208:211], v[132:135], v[196:199], v[204:207]
    v_rcp_f32 v143, v143
    v_rcp_f32 v144, v144
    v_cvt_pk_bf16_f32 v137, v142, v143
    v_rcp_f32 v145, v145
    v_rcp_f32 v146, v146
    v_rcp_f32 v147, v147
    v_cvt_pk_bf16_f32 v138, v144, v145
    v_cvt_pk_bf16_f32 v139, v146, v147
    s_nop 1
    v_mfma_f32_16x16x32_bf16 v[208:211], v[136:139], v[200:203], v[208:211]
    ds_read_b32 v246, v244 offset:0
    s_waitcnt lgkmcnt(0)
    v_bfe_u32 v247, v246, 0, 8
    v_lshlrev_b32 v247, 1, v247
    v_bfe_u32 v248, v246, 8, 8
    v_lshlrev_b32 v248, 1, v248
    v_bfe_u32 v249, v246, 16, 8
    v_lshlrev_b32 v249, 1, v249
    v_bfe_u32 v250, v246, 24, 8
    v_lshlrev_b32 v250, 1, v250
    buffer_load_ushort v247, v247, s[24:27], 0 offen
    buffer_load_ushort v248, v248, s[24:27], 0 offen
    buffer_load_ushort v249, v249, s[24:27], 0 offen
    buffer_load_ushort v250, v250, s[24:27], 0 offen
    s_waitcnt vmcnt(0)
    v_lshlrev_b32 v247, 16, v247
    v_mul_f32 v208, v208, v247
    v_lshlrev_b32 v248, 16, v248
    v_mul_f32 v209, v209, v248
    v_lshlrev_b32 v249, 16, v249
    v_mul_f32 v210, v210, v249
    v_lshlrev_b32 v250, 16, v250
    v_mul_f32 v211, v211, v250
    v_cvt_pk_bf16_f32 v208, v208, v209
    v_cvt_pk_bf16_f32 v209, v210, v211
    s_nop 1
    v_mfma_f32_4x4x4_16b_bf16 v[212:215], v[208:209], v[188:189], v[212:215] cbsz:4 abid:0
    s_nop 1
    v_mfma_f32_4x4x4_16b_bf16 v[212:215], v[208:209], v[190:191], v[212:215] cbsz:4 abid:4
    s_nop 1
    v_mfma_f32_4x4x4_16b_bf16 v[212:215], v[208:209], v[192:193], v[212:215] cbsz:4 abid:8
    s_nop 1
    v_mfma_f32_4x4x4_16b_bf16 v[212:215], v[208:209], v[194:195], v[212:215] cbsz:4 abid:12
Ls_flushz:
    s_nop 4
    v_cvt_pk_bf16_f32 v246, v212, v212
    v_mov_b32 v212, 0
    ds_write_b16 v240, v246
    s_branch L_store
Ls_flusht0:
    v_cvt_pk_bf16_f32 v246, v212, v212
    v_mov_b32 v212, 0
    ds_write_b16 v240, v246
    v_add_u32 v240, 128, v240
    s_add_u32 s24, s24, s32
    s_addc_u32 s25, s25, 0
    s_xor_b32 s32, s32, 0x18ffe0
    s_branch Ls_flushedt0
.section .rodata,"a"
.p2align 6
.amdhsa_kernel standalone__sequential_behavior_din__recsys_kernel
  .amdhsa_next_free_vgpr 256
  .amdhsa_next_free_sgpr 102
  .amdhsa_accum_offset 256
  .amdhsa_group_segment_fixed_size 0
  .amdhsa_kernarg_size 80
  .amdhsa_user_sgpr_count 2
  .amdhsa_user_sgpr_kernarg_segment_ptr 1
  .amdhsa_system_sgpr_workgroup_id_x 1
.end_amdhsa_kernel
```

```asm
; @launch grid=(256,1,1) block=(512,1,1) lds=163840
.amdgcn_target "amdgcn-amd-amdhsa--gfx950"
.text
.globl standalone__sequential_behavior_din__recsys_kernel
.p2align 8
.type standalone__sequential_behavior_din__recsys_kernel,@function
standalone__sequential_behavior_din__recsys_kernel:
    s_load_dwordx16 s[4:19], s[0:1], 0
    s_cmp_ge_u32 s2, 256
    s_cbranch_scc1 L_end
    v_lshrrev_b32 v1, 6, v0
    v_and_b32 v0, 63, v0
    v_readfirstlane_b32 s54, v1
    s_lshl_b32 s53, s2, 3
    v_lshlrev_b32 v2, 4, v0
    s_bfm_b64 s[28:29], 50, 0
    s_add_u32 s53, s53, s54
    s_mul_i32 s66, s53, 800
    s_mul_i32 s52, s54, 20480
    v_add_u32 v3, s66, v2
    v_and_b32 v248, 16, v0
    v_lshlrev_b32 v246, 1, v248
    v_xor_b32 v246, v246, v2
    s_lshl_b32 s67, s54, 12
    s_add_u32 m0, s52, 4160
    s_mov_b64 exec, s[28:29]
    s_waitcnt lgkmcnt(0)
    global_load_dwordx4 v[100:103], v3, s[8:9] nt
    s_mov_b64 exec, -1
    s_add_u32 s10, s10, s67
    s_addc_u32 s11, s11, 0
    v_xor_b32 v247, 64, v246
    global_load_lds_dwordx4 v246, s[10:11] offset:0
    global_load_lds_dwordx4 v247, s[10:11] offset:1024
    global_load_lds_dwordx4 v246, s[10:11] offset:2048
    global_load_lds_dwordx4 v247, s[10:11] offset:3072
    s_load_dword s30, s[16:17], 0
    v_lshrrev_b32 v1, 4, v0
    v_and_b32 v243, 0xf0, v2
    v_lshl_add_u32 v243, v1, 19, v243
    s_lshl_b32 s66, s53, 8
    s_add_u32 m0, s52, 8320
    v_add_u32 v243, s66, v243
    s_and_b32 s67, s54, 3
    global_load_lds_dwordx4 v243, s[4:5] nt
    s_lshl_b32 s66, s67, 5
    v_lshl_add_u32 v249, v1, 3, s66
    global_load_dwordx2 v[96:97], v249, s[12:13]
    v_and_b32 v250, 3, v0
    s_mul_i32 s66, s53, 51200
    s_add_u32 s6, s6, s66
    s_addc_u32 s7, s7, 0
    s_mov_b32 s20, s6
    s_and_b32 s21, s7, 0xffff
    s_or_b32 s21, s21, 0x800000
    s_mov_b32 s22, 200
    s_mov_b32 s23, 0x20000
    s_movk_i32 s31, 25600
    v_mov_b32 v148, -1
    v_mov_b32 v149, -1
    v_mov_b32 v150, -1
    v_mov_b32 v151, -1
    s_add_u32 s66, s52, 18432
    v_add_u32 v152, s66, v2
    ds_write_b128 v152, v[148:151]
    ds_write_b128 v152, v[148:151] offset:1024
    v_mov_b32 v153, -1
    v_mov_b32 v154, -1
    v_mov_b32 v155, -1
    s_add_u32 s64, s52, 18448
    v_lshrrev_b32 v237, 3, v0
    v_add_u32 v237, s64, v237
    v_lshl_add_u32 v244, v1, 2, s66
    v_and_b32 v231, 0x70, v2
    v_lshlrev_b32 v248, 2, v248
    v_xor_b32 v231, v231, v248
    v_mov_b32 v233, v231
    v_cmp_lt_u32 vcc, 24, v0
    v_mov_b32 v146, 0
    v_mov_b32 v147, 0
    v_cndmask_b32 v145, 0, 1, vcc
    v_mul_u32_u24 v142, 25, v145
    v_sub_u32 v142, v0, v142
    v_mul_u32_u24 v142, 0x80008, v142
    v_add_u32 v141, 0x10000, v142
    v_add_u32 v143, 0x50004, v142
    v_add_u32 v144, 0x70006, v142
    v_add_u32 v142, 0x30002, v142
    s_mov_b64 s[56:57], 0
    s_mov_b64 s[58:59], 0
    s_mov_b32 s60, 7
    s_mov_b32 s61, 7
    s_mov_b32 s92, 0xbfb8aa3b
    v_and_b32 v251, 15, v0
    v_bfe_u32 v252, v0, 2, 2
    v_lshlrev_b32 v253, 3, v250
    v_lshl_add_u32 v253, v252, 7, v253
    v_and_b32 v246, 24, v0
    v_lshlrev_b32 v246, 2, v246
    v_xor_b32 v246, v253, v246
    v_lshl_add_u32 v246, v1, 10, v246
    s_lshl_b32 s66, s67, 5
    v_xor_b32 v66, s66, v246
    v_add_u32 v66, 45120, v66
    s_lshr_b32 s66, s54, 1
    s_lshl_b32 s66, s66, 5
    v_xor_b32 v64, s66, v246
    s_and_b32 s66, s54, 1
    s_mul_i32 s66, s66, 20480
    s_add_u32 s66, s66, 4160
    v_add_u32 v64, s66, v64
    v_add_u32 v65, 81920, v64
    s_and_b32 s66, s54, 4
    v_lshrrev_b32 v246, 3, v251
    v_add_u32 v246, s66, v246
    v_mul_u32_u24 v246, 20480, v246
    v_lshl_add_u32 v246, v1, 4, v246
    v_and_b32 v247, 7, v0
    v_lshl_add_u32 v67, v247, 7, v246
    v_and_b32 v247, 1, v0
    v_lshlrev_b32 v247, 4, v247
    v_lshlrev_b32 v247, v247, 1
    v_cmp_gt_u32 vcc, 2, v250
    v_mov_b32 v229, 0
    v_mov_b32 v228, 0x3f80
    v_cndmask_b32 v241, 0, v247, vcc
    v_cmp_eq_u32 vcc, 0, v251
    v_sub_u32 v242, v247, v241
    v_mul_u32_u24 v218, 0x3f80, v241
    v_cndmask_b32 v220, 0, -1, vcc
    v_mul_u32_u24 v219, 0x3f80, v242
    s_and_b32 s66, s54, 3
    s_lshl_b32 s66, s66, 6
    s_add_u32 s66, s66, 9344
    v_and_b32 v247, 7, v0
    v_mul_u32_u24 v247, 144, v247
    v_add3_u32 v98, v67, v247, s66
    s_and_b32 s66, s54, 3
    s_mul_i32 s66, s66, 20480
    s_add_u32 s66, s66, 14592
    v_mov_b32 v221, s66
    s_cmp_ge_u32 s54, 4
    s_cselect_b32 s33, -1, 0
    ds_write_b32 v221, v229
    v_and_b32 v247, 8, v0
    v_lshlrev_b32 v247, 2, v247
    v_lshl_add_u32 v247, v251, 7, v247
    v_add_u32 v247, s52, v247
    v_and_b32 v248, 2, v0
    v_lshlrev_b32 v248, 1, v248
    v_xor_b32 v248, v248, v1
    v_lshl_add_u32 v234, v248, 4, v247
    v_xor_b32 v248, 4, v248
    v_lshl_add_u32 v235, v248, 4, v247
    v_and_b32 v247, 8, v0
    v_lshlrev_b32 v247, 3, v247
    v_lshl_add_u32 v248, v1, 5, v253
    v_xor_b32 v248, v248, v247
    v_add_u32 v236, s52, v248
    s_add_u32 s66, s52, 8320
    v_lshl_add_u32 v238, v250, 1, s66
    v_lshl_add_u32 v238, v1, 4, v238
    v_lshl_add_u32 v240, v0, 1, s66
    s_add_u32 s66, s52, 9344
    v_lshl_add_u32 v239, v1, 4, s66
    v_mov_b32 v188, 0
    v_mov_b32 v189, 0
    v_mov_b32 v190, 0
    v_mov_b32 v191, 0
    v_mov_b32 v192, 0
    v_mov_b32 v193, 0
    v_mov_b32 v194, 0
    v_mov_b32 v195, 0
    v_mov_b32 v208, 0
    v_mov_b32 v212, 0
    v_mov_b32 v209, 0
    v_mov_b32 v213, 0
    v_mov_b32 v210, 0
    v_mov_b32 v214, 0
    v_mov_b32 v211, 0
    v_mov_b32 v215, 0
    s_mov_b64 exec, s[28:29]
    v_add_u32 v3, 1638400, v3
    global_load_dwordx4 v[104:107], v3, s[8:9] nt
    v_add_u32 v3, 1638400, v3
    global_load_dwordx4 v[108:111], v3, s[8:9] nt
    v_add_u32 v3, 1638400, v3
    global_load_dwordx4 v[112:115], v3, s[8:9] nt
    s_mov_b64 exec, -1
    v_lshlrev_b32 v249, 3, v1
    v_lshl_add_u32 v249, v250, 5, v249
    global_load_dwordx2 v[216:217], v249, s[14:15]
    s_cmp_ge_u32 s54, 4
    s_cbranch_scc1 L_young1
    s_waitcnt vmcnt(10) lgkmcnt(0)
    s_call_b64 s[62:63], L_fp
    s_waitcnt vmcnt(9)
    s_branch L_old1
L_young1:
    s_waitcnt vmcnt(5)
L_old1:
    s_waitcnt lgkmcnt(0)
    s_barrier
    ds_read_b64_tr_b16 v[16:17], v66 offset:0
    ds_read_b64_tr_b16 v[18:19], v66 offset:512
    ds_read_b64_tr_b16 v[20:21], v66 offset:20480
    ds_read_b64_tr_b16 v[22:23], v66 offset:20992
    ds_read_b64_tr_b16 v[24:25], v66 offset:40960
    ds_read_b64_tr_b16 v[26:27], v66 offset:41472
    ds_read_b64_tr_b16 v[28:29], v66 offset:61440
    ds_read_b64_tr_b16 v[30:31], v66 offset:61952
    ds_read_b128 v[32:35], v67 offset:8320
    ds_read_b128 v[36:39], v67 offset:8384
    ds_read_b128 v[40:43], v67 offset:49280
    ds_read_b128 v[44:47], v67 offset:49344
    ds_read_b64_tr_b16 v[4:5], v64 offset:0
    ds_read_b64_tr_b16 v[8:9], v65 offset:0
    ds_read_b64_tr_b16 v[12:13], v65 offset:40960
    ds_read_b64_tr_b16 v[6:7], v64 offset:512
    ds_read_b64_tr_b16 v[10:11], v65 offset:512
    ds_read_b64_tr_b16 v[14:15], v65 offset:41472
    s_cmp_ge_u32 s54, 4
    s_cbranch_scc1 L_young2
    s_waitcnt vmcnt(8)
    s_branch L_old2
L_young2:
    s_waitcnt vmcnt(4)
L_old2:
    v_lshlrev_b32 v48, 16, v96
    v_and_b32 v49, 0xffff0000, v96
    v_lshlrev_b32 v50, 16, v97
    v_and_b32 v51, 0xffff0000, v97
    s_lshl_b32 s30, s30, 16
    v_and_b32 v204, s30, v220
    v_and_b32 v205, s30, v220
    v_and_b32 v206, s30, v220
    v_and_b32 v207, s30, v220
    s_waitcnt lgkmcnt(0)
    v_xor_b32 v24, 0x80008000, v24
    v_xor_b32 v25, 0x80008000, v25
    v_xor_b32 v26, 0x80008000, v26
    v_xor_b32 v27, 0x80008000, v27
    v_xor_b32 v28, 0x80008000, v28
    v_xor_b32 v29, 0x80008000, v29
    v_xor_b32 v30, 0x80008000, v30
    v_xor_b32 v31, 0x80008000, v31
    v_mfma_f32_4x4x4_16b_bf16 v[56:59], v[218:219], v[4:5], 0
    v_mfma_f32_4x4x4_16b_bf16 v[68:71], v[218:219], v[12:13], 0
    v_mfma_f32_4x4x4_16b_bf16 v[60:63], v[218:219], v[6:7], 0
    v_mfma_f32_4x4x4_16b_bf16 v[72:75], v[218:219], v[14:15], 0
    v_mfma_f32_4x4x4_16b_bf16 v[56:59], v[218:219], v[8:9], v[56:59]
    v_mfma_f32_4x4x4_16b_bf16 v[60:63], v[218:219], v[10:11], v[60:63]
    v_mfma_f32_16x16x32_bf16 v[52:55], v[16:19], v[40:43], v[48:51]
    v_mfma_f32_16x16x32_bf16 v[52:55], v[20:23], v[44:47], v[52:55]
    v_mfma_f32_16x16x32_bf16 v[52:55], v[24:27], v[40:43], v[52:55]
    v_mfma_f32_16x16x32_bf16 v[52:55], v[28:31], v[44:47], v[52:55]
    v_mfma_f32_16x16x32_bf16 v[48:51], v[16:19], v[32:35], v[48:51]
    v_mfma_f32_16x16x32_bf16 v[48:51], v[20:23], v[36:39], v[48:51]
    v_mfma_f32_16x16x32_bf16 v[48:51], v[24:27], v[32:35], v[48:51]
    v_mfma_f32_16x16x32_bf16 v[48:51], v[28:31], v[36:39], v[48:51]
    v_mul_f32 v56, s92, v56
    v_mul_f32 v57, s92, v57
    v_mul_f32 v58, s92, v58
    v_mul_f32 v59, s92, v59
    v_mul_f32 v60, s92, v60
    v_mul_f32 v61, s92, v61
    v_mul_f32 v62, s92, v62
    v_mul_f32 v63, s92, v63
    v_mul_f32 v68, s92, v68
    v_mul_f32 v69, s92, v69
    v_mul_f32 v70, s92, v70
    v_mul_f32 v71, s92, v71
    v_mul_f32 v72, s92, v72
    v_mul_f32 v73, s92, v73
    v_mul_f32 v74, s92, v74
    v_mul_f32 v75, s92, v75
    s_add_u32 s66, s52, 11520
    v_add_u32 v3, s66, v2
    v_cvt_pk_bf16_f32 v68, v68, v69
    v_cvt_pk_bf16_f32 v69, v70, v71
    v_cvt_pk_bf16_f32 v70, v72, v73
    v_cvt_pk_bf16_f32 v71, v74, v75
    v_mul_f32 v48, s92, v48
    v_mul_f32 v49, s92, v49
    v_mul_f32 v50, s92, v50
    v_mul_f32 v51, s92, v51
    v_mul_f32 v52, s92, v52
    v_mul_f32 v53, s92, v53
    v_mul_f32 v54, s92, v54
    v_mul_f32 v55, s92, v55
    ds_write_b128 v3, v[56:59]
    ds_write_b128 v3, v[60:63] offset:1024
    ds_write_b128 v3, v[68:71] offset:2048
    ds_write_b128 v98, v[48:51]
    ds_write_b128 v98, v[52:55] offset:40960
    v_add_u32 v3, 11520, v2
    v_add_u32 v246, 81920, v3
    s_waitcnt lgkmcnt(0)
    s_barrier
    s_cmp_lt_u32 s54, 4
    s_cbranch_scc1 L_old3
    s_call_b64 s[62:63], L_fp
L_old3:
    s_cmp_eq_u32 s94, 0
    s_cbranch_scc1 L_skip2
    s_bitcmp0_b64 s[56:57], 3
    s_cbranch_scc1 L_noadve2
    s_sub_u32 s60, s60, 1
    s_cselect_b32 s31, 0, s31
    s_add_u32 s20, s20, s31
    s_addc_u32 s21, s21, 0
    s_xor_b32 s31, s31, 0x63ff800
L_noadve2:
    s_add_u32 m0, s52, 4160
    v_mov_b32 v230, v152
    v_mov_b32 v232, v153
    buffer_load_dwordx4 v[230:231], s[20:23], 0 idxen offen nt lds
    s_add_u32 m0, s52, 5216
    s_nop 0
    buffer_load_dwordx4 v[232:233], s[20:23], 0 idxen offen nt lds
    s_bitcmp0_b64 s[56:57], 4
    s_cbranch_scc1 L_noadve3
    s_sub_u32 s60, s60, 1
    s_cselect_b32 s31, 0, s31
    s_add_u32 s20, s20, s31
    s_addc_u32 s21, s21, 0
    s_xor_b32 s31, s31, 0x63ff800
L_noadve3:
    s_add_u32 m0, s52, 6240
    v_mov_b32 v230, v154
    v_mov_b32 v232, v155
    buffer_load_dwordx4 v[230:231], s[20:23], 0 idxen offen nt lds
    s_add_u32 m0, s52, 7296
    s_nop 0
    buffer_load_dwordx4 v[232:233], s[20:23], 0 idxen offen nt lds
L_skip2:
    ds_read_b128 v[4:7], v3 offset:0
    ds_read_b128 v[8:11], v3 offset:1024
    ds_read_b128 v[68:71], v3 offset:2048
    ds_read_b128 v[12:15], v3 offset:20480
    ds_read_b128 v[16:19], v3 offset:21504
    ds_read_b128 v[72:75], v3 offset:22528
    s_waitcnt vmcnt(8)
    s_mov_b64 exec, s[28:29]
    v_cmp_neq_f16_sdwa s[68:69], v104, 0 src0_sel:WORD_0 src1_sel:WORD_0
    v_cmp_neq_f16_sdwa s[70:71], v104, 0 src0_sel:WORD_1 src1_sel:WORD_0
    v_cmp_neq_f16_sdwa s[72:73], v105, 0 src0_sel:WORD_0 src1_sel:WORD_0
    v_cmp_neq_f16_sdwa s[74:75], v105, 0 src0_sel:WORD_1 src1_sel:WORD_0
    v_cmp_neq_f16_sdwa s[76:77], v106, 0 src0_sel:WORD_0 src1_sel:WORD_0
    v_cmp_neq_f16_sdwa s[78:79], v106, 0 src0_sel:WORD_1 src1_sel:WORD_0
    v_cmp_neq_f16_sdwa s[80:81], v107, 0 src0_sel:WORD_0 src1_sel:WORD_0
    v_cmp_neq_f16_sdwa s[82:83], v107, 0 src0_sel:WORD_1 src1_sel:WORD_0
    v_sad_u16 v147, v104, 0, v147
    v_sad_u16 v147, v105, 0, v147
    v_sad_u16 v147, v106, 0, v147
    v_sad_u16 v147, v107, 0, v147
    v_or3_b32 v146, v104, v105, v146
    v_or3_b32 v146, v106, v107, v146
    s_mov_b64 exec, -1
    v_mov_b32 v132, s64
    v_mbcnt_lo_u32_b32 v132, s68, v132
    v_mbcnt_hi_u32_b32 v132, s69, v132
    v_mbcnt_lo_u32_b32 v132, s70, v132
    v_mbcnt_hi_u32_b32 v132, s71, v132
    v_mbcnt_lo_u32_b32 v132, s72, v132
    v_mbcnt_hi_u32_b32 v132, s73, v132
    v_mbcnt_lo_u32_b32 v132, s74, v132
    v_mbcnt_hi_u32_b32 v132, s75, v132
    v_mbcnt_lo_u32_b32 v132, s76, v132
    v_mbcnt_hi_u32_b32 v132, s77, v132
    v_mbcnt_lo_u32_b32 v132, s78, v132
    v_mbcnt_hi_u32_b32 v132, s79, v132
    v_mbcnt_lo_u32_b32 v132, s80, v132
    v_mbcnt_hi_u32_b32 v132, s81, v132
    v_mbcnt_lo_u32_b32 v132, s82, v132
    v_mbcnt_hi_u32_b32 v132, s83, v132
    s_add_u32 s34, s64, 16
    v_readlane_b32 s66, v132, 25
    v_readlane_b32 s67, v132, 63
    s_add_u32 s64, s66, 15
    s_and_b32 s64, s64, -16
    s_max_u32 s64, s64, s34
    s_sub_u32 s66, s64, s66
    v_mad_u32_u24 v132, v145, s66, v132
    s_lshr_b32 s35, s64, 4
    s_bitset1_b64 s[56:57], s35
    v_addc_co_u32 v133, vcc, 0, v132, s[68:69]
    v_addc_co_u32 v134, vcc, 0, v133, s[70:71]
    v_addc_co_u32 v135, vcc, 0, v134, s[72:73]
    v_addc_co_u32 v136, vcc, 0, v135, s[74:75]
    v_addc_co_u32 v137, vcc, 0, v136, s[76:77]
    v_addc_co_u32 v138, vcc, 0, v137, s[78:79]
    v_addc_co_u32 v139, vcc, 0, v138, s[80:81]
    v_addc_co_u32 v140, vcc, 0, v139, s[82:83]
    s_add_u32 s67, s67, s66
    s_add_u32 s67, s67, 15
    s_and_b32 s67, s67, -16
    s_add_u32 s64, s64, 16
    s_max_u32 s64, s64, s67
    s_mov_b64 exec, s[68:69]
    ds_write_b8 v132, v141
    s_mov_b64 exec, s[70:71]
    ds_write_b8_d16_hi v133, v141
    s_mov_b64 exec, s[72:73]
    ds_write_b8 v134, v142
    s_mov_b64 exec, s[74:75]
    ds_write_b8_d16_hi v135, v142
    s_mov_b64 exec, s[76:77]
    ds_write_b8 v136, v143
    s_mov_b64 exec, s[78:79]
    ds_write_b8_d16_hi v137, v143
    s_mov_b64 exec, s[80:81]
    ds_write_b8 v138, v144
    s_mov_b64 exec, s[82:83]
    ds_write_b8_d16_hi v139, v144
    s_mov_b64 exec, -1
    v_sub_u32 v140, v132, v140
    s_movk_i32 s66, 0x3f80
    v_mad_i32_i24 v147, v140, s66, v147
    s_lshr_b32 s35, s64, 4
    s_bitset1_b64 s[56:57], s35
    ds_read_b128 v[20:23], v3 offset:40960
    ds_read_b128 v[24:27], v3 offset:41984
    ds_read_b128 v[76:79], v3 offset:43008
    ds_read_b128 v[28:31], v3 offset:61440
    ds_read_b128 v[32:35], v3 offset:62464
    ds_read_b128 v[80:83], v3 offset:63488
    ds_read_b128 v[36:39], v246 offset:0
    ds_read_b128 v[40:43], v246 offset:1024
    ds_read_b128 v[84:87], v246 offset:2048
    s_mov_b64 exec, s[28:29]
    v_cmp_neq_f16_sdwa s[68:69], v108, 0 src0_sel:WORD_0 src1_sel:WORD_0
    v_cmp_neq_f16_sdwa s[70:71], v108, 0 src0_sel:WORD_1 src1_sel:WORD_0
    v_cmp_neq_f16_sdwa s[72:73], v109, 0 src0_sel:WORD_0 src1_sel:WORD_0
    v_cmp_neq_f16_sdwa s[74:75], v109, 0 src0_sel:WORD_1 src1_sel:WORD_0
    v_cmp_neq_f16_sdwa s[76:77], v110, 0 src0_sel:WORD_0 src1_sel:WORD_0
    v_cmp_neq_f16_sdwa s[78:79], v110, 0 src0_sel:WORD_1 src1_sel:WORD_0
    v_cmp_neq_f16_sdwa s[80:81], v111, 0 src0_sel:WORD_0 src1_sel:WORD_0
    v_cmp_neq_f16_sdwa s[82:83], v111, 0 src0_sel:WORD_1 src1_sel:WORD_0
    v_sad_u16 v147, v108, 0, v147
    v_sad_u16 v147, v109, 0, v147
    v_sad_u16 v147, v110, 0, v147
    v_sad_u16 v147, v111, 0, v147
    v_or3_b32 v146, v108, v109, v146
    v_or3_b32 v146, v110, v111, v146
    s_mov_b64 exec, -1
    v_mov_b32 v132, s64
    v_mbcnt_lo_u32_b32 v132, s68, v132
    v_mbcnt_hi_u32_b32 v132, s69, v132
    v_mbcnt_lo_u32_b32 v132, s70, v132
    v_mbcnt_hi_u32_b32 v132, s71, v132
    v_mbcnt_lo_u32_b32 v132, s72, v132
    v_mbcnt_hi_u32_b32 v132, s73, v132
    v_mbcnt_lo_u32_b32 v132, s74, v132
    v_mbcnt_hi_u32_b32 v132, s75, v132
    v_mbcnt_lo_u32_b32 v132, s76, v132
    v_mbcnt_hi_u32_b32 v132, s77, v132
    v_mbcnt_lo_u32_b32 v132, s78, v132
    v_mbcnt_hi_u32_b32 v132, s79, v132
    v_mbcnt_lo_u32_b32 v132, s80, v132
    v_mbcnt_hi_u32_b32 v132, s81, v132
    v_mbcnt_lo_u32_b32 v132, s82, v132
    v_mbcnt_hi_u32_b32 v132, s83, v132
    s_add_u32 s34, s64, 16
    v_readlane_b32 s66, v132, 25
    v_readlane_b32 s67, v132, 63
    s_add_u32 s64, s66, 15
    s_and_b32 s64, s64, -16
    s_max_u32 s64, s64, s34
    s_sub_u32 s66, s64, s66
    v_mad_u32_u24 v132, v145, s66, v132
    s_lshr_b32 s35, s64, 4
    s_lshl_b64 s[86:87], 1, s35
    s_bitcmp1_b32 s64, 10
    s_cselect_b64 s[88:89], 0, s[86:87]
    s_cselect_b64 s[90:91], s[86:87], 0
    s_or_b64 s[56:57], s[56:57], s[88:89]
    s_or_b64 s[58:59], s[58:59], s[90:91]
    v_addc_co_u32 v133, vcc, 0, v132, s[68:69]
    v_addc_co_u32 v134, vcc, 0, v133, s[70:71]
    v_addc_co_u32 v135, vcc, 0, v134, s[72:73]
    v_addc_co_u32 v136, vcc, 0, v135, s[74:75]
    v_addc_co_u32 v137, vcc, 0, v136, s[76:77]
    v_addc_co_u32 v138, vcc, 0, v137, s[78:79]
    v_addc_co_u32 v139, vcc, 0, v138, s[80:81]
    v_addc_co_u32 v140, vcc, 0, v139, s[82:83]
    s_add_u32 s67, s67, s66
    s_add_u32 s67, s67, 15
    s_and_b32 s67, s67, -16
    s_add_u32 s64, s64, 16
    s_max_u32 s64, s64, s67
    s_mov_b64 exec, s[68:69]
    ds_write_b8 v132, v141
    s_mov_b64 exec, s[70:71]
    ds_write_b8_d16_hi v133, v141
    s_mov_b64 exec, s[72:73]
    ds_write_b8 v134, v142
    s_mov_b64 exec, s[74:75]
    ds_write_b8_d16_hi v135, v142
    s_mov_b64 exec, s[76:77]
    ds_write_b8 v136, v143
    s_mov_b64 exec, s[78:79]
    ds_write_b8_d16_hi v137, v143
    s_mov_b64 exec, s[80:81]
    ds_write_b8 v138, v144
    s_mov_b64 exec, s[82:83]
    ds_write_b8_d16_hi v139, v144
    s_mov_b64 exec, -1
    v_sub_u32 v140, v132, v140
    s_movk_i32 s66, 0x3f80
    v_mad_i32_i24 v147, v140, s66, v147
    s_lshr_b32 s35, s64, 4
    s_lshl_b64 s[86:87], 1, s35
    s_bitcmp1_b32 s64, 10
    s_cselect_b64 s[88:89], 0, s[86:87]
    s_cselect_b64 s[90:91], s[86:87], 0
    s_or_b64 s[56:57], s[56:57], s[88:89]
    s_or_b64 s[58:59], s[58:59], s[90:91]
    ds_read_b128 v[44:47], v246 offset:20480
    ds_read_b128 v[48:51], v246 offset:21504
    ds_read_b128 v[88:91], v246 offset:22528
    ds_read_b128 v[52:55], v246 offset:40960
    ds_read_b128 v[56:59], v246 offset:41984
    ds_read_b128 v[92:95], v246 offset:43008
    ds_read_b128 v[60:63], v246 offset:61440
    ds_read_b128 v[64:67], v246 offset:62464
    ds_read_b128 v[96:99], v246 offset:63488
    ds_read_u16 v224, v238 offset:0
    ds_read_u16 v225, v238 offset:8
    ds_read_u16 v226, v238 offset:64
    ds_read_u16 v227, v238 offset:72
    s_mov_b64 exec, s[28:29]
    v_cmp_neq_f16_sdwa s[68:69], v112, 0 src0_sel:WORD_0 src1_sel:WORD_0
    v_cmp_neq_f16_sdwa s[70:71], v112, 0 src0_sel:WORD_1 src1_sel:WORD_0
    v_cmp_neq_f16_sdwa s[72:73], v113, 0 src0_sel:WORD_0 src1_sel:WORD_0
    v_cmp_neq_f16_sdwa s[74:75], v113, 0 src0_sel:WORD_1 src1_sel:WORD_0
    v_cmp_neq_f16_sdwa s[76:77], v114, 0 src0_sel:WORD_0 src1_sel:WORD_0
    v_cmp_neq_f16_sdwa s[78:79], v114, 0 src0_sel:WORD_1 src1_sel:WORD_0
    v_cmp_neq_f16_sdwa s[80:81], v115, 0 src0_sel:WORD_0 src1_sel:WORD_0
    v_cmp_neq_f16_sdwa s[82:83], v115, 0 src0_sel:WORD_1 src1_sel:WORD_0
    v_sad_u16 v147, v112, 0, v147
    v_sad_u16 v147, v113, 0, v147
    v_sad_u16 v147, v114, 0, v147
    v_sad_u16 v147, v115, 0, v147
    v_or3_b32 v146, v112, v113, v146
    v_or3_b32 v146, v114, v115, v146
    s_mov_b64 exec, -1
    v_mov_b32 v132, s64
    v_mbcnt_lo_u32_b32 v132, s68, v132
    v_mbcnt_hi_u32_b32 v132, s69, v132
    v_mbcnt_lo_u32_b32 v132, s70, v132
    v_mbcnt_hi_u32_b32 v132, s71, v132
    v_mbcnt_lo_u32_b32 v132, s72, v132
    v_mbcnt_hi_u32_b32 v132, s73, v132
    v_mbcnt_lo_u32_b32 v132, s74, v132
    v_mbcnt_hi_u32_b32 v132, s75, v132
    v_mbcnt_lo_u32_b32 v132, s76, v132
    v_mbcnt_hi_u32_b32 v132, s77, v132
    v_mbcnt_lo_u32_b32 v132, s78, v132
    v_mbcnt_hi_u32_b32 v132, s79, v132
    v_mbcnt_lo_u32_b32 v132, s80, v132
    v_mbcnt_hi_u32_b32 v132, s81, v132
    v_mbcnt_lo_u32_b32 v132, s82, v132
    v_mbcnt_hi_u32_b32 v132, s83, v132
    s_add_u32 s34, s64, 16
    v_readlane_b32 s66, v132, 25
    v_readlane_b32 s67, v132, 63
    s_add_u32 s64, s66, 15
    s_and_b32 s64, s64, -16
    s_max_u32 s64, s64, s34
    s_sub_u32 s66, s64, s66
    v_mad_u32_u24 v132, v145, s66, v132
    s_lshr_b32 s35, s64, 4
    s_lshl_b64 s[86:87], 1, s35
    s_bitcmp1_b32 s64, 10
    s_cselect_b64 s[88:89], 0, s[86:87]
    s_cselect_b64 s[90:91], s[86:87], 0
    s_or_b64 s[56:57], s[56:57], s[88:89]
    s_or_b64 s[58:59], s[58:59], s[90:91]
    v_addc_co_u32 v133, vcc, 0, v132, s[68:69]
    v_addc_co_u32 v134, vcc, 0, v133, s[70:71]
    v_addc_co_u32 v135, vcc, 0, v134, s[72:73]
    v_addc_co_u32 v136, vcc, 0, v135, s[74:75]
    v_addc_co_u32 v137, vcc, 0, v136, s[76:77]
    v_addc_co_u32 v138, vcc, 0, v137, s[78:79]
    v_addc_co_u32 v139, vcc, 0, v138, s[80:81]
    v_addc_co_u32 v140, vcc, 0, v139, s[82:83]
    s_add_u32 s67, s67, s66
    s_add_u32 s67, s67, 15
    s_and_b32 s67, s67, -16
    s_add_u32 s64, s64, 16
    s_max_u32 s64, s64, s67
    s_mov_b64 exec, s[68:69]
    ds_write_b8 v132, v141
    s_mov_b64 exec, s[70:71]
    ds_write_b8_d16_hi v133, v141
    s_mov_b64 exec, s[72:73]
    ds_write_b8 v134, v142
    s_mov_b64 exec, s[74:75]
    ds_write_b8_d16_hi v135, v142
    s_mov_b64 exec, s[76:77]
    ds_write_b8 v136, v143
    s_mov_b64 exec, s[78:79]
    ds_write_b8_d16_hi v137, v143
    s_mov_b64 exec, s[80:81]
    ds_write_b8 v138, v144
    s_mov_b64 exec, s[82:83]
    ds_write_b8_d16_hi v139, v144
    s_mov_b64 exec, -1
    v_sub_u32 v140, v132, v140
    s_movk_i32 s66, 0x3f80
    v_mad_i32_i24 v147, v140, s66, v147
    s_lshr_b32 s35, s64, 4
    s_lshl_b64 s[86:87], 1, s35
    s_bitcmp1_b32 s64, 10
    s_cselect_b64 s[88:89], 0, s[86:87]
    s_cselect_b64 s[90:91], s[86:87], 0
    s_or_b64 s[56:57], s[56:57], s[88:89]
    s_or_b64 s[58:59], s[58:59], s[90:91]
    s_mov_b32 s66, 0xc07fc07f
    v_and_or_b32 v146, v146, s66, v147
    v_cmp_ne_u32 s[84:85], 0, v146
    s_sub_u32 s66, s64, s52
    s_sub_u32 s66, s66, 18448
    s_lshr_b32 s66, s66, 3
    s_xor_b32 s66, s66, s33
    s_sub_u32 s66, s66, s33
    s_xor_b32 s67, 0xfffffffc, s33
    s_sub_u32 s67, s67, s33
    v_mov_b32 v2, v221
    v_mov_b32 v1, s66
    v_mov_b32 v3, s67
    s_mov_b64 exec, 1
    ds_add_u32 v2, v1
    s_mov_b64 exec, -1
    s_cmp_eq_u32 s94, 1
    s_cbranch_scc1 L_nolate
    ds_read_u8 v148, v237 offset:0
    ds_read_u8 v149, v237 offset:8
    ds_read_u8 v150, v237 offset:16
    ds_read_u8 v151, v237 offset:24
    ds_read_u8 v152, v237 offset:32
    ds_read_u8 v153, v237 offset:40
    ds_read_u8 v154, v237 offset:48
    ds_read_u8 v155, v237 offset:56
    s_waitcnt lgkmcnt(0)
    s_add_u32 m0, s52, 0
    v_mov_b32 v230, v148
    v_mov_b32 v232, v149
    buffer_load_dwordx4 v[230:231], s[20:23], 0 idxen offen nt lds
    s_add_u32 m0, s52, 1056
    s_nop 0
    buffer_load_dwordx4 v[232:233], s[20:23], 0 idxen offen nt lds
    s_bitcmp0_b64 s[56:57], 2
    s_cbranch_scc1 L_noadvl1
    s_sub_u32 s60, s60, 1
    s_cselect_b32 s31, 0, s31
    s_add_u32 s20, s20, s31
    s_addc_u32 s21, s21, 0
    s_xor_b32 s31, s31, 0x63ff800
L_noadvl1:
    s_add_u32 m0, s52, 2080
    v_mov_b32 v230, v150
    v_mov_b32 v232, v151
    buffer_load_dwordx4 v[230:231], s[20:23], 0 idxen offen nt lds
    s_add_u32 m0, s52, 3136
    s_nop 0
    buffer_load_dwordx4 v[232:233], s[20:23], 0 idxen offen nt lds
    s_bitcmp0_b64 s[56:57], 3
    s_cbranch_scc1 L_noadvl2
    s_sub_u32 s60, s60, 1
    s_cselect_b32 s31, 0, s31
    s_add_u32 s20, s20, s31
    s_addc_u32 s21, s21, 0
    s_xor_b32 s31, s31, 0x63ff800
L_noadvl2:
    s_add_u32 m0, s52, 4160
    v_mov_b32 v230, v152
    v_mov_b32 v232, v153
    buffer_load_dwordx4 v[230:231], s[20:23], 0 idxen offen nt lds
    s_add_u32 m0, s52, 5216
    s_nop 0
    buffer_load_dwordx4 v[232:233], s[20:23], 0 idxen offen nt lds
    s_bitcmp0_b64 s[56:57], 4
    s_cbranch_scc1 L_noadvl3
    s_sub_u32 s60, s60, 1
    s_cselect_b32 s31, 0, s31
    s_add_u32 s20, s20, s31
    s_addc_u32 s21, s21, 0
    s_xor_b32 s31, s31, 0x63ff800
L_noadvl3:
    s_add_u32 m0, s52, 6240
    v_mov_b32 v230, v154
    v_mov_b32 v232, v155
    buffer_load_dwordx4 v[230:231], s[20:23], 0 idxen offen nt lds
    s_add_u32 m0, s52, 7296
    s_nop 0
    buffer_load_dwordx4 v[232:233], s[20:23], 0 idxen offen nt lds
L_nolate:
    v_and_b32_dpp v196, v216, v220 quad_perm:[0,0,0,0] row_mask:0xf bank_mask:0xf
    v_and_b32_dpp v197, v217, v220 quad_perm:[0,0,0,0] row_mask:0xf bank_mask:0xf
    v_and_b32_dpp v198, v216, v220 quad_perm:[1,1,1,1] row_mask:0xf bank_mask:0xf
    v_and_b32_dpp v199, v217, v220 quad_perm:[1,1,1,1] row_mask:0xf bank_mask:0xf
    v_and_b32_dpp v200, v216, v220 quad_perm:[2,2,2,2] row_mask:0xf bank_mask:0xf
    v_and_b32_dpp v201, v217, v220 quad_perm:[2,2,2,2] row_mask:0xf bank_mask:0xf
    v_and_b32_dpp v202, v216, v220 quad_perm:[3,3,3,3] row_mask:0xf bank_mask:0xf
    v_and_b32_dpp v203, v217, v220 quad_perm:[3,3,3,3] row_mask:0xf bank_mask:0xf
    s_waitcnt vmcnt(6) lgkmcnt(0)
    ds_read_b128 v[180:183], v234 offset:0
    ds_read_b128 v[184:187], v235 offset:0
    v_mul_u32_u24 v216, v224, v241
    v_mul_u32_u24 v217, v224, v242
    v_mul_u32_u24 v218, v225, v241
    v_mul_u32_u24 v219, v225, v242
    v_mul_u32_u24 v220, v226, v241
    v_mul_u32_u24 v221, v226, v242
    v_mul_u32_u24 v222, v227, v241
    v_mul_u32_u24 v223, v227, v242
    v_add_u32 v238, 128, v238
    ds_read_b128 v[164:167], v239
    v_mfma_f32_4x4x4_16b_bf16 v[132:135], v[216:217], v[68:69], v[4:7]
    ds_read_b128 v[168:171], v239 offset:64
    ds_read_b128 v[172:175], v239 offset:128
    v_mfma_f32_4x4x4_16b_bf16 v[136:139], v[218:219], v[70:71], v[8:11]
    ds_read_b128 v[176:179], v239 offset:192
    ds_read_u16 v224, v238
    v_mfma_f32_4x4x4_16b_bf16 v[140:143], v[220:221], v[72:73], v[12:15]
    ds_read_u16 v225, v238 offset:8
    ds_read_u16 v226, v238 offset:64
    v_mfma_f32_4x4x4_16b_bf16 v[144:147], v[222:223], v[74:75], v[16:19]
    ds_read_u16 v227, v238 offset:72
    v_add_u32 v239, 272, v239
    v_mfma_f32_4x4x4_16b_bf16 v[246:249], v[216:217], v[76:77], v[20:23]
    v_cvt_pk_bf16_f32 v100, v132, v133
    v_cvt_pk_bf16_f32 v101, v134, v135
    v_mfma_f32_4x4x4_16b_bf16 v[250:253], v[218:219], v[78:79], v[24:27]
    v_cvt_pk_bf16_f32 v102, v136, v137
    v_cvt_pk_bf16_f32 v103, v138, v139
    v_mfma_f32_4x4x4_16b_bf16 v[132:135], v[220:221], v[80:81], v[28:31]
    v_cvt_pk_bf16_f32 v104, v140, v141
    v_cvt_pk_bf16_f32 v105, v142, v143
    v_mfma_f32_4x4x4_16b_bf16 v[136:139], v[222:223], v[82:83], v[32:35]
    v_cvt_pk_bf16_f32 v106, v144, v145
    v_cvt_pk_bf16_f32 v107, v146, v147
    v_mfma_f32_4x4x4_16b_bf16 v[140:143], v[216:217], v[84:85], v[36:39]
    v_cvt_pk_bf16_f32 v108, v246, v247
    v_cvt_pk_bf16_f32 v109, v248, v249
    v_mfma_f32_4x4x4_16b_bf16 v[144:147], v[218:219], v[86:87], v[40:43]
    v_cvt_pk_bf16_f32 v110, v250, v251
    v_cvt_pk_bf16_f32 v111, v252, v253
    v_mfma_f32_4x4x4_16b_bf16 v[246:249], v[220:221], v[88:89], v[44:47]
    v_cvt_pk_bf16_f32 v112, v132, v133
    v_cvt_pk_bf16_f32 v113, v134, v135
    v_mfma_f32_4x4x4_16b_bf16 v[250:253], v[222:223], v[90:91], v[48:51]
    v_cvt_pk_bf16_f32 v114, v136, v137
    v_cvt_pk_bf16_f32 v115, v138, v139
    v_mfma_f32_4x4x4_16b_bf16 v[132:135], v[216:217], v[92:93], v[52:55]
    v_cvt_pk_bf16_f32 v116, v140, v141
    v_cvt_pk_bf16_f32 v117, v142, v143
    v_mfma_f32_4x4x4_16b_bf16 v[136:139], v[218:219], v[94:95], v[56:59]
    v_cvt_pk_bf16_f32 v118, v144, v145
    v_cvt_pk_bf16_f32 v119, v146, v147
    v_mfma_f32_4x4x4_16b_bf16 v[140:143], v[220:221], v[96:97], v[60:63]
    v_cvt_pk_bf16_f32 v120, v246, v247
    v_cvt_pk_bf16_f32 v121, v248, v249
    v_mfma_f32_4x4x4_16b_bf16 v[144:147], v[222:223], v[98:99], v[64:67]
    v_cvt_pk_bf16_f32 v122, v250, v251
    v_cvt_pk_bf16_f32 v123, v252, v253
    v_cvt_pk_bf16_f32 v124, v132, v133
    v_cvt_pk_bf16_f32 v125, v134, v135
    v_cvt_pk_bf16_f32 v126, v136, v137
    v_cvt_pk_bf16_f32 v127, v138, v139
    v_cvt_pk_bf16_f32 v128, v140, v141
    v_cvt_pk_bf16_f32 v129, v142, v143
    v_cvt_pk_bf16_f32 v130, v144, v145
    v_cvt_pk_bf16_f32 v131, v146, v147
    s_waitcnt lgkmcnt(0)
    v_mfma_f32_16x16x32_bf16 v[148:151], v[100:103], v[180:183], v[164:167]
    v_mfma_f32_16x16x32_bf16 v[148:151], v[104:107], v[184:187], v[148:151]
    v_mfma_f32_16x16x32_bf16 v[152:155], v[108:111], v[180:183], v[168:171]
    v_mfma_f32_16x16x32_bf16 v[152:155], v[112:115], v[184:187], v[152:155]
    v_mfma_f32_16x16x32_bf16 v[156:159], v[116:119], v[180:183], v[172:175]
    v_mfma_f32_16x16x32_bf16 v[156:159], v[120:123], v[184:187], v[156:159]
    v_mfma_f32_16x16x32_bf16 v[160:163], v[124:127], v[180:183], v[176:179]
    v_mfma_f32_16x16x32_bf16 v[160:163], v[128:131], v[184:187], v[160:163]
    s_waitcnt vmcnt(4)
    ds_read_b128 v[180:183], v234 offset:2080
    ds_read_b128 v[184:187], v235 offset:2080
    ds_read_u8 v230, v237 offset:64
    ds_read_u8 v232, v237 offset:72
    s_lshr_b64 s[86:87], s[56:57], 2
    s_lshr_b64 s[36:37], s[56:57], 5
    s_or_b32 s36, s36, s86
    s_or_b32 s36, s36, s56
    s_cmp_lg_u64 s[84:85], 0
    s_cbranch_scc0 Lf_mid
    s_mul_i32 s66, s53, 800
    s_add_u32 s8, s8, s66
    s_addc_u32 s9, s9, 0
    s_mov_b32 s24, s8
    s_and_b32 s25, s9, 0xffff
    s_mov_b32 s26, 400
    s_mov_b32 s27, 0x20000
    s_movk_i32 s32, 400
    s_branch Ls_mid
L_fp:
    s_mov_b64 exec, s[28:29]
    v_cmp_neq_f16_sdwa s[68:69], v100, 0 src0_sel:WORD_0 src1_sel:WORD_0
    v_cmp_neq_f16_sdwa s[70:71], v100, 0 src0_sel:WORD_1 src1_sel:WORD_0
    v_cmp_neq_f16_sdwa s[72:73], v101, 0 src0_sel:WORD_0 src1_sel:WORD_0
    v_cmp_neq_f16_sdwa s[74:75], v101, 0 src0_sel:WORD_1 src1_sel:WORD_0
    v_cmp_neq_f16_sdwa s[76:77], v102, 0 src0_sel:WORD_0 src1_sel:WORD_0
    v_cmp_neq_f16_sdwa s[78:79], v102, 0 src0_sel:WORD_1 src1_sel:WORD_0
    v_cmp_neq_f16_sdwa s[80:81], v103, 0 src0_sel:WORD_0 src1_sel:WORD_0
    v_cmp_neq_f16_sdwa s[82:83], v103, 0 src0_sel:WORD_1 src1_sel:WORD_0
    v_sad_u16 v147, v100, 0, v147
    v_sad_u16 v147, v101, 0, v147
    v_sad_u16 v147, v102, 0, v147
    v_sad_u16 v147, v103, 0, v147
    v_or3_b32 v146, v100, v101, v146
    v_or3_b32 v146, v102, v103, v146
    s_mov_b64 exec, -1
    v_mov_b32 v132, s64
    v_mbcnt_lo_u32_b32 v132, s68, v132
    v_mbcnt_hi_u32_b32 v132, s69, v132
    v_mbcnt_lo_u32_b32 v132, s70, v132
    v_mbcnt_hi_u32_b32 v132, s71, v132
    v_mbcnt_lo_u32_b32 v132, s72, v132
    v_mbcnt_hi_u32_b32 v132, s73, v132
    v_mbcnt_lo_u32_b32 v132, s74, v132
    v_mbcnt_hi_u32_b32 v132, s75, v132
    v_mbcnt_lo_u32_b32 v132, s76, v132
    v_mbcnt_hi_u32_b32 v132, s77, v132
    v_mbcnt_lo_u32_b32 v132, s78, v132
    v_mbcnt_hi_u32_b32 v132, s79, v132
    v_mbcnt_lo_u32_b32 v132, s80, v132
    v_mbcnt_hi_u32_b32 v132, s81, v132
    v_mbcnt_lo_u32_b32 v132, s82, v132
    v_mbcnt_hi_u32_b32 v132, s83, v132
    s_add_u32 s34, s64, 16
    v_readlane_b32 s66, v132, 25
    v_readlane_b32 s67, v132, 63
    s_add_u32 s64, s66, 15
    s_and_b32 s64, s64, -16
    s_max_u32 s64, s64, s34
    s_sub_u32 s66, s64, s66
    v_mad_u32_u24 v132, v145, s66, v132
    s_lshr_b32 s35, s64, 4
    s_bitset1_b64 s[56:57], s35
    v_addc_co_u32 v133, vcc, 0, v132, s[68:69]
    v_addc_co_u32 v134, vcc, 0, v133, s[70:71]
    v_addc_co_u32 v135, vcc, 0, v134, s[72:73]
    v_addc_co_u32 v136, vcc, 0, v135, s[74:75]
    v_addc_co_u32 v137, vcc, 0, v136, s[76:77]
    v_addc_co_u32 v138, vcc, 0, v137, s[78:79]
    v_addc_co_u32 v139, vcc, 0, v138, s[80:81]
    v_addc_co_u32 v140, vcc, 0, v139, s[82:83]
    s_add_u32 s67, s67, s66
    s_add_u32 s67, s67, 15
    s_and_b32 s67, s67, -16
    s_add_u32 s64, s64, 16
    s_max_u32 s64, s64, s67
    s_mov_b64 exec, s[68:69]
    ds_write_b8 v132, v141
    s_mov_b64 exec, s[70:71]
    ds_write_b8_d16_hi v133, v141
    s_mov_b64 exec, s[72:73]
    ds_write_b8 v134, v142
    s_mov_b64 exec, s[74:75]
    ds_write_b8_d16_hi v135, v142
    s_mov_b64 exec, s[76:77]
    ds_write_b8 v136, v143
    s_mov_b64 exec, s[78:79]
    ds_write_b8_d16_hi v137, v143
    s_mov_b64 exec, s[80:81]
    ds_write_b8 v138, v144
    s_mov_b64 exec, s[82:83]
    ds_write_b8_d16_hi v139, v144
    s_mov_b64 exec, -1
    v_sub_u32 v140, v132, v140
    s_movk_i32 s66, 0x3f80
    v_mad_i32_i24 v147, v140, s66, v147
    s_lshr_b32 s35, s64, 4
    s_bitset1_b64 s[56:57], s35
    s_add_u32 s66, s52, 18512
    s_cmp_ge_u32 s64, s66
    s_cselect_b32 s94, 1, 0
    s_cbranch_scc1 L_early
    s_waitcnt vmcnt(0)
L_early:
    ds_read_u8 v148, v237 offset:0
    ds_read_u8 v149, v237 offset:8
    ds_read_u8 v150, v237 offset:16
    ds_read_u8 v151, v237 offset:24
    ds_read_u8 v152, v237 offset:32
    ds_read_u8 v153, v237 offset:40
    ds_read_u8 v154, v237 offset:48
    ds_read_u8 v155, v237 offset:56
    s_waitcnt lgkmcnt(0)
    s_cmp_eq_u32 s94, 0
    s_cbranch_scc1 L_skip0
    s_add_u32 m0, s52, 0
    v_mov_b32 v230, v148
    v_mov_b32 v232, v149
    buffer_load_dwordx4 v[230:231], s[20:23], 0 idxen offen nt lds
    s_add_u32 m0, s52, 1056
    s_nop 0
    buffer_load_dwordx4 v[232:233], s[20:23], 0 idxen offen nt lds
    s_bitcmp0_b64 s[56:57], 2
    s_cbranch_scc1 L_noadve1
    s_sub_u32 s60, s60, 1
    s_cselect_b32 s31, 0, s31
    s_add_u32 s20, s20, s31
    s_addc_u32 s21, s21, 0
    s_xor_b32 s31, s31, 0x63ff800
L_noadve1:
    s_add_u32 m0, s52, 2080
    v_mov_b32 v230, v150
    v_mov_b32 v232, v151
    buffer_load_dwordx4 v[230:231], s[20:23], 0 idxen offen nt lds
    s_add_u32 m0, s52, 3136
    s_nop 0
    buffer_load_dwordx4 v[232:233], s[20:23], 0 idxen offen nt lds
L_skip0:
    s_setpc_b64 s[62:63]
Lf_loop:
    ds_read_u8 v230, v237 offset:64
    ds_read_u8 v232, v237 offset:72
    v_mfma_f32_16x16x32_bf16 v[208:211], v[136:139], v[200:203], v[208:211]
Lf_mid:
    s_bitcmp1_b32 s36, 0
    s_cbranch_scc1 Lf_ev0
Lf_evd0:
    s_mov_b64 exec, 1
    ds_add_rtn_u32 v1, v2, v3
    s_mov_b64 exec, -1
    v_exp_f32 v132, v148
    v_exp_f32 v133, v149
    v_exp_f32 v134, v150
    v_exp_f32 v135, v151
    v_exp_f32 v136, v152
    v_exp_f32 v137, v153
    v_mfma_f32_4x4x4_16b_bf16 v[132:135], v[228:229], v[228:229], v[132:135]
    v_cvt_pk_bf16_f32 v208, v208, v209
    v_cvt_pk_bf16_f32 v209, v210, v211
    s_waitcnt lgkmcnt(2)
    v_mfma_f32_16x16x32_bf16 v[148:151], v[100:103], v[180:183], v[164:167]
    v_exp_f32 v138, v154
    v_mfma_f32_4x4x4_16b_bf16 v[212:215], v[208:209], v[188:189], v[212:215] cbsz:4 abid:0
    ds_read_b64_tr_b16 v[188:189], v236 offset:0
    v_exp_f32 v139, v155
    v_mfma_f32_16x16x32_bf16 v[152:155], v[108:111], v[180:183], v[168:171]
    v_exp_f32 v140, v156
    v_mfma_f32_4x4x4_16b_bf16 v[212:215], v[208:209], v[190:191], v[212:215] cbsz:4 abid:4
    ds_read_b64_tr_b16 v[190:191], v236 offset:512
    v_mfma_f32_4x4x4_16b_bf16 v[136:139], v[228:229], v[228:229], v[136:139]
    v_rcp_f32 v132, v132
    v_mfma_f32_4x4x4_16b_bf16 v[212:215], v[208:209], v[192:193], v[212:215] cbsz:4 abid:8
    ds_read_b64_tr_b16 v[192:193], v236 offset:1056
    v_exp_f32 v141, v157
    v_mfma_f32_16x16x32_bf16 v[148:151], v[104:107], v[184:187], v[148:151]
    v_rcp_f32 v133, v133
    v_mfma_f32_4x4x4_16b_bf16 v[212:215], v[208:209], v[194:195], v[212:215] cbsz:4 abid:12
    ds_read_b64_tr_b16 v[194:195], v236 offset:1568
    v_exp_f32 v142, v158
    v_mfma_f32_16x16x32_bf16 v[152:155], v[112:115], v[184:187], v[152:155]
    v_rcp_f32 v134, v134
    v_exp_f32 v143, v159
    v_rcp_f32 v135, v135
    v_cvt_pk_bf16_f32 v132, v132, v133
    v_mfma_f32_4x4x4_16b_bf16 v[140:143], v[228:229], v[228:229], v[140:143]
    v_exp_f32 v144, v160
    v_mfma_f32_16x16x32_bf16 v[156:159], v[116:119], v[180:183], v[172:175]
    v_rcp_f32 v136, v136
    v_cvt_pk_bf16_f32 v133, v134, v135
    v_exp_f32 v145, v161
    v_rcp_f32 v137, v137
    v_exp_f32 v146, v162
    v_rcp_f32 v138, v138
    v_cvt_pk_bf16_f32 v134, v136, v137
    v_exp_f32 v147, v163
    v_mfma_f32_16x16x32_bf16 v[160:163], v[124:127], v[180:183], v[176:179]
    s_waitcnt lgkmcnt(0)
    s_add_u32 m0, s52, 0
    v_rcp_f32 v139, v139
    buffer_load_dwordx4 v[230:231], s[20:23], 0 idxen offen nt lds
    v_mfma_f32_4x4x4_16b_bf16 v[144:147], v[228:229], v[228:229], v[144:147]
    v_mfma_f32_16x16x32_bf16 v[156:159], v[120:123], v[184:187], v[156:159]
    s_add_u32 m0, s52, 1056
    v_rcp_f32 v140, v140
    buffer_load_dwordx4 v[232:233], s[20:23], 0 idxen offen nt lds
    v_mfma_f32_16x16x32_bf16 v[160:163], v[128:131], v[184:187], v[160:163]
    v_readfirstlane_b32 s66, v1
    s_setprio 0
    s_xor_b32 s66, s66, s33
    s_cmp_gt_i32 s66, 0
    s_cbranch_scc0 Lf_lo0
    s_setprio 1
Lf_lo0:
    v_rcp_f32 v141, v141
    v_cvt_pk_bf16_f32 v135, v138, v139
    s_waitcnt vmcnt(4)
    ds_read_b128 v[180:183], v234 offset:4160
    ds_read_b128 v[184:187], v235 offset:4160
    v_rcp_f32 v142, v142
    v_cvt_pk_bf16_f32 v136, v140, v141
    v_mfma_f32_16x16x32_bf16 v[208:211], v[132:135], v[196:199], v[204:207]
    v_rcp_f32 v143, v143
    v_rcp_f32 v144, v144
    v_cvt_pk_bf16_f32 v137, v142, v143
    v_rcp_f32 v145, v145
    v_rcp_f32 v146, v146
    v_rcp_f32 v147, v147
    v_cvt_pk_bf16_f32 v138, v144, v145
    v_cvt_pk_bf16_f32 v139, v146, v147
    ds_read_u8 v230, v237 offset:80
    ds_read_u8 v232, v237 offset:88
    v_mfma_f32_16x16x32_bf16 v[208:211], v[136:139], v[200:203], v[208:211]
    s_bitcmp1_b32 s36, 1
    s_cbranch_scc1 Lf_ev1
Lf_evd1:
    v_exp_f32 v132, v148
    v_exp_f32 v133, v149
    v_exp_f32 v134, v150
    v_exp_f32 v135, v151
    v_exp_f32 v136, v152
    v_exp_f32 v137, v153
    v_mfma_f32_4x4x4_16b_bf16 v[132:135], v[228:229], v[228:229], v[132:135]
    v_cvt_pk_bf16_f32 v208, v208, v209
    v_cvt_pk_bf16_f32 v209, v210, v211
    s_waitcnt lgkmcnt(2)
    v_mfma_f32_16x16x32_bf16 v[148:151], v[100:103], v[180:183], v[164:167]
    v_exp_f32 v138, v154
    v_mfma_f32_4x4x4_16b_bf16 v[212:215], v[208:209], v[188:189], v[212:215] cbsz:4 abid:0
    ds_read_b64_tr_b16 v[188:189], v236 offset:2080
    v_exp_f32 v139, v155
    v_mfma_f32_16x16x32_bf16 v[152:155], v[108:111], v[180:183], v[168:171]
    v_exp_f32 v140, v156
    v_mfma_f32_4x4x4_16b_bf16 v[212:215], v[208:209], v[190:191], v[212:215] cbsz:4 abid:4
    ds_read_b64_tr_b16 v[190:191], v236 offset:2592
    v_mfma_f32_4x4x4_16b_bf16 v[136:139], v[228:229], v[228:229], v[136:139]
    v_rcp_f32 v132, v132
    v_mfma_f32_4x4x4_16b_bf16 v[212:215], v[208:209], v[192:193], v[212:215] cbsz:4 abid:8
    ds_read_b64_tr_b16 v[192:193], v236 offset:3136
    v_exp_f32 v141, v157
    v_mfma_f32_16x16x32_bf16 v[148:151], v[104:107], v[184:187], v[148:151]
    v_rcp_f32 v133, v133
    v_mfma_f32_4x4x4_16b_bf16 v[212:215], v[208:209], v[194:195], v[212:215] cbsz:4 abid:12
    ds_read_b64_tr_b16 v[194:195], v236 offset:3648
    v_exp_f32 v142, v158
    v_mfma_f32_16x16x32_bf16 v[152:155], v[112:115], v[184:187], v[152:155]
    v_rcp_f32 v134, v134
    v_exp_f32 v143, v159
    v_rcp_f32 v135, v135
    v_cvt_pk_bf16_f32 v132, v132, v133
    v_mfma_f32_4x4x4_16b_bf16 v[140:143], v[228:229], v[228:229], v[140:143]
    v_exp_f32 v144, v160
    v_mfma_f32_16x16x32_bf16 v[156:159], v[116:119], v[180:183], v[172:175]
    v_rcp_f32 v136, v136
    v_cvt_pk_bf16_f32 v133, v134, v135
    v_exp_f32 v145, v161
    v_rcp_f32 v137, v137
    v_exp_f32 v146, v162
    v_rcp_f32 v138, v138
    v_cvt_pk_bf16_f32 v134, v136, v137
    v_exp_f32 v147, v163
    v_mfma_f32_16x16x32_bf16 v[160:163], v[124:127], v[180:183], v[176:179]
    s_waitcnt lgkmcnt(0)
    s_add_u32 m0, s52, 2080
    v_rcp_f32 v139, v139
    buffer_load_dwordx4 v[230:231], s[20:23], 0 idxen offen nt lds
    v_mfma_f32_4x4x4_16b_bf16 v[144:147], v[228:229], v[228:229], v[144:147]
    v_mfma_f32_16x16x32_bf16 v[156:159], v[120:123], v[184:187], v[156:159]
    s_add_u32 m0, s52, 3136
    v_rcp_f32 v140, v140
    buffer_load_dwordx4 v[232:233], s[20:23], 0 idxen offen nt lds
    v_mfma_f32_16x16x32_bf16 v[160:163], v[128:131], v[184:187], v[160:163]
    v_rcp_f32 v141, v141
    v_cvt_pk_bf16_f32 v135, v138, v139
    s_waitcnt vmcnt(4)
    ds_read_b128 v[180:183], v234 offset:6240
    ds_read_b128 v[184:187], v235 offset:6240
    v_rcp_f32 v142, v142
    v_cvt_pk_bf16_f32 v136, v140, v141
    v_mfma_f32_16x16x32_bf16 v[208:211], v[132:135], v[196:199], v[204:207]
    v_rcp_f32 v143, v143
    v_rcp_f32 v144, v144
    v_cvt_pk_bf16_f32 v137, v142, v143
    v_rcp_f32 v145, v145
    v_rcp_f32 v146, v146
    v_rcp_f32 v147, v147
    v_cvt_pk_bf16_f32 v138, v144, v145
    v_cvt_pk_bf16_f32 v139, v146, v147
    ds_read_u8 v230, v237 offset:96
    ds_read_u8 v232, v237 offset:104
    v_mfma_f32_16x16x32_bf16 v[208:211], v[136:139], v[200:203], v[208:211]
    s_bitcmp1_b32 s36, 2
    s_cbranch_scc1 Lf_ev2
Lf_evd2:
    s_mov_b64 exec, 1
    ds_add_rtn_u32 v1, v2, v3
    s_mov_b64 exec, -1
    v_exp_f32 v132, v148
    v_exp_f32 v133, v149
    v_exp_f32 v134, v150
    v_exp_f32 v135, v151
    v_exp_f32 v136, v152
    v_exp_f32 v137, v153
    v_mfma_f32_4x4x4_16b_bf16 v[132:135], v[228:229], v[228:229], v[132:135]
    v_cvt_pk_bf16_f32 v208, v208, v209
    v_cvt_pk_bf16_f32 v209, v210, v211
    s_waitcnt lgkmcnt(2)
    v_mfma_f32_16x16x32_bf16 v[148:151], v[100:103], v[180:183], v[164:167]
    v_exp_f32 v138, v154
    v_mfma_f32_4x4x4_16b_bf16 v[212:215], v[208:209], v[188:189], v[212:215] cbsz:4 abid:0
    ds_read_b64_tr_b16 v[188:189], v236 offset:4160
    v_exp_f32 v139, v155
    v_mfma_f32_16x16x32_bf16 v[152:155], v[108:111], v[180:183], v[168:171]
    v_exp_f32 v140, v156
    v_mfma_f32_4x4x4_16b_bf16 v[212:215], v[208:209], v[190:191], v[212:215] cbsz:4 abid:4
    ds_read_b64_tr_b16 v[190:191], v236 offset:4672
    v_mfma_f32_4x4x4_16b_bf16 v[136:139], v[228:229], v[228:229], v[136:139]
    v_rcp_f32 v132, v132
    v_mfma_f32_4x4x4_16b_bf16 v[212:215], v[208:209], v[192:193], v[212:215] cbsz:4 abid:8
    ds_read_b64_tr_b16 v[192:193], v236 offset:5216
    v_exp_f32 v141, v157
    v_mfma_f32_16x16x32_bf16 v[148:151], v[104:107], v[184:187], v[148:151]
    v_rcp_f32 v133, v133
    v_mfma_f32_4x4x4_16b_bf16 v[212:215], v[208:209], v[194:195], v[212:215] cbsz:4 abid:12
    ds_read_b64_tr_b16 v[194:195], v236 offset:5728
    v_exp_f32 v142, v158
    v_mfma_f32_16x16x32_bf16 v[152:155], v[112:115], v[184:187], v[152:155]
    v_rcp_f32 v134, v134
    v_exp_f32 v143, v159
    v_rcp_f32 v135, v135
    v_cvt_pk_bf16_f32 v132, v132, v133
    v_mfma_f32_4x4x4_16b_bf16 v[140:143], v[228:229], v[228:229], v[140:143]
    v_exp_f32 v144, v160
    v_mfma_f32_16x16x32_bf16 v[156:159], v[116:119], v[180:183], v[172:175]
    v_rcp_f32 v136, v136
    v_cvt_pk_bf16_f32 v133, v134, v135
    v_exp_f32 v145, v161
    v_rcp_f32 v137, v137
    v_exp_f32 v146, v162
    v_rcp_f32 v138, v138
    v_cvt_pk_bf16_f32 v134, v136, v137
    v_exp_f32 v147, v163
    v_mfma_f32_16x16x32_bf16 v[160:163], v[124:127], v[180:183], v[176:179]
    s_waitcnt lgkmcnt(0)
    s_add_u32 m0, s52, 4160
    v_rcp_f32 v139, v139
    buffer_load_dwordx4 v[230:231], s[20:23], 0 idxen offen nt lds
    v_mfma_f32_4x4x4_16b_bf16 v[144:147], v[228:229], v[228:229], v[144:147]
    v_mfma_f32_16x16x32_bf16 v[156:159], v[120:123], v[184:187], v[156:159]
    s_add_u32 m0, s52, 5216
    v_rcp_f32 v140, v140
    buffer_load_dwordx4 v[232:233], s[20:23], 0 idxen offen nt lds
    v_mfma_f32_16x16x32_bf16 v[160:163], v[128:131], v[184:187], v[160:163]
    v_readfirstlane_b32 s66, v1
    s_setprio 0
    s_xor_b32 s66, s66, s33
    s_cmp_gt_i32 s66, 0
    s_cbranch_scc0 Lf_lo2
    s_setprio 1
Lf_lo2:
    v_rcp_f32 v141, v141
    v_cvt_pk_bf16_f32 v135, v138, v139
    s_waitcnt vmcnt(4)
    ds_read_b128 v[180:183], v234 offset:0
    ds_read_b128 v[184:187], v235 offset:0
    v_rcp_f32 v142, v142
    v_cvt_pk_bf16_f32 v136, v140, v141
    v_mfma_f32_16x16x32_bf16 v[208:211], v[132:135], v[196:199], v[204:207]
    v_rcp_f32 v143, v143
    v_rcp_f32 v144, v144
    v_cvt_pk_bf16_f32 v137, v142, v143
    v_rcp_f32 v145, v145
    v_rcp_f32 v146, v146
    v_rcp_f32 v147, v147
    v_cvt_pk_bf16_f32 v138, v144, v145
    v_cvt_pk_bf16_f32 v139, v146, v147
    ds_read_u8 v230, v237 offset:112
    ds_read_u8 v232, v237 offset:120
    v_mfma_f32_16x16x32_bf16 v[208:211], v[136:139], v[200:203], v[208:211]
    s_bitcmp1_b32 s36, 3
    s_cbranch_scc1 Lf_ev3
Lf_evd3:
    v_exp_f32 v132, v148
    v_exp_f32 v133, v149
    v_exp_f32 v134, v150
    v_exp_f32 v135, v151
    v_exp_f32 v136, v152
    v_exp_f32 v137, v153
    v_mfma_f32_4x4x4_16b_bf16 v[132:135], v[228:229], v[228:229], v[132:135]
    v_cvt_pk_bf16_f32 v208, v208, v209
    v_cvt_pk_bf16_f32 v209, v210, v211
    s_waitcnt lgkmcnt(2)
    v_mfma_f32_16x16x32_bf16 v[148:151], v[100:103], v[180:183], v[164:167]
    v_exp_f32 v138, v154
    v_mfma_f32_4x4x4_16b_bf16 v[212:215], v[208:209], v[188:189], v[212:215] cbsz:4 abid:0
    ds_read_b64_tr_b16 v[188:189], v236 offset:6240
    v_exp_f32 v139, v155
    v_mfma_f32_16x16x32_bf16 v[152:155], v[108:111], v[180:183], v[168:171]
    v_exp_f32 v140, v156
    v_mfma_f32_4x4x4_16b_bf16 v[212:215], v[208:209], v[190:191], v[212:215] cbsz:4 abid:4
    ds_read_b64_tr_b16 v[190:191], v236 offset:6752
    v_mfma_f32_4x4x4_16b_bf16 v[136:139], v[228:229], v[228:229], v[136:139]
    v_rcp_f32 v132, v132
    v_mfma_f32_4x4x4_16b_bf16 v[212:215], v[208:209], v[192:193], v[212:215] cbsz:4 abid:8
    ds_read_b64_tr_b16 v[192:193], v236 offset:7296
    v_exp_f32 v141, v157
    v_mfma_f32_16x16x32_bf16 v[148:151], v[104:107], v[184:187], v[148:151]
    v_rcp_f32 v133, v133
    v_mfma_f32_4x4x4_16b_bf16 v[212:215], v[208:209], v[194:195], v[212:215] cbsz:4 abid:12
    ds_read_b64_tr_b16 v[194:195], v236 offset:7808
    v_exp_f32 v142, v158
    v_mfma_f32_16x16x32_bf16 v[152:155], v[112:115], v[184:187], v[152:155]
    v_rcp_f32 v134, v134
    v_exp_f32 v143, v159
    v_rcp_f32 v135, v135
    v_cvt_pk_bf16_f32 v132, v132, v133
    v_mfma_f32_4x4x4_16b_bf16 v[140:143], v[228:229], v[228:229], v[140:143]
    v_exp_f32 v144, v160
    v_mfma_f32_16x16x32_bf16 v[156:159], v[116:119], v[180:183], v[172:175]
    v_rcp_f32 v136, v136
    v_cvt_pk_bf16_f32 v133, v134, v135
    v_exp_f32 v145, v161
    v_rcp_f32 v137, v137
    v_exp_f32 v146, v162
    v_rcp_f32 v138, v138
    v_cvt_pk_bf16_f32 v134, v136, v137
    v_exp_f32 v147, v163
    v_mfma_f32_16x16x32_bf16 v[160:163], v[124:127], v[180:183], v[176:179]
    s_waitcnt lgkmcnt(0)
    s_add_u32 m0, s52, 6240
    v_rcp_f32 v139, v139
    buffer_load_dwordx4 v[230:231], s[20:23], 0 idxen offen nt lds
    v_mfma_f32_4x4x4_16b_bf16 v[144:147], v[228:229], v[228:229], v[144:147]
    v_mfma_f32_16x16x32_bf16 v[156:159], v[120:123], v[184:187], v[156:159]
    s_add_u32 m0, s52, 7296
    v_rcp_f32 v140, v140
    buffer_load_dwordx4 v[232:233], s[20:23], 0 idxen offen nt lds
    v_mfma_f32_16x16x32_bf16 v[160:163], v[128:131], v[184:187], v[160:163]
    v_rcp_f32 v141, v141
    v_cvt_pk_bf16_f32 v135, v138, v139
    s_waitcnt vmcnt(4)
    ds_read_b128 v[180:183], v234 offset:2080
    ds_read_b128 v[184:187], v235 offset:2080
    v_rcp_f32 v142, v142
    v_cvt_pk_bf16_f32 v136, v140, v141
    v_mfma_f32_16x16x32_bf16 v[208:211], v[132:135], v[196:199], v[204:207]
    v_rcp_f32 v143, v143
    s_lshr_b64 s[56:57], s[56:57], 4
    s_lshl_b64 s[86:87], s[58:59], 60
    s_or_b64 s[56:57], s[56:57], s[86:87]
    s_lshr_b64 s[58:59], s[58:59], 4
    s_lshr_b64 s[86:87], s[56:57], 2
    s_lshr_b64 s[36:37], s[56:57], 5
    s_or_b32 s36, s36, s86
    s_or_b32 s36, s36, s56
    v_add_u32 v237, 64, v237
    v_rcp_f32 v144, v144
    v_cvt_pk_bf16_f32 v137, v142, v143
    v_rcp_f32 v145, v145
    v_rcp_f32 v146, v146
    v_rcp_f32 v147, v147
    v_cvt_pk_bf16_f32 v138, v144, v145
    v_cvt_pk_bf16_f32 v139, v146, v147
    s_branch Lf_loop
Lf_ev0:
    s_bitcmp0_b64 s[56:57], 0
    s_cbranch_scc1 Lf_nf0
    v_cvt_pk_bf16_f32 v246, v212, v212
    v_mov_b32 v212, 0
    ds_write_b16 v240, v246
    v_add_u32 v240, 128, v240
Lf_nf0:
    s_bitcmp0_b64 s[56:57], 5
    s_cbranch_scc1 Lf_na0
    s_sub_u32 s60, s60, 1
    s_cselect_b32 s31, 0, s31
    s_add_u32 s20, s20, s31
    s_addc_u32 s21, s21, 0
    s_xor_b32 s31, s31, 0x63ff800
Lf_na0:
    s_bitcmp0_b64 s[56:57], 2
    s_cbranch_scc1 Lf_evd0
    s_sub_u32 s61, s61, 1
    s_cbranch_scc1 Lf_last0
    v_mul_u32_u24 v216, v224, v241
    v_mul_u32_u24 v217, v224, v242
    v_mul_u32_u24 v218, v225, v241
    v_mul_u32_u24 v219, v225, v242
    v_mul_u32_u24 v220, v226, v241
    v_mul_u32_u24 v221, v226, v242
    v_mul_u32_u24 v222, v227, v241
    v_mul_u32_u24 v223, v227, v242
    v_add_u32 v238, 128, v238
    ds_read_b128 v[164:167], v239
    v_mfma_f32_4x4x4_16b_bf16 v[132:135], v[216:217], v[68:69], v[4:7]
    ds_read_b128 v[168:171], v239 offset:64
    ds_read_b128 v[172:175], v239 offset:128
    v_mfma_f32_4x4x4_16b_bf16 v[136:139], v[218:219], v[70:71], v[8:11]
    ds_read_b128 v[176:179], v239 offset:192
    ds_read_u16 v224, v238
    v_mfma_f32_4x4x4_16b_bf16 v[140:143], v[220:221], v[72:73], v[12:15]
    ds_read_u16 v225, v238 offset:8
    ds_read_u16 v226, v238 offset:64
    v_mfma_f32_4x4x4_16b_bf16 v[144:147], v[222:223], v[74:75], v[16:19]
    ds_read_u16 v227, v238 offset:72
    v_add_u32 v239, 272, v239
    v_mfma_f32_4x4x4_16b_bf16 v[246:249], v[216:217], v[76:77], v[20:23]
    v_cvt_pk_bf16_f32 v100, v132, v133
    v_cvt_pk_bf16_f32 v101, v134, v135
    v_mfma_f32_4x4x4_16b_bf16 v[250:253], v[218:219], v[78:79], v[24:27]
    v_cvt_pk_bf16_f32 v102, v136, v137
    v_cvt_pk_bf16_f32 v103, v138, v139
    v_mfma_f32_4x4x4_16b_bf16 v[132:135], v[220:221], v[80:81], v[28:31]
    v_cvt_pk_bf16_f32 v104, v140, v141
    v_cvt_pk_bf16_f32 v105, v142, v143
    v_mfma_f32_4x4x4_16b_bf16 v[136:139], v[222:223], v[82:83], v[32:35]
    v_cvt_pk_bf16_f32 v106, v144, v145
    v_cvt_pk_bf16_f32 v107, v146, v147
    v_mfma_f32_4x4x4_16b_bf16 v[140:143], v[216:217], v[84:85], v[36:39]
    v_cvt_pk_bf16_f32 v108, v246, v247
    v_cvt_pk_bf16_f32 v109, v248, v249
    v_mfma_f32_4x4x4_16b_bf16 v[144:147], v[218:219], v[86:87], v[40:43]
    v_cvt_pk_bf16_f32 v110, v250, v251
    v_cvt_pk_bf16_f32 v111, v252, v253
    v_mfma_f32_4x4x4_16b_bf16 v[246:249], v[220:221], v[88:89], v[44:47]
    v_cvt_pk_bf16_f32 v112, v132, v133
    v_cvt_pk_bf16_f32 v113, v134, v135
    v_mfma_f32_4x4x4_16b_bf16 v[250:253], v[222:223], v[90:91], v[48:51]
    v_cvt_pk_bf16_f32 v114, v136, v137
    v_cvt_pk_bf16_f32 v115, v138, v139
    v_mfma_f32_4x4x4_16b_bf16 v[132:135], v[216:217], v[92:93], v[52:55]
    v_cvt_pk_bf16_f32 v116, v140, v141
    v_cvt_pk_bf16_f32 v117, v142, v143
    v_mfma_f32_4x4x4_16b_bf16 v[136:139], v[218:219], v[94:95], v[56:59]
    v_cvt_pk_bf16_f32 v118, v144, v145
    v_cvt_pk_bf16_f32 v119, v146, v147
    v_mfma_f32_4x4x4_16b_bf16 v[140:143], v[220:221], v[96:97], v[60:63]
    v_cvt_pk_bf16_f32 v120, v246, v247
    v_cvt_pk_bf16_f32 v121, v248, v249
    v_mfma_f32_4x4x4_16b_bf16 v[144:147], v[222:223], v[98:99], v[64:67]
    v_cvt_pk_bf16_f32 v122, v250, v251
    v_cvt_pk_bf16_f32 v123, v252, v253
    v_cvt_pk_bf16_f32 v124, v132, v133
    v_cvt_pk_bf16_f32 v125, v134, v135
    v_cvt_pk_bf16_f32 v126, v136, v137
    v_cvt_pk_bf16_f32 v127, v138, v139
    v_cvt_pk_bf16_f32 v128, v140, v141
    v_cvt_pk_bf16_f32 v129, v142, v143
    v_cvt_pk_bf16_f32 v130, v144, v145
    v_cvt_pk_bf16_f32 v131, v146, v147
    s_waitcnt lgkmcnt(0)
    s_branch Lf_evd0
Lf_ev1:
    s_bitcmp0_b64 s[56:57], 1
    s_cbranch_scc1 Lf_nf1
    v_cvt_pk_bf16_f32 v246, v212, v212
    v_mov_b32 v212, 0
    ds_write_b16 v240, v246
    v_add_u32 v240, 128, v240
Lf_nf1:
    s_bitcmp0_b64 s[56:57], 6
    s_cbranch_scc1 Lf_na1
    s_sub_u32 s60, s60, 1
    s_cselect_b32 s31, 0, s31
    s_add_u32 s20, s20, s31
    s_addc_u32 s21, s21, 0
    s_xor_b32 s31, s31, 0x63ff800
Lf_na1:
    s_bitcmp0_b64 s[56:57], 3
    s_cbranch_scc1 Lf_evd1
    s_sub_u32 s61, s61, 1
    s_cbranch_scc1 Lf_last1
    v_mul_u32_u24 v216, v224, v241
    v_mul_u32_u24 v217, v224, v242
    v_mul_u32_u24 v218, v225, v241
    v_mul_u32_u24 v219, v225, v242
    v_mul_u32_u24 v220, v226, v241
    v_mul_u32_u24 v221, v226, v242
    v_mul_u32_u24 v222, v227, v241
    v_mul_u32_u24 v223, v227, v242
    v_add_u32 v238, 128, v238
    ds_read_b128 v[164:167], v239
    v_mfma_f32_4x4x4_16b_bf16 v[132:135], v[216:217], v[68:69], v[4:7]
    ds_read_b128 v[168:171], v239 offset:64
    ds_read_b128 v[172:175], v239 offset:128
    v_mfma_f32_4x4x4_16b_bf16 v[136:139], v[218:219], v[70:71], v[8:11]
    ds_read_b128 v[176:179], v239 offset:192
    ds_read_u16 v224, v238
    v_mfma_f32_4x4x4_16b_bf16 v[140:143], v[220:221], v[72:73], v[12:15]
    ds_read_u16 v225, v238 offset:8
    ds_read_u16 v226, v238 offset:64
    v_mfma_f32_4x4x4_16b_bf16 v[144:147], v[222:223], v[74:75], v[16:19]
    ds_read_u16 v227, v238 offset:72
    v_add_u32 v239, 272, v239
    v_mfma_f32_4x4x4_16b_bf16 v[246:249], v[216:217], v[76:77], v[20:23]
    v_cvt_pk_bf16_f32 v100, v132, v133
    v_cvt_pk_bf16_f32 v101, v134, v135
    v_mfma_f32_4x4x4_16b_bf16 v[250:253], v[218:219], v[78:79], v[24:27]
    v_cvt_pk_bf16_f32 v102, v136, v137
    v_cvt_pk_bf16_f32 v103, v138, v139
    v_mfma_f32_4x4x4_16b_bf16 v[132:135], v[220:221], v[80:81], v[28:31]
    v_cvt_pk_bf16_f32 v104, v140, v141
    v_cvt_pk_bf16_f32 v105, v142, v143
    v_mfma_f32_4x4x4_16b_bf16 v[136:139], v[222:223], v[82:83], v[32:35]
    v_cvt_pk_bf16_f32 v106, v144, v145
    v_cvt_pk_bf16_f32 v107, v146, v147
    v_mfma_f32_4x4x4_16b_bf16 v[140:143], v[216:217], v[84:85], v[36:39]
    v_cvt_pk_bf16_f32 v108, v246, v247
    v_cvt_pk_bf16_f32 v109, v248, v249
    v_mfma_f32_4x4x4_16b_bf16 v[144:147], v[218:219], v[86:87], v[40:43]
    v_cvt_pk_bf16_f32 v110, v250, v251
    v_cvt_pk_bf16_f32 v111, v252, v253
    v_mfma_f32_4x4x4_16b_bf16 v[246:249], v[220:221], v[88:89], v[44:47]
    v_cvt_pk_bf16_f32 v112, v132, v133
    v_cvt_pk_bf16_f32 v113, v134, v135
    v_mfma_f32_4x4x4_16b_bf16 v[250:253], v[222:223], v[90:91], v[48:51]
    v_cvt_pk_bf16_f32 v114, v136, v137
    v_cvt_pk_bf16_f32 v115, v138, v139
    v_mfma_f32_4x4x4_16b_bf16 v[132:135], v[216:217], v[92:93], v[52:55]
    v_cvt_pk_bf16_f32 v116, v140, v141
    v_cvt_pk_bf16_f32 v117, v142, v143
    v_mfma_f32_4x4x4_16b_bf16 v[136:139], v[218:219], v[94:95], v[56:59]
    v_cvt_pk_bf16_f32 v118, v144, v145
    v_cvt_pk_bf16_f32 v119, v146, v147
    v_mfma_f32_4x4x4_16b_bf16 v[140:143], v[220:221], v[96:97], v[60:63]
    v_cvt_pk_bf16_f32 v120, v246, v247
    v_cvt_pk_bf16_f32 v121, v248, v249
    v_mfma_f32_4x4x4_16b_bf16 v[144:147], v[222:223], v[98:99], v[64:67]
    v_cvt_pk_bf16_f32 v122, v250, v251
    v_cvt_pk_bf16_f32 v123, v252, v253
    v_cvt_pk_bf16_f32 v124, v132, v133
    v_cvt_pk_bf16_f32 v125, v134, v135
    v_cvt_pk_bf16_f32 v126, v136, v137
    v_cvt_pk_bf16_f32 v127, v138, v139
    v_cvt_pk_bf16_f32 v128, v140, v141
    v_cvt_pk_bf16_f32 v129, v142, v143
    v_cvt_pk_bf16_f32 v130, v144, v145
    v_cvt_pk_bf16_f32 v131, v146, v147
    s_waitcnt lgkmcnt(0)
    s_branch Lf_evd1
Lf_ev2:
    s_bitcmp0_b64 s[56:57], 2
    s_cbranch_scc1 Lf_nf2
    v_cvt_pk_bf16_f32 v246, v212, v212
    v_mov_b32 v212, 0
    ds_write_b16 v240, v246
    v_add_u32 v240, 128, v240
Lf_nf2:
    s_bitcmp0_b64 s[56:57], 7
    s_cbranch_scc1 Lf_na2
    s_sub_u32 s60, s60, 1
    s_cselect_b32 s31, 0, s31
    s_add_u32 s20, s20, s31
    s_addc_u32 s21, s21, 0
    s_xor_b32 s31, s31, 0x63ff800
Lf_na2:
    s_bitcmp0_b64 s[56:57], 4
    s_cbranch_scc1 Lf_evd2
    s_sub_u32 s61, s61, 1
    s_cbranch_scc1 Lf_last2
    v_mul_u32_u24 v216, v224, v241
    v_mul_u32_u24 v217, v224, v242
    v_mul_u32_u24 v218, v225, v241
    v_mul_u32_u24 v219, v225, v242
    v_mul_u32_u24 v220, v226, v241
    v_mul_u32_u24 v221, v226, v242
    v_mul_u32_u24 v222, v227, v241
    v_mul_u32_u24 v223, v227, v242
    v_add_u32 v238, 128, v238
    ds_read_b128 v[164:167], v239
    v_mfma_f32_4x4x4_16b_bf16 v[132:135], v[216:217], v[68:69], v[4:7]
    ds_read_b128 v[168:171], v239 offset:64
    ds_read_b128 v[172:175], v239 offset:128
    v_mfma_f32_4x4x4_16b_bf16 v[136:139], v[218:219], v[70:71], v[8:11]
    ds_read_b128 v[176:179], v239 offset:192
    ds_read_u16 v224, v238
    v_mfma_f32_4x4x4_16b_bf16 v[140:143], v[220:221], v[72:73], v[12:15]
    ds_read_u16 v225, v238 offset:8
    ds_read_u16 v226, v238 offset:64
    v_mfma_f32_4x4x4_16b_bf16 v[144:147], v[222:223], v[74:75], v[16:19]
    ds_read_u16 v227, v238 offset:72
    v_add_u32 v239, 272, v239
    v_mfma_f32_4x4x4_16b_bf16 v[246:249], v[216:217], v[76:77], v[20:23]
    v_cvt_pk_bf16_f32 v100, v132, v133
    v_cvt_pk_bf16_f32 v101, v134, v135
    v_mfma_f32_4x4x4_16b_bf16 v[250:253], v[218:219], v[78:79], v[24:27]
    v_cvt_pk_bf16_f32 v102, v136, v137
    v_cvt_pk_bf16_f32 v103, v138, v139
    v_mfma_f32_4x4x4_16b_bf16 v[132:135], v[220:221], v[80:81], v[28:31]
    v_cvt_pk_bf16_f32 v104, v140, v141
    v_cvt_pk_bf16_f32 v105, v142, v143
    v_mfma_f32_4x4x4_16b_bf16 v[136:139], v[222:223], v[82:83], v[32:35]
    v_cvt_pk_bf16_f32 v106, v144, v145
    v_cvt_pk_bf16_f32 v107, v146, v147
    v_mfma_f32_4x4x4_16b_bf16 v[140:143], v[216:217], v[84:85], v[36:39]
    v_cvt_pk_bf16_f32 v108, v246, v247
    v_cvt_pk_bf16_f32 v109, v248, v249
    v_mfma_f32_4x4x4_16b_bf16 v[144:147], v[218:219], v[86:87], v[40:43]
    v_cvt_pk_bf16_f32 v110, v250, v251
    v_cvt_pk_bf16_f32 v111, v252, v253
    v_mfma_f32_4x4x4_16b_bf16 v[246:249], v[220:221], v[88:89], v[44:47]
    v_cvt_pk_bf16_f32 v112, v132, v133
    v_cvt_pk_bf16_f32 v113, v134, v135
    v_mfma_f32_4x4x4_16b_bf16 v[250:253], v[222:223], v[90:91], v[48:51]
    v_cvt_pk_bf16_f32 v114, v136, v137
    v_cvt_pk_bf16_f32 v115, v138, v139
    v_mfma_f32_4x4x4_16b_bf16 v[132:135], v[216:217], v[92:93], v[52:55]
    v_cvt_pk_bf16_f32 v116, v140, v141
    v_cvt_pk_bf16_f32 v117, v142, v143
    v_mfma_f32_4x4x4_16b_bf16 v[136:139], v[218:219], v[94:95], v[56:59]
    v_cvt_pk_bf16_f32 v118, v144, v145
    v_cvt_pk_bf16_f32 v119, v146, v147
    v_mfma_f32_4x4x4_16b_bf16 v[140:143], v[220:221], v[96:97], v[60:63]
    v_cvt_pk_bf16_f32 v120, v246, v247
    v_cvt_pk_bf16_f32 v121, v248, v249
    v_mfma_f32_4x4x4_16b_bf16 v[144:147], v[222:223], v[98:99], v[64:67]
    v_cvt_pk_bf16_f32 v122, v250, v251
    v_cvt_pk_bf16_f32 v123, v252, v253
    v_cvt_pk_bf16_f32 v124, v132, v133
    v_cvt_pk_bf16_f32 v125, v134, v135
    v_cvt_pk_bf16_f32 v126, v136, v137
    v_cvt_pk_bf16_f32 v127, v138, v139
    v_cvt_pk_bf16_f32 v128, v140, v141
    v_cvt_pk_bf16_f32 v129, v142, v143
    v_cvt_pk_bf16_f32 v130, v144, v145
    v_cvt_pk_bf16_f32 v131, v146, v147
    s_waitcnt lgkmcnt(0)
    s_branch Lf_evd2
Lf_ev3:
    s_bitcmp0_b64 s[56:57], 3
    s_cbranch_scc1 Lf_nf3
    v_cvt_pk_bf16_f32 v246, v212, v212
    v_mov_b32 v212, 0
    ds_write_b16 v240, v246
    v_add_u32 v240, 128, v240
Lf_nf3:
    s_bitcmp0_b64 s[56:57], 8
    s_cbranch_scc1 Lf_na3
    s_sub_u32 s60, s60, 1
    s_cselect_b32 s31, 0, s31
    s_add_u32 s20, s20, s31
    s_addc_u32 s21, s21, 0
    s_xor_b32 s31, s31, 0x63ff800
Lf_na3:
    s_bitcmp0_b64 s[56:57], 5
    s_cbranch_scc1 Lf_evd3
    s_sub_u32 s61, s61, 1
    s_cbranch_scc1 Lf_last3
    v_mul_u32_u24 v216, v224, v241
    v_mul_u32_u24 v217, v224, v242
    v_mul_u32_u24 v218, v225, v241
    v_mul_u32_u24 v219, v225, v242
    v_mul_u32_u24 v220, v226, v241
    v_mul_u32_u24 v221, v226, v242
    v_mul_u32_u24 v222, v227, v241
    v_mul_u32_u24 v223, v227, v242
    v_add_u32 v238, 128, v238
    ds_read_b128 v[164:167], v239
    v_mfma_f32_4x4x4_16b_bf16 v[132:135], v[216:217], v[68:69], v[4:7]
    ds_read_b128 v[168:171], v239 offset:64
    ds_read_b128 v[172:175], v239 offset:128
    v_mfma_f32_4x4x4_16b_bf16 v[136:139], v[218:219], v[70:71], v[8:11]
    ds_read_b128 v[176:179], v239 offset:192
    ds_read_u16 v224, v238
    v_mfma_f32_4x4x4_16b_bf16 v[140:143], v[220:221], v[72:73], v[12:15]
    ds_read_u16 v225, v238 offset:8
    ds_read_u16 v226, v238 offset:64
    v_mfma_f32_4x4x4_16b_bf16 v[144:147], v[222:223], v[74:75], v[16:19]
    ds_read_u16 v227, v238 offset:72
    v_add_u32 v239, 272, v239
    v_mfma_f32_4x4x4_16b_bf16 v[246:249], v[216:217], v[76:77], v[20:23]
    v_cvt_pk_bf16_f32 v100, v132, v133
    v_cvt_pk_bf16_f32 v101, v134, v135
    v_mfma_f32_4x4x4_16b_bf16 v[250:253], v[218:219], v[78:79], v[24:27]
    v_cvt_pk_bf16_f32 v102, v136, v137
    v_cvt_pk_bf16_f32 v103, v138, v139
    v_mfma_f32_4x4x4_16b_bf16 v[132:135], v[220:221], v[80:81], v[28:31]
    v_cvt_pk_bf16_f32 v104, v140, v141
    v_cvt_pk_bf16_f32 v105, v142, v143
    v_mfma_f32_4x4x4_16b_bf16 v[136:139], v[222:223], v[82:83], v[32:35]
    v_cvt_pk_bf16_f32 v106, v144, v145
    v_cvt_pk_bf16_f32 v107, v146, v147
    v_mfma_f32_4x4x4_16b_bf16 v[140:143], v[216:217], v[84:85], v[36:39]
    v_cvt_pk_bf16_f32 v108, v246, v247
    v_cvt_pk_bf16_f32 v109, v248, v249
    v_mfma_f32_4x4x4_16b_bf16 v[144:147], v[218:219], v[86:87], v[40:43]
    v_cvt_pk_bf16_f32 v110, v250, v251
    v_cvt_pk_bf16_f32 v111, v252, v253
    v_mfma_f32_4x4x4_16b_bf16 v[246:249], v[220:221], v[88:89], v[44:47]
    v_cvt_pk_bf16_f32 v112, v132, v133
    v_cvt_pk_bf16_f32 v113, v134, v135
    v_mfma_f32_4x4x4_16b_bf16 v[250:253], v[222:223], v[90:91], v[48:51]
    v_cvt_pk_bf16_f32 v114, v136, v137
    v_cvt_pk_bf16_f32 v115, v138, v139
    v_mfma_f32_4x4x4_16b_bf16 v[132:135], v[216:217], v[92:93], v[52:55]
    v_cvt_pk_bf16_f32 v116, v140, v141
    v_cvt_pk_bf16_f32 v117, v142, v143
    v_mfma_f32_4x4x4_16b_bf16 v[136:139], v[218:219], v[94:95], v[56:59]
    v_cvt_pk_bf16_f32 v118, v144, v145
    v_cvt_pk_bf16_f32 v119, v146, v147
    v_mfma_f32_4x4x4_16b_bf16 v[140:143], v[220:221], v[96:97], v[60:63]
    v_cvt_pk_bf16_f32 v120, v246, v247
    v_cvt_pk_bf16_f32 v121, v248, v249
    v_mfma_f32_4x4x4_16b_bf16 v[144:147], v[222:223], v[98:99], v[64:67]
    v_cvt_pk_bf16_f32 v122, v250, v251
    v_cvt_pk_bf16_f32 v123, v252, v253
    v_cvt_pk_bf16_f32 v124, v132, v133
    v_cvt_pk_bf16_f32 v125, v134, v135
    v_cvt_pk_bf16_f32 v126, v136, v137
    v_cvt_pk_bf16_f32 v127, v138, v139
    v_cvt_pk_bf16_f32 v128, v140, v141
    v_cvt_pk_bf16_f32 v129, v142, v143
    v_cvt_pk_bf16_f32 v130, v144, v145
    v_cvt_pk_bf16_f32 v131, v146, v147
    s_waitcnt lgkmcnt(0)
    s_branch Lf_evd3
Lf_last0:
    s_branch Lf_tail
Lf_last1:
    v_add_u32 v236, 2080, v236
    s_lshr_b64 s[56:57], s[56:57], 1
    s_branch Lf_tail
Lf_last2:
    v_add_u32 v236, 4160, v236
    s_lshr_b64 s[56:57], s[56:57], 2
    s_branch Lf_tail
Lf_last3:
    v_add_u32 v236, 6240, v236
    s_lshr_b64 s[56:57], s[56:57], 3
Lf_tail:
    v_exp_f32 v132, v148
    v_exp_f32 v133, v149
    v_exp_f32 v134, v150
    v_exp_f32 v135, v151
    v_exp_f32 v136, v152
    v_exp_f32 v137, v153
    v_mfma_f32_4x4x4_16b_bf16 v[132:135], v[228:229], v[228:229], v[132:135]
    v_cvt_pk_bf16_f32 v208, v208, v209
    v_cvt_pk_bf16_f32 v209, v210, v211
    v_exp_f32 v138, v154
    s_nop 0
    v_mfma_f32_4x4x4_16b_bf16 v[212:215], v[208:209], v[188:189], v[212:215] cbsz:4 abid:0
    ds_read_b64_tr_b16 v[188:189], v236 offset:0
    v_exp_f32 v139, v155
    v_exp_f32 v140, v156
    v_mfma_f32_4x4x4_16b_bf16 v[212:215], v[208:209], v[190:191], v[212:215] cbsz:4 abid:4
    ds_read_b64_tr_b16 v[190:191], v236 offset:512
    v_mfma_f32_4x4x4_16b_bf16 v[136:139], v[228:229], v[228:229], v[136:139]
    v_rcp_f32 v132, v132
    v_mfma_f32_4x4x4_16b_bf16 v[212:215], v[208:209], v[192:193], v[212:215] cbsz:4 abid:8
    ds_read_b64_tr_b16 v[192:193], v236 offset:1056
    v_exp_f32 v141, v157
    v_rcp_f32 v133, v133
    v_mfma_f32_4x4x4_16b_bf16 v[212:215], v[208:209], v[194:195], v[212:215] cbsz:4 abid:12
    ds_read_b64_tr_b16 v[194:195], v236 offset:1568
    v_exp_f32 v142, v158
    v_rcp_f32 v134, v134
    v_exp_f32 v143, v159
    v_rcp_f32 v135, v135
    v_cvt_pk_bf16_f32 v132, v132, v133
    v_mfma_f32_4x4x4_16b_bf16 v[140:143], v[228:229], v[228:229], v[140:143]
    v_exp_f32 v144, v160
    v_rcp_f32 v136, v136
    v_cvt_pk_bf16_f32 v133, v134, v135
    s_bitcmp0_b64 s[56:57], 1
    s_cbranch_scc1 Lf_tnf
    v_cvt_pk_bf16_f32 v246, v212, v212
    v_mov_b32 v212, 0
    ds_write_b16 v240, v246
    v_add_u32 v240, 128, v240
Lf_tnf:
    v_exp_f32 v145, v161
    v_rcp_f32 v137, v137
    v_exp_f32 v146, v162
    v_rcp_f32 v138, v138
    v_cvt_pk_bf16_f32 v134, v136, v137
    v_exp_f32 v147, v163
    s_waitcnt lgkmcnt(0)
    v_rcp_f32 v139, v139
    v_mfma_f32_4x4x4_16b_bf16 v[144:147], v[228:229], v[228:229], v[144:147]
    v_rcp_f32 v140, v140
    v_rcp_f32 v141, v141
    v_cvt_pk_bf16_f32 v135, v138, v139
    v_rcp_f32 v142, v142
    v_cvt_pk_bf16_f32 v136, v140, v141
    v_mfma_f32_16x16x32_bf16 v[208:211], v[132:135], v[196:199], v[204:207]
    v_rcp_f32 v143, v143
    v_rcp_f32 v144, v144
    v_cvt_pk_bf16_f32 v137, v142, v143
    v_rcp_f32 v145, v145
    v_rcp_f32 v146, v146
    v_rcp_f32 v147, v147
    v_cvt_pk_bf16_f32 v138, v144, v145
    v_cvt_pk_bf16_f32 v139, v146, v147
    s_nop 1
    v_mfma_f32_16x16x32_bf16 v[208:211], v[136:139], v[200:203], v[208:211]
    s_nop 7
    v_cvt_pk_bf16_f32 v208, v208, v209
    v_cvt_pk_bf16_f32 v209, v210, v211
    s_nop 1
    v_mfma_f32_4x4x4_16b_bf16 v[212:215], v[208:209], v[188:189], v[212:215] cbsz:4 abid:0
    s_nop 1
    v_mfma_f32_4x4x4_16b_bf16 v[212:215], v[208:209], v[190:191], v[212:215] cbsz:4 abid:4
    s_nop 1
    v_mfma_f32_4x4x4_16b_bf16 v[212:215], v[208:209], v[192:193], v[212:215] cbsz:4 abid:8
    s_nop 1
    v_mfma_f32_4x4x4_16b_bf16 v[212:215], v[208:209], v[194:195], v[212:215] cbsz:4 abid:12
    s_nop 4
    v_cvt_pk_bf16_f32 v246, v212, v212
    ds_write_b16 v240, v246
L_store:
    s_add_u32 s66, s52, 8320
    v_lshl_add_u32 v247, v0, 4, s66
    s_waitcnt lgkmcnt(0)
    ds_read_b128 v[148:151], v247
    s_waitcnt lgkmcnt(0)
    global_store_dwordx4 v243, v[148:151], s[18:19]
L_end:
    s_endpgm
Ls_loop:
    ds_read_u8 v230, v237 offset:64
    ds_read_u8 v232, v237 offset:72
    v_mfma_f32_16x16x32_bf16 v[208:211], v[136:139], v[200:203], v[208:211]
Ls_mid:
    s_bitcmp1_b32 s36, 0
    s_cbranch_scc1 Ls_ev0
Ls_evd0:
    ds_read_b32 v246, v244 offset:0
    s_waitcnt lgkmcnt(0)
    v_bfe_u32 v247, v246, 0, 8
    v_lshlrev_b32 v247, 1, v247
    v_bfe_u32 v248, v246, 8, 8
    v_lshlrev_b32 v248, 1, v248
    v_bfe_u32 v249, v246, 16, 8
    v_lshlrev_b32 v249, 1, v249
    v_bfe_u32 v250, v246, 24, 8
    v_lshlrev_b32 v250, 1, v250
    buffer_load_ushort v247, v247, s[24:27], 0 offen
    buffer_load_ushort v248, v248, s[24:27], 0 offen
    buffer_load_ushort v249, v249, s[24:27], 0 offen
    buffer_load_ushort v250, v250, s[24:27], 0 offen
    s_waitcnt vmcnt(0)
    v_lshlrev_b32 v247, 16, v247
    v_mul_f32 v208, v208, v247
    v_lshlrev_b32 v248, 16, v248
    v_mul_f32 v209, v209, v248
    v_lshlrev_b32 v249, 16, v249
    v_mul_f32 v210, v210, v249
    v_lshlrev_b32 v250, 16, v250
    v_mul_f32 v211, v211, v250
    s_mov_b64 exec, 1
    ds_add_rtn_u32 v1, v2, v3
    s_mov_b64 exec, -1
    v_exp_f32 v132, v148
    v_exp_f32 v133, v149
    v_exp_f32 v134, v150
    v_exp_f32 v135, v151
    v_exp_f32 v136, v152
    v_exp_f32 v137, v153
    v_mfma_f32_4x4x4_16b_bf16 v[132:135], v[228:229], v[228:229], v[132:135]
    v_cvt_pk_bf16_f32 v208, v208, v209
    v_cvt_pk_bf16_f32 v209, v210, v211
    s_waitcnt lgkmcnt(2)
    v_mfma_f32_16x16x32_bf16 v[148:151], v[100:103], v[180:183], v[164:167]
    v_exp_f32 v138, v154
    v_mfma_f32_4x4x4_16b_bf16 v[212:215], v[208:209], v[188:189], v[212:215] cbsz:4 abid:0
    ds_read_b64_tr_b16 v[188:189], v236 offset:0
    v_exp_f32 v139, v155
    v_mfma_f32_16x16x32_bf16 v[152:155], v[108:111], v[180:183], v[168:171]
    v_exp_f32 v140, v156
    v_mfma_f32_4x4x4_16b_bf16 v[212:215], v[208:209], v[190:191], v[212:215] cbsz:4 abid:4
    ds_read_b64_tr_b16 v[190:191], v236 offset:512
    v_mfma_f32_4x4x4_16b_bf16 v[136:139], v[228:229], v[228:229], v[136:139]
    v_rcp_f32 v132, v132
    v_mfma_f32_4x4x4_16b_bf16 v[212:215], v[208:209], v[192:193], v[212:215] cbsz:4 abid:8
    ds_read_b64_tr_b16 v[192:193], v236 offset:1056
    v_exp_f32 v141, v157
    v_mfma_f32_16x16x32_bf16 v[148:151], v[104:107], v[184:187], v[148:151]
    v_rcp_f32 v133, v133
    v_mfma_f32_4x4x4_16b_bf16 v[212:215], v[208:209], v[194:195], v[212:215] cbsz:4 abid:12
    ds_read_b64_tr_b16 v[194:195], v236 offset:1568
    v_exp_f32 v142, v158
    v_mfma_f32_16x16x32_bf16 v[152:155], v[112:115], v[184:187], v[152:155]
    v_rcp_f32 v134, v134
    v_exp_f32 v143, v159
    v_rcp_f32 v135, v135
    v_cvt_pk_bf16_f32 v132, v132, v133
    v_mfma_f32_4x4x4_16b_bf16 v[140:143], v[228:229], v[228:229], v[140:143]
    v_exp_f32 v144, v160
    v_mfma_f32_16x16x32_bf16 v[156:159], v[116:119], v[180:183], v[172:175]
    v_rcp_f32 v136, v136
    v_cvt_pk_bf16_f32 v133, v134, v135
    v_exp_f32 v145, v161
    v_rcp_f32 v137, v137
    v_exp_f32 v146, v162
    v_rcp_f32 v138, v138
    v_cvt_pk_bf16_f32 v134, v136, v137
    v_exp_f32 v147, v163
    v_mfma_f32_16x16x32_bf16 v[160:163], v[124:127], v[180:183], v[176:179]
    s_waitcnt lgkmcnt(0)
    s_add_u32 m0, s52, 0
    v_rcp_f32 v139, v139
    buffer_load_dwordx4 v[230:231], s[20:23], 0 idxen offen nt lds
    v_mfma_f32_4x4x4_16b_bf16 v[144:147], v[228:229], v[228:229], v[144:147]
    v_mfma_f32_16x16x32_bf16 v[156:159], v[120:123], v[184:187], v[156:159]
    s_add_u32 m0, s52, 1056
    v_rcp_f32 v140, v140
    buffer_load_dwordx4 v[232:233], s[20:23], 0 idxen offen nt lds
    v_mfma_f32_16x16x32_bf16 v[160:163], v[128:131], v[184:187], v[160:163]
    v_readfirstlane_b32 s66, v1
    s_setprio 0
    s_xor_b32 s66, s66, s33
    s_cmp_gt_i32 s66, 0
    s_cbranch_scc0 Ls_lo0
    s_setprio 1
Ls_lo0:
    v_rcp_f32 v141, v141
    v_cvt_pk_bf16_f32 v135, v138, v139
    s_waitcnt vmcnt(4)
    ds_read_b128 v[180:183], v234 offset:4160
    ds_read_b128 v[184:187], v235 offset:4160
    v_rcp_f32 v142, v142
    v_cvt_pk_bf16_f32 v136, v140, v141
    v_mfma_f32_16x16x32_bf16 v[208:211], v[132:135], v[196:199], v[204:207]
    v_rcp_f32 v143, v143
    v_rcp_f32 v144, v144
    v_cvt_pk_bf16_f32 v137, v142, v143
    v_rcp_f32 v145, v145
    v_rcp_f32 v146, v146
    v_rcp_f32 v147, v147
    v_cvt_pk_bf16_f32 v138, v144, v145
    v_cvt_pk_bf16_f32 v139, v146, v147
    ds_read_u8 v230, v237 offset:80
    ds_read_u8 v232, v237 offset:88
    v_mfma_f32_16x16x32_bf16 v[208:211], v[136:139], v[200:203], v[208:211]
    s_bitcmp1_b32 s36, 1
    s_cbranch_scc1 Ls_ev1
Ls_evd1:
    ds_read_b32 v246, v244 offset:16
    s_waitcnt lgkmcnt(0)
    v_bfe_u32 v247, v246, 0, 8
    v_lshlrev_b32 v247, 1, v247
    v_bfe_u32 v248, v246, 8, 8
    v_lshlrev_b32 v248, 1, v248
    v_bfe_u32 v249, v246, 16, 8
    v_lshlrev_b32 v249, 1, v249
    v_bfe_u32 v250, v246, 24, 8
    v_lshlrev_b32 v250, 1, v250
    buffer_load_ushort v247, v247, s[24:27], 0 offen
    buffer_load_ushort v248, v248, s[24:27], 0 offen
    buffer_load_ushort v249, v249, s[24:27], 0 offen
    buffer_load_ushort v250, v250, s[24:27], 0 offen
    s_waitcnt vmcnt(0)
    v_lshlrev_b32 v247, 16, v247
    v_mul_f32 v208, v208, v247
    v_lshlrev_b32 v248, 16, v248
    v_mul_f32 v209, v209, v248
    v_lshlrev_b32 v249, 16, v249
    v_mul_f32 v210, v210, v249
    v_lshlrev_b32 v250, 16, v250
    v_mul_f32 v211, v211, v250
    v_exp_f32 v132, v148
    v_exp_f32 v133, v149
    v_exp_f32 v134, v150
    v_exp_f32 v135, v151
    v_exp_f32 v136, v152
    v_exp_f32 v137, v153
    v_mfma_f32_4x4x4_16b_bf16 v[132:135], v[228:229], v[228:229], v[132:135]
    v_cvt_pk_bf16_f32 v208, v208, v209
    v_cvt_pk_bf16_f32 v209, v210, v211
    s_waitcnt lgkmcnt(2)
    v_mfma_f32_16x16x32_bf16 v[148:151], v[100:103], v[180:183], v[164:167]
    v_exp_f32 v138, v154
    v_mfma_f32_4x4x4_16b_bf16 v[212:215], v[208:209], v[188:189], v[212:215] cbsz:4 abid:0
    ds_read_b64_tr_b16 v[188:189], v236 offset:2080
    v_exp_f32 v139, v155
    v_mfma_f32_16x16x32_bf16 v[152:155], v[108:111], v[180:183], v[168:171]
    v_exp_f32 v140, v156
    v_mfma_f32_4x4x4_16b_bf16 v[212:215], v[208:209], v[190:191], v[212:215] cbsz:4 abid:4
    ds_read_b64_tr_b16 v[190:191], v236 offset:2592
    v_mfma_f32_4x4x4_16b_bf16 v[136:139], v[228:229], v[228:229], v[136:139]
    v_rcp_f32 v132, v132
    v_mfma_f32_4x4x4_16b_bf16 v[212:215], v[208:209], v[192:193], v[212:215] cbsz:4 abid:8
    ds_read_b64_tr_b16 v[192:193], v236 offset:3136
    v_exp_f32 v141, v157
    v_mfma_f32_16x16x32_bf16 v[148:151], v[104:107], v[184:187], v[148:151]
    v_rcp_f32 v133, v133
    v_mfma_f32_4x4x4_16b_bf16 v[212:215], v[208:209], v[194:195], v[212:215] cbsz:4 abid:12
    ds_read_b64_tr_b16 v[194:195], v236 offset:3648
    v_exp_f32 v142, v158
    v_mfma_f32_16x16x32_bf16 v[152:155], v[112:115], v[184:187], v[152:155]
    v_rcp_f32 v134, v134
    v_exp_f32 v143, v159
    v_rcp_f32 v135, v135
    v_cvt_pk_bf16_f32 v132, v132, v133
    v_mfma_f32_4x4x4_16b_bf16 v[140:143], v[228:229], v[228:229], v[140:143]
    v_exp_f32 v144, v160
    v_mfma_f32_16x16x32_bf16 v[156:159], v[116:119], v[180:183], v[172:175]
    v_rcp_f32 v136, v136
    v_cvt_pk_bf16_f32 v133, v134, v135
    v_exp_f32 v145, v161
    v_rcp_f32 v137, v137
    v_exp_f32 v146, v162
    v_rcp_f32 v138, v138
    v_cvt_pk_bf16_f32 v134, v136, v137
    v_exp_f32 v147, v163
    v_mfma_f32_16x16x32_bf16 v[160:163], v[124:127], v[180:183], v[176:179]
    s_waitcnt lgkmcnt(0)
    s_add_u32 m0, s52, 2080
    v_rcp_f32 v139, v139
    buffer_load_dwordx4 v[230:231], s[20:23], 0 idxen offen nt lds
    v_mfma_f32_4x4x4_16b_bf16 v[144:147], v[228:229], v[228:229], v[144:147]
    v_mfma_f32_16x16x32_bf16 v[156:159], v[120:123], v[184:187], v[156:159]
    s_add_u32 m0, s52, 3136
    v_rcp_f32 v140, v140
    buffer_load_dwordx4 v[232:233], s[20:23], 0 idxen offen nt lds
    v_mfma_f32_16x16x32_bf16 v[160:163], v[128:131], v[184:187], v[160:163]
    v_rcp_f32 v141, v141
    v_cvt_pk_bf16_f32 v135, v138, v139
    s_waitcnt vmcnt(4)
    ds_read_b128 v[180:183], v234 offset:6240
    ds_read_b128 v[184:187], v235 offset:6240
    v_rcp_f32 v142, v142
    v_cvt_pk_bf16_f32 v136, v140, v141
    v_mfma_f32_16x16x32_bf16 v[208:211], v[132:135], v[196:199], v[204:207]
    v_rcp_f32 v143, v143
    v_rcp_f32 v144, v144
    v_cvt_pk_bf16_f32 v137, v142, v143
    v_rcp_f32 v145, v145
    v_rcp_f32 v146, v146
    v_rcp_f32 v147, v147
    v_cvt_pk_bf16_f32 v138, v144, v145
    v_cvt_pk_bf16_f32 v139, v146, v147
    ds_read_u8 v230, v237 offset:96
    ds_read_u8 v232, v237 offset:104
    v_mfma_f32_16x16x32_bf16 v[208:211], v[136:139], v[200:203], v[208:211]
    s_bitcmp1_b32 s36, 2
    s_cbranch_scc1 Ls_ev2
Ls_evd2:
    ds_read_b32 v246, v244 offset:32
    s_waitcnt lgkmcnt(0)
    v_bfe_u32 v247, v246, 0, 8
    v_lshlrev_b32 v247, 1, v247
    v_bfe_u32 v248, v246, 8, 8
    v_lshlrev_b32 v248, 1, v248
    v_bfe_u32 v249, v246, 16, 8
    v_lshlrev_b32 v249, 1, v249
    v_bfe_u32 v250, v246, 24, 8
    v_lshlrev_b32 v250, 1, v250
    buffer_load_ushort v247, v247, s[24:27], 0 offen
    buffer_load_ushort v248, v248, s[24:27], 0 offen
    buffer_load_ushort v249, v249, s[24:27], 0 offen
    buffer_load_ushort v250, v250, s[24:27], 0 offen
    s_waitcnt vmcnt(0)
    v_lshlrev_b32 v247, 16, v247
    v_mul_f32 v208, v208, v247
    v_lshlrev_b32 v248, 16, v248
    v_mul_f32 v209, v209, v248
    v_lshlrev_b32 v249, 16, v249
    v_mul_f32 v210, v210, v249
    v_lshlrev_b32 v250, 16, v250
    v_mul_f32 v211, v211, v250
    s_mov_b64 exec, 1
    ds_add_rtn_u32 v1, v2, v3
    s_mov_b64 exec, -1
    v_exp_f32 v132, v148
    v_exp_f32 v133, v149
    v_exp_f32 v134, v150
    v_exp_f32 v135, v151
    v_exp_f32 v136, v152
    v_exp_f32 v137, v153
    v_mfma_f32_4x4x4_16b_bf16 v[132:135], v[228:229], v[228:229], v[132:135]
    v_cvt_pk_bf16_f32 v208, v208, v209
    v_cvt_pk_bf16_f32 v209, v210, v211
    s_waitcnt lgkmcnt(2)
    v_mfma_f32_16x16x32_bf16 v[148:151], v[100:103], v[180:183], v[164:167]
    v_exp_f32 v138, v154
    v_mfma_f32_4x4x4_16b_bf16 v[212:215], v[208:209], v[188:189], v[212:215] cbsz:4 abid:0
    ds_read_b64_tr_b16 v[188:189], v236 offset:4160
    v_exp_f32 v139, v155
    v_mfma_f32_16x16x32_bf16 v[152:155], v[108:111], v[180:183], v[168:171]
    v_exp_f32 v140, v156
    v_mfma_f32_4x4x4_16b_bf16 v[212:215], v[208:209], v[190:191], v[212:215] cbsz:4 abid:4
    ds_read_b64_tr_b16 v[190:191], v236 offset:4672
    v_mfma_f32_4x4x4_16b_bf16 v[136:139], v[228:229], v[228:229], v[136:139]
    v_rcp_f32 v132, v132
    v_mfma_f32_4x4x4_16b_bf16 v[212:215], v[208:209], v[192:193], v[212:215] cbsz:4 abid:8
    ds_read_b64_tr_b16 v[192:193], v236 offset:5216
    v_exp_f32 v141, v157
    v_mfma_f32_16x16x32_bf16 v[148:151], v[104:107], v[184:187], v[148:151]
    v_rcp_f32 v133, v133
    v_mfma_f32_4x4x4_16b_bf16 v[212:215], v[208:209], v[194:195], v[212:215] cbsz:4 abid:12
    ds_read_b64_tr_b16 v[194:195], v236 offset:5728
    v_exp_f32 v142, v158
    v_mfma_f32_16x16x32_bf16 v[152:155], v[112:115], v[184:187], v[152:155]
    v_rcp_f32 v134, v134
    v_exp_f32 v143, v159
    v_rcp_f32 v135, v135
    v_cvt_pk_bf16_f32 v132, v132, v133
    v_mfma_f32_4x4x4_16b_bf16 v[140:143], v[228:229], v[228:229], v[140:143]
    v_exp_f32 v144, v160
    v_mfma_f32_16x16x32_bf16 v[156:159], v[116:119], v[180:183], v[172:175]
    v_rcp_f32 v136, v136
    v_cvt_pk_bf16_f32 v133, v134, v135
    v_exp_f32 v145, v161
    v_rcp_f32 v137, v137
    v_exp_f32 v146, v162
    v_rcp_f32 v138, v138
    v_cvt_pk_bf16_f32 v134, v136, v137
    v_exp_f32 v147, v163
    v_mfma_f32_16x16x32_bf16 v[160:163], v[124:127], v[180:183], v[176:179]
    s_waitcnt lgkmcnt(0)
    s_add_u32 m0, s52, 4160
    v_rcp_f32 v139, v139
    buffer_load_dwordx4 v[230:231], s[20:23], 0 idxen offen nt lds
    v_mfma_f32_4x4x4_16b_bf16 v[144:147], v[228:229], v[228:229], v[144:147]
    v_mfma_f32_16x16x32_bf16 v[156:159], v[120:123], v[184:187], v[156:159]
    s_add_u32 m0, s52, 5216
    v_rcp_f32 v140, v140
    buffer_load_dwordx4 v[232:233], s[20:23], 0 idxen offen nt lds
    v_mfma_f32_16x16x32_bf16 v[160:163], v[128:131], v[184:187], v[160:163]
    v_readfirstlane_b32 s66, v1
    s_setprio 0
    s_xor_b32 s66, s66, s33
    s_cmp_gt_i32 s66, 0
    s_cbranch_scc0 Ls_lo2
    s_setprio 1
Ls_lo2:
    v_rcp_f32 v141, v141
    v_cvt_pk_bf16_f32 v135, v138, v139
    s_waitcnt vmcnt(4)
    ds_read_b128 v[180:183], v234 offset:0
    ds_read_b128 v[184:187], v235 offset:0
    v_rcp_f32 v142, v142
    v_cvt_pk_bf16_f32 v136, v140, v141
    v_mfma_f32_16x16x32_bf16 v[208:211], v[132:135], v[196:199], v[204:207]
    v_rcp_f32 v143, v143
    v_rcp_f32 v144, v144
    v_cvt_pk_bf16_f32 v137, v142, v143
    v_rcp_f32 v145, v145
    v_rcp_f32 v146, v146
    v_rcp_f32 v147, v147
    v_cvt_pk_bf16_f32 v138, v144, v145
    v_cvt_pk_bf16_f32 v139, v146, v147
    ds_read_u8 v230, v237 offset:112
    ds_read_u8 v232, v237 offset:120
    v_mfma_f32_16x16x32_bf16 v[208:211], v[136:139], v[200:203], v[208:211]
    s_bitcmp1_b32 s36, 3
    s_cbranch_scc1 Ls_ev3
Ls_evd3:
    ds_read_b32 v246, v244 offset:48
    s_waitcnt lgkmcnt(0)
    v_bfe_u32 v247, v246, 0, 8
    v_lshlrev_b32 v247, 1, v247
    v_bfe_u32 v248, v246, 8, 8
    v_lshlrev_b32 v248, 1, v248
    v_bfe_u32 v249, v246, 16, 8
    v_lshlrev_b32 v249, 1, v249
    v_bfe_u32 v250, v246, 24, 8
    v_lshlrev_b32 v250, 1, v250
    buffer_load_ushort v247, v247, s[24:27], 0 offen
    buffer_load_ushort v248, v248, s[24:27], 0 offen
    buffer_load_ushort v249, v249, s[24:27], 0 offen
    buffer_load_ushort v250, v250, s[24:27], 0 offen
    s_waitcnt vmcnt(0)
    v_lshlrev_b32 v247, 16, v247
    v_mul_f32 v208, v208, v247
    v_lshlrev_b32 v248, 16, v248
    v_mul_f32 v209, v209, v248
    v_lshlrev_b32 v249, 16, v249
    v_mul_f32 v210, v210, v249
    v_lshlrev_b32 v250, 16, v250
    v_mul_f32 v211, v211, v250
    v_exp_f32 v132, v148
    v_exp_f32 v133, v149
    v_exp_f32 v134, v150
    v_exp_f32 v135, v151
    v_exp_f32 v136, v152
    v_exp_f32 v137, v153
    v_mfma_f32_4x4x4_16b_bf16 v[132:135], v[228:229], v[228:229], v[132:135]
    v_cvt_pk_bf16_f32 v208, v208, v209
    v_cvt_pk_bf16_f32 v209, v210, v211
    s_waitcnt lgkmcnt(2)
    v_mfma_f32_16x16x32_bf16 v[148:151], v[100:103], v[180:183], v[164:167]
    v_exp_f32 v138, v154
    v_mfma_f32_4x4x4_16b_bf16 v[212:215], v[208:209], v[188:189], v[212:215] cbsz:4 abid:0
    ds_read_b64_tr_b16 v[188:189], v236 offset:6240
    v_exp_f32 v139, v155
    v_mfma_f32_16x16x32_bf16 v[152:155], v[108:111], v[180:183], v[168:171]
    v_exp_f32 v140, v156
    v_mfma_f32_4x4x4_16b_bf16 v[212:215], v[208:209], v[190:191], v[212:215] cbsz:4 abid:4
    ds_read_b64_tr_b16 v[190:191], v236 offset:6752
    v_mfma_f32_4x4x4_16b_bf16 v[136:139], v[228:229], v[228:229], v[136:139]
    v_rcp_f32 v132, v132
    v_mfma_f32_4x4x4_16b_bf16 v[212:215], v[208:209], v[192:193], v[212:215] cbsz:4 abid:8
    ds_read_b64_tr_b16 v[192:193], v236 offset:7296
    v_exp_f32 v141, v157
    v_mfma_f32_16x16x32_bf16 v[148:151], v[104:107], v[184:187], v[148:151]
    v_rcp_f32 v133, v133
    v_mfma_f32_4x4x4_16b_bf16 v[212:215], v[208:209], v[194:195], v[212:215] cbsz:4 abid:12
    ds_read_b64_tr_b16 v[194:195], v236 offset:7808
    v_exp_f32 v142, v158
    v_mfma_f32_16x16x32_bf16 v[152:155], v[112:115], v[184:187], v[152:155]
    v_rcp_f32 v134, v134
    v_exp_f32 v143, v159
    v_rcp_f32 v135, v135
    v_cvt_pk_bf16_f32 v132, v132, v133
    v_mfma_f32_4x4x4_16b_bf16 v[140:143], v[228:229], v[228:229], v[140:143]
    v_exp_f32 v144, v160
    v_mfma_f32_16x16x32_bf16 v[156:159], v[116:119], v[180:183], v[172:175]
    v_rcp_f32 v136, v136
    v_cvt_pk_bf16_f32 v133, v134, v135
    v_exp_f32 v145, v161
    v_rcp_f32 v137, v137
    v_exp_f32 v146, v162
    v_rcp_f32 v138, v138
    v_cvt_pk_bf16_f32 v134, v136, v137
    v_exp_f32 v147, v163
    v_mfma_f32_16x16x32_bf16 v[160:163], v[124:127], v[180:183], v[176:179]
    s_waitcnt lgkmcnt(0)
    s_add_u32 m0, s52, 6240
    v_rcp_f32 v139, v139
    buffer_load_dwordx4 v[230:231], s[20:23], 0 idxen offen nt lds
    v_mfma_f32_4x4x4_16b_bf16 v[144:147], v[228:229], v[228:229], v[144:147]
    v_mfma_f32_16x16x32_bf16 v[156:159], v[120:123], v[184:187], v[156:159]
    s_add_u32 m0, s52, 7296
    v_rcp_f32 v140, v140
    buffer_load_dwordx4 v[232:233], s[20:23], 0 idxen offen nt lds
    v_mfma_f32_16x16x32_bf16 v[160:163], v[128:131], v[184:187], v[160:163]
    v_rcp_f32 v141, v141
    v_cvt_pk_bf16_f32 v135, v138, v139
    s_waitcnt vmcnt(4)
    ds_read_b128 v[180:183], v234 offset:2080
    ds_read_b128 v[184:187], v235 offset:2080
    v_rcp_f32 v142, v142
    v_cvt_pk_bf16_f32 v136, v140, v141
    v_mfma_f32_16x16x32_bf16 v[208:211], v[132:135], v[196:199], v[204:207]
    v_rcp_f32 v143, v143
    s_lshr_b64 s[56:57], s[56:57], 4
    s_lshl_b64 s[86:87], s[58:59], 60
    s_or_b64 s[56:57], s[56:57], s[86:87]
    s_lshr_b64 s[58:59], s[58:59], 4
    s_lshr_b64 s[86:87], s[56:57], 2
    s_lshr_b64 s[36:37], s[56:57], 5
    s_or_b32 s36, s36, s86
    s_or_b32 s36, s36, s56
    v_add_u32 v237, 64, v237
    v_add_u32 v244, 64, v244
    v_rcp_f32 v144, v144
    v_cvt_pk_bf16_f32 v137, v142, v143
    v_rcp_f32 v145, v145
    v_rcp_f32 v146, v146
    v_rcp_f32 v147, v147
    v_cvt_pk_bf16_f32 v138, v144, v145
    v_cvt_pk_bf16_f32 v139, v146, v147
    s_branch Ls_loop
Ls_ev0:
    s_bitcmp0_b64 s[56:57], 0
    s_cbranch_scc1 Ls_nf0
    v_cvt_pk_bf16_f32 v246, v212, v212
    v_mov_b32 v212, 0
    ds_write_b16 v240, v246
    v_add_u32 v240, 128, v240
    s_add_u32 s24, s24, s32
    s_addc_u32 s25, s25, 0
    s_xor_b32 s32, s32, 0x18ffe0
Ls_nf0:
    s_bitcmp0_b64 s[56:57], 5
    s_cbranch_scc1 Ls_na0
    s_sub_u32 s60, s60, 1
    s_cselect_b32 s31, 0, s31
    s_add_u32 s20, s20, s31
    s_addc_u32 s21, s21, 0
    s_xor_b32 s31, s31, 0x63ff800
Ls_na0:
    s_bitcmp0_b64 s[56:57], 2
    s_cbranch_scc1 Ls_evd0
    s_sub_u32 s61, s61, 1
    s_cbranch_scc1 Ls_last0
    v_mul_u32_u24 v216, v224, v241
    v_mul_u32_u24 v217, v224, v242
    v_mul_u32_u24 v218, v225, v241
    v_mul_u32_u24 v219, v225, v242
    v_mul_u32_u24 v220, v226, v241
    v_mul_u32_u24 v221, v226, v242
    v_mul_u32_u24 v222, v227, v241
    v_mul_u32_u24 v223, v227, v242
    v_add_u32 v238, 128, v238
    ds_read_b128 v[164:167], v239
    v_mfma_f32_4x4x4_16b_bf16 v[132:135], v[216:217], v[68:69], v[4:7]
    ds_read_b128 v[168:171], v239 offset:64
    ds_read_b128 v[172:175], v239 offset:128
    v_mfma_f32_4x4x4_16b_bf16 v[136:139], v[218:219], v[70:71], v[8:11]
    ds_read_b128 v[176:179], v239 offset:192
    ds_read_u16 v224, v238
    v_mfma_f32_4x4x4_16b_bf16 v[140:143], v[220:221], v[72:73], v[12:15]
    ds_read_u16 v225, v238 offset:8
    ds_read_u16 v226, v238 offset:64
    v_mfma_f32_4x4x4_16b_bf16 v[144:147], v[222:223], v[74:75], v[16:19]
    ds_read_u16 v227, v238 offset:72
    v_add_u32 v239, 272, v239
    v_mfma_f32_4x4x4_16b_bf16 v[246:249], v[216:217], v[76:77], v[20:23]
    v_cvt_pk_bf16_f32 v100, v132, v133
    v_cvt_pk_bf16_f32 v101, v134, v135
    v_mfma_f32_4x4x4_16b_bf16 v[250:253], v[218:219], v[78:79], v[24:27]
    v_cvt_pk_bf16_f32 v102, v136, v137
    v_cvt_pk_bf16_f32 v103, v138, v139
    v_mfma_f32_4x4x4_16b_bf16 v[132:135], v[220:221], v[80:81], v[28:31]
    v_cvt_pk_bf16_f32 v104, v140, v141
    v_cvt_pk_bf16_f32 v105, v142, v143
    v_mfma_f32_4x4x4_16b_bf16 v[136:139], v[222:223], v[82:83], v[32:35]
    v_cvt_pk_bf16_f32 v106, v144, v145
    v_cvt_pk_bf16_f32 v107, v146, v147
    v_mfma_f32_4x4x4_16b_bf16 v[140:143], v[216:217], v[84:85], v[36:39]
    v_cvt_pk_bf16_f32 v108, v246, v247
    v_cvt_pk_bf16_f32 v109, v248, v249
    v_mfma_f32_4x4x4_16b_bf16 v[144:147], v[218:219], v[86:87], v[40:43]
    v_cvt_pk_bf16_f32 v110, v250, v251
    v_cvt_pk_bf16_f32 v111, v252, v253
    v_mfma_f32_4x4x4_16b_bf16 v[246:249], v[220:221], v[88:89], v[44:47]
    v_cvt_pk_bf16_f32 v112, v132, v133
    v_cvt_pk_bf16_f32 v113, v134, v135
    v_mfma_f32_4x4x4_16b_bf16 v[250:253], v[222:223], v[90:91], v[48:51]
    v_cvt_pk_bf16_f32 v114, v136, v137
    v_cvt_pk_bf16_f32 v115, v138, v139
    v_mfma_f32_4x4x4_16b_bf16 v[132:135], v[216:217], v[92:93], v[52:55]
    v_cvt_pk_bf16_f32 v116, v140, v141
    v_cvt_pk_bf16_f32 v117, v142, v143
    v_mfma_f32_4x4x4_16b_bf16 v[136:139], v[218:219], v[94:95], v[56:59]
    v_cvt_pk_bf16_f32 v118, v144, v145
    v_cvt_pk_bf16_f32 v119, v146, v147
    v_mfma_f32_4x4x4_16b_bf16 v[140:143], v[220:221], v[96:97], v[60:63]
    v_cvt_pk_bf16_f32 v120, v246, v247
    v_cvt_pk_bf16_f32 v121, v248, v249
    v_mfma_f32_4x4x4_16b_bf16 v[144:147], v[222:223], v[98:99], v[64:67]
    v_cvt_pk_bf16_f32 v122, v250, v251
    v_cvt_pk_bf16_f32 v123, v252, v253
    v_cvt_pk_bf16_f32 v124, v132, v133
    v_cvt_pk_bf16_f32 v125, v134, v135
    v_cvt_pk_bf16_f32 v126, v136, v137
    v_cvt_pk_bf16_f32 v127, v138, v139
    v_cvt_pk_bf16_f32 v128, v140, v141
    v_cvt_pk_bf16_f32 v129, v142, v143
    v_cvt_pk_bf16_f32 v130, v144, v145
    v_cvt_pk_bf16_f32 v131, v146, v147
    s_waitcnt lgkmcnt(0)
    s_branch Ls_evd0
Ls_ev1:
    s_bitcmp0_b64 s[56:57], 1
    s_cbranch_scc1 Ls_nf1
    v_cvt_pk_bf16_f32 v246, v212, v212
    v_mov_b32 v212, 0
    ds_write_b16 v240, v246
    v_add_u32 v240, 128, v240
    s_add_u32 s24, s24, s32
    s_addc_u32 s25, s25, 0
    s_xor_b32 s32, s32, 0x18ffe0
Ls_nf1:
    s_bitcmp0_b64 s[56:57], 6
    s_cbranch_scc1 Ls_na1
    s_sub_u32 s60, s60, 1
    s_cselect_b32 s31, 0, s31
    s_add_u32 s20, s20, s31
    s_addc_u32 s21, s21, 0
    s_xor_b32 s31, s31, 0x63ff800
Ls_na1:
    s_bitcmp0_b64 s[56:57], 3
    s_cbranch_scc1 Ls_evd1
    s_sub_u32 s61, s61, 1
    s_cbranch_scc1 Ls_last1
    v_mul_u32_u24 v216, v224, v241
    v_mul_u32_u24 v217, v224, v242
    v_mul_u32_u24 v218, v225, v241
    v_mul_u32_u24 v219, v225, v242
    v_mul_u32_u24 v220, v226, v241
    v_mul_u32_u24 v221, v226, v242
    v_mul_u32_u24 v222, v227, v241
    v_mul_u32_u24 v223, v227, v242
    v_add_u32 v238, 128, v238
    ds_read_b128 v[164:167], v239
    v_mfma_f32_4x4x4_16b_bf16 v[132:135], v[216:217], v[68:69], v[4:7]
    ds_read_b128 v[168:171], v239 offset:64
    ds_read_b128 v[172:175], v239 offset:128
    v_mfma_f32_4x4x4_16b_bf16 v[136:139], v[218:219], v[70:71], v[8:11]
    ds_read_b128 v[176:179], v239 offset:192
    ds_read_u16 v224, v238
    v_mfma_f32_4x4x4_16b_bf16 v[140:143], v[220:221], v[72:73], v[12:15]
    ds_read_u16 v225, v238 offset:8
    ds_read_u16 v226, v238 offset:64
    v_mfma_f32_4x4x4_16b_bf16 v[144:147], v[222:223], v[74:75], v[16:19]
    ds_read_u16 v227, v238 offset:72
    v_add_u32 v239, 272, v239
    v_mfma_f32_4x4x4_16b_bf16 v[246:249], v[216:217], v[76:77], v[20:23]
    v_cvt_pk_bf16_f32 v100, v132, v133
    v_cvt_pk_bf16_f32 v101, v134, v135
    v_mfma_f32_4x4x4_16b_bf16 v[250:253], v[218:219], v[78:79], v[24:27]
    v_cvt_pk_bf16_f32 v102, v136, v137
    v_cvt_pk_bf16_f32 v103, v138, v139
    v_mfma_f32_4x4x4_16b_bf16 v[132:135], v[220:221], v[80:81], v[28:31]
    v_cvt_pk_bf16_f32 v104, v140, v141
    v_cvt_pk_bf16_f32 v105, v142, v143
    v_mfma_f32_4x4x4_16b_bf16 v[136:139], v[222:223], v[82:83], v[32:35]
    v_cvt_pk_bf16_f32 v106, v144, v145
    v_cvt_pk_bf16_f32 v107, v146, v147
    v_mfma_f32_4x4x4_16b_bf16 v[140:143], v[216:217], v[84:85], v[36:39]
    v_cvt_pk_bf16_f32 v108, v246, v247
    v_cvt_pk_bf16_f32 v109, v248, v249
    v_mfma_f32_4x4x4_16b_bf16 v[144:147], v[218:219], v[86:87], v[40:43]
    v_cvt_pk_bf16_f32 v110, v250, v251
    v_cvt_pk_bf16_f32 v111, v252, v253
    v_mfma_f32_4x4x4_16b_bf16 v[246:249], v[220:221], v[88:89], v[44:47]
    v_cvt_pk_bf16_f32 v112, v132, v133
    v_cvt_pk_bf16_f32 v113, v134, v135
    v_mfma_f32_4x4x4_16b_bf16 v[250:253], v[222:223], v[90:91], v[48:51]
    v_cvt_pk_bf16_f32 v114, v136, v137
    v_cvt_pk_bf16_f32 v115, v138, v139
    v_mfma_f32_4x4x4_16b_bf16 v[132:135], v[216:217], v[92:93], v[52:55]
    v_cvt_pk_bf16_f32 v116, v140, v141
    v_cvt_pk_bf16_f32 v117, v142, v143
    v_mfma_f32_4x4x4_16b_bf16 v[136:139], v[218:219], v[94:95], v[56:59]
    v_cvt_pk_bf16_f32 v118, v144, v145
    v_cvt_pk_bf16_f32 v119, v146, v147
    v_mfma_f32_4x4x4_16b_bf16 v[140:143], v[220:221], v[96:97], v[60:63]
    v_cvt_pk_bf16_f32 v120, v246, v247
    v_cvt_pk_bf16_f32 v121, v248, v249
    v_mfma_f32_4x4x4_16b_bf16 v[144:147], v[222:223], v[98:99], v[64:67]
    v_cvt_pk_bf16_f32 v122, v250, v251
    v_cvt_pk_bf16_f32 v123, v252, v253
    v_cvt_pk_bf16_f32 v124, v132, v133
    v_cvt_pk_bf16_f32 v125, v134, v135
    v_cvt_pk_bf16_f32 v126, v136, v137
    v_cvt_pk_bf16_f32 v127, v138, v139
    v_cvt_pk_bf16_f32 v128, v140, v141
    v_cvt_pk_bf16_f32 v129, v142, v143
    v_cvt_pk_bf16_f32 v130, v144, v145
    v_cvt_pk_bf16_f32 v131, v146, v147
    s_waitcnt lgkmcnt(0)
    s_branch Ls_evd1
Ls_ev2:
    s_bitcmp0_b64 s[56:57], 2
    s_cbranch_scc1 Ls_nf2
    v_cvt_pk_bf16_f32 v246, v212, v212
    v_mov_b32 v212, 0
    ds_write_b16 v240, v246
    v_add_u32 v240, 128, v240
    s_add_u32 s24, s24, s32
    s_addc_u32 s25, s25, 0
    s_xor_b32 s32, s32, 0x18ffe0
Ls_nf2:
    s_bitcmp0_b64 s[56:57], 7
    s_cbranch_scc1 Ls_na2
    s_sub_u32 s60, s60, 1
    s_cselect_b32 s31, 0, s31
    s_add_u32 s20, s20, s31
    s_addc_u32 s21, s21, 0
    s_xor_b32 s31, s31, 0x63ff800
Ls_na2:
    s_bitcmp0_b64 s[56:57], 4
    s_cbranch_scc1 Ls_evd2
    s_sub_u32 s61, s61, 1
    s_cbranch_scc1 Ls_last2
    v_mul_u32_u24 v216, v224, v241
    v_mul_u32_u24 v217, v224, v242
    v_mul_u32_u24 v218, v225, v241
    v_mul_u32_u24 v219, v225, v242
    v_mul_u32_u24 v220, v226, v241
    v_mul_u32_u24 v221, v226, v242
    v_mul_u32_u24 v222, v227, v241
    v_mul_u32_u24 v223, v227, v242
    v_add_u32 v238, 128, v238
    ds_read_b128 v[164:167], v239
    v_mfma_f32_4x4x4_16b_bf16 v[132:135], v[216:217], v[68:69], v[4:7]
    ds_read_b128 v[168:171], v239 offset:64
    ds_read_b128 v[172:175], v239 offset:128
    v_mfma_f32_4x4x4_16b_bf16 v[136:139], v[218:219], v[70:71], v[8:11]
    ds_read_b128 v[176:179], v239 offset:192
    ds_read_u16 v224, v238
    v_mfma_f32_4x4x4_16b_bf16 v[140:143], v[220:221], v[72:73], v[12:15]
    ds_read_u16 v225, v238 offset:8
    ds_read_u16 v226, v238 offset:64
    v_mfma_f32_4x4x4_16b_bf16 v[144:147], v[222:223], v[74:75], v[16:19]
    ds_read_u16 v227, v238 offset:72
    v_add_u32 v239, 272, v239
    v_mfma_f32_4x4x4_16b_bf16 v[246:249], v[216:217], v[76:77], v[20:23]
    v_cvt_pk_bf16_f32 v100, v132, v133
    v_cvt_pk_bf16_f32 v101, v134, v135
    v_mfma_f32_4x4x4_16b_bf16 v[250:253], v[218:219], v[78:79], v[24:27]
    v_cvt_pk_bf16_f32 v102, v136, v137
    v_cvt_pk_bf16_f32 v103, v138, v139
    v_mfma_f32_4x4x4_16b_bf16 v[132:135], v[220:221], v[80:81], v[28:31]
    v_cvt_pk_bf16_f32 v104, v140, v141
    v_cvt_pk_bf16_f32 v105, v142, v143
    v_mfma_f32_4x4x4_16b_bf16 v[136:139], v[222:223], v[82:83], v[32:35]
    v_cvt_pk_bf16_f32 v106, v144, v145
    v_cvt_pk_bf16_f32 v107, v146, v147
    v_mfma_f32_4x4x4_16b_bf16 v[140:143], v[216:217], v[84:85], v[36:39]
    v_cvt_pk_bf16_f32 v108, v246, v247
    v_cvt_pk_bf16_f32 v109, v248, v249
    v_mfma_f32_4x4x4_16b_bf16 v[144:147], v[218:219], v[86:87], v[40:43]
    v_cvt_pk_bf16_f32 v110, v250, v251
    v_cvt_pk_bf16_f32 v111, v252, v253
    v_mfma_f32_4x4x4_16b_bf16 v[246:249], v[220:221], v[88:89], v[44:47]
    v_cvt_pk_bf16_f32 v112, v132, v133
    v_cvt_pk_bf16_f32 v113, v134, v135
    v_mfma_f32_4x4x4_16b_bf16 v[250:253], v[222:223], v[90:91], v[48:51]
    v_cvt_pk_bf16_f32 v114, v136, v137
    v_cvt_pk_bf16_f32 v115, v138, v139
    v_mfma_f32_4x4x4_16b_bf16 v[132:135], v[216:217], v[92:93], v[52:55]
    v_cvt_pk_bf16_f32 v116, v140, v141
    v_cvt_pk_bf16_f32 v117, v142, v143
    v_mfma_f32_4x4x4_16b_bf16 v[136:139], v[218:219], v[94:95], v[56:59]
    v_cvt_pk_bf16_f32 v118, v144, v145
    v_cvt_pk_bf16_f32 v119, v146, v147
    v_mfma_f32_4x4x4_16b_bf16 v[140:143], v[220:221], v[96:97], v[60:63]
    v_cvt_pk_bf16_f32 v120, v246, v247
    v_cvt_pk_bf16_f32 v121, v248, v249
    v_mfma_f32_4x4x4_16b_bf16 v[144:147], v[222:223], v[98:99], v[64:67]
    v_cvt_pk_bf16_f32 v122, v250, v251
    v_cvt_pk_bf16_f32 v123, v252, v253
    v_cvt_pk_bf16_f32 v124, v132, v133
    v_cvt_pk_bf16_f32 v125, v134, v135
    v_cvt_pk_bf16_f32 v126, v136, v137
    v_cvt_pk_bf16_f32 v127, v138, v139
    v_cvt_pk_bf16_f32 v128, v140, v141
    v_cvt_pk_bf16_f32 v129, v142, v143
    v_cvt_pk_bf16_f32 v130, v144, v145
    v_cvt_pk_bf16_f32 v131, v146, v147
    s_waitcnt lgkmcnt(0)
    s_branch Ls_evd2
Ls_ev3:
    s_bitcmp0_b64 s[56:57], 3
    s_cbranch_scc1 Ls_nf3
    v_cvt_pk_bf16_f32 v246, v212, v212
    v_mov_b32 v212, 0
    ds_write_b16 v240, v246
    v_add_u32 v240, 128, v240
    s_add_u32 s24, s24, s32
    s_addc_u32 s25, s25, 0
    s_xor_b32 s32, s32, 0x18ffe0
Ls_nf3:
    s_bitcmp0_b64 s[56:57], 8
    s_cbranch_scc1 Ls_na3
    s_sub_u32 s60, s60, 1
    s_cselect_b32 s31, 0, s31
    s_add_u32 s20, s20, s31
    s_addc_u32 s21, s21, 0
    s_xor_b32 s31, s31, 0x63ff800
Ls_na3:
    s_bitcmp0_b64 s[56:57], 5
    s_cbranch_scc1 Ls_evd3
    s_sub_u32 s61, s61, 1
    s_cbranch_scc1 Ls_last3
    v_mul_u32_u24 v216, v224, v241
    v_mul_u32_u24 v217, v224, v242
    v_mul_u32_u24 v218, v225, v241
    v_mul_u32_u24 v219, v225, v242
    v_mul_u32_u24 v220, v226, v241
    v_mul_u32_u24 v221, v226, v242
    v_mul_u32_u24 v222, v227, v241
    v_mul_u32_u24 v223, v227, v242
    v_add_u32 v238, 128, v238
    ds_read_b128 v[164:167], v239
    v_mfma_f32_4x4x4_16b_bf16 v[132:135], v[216:217], v[68:69], v[4:7]
    ds_read_b128 v[168:171], v239 offset:64
    ds_read_b128 v[172:175], v239 offset:128
    v_mfma_f32_4x4x4_16b_bf16 v[136:139], v[218:219], v[70:71], v[8:11]
    ds_read_b128 v[176:179], v239 offset:192
    ds_read_u16 v224, v238
    v_mfma_f32_4x4x4_16b_bf16 v[140:143], v[220:221], v[72:73], v[12:15]
    ds_read_u16 v225, v238 offset:8
    ds_read_u16 v226, v238 offset:64
    v_mfma_f32_4x4x4_16b_bf16 v[144:147], v[222:223], v[74:75], v[16:19]
    ds_read_u16 v227, v238 offset:72
    v_add_u32 v239, 272, v239
    v_mfma_f32_4x4x4_16b_bf16 v[246:249], v[216:217], v[76:77], v[20:23]
    v_cvt_pk_bf16_f32 v100, v132, v133
    v_cvt_pk_bf16_f32 v101, v134, v135
    v_mfma_f32_4x4x4_16b_bf16 v[250:253], v[218:219], v[78:79], v[24:27]
    v_cvt_pk_bf16_f32 v102, v136, v137
    v_cvt_pk_bf16_f32 v103, v138, v139
    v_mfma_f32_4x4x4_16b_bf16 v[132:135], v[220:221], v[80:81], v[28:31]
    v_cvt_pk_bf16_f32 v104, v140, v141
    v_cvt_pk_bf16_f32 v105, v142, v143
    v_mfma_f32_4x4x4_16b_bf16 v[136:139], v[222:223], v[82:83], v[32:35]
    v_cvt_pk_bf16_f32 v106, v144, v145
    v_cvt_pk_bf16_f32 v107, v146, v147
    v_mfma_f32_4x4x4_16b_bf16 v[140:143], v[216:217], v[84:85], v[36:39]
    v_cvt_pk_bf16_f32 v108, v246, v247
    v_cvt_pk_bf16_f32 v109, v248, v249
    v_mfma_f32_4x4x4_16b_bf16 v[144:147], v[218:219], v[86:87], v[40:43]
    v_cvt_pk_bf16_f32 v110, v250, v251
    v_cvt_pk_bf16_f32 v111, v252, v253
    v_mfma_f32_4x4x4_16b_bf16 v[246:249], v[220:221], v[88:89], v[44:47]
    v_cvt_pk_bf16_f32 v112, v132, v133
    v_cvt_pk_bf16_f32 v113, v134, v135
    v_mfma_f32_4x4x4_16b_bf16 v[250:253], v[222:223], v[90:91], v[48:51]
    v_cvt_pk_bf16_f32 v114, v136, v137
    v_cvt_pk_bf16_f32 v115, v138, v139
    v_mfma_f32_4x4x4_16b_bf16 v[132:135], v[216:217], v[92:93], v[52:55]
    v_cvt_pk_bf16_f32 v116, v140, v141
    v_cvt_pk_bf16_f32 v117, v142, v143
    v_mfma_f32_4x4x4_16b_bf16 v[136:139], v[218:219], v[94:95], v[56:59]
    v_cvt_pk_bf16_f32 v118, v144, v145
    v_cvt_pk_bf16_f32 v119, v146, v147
    v_mfma_f32_4x4x4_16b_bf16 v[140:143], v[220:221], v[96:97], v[60:63]
    v_cvt_pk_bf16_f32 v120, v246, v247
    v_cvt_pk_bf16_f32 v121, v248, v249
    v_mfma_f32_4x4x4_16b_bf16 v[144:147], v[222:223], v[98:99], v[64:67]
    v_cvt_pk_bf16_f32 v122, v250, v251
    v_cvt_pk_bf16_f32 v123, v252, v253
    v_cvt_pk_bf16_f32 v124, v132, v133
    v_cvt_pk_bf16_f32 v125, v134, v135
    v_cvt_pk_bf16_f32 v126, v136, v137
    v_cvt_pk_bf16_f32 v127, v138, v139
    v_cvt_pk_bf16_f32 v128, v140, v141
    v_cvt_pk_bf16_f32 v129, v142, v143
    v_cvt_pk_bf16_f32 v130, v144, v145
    v_cvt_pk_bf16_f32 v131, v146, v147
    s_waitcnt lgkmcnt(0)
    s_branch Ls_evd3
Ls_last0:
    s_branch Ls_tail
Ls_last1:
    v_add_u32 v236, 2080, v236
    s_lshr_b64 s[56:57], s[56:57], 1
    v_add_u32 v244, 16, v244
    s_branch Ls_tail
Ls_last2:
    v_add_u32 v236, 4160, v236
    s_lshr_b64 s[56:57], s[56:57], 2
    v_add_u32 v244, 32, v244
    s_branch Ls_tail
Ls_last3:
    v_add_u32 v236, 6240, v236
    s_lshr_b64 s[56:57], s[56:57], 3
    v_add_u32 v244, 48, v244
Ls_tail:
    ds_read_b32 v246, v244 offset:0
    s_waitcnt lgkmcnt(0)
    v_bfe_u32 v247, v246, 0, 8
    v_lshlrev_b32 v247, 1, v247
    v_bfe_u32 v248, v246, 8, 8
    v_lshlrev_b32 v248, 1, v248
    v_bfe_u32 v249, v246, 16, 8
    v_lshlrev_b32 v249, 1, v249
    v_bfe_u32 v250, v246, 24, 8
    v_lshlrev_b32 v250, 1, v250
    buffer_load_ushort v247, v247, s[24:27], 0 offen
    buffer_load_ushort v248, v248, s[24:27], 0 offen
    buffer_load_ushort v249, v249, s[24:27], 0 offen
    buffer_load_ushort v250, v250, s[24:27], 0 offen
    s_waitcnt vmcnt(0)
    v_lshlrev_b32 v247, 16, v247
    v_mul_f32 v208, v208, v247
    v_lshlrev_b32 v248, 16, v248
    v_mul_f32 v209, v209, v248
    v_lshlrev_b32 v249, 16, v249
    v_mul_f32 v210, v210, v249
    v_lshlrev_b32 v250, 16, v250
    v_mul_f32 v211, v211, v250
    v_exp_f32 v132, v148
    v_exp_f32 v133, v149
    v_exp_f32 v134, v150
    v_exp_f32 v135, v151
    v_exp_f32 v136, v152
    v_exp_f32 v137, v153
    v_mfma_f32_4x4x4_16b_bf16 v[132:135], v[228:229], v[228:229], v[132:135]
    v_cvt_pk_bf16_f32 v208, v208, v209
    v_cvt_pk_bf16_f32 v209, v210, v211
    v_exp_f32 v138, v154
    s_nop 0
    v_mfma_f32_4x4x4_16b_bf16 v[212:215], v[208:209], v[188:189], v[212:215] cbsz:4 abid:0
    ds_read_b64_tr_b16 v[188:189], v236 offset:0
    v_exp_f32 v139, v155
    v_exp_f32 v140, v156
    v_mfma_f32_4x4x4_16b_bf16 v[212:215], v[208:209], v[190:191], v[212:215] cbsz:4 abid:4
    ds_read_b64_tr_b16 v[190:191], v236 offset:512
    v_mfma_f32_4x4x4_16b_bf16 v[136:139], v[228:229], v[228:229], v[136:139]
    v_rcp_f32 v132, v132
    v_mfma_f32_4x4x4_16b_bf16 v[212:215], v[208:209], v[192:193], v[212:215] cbsz:4 abid:8
    ds_read_b64_tr_b16 v[192:193], v236 offset:1056
    v_exp_f32 v141, v157
    v_rcp_f32 v133, v133
    v_mfma_f32_4x4x4_16b_bf16 v[212:215], v[208:209], v[194:195], v[212:215] cbsz:4 abid:12
    ds_read_b64_tr_b16 v[194:195], v236 offset:1568
    v_exp_f32 v142, v158
    v_rcp_f32 v134, v134
    v_exp_f32 v143, v159
    v_rcp_f32 v135, v135
    v_cvt_pk_bf16_f32 v132, v132, v133
    v_mfma_f32_4x4x4_16b_bf16 v[140:143], v[228:229], v[228:229], v[140:143]
    v_exp_f32 v144, v160
    v_rcp_f32 v136, v136
    v_cvt_pk_bf16_f32 v133, v134, v135
    s_bitcmp0_b64 s[56:57], 1
    s_cbranch_scc1 Ls_tnf
    v_cvt_pk_bf16_f32 v246, v212, v212
    v_mov_b32 v212, 0
    ds_write_b16 v240, v246
    v_add_u32 v240, 128, v240
    s_add_u32 s24, s24, s32
    s_addc_u32 s25, s25, 0
    s_xor_b32 s32, s32, 0x18ffe0
Ls_tnf:
    v_exp_f32 v145, v161
    v_rcp_f32 v137, v137
    v_exp_f32 v146, v162
    v_rcp_f32 v138, v138
    v_cvt_pk_bf16_f32 v134, v136, v137
    v_exp_f32 v147, v163
    s_waitcnt lgkmcnt(0)
    v_rcp_f32 v139, v139
    v_mfma_f32_4x4x4_16b_bf16 v[144:147], v[228:229], v[228:229], v[144:147]
    v_rcp_f32 v140, v140
    v_rcp_f32 v141, v141
    v_cvt_pk_bf16_f32 v135, v138, v139
    v_rcp_f32 v142, v142
    v_cvt_pk_bf16_f32 v136, v140, v141
    v_mfma_f32_16x16x32_bf16 v[208:211], v[132:135], v[196:199], v[204:207]
    v_rcp_f32 v143, v143
    v_rcp_f32 v144, v144
    v_cvt_pk_bf16_f32 v137, v142, v143
    v_rcp_f32 v145, v145
    v_rcp_f32 v146, v146
    v_rcp_f32 v147, v147
    v_cvt_pk_bf16_f32 v138, v144, v145
    v_cvt_pk_bf16_f32 v139, v146, v147
    s_nop 1
    v_mfma_f32_16x16x32_bf16 v[208:211], v[136:139], v[200:203], v[208:211]
    ds_read_b32 v246, v244 offset:16
    s_waitcnt lgkmcnt(0)
    v_bfe_u32 v247, v246, 0, 8
    v_lshlrev_b32 v247, 1, v247
    v_bfe_u32 v248, v246, 8, 8
    v_lshlrev_b32 v248, 1, v248
    v_bfe_u32 v249, v246, 16, 8
    v_lshlrev_b32 v249, 1, v249
    v_bfe_u32 v250, v246, 24, 8
    v_lshlrev_b32 v250, 1, v250
    buffer_load_ushort v247, v247, s[24:27], 0 offen
    buffer_load_ushort v248, v248, s[24:27], 0 offen
    buffer_load_ushort v249, v249, s[24:27], 0 offen
    buffer_load_ushort v250, v250, s[24:27], 0 offen
    s_waitcnt vmcnt(0)
    v_lshlrev_b32 v247, 16, v247
    v_mul_f32 v208, v208, v247
    v_lshlrev_b32 v248, 16, v248
    v_mul_f32 v209, v209, v248
    v_lshlrev_b32 v249, 16, v249
    v_mul_f32 v210, v210, v249
    v_lshlrev_b32 v250, 16, v250
    v_mul_f32 v211, v211, v250
    v_cvt_pk_bf16_f32 v208, v208, v209
    v_cvt_pk_bf16_f32 v209, v210, v211
    s_nop 1
    v_mfma_f32_4x4x4_16b_bf16 v[212:215], v[208:209], v[188:189], v[212:215] cbsz:4 abid:0
    s_nop 1
    v_mfma_f32_4x4x4_16b_bf16 v[212:215], v[208:209], v[190:191], v[212:215] cbsz:4 abid:4
    s_nop 1
    v_mfma_f32_4x4x4_16b_bf16 v[212:215], v[208:209], v[192:193], v[212:215] cbsz:4 abid:8
    s_nop 1
    v_mfma_f32_4x4x4_16b_bf16 v[212:215], v[208:209], v[194:195], v[212:215] cbsz:4 abid:12
    s_nop 4
    v_cvt_pk_bf16_f32 v246, v212, v212
    ds_write_b16 v240, v246
    s_branch L_store
.section .rodata,"a"
.p2align 6
.amdhsa_kernel standalone__sequential_behavior_din__recsys_kernel
  .amdhsa_next_free_vgpr 256
  .amdhsa_next_free_sgpr 102
  .amdhsa_accum_offset 256
  .amdhsa_group_segment_fixed_size 0
  .amdhsa_kernarg_size 80
  .amdhsa_user_sgpr_count 2
  .amdhsa_user_sgpr_kernarg_segment_ptr 1
  .amdhsa_system_sgpr_workgroup_id_x 1
.end_amdhsa_kernel
```

```asm
; @launch grid=(256,1,1) block=(512,1,1) lds=163840
.amdgcn_target "amdgcn-amd-amdhsa--gfx950"
.text
.globl standalone__sequential_behavior_din__recsys_kernel
.p2align 8
.type standalone__sequential_behavior_din__recsys_kernel,@function
standalone__sequential_behavior_din__recsys_kernel:
    s_load_dwordx16 s[4:19], s[0:1], 0
    s_cmp_ge_u32 s2, 256
    s_cbranch_scc1 L_end
    v_lshrrev_b32 v1, 6, v0
    v_and_b32 v0, 63, v0
    v_readfirstlane_b32 s54, v1
    s_lshl_b32 s53, s2, 3
    v_lshlrev_b32 v2, 4, v0
    s_bfm_b64 s[28:29], 50, 0
    s_add_u32 s53, s53, s54
    s_mul_i32 s66, s53, 800
    s_mul_i32 s52, s54, 20480
    v_add_u32 v3, s66, v2
    v_and_b32 v248, 16, v0
    v_lshlrev_b32 v246, 1, v248
    v_xor_b32 v246, v246, v2
    s_lshl_b32 s67, s54, 12
    s_add_u32 m0, s52, 4160
    s_mov_b64 exec, s[28:29]
    s_waitcnt lgkmcnt(0)
    global_load_dwordx4 v[100:103], v3, s[8:9] nt
    s_mov_b64 exec, -1
    s_add_u32 s10, s10, s67
    s_addc_u32 s11, s11, 0
    v_xor_b32 v247, 64, v246
    global_load_lds_dwordx4 v246, s[10:11] offset:0
    global_load_lds_dwordx4 v247, s[10:11] offset:1024
    global_load_lds_dwordx4 v246, s[10:11] offset:2048
    global_load_lds_dwordx4 v247, s[10:11] offset:3072
    s_load_dword s30, s[16:17], 0
    v_lshrrev_b32 v1, 4, v0
    v_and_b32 v243, 0xf0, v2
    v_lshl_add_u32 v243, v1, 19, v243
    s_lshl_b32 s66, s53, 8
    s_add_u32 m0, s52, 8320
    v_add_u32 v243, s66, v243
    s_and_b32 s67, s54, 3
    global_load_lds_dwordx4 v243, s[4:5] nt
    s_lshl_b32 s66, s67, 5
    v_lshl_add_u32 v249, v1, 3, s66
    global_load_dwordx2 v[96:97], v249, s[12:13]
    v_and_b32 v250, 3, v0
    s_mul_i32 s66, s53, 51200
    s_add_u32 s6, s6, s66
    s_addc_u32 s7, s7, 0
    s_mov_b32 s20, s6
    s_and_b32 s21, s7, 0xffff
    s_or_b32 s21, s21, 0x800000
    s_mov_b32 s22, 200
    s_mov_b32 s23, 0x20000
    s_sub_u32 s6, s6, 1056
    s_subb_u32 s7, s7, 0
    s_mov_b32 s40, s6
    s_and_b32 s41, s7, 0xffff
    s_or_b32 s41, s41, 0x800000
    s_mov_b32 s42, 200
    s_mov_b32 s43, 0x20000
    s_movk_i32 s31, 25600
    v_mov_b32 v148, -1
    v_mov_b32 v149, -1
    v_mov_b32 v150, -1
    v_mov_b32 v151, -1
    s_add_u32 s66, s52, 18432
    v_add_u32 v152, s66, v2
    ds_write_b128 v152, v[148:151]
    ds_write_b128 v152, v[148:151] offset:1024
    v_mov_b32 v153, -1
    v_mov_b32 v154, -1
    v_mov_b32 v155, -1
    s_add_u32 s64, s52, 18448
    v_lshrrev_b32 v237, 3, v0
    v_add_u32 v237, s64, v237
    v_lshl_add_u32 v244, v1, 2, s66
    v_and_b32 v231, 0x70, v2
    v_lshlrev_b32 v248, 2, v248
    v_xor_b32 v231, v231, v248
    v_mov_b32 v233, v231
    v_cmp_lt_u32 vcc, 24, v0
    v_mov_b32 v146, 0
    v_mov_b32 v147, 0
    v_cndmask_b32 v145, 0, 1, vcc
    v_mul_u32_u24 v142, 25, v145
    v_sub_u32 v142, v0, v142
    v_mul_u32_u24 v142, 0x80008, v142
    v_add_u32 v141, 0x10000, v142
    v_add_u32 v143, 0x50004, v142
    v_add_u32 v144, 0x70006, v142
    v_add_u32 v142, 0x30002, v142
    s_mov_b64 s[56:57], 0
    s_mov_b64 s[58:59], 0
    s_mov_b32 s60, 7
    s_mov_b32 s61, 7
    s_mov_b32 s92, 0xbfb8aa3b
    v_and_b32 v251, 15, v0
    v_bfe_u32 v252, v0, 2, 2
    v_lshlrev_b32 v253, 3, v250
    v_lshl_add_u32 v253, v252, 7, v253
    v_and_b32 v246, 24, v0
    v_lshlrev_b32 v246, 2, v246
    v_xor_b32 v246, v253, v246
    v_lshl_add_u32 v246, v1, 10, v246
    s_lshl_b32 s66, s67, 5
    v_xor_b32 v66, s66, v246
    v_add_u32 v66, 45120, v66
    s_lshr_b32 s66, s54, 1
    s_lshl_b32 s66, s66, 5
    v_xor_b32 v64, s66, v246
    s_and_b32 s66, s54, 1
    s_mul_i32 s66, s66, 20480
    s_add_u32 s66, s66, 4160
    v_add_u32 v64, s66, v64
    v_add_u32 v65, 81920, v64
    s_and_b32 s66, s54, 4
    v_lshrrev_b32 v246, 3, v251
    v_add_u32 v246, s66, v246
    v_mul_u32_u24 v246, 20480, v246
    v_lshl_add_u32 v246, v1, 4, v246
    v_and_b32 v247, 7, v0
    v_lshl_add_u32 v67, v247, 7, v246
    v_and_b32 v247, 1, v0
    v_lshlrev_b32 v247, 4, v247
    v_lshlrev_b32 v247, v247, 1
    v_cmp_gt_u32 vcc, 2, v250
    v_mov_b32 v229, 0
    v_mov_b32 v228, 0x3f80
    v_cndmask_b32 v241, 0, v247, vcc
    v_cmp_eq_u32 vcc, 0, v251
    v_sub_u32 v242, v247, v241
    v_mul_u32_u24 v218, 0x3f80, v241
    v_cndmask_b32 v220, 0, -1, vcc
    v_mul_u32_u24 v219, 0x3f80, v242
    s_and_b32 s66, s54, 3
    s_lshl_b32 s66, s66, 6
    s_add_u32 s66, s66, 9344
    v_and_b32 v247, 7, v0
    v_mul_u32_u24 v247, 144, v247
    v_add3_u32 v98, v67, v247, s66
    s_and_b32 s66, s54, 3
    s_mul_i32 s66, s66, 20480
    s_add_u32 s66, s66, 14592
    v_mov_b32 v221, s66
    s_cmp_ge_u32 s54, 4
    s_cselect_b32 s33, -1, 0
    ds_write_b32 v221, v229
    v_and_b32 v247, 8, v0
    v_lshlrev_b32 v247, 2, v247
    v_lshl_add_u32 v247, v251, 7, v247
    v_add_u32 v247, s52, v247
    v_and_b32 v248, 2, v0
    v_lshlrev_b32 v248, 1, v248
    v_xor_b32 v248, v248, v1
    v_lshl_add_u32 v234, v248, 4, v247
    v_xor_b32 v248, 4, v248
    v_lshl_add_u32 v235, v248, 4, v247
    v_and_b32 v247, 8, v0
    v_lshlrev_b32 v247, 3, v247
    v_lshl_add_u32 v248, v1, 5, v253
    v_xor_b32 v248, v248, v247
    v_add_u32 v236, s52, v248
    s_add_u32 s66, s52, 8320
    v_lshl_add_u32 v238, v250, 1, s66
    v_lshl_add_u32 v238, v1, 4, v238
    v_lshl_add_u32 v240, v0, 1, s66
    s_add_u32 s66, s52, 9344
    v_lshl_add_u32 v239, v1, 4, s66
    v_mov_b32 v188, 0
    v_mov_b32 v189, 0
    v_mov_b32 v190, 0
    v_mov_b32 v191, 0
    v_mov_b32 v192, 0
    v_mov_b32 v193, 0
    v_mov_b32 v194, 0
    v_mov_b32 v195, 0
    v_mov_b32 v208, 0
    v_mov_b32 v212, 0
    v_mov_b32 v209, 0
    v_mov_b32 v213, 0
    v_mov_b32 v210, 0
    v_mov_b32 v214, 0
    v_mov_b32 v211, 0
    v_mov_b32 v215, 0
    s_mov_b64 exec, s[28:29]
    v_add_u32 v3, 1638400, v3
    global_load_dwordx4 v[104:107], v3, s[8:9] nt
    v_add_u32 v3, 1638400, v3
    global_load_dwordx4 v[108:111], v3, s[8:9] nt
    v_add_u32 v3, 1638400, v3
    global_load_dwordx4 v[112:115], v3, s[8:9] nt
    s_mov_b64 exec, -1
    v_lshlrev_b32 v249, 3, v1
    v_lshl_add_u32 v249, v250, 5, v249
    global_load_dwordx2 v[216:217], v249, s[14:15]
    s_cmp_ge_u32 s54, 4
    s_cbranch_scc1 L_young1
    s_waitcnt vmcnt(10) lgkmcnt(0)
    s_call_b64 s[62:63], L_fp
    s_waitcnt vmcnt(9)
    s_branch L_old1
L_young1:
    s_waitcnt vmcnt(5)
L_old1:
    s_waitcnt lgkmcnt(0)
    s_barrier
    ds_read_b64_tr_b16 v[16:17], v66 offset:0
    ds_read_b64_tr_b16 v[18:19], v66 offset:512
    ds_read_b64_tr_b16 v[20:21], v66 offset:20480
    ds_read_b64_tr_b16 v[22:23], v66 offset:20992
    ds_read_b64_tr_b16 v[24:25], v66 offset:40960
    ds_read_b64_tr_b16 v[26:27], v66 offset:41472
    ds_read_b64_tr_b16 v[28:29], v66 offset:61440
    ds_read_b64_tr_b16 v[30:31], v66 offset:61952
    ds_read_b128 v[32:35], v67 offset:8320
    ds_read_b128 v[36:39], v67 offset:8384
    ds_read_b128 v[40:43], v67 offset:49280
    ds_read_b128 v[44:47], v67 offset:49344
    ds_read_b64_tr_b16 v[4:5], v64 offset:0
    ds_read_b64_tr_b16 v[8:9], v65 offset:0
    ds_read_b64_tr_b16 v[12:13], v65 offset:40960
    ds_read_b64_tr_b16 v[6:7], v64 offset:512
    ds_read_b64_tr_b16 v[10:11], v65 offset:512
    ds_read_b64_tr_b16 v[14:15], v65 offset:41472
    s_cmp_ge_u32 s54, 4
    s_cbranch_scc1 L_young2
    s_waitcnt vmcnt(8)
    s_branch L_old2
L_young2:
    s_waitcnt vmcnt(4)
L_old2:
    v_lshlrev_b32 v48, 16, v96
    v_and_b32 v49, 0xffff0000, v96
    v_lshlrev_b32 v50, 16, v97
    v_and_b32 v51, 0xffff0000, v97
    s_lshl_b32 s30, s30, 16
    v_and_b32 v204, s30, v220
    v_and_b32 v205, s30, v220
    v_and_b32 v206, s30, v220
    v_and_b32 v207, s30, v220
    s_waitcnt lgkmcnt(0)
    v_xor_b32 v24, 0x80008000, v24
    v_xor_b32 v25, 0x80008000, v25
    v_xor_b32 v26, 0x80008000, v26
    v_xor_b32 v27, 0x80008000, v27
    v_xor_b32 v28, 0x80008000, v28
    v_xor_b32 v29, 0x80008000, v29
    v_xor_b32 v30, 0x80008000, v30
    v_xor_b32 v31, 0x80008000, v31
    v_mfma_f32_4x4x4_16b_bf16 v[56:59], v[218:219], v[4:5], 0
    v_mfma_f32_4x4x4_16b_bf16 v[68:71], v[218:219], v[12:13], 0
    v_mfma_f32_4x4x4_16b_bf16 v[60:63], v[218:219], v[6:7], 0
    v_mfma_f32_4x4x4_16b_bf16 v[72:75], v[218:219], v[14:15], 0
    v_mfma_f32_4x4x4_16b_bf16 v[56:59], v[218:219], v[8:9], v[56:59]
    v_mfma_f32_4x4x4_16b_bf16 v[60:63], v[218:219], v[10:11], v[60:63]
    v_mfma_f32_16x16x32_bf16 v[52:55], v[16:19], v[40:43], v[48:51]
    v_mfma_f32_16x16x32_bf16 v[52:55], v[20:23], v[44:47], v[52:55]
    v_mfma_f32_16x16x32_bf16 v[52:55], v[24:27], v[40:43], v[52:55]
    v_mfma_f32_16x16x32_bf16 v[52:55], v[28:31], v[44:47], v[52:55]
    v_mfma_f32_16x16x32_bf16 v[48:51], v[16:19], v[32:35], v[48:51]
    v_mfma_f32_16x16x32_bf16 v[48:51], v[20:23], v[36:39], v[48:51]
    v_mfma_f32_16x16x32_bf16 v[48:51], v[24:27], v[32:35], v[48:51]
    v_mfma_f32_16x16x32_bf16 v[48:51], v[28:31], v[36:39], v[48:51]
    v_mul_f32 v56, s92, v56
    v_mul_f32 v57, s92, v57
    v_mul_f32 v58, s92, v58
    v_mul_f32 v59, s92, v59
    v_mul_f32 v60, s92, v60
    v_mul_f32 v61, s92, v61
    v_mul_f32 v62, s92, v62
    v_mul_f32 v63, s92, v63
    v_mul_f32 v68, s92, v68
    v_mul_f32 v69, s92, v69
    v_mul_f32 v70, s92, v70
    v_mul_f32 v71, s92, v71
    v_mul_f32 v72, s92, v72
    v_mul_f32 v73, s92, v73
    v_mul_f32 v74, s92, v74
    v_mul_f32 v75, s92, v75
    s_add_u32 s66, s52, 11520
    v_add_u32 v3, s66, v2
    v_cvt_pk_bf16_f32 v68, v68, v69
    v_cvt_pk_bf16_f32 v69, v70, v71
    v_cvt_pk_bf16_f32 v70, v72, v73
    v_cvt_pk_bf16_f32 v71, v74, v75
    v_mul_f32 v48, s92, v48
    v_mul_f32 v49, s92, v49
    v_mul_f32 v50, s92, v50
    v_mul_f32 v51, s92, v51
    v_mul_f32 v52, s92, v52
    v_mul_f32 v53, s92, v53
    v_mul_f32 v54, s92, v54
    v_mul_f32 v55, s92, v55
    ds_write_b128 v3, v[56:59]
    ds_write_b128 v3, v[60:63] offset:1024
    ds_write_b128 v3, v[68:71] offset:2048
    ds_write_b128 v98, v[48:51]
    ds_write_b128 v98, v[52:55] offset:40960
    v_add_u32 v3, 11520, v2
    v_add_u32 v246, 81920, v3
    s_waitcnt lgkmcnt(0)
    s_barrier
    s_cmp_lt_u32 s54, 4
    s_cbranch_scc1 L_old3
    s_call_b64 s[62:63], L_fp
L_old3:
    s_cmp_eq_u32 s94, 0
    s_cbranch_scc1 L_skip2
    s_bitcmp0_b64 s[56:57], 3
    s_cbranch_scc1 L_noadve2
    s_sub_u32 s60, s60, 1
    s_cselect_b32 s31, 0, s31
    s_add_u32 s20, s20, s31
    s_addc_u32 s21, s21, 0
    s_add_u32 s40, s40, s31
    s_addc_u32 s41, s41, 0
    s_xor_b32 s31, s31, 0x63ff800
L_noadve2:
    s_add_u32 m0, s52, 4160
    v_mov_b32 v230, v152
    v_mov_b32 v232, v153
    buffer_load_dwordx4 v[230:231], s[20:23], 0 idxen offen nt lds
    buffer_load_dwordx4 v[232:233], s[40:43], 0 idxen offen offset:1056 nt lds
    s_bitcmp0_b64 s[56:57], 4
    s_cbranch_scc1 L_noadve3
    s_sub_u32 s60, s60, 1
    s_cselect_b32 s31, 0, s31
    s_add_u32 s20, s20, s31
    s_addc_u32 s21, s21, 0
    s_add_u32 s40, s40, s31
    s_addc_u32 s41, s41, 0
    s_xor_b32 s31, s31, 0x63ff800
L_noadve3:
    s_add_u32 m0, s52, 6240
    v_mov_b32 v230, v154
    v_mov_b32 v232, v155
    buffer_load_dwordx4 v[230:231], s[20:23], 0 idxen offen nt lds
    buffer_load_dwordx4 v[232:233], s[40:43], 0 idxen offen offset:1056 nt lds
L_skip2:
    ds_read_b128 v[4:7], v3 offset:0
    ds_read_b128 v[8:11], v3 offset:1024
    ds_read_b128 v[68:71], v3 offset:2048
    ds_read_b128 v[12:15], v3 offset:20480
    ds_read_b128 v[16:19], v3 offset:21504
    ds_read_b128 v[72:75], v3 offset:22528
    s_waitcnt vmcnt(8)
    s_mov_b64 exec, s[28:29]
    v_cmp_neq_f16_sdwa s[68:69], v104, 0 src0_sel:WORD_0 src1_sel:WORD_0
    v_cmp_neq_f16_sdwa s[70:71], v104, 0 src0_sel:WORD_1 src1_sel:WORD_0
    v_cmp_neq_f16_sdwa s[72:73], v105, 0 src0_sel:WORD_0 src1_sel:WORD_0
    v_cmp_neq_f16_sdwa s[74:75], v105, 0 src0_sel:WORD_1 src1_sel:WORD_0
    v_cmp_neq_f16_sdwa s[76:77], v106, 0 src0_sel:WORD_0 src1_sel:WORD_0
    v_cmp_neq_f16_sdwa s[78:79], v106, 0 src0_sel:WORD_1 src1_sel:WORD_0
    v_cmp_neq_f16_sdwa s[80:81], v107, 0 src0_sel:WORD_0 src1_sel:WORD_0
    v_cmp_neq_f16_sdwa s[82:83], v107, 0 src0_sel:WORD_1 src1_sel:WORD_0
    v_sad_u16 v147, v104, 0, v147
    v_sad_u16 v147, v105, 0, v147
    v_sad_u16 v147, v106, 0, v147
    v_sad_u16 v147, v107, 0, v147
    v_or3_b32 v146, v104, v105, v146
    v_or3_b32 v146, v106, v107, v146
    s_mov_b64 exec, -1
    v_mov_b32 v132, s64
    v_mbcnt_lo_u32_b32 v132, s68, v132
    v_mbcnt_hi_u32_b32 v132, s69, v132
    v_mbcnt_lo_u32_b32 v132, s70, v132
    v_mbcnt_hi_u32_b32 v132, s71, v132
    v_mbcnt_lo_u32_b32 v132, s72, v132
    v_mbcnt_hi_u32_b32 v132, s73, v132
    v_mbcnt_lo_u32_b32 v132, s74, v132
    v_mbcnt_hi_u32_b32 v132, s75, v132
    v_mbcnt_lo_u32_b32 v132, s76, v132
    v_mbcnt_hi_u32_b32 v132, s77, v132
    v_mbcnt_lo_u32_b32 v132, s78, v132
    v_mbcnt_hi_u32_b32 v132, s79, v132
    v_mbcnt_lo_u32_b32 v132, s80, v132
    v_mbcnt_hi_u32_b32 v132, s81, v132
    v_mbcnt_lo_u32_b32 v132, s82, v132
    v_mbcnt_hi_u32_b32 v132, s83, v132
    s_add_u32 s34, s64, 16
    v_readlane_b32 s66, v132, 25
    v_readlane_b32 s67, v132, 63
    s_add_u32 s64, s66, 15
    s_and_b32 s64, s64, -16
    s_max_u32 s64, s64, s34
    s_sub_u32 s66, s64, s66
    v_mad_u32_u24 v132, v145, s66, v132
    s_lshr_b32 s35, s64, 4
    s_bitset1_b64 s[56:57], s35
    v_addc_co_u32 v133, vcc, 0, v132, s[68:69]
    v_addc_co_u32 v134, vcc, 0, v133, s[70:71]
    v_addc_co_u32 v135, vcc, 0, v134, s[72:73]
    v_addc_co_u32 v136, vcc, 0, v135, s[74:75]
    v_addc_co_u32 v137, vcc, 0, v136, s[76:77]
    v_addc_co_u32 v138, vcc, 0, v137, s[78:79]
    v_addc_co_u32 v139, vcc, 0, v138, s[80:81]
    v_addc_co_u32 v140, vcc, 0, v139, s[82:83]
    s_add_u32 s67, s67, s66
    s_add_u32 s67, s67, 15
    s_and_b32 s67, s67, -16
    s_add_u32 s64, s64, 16
    s_max_u32 s64, s64, s67
    s_mov_b64 exec, s[68:69]
    ds_write_b8 v132, v141
    s_mov_b64 exec, s[70:71]
    ds_write_b8_d16_hi v133, v141
    s_mov_b64 exec, s[72:73]
    ds_write_b8 v134, v142
    s_mov_b64 exec, s[74:75]
    ds_write_b8_d16_hi v135, v142
    s_mov_b64 exec, s[76:77]
    ds_write_b8 v136, v143
    s_mov_b64 exec, s[78:79]
    ds_write_b8_d16_hi v137, v143
    s_mov_b64 exec, s[80:81]
    ds_write_b8 v138, v144
    s_mov_b64 exec, s[82:83]
    ds_write_b8_d16_hi v139, v144
    s_mov_b64 exec, -1
    v_sub_u32 v140, v132, v140
    s_movk_i32 s66, 0x3f80
    v_mad_i32_i24 v147, v140, s66, v147
    s_lshr_b32 s35, s64, 4
    s_bitset1_b64 s[56:57], s35
    ds_read_b128 v[20:23], v3 offset:40960
    ds_read_b128 v[24:27], v3 offset:41984
    ds_read_b128 v[76:79], v3 offset:43008
    ds_read_b128 v[28:31], v3 offset:61440
    ds_read_b128 v[32:35], v3 offset:62464
    ds_read_b128 v[80:83], v3 offset:63488
    ds_read_b128 v[36:39], v246 offset:0
    ds_read_b128 v[40:43], v246 offset:1024
    ds_read_b128 v[84:87], v246 offset:2048
    s_mov_b64 exec, s[28:29]
    v_cmp_neq_f16_sdwa s[68:69], v108, 0 src0_sel:WORD_0 src1_sel:WORD_0
    v_cmp_neq_f16_sdwa s[70:71], v108, 0 src0_sel:WORD_1 src1_sel:WORD_0
    v_cmp_neq_f16_sdwa s[72:73], v109, 0 src0_sel:WORD_0 src1_sel:WORD_0
    v_cmp_neq_f16_sdwa s[74:75], v109, 0 src0_sel:WORD_1 src1_sel:WORD_0
    v_cmp_neq_f16_sdwa s[76:77], v110, 0 src0_sel:WORD_0 src1_sel:WORD_0
    v_cmp_neq_f16_sdwa s[78:79], v110, 0 src0_sel:WORD_1 src1_sel:WORD_0
    v_cmp_neq_f16_sdwa s[80:81], v111, 0 src0_sel:WORD_0 src1_sel:WORD_0
    v_cmp_neq_f16_sdwa s[82:83], v111, 0 src0_sel:WORD_1 src1_sel:WORD_0
    v_sad_u16 v147, v108, 0, v147
    v_sad_u16 v147, v109, 0, v147
    v_sad_u16 v147, v110, 0, v147
    v_sad_u16 v147, v111, 0, v147
    v_or3_b32 v146, v108, v109, v146
    v_or3_b32 v146, v110, v111, v146
    s_mov_b64 exec, -1
    v_mov_b32 v132, s64
    v_mbcnt_lo_u32_b32 v132, s68, v132
    v_mbcnt_hi_u32_b32 v132, s69, v132
    v_mbcnt_lo_u32_b32 v132, s70, v132
    v_mbcnt_hi_u32_b32 v132, s71, v132
    v_mbcnt_lo_u32_b32 v132, s72, v132
    v_mbcnt_hi_u32_b32 v132, s73, v132
    v_mbcnt_lo_u32_b32 v132, s74, v132
    v_mbcnt_hi_u32_b32 v132, s75, v132
    v_mbcnt_lo_u32_b32 v132, s76, v132
    v_mbcnt_hi_u32_b32 v132, s77, v132
    v_mbcnt_lo_u32_b32 v132, s78, v132
    v_mbcnt_hi_u32_b32 v132, s79, v132
    v_mbcnt_lo_u32_b32 v132, s80, v132
    v_mbcnt_hi_u32_b32 v132, s81, v132
    v_mbcnt_lo_u32_b32 v132, s82, v132
    v_mbcnt_hi_u32_b32 v132, s83, v132
    s_add_u32 s34, s64, 16
    v_readlane_b32 s66, v132, 25
    v_readlane_b32 s67, v132, 63
    s_add_u32 s64, s66, 15
    s_and_b32 s64, s64, -16
    s_max_u32 s64, s64, s34
    s_sub_u32 s66, s64, s66
    v_mad_u32_u24 v132, v145, s66, v132
    s_lshr_b32 s35, s64, 4
    s_lshl_b64 s[86:87], 1, s35
    s_bitcmp1_b32 s64, 10
    s_cselect_b64 s[88:89], 0, s[86:87]
    s_cselect_b64 s[90:91], s[86:87], 0
    s_or_b64 s[56:57], s[56:57], s[88:89]
    s_or_b64 s[58:59], s[58:59], s[90:91]
    v_addc_co_u32 v133, vcc, 0, v132, s[68:69]
    v_addc_co_u32 v134, vcc, 0, v133, s[70:71]
    v_addc_co_u32 v135, vcc, 0, v134, s[72:73]
    v_addc_co_u32 v136, vcc, 0, v135, s[74:75]
    v_addc_co_u32 v137, vcc, 0, v136, s[76:77]
    v_addc_co_u32 v138, vcc, 0, v137, s[78:79]
    v_addc_co_u32 v139, vcc, 0, v138, s[80:81]
    v_addc_co_u32 v140, vcc, 0, v139, s[82:83]
    s_add_u32 s67, s67, s66
    s_add_u32 s67, s67, 15
    s_and_b32 s67, s67, -16
    s_add_u32 s64, s64, 16
    s_max_u32 s64, s64, s67
    s_mov_b64 exec, s[68:69]
    ds_write_b8 v132, v141
    s_mov_b64 exec, s[70:71]
    ds_write_b8_d16_hi v133, v141
    s_mov_b64 exec, s[72:73]
    ds_write_b8 v134, v142
    s_mov_b64 exec, s[74:75]
    ds_write_b8_d16_hi v135, v142
    s_mov_b64 exec, s[76:77]
    ds_write_b8 v136, v143
    s_mov_b64 exec, s[78:79]
    ds_write_b8_d16_hi v137, v143
    s_mov_b64 exec, s[80:81]
    ds_write_b8 v138, v144
    s_mov_b64 exec, s[82:83]
    ds_write_b8_d16_hi v139, v144
    s_mov_b64 exec, -1
    v_sub_u32 v140, v132, v140
    s_movk_i32 s66, 0x3f80
    v_mad_i32_i24 v147, v140, s66, v147
    s_lshr_b32 s35, s64, 4
    s_lshl_b64 s[86:87], 1, s35
    s_bitcmp1_b32 s64, 10
    s_cselect_b64 s[88:89], 0, s[86:87]
    s_cselect_b64 s[90:91], s[86:87], 0
    s_or_b64 s[56:57], s[56:57], s[88:89]
    s_or_b64 s[58:59], s[58:59], s[90:91]
    ds_read_b128 v[44:47], v246 offset:20480
    ds_read_b128 v[48:51], v246 offset:21504
    ds_read_b128 v[88:91], v246 offset:22528
    ds_read_b128 v[52:55], v246 offset:40960
    ds_read_b128 v[56:59], v246 offset:41984
    ds_read_b128 v[92:95], v246 offset:43008
    ds_read_b128 v[60:63], v246 offset:61440
    ds_read_b128 v[64:67], v246 offset:62464
    ds_read_b128 v[96:99], v246 offset:63488
    ds_read_u16 v224, v238 offset:0
    ds_read_u16 v225, v238 offset:8
    ds_read_u16 v226, v238 offset:64
    ds_read_u16 v227, v238 offset:72
    s_mov_b64 exec, s[28:29]
    v_cmp_neq_f16_sdwa s[68:69], v112, 0 src0_sel:WORD_0 src1_sel:WORD_0
    v_cmp_neq_f16_sdwa s[70:71], v112, 0 src0_sel:WORD_1 src1_sel:WORD_0
    v_cmp_neq_f16_sdwa s[72:73], v113, 0 src0_sel:WORD_0 src1_sel:WORD_0
    v_cmp_neq_f16_sdwa s[74:75], v113, 0 src0_sel:WORD_1 src1_sel:WORD_0
    v_cmp_neq_f16_sdwa s[76:77], v114, 0 src0_sel:WORD_0 src1_sel:WORD_0
    v_cmp_neq_f16_sdwa s[78:79], v114, 0 src0_sel:WORD_1 src1_sel:WORD_0
    v_cmp_neq_f16_sdwa s[80:81], v115, 0 src0_sel:WORD_0 src1_sel:WORD_0
    v_cmp_neq_f16_sdwa s[82:83], v115, 0 src0_sel:WORD_1 src1_sel:WORD_0
    v_sad_u16 v147, v112, 0, v147
    v_sad_u16 v147, v113, 0, v147
    v_sad_u16 v147, v114, 0, v147
    v_sad_u16 v147, v115, 0, v147
    v_or3_b32 v146, v112, v113, v146
    v_or3_b32 v146, v114, v115, v146
    s_mov_b64 exec, -1
    v_mov_b32 v132, s64
    v_mbcnt_lo_u32_b32 v132, s68, v132
    v_mbcnt_hi_u32_b32 v132, s69, v132
    v_mbcnt_lo_u32_b32 v132, s70, v132
    v_mbcnt_hi_u32_b32 v132, s71, v132
    v_mbcnt_lo_u32_b32 v132, s72, v132
    v_mbcnt_hi_u32_b32 v132, s73, v132
    v_mbcnt_lo_u32_b32 v132, s74, v132
    v_mbcnt_hi_u32_b32 v132, s75, v132
    v_mbcnt_lo_u32_b32 v132, s76, v132
    v_mbcnt_hi_u32_b32 v132, s77, v132
    v_mbcnt_lo_u32_b32 v132, s78, v132
    v_mbcnt_hi_u32_b32 v132, s79, v132
    v_mbcnt_lo_u32_b32 v132, s80, v132
    v_mbcnt_hi_u32_b32 v132, s81, v132
    v_mbcnt_lo_u32_b32 v132, s82, v132
    v_mbcnt_hi_u32_b32 v132, s83, v132
    s_add_u32 s34, s64, 16
    v_readlane_b32 s66, v132, 25
    v_readlane_b32 s67, v132, 63
    s_add_u32 s64, s66, 15
    s_and_b32 s64, s64, -16
    s_max_u32 s64, s64, s34
    s_sub_u32 s66, s64, s66
    v_mad_u32_u24 v132, v145, s66, v132
    s_lshr_b32 s35, s64, 4
    s_lshl_b64 s[86:87], 1, s35
    s_bitcmp1_b32 s64, 10
    s_cselect_b64 s[88:89], 0, s[86:87]
    s_cselect_b64 s[90:91], s[86:87], 0
    s_or_b64 s[56:57], s[56:57], s[88:89]
    s_or_b64 s[58:59], s[58:59], s[90:91]
    v_addc_co_u32 v133, vcc, 0, v132, s[68:69]
    v_addc_co_u32 v134, vcc, 0, v133, s[70:71]
    v_addc_co_u32 v135, vcc, 0, v134, s[72:73]
    v_addc_co_u32 v136, vcc, 0, v135, s[74:75]
    v_addc_co_u32 v137, vcc, 0, v136, s[76:77]
    v_addc_co_u32 v138, vcc, 0, v137, s[78:79]
    v_addc_co_u32 v139, vcc, 0, v138, s[80:81]
    v_addc_co_u32 v140, vcc, 0, v139, s[82:83]
    s_add_u32 s67, s67, s66
    s_add_u32 s67, s67, 15
    s_and_b32 s67, s67, -16
    s_add_u32 s64, s64, 16
    s_max_u32 s64, s64, s67
    s_mov_b64 exec, s[68:69]
    ds_write_b8 v132, v141
    s_mov_b64 exec, s[70:71]
    ds_write_b8_d16_hi v133, v141
    s_mov_b64 exec, s[72:73]
    ds_write_b8 v134, v142
    s_mov_b64 exec, s[74:75]
    ds_write_b8_d16_hi v135, v142
    s_mov_b64 exec, s[76:77]
    ds_write_b8 v136, v143
    s_mov_b64 exec, s[78:79]
    ds_write_b8_d16_hi v137, v143
    s_mov_b64 exec, s[80:81]
    ds_write_b8 v138, v144
    s_mov_b64 exec, s[82:83]
    ds_write_b8_d16_hi v139, v144
    s_mov_b64 exec, -1
    v_sub_u32 v140, v132, v140
    s_movk_i32 s66, 0x3f80
    v_mad_i32_i24 v147, v140, s66, v147
    s_lshr_b32 s35, s64, 4
    s_lshl_b64 s[86:87], 1, s35
    s_bitcmp1_b32 s64, 10
    s_cselect_b64 s[88:89], 0, s[86:87]
    s_cselect_b64 s[90:91], s[86:87], 0
    s_or_b64 s[56:57], s[56:57], s[88:89]
    s_or_b64 s[58:59], s[58:59], s[90:91]
    s_mov_b32 s66, 0xc07fc07f
    v_and_or_b32 v146, v146, s66, v147
    v_cmp_ne_u32 s[84:85], 0, v146
    s_sub_u32 s66, s64, s52
    s_sub_u32 s66, s66, 18448
    s_lshr_b32 s66, s66, 3
    s_xor_b32 s66, s66, s33
    s_sub_u32 s66, s66, s33
    s_xor_b32 s67, 0xfffffff8, s33
    s_sub_u32 s67, s67, s33
    v_mov_b32 v2, v221
    v_mov_b32 v1, s66
    v_mov_b32 v3, s67
    s_mov_b64 exec, 1
    ds_add_u32 v2, v1
    s_mov_b64 exec, -1
    s_cmp_eq_u32 s94, 1
    s_cbranch_scc1 L_nolate
    ds_read_u8 v148, v237 offset:0
    ds_read_u8 v149, v237 offset:8
    ds_read_u8 v150, v237 offset:16
    ds_read_u8 v151, v237 offset:24
    ds_read_u8 v152, v237 offset:32
    ds_read_u8 v153, v237 offset:40
    ds_read_u8 v154, v237 offset:48
    ds_read_u8 v155, v237 offset:56
    s_waitcnt lgkmcnt(0)
    s_add_u32 m0, s52, 0
    v_mov_b32 v230, v148
    v_mov_b32 v232, v149
    buffer_load_dwordx4 v[230:231], s[20:23], 0 idxen offen nt lds
    buffer_load_dwordx4 v[232:233], s[40:43], 0 idxen offen offset:1056 nt lds
    s_bitcmp0_b64 s[56:57], 2
    s_cbranch_scc1 L_noadvl1
    s_sub_u32 s60, s60, 1
    s_cselect_b32 s31, 0, s31
    s_add_u32 s20, s20, s31
    s_addc_u32 s21, s21, 0
    s_add_u32 s40, s40, s31
    s_addc_u32 s41, s41, 0
    s_xor_b32 s31, s31, 0x63ff800
L_noadvl1:
    s_add_u32 m0, s52, 2080
    v_mov_b32 v230, v150
    v_mov_b32 v232, v151
    buffer_load_dwordx4 v[230:231], s[20:23], 0 idxen offen nt lds
    buffer_load_dwordx4 v[232:233], s[40:43], 0 idxen offen offset:1056 nt lds
    s_bitcmp0_b64 s[56:57], 3
    s_cbranch_scc1 L_noadvl2
    s_sub_u32 s60, s60, 1
    s_cselect_b32 s31, 0, s31
    s_add_u32 s20, s20, s31
    s_addc_u32 s21, s21, 0
    s_add_u32 s40, s40, s31
    s_addc_u32 s41, s41, 0
    s_xor_b32 s31, s31, 0x63ff800
L_noadvl2:
    s_add_u32 m0, s52, 4160
    v_mov_b32 v230, v152
    v_mov_b32 v232, v153
    buffer_load_dwordx4 v[230:231], s[20:23], 0 idxen offen nt lds
    buffer_load_dwordx4 v[232:233], s[40:43], 0 idxen offen offset:1056 nt lds
    s_bitcmp0_b64 s[56:57], 4
    s_cbranch_scc1 L_noadvl3
    s_sub_u32 s60, s60, 1
    s_cselect_b32 s31, 0, s31
    s_add_u32 s20, s20, s31
    s_addc_u32 s21, s21, 0
    s_add_u32 s40, s40, s31
    s_addc_u32 s41, s41, 0
    s_xor_b32 s31, s31, 0x63ff800
L_noadvl3:
    s_add_u32 m0, s52, 6240
    v_mov_b32 v230, v154
    v_mov_b32 v232, v155
    buffer_load_dwordx4 v[230:231], s[20:23], 0 idxen offen nt lds
    buffer_load_dwordx4 v[232:233], s[40:43], 0 idxen offen offset:1056 nt lds
L_nolate:
    v_and_b32_dpp v196, v216, v220 quad_perm:[0,0,0,0] row_mask:0xf bank_mask:0xf
    v_and_b32_dpp v197, v217, v220 quad_perm:[0,0,0,0] row_mask:0xf bank_mask:0xf
    v_and_b32_dpp v198, v216, v220 quad_perm:[1,1,1,1] row_mask:0xf bank_mask:0xf
    v_and_b32_dpp v199, v217, v220 quad_perm:[1,1,1,1] row_mask:0xf bank_mask:0xf
    v_and_b32_dpp v200, v216, v220 quad_perm:[2,2,2,2] row_mask:0xf bank_mask:0xf
    v_and_b32_dpp v201, v217, v220 quad_perm:[2,2,2,2] row_mask:0xf bank_mask:0xf
    v_and_b32_dpp v202, v216, v220 quad_perm:[3,3,3,3] row_mask:0xf bank_mask:0xf
    v_and_b32_dpp v203, v217, v220 quad_perm:[3,3,3,3] row_mask:0xf bank_mask:0xf
    s_waitcnt vmcnt(6) lgkmcnt(0)
    ds_read_b128 v[180:183], v234 offset:0
    ds_read_b128 v[184:187], v235 offset:0
    v_mul_u32_u24 v216, v224, v241
    v_mul_u32_u24 v217, v224, v242
    v_mul_u32_u24 v218, v225, v241
    v_mul_u32_u24 v219, v225, v242
    v_mul_u32_u24 v220, v226, v241
    v_mul_u32_u24 v221, v226, v242
    v_mul_u32_u24 v222, v227, v241
    v_mul_u32_u24 v223, v227, v242
    v_add_u32 v238, 128, v238
    ds_read_b128 v[164:167], v239
    v_mfma_f32_4x4x4_16b_bf16 v[132:135], v[216:217], v[68:69], v[4:7]
    ds_read_b128 v[168:171], v239 offset:64
    ds_read_b128 v[172:175], v239 offset:128
    v_mfma_f32_4x4x4_16b_bf16 v[136:139], v[218:219], v[70:71], v[8:11]
    ds_read_b128 v[176:179], v239 offset:192
    ds_read_u16 v224, v238
    v_mfma_f32_4x4x4_16b_bf16 v[140:143], v[220:221], v[72:73], v[12:15]
    ds_read_u16 v225, v238 offset:8
    ds_read_u16 v226, v238 offset:64
    v_mfma_f32_4x4x4_16b_bf16 v[144:147], v[222:223], v[74:75], v[16:19]
    ds_read_u16 v227, v238 offset:72
    v_add_u32 v239, 272, v239
    v_mfma_f32_4x4x4_16b_bf16 v[246:249], v[216:217], v[76:77], v[20:23]
    v_cvt_pk_bf16_f32 v100, v132, v133
    v_cvt_pk_bf16_f32 v101, v134, v135
    v_mfma_f32_4x4x4_16b_bf16 v[250:253], v[218:219], v[78:79], v[24:27]
    v_cvt_pk_bf16_f32 v102, v136, v137
    v_cvt_pk_bf16_f32 v103, v138, v139
    v_mfma_f32_4x4x4_16b_bf16 v[132:135], v[220:221], v[80:81], v[28:31]
    v_cvt_pk_bf16_f32 v104, v140, v141
    v_cvt_pk_bf16_f32 v105, v142, v143
    v_mfma_f32_4x4x4_16b_bf16 v[136:139], v[222:223], v[82:83], v[32:35]
    v_cvt_pk_bf16_f32 v106, v144, v145
    v_cvt_pk_bf16_f32 v107, v146, v147
    v_mfma_f32_4x4x4_16b_bf16 v[140:143], v[216:217], v[84:85], v[36:39]
    v_cvt_pk_bf16_f32 v108, v246, v247
    v_cvt_pk_bf16_f32 v109, v248, v249
    v_mfma_f32_4x4x4_16b_bf16 v[144:147], v[218:219], v[86:87], v[40:43]
    v_cvt_pk_bf16_f32 v110, v250, v251
    v_cvt_pk_bf16_f32 v111, v252, v253
    v_mfma_f32_4x4x4_16b_bf16 v[246:249], v[220:221], v[88:89], v[44:47]
    v_cvt_pk_bf16_f32 v112, v132, v133
    v_cvt_pk_bf16_f32 v113, v134, v135
    v_mfma_f32_4x4x4_16b_bf16 v[250:253], v[222:223], v[90:91], v[48:51]
    v_cvt_pk_bf16_f32 v114, v136, v137
    v_cvt_pk_bf16_f32 v115, v138, v139
    v_mfma_f32_4x4x4_16b_bf16 v[132:135], v[216:217], v[92:93], v[52:55]
    v_cvt_pk_bf16_f32 v116, v140, v141
    v_cvt_pk_bf16_f32 v117, v142, v143
    v_mfma_f32_4x4x4_16b_bf16 v[136:139], v[218:219], v[94:95], v[56:59]
    v_cvt_pk_bf16_f32 v118, v144, v145
    v_cvt_pk_bf16_f32 v119, v146, v147
    v_mfma_f32_4x4x4_16b_bf16 v[140:143], v[220:221], v[96:97], v[60:63]
    v_cvt_pk_bf16_f32 v120, v246, v247
    v_cvt_pk_bf16_f32 v121, v248, v249
    v_mfma_f32_4x4x4_16b_bf16 v[144:147], v[222:223], v[98:99], v[64:67]
    v_cvt_pk_bf16_f32 v122, v250, v251
    v_cvt_pk_bf16_f32 v123, v252, v253
    v_cvt_pk_bf16_f32 v124, v132, v133
    v_cvt_pk_bf16_f32 v125, v134, v135
    v_cvt_pk_bf16_f32 v126, v136, v137
    v_cvt_pk_bf16_f32 v127, v138, v139
    v_cvt_pk_bf16_f32 v128, v140, v141
    v_cvt_pk_bf16_f32 v129, v142, v143
    v_cvt_pk_bf16_f32 v130, v144, v145
    v_cvt_pk_bf16_f32 v131, v146, v147
    s_waitcnt lgkmcnt(0)
    v_mfma_f32_16x16x32_bf16 v[148:151], v[100:103], v[180:183], v[164:167]
    v_mfma_f32_16x16x32_bf16 v[148:151], v[104:107], v[184:187], v[148:151]
    v_mfma_f32_16x16x32_bf16 v[152:155], v[108:111], v[180:183], v[168:171]
    v_mfma_f32_16x16x32_bf16 v[152:155], v[112:115], v[184:187], v[152:155]
    v_mfma_f32_16x16x32_bf16 v[156:159], v[116:119], v[180:183], v[172:175]
    v_mfma_f32_16x16x32_bf16 v[156:159], v[120:123], v[184:187], v[156:159]
    v_mfma_f32_16x16x32_bf16 v[160:163], v[124:127], v[180:183], v[176:179]
    v_mfma_f32_16x16x32_bf16 v[160:163], v[128:131], v[184:187], v[160:163]
    s_waitcnt vmcnt(4)
    ds_read_b128 v[180:183], v234 offset:2080
    ds_read_b128 v[184:187], v235 offset:2080
    ds_read_u8 v230, v237 offset:64
    ds_read_u8 v232, v237 offset:72
    s_lshr_b64 s[86:87], s[56:57], 2
    s_lshr_b64 s[36:37], s[56:57], 5
    s_or_b32 s36, s36, s86
    s_or_b32 s36, s36, s56
    s_cmp_lg_u64 s[84:85], 0
    s_cbranch_scc0 Lf_mid
    s_mul_i32 s66, s53, 800
    s_add_u32 s8, s8, s66
    s_addc_u32 s9, s9, 0
    s_mov_b32 s24, s8
    s_and_b32 s25, s9, 0xffff
    s_mov_b32 s26, 400
    s_mov_b32 s27, 0x20000
    s_movk_i32 s32, 400
    s_branch Ls_mid
L_fp:
    s_mov_b64 exec, s[28:29]
    v_cmp_neq_f16_sdwa s[68:69], v100, 0 src0_sel:WORD_0 src1_sel:WORD_0
    v_cmp_neq_f16_sdwa s[70:71], v100, 0 src0_sel:WORD_1 src1_sel:WORD_0
    v_cmp_neq_f16_sdwa s[72:73], v101, 0 src0_sel:WORD_0 src1_sel:WORD_0
    v_cmp_neq_f16_sdwa s[74:75], v101, 0 src0_sel:WORD_1 src1_sel:WORD_0
    v_cmp_neq_f16_sdwa s[76:77], v102, 0 src0_sel:WORD_0 src1_sel:WORD_0
    v_cmp_neq_f16_sdwa s[78:79], v102, 0 src0_sel:WORD_1 src1_sel:WORD_0
    v_cmp_neq_f16_sdwa s[80:81], v103, 0 src0_sel:WORD_0 src1_sel:WORD_0
    v_cmp_neq_f16_sdwa s[82:83], v103, 0 src0_sel:WORD_1 src1_sel:WORD_0
    v_sad_u16 v147, v100, 0, v147
    v_sad_u16 v147, v101, 0, v147
    v_sad_u16 v147, v102, 0, v147
    v_sad_u16 v147, v103, 0, v147
    v_or3_b32 v146, v100, v101, v146
    v_or3_b32 v146, v102, v103, v146
    s_mov_b64 exec, -1
    v_mov_b32 v132, s64
    v_mbcnt_lo_u32_b32 v132, s68, v132
    v_mbcnt_hi_u32_b32 v132, s69, v132
    v_mbcnt_lo_u32_b32 v132, s70, v132
    v_mbcnt_hi_u32_b32 v132, s71, v132
    v_mbcnt_lo_u32_b32 v132, s72, v132
    v_mbcnt_hi_u32_b32 v132, s73, v132
    v_mbcnt_lo_u32_b32 v132, s74, v132
    v_mbcnt_hi_u32_b32 v132, s75, v132
    v_mbcnt_lo_u32_b32 v132, s76, v132
    v_mbcnt_hi_u32_b32 v132, s77, v132
    v_mbcnt_lo_u32_b32 v132, s78, v132
    v_mbcnt_hi_u32_b32 v132, s79, v132
    v_mbcnt_lo_u32_b32 v132, s80, v132
    v_mbcnt_hi_u32_b32 v132, s81, v132
    v_mbcnt_lo_u32_b32 v132, s82, v132
    v_mbcnt_hi_u32_b32 v132, s83, v132
    s_add_u32 s34, s64, 16
    v_readlane_b32 s66, v132, 25
    v_readlane_b32 s67, v132, 63
    s_add_u32 s64, s66, 15
    s_and_b32 s64, s64, -16
    s_max_u32 s64, s64, s34
    s_sub_u32 s66, s64, s66
    v_mad_u32_u24 v132, v145, s66, v132
    s_lshr_b32 s35, s64, 4
    s_bitset1_b64 s[56:57], s35
    v_addc_co_u32 v133, vcc, 0, v132, s[68:69]
    v_addc_co_u32 v134, vcc, 0, v133, s[70:71]
    v_addc_co_u32 v135, vcc, 0, v134, s[72:73]
    v_addc_co_u32 v136, vcc, 0, v135, s[74:75]
    v_addc_co_u32 v137, vcc, 0, v136, s[76:77]
    v_addc_co_u32 v138, vcc, 0, v137, s[78:79]
    v_addc_co_u32 v139, vcc, 0, v138, s[80:81]
    v_addc_co_u32 v140, vcc, 0, v139, s[82:83]
    s_add_u32 s67, s67, s66
    s_add_u32 s67, s67, 15
    s_and_b32 s67, s67, -16
    s_add_u32 s64, s64, 16
    s_max_u32 s64, s64, s67
    s_mov_b64 exec, s[68:69]
    ds_write_b8 v132, v141
    s_mov_b64 exec, s[70:71]
    ds_write_b8_d16_hi v133, v141
    s_mov_b64 exec, s[72:73]
    ds_write_b8 v134, v142
    s_mov_b64 exec, s[74:75]
    ds_write_b8_d16_hi v135, v142
    s_mov_b64 exec, s[76:77]
    ds_write_b8 v136, v143
    s_mov_b64 exec, s[78:79]
    ds_write_b8_d16_hi v137, v143
    s_mov_b64 exec, s[80:81]
    ds_write_b8 v138, v144
    s_mov_b64 exec, s[82:83]
    ds_write_b8_d16_hi v139, v144
    s_mov_b64 exec, -1
    v_sub_u32 v140, v132, v140
    s_movk_i32 s66, 0x3f80
    v_mad_i32_i24 v147, v140, s66, v147
    s_lshr_b32 s35, s64, 4
    s_bitset1_b64 s[56:57], s35
    s_add_u32 s66, s52, 18512
    s_cmp_ge_u32 s64, s66
    s_cselect_b32 s94, 1, 0
    s_cbranch_scc1 L_early
    s_waitcnt vmcnt(0)
L_early:
    ds_read_u8 v148, v237 offset:0
    ds_read_u8 v149, v237 offset:8
    ds_read_u8 v150, v237 offset:16
    ds_read_u8 v151, v237 offset:24
    ds_read_u8 v152, v237 offset:32
    ds_read_u8 v153, v237 offset:40
    ds_read_u8 v154, v237 offset:48
    ds_read_u8 v155, v237 offset:56
    s_waitcnt lgkmcnt(0)
    s_cmp_eq_u32 s94, 0
    s_cbranch_scc1 L_skip0
    s_add_u32 m0, s52, 0
    v_mov_b32 v230, v148
    v_mov_b32 v232, v149
    buffer_load_dwordx4 v[230:231], s[20:23], 0 idxen offen nt lds
    buffer_load_dwordx4 v[232:233], s[40:43], 0 idxen offen offset:1056 nt lds
    s_bitcmp0_b64 s[56:57], 2
    s_cbranch_scc1 L_noadve1
    s_sub_u32 s60, s60, 1
    s_cselect_b32 s31, 0, s31
    s_add_u32 s20, s20, s31
    s_addc_u32 s21, s21, 0
    s_add_u32 s40, s40, s31
    s_addc_u32 s41, s41, 0
    s_xor_b32 s31, s31, 0x63ff800
L_noadve1:
    s_add_u32 m0, s52, 2080
    v_mov_b32 v230, v150
    v_mov_b32 v232, v151
    buffer_load_dwordx4 v[230:231], s[20:23], 0 idxen offen nt lds
    buffer_load_dwordx4 v[232:233], s[40:43], 0 idxen offen offset:1056 nt lds
L_skip0:
    s_setpc_b64 s[62:63]
Lf_loop:
    ds_read_u8 v230, v237 offset:64
    ds_read_u8 v232, v237 offset:72
    v_mfma_f32_16x16x32_bf16 v[208:211], v[136:139], v[200:203], v[208:211]
Lf_mid:
    s_bitcmp1_b32 s36, 0
    s_cbranch_scc1 Lf_ev0
Lf_evd0:
    s_mov_b64 exec, 1
    ds_add_rtn_u32 v1, v2, v3
    s_mov_b64 exec, -1
    v_exp_f32 v132, v148
    v_exp_f32 v133, v149
    v_exp_f32 v134, v150
    v_exp_f32 v135, v151
    v_exp_f32 v136, v152
    v_exp_f32 v137, v153
    v_mfma_f32_4x4x4_16b_bf16 v[132:135], v[228:229], v[228:229], v[132:135]
    v_cvt_pk_bf16_f32 v208, v208, v209
    v_cvt_pk_bf16_f32 v209, v210, v211
    s_waitcnt lgkmcnt(2)
    v_mfma_f32_16x16x32_bf16 v[148:151], v[100:103], v[180:183], v[164:167]
    v_exp_f32 v138, v154
    v_mfma_f32_4x4x4_16b_bf16 v[212:215], v[208:209], v[188:189], v[212:215] cbsz:4 abid:0
    ds_read_b64_tr_b16 v[188:189], v236 offset:0
    v_exp_f32 v139, v155
    v_mfma_f32_16x16x32_bf16 v[152:155], v[108:111], v[180:183], v[168:171]
    v_exp_f32 v140, v156
    v_mfma_f32_4x4x4_16b_bf16 v[212:215], v[208:209], v[190:191], v[212:215] cbsz:4 abid:4
    ds_read_b64_tr_b16 v[190:191], v236 offset:512
    v_mfma_f32_4x4x4_16b_bf16 v[136:139], v[228:229], v[228:229], v[136:139]
    v_rcp_f32 v132, v132
    v_mfma_f32_4x4x4_16b_bf16 v[212:215], v[208:209], v[192:193], v[212:215] cbsz:4 abid:8
    ds_read_b64_tr_b16 v[192:193], v236 offset:1056
    v_exp_f32 v141, v157
    v_mfma_f32_16x16x32_bf16 v[148:151], v[104:107], v[184:187], v[148:151]
    v_rcp_f32 v133, v133
    v_mfma_f32_4x4x4_16b_bf16 v[212:215], v[208:209], v[194:195], v[212:215] cbsz:4 abid:12
    ds_read_b64_tr_b16 v[194:195], v236 offset:1568
    v_exp_f32 v142, v158
    v_mfma_f32_16x16x32_bf16 v[152:155], v[112:115], v[184:187], v[152:155]
    v_rcp_f32 v134, v134
    v_exp_f32 v143, v159
    v_rcp_f32 v135, v135
    v_cvt_pk_bf16_f32 v132, v132, v133
    v_mfma_f32_4x4x4_16b_bf16 v[140:143], v[228:229], v[228:229], v[140:143]
    v_exp_f32 v144, v160
    v_mfma_f32_16x16x32_bf16 v[156:159], v[116:119], v[180:183], v[172:175]
    v_rcp_f32 v136, v136
    v_cvt_pk_bf16_f32 v133, v134, v135
    s_add_u32 m0, s52, 0
    s_waitcnt lgkmcnt(0)
    buffer_load_dwordx4 v[230:231], s[20:23], 0 idxen offen nt lds
    v_exp_f32 v145, v161
    buffer_load_dwordx4 v[232:233], s[40:43], 0 idxen offen offset:1056 nt lds
    v_rcp_f32 v137, v137
    v_exp_f32 v146, v162
    v_rcp_f32 v138, v138
    v_cvt_pk_bf16_f32 v134, v136, v137
    v_exp_f32 v147, v163
    v_mfma_f32_16x16x32_bf16 v[160:163], v[124:127], v[180:183], v[176:179]
    v_readfirstlane_b32 s66, v1
    s_setprio 0
    s_xor_b32 s66, s66, s33
    s_cmp_gt_i32 s66, 0
    s_cbranch_scc0 Lf_lo0
    s_setprio 1
Lf_lo0:
    v_rcp_f32 v139, v139
    v_mfma_f32_4x4x4_16b_bf16 v[144:147], v[228:229], v[228:229], v[144:147]
    v_mfma_f32_16x16x32_bf16 v[156:159], v[120:123], v[184:187], v[156:159]
    v_rcp_f32 v140, v140
    v_mfma_f32_16x16x32_bf16 v[160:163], v[128:131], v[184:187], v[160:163]
    v_rcp_f32 v141, v141
    v_cvt_pk_bf16_f32 v135, v138, v139
    s_waitcnt vmcnt(4)
    ds_read_b128 v[180:183], v234 offset:4160
    ds_read_b128 v[184:187], v235 offset:4160
    v_rcp_f32 v142, v142
    v_cvt_pk_bf16_f32 v136, v140, v141
    v_mfma_f32_16x16x32_bf16 v[208:211], v[132:135], v[196:199], v[204:207]
    v_rcp_f32 v143, v143
    v_rcp_f32 v144, v144
    v_cvt_pk_bf16_f32 v137, v142, v143
    v_rcp_f32 v145, v145
    v_rcp_f32 v146, v146
    v_rcp_f32 v147, v147
    v_cvt_pk_bf16_f32 v138, v144, v145
    v_cvt_pk_bf16_f32 v139, v146, v147
    ds_read_u8 v230, v237 offset:80
    ds_read_u8 v232, v237 offset:88
    v_mfma_f32_16x16x32_bf16 v[208:211], v[136:139], v[200:203], v[208:211]
    s_bitcmp1_b32 s36, 1
    s_cbranch_scc1 Lf_ev1
Lf_evd1:
    v_exp_f32 v132, v148
    v_exp_f32 v133, v149
    v_exp_f32 v134, v150
    v_exp_f32 v135, v151
    v_exp_f32 v136, v152
    v_exp_f32 v137, v153
    v_mfma_f32_4x4x4_16b_bf16 v[132:135], v[228:229], v[228:229], v[132:135]
    v_cvt_pk_bf16_f32 v208, v208, v209
    v_cvt_pk_bf16_f32 v209, v210, v211
    s_waitcnt lgkmcnt(2)
    v_mfma_f32_16x16x32_bf16 v[148:151], v[100:103], v[180:183], v[164:167]
    v_exp_f32 v138, v154
    v_mfma_f32_4x4x4_16b_bf16 v[212:215], v[208:209], v[188:189], v[212:215] cbsz:4 abid:0
    ds_read_b64_tr_b16 v[188:189], v236 offset:2080
    v_exp_f32 v139, v155
    v_mfma_f32_16x16x32_bf16 v[152:155], v[108:111], v[180:183], v[168:171]
    v_exp_f32 v140, v156
    v_mfma_f32_4x4x4_16b_bf16 v[212:215], v[208:209], v[190:191], v[212:215] cbsz:4 abid:4
    ds_read_b64_tr_b16 v[190:191], v236 offset:2592
    v_mfma_f32_4x4x4_16b_bf16 v[136:139], v[228:229], v[228:229], v[136:139]
    v_rcp_f32 v132, v132
    v_mfma_f32_4x4x4_16b_bf16 v[212:215], v[208:209], v[192:193], v[212:215] cbsz:4 abid:8
    ds_read_b64_tr_b16 v[192:193], v236 offset:3136
    v_exp_f32 v141, v157
    v_mfma_f32_16x16x32_bf16 v[148:151], v[104:107], v[184:187], v[148:151]
    v_rcp_f32 v133, v133
    v_mfma_f32_4x4x4_16b_bf16 v[212:215], v[208:209], v[194:195], v[212:215] cbsz:4 abid:12
    ds_read_b64_tr_b16 v[194:195], v236 offset:3648
    v_exp_f32 v142, v158
    v_mfma_f32_16x16x32_bf16 v[152:155], v[112:115], v[184:187], v[152:155]
    v_rcp_f32 v134, v134
    v_exp_f32 v143, v159
    v_rcp_f32 v135, v135
    v_cvt_pk_bf16_f32 v132, v132, v133
    v_mfma_f32_4x4x4_16b_bf16 v[140:143], v[228:229], v[228:229], v[140:143]
    v_exp_f32 v144, v160
    v_mfma_f32_16x16x32_bf16 v[156:159], v[116:119], v[180:183], v[172:175]
    v_rcp_f32 v136, v136
    v_cvt_pk_bf16_f32 v133, v134, v135
    s_add_u32 m0, s52, 2080
    s_waitcnt lgkmcnt(0)
    buffer_load_dwordx4 v[230:231], s[20:23], 0 idxen offen nt lds
    v_exp_f32 v145, v161
    buffer_load_dwordx4 v[232:233], s[40:43], 0 idxen offen offset:1056 nt lds
    v_rcp_f32 v137, v137
    v_exp_f32 v146, v162
    v_rcp_f32 v138, v138
    v_cvt_pk_bf16_f32 v134, v136, v137
    v_exp_f32 v147, v163
    v_mfma_f32_16x16x32_bf16 v[160:163], v[124:127], v[180:183], v[176:179]
    v_rcp_f32 v139, v139
    v_mfma_f32_4x4x4_16b_bf16 v[144:147], v[228:229], v[228:229], v[144:147]
    v_mfma_f32_16x16x32_bf16 v[156:159], v[120:123], v[184:187], v[156:159]
    v_rcp_f32 v140, v140
    v_mfma_f32_16x16x32_bf16 v[160:163], v[128:131], v[184:187], v[160:163]
    v_rcp_f32 v141, v141
    v_cvt_pk_bf16_f32 v135, v138, v139
    s_waitcnt vmcnt(4)
    ds_read_b128 v[180:183], v234 offset:6240
    ds_read_b128 v[184:187], v235 offset:6240
    v_rcp_f32 v142, v142
    v_cvt_pk_bf16_f32 v136, v140, v141
    v_mfma_f32_16x16x32_bf16 v[208:211], v[132:135], v[196:199], v[204:207]
    v_rcp_f32 v143, v143
    v_rcp_f32 v144, v144
    v_cvt_pk_bf16_f32 v137, v142, v143
    v_rcp_f32 v145, v145
    v_rcp_f32 v146, v146
    v_rcp_f32 v147, v147
    v_cvt_pk_bf16_f32 v138, v144, v145
    v_cvt_pk_bf16_f32 v139, v146, v147
    ds_read_u8 v230, v237 offset:96
    ds_read_u8 v232, v237 offset:104
    v_mfma_f32_16x16x32_bf16 v[208:211], v[136:139], v[200:203], v[208:211]
    s_bitcmp1_b32 s36, 2
    s_cbranch_scc1 Lf_ev2
Lf_evd2:
    v_exp_f32 v132, v148
    v_exp_f32 v133, v149
    v_exp_f32 v134, v150
    v_exp_f32 v135, v151
    v_exp_f32 v136, v152
    v_exp_f32 v137, v153
    v_mfma_f32_4x4x4_16b_bf16 v[132:135], v[228:229], v[228:229], v[132:135]
    v_cvt_pk_bf16_f32 v208, v208, v209
    v_cvt_pk_bf16_f32 v209, v210, v211
    s_waitcnt lgkmcnt(2)
    v_mfma_f32_16x16x32_bf16 v[148:151], v[100:103], v[180:183], v[164:167]
    v_exp_f32 v138, v154
    v_mfma_f32_4x4x4_16b_bf16 v[212:215], v[208:209], v[188:189], v[212:215] cbsz:4 abid:0
    ds_read_b64_tr_b16 v[188:189], v236 offset:4160
    v_exp_f32 v139, v155
    v_mfma_f32_16x16x32_bf16 v[152:155], v[108:111], v[180:183], v[168:171]
    v_exp_f32 v140, v156
    v_mfma_f32_4x4x4_16b_bf16 v[212:215], v[208:209], v[190:191], v[212:215] cbsz:4 abid:4
    ds_read_b64_tr_b16 v[190:191], v236 offset:4672
    v_mfma_f32_4x4x4_16b_bf16 v[136:139], v[228:229], v[228:229], v[136:139]
    v_rcp_f32 v132, v132
    v_mfma_f32_4x4x4_16b_bf16 v[212:215], v[208:209], v[192:193], v[212:215] cbsz:4 abid:8
    ds_read_b64_tr_b16 v[192:193], v236 offset:5216
    v_exp_f32 v141, v157
    v_mfma_f32_16x16x32_bf16 v[148:151], v[104:107], v[184:187], v[148:151]
    v_rcp_f32 v133, v133
    v_mfma_f32_4x4x4_16b_bf16 v[212:215], v[208:209], v[194:195], v[212:215] cbsz:4 abid:12
    ds_read_b64_tr_b16 v[194:195], v236 offset:5728
    v_exp_f32 v142, v158
    v_mfma_f32_16x16x32_bf16 v[152:155], v[112:115], v[184:187], v[152:155]
    v_rcp_f32 v134, v134
    v_exp_f32 v143, v159
    v_rcp_f32 v135, v135
    v_cvt_pk_bf16_f32 v132, v132, v133
    v_mfma_f32_4x4x4_16b_bf16 v[140:143], v[228:229], v[228:229], v[140:143]
    v_exp_f32 v144, v160
    v_mfma_f32_16x16x32_bf16 v[156:159], v[116:119], v[180:183], v[172:175]
    v_rcp_f32 v136, v136
    v_cvt_pk_bf16_f32 v133, v134, v135
    s_add_u32 m0, s52, 4160
    s_waitcnt lgkmcnt(0)
    buffer_load_dwordx4 v[230:231], s[20:23], 0 idxen offen nt lds
    v_exp_f32 v145, v161
    buffer_load_dwordx4 v[232:233], s[40:43], 0 idxen offen offset:1056 nt lds
    v_rcp_f32 v137, v137
    v_exp_f32 v146, v162
    v_rcp_f32 v138, v138
    v_cvt_pk_bf16_f32 v134, v136, v137
    v_exp_f32 v147, v163
    v_mfma_f32_16x16x32_bf16 v[160:163], v[124:127], v[180:183], v[176:179]
    v_rcp_f32 v139, v139
    v_mfma_f32_4x4x4_16b_bf16 v[144:147], v[228:229], v[228:229], v[144:147]
    v_mfma_f32_16x16x32_bf16 v[156:159], v[120:123], v[184:187], v[156:159]
    v_rcp_f32 v140, v140
    v_mfma_f32_16x16x32_bf16 v[160:163], v[128:131], v[184:187], v[160:163]
    v_rcp_f32 v141, v141
    v_cvt_pk_bf16_f32 v135, v138, v139
    s_waitcnt vmcnt(4)
    ds_read_b128 v[180:183], v234 offset:0
    ds_read_b128 v[184:187], v235 offset:0
    v_rcp_f32 v142, v142
    v_cvt_pk_bf16_f32 v136, v140, v141
    v_mfma_f32_16x16x32_bf16 v[208:211], v[132:135], v[196:199], v[204:207]
    v_rcp_f32 v143, v143
    v_rcp_f32 v144, v144
    v_cvt_pk_bf16_f32 v137, v142, v143
    v_rcp_f32 v145, v145
    v_rcp_f32 v146, v146
    v_rcp_f32 v147, v147
    v_cvt_pk_bf16_f32 v138, v144, v145
    v_cvt_pk_bf16_f32 v139, v146, v147
    ds_read_u8 v230, v237 offset:112
    ds_read_u8 v232, v237 offset:120
    v_mfma_f32_16x16x32_bf16 v[208:211], v[136:139], v[200:203], v[208:211]
    s_bitcmp1_b32 s36, 3
    s_cbranch_scc1 Lf_ev3
Lf_evd3:
    v_exp_f32 v132, v148
    v_exp_f32 v133, v149
    v_exp_f32 v134, v150
    v_exp_f32 v135, v151
    v_exp_f32 v136, v152
    v_exp_f32 v137, v153
    v_mfma_f32_4x4x4_16b_bf16 v[132:135], v[228:229], v[228:229], v[132:135]
    v_cvt_pk_bf16_f32 v208, v208, v209
    v_cvt_pk_bf16_f32 v209, v210, v211
    s_waitcnt lgkmcnt(2)
    v_mfma_f32_16x16x32_bf16 v[148:151], v[100:103], v[180:183], v[164:167]
    v_exp_f32 v138, v154
    v_mfma_f32_4x4x4_16b_bf16 v[212:215], v[208:209], v[188:189], v[212:215] cbsz:4 abid:0
    ds_read_b64_tr_b16 v[188:189], v236 offset:6240
    v_exp_f32 v139, v155
    v_mfma_f32_16x16x32_bf16 v[152:155], v[108:111], v[180:183], v[168:171]
    v_exp_f32 v140, v156
    v_mfma_f32_4x4x4_16b_bf16 v[212:215], v[208:209], v[190:191], v[212:215] cbsz:4 abid:4
    ds_read_b64_tr_b16 v[190:191], v236 offset:6752
    v_mfma_f32_4x4x4_16b_bf16 v[136:139], v[228:229], v[228:229], v[136:139]
    v_rcp_f32 v132, v132
    v_mfma_f32_4x4x4_16b_bf16 v[212:215], v[208:209], v[192:193], v[212:215] cbsz:4 abid:8
    ds_read_b64_tr_b16 v[192:193], v236 offset:7296
    v_exp_f32 v141, v157
    v_mfma_f32_16x16x32_bf16 v[148:151], v[104:107], v[184:187], v[148:151]
    v_rcp_f32 v133, v133
    v_mfma_f32_4x4x4_16b_bf16 v[212:215], v[208:209], v[194:195], v[212:215] cbsz:4 abid:12
    ds_read_b64_tr_b16 v[194:195], v236 offset:7808
    v_exp_f32 v142, v158
    v_mfma_f32_16x16x32_bf16 v[152:155], v[112:115], v[184:187], v[152:155]
    v_rcp_f32 v134, v134
    v_exp_f32 v143, v159
    v_rcp_f32 v135, v135
    v_cvt_pk_bf16_f32 v132, v132, v133
    v_mfma_f32_4x4x4_16b_bf16 v[140:143], v[228:229], v[228:229], v[140:143]
    v_exp_f32 v144, v160
    v_mfma_f32_16x16x32_bf16 v[156:159], v[116:119], v[180:183], v[172:175]
    v_rcp_f32 v136, v136
    v_cvt_pk_bf16_f32 v133, v134, v135
    s_add_u32 m0, s52, 6240
    s_waitcnt lgkmcnt(0)
    buffer_load_dwordx4 v[230:231], s[20:23], 0 idxen offen nt lds
    v_exp_f32 v145, v161
    buffer_load_dwordx4 v[232:233], s[40:43], 0 idxen offen offset:1056 nt lds
    v_rcp_f32 v137, v137
    v_exp_f32 v146, v162
    v_rcp_f32 v138, v138
    v_cvt_pk_bf16_f32 v134, v136, v137
    v_exp_f32 v147, v163
    v_mfma_f32_16x16x32_bf16 v[160:163], v[124:127], v[180:183], v[176:179]
    v_rcp_f32 v139, v139
    v_mfma_f32_4x4x4_16b_bf16 v[144:147], v[228:229], v[228:229], v[144:147]
    v_mfma_f32_16x16x32_bf16 v[156:159], v[120:123], v[184:187], v[156:159]
    v_rcp_f32 v140, v140
    v_mfma_f32_16x16x32_bf16 v[160:163], v[128:131], v[184:187], v[160:163]
    v_rcp_f32 v141, v141
    v_cvt_pk_bf16_f32 v135, v138, v139
    s_waitcnt vmcnt(4)
    ds_read_b128 v[180:183], v234 offset:2080
    ds_read_b128 v[184:187], v235 offset:2080
    v_rcp_f32 v142, v142
    v_cvt_pk_bf16_f32 v136, v140, v141
    v_mfma_f32_16x16x32_bf16 v[208:211], v[132:135], v[196:199], v[204:207]
    v_rcp_f32 v143, v143
    s_lshr_b64 s[56:57], s[56:57], 4
    s_lshl_b64 s[86:87], s[58:59], 60
    s_or_b64 s[56:57], s[56:57], s[86:87]
    s_lshr_b64 s[58:59], s[58:59], 4
    s_lshr_b64 s[86:87], s[56:57], 2
    s_lshr_b64 s[36:37], s[56:57], 5
    s_or_b32 s36, s36, s86
    s_or_b32 s36, s36, s56
    v_add_u32 v237, 64, v237
    v_rcp_f32 v144, v144
    v_cvt_pk_bf16_f32 v137, v142, v143
    v_rcp_f32 v145, v145
    v_rcp_f32 v146, v146
    v_rcp_f32 v147, v147
    v_cvt_pk_bf16_f32 v138, v144, v145
    v_cvt_pk_bf16_f32 v139, v146, v147
    s_branch Lf_loop
Lf_ev0:
    s_bitcmp0_b64 s[56:57], 0
    s_cbranch_scc1 Lf_nf0
    v_cvt_pk_bf16_f32 v246, v212, v212
    v_mov_b32 v212, 0
    ds_write_b16 v240, v246
    v_add_u32 v240, 128, v240
Lf_nf0:
    s_bitcmp0_b64 s[56:57], 5
    s_cbranch_scc1 Lf_na0
    s_sub_u32 s60, s60, 1
    s_cselect_b32 s31, 0, s31
    s_add_u32 s20, s20, s31
    s_addc_u32 s21, s21, 0
    s_add_u32 s40, s40, s31
    s_addc_u32 s41, s41, 0
    s_xor_b32 s31, s31, 0x63ff800
Lf_na0:
    s_bitcmp0_b64 s[56:57], 2
    s_cbranch_scc1 Lf_evd0
    s_sub_u32 s61, s61, 1
    s_cbranch_scc1 Lf_last0
    v_mul_u32_u24 v216, v224, v241
    v_mul_u32_u24 v217, v224, v242
    v_mul_u32_u24 v218, v225, v241
    v_mul_u32_u24 v219, v225, v242
    v_mul_u32_u24 v220, v226, v241
    v_mul_u32_u24 v221, v226, v242
    v_mul_u32_u24 v222, v227, v241
    v_mul_u32_u24 v223, v227, v242
    v_add_u32 v238, 128, v238
    ds_read_b128 v[164:167], v239
    v_mfma_f32_4x4x4_16b_bf16 v[132:135], v[216:217], v[68:69], v[4:7]
    ds_read_b128 v[168:171], v239 offset:64
    ds_read_b128 v[172:175], v239 offset:128
    v_mfma_f32_4x4x4_16b_bf16 v[136:139], v[218:219], v[70:71], v[8:11]
    ds_read_b128 v[176:179], v239 offset:192
    ds_read_u16 v224, v238
    v_mfma_f32_4x4x4_16b_bf16 v[140:143], v[220:221], v[72:73], v[12:15]
    ds_read_u16 v225, v238 offset:8
    ds_read_u16 v226, v238 offset:64
    v_mfma_f32_4x4x4_16b_bf16 v[144:147], v[222:223], v[74:75], v[16:19]
    ds_read_u16 v227, v238 offset:72
    v_add_u32 v239, 272, v239
    v_mfma_f32_4x4x4_16b_bf16 v[246:249], v[216:217], v[76:77], v[20:23]
    v_cvt_pk_bf16_f32 v100, v132, v133
    v_cvt_pk_bf16_f32 v101, v134, v135
    v_mfma_f32_4x4x4_16b_bf16 v[250:253], v[218:219], v[78:79], v[24:27]
    v_cvt_pk_bf16_f32 v102, v136, v137
    v_cvt_pk_bf16_f32 v103, v138, v139
    v_mfma_f32_4x4x4_16b_bf16 v[132:135], v[220:221], v[80:81], v[28:31]
    v_cvt_pk_bf16_f32 v104, v140, v141
    v_cvt_pk_bf16_f32 v105, v142, v143
    v_mfma_f32_4x4x4_16b_bf16 v[136:139], v[222:223], v[82:83], v[32:35]
    v_cvt_pk_bf16_f32 v106, v144, v145
    v_cvt_pk_bf16_f32 v107, v146, v147
    v_mfma_f32_4x4x4_16b_bf16 v[140:143], v[216:217], v[84:85], v[36:39]
    v_cvt_pk_bf16_f32 v108, v246, v247
    v_cvt_pk_bf16_f32 v109, v248, v249
    v_mfma_f32_4x4x4_16b_bf16 v[144:147], v[218:219], v[86:87], v[40:43]
    v_cvt_pk_bf16_f32 v110, v250, v251
    v_cvt_pk_bf16_f32 v111, v252, v253
    v_mfma_f32_4x4x4_16b_bf16 v[246:249], v[220:221], v[88:89], v[44:47]
    v_cvt_pk_bf16_f32 v112, v132, v133
    v_cvt_pk_bf16_f32 v113, v134, v135
    v_mfma_f32_4x4x4_16b_bf16 v[250:253], v[222:223], v[90:91], v[48:51]
    v_cvt_pk_bf16_f32 v114, v136, v137
    v_cvt_pk_bf16_f32 v115, v138, v139
    v_mfma_f32_4x4x4_16b_bf16 v[132:135], v[216:217], v[92:93], v[52:55]
    v_cvt_pk_bf16_f32 v116, v140, v141
    v_cvt_pk_bf16_f32 v117, v142, v143
    v_mfma_f32_4x4x4_16b_bf16 v[136:139], v[218:219], v[94:95], v[56:59]
    v_cvt_pk_bf16_f32 v118, v144, v145
    v_cvt_pk_bf16_f32 v119, v146, v147
    v_mfma_f32_4x4x4_16b_bf16 v[140:143], v[220:221], v[96:97], v[60:63]
    v_cvt_pk_bf16_f32 v120, v246, v247
    v_cvt_pk_bf16_f32 v121, v248, v249
    v_mfma_f32_4x4x4_16b_bf16 v[144:147], v[222:223], v[98:99], v[64:67]
    v_cvt_pk_bf16_f32 v122, v250, v251
    v_cvt_pk_bf16_f32 v123, v252, v253
    v_cvt_pk_bf16_f32 v124, v132, v133
    v_cvt_pk_bf16_f32 v125, v134, v135
    v_cvt_pk_bf16_f32 v126, v136, v137
    v_cvt_pk_bf16_f32 v127, v138, v139
    v_cvt_pk_bf16_f32 v128, v140, v141
    v_cvt_pk_bf16_f32 v129, v142, v143
    v_cvt_pk_bf16_f32 v130, v144, v145
    v_cvt_pk_bf16_f32 v131, v146, v147
    s_waitcnt lgkmcnt(0)
    s_branch Lf_evd0
Lf_ev1:
    s_bitcmp0_b64 s[56:57], 1
    s_cbranch_scc1 Lf_nf1
    v_cvt_pk_bf16_f32 v246, v212, v212
    v_mov_b32 v212, 0
    ds_write_b16 v240, v246
    v_add_u32 v240, 128, v240
Lf_nf1:
    s_bitcmp0_b64 s[56:57], 6
    s_cbranch_scc1 Lf_na1
    s_sub_u32 s60, s60, 1
    s_cselect_b32 s31, 0, s31
    s_add_u32 s20, s20, s31
    s_addc_u32 s21, s21, 0
    s_add_u32 s40, s40, s31
    s_addc_u32 s41, s41, 0
    s_xor_b32 s31, s31, 0x63ff800
Lf_na1:
    s_bitcmp0_b64 s[56:57], 3
    s_cbranch_scc1 Lf_evd1
    s_sub_u32 s61, s61, 1
    s_cbranch_scc1 Lf_last1
    v_mul_u32_u24 v216, v224, v241
    v_mul_u32_u24 v217, v224, v242
    v_mul_u32_u24 v218, v225, v241
    v_mul_u32_u24 v219, v225, v242
    v_mul_u32_u24 v220, v226, v241
    v_mul_u32_u24 v221, v226, v242
    v_mul_u32_u24 v222, v227, v241
    v_mul_u32_u24 v223, v227, v242
    v_add_u32 v238, 128, v238
    ds_read_b128 v[164:167], v239
    v_mfma_f32_4x4x4_16b_bf16 v[132:135], v[216:217], v[68:69], v[4:7]
    ds_read_b128 v[168:171], v239 offset:64
    ds_read_b128 v[172:175], v239 offset:128
    v_mfma_f32_4x4x4_16b_bf16 v[136:139], v[218:219], v[70:71], v[8:11]
    ds_read_b128 v[176:179], v239 offset:192
    ds_read_u16 v224, v238
    v_mfma_f32_4x4x4_16b_bf16 v[140:143], v[220:221], v[72:73], v[12:15]
    ds_read_u16 v225, v238 offset:8
    ds_read_u16 v226, v238 offset:64
    v_mfma_f32_4x4x4_16b_bf16 v[144:147], v[222:223], v[74:75], v[16:19]
    ds_read_u16 v227, v238 offset:72
    v_add_u32 v239, 272, v239
    v_mfma_f32_4x4x4_16b_bf16 v[246:249], v[216:217], v[76:77], v[20:23]
    v_cvt_pk_bf16_f32 v100, v132, v133
    v_cvt_pk_bf16_f32 v101, v134, v135
    v_mfma_f32_4x4x4_16b_bf16 v[250:253], v[218:219], v[78:79], v[24:27]
    v_cvt_pk_bf16_f32 v102, v136, v137
    v_cvt_pk_bf16_f32 v103, v138, v139
    v_mfma_f32_4x4x4_16b_bf16 v[132:135], v[220:221], v[80:81], v[28:31]
    v_cvt_pk_bf16_f32 v104, v140, v141
    v_cvt_pk_bf16_f32 v105, v142, v143
    v_mfma_f32_4x4x4_16b_bf16 v[136:139], v[222:223], v[82:83], v[32:35]
    v_cvt_pk_bf16_f32 v106, v144, v145
    v_cvt_pk_bf16_f32 v107, v146, v147
    v_mfma_f32_4x4x4_16b_bf16 v[140:143], v[216:217], v[84:85], v[36:39]
    v_cvt_pk_bf16_f32 v108, v246, v247
    v_cvt_pk_bf16_f32 v109, v248, v249
    v_mfma_f32_4x4x4_16b_bf16 v[144:147], v[218:219], v[86:87], v[40:43]
    v_cvt_pk_bf16_f32 v110, v250, v251
    v_cvt_pk_bf16_f32 v111, v252, v253
    v_mfma_f32_4x4x4_16b_bf16 v[246:249], v[220:221], v[88:89], v[44:47]
    v_cvt_pk_bf16_f32 v112, v132, v133
    v_cvt_pk_bf16_f32 v113, v134, v135
    v_mfma_f32_4x4x4_16b_bf16 v[250:253], v[222:223], v[90:91], v[48:51]
    v_cvt_pk_bf16_f32 v114, v136, v137
    v_cvt_pk_bf16_f32 v115, v138, v139
    v_mfma_f32_4x4x4_16b_bf16 v[132:135], v[216:217], v[92:93], v[52:55]
    v_cvt_pk_bf16_f32 v116, v140, v141
    v_cvt_pk_bf16_f32 v117, v142, v143
    v_mfma_f32_4x4x4_16b_bf16 v[136:139], v[218:219], v[94:95], v[56:59]
    v_cvt_pk_bf16_f32 v118, v144, v145
    v_cvt_pk_bf16_f32 v119, v146, v147
    v_mfma_f32_4x4x4_16b_bf16 v[140:143], v[220:221], v[96:97], v[60:63]
    v_cvt_pk_bf16_f32 v120, v246, v247
    v_cvt_pk_bf16_f32 v121, v248, v249
    v_mfma_f32_4x4x4_16b_bf16 v[144:147], v[222:223], v[98:99], v[64:67]
    v_cvt_pk_bf16_f32 v122, v250, v251
    v_cvt_pk_bf16_f32 v123, v252, v253
    v_cvt_pk_bf16_f32 v124, v132, v133
    v_cvt_pk_bf16_f32 v125, v134, v135
    v_cvt_pk_bf16_f32 v126, v136, v137
    v_cvt_pk_bf16_f32 v127, v138, v139
    v_cvt_pk_bf16_f32 v128, v140, v141
    v_cvt_pk_bf16_f32 v129, v142, v143
    v_cvt_pk_bf16_f32 v130, v144, v145
    v_cvt_pk_bf16_f32 v131, v146, v147
    s_waitcnt lgkmcnt(0)
    s_branch Lf_evd1
Lf_ev2:
    s_bitcmp0_b64 s[56:57], 2
    s_cbranch_scc1 Lf_nf2
    v_cvt_pk_bf16_f32 v246, v212, v212
    v_mov_b32 v212, 0
    ds_write_b16 v240, v246
    v_add_u32 v240, 128, v240
Lf_nf2:
    s_bitcmp0_b64 s[56:57], 7
    s_cbranch_scc1 Lf_na2
    s_sub_u32 s60, s60, 1
    s_cselect_b32 s31, 0, s31
    s_add_u32 s20, s20, s31
    s_addc_u32 s21, s21, 0
    s_add_u32 s40, s40, s31
    s_addc_u32 s41, s41, 0
    s_xor_b32 s31, s31, 0x63ff800
Lf_na2:
    s_bitcmp0_b64 s[56:57], 4
    s_cbranch_scc1 Lf_evd2
    s_sub_u32 s61, s61, 1
    s_cbranch_scc1 Lf_last2
    v_mul_u32_u24 v216, v224, v241
    v_mul_u32_u24 v217, v224, v242
    v_mul_u32_u24 v218, v225, v241
    v_mul_u32_u24 v219, v225, v242
    v_mul_u32_u24 v220, v226, v241
    v_mul_u32_u24 v221, v226, v242
    v_mul_u32_u24 v222, v227, v241
    v_mul_u32_u24 v223, v227, v242
    v_add_u32 v238, 128, v238
    ds_read_b128 v[164:167], v239
    v_mfma_f32_4x4x4_16b_bf16 v[132:135], v[216:217], v[68:69], v[4:7]
    ds_read_b128 v[168:171], v239 offset:64
    ds_read_b128 v[172:175], v239 offset:128
    v_mfma_f32_4x4x4_16b_bf16 v[136:139], v[218:219], v[70:71], v[8:11]
    ds_read_b128 v[176:179], v239 offset:192
    ds_read_u16 v224, v238
    v_mfma_f32_4x4x4_16b_bf16 v[140:143], v[220:221], v[72:73], v[12:15]
    ds_read_u16 v225, v238 offset:8
    ds_read_u16 v226, v238 offset:64
    v_mfma_f32_4x4x4_16b_bf16 v[144:147], v[222:223], v[74:75], v[16:19]
    ds_read_u16 v227, v238 offset:72
    v_add_u32 v239, 272, v239
    v_mfma_f32_4x4x4_16b_bf16 v[246:249], v[216:217], v[76:77], v[20:23]
    v_cvt_pk_bf16_f32 v100, v132, v133
    v_cvt_pk_bf16_f32 v101, v134, v135
    v_mfma_f32_4x4x4_16b_bf16 v[250:253], v[218:219], v[78:79], v[24:27]
    v_cvt_pk_bf16_f32 v102, v136, v137
    v_cvt_pk_bf16_f32 v103, v138, v139
    v_mfma_f32_4x4x4_16b_bf16 v[132:135], v[220:221], v[80:81], v[28:31]
    v_cvt_pk_bf16_f32 v104, v140, v141
    v_cvt_pk_bf16_f32 v105, v142, v143
    v_mfma_f32_4x4x4_16b_bf16 v[136:139], v[222:223], v[82:83], v[32:35]
    v_cvt_pk_bf16_f32 v106, v144, v145
    v_cvt_pk_bf16_f32 v107, v146, v147
    v_mfma_f32_4x4x4_16b_bf16 v[140:143], v[216:217], v[84:85], v[36:39]
    v_cvt_pk_bf16_f32 v108, v246, v247
    v_cvt_pk_bf16_f32 v109, v248, v249
    v_mfma_f32_4x4x4_16b_bf16 v[144:147], v[218:219], v[86:87], v[40:43]
    v_cvt_pk_bf16_f32 v110, v250, v251
    v_cvt_pk_bf16_f32 v111, v252, v253
    v_mfma_f32_4x4x4_16b_bf16 v[246:249], v[220:221], v[88:89], v[44:47]
    v_cvt_pk_bf16_f32 v112, v132, v133
    v_cvt_pk_bf16_f32 v113, v134, v135
    v_mfma_f32_4x4x4_16b_bf16 v[250:253], v[222:223], v[90:91], v[48:51]
    v_cvt_pk_bf16_f32 v114, v136, v137
    v_cvt_pk_bf16_f32 v115, v138, v139
    v_mfma_f32_4x4x4_16b_bf16 v[132:135], v[216:217], v[92:93], v[52:55]
    v_cvt_pk_bf16_f32 v116, v140, v141
    v_cvt_pk_bf16_f32 v117, v142, v143
    v_mfma_f32_4x4x4_16b_bf16 v[136:139], v[218:219], v[94:95], v[56:59]
    v_cvt_pk_bf16_f32 v118, v144, v145
    v_cvt_pk_bf16_f32 v119, v146, v147
    v_mfma_f32_4x4x4_16b_bf16 v[140:143], v[220:221], v[96:97], v[60:63]
    v_cvt_pk_bf16_f32 v120, v246, v247
    v_cvt_pk_bf16_f32 v121, v248, v249
    v_mfma_f32_4x4x4_16b_bf16 v[144:147], v[222:223], v[98:99], v[64:67]
    v_cvt_pk_bf16_f32 v122, v250, v251
    v_cvt_pk_bf16_f32 v123, v252, v253
    v_cvt_pk_bf16_f32 v124, v132, v133
    v_cvt_pk_bf16_f32 v125, v134, v135
    v_cvt_pk_bf16_f32 v126, v136, v137
    v_cvt_pk_bf16_f32 v127, v138, v139
    v_cvt_pk_bf16_f32 v128, v140, v141
    v_cvt_pk_bf16_f32 v129, v142, v143
    v_cvt_pk_bf16_f32 v130, v144, v145
    v_cvt_pk_bf16_f32 v131, v146, v147
    s_waitcnt lgkmcnt(0)
    s_branch Lf_evd2
Lf_ev3:
    s_bitcmp0_b64 s[56:57], 3
    s_cbranch_scc1 Lf_nf3
    v_cvt_pk_bf16_f32 v246, v212, v212
    v_mov_b32 v212, 0
    ds_write_b16 v240, v246
    v_add_u32 v240, 128, v240
Lf_nf3:
    s_bitcmp0_b64 s[56:57], 8
    s_cbranch_scc1 Lf_na3
    s_sub_u32 s60, s60, 1
    s_cselect_b32 s31, 0, s31
    s_add_u32 s20, s20, s31
    s_addc_u32 s21, s21, 0
    s_add_u32 s40, s40, s31
    s_addc_u32 s41, s41, 0
    s_xor_b32 s31, s31, 0x63ff800
Lf_na3:
    s_bitcmp0_b64 s[56:57], 5
    s_cbranch_scc1 Lf_evd3
    s_sub_u32 s61, s61, 1
    s_cbranch_scc1 Lf_last3
    v_mul_u32_u24 v216, v224, v241
    v_mul_u32_u24 v217, v224, v242
    v_mul_u32_u24 v218, v225, v241
    v_mul_u32_u24 v219, v225, v242
    v_mul_u32_u24 v220, v226, v241
    v_mul_u32_u24 v221, v226, v242
    v_mul_u32_u24 v222, v227, v241
    v_mul_u32_u24 v223, v227, v242
    v_add_u32 v238, 128, v238
    ds_read_b128 v[164:167], v239
    v_mfma_f32_4x4x4_16b_bf16 v[132:135], v[216:217], v[68:69], v[4:7]
    ds_read_b128 v[168:171], v239 offset:64
    ds_read_b128 v[172:175], v239 offset:128
    v_mfma_f32_4x4x4_16b_bf16 v[136:139], v[218:219], v[70:71], v[8:11]
    ds_read_b128 v[176:179], v239 offset:192
    ds_read_u16 v224, v238
    v_mfma_f32_4x4x4_16b_bf16 v[140:143], v[220:221], v[72:73], v[12:15]
    ds_read_u16 v225, v238 offset:8
    ds_read_u16 v226, v238 offset:64
    v_mfma_f32_4x4x4_16b_bf16 v[144:147], v[222:223], v[74:75], v[16:19]
    ds_read_u16 v227, v238 offset:72
    v_add_u32 v239, 272, v239
    v_mfma_f32_4x4x4_16b_bf16 v[246:249], v[216:217], v[76:77], v[20:23]
    v_cvt_pk_bf16_f32 v100, v132, v133
    v_cvt_pk_bf16_f32 v101, v134, v135
    v_mfma_f32_4x4x4_16b_bf16 v[250:253], v[218:219], v[78:79], v[24:27]
    v_cvt_pk_bf16_f32 v102, v136, v137
    v_cvt_pk_bf16_f32 v103, v138, v139
    v_mfma_f32_4x4x4_16b_bf16 v[132:135], v[220:221], v[80:81], v[28:31]
    v_cvt_pk_bf16_f32 v104, v140, v141
    v_cvt_pk_bf16_f32 v105, v142, v143
    v_mfma_f32_4x4x4_16b_bf16 v[136:139], v[222:223], v[82:83], v[32:35]
    v_cvt_pk_bf16_f32 v106, v144, v145
    v_cvt_pk_bf16_f32 v107, v146, v147
    v_mfma_f32_4x4x4_16b_bf16 v[140:143], v[216:217], v[84:85], v[36:39]
    v_cvt_pk_bf16_f32 v108, v246, v247
    v_cvt_pk_bf16_f32 v109, v248, v249
    v_mfma_f32_4x4x4_16b_bf16 v[144:147], v[218:219], v[86:87], v[40:43]
    v_cvt_pk_bf16_f32 v110, v250, v251
    v_cvt_pk_bf16_f32 v111, v252, v253
    v_mfma_f32_4x4x4_16b_bf16 v[246:249], v[220:221], v[88:89], v[44:47]
    v_cvt_pk_bf16_f32 v112, v132, v133
    v_cvt_pk_bf16_f32 v113, v134, v135
    v_mfma_f32_4x4x4_16b_bf16 v[250:253], v[222:223], v[90:91], v[48:51]
    v_cvt_pk_bf16_f32 v114, v136, v137
    v_cvt_pk_bf16_f32 v115, v138, v139
    v_mfma_f32_4x4x4_16b_bf16 v[132:135], v[216:217], v[92:93], v[52:55]
    v_cvt_pk_bf16_f32 v116, v140, v141
    v_cvt_pk_bf16_f32 v117, v142, v143
    v_mfma_f32_4x4x4_16b_bf16 v[136:139], v[218:219], v[94:95], v[56:59]
    v_cvt_pk_bf16_f32 v118, v144, v145
    v_cvt_pk_bf16_f32 v119, v146, v147
    v_mfma_f32_4x4x4_16b_bf16 v[140:143], v[220:221], v[96:97], v[60:63]
    v_cvt_pk_bf16_f32 v120, v246, v247
    v_cvt_pk_bf16_f32 v121, v248, v249
    v_mfma_f32_4x4x4_16b_bf16 v[144:147], v[222:223], v[98:99], v[64:67]
    v_cvt_pk_bf16_f32 v122, v250, v251
    v_cvt_pk_bf16_f32 v123, v252, v253
    v_cvt_pk_bf16_f32 v124, v132, v133
    v_cvt_pk_bf16_f32 v125, v134, v135
    v_cvt_pk_bf16_f32 v126, v136, v137
    v_cvt_pk_bf16_f32 v127, v138, v139
    v_cvt_pk_bf16_f32 v128, v140, v141
    v_cvt_pk_bf16_f32 v129, v142, v143
    v_cvt_pk_bf16_f32 v130, v144, v145
    v_cvt_pk_bf16_f32 v131, v146, v147
    s_waitcnt lgkmcnt(0)
    s_branch Lf_evd3
Lf_last0:
    s_branch Lf_tail
Lf_last1:
    v_add_u32 v236, 2080, v236
    s_lshr_b64 s[56:57], s[56:57], 1
    s_branch Lf_tail
Lf_last2:
    v_add_u32 v236, 4160, v236
    s_lshr_b64 s[56:57], s[56:57], 2
    s_branch Lf_tail
Lf_last3:
    v_add_u32 v236, 6240, v236
    s_lshr_b64 s[56:57], s[56:57], 3
Lf_tail:
    v_exp_f32 v132, v148
    v_exp_f32 v133, v149
    v_exp_f32 v134, v150
    v_exp_f32 v135, v151
    v_exp_f32 v136, v152
    v_exp_f32 v137, v153
    v_mfma_f32_4x4x4_16b_bf16 v[132:135], v[228:229], v[228:229], v[132:135]
    v_cvt_pk_bf16_f32 v208, v208, v209
    v_cvt_pk_bf16_f32 v209, v210, v211
    v_exp_f32 v138, v154
    s_nop 0
    v_mfma_f32_4x4x4_16b_bf16 v[212:215], v[208:209], v[188:189], v[212:215] cbsz:4 abid:0
    ds_read_b64_tr_b16 v[188:189], v236 offset:0
    v_exp_f32 v139, v155
    v_exp_f32 v140, v156
    v_mfma_f32_4x4x4_16b_bf16 v[212:215], v[208:209], v[190:191], v[212:215] cbsz:4 abid:4
    ds_read_b64_tr_b16 v[190:191], v236 offset:512
    v_mfma_f32_4x4x4_16b_bf16 v[136:139], v[228:229], v[228:229], v[136:139]
    v_rcp_f32 v132, v132
    v_mfma_f32_4x4x4_16b_bf16 v[212:215], v[208:209], v[192:193], v[212:215] cbsz:4 abid:8
    ds_read_b64_tr_b16 v[192:193], v236 offset:1056
    v_exp_f32 v141, v157
    v_rcp_f32 v133, v133
    v_mfma_f32_4x4x4_16b_bf16 v[212:215], v[208:209], v[194:195], v[212:215] cbsz:4 abid:12
    ds_read_b64_tr_b16 v[194:195], v236 offset:1568
    v_exp_f32 v142, v158
    v_rcp_f32 v134, v134
    v_exp_f32 v143, v159
    v_rcp_f32 v135, v135
    v_cvt_pk_bf16_f32 v132, v132, v133
    v_mfma_f32_4x4x4_16b_bf16 v[140:143], v[228:229], v[228:229], v[140:143]
    v_exp_f32 v144, v160
    v_rcp_f32 v136, v136
    v_cvt_pk_bf16_f32 v133, v134, v135
    s_bitcmp0_b64 s[56:57], 1
    s_cbranch_scc1 Lf_tnf
    v_cvt_pk_bf16_f32 v246, v212, v212
    v_mov_b32 v212, 0
    ds_write_b16 v240, v246
    v_add_u32 v240, 128, v240
Lf_tnf:
    s_waitcnt lgkmcnt(0)
    v_exp_f32 v145, v161
    v_rcp_f32 v137, v137
    v_exp_f32 v146, v162
    v_rcp_f32 v138, v138
    v_cvt_pk_bf16_f32 v134, v136, v137
    v_exp_f32 v147, v163
    v_rcp_f32 v139, v139
    s_nop 0
    v_mfma_f32_4x4x4_16b_bf16 v[144:147], v[228:229], v[228:229], v[144:147]
    v_rcp_f32 v140, v140
    v_rcp_f32 v141, v141
    v_cvt_pk_bf16_f32 v135, v138, v139
    v_rcp_f32 v142, v142
    v_cvt_pk_bf16_f32 v136, v140, v141
    v_mfma_f32_16x16x32_bf16 v[208:211], v[132:135], v[196:199], v[204:207]
    v_rcp_f32 v143, v143
    v_rcp_f32 v144, v144
    v_cvt_pk_bf16_f32 v137, v142, v143
    v_rcp_f32 v145, v145
    v_rcp_f32 v146, v146
    v_rcp_f32 v147, v147
    v_cvt_pk_bf16_f32 v138, v144, v145
    v_cvt_pk_bf16_f32 v139, v146, v147
    s_nop 1
    v_mfma_f32_16x16x32_bf16 v[208:211], v[136:139], v[200:203], v[208:211]
    s_nop 7
    v_cvt_pk_bf16_f32 v208, v208, v209
    v_cvt_pk_bf16_f32 v209, v210, v211
    s_nop 1
    v_mfma_f32_4x4x4_16b_bf16 v[212:215], v[208:209], v[188:189], v[212:215] cbsz:4 abid:0
    s_nop 1
    v_mfma_f32_4x4x4_16b_bf16 v[212:215], v[208:209], v[190:191], v[212:215] cbsz:4 abid:4
    s_nop 1
    v_mfma_f32_4x4x4_16b_bf16 v[212:215], v[208:209], v[192:193], v[212:215] cbsz:4 abid:8
    s_nop 1
    v_mfma_f32_4x4x4_16b_bf16 v[212:215], v[208:209], v[194:195], v[212:215] cbsz:4 abid:12
    s_nop 4
    v_cvt_pk_bf16_f32 v246, v212, v212
    ds_write_b16 v240, v246
L_store:
    s_add_u32 s66, s52, 8320
    v_lshl_add_u32 v247, v0, 4, s66
    s_waitcnt lgkmcnt(0)
    ds_read_b128 v[148:151], v247
    s_waitcnt lgkmcnt(0)
    global_store_dwordx4 v243, v[148:151], s[18:19]
L_end:
    s_endpgm
Ls_loop:
    ds_read_u8 v230, v237 offset:64
    ds_read_u8 v232, v237 offset:72
    v_mfma_f32_16x16x32_bf16 v[208:211], v[136:139], v[200:203], v[208:211]
Ls_mid:
    s_bitcmp1_b32 s36, 0
    s_cbranch_scc1 Ls_ev0
Ls_evd0:
    ds_read_b32 v246, v244 offset:0
    s_waitcnt lgkmcnt(0)
    v_bfe_u32 v247, v246, 0, 8
    v_lshlrev_b32 v247, 1, v247
    v_bfe_u32 v248, v246, 8, 8
    v_lshlrev_b32 v248, 1, v248
    v_bfe_u32 v249, v246, 16, 8
    v_lshlrev_b32 v249, 1, v249
    v_bfe_u32 v250, v246, 24, 8
    v_lshlrev_b32 v250, 1, v250
    buffer_load_ushort v247, v247, s[24:27], 0 offen
    buffer_load_ushort v248, v248, s[24:27], 0 offen
    buffer_load_ushort v249, v249, s[24:27], 0 offen
    buffer_load_ushort v250, v250, s[24:27], 0 offen
    s_waitcnt vmcnt(0)
    v_lshlrev_b32 v247, 16, v247
    v_mul_f32 v208, v208, v247
    v_lshlrev_b32 v248, 16, v248
    v_mul_f32 v209, v209, v248
    v_lshlrev_b32 v249, 16, v249
    v_mul_f32 v210, v210, v249
    v_lshlrev_b32 v250, 16, v250
    v_mul_f32 v211, v211, v250
    s_mov_b64 exec, 1
    ds_add_rtn_u32 v1, v2, v3
    s_mov_b64 exec, -1
    v_exp_f32 v132, v148
    v_exp_f32 v133, v149
    v_exp_f32 v134, v150
    v_exp_f32 v135, v151
    v_exp_f32 v136, v152
    v_exp_f32 v137, v153
    v_mfma_f32_4x4x4_16b_bf16 v[132:135], v[228:229], v[228:229], v[132:135]
    v_cvt_pk_bf16_f32 v208, v208, v209
    v_cvt_pk_bf16_f32 v209, v210, v211
    s_waitcnt lgkmcnt(2)
    v_mfma_f32_16x16x32_bf16 v[148:151], v[100:103], v[180:183], v[164:167]
    v_exp_f32 v138, v154
    v_mfma_f32_4x4x4_16b_bf16 v[212:215], v[208:209], v[188:189], v[212:215] cbsz:4 abid:0
    ds_read_b64_tr_b16 v[188:189], v236 offset:0
    v_exp_f32 v139, v155
    v_mfma_f32_16x16x32_bf16 v[152:155], v[108:111], v[180:183], v[168:171]
    v_exp_f32 v140, v156
    v_mfma_f32_4x4x4_16b_bf16 v[212:215], v[208:209], v[190:191], v[212:215] cbsz:4 abid:4
    ds_read_b64_tr_b16 v[190:191], v236 offset:512
    v_mfma_f32_4x4x4_16b_bf16 v[136:139], v[228:229], v[228:229], v[136:139]
    v_rcp_f32 v132, v132
    v_mfma_f32_4x4x4_16b_bf16 v[212:215], v[208:209], v[192:193], v[212:215] cbsz:4 abid:8
    ds_read_b64_tr_b16 v[192:193], v236 offset:1056
    v_exp_f32 v141, v157
    v_mfma_f32_16x16x32_bf16 v[148:151], v[104:107], v[184:187], v[148:151]
    v_rcp_f32 v133, v133
    v_mfma_f32_4x4x4_16b_bf16 v[212:215], v[208:209], v[194:195], v[212:215] cbsz:4 abid:12
    ds_read_b64_tr_b16 v[194:195], v236 offset:1568
    v_exp_f32 v142, v158
    v_mfma_f32_16x16x32_bf16 v[152:155], v[112:115], v[184:187], v[152:155]
    v_rcp_f32 v134, v134
    v_exp_f32 v143, v159
    v_rcp_f32 v135, v135
    v_cvt_pk_bf16_f32 v132, v132, v133
    v_mfma_f32_4x4x4_16b_bf16 v[140:143], v[228:229], v[228:229], v[140:143]
    v_exp_f32 v144, v160
    v_mfma_f32_16x16x32_bf16 v[156:159], v[116:119], v[180:183], v[172:175]
    v_rcp_f32 v136, v136
    v_cvt_pk_bf16_f32 v133, v134, v135
    s_add_u32 m0, s52, 0
    s_waitcnt lgkmcnt(0)
    buffer_load_dwordx4 v[230:231], s[20:23], 0 idxen offen nt lds
    v_exp_f32 v145, v161
    buffer_load_dwordx4 v[232:233], s[40:43], 0 idxen offen offset:1056 nt lds
    v_rcp_f32 v137, v137
    v_exp_f32 v146, v162
    v_rcp_f32 v138, v138
    v_cvt_pk_bf16_f32 v134, v136, v137
    v_exp_f32 v147, v163
    v_mfma_f32_16x16x32_bf16 v[160:163], v[124:127], v[180:183], v[176:179]
    v_readfirstlane_b32 s66, v1
    s_setprio 0
    s_xor_b32 s66, s66, s33
    s_cmp_gt_i32 s66, 0
    s_cbranch_scc0 Ls_lo0
    s_setprio 1
Ls_lo0:
    v_rcp_f32 v139, v139
    v_mfma_f32_4x4x4_16b_bf16 v[144:147], v[228:229], v[228:229], v[144:147]
    v_mfma_f32_16x16x32_bf16 v[156:159], v[120:123], v[184:187], v[156:159]
    v_rcp_f32 v140, v140
    v_mfma_f32_16x16x32_bf16 v[160:163], v[128:131], v[184:187], v[160:163]
    v_rcp_f32 v141, v141
    v_cvt_pk_bf16_f32 v135, v138, v139
    s_waitcnt vmcnt(4)
    ds_read_b128 v[180:183], v234 offset:4160
    ds_read_b128 v[184:187], v235 offset:4160
    v_rcp_f32 v142, v142
    v_cvt_pk_bf16_f32 v136, v140, v141
    v_mfma_f32_16x16x32_bf16 v[208:211], v[132:135], v[196:199], v[204:207]
    v_rcp_f32 v143, v143
    v_rcp_f32 v144, v144
    v_cvt_pk_bf16_f32 v137, v142, v143
    v_rcp_f32 v145, v145
    v_rcp_f32 v146, v146
    v_rcp_f32 v147, v147
    v_cvt_pk_bf16_f32 v138, v144, v145
    v_cvt_pk_bf16_f32 v139, v146, v147
    ds_read_u8 v230, v237 offset:80
    ds_read_u8 v232, v237 offset:88
    v_mfma_f32_16x16x32_bf16 v[208:211], v[136:139], v[200:203], v[208:211]
    s_bitcmp1_b32 s36, 1
    s_cbranch_scc1 Ls_ev1
Ls_evd1:
    ds_read_b32 v246, v244 offset:16
    s_waitcnt lgkmcnt(0)
    v_bfe_u32 v247, v246, 0, 8
    v_lshlrev_b32 v247, 1, v247
    v_bfe_u32 v248, v246, 8, 8
    v_lshlrev_b32 v248, 1, v248
    v_bfe_u32 v249, v246, 16, 8
    v_lshlrev_b32 v249, 1, v249
    v_bfe_u32 v250, v246, 24, 8
    v_lshlrev_b32 v250, 1, v250
    buffer_load_ushort v247, v247, s[24:27], 0 offen
    buffer_load_ushort v248, v248, s[24:27], 0 offen
    buffer_load_ushort v249, v249, s[24:27], 0 offen
    buffer_load_ushort v250, v250, s[24:27], 0 offen
    s_waitcnt vmcnt(0)
    v_lshlrev_b32 v247, 16, v247
    v_mul_f32 v208, v208, v247
    v_lshlrev_b32 v248, 16, v248
    v_mul_f32 v209, v209, v248
    v_lshlrev_b32 v249, 16, v249
    v_mul_f32 v210, v210, v249
    v_lshlrev_b32 v250, 16, v250
    v_mul_f32 v211, v211, v250
    v_exp_f32 v132, v148
    v_exp_f32 v133, v149
    v_exp_f32 v134, v150
    v_exp_f32 v135, v151
    v_exp_f32 v136, v152
    v_exp_f32 v137, v153
    v_mfma_f32_4x4x4_16b_bf16 v[132:135], v[228:229], v[228:229], v[132:135]
    v_cvt_pk_bf16_f32 v208, v208, v209
    v_cvt_pk_bf16_f32 v209, v210, v211
    s_waitcnt lgkmcnt(2)
    v_mfma_f32_16x16x32_bf16 v[148:151], v[100:103], v[180:183], v[164:167]
    v_exp_f32 v138, v154
    v_mfma_f32_4x4x4_16b_bf16 v[212:215], v[208:209], v[188:189], v[212:215] cbsz:4 abid:0
    ds_read_b64_tr_b16 v[188:189], v236 offset:2080
    v_exp_f32 v139, v155
    v_mfma_f32_16x16x32_bf16 v[152:155], v[108:111], v[180:183], v[168:171]
    v_exp_f32 v140, v156
    v_mfma_f32_4x4x4_16b_bf16 v[212:215], v[208:209], v[190:191], v[212:215] cbsz:4 abid:4
    ds_read_b64_tr_b16 v[190:191], v236 offset:2592
    v_mfma_f32_4x4x4_16b_bf16 v[136:139], v[228:229], v[228:229], v[136:139]
    v_rcp_f32 v132, v132
    v_mfma_f32_4x4x4_16b_bf16 v[212:215], v[208:209], v[192:193], v[212:215] cbsz:4 abid:8
    ds_read_b64_tr_b16 v[192:193], v236 offset:3136
    v_exp_f32 v141, v157
    v_mfma_f32_16x16x32_bf16 v[148:151], v[104:107], v[184:187], v[148:151]
    v_rcp_f32 v133, v133
    v_mfma_f32_4x4x4_16b_bf16 v[212:215], v[208:209], v[194:195], v[212:215] cbsz:4 abid:12
    ds_read_b64_tr_b16 v[194:195], v236 offset:3648
    v_exp_f32 v142, v158
    v_mfma_f32_16x16x32_bf16 v[152:155], v[112:115], v[184:187], v[152:155]
    v_rcp_f32 v134, v134
    v_exp_f32 v143, v159
    v_rcp_f32 v135, v135
    v_cvt_pk_bf16_f32 v132, v132, v133
    v_mfma_f32_4x4x4_16b_bf16 v[140:143], v[228:229], v[228:229], v[140:143]
    v_exp_f32 v144, v160
    v_mfma_f32_16x16x32_bf16 v[156:159], v[116:119], v[180:183], v[172:175]
    v_rcp_f32 v136, v136
    v_cvt_pk_bf16_f32 v133, v134, v135
    s_add_u32 m0, s52, 2080
    s_waitcnt lgkmcnt(0)
    buffer_load_dwordx4 v[230:231], s[20:23], 0 idxen offen nt lds
    v_exp_f32 v145, v161
    buffer_load_dwordx4 v[232:233], s[40:43], 0 idxen offen offset:1056 nt lds
    v_rcp_f32 v137, v137
    v_exp_f32 v146, v162
    v_rcp_f32 v138, v138
    v_cvt_pk_bf16_f32 v134, v136, v137
    v_exp_f32 v147, v163
    v_mfma_f32_16x16x32_bf16 v[160:163], v[124:127], v[180:183], v[176:179]
    v_rcp_f32 v139, v139
    v_mfma_f32_4x4x4_16b_bf16 v[144:147], v[228:229], v[228:229], v[144:147]
    v_mfma_f32_16x16x32_bf16 v[156:159], v[120:123], v[184:187], v[156:159]
    v_rcp_f32 v140, v140
    v_mfma_f32_16x16x32_bf16 v[160:163], v[128:131], v[184:187], v[160:163]
    v_rcp_f32 v141, v141
    v_cvt_pk_bf16_f32 v135, v138, v139
    s_waitcnt vmcnt(4)
    ds_read_b128 v[180:183], v234 offset:6240
    ds_read_b128 v[184:187], v235 offset:6240
    v_rcp_f32 v142, v142
    v_cvt_pk_bf16_f32 v136, v140, v141
    v_mfma_f32_16x16x32_bf16 v[208:211], v[132:135], v[196:199], v[204:207]
    v_rcp_f32 v143, v143
    v_rcp_f32 v144, v144
    v_cvt_pk_bf16_f32 v137, v142, v143
    v_rcp_f32 v145, v145
    v_rcp_f32 v146, v146
    v_rcp_f32 v147, v147
    v_cvt_pk_bf16_f32 v138, v144, v145
    v_cvt_pk_bf16_f32 v139, v146, v147
    ds_read_u8 v230, v237 offset:96
    ds_read_u8 v232, v237 offset:104
    v_mfma_f32_16x16x32_bf16 v[208:211], v[136:139], v[200:203], v[208:211]
    s_bitcmp1_b32 s36, 2
    s_cbranch_scc1 Ls_ev2
Ls_evd2:
    ds_read_b32 v246, v244 offset:32
    s_waitcnt lgkmcnt(0)
    v_bfe_u32 v247, v246, 0, 8
    v_lshlrev_b32 v247, 1, v247
    v_bfe_u32 v248, v246, 8, 8
    v_lshlrev_b32 v248, 1, v248
    v_bfe_u32 v249, v246, 16, 8
    v_lshlrev_b32 v249, 1, v249
    v_bfe_u32 v250, v246, 24, 8
    v_lshlrev_b32 v250, 1, v250
    buffer_load_ushort v247, v247, s[24:27], 0 offen
    buffer_load_ushort v248, v248, s[24:27], 0 offen
    buffer_load_ushort v249, v249, s[24:27], 0 offen
    buffer_load_ushort v250, v250, s[24:27], 0 offen
    s_waitcnt vmcnt(0)
    v_lshlrev_b32 v247, 16, v247
    v_mul_f32 v208, v208, v247
    v_lshlrev_b32 v248, 16, v248
    v_mul_f32 v209, v209, v248
    v_lshlrev_b32 v249, 16, v249
    v_mul_f32 v210, v210, v249
    v_lshlrev_b32 v250, 16, v250
    v_mul_f32 v211, v211, v250
    v_exp_f32 v132, v148
    v_exp_f32 v133, v149
    v_exp_f32 v134, v150
    v_exp_f32 v135, v151
    v_exp_f32 v136, v152
    v_exp_f32 v137, v153
    v_mfma_f32_4x4x4_16b_bf16 v[132:135], v[228:229], v[228:229], v[132:135]
    v_cvt_pk_bf16_f32 v208, v208, v209
    v_cvt_pk_bf16_f32 v209, v210, v211
    s_waitcnt lgkmcnt(2)
    v_mfma_f32_16x16x32_bf16 v[148:151], v[100:103], v[180:183], v[164:167]
    v_exp_f32 v138, v154
    v_mfma_f32_4x4x4_16b_bf16 v[212:215], v[208:209], v[188:189], v[212:215] cbsz:4 abid:0
    ds_read_b64_tr_b16 v[188:189], v236 offset:4160
    v_exp_f32 v139, v155
    v_mfma_f32_16x16x32_bf16 v[152:155], v[108:111], v[180:183], v[168:171]
    v_exp_f32 v140, v156
    v_mfma_f32_4x4x4_16b_bf16 v[212:215], v[208:209], v[190:191], v[212:215] cbsz:4 abid:4
    ds_read_b64_tr_b16 v[190:191], v236 offset:4672
    v_mfma_f32_4x4x4_16b_bf16 v[136:139], v[228:229], v[228:229], v[136:139]
    v_rcp_f32 v132, v132
    v_mfma_f32_4x4x4_16b_bf16 v[212:215], v[208:209], v[192:193], v[212:215] cbsz:4 abid:8
    ds_read_b64_tr_b16 v[192:193], v236 offset:5216
    v_exp_f32 v141, v157
    v_mfma_f32_16x16x32_bf16 v[148:151], v[104:107], v[184:187], v[148:151]
    v_rcp_f32 v133, v133
    v_mfma_f32_4x4x4_16b_bf16 v[212:215], v[208:209], v[194:195], v[212:215] cbsz:4 abid:12
    ds_read_b64_tr_b16 v[194:195], v236 offset:5728
    v_exp_f32 v142, v158
    v_mfma_f32_16x16x32_bf16 v[152:155], v[112:115], v[184:187], v[152:155]
    v_rcp_f32 v134, v134
    v_exp_f32 v143, v159
    v_rcp_f32 v135, v135
    v_cvt_pk_bf16_f32 v132, v132, v133
    v_mfma_f32_4x4x4_16b_bf16 v[140:143], v[228:229], v[228:229], v[140:143]
    v_exp_f32 v144, v160
    v_mfma_f32_16x16x32_bf16 v[156:159], v[116:119], v[180:183], v[172:175]
    v_rcp_f32 v136, v136
    v_cvt_pk_bf16_f32 v133, v134, v135
    s_add_u32 m0, s52, 4160
    s_waitcnt lgkmcnt(0)
    buffer_load_dwordx4 v[230:231], s[20:23], 0 idxen offen nt lds
    v_exp_f32 v145, v161
    buffer_load_dwordx4 v[232:233], s[40:43], 0 idxen offen offset:1056 nt lds
    v_rcp_f32 v137, v137
    v_exp_f32 v146, v162
    v_rcp_f32 v138, v138
    v_cvt_pk_bf16_f32 v134, v136, v137
    v_exp_f32 v147, v163
    v_mfma_f32_16x16x32_bf16 v[160:163], v[124:127], v[180:183], v[176:179]
    v_rcp_f32 v139, v139
    v_mfma_f32_4x4x4_16b_bf16 v[144:147], v[228:229], v[228:229], v[144:147]
    v_mfma_f32_16x16x32_bf16 v[156:159], v[120:123], v[184:187], v[156:159]
    v_rcp_f32 v140, v140
    v_mfma_f32_16x16x32_bf16 v[160:163], v[128:131], v[184:187], v[160:163]
    v_rcp_f32 v141, v141
    v_cvt_pk_bf16_f32 v135, v138, v139
    s_waitcnt vmcnt(4)
    ds_read_b128 v[180:183], v234 offset:0
    ds_read_b128 v[184:187], v235 offset:0
    v_rcp_f32 v142, v142
    v_cvt_pk_bf16_f32 v136, v140, v141
    v_mfma_f32_16x16x32_bf16 v[208:211], v[132:135], v[196:199], v[204:207]
    v_rcp_f32 v143, v143
    v_rcp_f32 v144, v144
    v_cvt_pk_bf16_f32 v137, v142, v143
    v_rcp_f32 v145, v145
    v_rcp_f32 v146, v146
    v_rcp_f32 v147, v147
    v_cvt_pk_bf16_f32 v138, v144, v145
    v_cvt_pk_bf16_f32 v139, v146, v147
    ds_read_u8 v230, v237 offset:112
    ds_read_u8 v232, v237 offset:120
    v_mfma_f32_16x16x32_bf16 v[208:211], v[136:139], v[200:203], v[208:211]
    s_bitcmp1_b32 s36, 3
    s_cbranch_scc1 Ls_ev3
Ls_evd3:
    ds_read_b32 v246, v244 offset:48
    s_waitcnt lgkmcnt(0)
    v_bfe_u32 v247, v246, 0, 8
    v_lshlrev_b32 v247, 1, v247
    v_bfe_u32 v248, v246, 8, 8
    v_lshlrev_b32 v248, 1, v248
    v_bfe_u32 v249, v246, 16, 8
    v_lshlrev_b32 v249, 1, v249
    v_bfe_u32 v250, v246, 24, 8
    v_lshlrev_b32 v250, 1, v250
    buffer_load_ushort v247, v247, s[24:27], 0 offen
    buffer_load_ushort v248, v248, s[24:27], 0 offen
    buffer_load_ushort v249, v249, s[24:27], 0 offen
    buffer_load_ushort v250, v250, s[24:27], 0 offen
    s_waitcnt vmcnt(0)
    v_lshlrev_b32 v247, 16, v247
    v_mul_f32 v208, v208, v247
    v_lshlrev_b32 v248, 16, v248
    v_mul_f32 v209, v209, v248
    v_lshlrev_b32 v249, 16, v249
    v_mul_f32 v210, v210, v249
    v_lshlrev_b32 v250, 16, v250
    v_mul_f32 v211, v211, v250
    v_exp_f32 v132, v148
    v_exp_f32 v133, v149
    v_exp_f32 v134, v150
    v_exp_f32 v135, v151
    v_exp_f32 v136, v152
    v_exp_f32 v137, v153
    v_mfma_f32_4x4x4_16b_bf16 v[132:135], v[228:229], v[228:229], v[132:135]
    v_cvt_pk_bf16_f32 v208, v208, v209
    v_cvt_pk_bf16_f32 v209, v210, v211
    s_waitcnt lgkmcnt(2)
    v_mfma_f32_16x16x32_bf16 v[148:151], v[100:103], v[180:183], v[164:167]
    v_exp_f32 v138, v154
    v_mfma_f32_4x4x4_16b_bf16 v[212:215], v[208:209], v[188:189], v[212:215] cbsz:4 abid:0
    ds_read_b64_tr_b16 v[188:189], v236 offset:6240
    v_exp_f32 v139, v155
    v_mfma_f32_16x16x32_bf16 v[152:155], v[108:111], v[180:183], v[168:171]
    v_exp_f32 v140, v156
    v_mfma_f32_4x4x4_16b_bf16 v[212:215], v[208:209], v[190:191], v[212:215] cbsz:4 abid:4
    ds_read_b64_tr_b16 v[190:191], v236 offset:6752
    v_mfma_f32_4x4x4_16b_bf16 v[136:139], v[228:229], v[228:229], v[136:139]
    v_rcp_f32 v132, v132
    v_mfma_f32_4x4x4_16b_bf16 v[212:215], v[208:209], v[192:193], v[212:215] cbsz:4 abid:8
    ds_read_b64_tr_b16 v[192:193], v236 offset:7296
    v_exp_f32 v141, v157
    v_mfma_f32_16x16x32_bf16 v[148:151], v[104:107], v[184:187], v[148:151]
    v_rcp_f32 v133, v133
    v_mfma_f32_4x4x4_16b_bf16 v[212:215], v[208:209], v[194:195], v[212:215] cbsz:4 abid:12
    ds_read_b64_tr_b16 v[194:195], v236 offset:7808
    v_exp_f32 v142, v158
    v_mfma_f32_16x16x32_bf16 v[152:155], v[112:115], v[184:187], v[152:155]
    v_rcp_f32 v134, v134
    v_exp_f32 v143, v159
    v_rcp_f32 v135, v135
    v_cvt_pk_bf16_f32 v132, v132, v133
    v_mfma_f32_4x4x4_16b_bf16 v[140:143], v[228:229], v[228:229], v[140:143]
    v_exp_f32 v144, v160
    v_mfma_f32_16x16x32_bf16 v[156:159], v[116:119], v[180:183], v[172:175]
    v_rcp_f32 v136, v136
    v_cvt_pk_bf16_f32 v133, v134, v135
    s_add_u32 m0, s52, 6240
    s_waitcnt lgkmcnt(0)
    buffer_load_dwordx4 v[230:231], s[20:23], 0 idxen offen nt lds
    v_exp_f32 v145, v161
    buffer_load_dwordx4 v[232:233], s[40:43], 0 idxen offen offset:1056 nt lds
    v_rcp_f32 v137, v137
    v_exp_f32 v146, v162
    v_rcp_f32 v138, v138
    v_cvt_pk_bf16_f32 v134, v136, v137
    v_exp_f32 v147, v163
    v_mfma_f32_16x16x32_bf16 v[160:163], v[124:127], v[180:183], v[176:179]
    v_rcp_f32 v139, v139
    v_mfma_f32_4x4x4_16b_bf16 v[144:147], v[228:229], v[228:229], v[144:147]
    v_mfma_f32_16x16x32_bf16 v[156:159], v[120:123], v[184:187], v[156:159]
    v_rcp_f32 v140, v140
    v_mfma_f32_16x16x32_bf16 v[160:163], v[128:131], v[184:187], v[160:163]
    v_rcp_f32 v141, v141
    v_cvt_pk_bf16_f32 v135, v138, v139
    s_waitcnt vmcnt(4)
    ds_read_b128 v[180:183], v234 offset:2080
    ds_read_b128 v[184:187], v235 offset:2080
    v_rcp_f32 v142, v142
    v_cvt_pk_bf16_f32 v136, v140, v141
    v_mfma_f32_16x16x32_bf16 v[208:211], v[132:135], v[196:199], v[204:207]
    v_rcp_f32 v143, v143
    s_lshr_b64 s[56:57], s[56:57], 4
    s_lshl_b64 s[86:87], s[58:59], 60
    s_or_b64 s[56:57], s[56:57], s[86:87]
    s_lshr_b64 s[58:59], s[58:59], 4
    s_lshr_b64 s[86:87], s[56:57], 2
    s_lshr_b64 s[36:37], s[56:57], 5
    s_or_b32 s36, s36, s86
    s_or_b32 s36, s36, s56
    v_add_u32 v237, 64, v237
    v_add_u32 v244, 64, v244
    v_rcp_f32 v144, v144
    v_cvt_pk_bf16_f32 v137, v142, v143
    v_rcp_f32 v145, v145
    v_rcp_f32 v146, v146
    v_rcp_f32 v147, v147
    v_cvt_pk_bf16_f32 v138, v144, v145
    v_cvt_pk_bf16_f32 v139, v146, v147
    s_branch Ls_loop
Ls_ev0:
    s_bitcmp0_b64 s[56:57], 0
    s_cbranch_scc1 Ls_nf0
    v_cvt_pk_bf16_f32 v246, v212, v212
    v_mov_b32 v212, 0
    ds_write_b16 v240, v246
    v_add_u32 v240, 128, v240
    s_add_u32 s24, s24, s32
    s_addc_u32 s25, s25, 0
    s_xor_b32 s32, s32, 0x18ffe0
Ls_nf0:
    s_bitcmp0_b64 s[56:57], 5
    s_cbranch_scc1 Ls_na0
    s_sub_u32 s60, s60, 1
    s_cselect_b32 s31, 0, s31
    s_add_u32 s20, s20, s31
    s_addc_u32 s21, s21, 0
    s_add_u32 s40, s40, s31
    s_addc_u32 s41, s41, 0
    s_xor_b32 s31, s31, 0x63ff800
Ls_na0:
    s_bitcmp0_b64 s[56:57], 2
    s_cbranch_scc1 Ls_evd0
    s_sub_u32 s61, s61, 1
    s_cbranch_scc1 Ls_last0
    v_mul_u32_u24 v216, v224, v241
    v_mul_u32_u24 v217, v224, v242
    v_mul_u32_u24 v218, v225, v241
    v_mul_u32_u24 v219, v225, v242
    v_mul_u32_u24 v220, v226, v241
    v_mul_u32_u24 v221, v226, v242
    v_mul_u32_u24 v222, v227, v241
    v_mul_u32_u24 v223, v227, v242
    v_add_u32 v238, 128, v238
    ds_read_b128 v[164:167], v239
    v_mfma_f32_4x4x4_16b_bf16 v[132:135], v[216:217], v[68:69], v[4:7]
    ds_read_b128 v[168:171], v239 offset:64
    ds_read_b128 v[172:175], v239 offset:128
    v_mfma_f32_4x4x4_16b_bf16 v[136:139], v[218:219], v[70:71], v[8:11]
    ds_read_b128 v[176:179], v239 offset:192
    ds_read_u16 v224, v238
    v_mfma_f32_4x4x4_16b_bf16 v[140:143], v[220:221], v[72:73], v[12:15]
    ds_read_u16 v225, v238 offset:8
    ds_read_u16 v226, v238 offset:64
    v_mfma_f32_4x4x4_16b_bf16 v[144:147], v[222:223], v[74:75], v[16:19]
    ds_read_u16 v227, v238 offset:72
    v_add_u32 v239, 272, v239
    v_mfma_f32_4x4x4_16b_bf16 v[246:249], v[216:217], v[76:77], v[20:23]
    v_cvt_pk_bf16_f32 v100, v132, v133
    v_cvt_pk_bf16_f32 v101, v134, v135
    v_mfma_f32_4x4x4_16b_bf16 v[250:253], v[218:219], v[78:79], v[24:27]
    v_cvt_pk_bf16_f32 v102, v136, v137
    v_cvt_pk_bf16_f32 v103, v138, v139
    v_mfma_f32_4x4x4_16b_bf16 v[132:135], v[220:221], v[80:81], v[28:31]
    v_cvt_pk_bf16_f32 v104, v140, v141
    v_cvt_pk_bf16_f32 v105, v142, v143
    v_mfma_f32_4x4x4_16b_bf16 v[136:139], v[222:223], v[82:83], v[32:35]
    v_cvt_pk_bf16_f32 v106, v144, v145
    v_cvt_pk_bf16_f32 v107, v146, v147
    v_mfma_f32_4x4x4_16b_bf16 v[140:143], v[216:217], v[84:85], v[36:39]
    v_cvt_pk_bf16_f32 v108, v246, v247
    v_cvt_pk_bf16_f32 v109, v248, v249
    v_mfma_f32_4x4x4_16b_bf16 v[144:147], v[218:219], v[86:87], v[40:43]
    v_cvt_pk_bf16_f32 v110, v250, v251
    v_cvt_pk_bf16_f32 v111, v252, v253
    v_mfma_f32_4x4x4_16b_bf16 v[246:249], v[220:221], v[88:89], v[44:47]
    v_cvt_pk_bf16_f32 v112, v132, v133
    v_cvt_pk_bf16_f32 v113, v134, v135
    v_mfma_f32_4x4x4_16b_bf16 v[250:253], v[222:223], v[90:91], v[48:51]
    v_cvt_pk_bf16_f32 v114, v136, v137
    v_cvt_pk_bf16_f32 v115, v138, v139
    v_mfma_f32_4x4x4_16b_bf16 v[132:135], v[216:217], v[92:93], v[52:55]
    v_cvt_pk_bf16_f32 v116, v140, v141
    v_cvt_pk_bf16_f32 v117, v142, v143
    v_mfma_f32_4x4x4_16b_bf16 v[136:139], v[218:219], v[94:95], v[56:59]
    v_cvt_pk_bf16_f32 v118, v144, v145
    v_cvt_pk_bf16_f32 v119, v146, v147
    v_mfma_f32_4x4x4_16b_bf16 v[140:143], v[220:221], v[96:97], v[60:63]
    v_cvt_pk_bf16_f32 v120, v246, v247
    v_cvt_pk_bf16_f32 v121, v248, v249
    v_mfma_f32_4x4x4_16b_bf16 v[144:147], v[222:223], v[98:99], v[64:67]
    v_cvt_pk_bf16_f32 v122, v250, v251
    v_cvt_pk_bf16_f32 v123, v252, v253
    v_cvt_pk_bf16_f32 v124, v132, v133
    v_cvt_pk_bf16_f32 v125, v134, v135
    v_cvt_pk_bf16_f32 v126, v136, v137
    v_cvt_pk_bf16_f32 v127, v138, v139
    v_cvt_pk_bf16_f32 v128, v140, v141
    v_cvt_pk_bf16_f32 v129, v142, v143
    v_cvt_pk_bf16_f32 v130, v144, v145
    v_cvt_pk_bf16_f32 v131, v146, v147
    s_waitcnt lgkmcnt(0)
    s_branch Ls_evd0
Ls_ev1:
    s_bitcmp0_b64 s[56:57], 1
    s_cbranch_scc1 Ls_nf1
    v_cvt_pk_bf16_f32 v246, v212, v212
    v_mov_b32 v212, 0
    ds_write_b16 v240, v246
    v_add_u32 v240, 128, v240
    s_add_u32 s24, s24, s32
    s_addc_u32 s25, s25, 0
    s_xor_b32 s32, s32, 0x18ffe0
Ls_nf1:
    s_bitcmp0_b64 s[56:57], 6
    s_cbranch_scc1 Ls_na1
    s_sub_u32 s60, s60, 1
    s_cselect_b32 s31, 0, s31
    s_add_u32 s20, s20, s31
    s_addc_u32 s21, s21, 0
    s_add_u32 s40, s40, s31
    s_addc_u32 s41, s41, 0
    s_xor_b32 s31, s31, 0x63ff800
Ls_na1:
    s_bitcmp0_b64 s[56:57], 3
    s_cbranch_scc1 Ls_evd1
    s_sub_u32 s61, s61, 1
    s_cbranch_scc1 Ls_last1
    v_mul_u32_u24 v216, v224, v241
    v_mul_u32_u24 v217, v224, v242
    v_mul_u32_u24 v218, v225, v241
    v_mul_u32_u24 v219, v225, v242
    v_mul_u32_u24 v220, v226, v241
    v_mul_u32_u24 v221, v226, v242
    v_mul_u32_u24 v222, v227, v241
    v_mul_u32_u24 v223, v227, v242
    v_add_u32 v238, 128, v238
    ds_read_b128 v[164:167], v239
    v_mfma_f32_4x4x4_16b_bf16 v[132:135], v[216:217], v[68:69], v[4:7]
    ds_read_b128 v[168:171], v239 offset:64
    ds_read_b128 v[172:175], v239 offset:128
    v_mfma_f32_4x4x4_16b_bf16 v[136:139], v[218:219], v[70:71], v[8:11]
    ds_read_b128 v[176:179], v239 offset:192
    ds_read_u16 v224, v238
    v_mfma_f32_4x4x4_16b_bf16 v[140:143], v[220:221], v[72:73], v[12:15]
    ds_read_u16 v225, v238 offset:8
    ds_read_u16 v226, v238 offset:64
    v_mfma_f32_4x4x4_16b_bf16 v[144:147], v[222:223], v[74:75], v[16:19]
    ds_read_u16 v227, v238 offset:72
    v_add_u32 v239, 272, v239
    v_mfma_f32_4x4x4_16b_bf16 v[246:249], v[216:217], v[76:77], v[20:23]
    v_cvt_pk_bf16_f32 v100, v132, v133
    v_cvt_pk_bf16_f32 v101, v134, v135
    v_mfma_f32_4x4x4_16b_bf16 v[250:253], v[218:219], v[78:79], v[24:27]
    v_cvt_pk_bf16_f32 v102, v136, v137
    v_cvt_pk_bf16_f32 v103, v138, v139
    v_mfma_f32_4x4x4_16b_bf16 v[132:135], v[220:221], v[80:81], v[28:31]
    v_cvt_pk_bf16_f32 v104, v140, v141
    v_cvt_pk_bf16_f32 v105, v142, v143
    v_mfma_f32_4x4x4_16b_bf16 v[136:139], v[222:223], v[82:83], v[32:35]
    v_cvt_pk_bf16_f32 v106, v144, v145
    v_cvt_pk_bf16_f32 v107, v146, v147
    v_mfma_f32_4x4x4_16b_bf16 v[140:143], v[216:217], v[84:85], v[36:39]
    v_cvt_pk_bf16_f32 v108, v246, v247
    v_cvt_pk_bf16_f32 v109, v248, v249
    v_mfma_f32_4x4x4_16b_bf16 v[144:147], v[218:219], v[86:87], v[40:43]
    v_cvt_pk_bf16_f32 v110, v250, v251
    v_cvt_pk_bf16_f32 v111, v252, v253
    v_mfma_f32_4x4x4_16b_bf16 v[246:249], v[220:221], v[88:89], v[44:47]
    v_cvt_pk_bf16_f32 v112, v132, v133
    v_cvt_pk_bf16_f32 v113, v134, v135
    v_mfma_f32_4x4x4_16b_bf16 v[250:253], v[222:223], v[90:91], v[48:51]
    v_cvt_pk_bf16_f32 v114, v136, v137
    v_cvt_pk_bf16_f32 v115, v138, v139
    v_mfma_f32_4x4x4_16b_bf16 v[132:135], v[216:217], v[92:93], v[52:55]
    v_cvt_pk_bf16_f32 v116, v140, v141
    v_cvt_pk_bf16_f32 v117, v142, v143
    v_mfma_f32_4x4x4_16b_bf16 v[136:139], v[218:219], v[94:95], v[56:59]
    v_cvt_pk_bf16_f32 v118, v144, v145
    v_cvt_pk_bf16_f32 v119, v146, v147
    v_mfma_f32_4x4x4_16b_bf16 v[140:143], v[220:221], v[96:97], v[60:63]
    v_cvt_pk_bf16_f32 v120, v246, v247
    v_cvt_pk_bf16_f32 v121, v248, v249
    v_mfma_f32_4x4x4_16b_bf16 v[144:147], v[222:223], v[98:99], v[64:67]
    v_cvt_pk_bf16_f32 v122, v250, v251
    v_cvt_pk_bf16_f32 v123, v252, v253
    v_cvt_pk_bf16_f32 v124, v132, v133
    v_cvt_pk_bf16_f32 v125, v134, v135
    v_cvt_pk_bf16_f32 v126, v136, v137
    v_cvt_pk_bf16_f32 v127, v138, v139
    v_cvt_pk_bf16_f32 v128, v140, v141
    v_cvt_pk_bf16_f32 v129, v142, v143
    v_cvt_pk_bf16_f32 v130, v144, v145
    v_cvt_pk_bf16_f32 v131, v146, v147
    s_waitcnt lgkmcnt(0)
    s_branch Ls_evd1
Ls_ev2:
    s_bitcmp0_b64 s[56:57], 2
    s_cbranch_scc1 Ls_nf2
    v_cvt_pk_bf16_f32 v246, v212, v212
    v_mov_b32 v212, 0
    ds_write_b16 v240, v246
    v_add_u32 v240, 128, v240
    s_add_u32 s24, s24, s32
    s_addc_u32 s25, s25, 0
    s_xor_b32 s32, s32, 0x18ffe0
Ls_nf2:
    s_bitcmp0_b64 s[56:57], 7
    s_cbranch_scc1 Ls_na2
    s_sub_u32 s60, s60, 1
    s_cselect_b32 s31, 0, s31
    s_add_u32 s20, s20, s31
    s_addc_u32 s21, s21, 0
    s_add_u32 s40, s40, s31
    s_addc_u32 s41, s41, 0
    s_xor_b32 s31, s31, 0x63ff800
Ls_na2:
    s_bitcmp0_b64 s[56:57], 4
    s_cbranch_scc1 Ls_evd2
    s_sub_u32 s61, s61, 1
    s_cbranch_scc1 Ls_last2
    v_mul_u32_u24 v216, v224, v241
    v_mul_u32_u24 v217, v224, v242
    v_mul_u32_u24 v218, v225, v241
    v_mul_u32_u24 v219, v225, v242
    v_mul_u32_u24 v220, v226, v241
    v_mul_u32_u24 v221, v226, v242
    v_mul_u32_u24 v222, v227, v241
    v_mul_u32_u24 v223, v227, v242
    v_add_u32 v238, 128, v238
    ds_read_b128 v[164:167], v239
    v_mfma_f32_4x4x4_16b_bf16 v[132:135], v[216:217], v[68:69], v[4:7]
    ds_read_b128 v[168:171], v239 offset:64
    ds_read_b128 v[172:175], v239 offset:128
    v_mfma_f32_4x4x4_16b_bf16 v[136:139], v[218:219], v[70:71], v[8:11]
    ds_read_b128 v[176:179], v239 offset:192
    ds_read_u16 v224, v238
    v_mfma_f32_4x4x4_16b_bf16 v[140:143], v[220:221], v[72:73], v[12:15]
    ds_read_u16 v225, v238 offset:8
    ds_read_u16 v226, v238 offset:64
    v_mfma_f32_4x4x4_16b_bf16 v[144:147], v[222:223], v[74:75], v[16:19]
    ds_read_u16 v227, v238 offset:72
    v_add_u32 v239, 272, v239
    v_mfma_f32_4x4x4_16b_bf16 v[246:249], v[216:217], v[76:77], v[20:23]
    v_cvt_pk_bf16_f32 v100, v132, v133
    v_cvt_pk_bf16_f32 v101, v134, v135
    v_mfma_f32_4x4x4_16b_bf16 v[250:253], v[218:219], v[78:79], v[24:27]
    v_cvt_pk_bf16_f32 v102, v136, v137
    v_cvt_pk_bf16_f32 v103, v138, v139
    v_mfma_f32_4x4x4_16b_bf16 v[132:135], v[220:221], v[80:81], v[28:31]
    v_cvt_pk_bf16_f32 v104, v140, v141
    v_cvt_pk_bf16_f32 v105, v142, v143
    v_mfma_f32_4x4x4_16b_bf16 v[136:139], v[222:223], v[82:83], v[32:35]
    v_cvt_pk_bf16_f32 v106, v144, v145
    v_cvt_pk_bf16_f32 v107, v146, v147
    v_mfma_f32_4x4x4_16b_bf16 v[140:143], v[216:217], v[84:85], v[36:39]
    v_cvt_pk_bf16_f32 v108, v246, v247
    v_cvt_pk_bf16_f32 v109, v248, v249
    v_mfma_f32_4x4x4_16b_bf16 v[144:147], v[218:219], v[86:87], v[40:43]
    v_cvt_pk_bf16_f32 v110, v250, v251
    v_cvt_pk_bf16_f32 v111, v252, v253
    v_mfma_f32_4x4x4_16b_bf16 v[246:249], v[220:221], v[88:89], v[44:47]
    v_cvt_pk_bf16_f32 v112, v132, v133
    v_cvt_pk_bf16_f32 v113, v134, v135
    v_mfma_f32_4x4x4_16b_bf16 v[250:253], v[222:223], v[90:91], v[48:51]
    v_cvt_pk_bf16_f32 v114, v136, v137
    v_cvt_pk_bf16_f32 v115, v138, v139
    v_mfma_f32_4x4x4_16b_bf16 v[132:135], v[216:217], v[92:93], v[52:55]
    v_cvt_pk_bf16_f32 v116, v140, v141
    v_cvt_pk_bf16_f32 v117, v142, v143
    v_mfma_f32_4x4x4_16b_bf16 v[136:139], v[218:219], v[94:95], v[56:59]
    v_cvt_pk_bf16_f32 v118, v144, v145
    v_cvt_pk_bf16_f32 v119, v146, v147
    v_mfma_f32_4x4x4_16b_bf16 v[140:143], v[220:221], v[96:97], v[60:63]
    v_cvt_pk_bf16_f32 v120, v246, v247
    v_cvt_pk_bf16_f32 v121, v248, v249
    v_mfma_f32_4x4x4_16b_bf16 v[144:147], v[222:223], v[98:99], v[64:67]
    v_cvt_pk_bf16_f32 v122, v250, v251
    v_cvt_pk_bf16_f32 v123, v252, v253
    v_cvt_pk_bf16_f32 v124, v132, v133
    v_cvt_pk_bf16_f32 v125, v134, v135
    v_cvt_pk_bf16_f32 v126, v136, v137
    v_cvt_pk_bf16_f32 v127, v138, v139
    v_cvt_pk_bf16_f32 v128, v140, v141
    v_cvt_pk_bf16_f32 v129, v142, v143
    v_cvt_pk_bf16_f32 v130, v144, v145
    v_cvt_pk_bf16_f32 v131, v146, v147
    s_waitcnt lgkmcnt(0)
    s_branch Ls_evd2
Ls_ev3:
    s_bitcmp0_b64 s[56:57], 3
    s_cbranch_scc1 Ls_nf3
    v_cvt_pk_bf16_f32 v246, v212, v212
    v_mov_b32 v212, 0
    ds_write_b16 v240, v246
    v_add_u32 v240, 128, v240
    s_add_u32 s24, s24, s32
    s_addc_u32 s25, s25, 0
    s_xor_b32 s32, s32, 0x18ffe0
Ls_nf3:
    s_bitcmp0_b64 s[56:57], 8
    s_cbranch_scc1 Ls_na3
    s_sub_u32 s60, s60, 1
    s_cselect_b32 s31, 0, s31
    s_add_u32 s20, s20, s31
    s_addc_u32 s21, s21, 0
    s_add_u32 s40, s40, s31
    s_addc_u32 s41, s41, 0
    s_xor_b32 s31, s31, 0x63ff800
Ls_na3:
    s_bitcmp0_b64 s[56:57], 5
    s_cbranch_scc1 Ls_evd3
    s_sub_u32 s61, s61, 1
    s_cbranch_scc1 Ls_last3
    v_mul_u32_u24 v216, v224, v241
    v_mul_u32_u24 v217, v224, v242
    v_mul_u32_u24 v218, v225, v241
    v_mul_u32_u24 v219, v225, v242
    v_mul_u32_u24 v220, v226, v241
    v_mul_u32_u24 v221, v226, v242
    v_mul_u32_u24 v222, v227, v241
    v_mul_u32_u24 v223, v227, v242
    v_add_u32 v238, 128, v238
    ds_read_b128 v[164:167], v239
    v_mfma_f32_4x4x4_16b_bf16 v[132:135], v[216:217], v[68:69], v[4:7]
    ds_read_b128 v[168:171], v239 offset:64
    ds_read_b128 v[172:175], v239 offset:128
    v_mfma_f32_4x4x4_16b_bf16 v[136:139], v[218:219], v[70:71], v[8:11]
    ds_read_b128 v[176:179], v239 offset:192
    ds_read_u16 v224, v238
    v_mfma_f32_4x4x4_16b_bf16 v[140:143], v[220:221], v[72:73], v[12:15]
    ds_read_u16 v225, v238 offset:8
    ds_read_u16 v226, v238 offset:64
    v_mfma_f32_4x4x4_16b_bf16 v[144:147], v[222:223], v[74:75], v[16:19]
    ds_read_u16 v227, v238 offset:72
    v_add_u32 v239, 272, v239
    v_mfma_f32_4x4x4_16b_bf16 v[246:249], v[216:217], v[76:77], v[20:23]
    v_cvt_pk_bf16_f32 v100, v132, v133
    v_cvt_pk_bf16_f32 v101, v134, v135
    v_mfma_f32_4x4x4_16b_bf16 v[250:253], v[218:219], v[78:79], v[24:27]
    v_cvt_pk_bf16_f32 v102, v136, v137
    v_cvt_pk_bf16_f32 v103, v138, v139
    v_mfma_f32_4x4x4_16b_bf16 v[132:135], v[220:221], v[80:81], v[28:31]
    v_cvt_pk_bf16_f32 v104, v140, v141
    v_cvt_pk_bf16_f32 v105, v142, v143
    v_mfma_f32_4x4x4_16b_bf16 v[136:139], v[222:223], v[82:83], v[32:35]
    v_cvt_pk_bf16_f32 v106, v144, v145
    v_cvt_pk_bf16_f32 v107, v146, v147
    v_mfma_f32_4x4x4_16b_bf16 v[140:143], v[216:217], v[84:85], v[36:39]
    v_cvt_pk_bf16_f32 v108, v246, v247
    v_cvt_pk_bf16_f32 v109, v248, v249
    v_mfma_f32_4x4x4_16b_bf16 v[144:147], v[218:219], v[86:87], v[40:43]
    v_cvt_pk_bf16_f32 v110, v250, v251
    v_cvt_pk_bf16_f32 v111, v252, v253
    v_mfma_f32_4x4x4_16b_bf16 v[246:249], v[220:221], v[88:89], v[44:47]
    v_cvt_pk_bf16_f32 v112, v132, v133
    v_cvt_pk_bf16_f32 v113, v134, v135
    v_mfma_f32_4x4x4_16b_bf16 v[250:253], v[222:223], v[90:91], v[48:51]
    v_cvt_pk_bf16_f32 v114, v136, v137
    v_cvt_pk_bf16_f32 v115, v138, v139
    v_mfma_f32_4x4x4_16b_bf16 v[132:135], v[216:217], v[92:93], v[52:55]
    v_cvt_pk_bf16_f32 v116, v140, v141
    v_cvt_pk_bf16_f32 v117, v142, v143
    v_mfma_f32_4x4x4_16b_bf16 v[136:139], v[218:219], v[94:95], v[56:59]
    v_cvt_pk_bf16_f32 v118, v144, v145
    v_cvt_pk_bf16_f32 v119, v146, v147
    v_mfma_f32_4x4x4_16b_bf16 v[140:143], v[220:221], v[96:97], v[60:63]
    v_cvt_pk_bf16_f32 v120, v246, v247
    v_cvt_pk_bf16_f32 v121, v248, v249
    v_mfma_f32_4x4x4_16b_bf16 v[144:147], v[222:223], v[98:99], v[64:67]
    v_cvt_pk_bf16_f32 v122, v250, v251
    v_cvt_pk_bf16_f32 v123, v252, v253
    v_cvt_pk_bf16_f32 v124, v132, v133
    v_cvt_pk_bf16_f32 v125, v134, v135
    v_cvt_pk_bf16_f32 v126, v136, v137
    v_cvt_pk_bf16_f32 v127, v138, v139
    v_cvt_pk_bf16_f32 v128, v140, v141
    v_cvt_pk_bf16_f32 v129, v142, v143
    v_cvt_pk_bf16_f32 v130, v144, v145
    v_cvt_pk_bf16_f32 v131, v146, v147
    s_waitcnt lgkmcnt(0)
    s_branch Ls_evd3
Ls_last0:
    s_branch Ls_tail
Ls_last1:
    v_add_u32 v236, 2080, v236
    s_lshr_b64 s[56:57], s[56:57], 1
    v_add_u32 v244, 16, v244
    s_branch Ls_tail
Ls_last2:
    v_add_u32 v236, 4160, v236
    s_lshr_b64 s[56:57], s[56:57], 2
    v_add_u32 v244, 32, v244
    s_branch Ls_tail
Ls_last3:
    v_add_u32 v236, 6240, v236
    s_lshr_b64 s[56:57], s[56:57], 3
    v_add_u32 v244, 48, v244
Ls_tail:
    ds_read_b32 v246, v244 offset:0
    s_waitcnt lgkmcnt(0)
    v_bfe_u32 v247, v246, 0, 8
    v_lshlrev_b32 v247, 1, v247
    v_bfe_u32 v248, v246, 8, 8
    v_lshlrev_b32 v248, 1, v248
    v_bfe_u32 v249, v246, 16, 8
    v_lshlrev_b32 v249, 1, v249
    v_bfe_u32 v250, v246, 24, 8
    v_lshlrev_b32 v250, 1, v250
    buffer_load_ushort v247, v247, s[24:27], 0 offen
    buffer_load_ushort v248, v248, s[24:27], 0 offen
    buffer_load_ushort v249, v249, s[24:27], 0 offen
    buffer_load_ushort v250, v250, s[24:27], 0 offen
    s_waitcnt vmcnt(0)
    v_lshlrev_b32 v247, 16, v247
    v_mul_f32 v208, v208, v247
    v_lshlrev_b32 v248, 16, v248
    v_mul_f32 v209, v209, v248
    v_lshlrev_b32 v249, 16, v249
    v_mul_f32 v210, v210, v249
    v_lshlrev_b32 v250, 16, v250
    v_mul_f32 v211, v211, v250
    v_exp_f32 v132, v148
    v_exp_f32 v133, v149
    v_exp_f32 v134, v150
    v_exp_f32 v135, v151
    v_exp_f32 v136, v152
    v_exp_f32 v137, v153
    v_mfma_f32_4x4x4_16b_bf16 v[132:135], v[228:229], v[228:229], v[132:135]
    v_cvt_pk_bf16_f32 v208, v208, v209
    v_cvt_pk_bf16_f32 v209, v210, v211
    v_exp_f32 v138, v154
    s_nop 0
    v_mfma_f32_4x4x4_16b_bf16 v[212:215], v[208:209], v[188:189], v[212:215] cbsz:4 abid:0
    ds_read_b64_tr_b16 v[188:189], v236 offset:0
    v_exp_f32 v139, v155
    v_exp_f32 v140, v156
    v_mfma_f32_4x4x4_16b_bf16 v[212:215], v[208:209], v[190:191], v[212:215] cbsz:4 abid:4
    ds_read_b64_tr_b16 v[190:191], v236 offset:512
    v_mfma_f32_4x4x4_16b_bf16 v[136:139], v[228:229], v[228:229], v[136:139]
    v_rcp_f32 v132, v132
    v_mfma_f32_4x4x4_16b_bf16 v[212:215], v[208:209], v[192:193], v[212:215] cbsz:4 abid:8
    ds_read_b64_tr_b16 v[192:193], v236 offset:1056
    v_exp_f32 v141, v157
    v_rcp_f32 v133, v133
    v_mfma_f32_4x4x4_16b_bf16 v[212:215], v[208:209], v[194:195], v[212:215] cbsz:4 abid:12
    ds_read_b64_tr_b16 v[194:195], v236 offset:1568
    v_exp_f32 v142, v158
    v_rcp_f32 v134, v134
    v_exp_f32 v143, v159
    v_rcp_f32 v135, v135
    v_cvt_pk_bf16_f32 v132, v132, v133
    v_mfma_f32_4x4x4_16b_bf16 v[140:143], v[228:229], v[228:229], v[140:143]
    v_exp_f32 v144, v160
    v_rcp_f32 v136, v136
    v_cvt_pk_bf16_f32 v133, v134, v135
    s_bitcmp0_b64 s[56:57], 1
    s_cbranch_scc1 Ls_tnf
    v_cvt_pk_bf16_f32 v246, v212, v212
    v_mov_b32 v212, 0
    ds_write_b16 v240, v246
    v_add_u32 v240, 128, v240
    s_add_u32 s24, s24, s32
    s_addc_u32 s25, s25, 0
    s_xor_b32 s32, s32, 0x18ffe0
Ls_tnf:
    s_waitcnt lgkmcnt(0)
    v_exp_f32 v145, v161
    v_rcp_f32 v137, v137
    v_exp_f32 v146, v162
    v_rcp_f32 v138, v138
    v_cvt_pk_bf16_f32 v134, v136, v137
    v_exp_f32 v147, v163
    v_rcp_f32 v139, v139
    s_nop 0
    v_mfma_f32_4x4x4_16b_bf16 v[144:147], v[228:229], v[228:229], v[144:147]
    v_rcp_f32 v140, v140
    v_rcp_f32 v141, v141
    v_cvt_pk_bf16_f32 v135, v138, v139
    v_rcp_f32 v142, v142
    v_cvt_pk_bf16_f32 v136, v140, v141
    v_mfma_f32_16x16x32_bf16 v[208:211], v[132:135], v[196:199], v[204:207]
    v_rcp_f32 v143, v143
    v_rcp_f32 v144, v144
    v_cvt_pk_bf16_f32 v137, v142, v143
    v_rcp_f32 v145, v145
    v_rcp_f32 v146, v146
    v_rcp_f32 v147, v147
    v_cvt_pk_bf16_f32 v138, v144, v145
    v_cvt_pk_bf16_f32 v139, v146, v147
    s_nop 1
    v_mfma_f32_16x16x32_bf16 v[208:211], v[136:139], v[200:203], v[208:211]
    ds_read_b32 v246, v244 offset:16
    s_waitcnt lgkmcnt(0)
    v_bfe_u32 v247, v246, 0, 8
    v_lshlrev_b32 v247, 1, v247
    v_bfe_u32 v248, v246, 8, 8
    v_lshlrev_b32 v248, 1, v248
    v_bfe_u32 v249, v246, 16, 8
    v_lshlrev_b32 v249, 1, v249
    v_bfe_u32 v250, v246, 24, 8
    v_lshlrev_b32 v250, 1, v250
    buffer_load_ushort v247, v247, s[24:27], 0 offen
    buffer_load_ushort v248, v248, s[24:27], 0 offen
    buffer_load_ushort v249, v249, s[24:27], 0 offen
    buffer_load_ushort v250, v250, s[24:27], 0 offen
    s_waitcnt vmcnt(0)
    v_lshlrev_b32 v247, 16, v247
    v_mul_f32 v208, v208, v247
    v_lshlrev_b32 v248, 16, v248
    v_mul_f32 v209, v209, v248
    v_lshlrev_b32 v249, 16, v249
    v_mul_f32 v210, v210, v249
    v_lshlrev_b32 v250, 16, v250
    v_mul_f32 v211, v211, v250
    v_cvt_pk_bf16_f32 v208, v208, v209
    v_cvt_pk_bf16_f32 v209, v210, v211
    s_nop 1
    v_mfma_f32_4x4x4_16b_bf16 v[212:215], v[208:209], v[188:189], v[212:215] cbsz:4 abid:0
    s_nop 1
    v_mfma_f32_4x4x4_16b_bf16 v[212:215], v[208:209], v[190:191], v[212:215] cbsz:4 abid:4
    s_nop 1
    v_mfma_f32_4x4x4_16b_bf16 v[212:215], v[208:209], v[192:193], v[212:215] cbsz:4 abid:8
    s_nop 1
    v_mfma_f32_4x4x4_16b_bf16 v[212:215], v[208:209], v[194:195], v[212:215] cbsz:4 abid:12
    s_nop 4
    v_cvt_pk_bf16_f32 v246, v212, v212
    ds_write_b16 v240, v246
    s_branch L_store
.section .rodata,"a"
.p2align 6
.amdhsa_kernel standalone__sequential_behavior_din__recsys_kernel
  .amdhsa_next_free_vgpr 256
  .amdhsa_next_free_sgpr 102
  .amdhsa_accum_offset 256
  .amdhsa_group_segment_fixed_size 0
  .amdhsa_kernarg_size 80
  .amdhsa_user_sgpr_count 2
  .amdhsa_user_sgpr_kernarg_segment_ptr 1
  .amdhsa_system_sgpr_workgroup_id_x 1
.end_amdhsa_kernel
```

```asm
; @launch grid=(256,1,1) block=(512,1,1) lds=163840
.amdgcn_target "amdgcn-amd-amdhsa--gfx950"
.text
.globl standalone__sequential_behavior_din__recsys_kernel
.p2align 8
.type standalone__sequential_behavior_din__recsys_kernel,@function
standalone__sequential_behavior_din__recsys_kernel:
    s_load_dwordx16 s[4:19], s[0:1], 0
    s_cmp_ge_u32 s2, 256
    s_cbranch_scc1 L_end
    v_lshrrev_b32 v1, 6, v0
    v_and_b32 v0, 63, v0
    v_readfirstlane_b32 s54, v1
    s_lshl_b32 s53, s2, 3
    v_lshlrev_b32 v2, 4, v0
    v_lshrrev_b32 v1, 4, v0
    v_and_b32 v3, 0xf0, v2
    v_lshlrev_b32 v3, 2, v3
    v_lshl_add_u32 v130, v1, 4, v3
    v_bfrev_b32 v3, 1
    s_add_u32 s53, s53, s54
    s_movk_i32 s66, 800
    v_cmp_gt_u32 vcc, s66, v130
    s_mul_i32 s93, s53, 800
    s_mul_i32 s52, s54, 20480
    s_mov_b64 s[28:29], vcc
    v_cndmask_b32 v3, v3, v130, vcc
    v_and_b32 v248, 16, v0
    v_lshlrev_b32 v246, 1, v248
    v_xor_b32 v246, v246, v2
    s_lshl_b32 s67, s54, 12
    s_add_u32 m0, s52, 4160
    s_mov_b32 s26, 6553600
    s_mov_b32 s27, 0x20000
    s_waitcnt lgkmcnt(0)
    s_mov_b32 s24, s8
    s_and_b32 s25, s9, 0xffff
    buffer_load_dwordx4 v[100:103], v3, s[24:27], s93 offen nt
    s_add_u32 s10, s10, s67
    s_addc_u32 s11, s11, 0
    v_xor_b32 v247, 64, v246
    global_load_lds_dwordx4 v246, s[10:11] offset:0
    global_load_lds_dwordx4 v247, s[10:11] offset:1024
    global_load_lds_dwordx4 v246, s[10:11] offset:2048
    global_load_lds_dwordx4 v247, s[10:11] offset:3072
    s_load_dword s30, s[16:17], 0
    v_and_b32 v243, 0xf0, v2
    v_lshl_add_u32 v243, v1, 19, v243
    s_lshl_b32 s66, s53, 8
    s_add_u32 m0, s52, 8320
    v_add_u32 v243, s66, v243
    s_and_b32 s67, s54, 3
    global_load_lds_dwordx4 v243, s[4:5] nt
    s_lshl_b32 s66, s67, 5
    v_lshl_add_u32 v249, v1, 3, s66
    global_load_dwordx2 v[96:97], v249, s[12:13]
    v_and_b32 v250, 3, v0
    s_mul_i32 s66, s53, 51200
    s_add_u32 s6, s6, s66
    s_addc_u32 s7, s7, 0
    s_mov_b32 s20, s6
    s_and_b32 s21, s7, 0xffff
    s_or_b32 s21, s21, 0x800000
    s_mov_b32 s22, 200
    s_mov_b32 s23, 0x20000
    s_sub_u32 s40, s20, 1056
    s_subb_u32 s41, s21, 0
    s_mov_b32 s42, 200
    s_mov_b32 s43, 0x20000
    s_movk_i32 s31, 25600
    s_mov_b32 s60, 7
    s_mov_b64 s[56:57], 0
    s_mov_b64 s[58:59], 0
    v_mov_b32 v148, -1
    v_mov_b32 v149, -1
    v_mov_b32 v150, -1
    v_mov_b32 v151, -1
    s_add_u32 s66, s52, 18432
    v_add_u32 v152, s66, v2
    ds_write_b128 v152, v[148:151]
    ds_write_b128 v152, v[148:151] offset:1024
    s_add_u32 s64, s52, 18448
    v_mov_b32 v153, -1
    v_mov_b32 v154, -1
    v_mov_b32 v155, -1
    v_lshrrev_b32 v237, 3, v0
    v_add_u32 v237, s64, v237
    v_lshl_add_u32 v244, v1, 2, s66
    v_and_b32 v231, 0x70, v2
    v_lshlrev_b32 v248, 2, v248
    v_xor_b32 v231, v231, v248
    v_mov_b32 v233, v231
    s_movk_i32 s66, 400
    v_cmp_le_u32 vcc, s66, v130
    v_lshrrev_b32 v126, 1, v130
    s_movk_i32 s66, -200
    v_cndmask_b32 v130, 0, 1, vcc
    v_mad_i32_i24 v126, v130, s66, v126
    v_mul_u32_u24 v127, 0x10001, v126
    v_add_u32 v126, 0x10000, v127
    v_add_u32 v128, 0x50004, v127
    v_add_u32 v129, 0x70006, v127
    v_add_u32 v127, 0x30002, v127
    v_mov_b32 v131, 0xbfe0bfe0
    s_mov_b32 s86, 0xfff0ffff
    s_mov_b32 s87, 0xf000ff00
    s_mov_b32 s88, 0xff00fff0
    s_mov_b32 s89, 0xf000
    s_mov_b32 s90, 0xf0000f
    s_mov_b32 s91, 0xf0000f00
    s_mov_b32 s84, 0x11111113
    s_mov_b32 s85, 0x11111111
    v_cndmask_b32 v116, 0, v131, s[86:87]
    v_cndmask_b32 v120, 0, v131, s[88:89]
    v_cndmask_b32 v117, 0, v131, s[86:87]
    v_cndmask_b32 v121, 0, v131, s[88:89]
    v_cndmask_b32 v122, 0, v131, s[84:85]
    v_cndmask_b32 v123, 0, v131, s[84:85]
    v_cndmask_b32 v124, 0, v131, s[84:85]
    v_cndmask_b32 v125, 0, v131, s[84:85]
    v_lshlrev_b32 v246, 4, v250
    v_sub_u32 v246, 48, v246
    s_mov_b32 s86, 0xbfe0bfe0
    s_mov_b32 s87, 0xf0bfe0
    v_lshrrev_b64 v[118:119], v246, s[86:87]
    v_mov_b32 v131, 0
    s_mov_b64 s[84:85], 0
    v_cndmask_b32 v118, v120, v118, s[90:91]
    v_cndmask_b32 v119, v121, v119, s[90:91]
    s_mov_b32 s61, 7
    s_mov_b32 s92, 0xbfb8aa3b
    v_and_b32 v251, 15, v0
    v_bfe_u32 v252, v0, 2, 2
    v_lshlrev_b32 v253, 3, v250
    v_lshl_add_u32 v253, v252, 7, v253
    v_and_b32 v246, 24, v0
    v_lshlrev_b32 v246, 2, v246
    v_xor_b32 v246, v253, v246
    v_lshl_add_u32 v246, v1, 10, v246
    s_lshl_b32 s66, s67, 5
    v_xor_b32 v66, s66, v246
    v_add_u32 v66, 45120, v66
    s_lshr_b32 s66, s54, 1
    s_lshl_b32 s66, s66, 5
    v_xor_b32 v64, s66, v246
    s_and_b32 s66, s54, 1
    s_mul_i32 s66, s66, 20480
    s_add_u32 s66, s66, 4160
    v_add_u32 v64, s66, v64
    v_add_u32 v65, 81920, v64
    s_and_b32 s66, s54, 4
    v_lshrrev_b32 v246, 3, v251
    v_add_u32 v246, s66, v246
    v_mul_u32_u24 v246, 20480, v246
    v_lshl_add_u32 v246, v1, 4, v246
    v_and_b32 v247, 7, v0
    v_lshl_add_u32 v67, v247, 7, v246
    v_and_b32 v247, 1, v0
    v_lshlrev_b32 v247, 4, v247
    v_lshlrev_b32 v247, v247, 1
    v_cmp_gt_u32 vcc, 2, v250
    v_mov_b32 v229, 0
    v_mov_b32 v228, 0x3f80
    v_cndmask_b32 v241, 0, v247, vcc
    v_cmp_eq_u32 vcc, 0, v251
    v_sub_u32 v242, v247, v241
    v_mul_u32_u24 v218, 0x3f80, v241
    v_cndmask_b32 v220, 0, -1, vcc
    v_mul_u32_u24 v219, 0x3f80, v242
    s_and_b32 s66, s54, 3
    s_lshl_b32 s66, s66, 6
    s_add_u32 s66, s66, 9344
    v_and_b32 v247, 7, v0
    v_mul_u32_u24 v247, 144, v247
    v_add3_u32 v98, v67, v247, s66
    s_and_b32 s66, s54, 3
    s_mul_i32 s66, s66, 20480
    s_add_u32 s66, s66, 14592
    v_mov_b32 v221, s66
    s_cmp_ge_u32 s54, 4
    s_cselect_b32 s33, -1, 0
    ds_write_b32 v221, v229
    v_and_b32 v247, 8, v0
    v_lshlrev_b32 v247, 2, v247
    v_lshl_add_u32 v247, v251, 7, v247
    v_add_u32 v247, s52, v247
    v_and_b32 v248, 2, v0
    v_lshlrev_b32 v248, 1, v248
    v_xor_b32 v248, v248, v1
    v_lshl_add_u32 v234, v248, 4, v247
    v_xor_b32 v248, 4, v248
    v_lshl_add_u32 v235, v248, 4, v247
    v_and_b32 v247, 8, v0
    v_lshlrev_b32 v247, 3, v247
    v_lshl_add_u32 v248, v1, 5, v253
    v_xor_b32 v248, v248, v247
    v_add_u32 v236, s52, v248
    s_add_u32 s66, s52, 8320
    v_lshl_add_u32 v238, v250, 1, s66
    v_lshl_add_u32 v238, v1, 4, v238
    v_lshl_add_u32 v240, v0, 1, s66
    s_add_u32 s66, s52, 9344
    v_lshl_add_u32 v239, v1, 4, s66
    v_mov_b32 v188, 0
    v_mov_b32 v189, 0
    v_mov_b32 v190, 0
    v_mov_b32 v191, 0
    v_mov_b32 v192, 0
    v_mov_b32 v193, 0
    v_mov_b32 v194, 0
    v_mov_b32 v195, 0
    v_mov_b32 v208, 0
    v_mov_b32 v212, 0
    v_mov_b32 v209, 0
    v_mov_b32 v213, 0
    v_mov_b32 v210, 0
    v_mov_b32 v214, 0
    v_mov_b32 v211, 0
    v_mov_b32 v215, 0
    s_add_u32 s93, s93, 1638400
    buffer_load_dwordx4 v[104:107], v3, s[24:27], s93 offen nt
    s_add_u32 s93, s93, 1638400
    buffer_load_dwordx4 v[108:111], v3, s[24:27], s93 offen nt
    s_add_u32 s93, s93, 1638400
    buffer_load_dwordx4 v[112:115], v3, s[24:27], s93 offen nt
    v_lshlrev_b32 v249, 3, v1
    v_lshl_add_u32 v249, v250, 5, v249
    global_load_dwordx2 v[216:217], v249, s[14:15]
    s_cmp_ge_u32 s54, 4
    s_cbranch_scc1 L_young1
    s_waitcnt vmcnt(10) lgkmcnt(0)
    s_call_b64 s[62:63], L_fp
    s_waitcnt vmcnt(9)
    s_branch L_old1
L_young1:
    s_waitcnt vmcnt(5)
L_old1:
    s_waitcnt lgkmcnt(0)
    s_barrier
    ds_read_b64_tr_b16 v[16:17], v66 offset:0
    ds_read_b64_tr_b16 v[18:19], v66 offset:512
    ds_read_b64_tr_b16 v[20:21], v66 offset:20480
    ds_read_b64_tr_b16 v[22:23], v66 offset:20992
    ds_read_b64_tr_b16 v[24:25], v66 offset:40960
    ds_read_b64_tr_b16 v[26:27], v66 offset:41472
    ds_read_b64_tr_b16 v[28:29], v66 offset:61440
    ds_read_b64_tr_b16 v[30:31], v66 offset:61952
    ds_read_b128 v[32:35], v67 offset:8320
    ds_read_b128 v[36:39], v67 offset:8384
    ds_read_b128 v[40:43], v67 offset:49280
    ds_read_b128 v[44:47], v67 offset:49344
    ds_read_b64_tr_b16 v[4:5], v64 offset:0
    ds_read_b64_tr_b16 v[8:9], v65 offset:0
    ds_read_b64_tr_b16 v[12:13], v65 offset:40960
    ds_read_b64_tr_b16 v[6:7], v64 offset:512
    ds_read_b64_tr_b16 v[10:11], v65 offset:512
    ds_read_b64_tr_b16 v[14:15], v65 offset:41472
    s_cmp_ge_u32 s54, 4
    s_cbranch_scc1 L_young2
    s_waitcnt vmcnt(8)
    s_branch L_old2
L_young2:
    s_waitcnt vmcnt(4)
L_old2:
    v_lshlrev_b32 v48, 16, v96
    v_and_b32 v49, 0xffff0000, v96
    v_lshlrev_b32 v50, 16, v97
    v_and_b32 v51, 0xffff0000, v97
    s_lshl_b32 s30, s30, 16
    v_and_b32 v204, s30, v220
    v_and_b32 v205, s30, v220
    v_and_b32 v206, s30, v220
    v_and_b32 v207, s30, v220
    s_waitcnt lgkmcnt(0)
    v_xor_b32 v24, 0x80008000, v24
    v_xor_b32 v25, 0x80008000, v25
    v_xor_b32 v26, 0x80008000, v26
    v_xor_b32 v27, 0x80008000, v27
    v_xor_b32 v28, 0x80008000, v28
    v_xor_b32 v29, 0x80008000, v29
    v_xor_b32 v30, 0x80008000, v30
    v_xor_b32 v31, 0x80008000, v31
    v_mfma_f32_4x4x4_16b_bf16 v[56:59], v[218:219], v[4:5], 0
    v_mfma_f32_4x4x4_16b_bf16 v[68:71], v[218:219], v[12:13], 0
    v_mfma_f32_4x4x4_16b_bf16 v[60:63], v[218:219], v[6:7], 0
    v_mfma_f32_4x4x4_16b_bf16 v[72:75], v[218:219], v[14:15], 0
    v_mfma_f32_4x4x4_16b_bf16 v[56:59], v[218:219], v[8:9], v[56:59]
    v_mfma_f32_4x4x4_16b_bf16 v[60:63], v[218:219], v[10:11], v[60:63]
    v_mfma_f32_16x16x32_bf16 v[52:55], v[16:19], v[40:43], v[48:51]
    v_mfma_f32_16x16x32_bf16 v[52:55], v[20:23], v[44:47], v[52:55]
    v_mfma_f32_16x16x32_bf16 v[52:55], v[24:27], v[40:43], v[52:55]
    v_mfma_f32_16x16x32_bf16 v[52:55], v[28:31], v[44:47], v[52:55]
    v_mfma_f32_16x16x32_bf16 v[48:51], v[16:19], v[32:35], v[48:51]
    v_mfma_f32_16x16x32_bf16 v[48:51], v[20:23], v[36:39], v[48:51]
    v_mfma_f32_16x16x32_bf16 v[48:51], v[24:27], v[32:35], v[48:51]
    v_mfma_f32_16x16x32_bf16 v[48:51], v[28:31], v[36:39], v[48:51]
    v_mul_f32 v56, s92, v56
    v_mul_f32 v57, s92, v57
    v_mul_f32 v58, s92, v58
    v_mul_f32 v59, s92, v59
    v_mul_f32 v60, s92, v60
    v_mul_f32 v61, s92, v61
    v_mul_f32 v62, s92, v62
    v_mul_f32 v63, s92, v63
    v_mul_f32 v68, s92, v68
    v_mul_f32 v69, s92, v69
    v_mul_f32 v70, s92, v70
    v_mul_f32 v71, s92, v71
    v_mul_f32 v72, s92, v72
    v_mul_f32 v73, s92, v73
    v_mul_f32 v74, s92, v74
    v_mul_f32 v75, s92, v75
    s_add_u32 s66, s52, 11520
    v_add_u32 v3, s66, v2
    v_cvt_pk_bf16_f32 v68, v68, v69
    v_cvt_pk_bf16_f32 v69, v70, v71
    v_cvt_pk_bf16_f32 v70, v72, v73
    v_cvt_pk_bf16_f32 v71, v74, v75
    v_mul_f32 v48, s92, v48
    v_mul_f32 v49, s92, v49
    v_mul_f32 v50, s92, v50
    v_mul_f32 v51, s92, v51
    v_mul_f32 v52, s92, v52
    v_mul_f32 v53, s92, v53
    v_mul_f32 v54, s92, v54
    v_mul_f32 v55, s92, v55
    ds_write_b128 v3, v[56:59]
    ds_write_b128 v3, v[60:63] offset:1024
    ds_write_b128 v3, v[68:71] offset:2048
    ds_write_b128 v98, v[48:51]
    ds_write_b128 v98, v[52:55] offset:40960
    v_add_u32 v3, 11520, v2
    v_add_u32 v246, 81920, v3
    s_waitcnt lgkmcnt(0)
    s_barrier
    s_cmp_ge_u32 s54, 4
    s_cbranch_scc0 L_old3
    s_call_b64 s[62:63], L_fp
    s_branch L_yng3
L_old3:
    s_call_b64 s[62:63], L_t23
L_yng3:
    ds_read_b128 v[4:7], v3 offset:0
    ds_read_b128 v[8:11], v3 offset:1024
    ds_read_b128 v[68:71], v3 offset:2048
    ds_read_b128 v[12:15], v3 offset:20480
    ds_read_b128 v[16:19], v3 offset:21504
    ds_read_b128 v[72:75], v3 offset:22528
    ds_read_b128 v[20:23], v3 offset:40960
    ds_read_b128 v[24:27], v3 offset:41984
    ds_read_b128 v[76:79], v3 offset:43008
    s_waitcnt vmcnt(4)
    v_mfma_i32_16x16x64_i8 v[172:175], v[122:125], v[104:107], 0
    v_mfma_i32_16x16x64_i8 v[176:179], v[122:125], v[108:111], 0
    v_mfma_i32_16x16x64_i8 v[180:183], v[122:125], v[112:115], 0
    v_and_b32 v160, 0x800080, v104
    v_mul_u32_u24 v160, 0x7f, v160
    v_bitop3_b32 v131, v104, v160, v131 bitop3:0xbe
    v_and_b32 v161, 0x800080, v105
    v_mul_u32_u24 v161, 0x7f, v161
    v_bitop3_b32 v131, v105, v161, v131 bitop3:0xbe
    v_and_b32 v160, 0x800080, v106
    v_mul_u32_u24 v160, 0x7f, v160
    v_bitop3_b32 v131, v106, v160, v131 bitop3:0xbe
    v_mov_b32_dpp v184, v172 row_shr:1 row_mask:0xf bank_mask:0xf bound_ctrl:0
    v_mov_b32_dpp v185, v176 row_shr:1 row_mask:0xf bank_mask:0xf bound_ctrl:0
    v_mov_b32_dpp v186, v180 row_shr:1 row_mask:0xf bank_mask:0xf bound_ctrl:0
    v_add_u32_dpp v184, v184, v184 row_shr:1 row_mask:0xf bank_mask:0xf bound_ctrl:0
    v_add_u32_dpp v185, v185, v185 row_shr:1 row_mask:0xf bank_mask:0xf bound_ctrl:0
    v_add_u32_dpp v186, v186, v186 row_shr:1 row_mask:0xf bank_mask:0xf bound_ctrl:0
    v_add_u32_dpp v184, v184, v184 row_shr:2 row_mask:0xf bank_mask:0xf bound_ctrl:0
    v_add_u32_dpp v185, v185, v185 row_shr:2 row_mask:0xf bank_mask:0xf bound_ctrl:0
    v_add_u32_dpp v186, v186, v186 row_shr:2 row_mask:0xf bank_mask:0xf bound_ctrl:0
    v_add_u32_dpp v184, v184, v184 row_shr:4 row_mask:0xf bank_mask:0xf bound_ctrl:0
    v_add_u32_dpp v185, v185, v185 row_shr:4 row_mask:0xf bank_mask:0xf bound_ctrl:0
    v_add_u32_dpp v186, v186, v186 row_shr:4 row_mask:0xf bank_mask:0xf bound_ctrl:0
    v_add_u32_dpp v184, v184, v184 row_shr:8 row_mask:0xf bank_mask:0xf bound_ctrl:0
    v_add_u32_dpp v185, v185, v185 row_shr:8 row_mask:0xf bank_mask:0xf bound_ctrl:0
    v_add_u32_dpp v186, v186, v186 row_shr:8 row_mask:0xf bank_mask:0xf bound_ctrl:0
    ds_read_b128 v[28:31], v3 offset:61440
    ds_read_b128 v[32:35], v3 offset:62464
    ds_read_b128 v[80:83], v3 offset:63488
    ds_read_b128 v[36:39], v246 offset:0
    ds_read_b128 v[40:43], v246 offset:1024
    ds_read_b128 v[84:87], v246 offset:2048
    v_and_b32 v161, 0x800080, v107
    v_mul_u32_u24 v161, 0x7f, v161
    v_bitop3_b32 v131, v107, v161, v131 bitop3:0xbe
    v_and_b32 v160, 0x800080, v108
    v_mul_u32_u24 v160, 0x7f, v160
    v_bitop3_b32 v131, v108, v160, v131 bitop3:0xbe
    v_and_b32 v161, 0x800080, v109
    v_mul_u32_u24 v161, 0x7f, v161
    v_bitop3_b32 v131, v109, v161, v131 bitop3:0xbe
    v_and_b32 v160, 0x800080, v110
    v_mul_u32_u24 v160, 0x7f, v160
    v_bitop3_b32 v131, v110, v160, v131 bitop3:0xbe
    v_and_b32 v161, 0x800080, v111
    v_mul_u32_u24 v161, 0x7f, v161
    v_bitop3_b32 v131, v111, v161, v131 bitop3:0xbe
    v_and_b32 v160, 0x800080, v112
    v_mul_u32_u24 v160, 0x7f, v160
    v_bitop3_b32 v131, v112, v160, v131 bitop3:0xbe
    v_and_b32 v161, 0x800080, v113
    v_mul_u32_u24 v161, 0x7f, v161
    v_bitop3_b32 v131, v113, v161, v131 bitop3:0xbe
    v_and_b32 v160, 0x800080, v114
    v_mul_u32_u24 v160, 0x7f, v160
    v_bitop3_b32 v131, v114, v160, v131 bitop3:0xbe
    v_and_b32 v161, 0x800080, v115
    v_mul_u32_u24 v161, 0x7f, v161
    v_bitop3_b32 v131, v115, v161, v131 bitop3:0xbe
    v_cmp_ne_u32 vcc, 0, v131
    v_readlane_b32 s68, v184, 6
    v_readlane_b32 s69, v173, 6
    v_readlane_b32 s70, v184, 15
    v_readlane_b32 s72, v185, 6
    v_readlane_b32 s73, v177, 6
    v_readlane_b32 s74, v185, 15
    v_readlane_b32 s76, v186, 6
    v_readlane_b32 s77, v181, 6
    v_readlane_b32 s78, v186, 15
    s_cbranch_vccnz L_general
    s_add_u32 s66, s68, s69
    s_add_u32 s66, s66, s64
    s_add_u32 s67, s66, 15
    s_and_b32 s67, s67, -16
    s_add_u32 s55, s64, 16
    s_max_u32 s67, s67, s55
    s_sub_u32 s66, s67, s66
    v_mad_u32_u24 v184, v130, s66, v184
    s_sub_u32 s55, s64, 2048
    v_add_u32 v172, s55, v184
    v_add_u32 v173, s55, v184
    v_add_u32 v174, s55, v184
    v_add_u32 v175, s55, v184
    s_add_u32 s64, s64, s70
    s_add_u32 s64, s64, s66
    v_mfma_i32_16x16x64_i8 v[132:135], v[118:121], v[104:107], v[172:175]
    v_mfma_i32_16x16x64_i8 v[136:139], v[116:119], v[104:107], v[172:175]
    s_add_u32 s64, s64, 15
    s_and_b32 s64, s64, -16
    s_add_u32 s55, s67, 16
    s_max_u32 s64, s64, s55
    s_lshr_b32 s95, s67, 4
    s_bitset1_b64 s[56:57], s95
    s_lshr_b32 s95, s64, 4
    s_bitset1_b64 s[56:57], s95
    s_add_u32 s66, s72, s73
    s_add_u32 s66, s66, s64
    s_add_u32 s67, s66, 15
    s_and_b32 s67, s67, -16
    s_add_u32 s55, s64, 16
    s_max_u32 s67, s67, s55
    s_sub_u32 s66, s67, s66
    v_mad_u32_u24 v185, v130, s66, v185
    s_sub_u32 s55, s64, 2048
    v_add_u32 v176, s55, v185
    v_add_u32 v177, s55, v185
    v_add_u32 v178, s55, v185
    v_add_u32 v179, s55, v185
    s_add_u32 s64, s64, s74
    s_add_u32 s64, s64, s66
    v_mfma_i32_16x16x64_i8 v[140:143], v[118:121], v[108:111], v[176:179]
    v_mfma_i32_16x16x64_i8 v[144:147], v[116:119], v[108:111], v[176:179]
    s_add_u32 s64, s64, 15
    s_and_b32 s64, s64, -16
    s_add_u32 s55, s67, 16
    s_max_u32 s64, s64, s55
    s_lshr_b32 s95, s67, 4
    s_lshl_b64 s[86:87], 1, s95
    s_bitcmp1_b32 s67, 10
    s_cselect_b64 s[88:89], 0, s[86:87]
    s_cselect_b64 s[90:91], s[86:87], 0
    s_or_b64 s[56:57], s[56:57], s[88:89]
    s_or_b64 s[58:59], s[58:59], s[90:91]
    s_lshr_b32 s95, s64, 4
    s_lshl_b64 s[86:87], 1, s95
    s_bitcmp1_b32 s64, 10
    s_cselect_b64 s[88:89], 0, s[86:87]
    s_cselect_b64 s[90:91], s[86:87], 0
    s_or_b64 s[56:57], s[56:57], s[88:89]
    s_or_b64 s[58:59], s[58:59], s[90:91]
    ds_write_b8 v132, v126
    ds_write_b8_d16_hi v133, v126
    ds_write_b8 v134, v127
    ds_write_b8_d16_hi v135, v127
    ds_write_b8 v136, v128
    ds_write_b8_d16_hi v137, v128
    ds_write_b8 v138, v129
    ds_write_b8_d16_hi v139, v129
    s_add_u32 s66, s76, s77
    s_add_u32 s66, s66, s64
    s_add_u32 s67, s66, 15
    s_and_b32 s67, s67, -16
    s_add_u32 s55, s64, 16
    s_max_u32 s67, s67, s55
    s_sub_u32 s66, s67, s66
    v_mad_u32_u24 v186, v130, s66, v186
    s_sub_u32 s55, s64, 2048
    v_add_u32 v180, s55, v186
    v_add_u32 v181, s55, v186
    v_add_u32 v182, s55, v186
    v_add_u32 v183, s55, v186
    s_add_u32 s64, s64, s78
    s_add_u32 s64, s64, s66
    v_mfma_i32_16x16x64_i8 v[164:167], v[118:121], v[112:115], v[180:183]
    v_mfma_i32_16x16x64_i8 v[168:171], v[116:119], v[112:115], v[180:183]
    s_add_u32 s64, s64, 15
    s_and_b32 s64, s64, -16
    s_add_u32 s55, s67, 16
    s_max_u32 s64, s64, s55
    s_lshr_b32 s95, s67, 4
    s_lshl_b64 s[86:87], 1, s95
    s_bitcmp1_b32 s67, 10
    s_cselect_b64 s[88:89], 0, s[86:87]
    s_cselect_b64 s[90:91], s[86:87], 0
    s_or_b64 s[56:57], s[56:57], s[88:89]
    s_or_b64 s[58:59], s[58:59], s[90:91]
    s_lshr_b32 s95, s64, 4
    s_lshl_b64 s[86:87], 1, s95
    s_bitcmp1_b32 s64, 10
    s_cselect_b64 s[88:89], 0, s[86:87]
    s_cselect_b64 s[90:91], s[86:87], 0
    s_or_b64 s[56:57], s[56:57], s[88:89]
    s_or_b64 s[58:59], s[58:59], s[90:91]
    ds_write_b8 v140, v126
    ds_write_b8_d16_hi v141, v126
    ds_write_b8 v142, v127
    ds_write_b8_d16_hi v143, v127
    ds_write_b8 v144, v128
    ds_write_b8_d16_hi v145, v128
    ds_write_b8 v146, v129
    ds_write_b8_d16_hi v147, v129
    ds_read_b128 v[44:47], v246 offset:20480
    ds_read_b128 v[48:51], v246 offset:21504
    ds_read_b128 v[88:91], v246 offset:22528
    ds_read_b128 v[52:55], v246 offset:40960
    ds_read_b128 v[56:59], v246 offset:41984
    ds_read_b128 v[92:95], v246 offset:43008
    ds_read_b128 v[60:63], v246 offset:61440
    ds_read_b128 v[64:67], v246 offset:62464
    ds_read_b128 v[96:99], v246 offset:63488
    ds_read_u16 v224, v238 offset:0
    ds_read_u16 v225, v238 offset:8
    ds_read_u16 v226, v238 offset:64
    ds_read_u16 v227, v238 offset:72
    ds_write_b8 v164, v126
    ds_write_b8_d16_hi v165, v126
    ds_write_b8 v166, v127
    ds_write_b8_d16_hi v167, v127
    ds_write_b8 v168, v128
    ds_write_b8_d16_hi v169, v128
    ds_write_b8 v170, v129
    ds_write_b8_d16_hi v171, v129
    s_cmp_ge_u32 s54, 4
    s_cbranch_scc0 L_old3b
    s_call_b64 s[62:63], L_t23
L_old3b:
L_listed:
    s_sub_u32 s66, s64, s52
    s_sub_u32 s66, s66, 18448
    s_lshr_b32 s66, s66, 3
    s_xor_b32 s66, s66, s33
    s_sub_u32 s66, s66, s33
    s_xor_b32 s67, 0xfffffff8, s33
    s_sub_u32 s67, s67, s33
    v_mov_b32 v2, v221
    v_mov_b32 v1, s66
    v_mov_b32 v3, s67
    s_mov_b64 exec, 1
    ds_add_u32 v2, v1
    s_mov_b64 exec, -1
    s_cmp_eq_u32 s94, 1
    s_cbranch_scc1 L_nolate
    ds_read_u8 v148, v237 offset:0
    ds_read_u8 v149, v237 offset:8
    ds_read_u8 v150, v237 offset:16
    ds_read_u8 v151, v237 offset:24
    ds_read_u8 v152, v237 offset:32
    ds_read_u8 v153, v237 offset:40
    ds_read_u8 v154, v237 offset:48
    ds_read_u8 v155, v237 offset:56
    s_waitcnt lgkmcnt(0)
    s_add_u32 m0, s52, 0
    v_mov_b32 v230, v148
    v_mov_b32 v232, v149
    buffer_load_dwordx4 v[230:231], s[20:23], 0 idxen offen nt lds
    buffer_load_dwordx4 v[232:233], s[40:43], 0 idxen offen offset:1056 nt lds
    s_bitcmp0_b64 s[56:57], 2
    s_cbranch_scc1 L_noadvl1
    s_sub_u32 s60, s60, 1
    s_cselect_b32 s31, 0, s31
    s_add_u32 s20, s20, s31
    s_addc_u32 s21, s21, 0
    s_add_u32 s40, s40, s31
    s_addc_u32 s41, s41, 0
    s_xor_b32 s31, s31, 0x63ff800
L_noadvl1:
    s_add_u32 m0, s52, 2080
    v_mov_b32 v230, v150
    v_mov_b32 v232, v151
    buffer_load_dwordx4 v[230:231], s[20:23], 0 idxen offen nt lds
    buffer_load_dwordx4 v[232:233], s[40:43], 0 idxen offen offset:1056 nt lds
    s_bitcmp0_b64 s[56:57], 3
    s_cbranch_scc1 L_noadvl2
    s_sub_u32 s60, s60, 1
    s_cselect_b32 s31, 0, s31
    s_add_u32 s20, s20, s31
    s_addc_u32 s21, s21, 0
    s_add_u32 s40, s40, s31
    s_addc_u32 s41, s41, 0
    s_xor_b32 s31, s31, 0x63ff800
L_noadvl2:
    s_add_u32 m0, s52, 4160
    v_mov_b32 v230, v152
    v_mov_b32 v232, v153
    buffer_load_dwordx4 v[230:231], s[20:23], 0 idxen offen nt lds
    buffer_load_dwordx4 v[232:233], s[40:43], 0 idxen offen offset:1056 nt lds
    s_bitcmp0_b64 s[56:57], 4
    s_cbranch_scc1 L_noadvl3
    s_sub_u32 s60, s60, 1
    s_cselect_b32 s31, 0, s31
    s_add_u32 s20, s20, s31
    s_addc_u32 s21, s21, 0
    s_add_u32 s40, s40, s31
    s_addc_u32 s41, s41, 0
    s_xor_b32 s31, s31, 0x63ff800
L_noadvl3:
    s_add_u32 m0, s52, 6240
    v_mov_b32 v230, v154
    v_mov_b32 v232, v155
    buffer_load_dwordx4 v[230:231], s[20:23], 0 idxen offen nt lds
    buffer_load_dwordx4 v[232:233], s[40:43], 0 idxen offen offset:1056 nt lds
L_nolate:
    v_and_b32_dpp v196, v216, v220 quad_perm:[0,0,0,0] row_mask:0xf bank_mask:0xf
    v_and_b32_dpp v197, v217, v220 quad_perm:[0,0,0,0] row_mask:0xf bank_mask:0xf
    v_and_b32_dpp v198, v216, v220 quad_perm:[1,1,1,1] row_mask:0xf bank_mask:0xf
    v_and_b32_dpp v199, v217, v220 quad_perm:[1,1,1,1] row_mask:0xf bank_mask:0xf
    v_and_b32_dpp v200, v216, v220 quad_perm:[2,2,2,2] row_mask:0xf bank_mask:0xf
    v_and_b32_dpp v201, v217, v220 quad_perm:[2,2,2,2] row_mask:0xf bank_mask:0xf
    v_and_b32_dpp v202, v216, v220 quad_perm:[3,3,3,3] row_mask:0xf bank_mask:0xf
    v_and_b32_dpp v203, v217, v220 quad_perm:[3,3,3,3] row_mask:0xf bank_mask:0xf
    s_waitcnt vmcnt(6) lgkmcnt(0)
    ds_read_b128 v[180:183], v234 offset:0
    ds_read_b128 v[184:187], v235 offset:0
    v_mul_u32_u24 v216, v224, v241
    v_mul_u32_u24 v217, v224, v242
    v_mul_u32_u24 v218, v225, v241
    v_mul_u32_u24 v219, v225, v242
    v_mul_u32_u24 v220, v226, v241
    v_mul_u32_u24 v221, v226, v242
    v_mul_u32_u24 v222, v227, v241
    v_mul_u32_u24 v223, v227, v242
    v_add_u32 v238, 128, v238
    ds_read_b128 v[164:167], v239
    v_mfma_f32_4x4x4_16b_bf16 v[132:135], v[216:217], v[68:69], v[4:7]
    ds_read_b128 v[168:171], v239 offset:64
    ds_read_b128 v[172:175], v239 offset:128
    v_mfma_f32_4x4x4_16b_bf16 v[136:139], v[218:219], v[70:71], v[8:11]
    ds_read_b128 v[176:179], v239 offset:192
    ds_read_u16 v224, v238
    v_mfma_f32_4x4x4_16b_bf16 v[140:143], v[220:221], v[72:73], v[12:15]
    ds_read_u16 v225, v238 offset:8
    ds_read_u16 v226, v238 offset:64
    v_mfma_f32_4x4x4_16b_bf16 v[144:147], v[222:223], v[74:75], v[16:19]
    ds_read_u16 v227, v238 offset:72
    v_add_u32 v239, 272, v239
    v_mfma_f32_4x4x4_16b_bf16 v[246:249], v[216:217], v[76:77], v[20:23]
    v_cvt_pk_bf16_f32 v100, v132, v133
    v_cvt_pk_bf16_f32 v101, v134, v135
    v_mfma_f32_4x4x4_16b_bf16 v[250:253], v[218:219], v[78:79], v[24:27]
    v_cvt_pk_bf16_f32 v102, v136, v137
    v_cvt_pk_bf16_f32 v103, v138, v139
    v_mfma_f32_4x4x4_16b_bf16 v[132:135], v[220:221], v[80:81], v[28:31]
    v_cvt_pk_bf16_f32 v104, v140, v141
    v_cvt_pk_bf16_f32 v105, v142, v143
    v_mfma_f32_4x4x4_16b_bf16 v[136:139], v[222:223], v[82:83], v[32:35]
    v_cvt_pk_bf16_f32 v106, v144, v145
    v_cvt_pk_bf16_f32 v107, v146, v147
    v_mfma_f32_4x4x4_16b_bf16 v[140:143], v[216:217], v[84:85], v[36:39]
    v_cvt_pk_bf16_f32 v108, v246, v247
    v_cvt_pk_bf16_f32 v109, v248, v249
    v_mfma_f32_4x4x4_16b_bf16 v[144:147], v[218:219], v[86:87], v[40:43]
    v_cvt_pk_bf16_f32 v110, v250, v251
    v_cvt_pk_bf16_f32 v111, v252, v253
    v_mfma_f32_4x4x4_16b_bf16 v[246:249], v[220:221], v[88:89], v[44:47]
    v_cvt_pk_bf16_f32 v112, v132, v133
    v_cvt_pk_bf16_f32 v113, v134, v135
    v_mfma_f32_4x4x4_16b_bf16 v[250:253], v[222:223], v[90:91], v[48:51]
    v_cvt_pk_bf16_f32 v114, v136, v137
    v_cvt_pk_bf16_f32 v115, v138, v139
    v_mfma_f32_4x4x4_16b_bf16 v[132:135], v[216:217], v[92:93], v[52:55]
    v_cvt_pk_bf16_f32 v116, v140, v141
    v_cvt_pk_bf16_f32 v117, v142, v143
    v_mfma_f32_4x4x4_16b_bf16 v[136:139], v[218:219], v[94:95], v[56:59]
    v_cvt_pk_bf16_f32 v118, v144, v145
    v_cvt_pk_bf16_f32 v119, v146, v147
    v_mfma_f32_4x4x4_16b_bf16 v[140:143], v[220:221], v[96:97], v[60:63]
    v_cvt_pk_bf16_f32 v120, v246, v247
    v_cvt_pk_bf16_f32 v121, v248, v249
    v_mfma_f32_4x4x4_16b_bf16 v[144:147], v[222:223], v[98:99], v[64:67]
    v_cvt_pk_bf16_f32 v122, v250, v251
    v_cvt_pk_bf16_f32 v123, v252, v253
    v_cvt_pk_bf16_f32 v124, v132, v133
    v_cvt_pk_bf16_f32 v125, v134, v135
    v_cvt_pk_bf16_f32 v126, v136, v137
    v_cvt_pk_bf16_f32 v127, v138, v139
    v_cvt_pk_bf16_f32 v128, v140, v141
    v_cvt_pk_bf16_f32 v129, v142, v143
    v_cvt_pk_bf16_f32 v130, v144, v145
    v_cvt_pk_bf16_f32 v131, v146, v147
    s_waitcnt lgkmcnt(0)
    v_mfma_f32_16x16x32_bf16 v[148:151], v[100:103], v[180:183], v[164:167]
    v_mfma_f32_16x16x32_bf16 v[148:151], v[104:107], v[184:187], v[148:151]
    v_mfma_f32_16x16x32_bf16 v[152:155], v[108:111], v[180:183], v[168:171]
    v_mfma_f32_16x16x32_bf16 v[152:155], v[112:115], v[184:187], v[152:155]
    v_mfma_f32_16x16x32_bf16 v[156:159], v[116:119], v[180:183], v[172:175]
    v_mfma_f32_16x16x32_bf16 v[156:159], v[120:123], v[184:187], v[156:159]
    v_mfma_f32_16x16x32_bf16 v[160:163], v[124:127], v[180:183], v[176:179]
    v_mfma_f32_16x16x32_bf16 v[160:163], v[128:131], v[184:187], v[160:163]
    s_waitcnt vmcnt(4)
    ds_read_b128 v[180:183], v234 offset:2080
    ds_read_b128 v[184:187], v235 offset:2080
    ds_read_u8 v230, v237 offset:64
    ds_read_u8 v232, v237 offset:72
    s_lshr_b64 s[86:87], s[56:57], 2
    s_lshr_b64 s[36:37], s[56:57], 5
    s_or_b32 s36, s36, s86
    s_or_b32 s36, s36, s56
    s_cmp_lg_u64 s[84:85], 0
    s_cbranch_scc0 Lf_mid
    s_mul_i32 s66, s53, 800
    s_add_u32 s8, s8, s66
    s_addc_u32 s9, s9, 0
    s_mov_b32 s24, s8
    s_and_b32 s25, s9, 0xffff
    s_mov_b32 s26, 400
    s_mov_b32 s27, 0x20000
    s_movk_i32 s32, 400
    s_branch Ls_mid
L_fp:
    v_mfma_i32_16x16x64_i8 v[172:175], v[122:125], v[100:103], 0
    v_and_b32 v160, 0x800080, v100
    v_mul_u32_u24 v160, 0x7f, v160
    v_bitop3_b32 v131, v100, v160, v131 bitop3:0xbe
    v_and_b32 v161, 0x800080, v101
    v_mul_u32_u24 v161, 0x7f, v161
    v_bitop3_b32 v131, v101, v161, v131 bitop3:0xbe
    v_and_b32 v160, 0x800080, v102
    v_mul_u32_u24 v160, 0x7f, v160
    v_mov_b32_dpp v184, v172 row_shr:1 row_mask:0xf bank_mask:0xf bound_ctrl:0
    v_bitop3_b32 v131, v102, v160, v131 bitop3:0xbe
    s_nop 0
    v_add_u32_dpp v184, v184, v184 row_shr:1 row_mask:0xf bank_mask:0xf bound_ctrl:0
    v_and_b32 v161, 0x800080, v103
    s_nop 0
    v_add_u32_dpp v184, v184, v184 row_shr:2 row_mask:0xf bank_mask:0xf bound_ctrl:0
    v_mul_u32_u24 v161, 0x7f, v161
    s_nop 0
    v_add_u32_dpp v184, v184, v184 row_shr:4 row_mask:0xf bank_mask:0xf bound_ctrl:0
    v_bitop3_b32 v131, v103, v161, v131 bitop3:0xbe
    s_nop 0
    v_add_u32_dpp v184, v184, v184 row_shr:8 row_mask:0xf bank_mask:0xf bound_ctrl:0
    v_cmp_ne_u32 vcc, 0, v131
    v_readlane_b32 s68, v184, 6
    v_readlane_b32 s69, v173, 6
    v_readlane_b32 s70, v184, 15
    s_mov_b32 s94, 0
    s_cbranch_vccnz L_late
    s_add_u32 s66, s68, s69
    s_add_u32 s66, s66, s64
    s_add_u32 s67, s66, 15
    s_and_b32 s67, s67, -16
    s_add_u32 s55, s64, 16
    s_max_u32 s67, s67, s55
    s_sub_u32 s66, s67, s66
    v_mad_u32_u24 v184, v130, s66, v184
    s_sub_u32 s55, s64, 2048
    v_add_u32 v172, s55, v184
    v_add_u32 v173, s55, v184
    v_add_u32 v174, s55, v184
    v_add_u32 v175, s55, v184
    s_add_u32 s64, s64, s70
    s_add_u32 s64, s64, s66
    v_mfma_i32_16x16x64_i8 v[132:135], v[118:121], v[100:103], v[172:175]
    v_mfma_i32_16x16x64_i8 v[136:139], v[116:119], v[100:103], v[172:175]
    s_add_u32 s64, s64, 15
    s_and_b32 s64, s64, -16
    s_add_u32 s55, s67, 16
    s_max_u32 s64, s64, s55
    s_lshr_b32 s95, s67, 4
    s_bitset1_b64 s[56:57], s95
    s_lshr_b32 s95, s64, 4
    s_bitset1_b64 s[56:57], s95
    s_add_u32 s66, s52, 18512
    s_cmp_ge_u32 s64, s66
    ds_write_b8 v132, v126
    ds_write_b8_d16_hi v133, v126
    ds_write_b8 v134, v127
    ds_write_b8_d16_hi v135, v127
    ds_write_b8 v136, v128
    ds_write_b8_d16_hi v137, v128
    ds_write_b8 v138, v129
    ds_write_b8_d16_hi v139, v129
    s_cbranch_scc0 L_late
    s_mov_b32 s94, 1
    ds_read_u8 v148, v237 offset:0
    ds_read_u8 v149, v237 offset:8
    ds_read_u8 v150, v237 offset:16
    ds_read_u8 v151, v237 offset:24
    ds_read_u8 v152, v237 offset:32
    ds_read_u8 v153, v237 offset:40
    ds_read_u8 v154, v237 offset:48
    ds_read_u8 v155, v237 offset:56
    s_waitcnt lgkmcnt(0)
    s_add_u32 m0, s52, 0
    v_mov_b32 v230, v148
    v_mov_b32 v232, v149
    buffer_load_dwordx4 v[230:231], s[20:23], 0 idxen offen nt lds
    buffer_load_dwordx4 v[232:233], s[40:43], 0 idxen offen offset:1056 nt lds
    s_bitcmp0_b64 s[56:57], 2
    s_cbranch_scc1 L_noadve1
    s_sub_u32 s60, s60, 1
    s_cselect_b32 s31, 0, s31
    s_add_u32 s20, s20, s31
    s_addc_u32 s21, s21, 0
    s_add_u32 s40, s40, s31
    s_addc_u32 s41, s41, 0
    s_xor_b32 s31, s31, 0x63ff800
L_noadve1:
    s_add_u32 m0, s52, 2080
    v_mov_b32 v230, v150
    v_mov_b32 v232, v151
    buffer_load_dwordx4 v[230:231], s[20:23], 0 idxen offen nt lds
    buffer_load_dwordx4 v[232:233], s[40:43], 0 idxen offen offset:1056 nt lds
    s_setpc_b64 s[62:63]
L_late:
    s_waitcnt vmcnt(0)
    s_setpc_b64 s[62:63]
L_t23:
    s_cmp_eq_u32 s94, 0
    s_cbranch_scc1 L_skip2
    s_bitcmp0_b64 s[56:57], 3
    s_cbranch_scc1 L_noadve2
    s_sub_u32 s60, s60, 1
    s_cselect_b32 s31, 0, s31
    s_add_u32 s20, s20, s31
    s_addc_u32 s21, s21, 0
    s_add_u32 s40, s40, s31
    s_addc_u32 s41, s41, 0
    s_xor_b32 s31, s31, 0x63ff800
L_noadve2:
    s_add_u32 m0, s52, 4160
    v_mov_b32 v230, v152
    v_mov_b32 v232, v153
    buffer_load_dwordx4 v[230:231], s[20:23], 0 idxen offen nt lds
    buffer_load_dwordx4 v[232:233], s[40:43], 0 idxen offen offset:1056 nt lds
    s_bitcmp0_b64 s[56:57], 4
    s_cbranch_scc1 L_noadve3
    s_sub_u32 s60, s60, 1
    s_cselect_b32 s31, 0, s31
    s_add_u32 s20, s20, s31
    s_addc_u32 s21, s21, 0
    s_add_u32 s40, s40, s31
    s_addc_u32 s41, s41, 0
    s_xor_b32 s31, s31, 0x63ff800
L_noadve3:
    s_add_u32 m0, s52, 6240
    v_mov_b32 v230, v154
    v_mov_b32 v232, v155
    buffer_load_dwordx4 v[230:231], s[20:23], 0 idxen offen nt lds
    buffer_load_dwordx4 v[232:233], s[40:43], 0 idxen offen offset:1056 nt lds
L_skip2:
    s_setpc_b64 s[62:63]
Lf_loop:
    ds_read_u8 v230, v237 offset:64
    ds_read_u8 v232, v237 offset:72
    v_mfma_f32_16x16x32_bf16 v[208:211], v[136:139], v[200:203], v[208:211]
Lf_mid:
    s_bitcmp1_b32 s36, 0
    s_cbranch_scc1 Lf_ev0
Lf_evd0:
    s_mov_b64 exec, 1
    ds_add_rtn_u32 v1, v2, v3
    s_mov_b64 exec, -1
    v_exp_f32 v132, v148
    v_exp_f32 v133, v149
    v_exp_f32 v134, v150
    v_exp_f32 v135, v151
    v_exp_f32 v136, v152
    v_exp_f32 v137, v153
    v_mfma_f32_4x4x4_16b_bf16 v[132:135], v[228:229], v[228:229], v[132:135]
    v_cvt_pk_bf16_f32 v208, v208, v209
    v_cvt_pk_bf16_f32 v209, v210, v211
    s_waitcnt lgkmcnt(2)
    v_mfma_f32_16x16x32_bf16 v[148:151], v[100:103], v[180:183], v[164:167]
    v_exp_f32 v138, v154
    v_mfma_f32_4x4x4_16b_bf16 v[212:215], v[208:209], v[188:189], v[212:215] cbsz:4 abid:0
    ds_read_b64_tr_b16 v[188:189], v236 offset:0
    v_exp_f32 v139, v155
    v_mfma_f32_16x16x32_bf16 v[152:155], v[108:111], v[180:183], v[168:171]
    v_exp_f32 v140, v156
    v_mfma_f32_4x4x4_16b_bf16 v[212:215], v[208:209], v[190:191], v[212:215] cbsz:4 abid:4
    ds_read_b64_tr_b16 v[190:191], v236 offset:512
    v_mfma_f32_4x4x4_16b_bf16 v[136:139], v[228:229], v[228:229], v[136:139]
    v_rcp_f32 v132, v132
    v_mfma_f32_4x4x4_16b_bf16 v[212:215], v[208:209], v[192:193], v[212:215] cbsz:4 abid:8
    ds_read_b64_tr_b16 v[192:193], v236 offset:1056
    v_exp_f32 v141, v157
    v_mfma_f32_16x16x32_bf16 v[148:151], v[104:107], v[184:187], v[148:151]
    v_rcp_f32 v133, v133
    v_mfma_f32_4x4x4_16b_bf16 v[212:215], v[208:209], v[194:195], v[212:215] cbsz:4 abid:12
    ds_read_b64_tr_b16 v[194:195], v236 offset:1568
    v_exp_f32 v142, v158
    v_mfma_f32_16x16x32_bf16 v[152:155], v[112:115], v[184:187], v[152:155]
    v_rcp_f32 v134, v134
    v_exp_f32 v143, v159
    v_rcp_f32 v135, v135
    v_cvt_pk_bf16_f32 v132, v132, v133
    v_mfma_f32_4x4x4_16b_bf16 v[140:143], v[228:229], v[228:229], v[140:143]
    v_exp_f32 v144, v160
    v_mfma_f32_16x16x32_bf16 v[156:159], v[116:119], v[180:183], v[172:175]
    v_rcp_f32 v136, v136
    v_cvt_pk_bf16_f32 v133, v134, v135
    s_add_u32 m0, s52, 0
    s_waitcnt lgkmcnt(0)
    buffer_load_dwordx4 v[230:231], s[20:23], 0 idxen offen nt lds
    v_exp_f32 v145, v161
    buffer_load_dwordx4 v[232:233], s[40:43], 0 idxen offen offset:1056 nt lds
    v_rcp_f32 v137, v137
    v_exp_f32 v146, v162
    v_rcp_f32 v138, v138
    v_cvt_pk_bf16_f32 v134, v136, v137
    v_exp_f32 v147, v163
    v_mfma_f32_16x16x32_bf16 v[160:163], v[124:127], v[180:183], v[176:179]
    v_readfirstlane_b32 s66, v1
    s_setprio 0
    s_xor_b32 s66, s66, s33
    s_cmp_gt_i32 s66, 0
    s_cbranch_scc0 Lf_lo0
    s_setprio 1
Lf_lo0:
    v_rcp_f32 v139, v139
    v_mfma_f32_4x4x4_16b_bf16 v[144:147], v[228:229], v[228:229], v[144:147]
    v_mfma_f32_16x16x32_bf16 v[156:159], v[120:123], v[184:187], v[156:159]
    v_rcp_f32 v140, v140
    v_mfma_f32_16x16x32_bf16 v[160:163], v[128:131], v[184:187], v[160:163]
    v_rcp_f32 v141, v141
    v_cvt_pk_bf16_f32 v135, v138, v139
    s_waitcnt vmcnt(4)
    ds_read_b128 v[180:183], v234 offset:4160
    ds_read_b128 v[184:187], v235 offset:4160
    v_rcp_f32 v142, v142
    v_cvt_pk_bf16_f32 v136, v140, v141
    v_mfma_f32_16x16x32_bf16 v[208:211], v[132:135], v[196:199], v[204:207]
    v_rcp_f32 v143, v143
    v_rcp_f32 v144, v144
    v_cvt_pk_bf16_f32 v137, v142, v143
    v_rcp_f32 v145, v145
    v_rcp_f32 v146, v146
    v_rcp_f32 v147, v147
    v_cvt_pk_bf16_f32 v138, v144, v145
    v_cvt_pk_bf16_f32 v139, v146, v147
    ds_read_u8 v230, v237 offset:80
    ds_read_u8 v232, v237 offset:88
    v_mfma_f32_16x16x32_bf16 v[208:211], v[136:139], v[200:203], v[208:211]
    s_bitcmp1_b32 s36, 1
    s_cbranch_scc1 Lf_ev1
Lf_evd1:
    v_exp_f32 v132, v148
    v_exp_f32 v133, v149
    v_exp_f32 v134, v150
    v_exp_f32 v135, v151
    v_exp_f32 v136, v152
    v_exp_f32 v137, v153
    v_mfma_f32_4x4x4_16b_bf16 v[132:135], v[228:229], v[228:229], v[132:135]
    v_cvt_pk_bf16_f32 v208, v208, v209
    v_cvt_pk_bf16_f32 v209, v210, v211
    s_waitcnt lgkmcnt(2)
    v_mfma_f32_16x16x32_bf16 v[148:151], v[100:103], v[180:183], v[164:167]
    v_exp_f32 v138, v154
    v_mfma_f32_4x4x4_16b_bf16 v[212:215], v[208:209], v[188:189], v[212:215] cbsz:4 abid:0
    ds_read_b64_tr_b16 v[188:189], v236 offset:2080
    v_exp_f32 v139, v155
    v_mfma_f32_16x16x32_bf16 v[152:155], v[108:111], v[180:183], v[168:171]
    v_exp_f32 v140, v156
    v_mfma_f32_4x4x4_16b_bf16 v[212:215], v[208:209], v[190:191], v[212:215] cbsz:4 abid:4
    ds_read_b64_tr_b16 v[190:191], v236 offset:2592
    v_mfma_f32_4x4x4_16b_bf16 v[136:139], v[228:229], v[228:229], v[136:139]
    v_rcp_f32 v132, v132
    v_mfma_f32_4x4x4_16b_bf16 v[212:215], v[208:209], v[192:193], v[212:215] cbsz:4 abid:8
    ds_read_b64_tr_b16 v[192:193], v236 offset:3136
    v_exp_f32 v141, v157
    v_mfma_f32_16x16x32_bf16 v[148:151], v[104:107], v[184:187], v[148:151]
    v_rcp_f32 v133, v133
    v_mfma_f32_4x4x4_16b_bf16 v[212:215], v[208:209], v[194:195], v[212:215] cbsz:4 abid:12
    ds_read_b64_tr_b16 v[194:195], v236 offset:3648
    v_exp_f32 v142, v158
    v_mfma_f32_16x16x32_bf16 v[152:155], v[112:115], v[184:187], v[152:155]
    v_rcp_f32 v134, v134
    v_exp_f32 v143, v159
    v_rcp_f32 v135, v135
    v_cvt_pk_bf16_f32 v132, v132, v133
    v_mfma_f32_4x4x4_16b_bf16 v[140:143], v[228:229], v[228:229], v[140:143]
    v_exp_f32 v144, v160
    v_mfma_f32_16x16x32_bf16 v[156:159], v[116:119], v[180:183], v[172:175]
    v_rcp_f32 v136, v136
    v_cvt_pk_bf16_f32 v133, v134, v135
    s_add_u32 m0, s52, 2080
    s_waitcnt lgkmcnt(0)
    buffer_load_dwordx4 v[230:231], s[20:23], 0 idxen offen nt lds
    v_exp_f32 v145, v161
    buffer_load_dwordx4 v[232:233], s[40:43], 0 idxen offen offset:1056 nt lds
    v_rcp_f32 v137, v137
    v_exp_f32 v146, v162
    v_rcp_f32 v138, v138
    v_cvt_pk_bf16_f32 v134, v136, v137
    v_exp_f32 v147, v163
    v_mfma_f32_16x16x32_bf16 v[160:163], v[124:127], v[180:183], v[176:179]
    v_rcp_f32 v139, v139
    v_mfma_f32_4x4x4_16b_bf16 v[144:147], v[228:229], v[228:229], v[144:147]
    v_mfma_f32_16x16x32_bf16 v[156:159], v[120:123], v[184:187], v[156:159]
    v_rcp_f32 v140, v140
    v_mfma_f32_16x16x32_bf16 v[160:163], v[128:131], v[184:187], v[160:163]
    v_rcp_f32 v141, v141
    v_cvt_pk_bf16_f32 v135, v138, v139
    s_waitcnt vmcnt(4)
    ds_read_b128 v[180:183], v234 offset:6240
    ds_read_b128 v[184:187], v235 offset:6240
    v_rcp_f32 v142, v142
    v_cvt_pk_bf16_f32 v136, v140, v141
    v_mfma_f32_16x16x32_bf16 v[208:211], v[132:135], v[196:199], v[204:207]
    v_rcp_f32 v143, v143
    v_rcp_f32 v144, v144
    v_cvt_pk_bf16_f32 v137, v142, v143
    v_rcp_f32 v145, v145
    v_rcp_f32 v146, v146
    v_rcp_f32 v147, v147
    v_cvt_pk_bf16_f32 v138, v144, v145
    v_cvt_pk_bf16_f32 v139, v146, v147
    ds_read_u8 v230, v237 offset:96
    ds_read_u8 v232, v237 offset:104
    v_mfma_f32_16x16x32_bf16 v[208:211], v[136:139], v[200:203], v[208:211]
    s_bitcmp1_b32 s36, 2
    s_cbranch_scc1 Lf_ev2
Lf_evd2:
    v_exp_f32 v132, v148
    v_exp_f32 v133, v149
    v_exp_f32 v134, v150
    v_exp_f32 v135, v151
    v_exp_f32 v136, v152
    v_exp_f32 v137, v153
    v_mfma_f32_4x4x4_16b_bf16 v[132:135], v[228:229], v[228:229], v[132:135]
    v_cvt_pk_bf16_f32 v208, v208, v209
    v_cvt_pk_bf16_f32 v209, v210, v211
    s_waitcnt lgkmcnt(2)
    v_mfma_f32_16x16x32_bf16 v[148:151], v[100:103], v[180:183], v[164:167]
    v_exp_f32 v138, v154
    v_mfma_f32_4x4x4_16b_bf16 v[212:215], v[208:209], v[188:189], v[212:215] cbsz:4 abid:0
    ds_read_b64_tr_b16 v[188:189], v236 offset:4160
    v_exp_f32 v139, v155
    v_mfma_f32_16x16x32_bf16 v[152:155], v[108:111], v[180:183], v[168:171]
    v_exp_f32 v140, v156
    v_mfma_f32_4x4x4_16b_bf16 v[212:215], v[208:209], v[190:191], v[212:215] cbsz:4 abid:4
    ds_read_b64_tr_b16 v[190:191], v236 offset:4672
    v_mfma_f32_4x4x4_16b_bf16 v[136:139], v[228:229], v[228:229], v[136:139]
    v_rcp_f32 v132, v132
    v_mfma_f32_4x4x4_16b_bf16 v[212:215], v[208:209], v[192:193], v[212:215] cbsz:4 abid:8
    ds_read_b64_tr_b16 v[192:193], v236 offset:5216
    v_exp_f32 v141, v157
    v_mfma_f32_16x16x32_bf16 v[148:151], v[104:107], v[184:187], v[148:151]
    v_rcp_f32 v133, v133
    v_mfma_f32_4x4x4_16b_bf16 v[212:215], v[208:209], v[194:195], v[212:215] cbsz:4 abid:12
    ds_read_b64_tr_b16 v[194:195], v236 offset:5728
    v_exp_f32 v142, v158
    v_mfma_f32_16x16x32_bf16 v[152:155], v[112:115], v[184:187], v[152:155]
    v_rcp_f32 v134, v134
    v_exp_f32 v143, v159
    v_rcp_f32 v135, v135
    v_cvt_pk_bf16_f32 v132, v132, v133
    v_mfma_f32_4x4x4_16b_bf16 v[140:143], v[228:229], v[228:229], v[140:143]
    v_exp_f32 v144, v160
    v_mfma_f32_16x16x32_bf16 v[156:159], v[116:119], v[180:183], v[172:175]
    v_rcp_f32 v136, v136
    v_cvt_pk_bf16_f32 v133, v134, v135
    s_add_u32 m0, s52, 4160
    s_waitcnt lgkmcnt(0)
    buffer_load_dwordx4 v[230:231], s[20:23], 0 idxen offen nt lds
    v_exp_f32 v145, v161
    buffer_load_dwordx4 v[232:233], s[40:43], 0 idxen offen offset:1056 nt lds
    v_rcp_f32 v137, v137
    v_exp_f32 v146, v162
    v_rcp_f32 v138, v138
    v_cvt_pk_bf16_f32 v134, v136, v137
    v_exp_f32 v147, v163
    v_mfma_f32_16x16x32_bf16 v[160:163], v[124:127], v[180:183], v[176:179]
    v_rcp_f32 v139, v139
    v_mfma_f32_4x4x4_16b_bf16 v[144:147], v[228:229], v[228:229], v[144:147]
    v_mfma_f32_16x16x32_bf16 v[156:159], v[120:123], v[184:187], v[156:159]
    v_rcp_f32 v140, v140
    v_mfma_f32_16x16x32_bf16 v[160:163], v[128:131], v[184:187], v[160:163]
    v_rcp_f32 v141, v141
    v_cvt_pk_bf16_f32 v135, v138, v139
    s_waitcnt vmcnt(4)
    ds_read_b128 v[180:183], v234 offset:0
    ds_read_b128 v[184:187], v235 offset:0
    v_rcp_f32 v142, v142
    v_cvt_pk_bf16_f32 v136, v140, v141
    v_mfma_f32_16x16x32_bf16 v[208:211], v[132:135], v[196:199], v[204:207]
    v_rcp_f32 v143, v143
    v_rcp_f32 v144, v144
    v_cvt_pk_bf16_f32 v137, v142, v143
    v_rcp_f32 v145, v145
    v_rcp_f32 v146, v146
    v_rcp_f32 v147, v147
    v_cvt_pk_bf16_f32 v138, v144, v145
    v_cvt_pk_bf16_f32 v139, v146, v147
    ds_read_u8 v230, v237 offset:112
    ds_read_u8 v232, v237 offset:120
    v_mfma_f32_16x16x32_bf16 v[208:211], v[136:139], v[200:203], v[208:211]
    s_bitcmp1_b32 s36, 3
    s_cbranch_scc1 Lf_ev3
Lf_evd3:
    v_exp_f32 v132, v148
    v_exp_f32 v133, v149
    v_exp_f32 v134, v150
    v_exp_f32 v135, v151
    v_exp_f32 v136, v152
    v_exp_f32 v137, v153
    v_mfma_f32_4x4x4_16b_bf16 v[132:135], v[228:229], v[228:229], v[132:135]
    v_cvt_pk_bf16_f32 v208, v208, v209
    v_cvt_pk_bf16_f32 v209, v210, v211
    s_waitcnt lgkmcnt(2)
    v_mfma_f32_16x16x32_bf16 v[148:151], v[100:103], v[180:183], v[164:167]
    v_exp_f32 v138, v154
    v_mfma_f32_4x4x4_16b_bf16 v[212:215], v[208:209], v[188:189], v[212:215] cbsz:4 abid:0
    ds_read_b64_tr_b16 v[188:189], v236 offset:6240
    v_exp_f32 v139, v155
    v_mfma_f32_16x16x32_bf16 v[152:155], v[108:111], v[180:183], v[168:171]
    v_exp_f32 v140, v156
    v_mfma_f32_4x4x4_16b_bf16 v[212:215], v[208:209], v[190:191], v[212:215] cbsz:4 abid:4
    ds_read_b64_tr_b16 v[190:191], v236 offset:6752
    v_mfma_f32_4x4x4_16b_bf16 v[136:139], v[228:229], v[228:229], v[136:139]
    v_rcp_f32 v132, v132
    v_mfma_f32_4x4x4_16b_bf16 v[212:215], v[208:209], v[192:193], v[212:215] cbsz:4 abid:8
    ds_read_b64_tr_b16 v[192:193], v236 offset:7296
    v_exp_f32 v141, v157
    v_mfma_f32_16x16x32_bf16 v[148:151], v[104:107], v[184:187], v[148:151]
    v_rcp_f32 v133, v133
    v_mfma_f32_4x4x4_16b_bf16 v[212:215], v[208:209], v[194:195], v[212:215] cbsz:4 abid:12
    ds_read_b64_tr_b16 v[194:195], v236 offset:7808
    v_exp_f32 v142, v158
    v_mfma_f32_16x16x32_bf16 v[152:155], v[112:115], v[184:187], v[152:155]
    v_rcp_f32 v134, v134
    v_exp_f32 v143, v159
    v_rcp_f32 v135, v135
    v_cvt_pk_bf16_f32 v132, v132, v133
    v_mfma_f32_4x4x4_16b_bf16 v[140:143], v[228:229], v[228:229], v[140:143]
    v_exp_f32 v144, v160
    v_mfma_f32_16x16x32_bf16 v[156:159], v[116:119], v[180:183], v[172:175]
    v_rcp_f32 v136, v136
    v_cvt_pk_bf16_f32 v133, v134, v135
    s_add_u32 m0, s52, 6240
    s_waitcnt lgkmcnt(0)
    buffer_load_dwordx4 v[230:231], s[20:23], 0 idxen offen nt lds
    v_exp_f32 v145, v161
    buffer_load_dwordx4 v[232:233], s[40:43], 0 idxen offen offset:1056 nt lds
    v_rcp_f32 v137, v137
    v_exp_f32 v146, v162
    v_rcp_f32 v138, v138
    v_cvt_pk_bf16_f32 v134, v136, v137
    v_exp_f32 v147, v163
    v_mfma_f32_16x16x32_bf16 v[160:163], v[124:127], v[180:183], v[176:179]
    v_rcp_f32 v139, v139
    v_mfma_f32_4x4x4_16b_bf16 v[144:147], v[228:229], v[228:229], v[144:147]
    v_mfma_f32_16x16x32_bf16 v[156:159], v[120:123], v[184:187], v[156:159]
    v_rcp_f32 v140, v140
    v_mfma_f32_16x16x32_bf16 v[160:163], v[128:131], v[184:187], v[160:163]
    v_rcp_f32 v141, v141
    v_cvt_pk_bf16_f32 v135, v138, v139
    s_waitcnt vmcnt(4)
    ds_read_b128 v[180:183], v234 offset:2080
    ds_read_b128 v[184:187], v235 offset:2080
    v_rcp_f32 v142, v142
    v_cvt_pk_bf16_f32 v136, v140, v141
    v_mfma_f32_16x16x32_bf16 v[208:211], v[132:135], v[196:199], v[204:207]
    v_rcp_f32 v143, v143
    s_lshr_b64 s[56:57], s[56:57], 4
    s_lshl_b64 s[86:87], s[58:59], 60
    s_or_b64 s[56:57], s[56:57], s[86:87]
    s_lshr_b64 s[58:59], s[58:59], 4
    s_lshr_b64 s[86:87], s[56:57], 2
    s_lshr_b64 s[36:37], s[56:57], 5
    s_or_b32 s36, s36, s86
    s_or_b32 s36, s36, s56
    v_add_u32 v237, 64, v237
    v_rcp_f32 v144, v144
    v_cvt_pk_bf16_f32 v137, v142, v143
    v_rcp_f32 v145, v145
    v_rcp_f32 v146, v146
    v_rcp_f32 v147, v147
    v_cvt_pk_bf16_f32 v138, v144, v145
    v_cvt_pk_bf16_f32 v139, v146, v147
    s_branch Lf_loop
Lf_ev0:
    s_bitcmp0_b64 s[56:57], 0
    s_cbranch_scc1 Lf_nf0
    v_cvt_pk_bf16_f32 v246, v212, v212
    v_mov_b32 v212, 0
    ds_write_b16 v240, v246
    v_add_u32 v240, 128, v240
Lf_nf0:
    s_bitcmp0_b64 s[56:57], 5
    s_cbranch_scc1 Lf_na0
    s_sub_u32 s60, s60, 1
    s_cselect_b32 s31, 0, s31
    s_add_u32 s20, s20, s31
    s_addc_u32 s21, s21, 0
    s_add_u32 s40, s40, s31
    s_addc_u32 s41, s41, 0
    s_xor_b32 s31, s31, 0x63ff800
Lf_na0:
    s_bitcmp0_b64 s[56:57], 2
    s_cbranch_scc1 Lf_evd0
    s_sub_u32 s61, s61, 1
    s_cbranch_scc1 Lf_last0
    v_mul_u32_u24 v216, v224, v241
    v_mul_u32_u24 v217, v224, v242
    v_mul_u32_u24 v218, v225, v241
    v_mul_u32_u24 v219, v225, v242
    v_mul_u32_u24 v220, v226, v241
    v_mul_u32_u24 v221, v226, v242
    v_mul_u32_u24 v222, v227, v241
    v_mul_u32_u24 v223, v227, v242
    v_add_u32 v238, 128, v238
    ds_read_b128 v[164:167], v239
    v_mfma_f32_4x4x4_16b_bf16 v[132:135], v[216:217], v[68:69], v[4:7]
    ds_read_b128 v[168:171], v239 offset:64
    ds_read_b128 v[172:175], v239 offset:128
    v_mfma_f32_4x4x4_16b_bf16 v[136:139], v[218:219], v[70:71], v[8:11]
    ds_read_b128 v[176:179], v239 offset:192
    ds_read_u16 v224, v238
    v_mfma_f32_4x4x4_16b_bf16 v[140:143], v[220:221], v[72:73], v[12:15]
    ds_read_u16 v225, v238 offset:8
    ds_read_u16 v226, v238 offset:64
    v_mfma_f32_4x4x4_16b_bf16 v[144:147], v[222:223], v[74:75], v[16:19]
    ds_read_u16 v227, v238 offset:72
    v_add_u32 v239, 272, v239
    v_mfma_f32_4x4x4_16b_bf16 v[246:249], v[216:217], v[76:77], v[20:23]
    v_cvt_pk_bf16_f32 v100, v132, v133
    v_cvt_pk_bf16_f32 v101, v134, v135
    v_mfma_f32_4x4x4_16b_bf16 v[250:253], v[218:219], v[78:79], v[24:27]
    v_cvt_pk_bf16_f32 v102, v136, v137
    v_cvt_pk_bf16_f32 v103, v138, v139
    v_mfma_f32_4x4x4_16b_bf16 v[132:135], v[220:221], v[80:81], v[28:31]
    v_cvt_pk_bf16_f32 v104, v140, v141
    v_cvt_pk_bf16_f32 v105, v142, v143
    v_mfma_f32_4x4x4_16b_bf16 v[136:139], v[222:223], v[82:83], v[32:35]
    v_cvt_pk_bf16_f32 v106, v144, v145
    v_cvt_pk_bf16_f32 v107, v146, v147
    v_mfma_f32_4x4x4_16b_bf16 v[140:143], v[216:217], v[84:85], v[36:39]
    v_cvt_pk_bf16_f32 v108, v246, v247
    v_cvt_pk_bf16_f32 v109, v248, v249
    v_mfma_f32_4x4x4_16b_bf16 v[144:147], v[218:219], v[86:87], v[40:43]
    v_cvt_pk_bf16_f32 v110, v250, v251
    v_cvt_pk_bf16_f32 v111, v252, v253
    v_mfma_f32_4x4x4_16b_bf16 v[246:249], v[220:221], v[88:89], v[44:47]
    v_cvt_pk_bf16_f32 v112, v132, v133
    v_cvt_pk_bf16_f32 v113, v134, v135
    v_mfma_f32_4x4x4_16b_bf16 v[250:253], v[222:223], v[90:91], v[48:51]
    v_cvt_pk_bf16_f32 v114, v136, v137
    v_cvt_pk_bf16_f32 v115, v138, v139
    v_mfma_f32_4x4x4_16b_bf16 v[132:135], v[216:217], v[92:93], v[52:55]
    v_cvt_pk_bf16_f32 v116, v140, v141
    v_cvt_pk_bf16_f32 v117, v142, v143
    v_mfma_f32_4x4x4_16b_bf16 v[136:139], v[218:219], v[94:95], v[56:59]
    v_cvt_pk_bf16_f32 v118, v144, v145
    v_cvt_pk_bf16_f32 v119, v146, v147
    v_mfma_f32_4x4x4_16b_bf16 v[140:143], v[220:221], v[96:97], v[60:63]
    v_cvt_pk_bf16_f32 v120, v246, v247
    v_cvt_pk_bf16_f32 v121, v248, v249
    v_mfma_f32_4x4x4_16b_bf16 v[144:147], v[222:223], v[98:99], v[64:67]
    v_cvt_pk_bf16_f32 v122, v250, v251
    v_cvt_pk_bf16_f32 v123, v252, v253
    v_cvt_pk_bf16_f32 v124, v132, v133
    v_cvt_pk_bf16_f32 v125, v134, v135
    v_cvt_pk_bf16_f32 v126, v136, v137
    v_cvt_pk_bf16_f32 v127, v138, v139
    v_cvt_pk_bf16_f32 v128, v140, v141
    v_cvt_pk_bf16_f32 v129, v142, v143
    v_cvt_pk_bf16_f32 v130, v144, v145
    v_cvt_pk_bf16_f32 v131, v146, v147
    s_waitcnt lgkmcnt(0)
    s_branch Lf_evd0
Lf_ev1:
    s_bitcmp0_b64 s[56:57], 1
    s_cbranch_scc1 Lf_nf1
    v_cvt_pk_bf16_f32 v246, v212, v212
    v_mov_b32 v212, 0
    ds_write_b16 v240, v246
    v_add_u32 v240, 128, v240
Lf_nf1:
    s_bitcmp0_b64 s[56:57], 6
    s_cbranch_scc1 Lf_na1
    s_sub_u32 s60, s60, 1
    s_cselect_b32 s31, 0, s31
    s_add_u32 s20, s20, s31
    s_addc_u32 s21, s21, 0
    s_add_u32 s40, s40, s31
    s_addc_u32 s41, s41, 0
    s_xor_b32 s31, s31, 0x63ff800
Lf_na1:
    s_bitcmp0_b64 s[56:57], 3
    s_cbranch_scc1 Lf_evd1
    s_sub_u32 s61, s61, 1
    s_cbranch_scc1 Lf_last1
    v_mul_u32_u24 v216, v224, v241
    v_mul_u32_u24 v217, v224, v242
    v_mul_u32_u24 v218, v225, v241
    v_mul_u32_u24 v219, v225, v242
    v_mul_u32_u24 v220, v226, v241
    v_mul_u32_u24 v221, v226, v242
    v_mul_u32_u24 v222, v227, v241
    v_mul_u32_u24 v223, v227, v242
    v_add_u32 v238, 128, v238
    ds_read_b128 v[164:167], v239
    v_mfma_f32_4x4x4_16b_bf16 v[132:135], v[216:217], v[68:69], v[4:7]
    ds_read_b128 v[168:171], v239 offset:64
    ds_read_b128 v[172:175], v239 offset:128
    v_mfma_f32_4x4x4_16b_bf16 v[136:139], v[218:219], v[70:71], v[8:11]
    ds_read_b128 v[176:179], v239 offset:192
    ds_read_u16 v224, v238
    v_mfma_f32_4x4x4_16b_bf16 v[140:143], v[220:221], v[72:73], v[12:15]
    ds_read_u16 v225, v238 offset:8
    ds_read_u16 v226, v238 offset:64
    v_mfma_f32_4x4x4_16b_bf16 v[144:147], v[222:223], v[74:75], v[16:19]
    ds_read_u16 v227, v238 offset:72
    v_add_u32 v239, 272, v239
    v_mfma_f32_4x4x4_16b_bf16 v[246:249], v[216:217], v[76:77], v[20:23]
    v_cvt_pk_bf16_f32 v100, v132, v133
    v_cvt_pk_bf16_f32 v101, v134, v135
    v_mfma_f32_4x4x4_16b_bf16 v[250:253], v[218:219], v[78:79], v[24:27]
    v_cvt_pk_bf16_f32 v102, v136, v137
    v_cvt_pk_bf16_f32 v103, v138, v139
    v_mfma_f32_4x4x4_16b_bf16 v[132:135], v[220:221], v[80:81], v[28:31]
    v_cvt_pk_bf16_f32 v104, v140, v141
    v_cvt_pk_bf16_f32 v105, v142, v143
    v_mfma_f32_4x4x4_16b_bf16 v[136:139], v[222:223], v[82:83], v[32:35]
    v_cvt_pk_bf16_f32 v106, v144, v145
    v_cvt_pk_bf16_f32 v107, v146, v147
    v_mfma_f32_4x4x4_16b_bf16 v[140:143], v[216:217], v[84:85], v[36:39]
    v_cvt_pk_bf16_f32 v108, v246, v247
    v_cvt_pk_bf16_f32 v109, v248, v249
    v_mfma_f32_4x4x4_16b_bf16 v[144:147], v[218:219], v[86:87], v[40:43]
    v_cvt_pk_bf16_f32 v110, v250, v251
    v_cvt_pk_bf16_f32 v111, v252, v253
    v_mfma_f32_4x4x4_16b_bf16 v[246:249], v[220:221], v[88:89], v[44:47]
    v_cvt_pk_bf16_f32 v112, v132, v133
    v_cvt_pk_bf16_f32 v113, v134, v135
    v_mfma_f32_4x4x4_16b_bf16 v[250:253], v[222:223], v[90:91], v[48:51]
    v_cvt_pk_bf16_f32 v114, v136, v137
    v_cvt_pk_bf16_f32 v115, v138, v139
    v_mfma_f32_4x4x4_16b_bf16 v[132:135], v[216:217], v[92:93], v[52:55]
    v_cvt_pk_bf16_f32 v116, v140, v141
    v_cvt_pk_bf16_f32 v117, v142, v143
    v_mfma_f32_4x4x4_16b_bf16 v[136:139], v[218:219], v[94:95], v[56:59]
    v_cvt_pk_bf16_f32 v118, v144, v145
    v_cvt_pk_bf16_f32 v119, v146, v147
    v_mfma_f32_4x4x4_16b_bf16 v[140:143], v[220:221], v[96:97], v[60:63]
    v_cvt_pk_bf16_f32 v120, v246, v247
    v_cvt_pk_bf16_f32 v121, v248, v249
    v_mfma_f32_4x4x4_16b_bf16 v[144:147], v[222:223], v[98:99], v[64:67]
    v_cvt_pk_bf16_f32 v122, v250, v251
    v_cvt_pk_bf16_f32 v123, v252, v253
    v_cvt_pk_bf16_f32 v124, v132, v133
    v_cvt_pk_bf16_f32 v125, v134, v135
    v_cvt_pk_bf16_f32 v126, v136, v137
    v_cvt_pk_bf16_f32 v127, v138, v139
    v_cvt_pk_bf16_f32 v128, v140, v141
    v_cvt_pk_bf16_f32 v129, v142, v143
    v_cvt_pk_bf16_f32 v130, v144, v145
    v_cvt_pk_bf16_f32 v131, v146, v147
    s_waitcnt lgkmcnt(0)
    s_branch Lf_evd1
Lf_ev2:
    s_bitcmp0_b64 s[56:57], 2
    s_cbranch_scc1 Lf_nf2
    v_cvt_pk_bf16_f32 v246, v212, v212
    v_mov_b32 v212, 0
    ds_write_b16 v240, v246
    v_add_u32 v240, 128, v240
Lf_nf2:
    s_bitcmp0_b64 s[56:57], 7
    s_cbranch_scc1 Lf_na2
    s_sub_u32 s60, s60, 1
    s_cselect_b32 s31, 0, s31
    s_add_u32 s20, s20, s31
    s_addc_u32 s21, s21, 0
    s_add_u32 s40, s40, s31
    s_addc_u32 s41, s41, 0
    s_xor_b32 s31, s31, 0x63ff800
Lf_na2:
    s_bitcmp0_b64 s[56:57], 4
    s_cbranch_scc1 Lf_evd2
    s_sub_u32 s61, s61, 1
    s_cbranch_scc1 Lf_last2
    v_mul_u32_u24 v216, v224, v241
    v_mul_u32_u24 v217, v224, v242
    v_mul_u32_u24 v218, v225, v241
    v_mul_u32_u24 v219, v225, v242
    v_mul_u32_u24 v220, v226, v241
    v_mul_u32_u24 v221, v226, v242
    v_mul_u32_u24 v222, v227, v241
    v_mul_u32_u24 v223, v227, v242
    v_add_u32 v238, 128, v238
    ds_read_b128 v[164:167], v239
    v_mfma_f32_4x4x4_16b_bf16 v[132:135], v[216:217], v[68:69], v[4:7]
    ds_read_b128 v[168:171], v239 offset:64
    ds_read_b128 v[172:175], v239 offset:128
    v_mfma_f32_4x4x4_16b_bf16 v[136:139], v[218:219], v[70:71], v[8:11]
    ds_read_b128 v[176:179], v239 offset:192
    ds_read_u16 v224, v238
    v_mfma_f32_4x4x4_16b_bf16 v[140:143], v[220:221], v[72:73], v[12:15]
    ds_read_u16 v225, v238 offset:8
    ds_read_u16 v226, v238 offset:64
    v_mfma_f32_4x4x4_16b_bf16 v[144:147], v[222:223], v[74:75], v[16:19]
    ds_read_u16 v227, v238 offset:72
    v_add_u32 v239, 272, v239
    v_mfma_f32_4x4x4_16b_bf16 v[246:249], v[216:217], v[76:77], v[20:23]
    v_cvt_pk_bf16_f32 v100, v132, v133
    v_cvt_pk_bf16_f32 v101, v134, v135
    v_mfma_f32_4x4x4_16b_bf16 v[250:253], v[218:219], v[78:79], v[24:27]
    v_cvt_pk_bf16_f32 v102, v136, v137
    v_cvt_pk_bf16_f32 v103, v138, v139
    v_mfma_f32_4x4x4_16b_bf16 v[132:135], v[220:221], v[80:81], v[28:31]
    v_cvt_pk_bf16_f32 v104, v140, v141
    v_cvt_pk_bf16_f32 v105, v142, v143
    v_mfma_f32_4x4x4_16b_bf16 v[136:139], v[222:223], v[82:83], v[32:35]
    v_cvt_pk_bf16_f32 v106, v144, v145
    v_cvt_pk_bf16_f32 v107, v146, v147
    v_mfma_f32_4x4x4_16b_bf16 v[140:143], v[216:217], v[84:85], v[36:39]
    v_cvt_pk_bf16_f32 v108, v246, v247
    v_cvt_pk_bf16_f32 v109, v248, v249
    v_mfma_f32_4x4x4_16b_bf16 v[144:147], v[218:219], v[86:87], v[40:43]
    v_cvt_pk_bf16_f32 v110, v250, v251
    v_cvt_pk_bf16_f32 v111, v252, v253
    v_mfma_f32_4x4x4_16b_bf16 v[246:249], v[220:221], v[88:89], v[44:47]
    v_cvt_pk_bf16_f32 v112, v132, v133
    v_cvt_pk_bf16_f32 v113, v134, v135
    v_mfma_f32_4x4x4_16b_bf16 v[250:253], v[222:223], v[90:91], v[48:51]
    v_cvt_pk_bf16_f32 v114, v136, v137
    v_cvt_pk_bf16_f32 v115, v138, v139
    v_mfma_f32_4x4x4_16b_bf16 v[132:135], v[216:217], v[92:93], v[52:55]
    v_cvt_pk_bf16_f32 v116, v140, v141
    v_cvt_pk_bf16_f32 v117, v142, v143
    v_mfma_f32_4x4x4_16b_bf16 v[136:139], v[218:219], v[94:95], v[56:59]
    v_cvt_pk_bf16_f32 v118, v144, v145
    v_cvt_pk_bf16_f32 v119, v146, v147
    v_mfma_f32_4x4x4_16b_bf16 v[140:143], v[220:221], v[96:97], v[60:63]
    v_cvt_pk_bf16_f32 v120, v246, v247
    v_cvt_pk_bf16_f32 v121, v248, v249
    v_mfma_f32_4x4x4_16b_bf16 v[144:147], v[222:223], v[98:99], v[64:67]
    v_cvt_pk_bf16_f32 v122, v250, v251
    v_cvt_pk_bf16_f32 v123, v252, v253
    v_cvt_pk_bf16_f32 v124, v132, v133
    v_cvt_pk_bf16_f32 v125, v134, v135
    v_cvt_pk_bf16_f32 v126, v136, v137
    v_cvt_pk_bf16_f32 v127, v138, v139
    v_cvt_pk_bf16_f32 v128, v140, v141
    v_cvt_pk_bf16_f32 v129, v142, v143
    v_cvt_pk_bf16_f32 v130, v144, v145
    v_cvt_pk_bf16_f32 v131, v146, v147
    s_waitcnt lgkmcnt(0)
    s_branch Lf_evd2
Lf_ev3:
    s_bitcmp0_b64 s[56:57], 3
    s_cbranch_scc1 Lf_nf3
    v_cvt_pk_bf16_f32 v246, v212, v212
    v_mov_b32 v212, 0
    ds_write_b16 v240, v246
    v_add_u32 v240, 128, v240
Lf_nf3:
    s_bitcmp0_b64 s[56:57], 8
    s_cbranch_scc1 Lf_na3
    s_sub_u32 s60, s60, 1
    s_cselect_b32 s31, 0, s31
    s_add_u32 s20, s20, s31
    s_addc_u32 s21, s21, 0
    s_add_u32 s40, s40, s31
    s_addc_u32 s41, s41, 0
    s_xor_b32 s31, s31, 0x63ff800
Lf_na3:
    s_bitcmp0_b64 s[56:57], 5
    s_cbranch_scc1 Lf_evd3
    s_sub_u32 s61, s61, 1
    s_cbranch_scc1 Lf_last3
    v_mul_u32_u24 v216, v224, v241
    v_mul_u32_u24 v217, v224, v242
    v_mul_u32_u24 v218, v225, v241
    v_mul_u32_u24 v219, v225, v242
    v_mul_u32_u24 v220, v226, v241
    v_mul_u32_u24 v221, v226, v242
    v_mul_u32_u24 v222, v227, v241
    v_mul_u32_u24 v223, v227, v242
    v_add_u32 v238, 128, v238
    ds_read_b128 v[164:167], v239
    v_mfma_f32_4x4x4_16b_bf16 v[132:135], v[216:217], v[68:69], v[4:7]
    ds_read_b128 v[168:171], v239 offset:64
    ds_read_b128 v[172:175], v239 offset:128
    v_mfma_f32_4x4x4_16b_bf16 v[136:139], v[218:219], v[70:71], v[8:11]
    ds_read_b128 v[176:179], v239 offset:192
    ds_read_u16 v224, v238
    v_mfma_f32_4x4x4_16b_bf16 v[140:143], v[220:221], v[72:73], v[12:15]
    ds_read_u16 v225, v238 offset:8
    ds_read_u16 v226, v238 offset:64
    v_mfma_f32_4x4x4_16b_bf16 v[144:147], v[222:223], v[74:75], v[16:19]
    ds_read_u16 v227, v238 offset:72
    v_add_u32 v239, 272, v239
    v_mfma_f32_4x4x4_16b_bf16 v[246:249], v[216:217], v[76:77], v[20:23]
    v_cvt_pk_bf16_f32 v100, v132, v133
    v_cvt_pk_bf16_f32 v101, v134, v135
    v_mfma_f32_4x4x4_16b_bf16 v[250:253], v[218:219], v[78:79], v[24:27]
    v_cvt_pk_bf16_f32 v102, v136, v137
    v_cvt_pk_bf16_f32 v103, v138, v139
    v_mfma_f32_4x4x4_16b_bf16 v[132:135], v[220:221], v[80:81], v[28:31]
    v_cvt_pk_bf16_f32 v104, v140, v141
    v_cvt_pk_bf16_f32 v105, v142, v143
    v_mfma_f32_4x4x4_16b_bf16 v[136:139], v[222:223], v[82:83], v[32:35]
    v_cvt_pk_bf16_f32 v106, v144, v145
    v_cvt_pk_bf16_f32 v107, v146, v147
    v_mfma_f32_4x4x4_16b_bf16 v[140:143], v[216:217], v[84:85], v[36:39]
    v_cvt_pk_bf16_f32 v108, v246, v247
    v_cvt_pk_bf16_f32 v109, v248, v249
    v_mfma_f32_4x4x4_16b_bf16 v[144:147], v[218:219], v[86:87], v[40:43]
    v_cvt_pk_bf16_f32 v110, v250, v251
    v_cvt_pk_bf16_f32 v111, v252, v253
    v_mfma_f32_4x4x4_16b_bf16 v[246:249], v[220:221], v[88:89], v[44:47]
    v_cvt_pk_bf16_f32 v112, v132, v133
    v_cvt_pk_bf16_f32 v113, v134, v135
    v_mfma_f32_4x4x4_16b_bf16 v[250:253], v[222:223], v[90:91], v[48:51]
    v_cvt_pk_bf16_f32 v114, v136, v137
    v_cvt_pk_bf16_f32 v115, v138, v139
    v_mfma_f32_4x4x4_16b_bf16 v[132:135], v[216:217], v[92:93], v[52:55]
    v_cvt_pk_bf16_f32 v116, v140, v141
    v_cvt_pk_bf16_f32 v117, v142, v143
    v_mfma_f32_4x4x4_16b_bf16 v[136:139], v[218:219], v[94:95], v[56:59]
    v_cvt_pk_bf16_f32 v118, v144, v145
    v_cvt_pk_bf16_f32 v119, v146, v147
    v_mfma_f32_4x4x4_16b_bf16 v[140:143], v[220:221], v[96:97], v[60:63]
    v_cvt_pk_bf16_f32 v120, v246, v247
    v_cvt_pk_bf16_f32 v121, v248, v249
    v_mfma_f32_4x4x4_16b_bf16 v[144:147], v[222:223], v[98:99], v[64:67]
    v_cvt_pk_bf16_f32 v122, v250, v251
    v_cvt_pk_bf16_f32 v123, v252, v253
    v_cvt_pk_bf16_f32 v124, v132, v133
    v_cvt_pk_bf16_f32 v125, v134, v135
    v_cvt_pk_bf16_f32 v126, v136, v137
    v_cvt_pk_bf16_f32 v127, v138, v139
    v_cvt_pk_bf16_f32 v128, v140, v141
    v_cvt_pk_bf16_f32 v129, v142, v143
    v_cvt_pk_bf16_f32 v130, v144, v145
    v_cvt_pk_bf16_f32 v131, v146, v147
    s_waitcnt lgkmcnt(0)
    s_branch Lf_evd3
Lf_last0:
    s_branch Lf_tail
Lf_last1:
    v_add_u32 v236, 2080, v236
    s_lshr_b64 s[56:57], s[56:57], 1
    s_branch Lf_tail
Lf_last2:
    v_add_u32 v236, 4160, v236
    s_lshr_b64 s[56:57], s[56:57], 2
    s_branch Lf_tail
Lf_last3:
    v_add_u32 v236, 6240, v236
    s_lshr_b64 s[56:57], s[56:57], 3
Lf_tail:
    v_exp_f32 v132, v148
    v_exp_f32 v133, v149
    v_exp_f32 v134, v150
    v_exp_f32 v135, v151
    v_exp_f32 v136, v152
    v_exp_f32 v137, v153
    v_mfma_f32_4x4x4_16b_bf16 v[132:135], v[228:229], v[228:229], v[132:135]
    v_cvt_pk_bf16_f32 v208, v208, v209
    v_cvt_pk_bf16_f32 v209, v210, v211
    v_exp_f32 v138, v154
    s_nop 0
    v_mfma_f32_4x4x4_16b_bf16 v[212:215], v[208:209], v[188:189], v[212:215] cbsz:4 abid:0
    ds_read_b64_tr_b16 v[188:189], v236 offset:0
    v_exp_f32 v139, v155
    v_exp_f32 v140, v156
    v_mfma_f32_4x4x4_16b_bf16 v[212:215], v[208:209], v[190:191], v[212:215] cbsz:4 abid:4
    ds_read_b64_tr_b16 v[190:191], v236 offset:512
    v_mfma_f32_4x4x4_16b_bf16 v[136:139], v[228:229], v[228:229], v[136:139]
    v_rcp_f32 v132, v132
    v_mfma_f32_4x4x4_16b_bf16 v[212:215], v[208:209], v[192:193], v[212:215] cbsz:4 abid:8
    ds_read_b64_tr_b16 v[192:193], v236 offset:1056
    v_exp_f32 v141, v157
    v_rcp_f32 v133, v133
    v_mfma_f32_4x4x4_16b_bf16 v[212:215], v[208:209], v[194:195], v[212:215] cbsz:4 abid:12
    ds_read_b64_tr_b16 v[194:195], v236 offset:1568
    v_exp_f32 v142, v158
    v_rcp_f32 v134, v134
    v_exp_f32 v143, v159
    v_rcp_f32 v135, v135
    v_cvt_pk_bf16_f32 v132, v132, v133
    v_mfma_f32_4x4x4_16b_bf16 v[140:143], v[228:229], v[228:229], v[140:143]
    v_exp_f32 v144, v160
    v_rcp_f32 v136, v136
    v_cvt_pk_bf16_f32 v133, v134, v135
    s_bitcmp0_b64 s[56:57], 1
    s_cbranch_scc1 Lf_tnf
    v_cvt_pk_bf16_f32 v246, v212, v212
    v_mov_b32 v212, 0
    ds_write_b16 v240, v246
    v_add_u32 v240, 128, v240
Lf_tnf:
    s_waitcnt lgkmcnt(0)
    v_exp_f32 v145, v161
    v_rcp_f32 v137, v137
    v_exp_f32 v146, v162
    v_rcp_f32 v138, v138
    v_cvt_pk_bf16_f32 v134, v136, v137
    v_exp_f32 v147, v163
    v_rcp_f32 v139, v139
    s_nop 0
    v_mfma_f32_4x4x4_16b_bf16 v[144:147], v[228:229], v[228:229], v[144:147]
    v_rcp_f32 v140, v140
    v_rcp_f32 v141, v141
    v_cvt_pk_bf16_f32 v135, v138, v139
    v_rcp_f32 v142, v142
    v_cvt_pk_bf16_f32 v136, v140, v141
    v_mfma_f32_16x16x32_bf16 v[208:211], v[132:135], v[196:199], v[204:207]
    v_rcp_f32 v143, v143
    v_rcp_f32 v144, v144
    v_cvt_pk_bf16_f32 v137, v142, v143
    v_rcp_f32 v145, v145
    v_rcp_f32 v146, v146
    v_rcp_f32 v147, v147
    v_cvt_pk_bf16_f32 v138, v144, v145
    v_cvt_pk_bf16_f32 v139, v146, v147
    s_nop 1
    v_mfma_f32_16x16x32_bf16 v[208:211], v[136:139], v[200:203], v[208:211]
    s_nop 7
    v_cvt_pk_bf16_f32 v208, v208, v209
    v_cvt_pk_bf16_f32 v209, v210, v211
    s_nop 1
    v_mfma_f32_4x4x4_16b_bf16 v[212:215], v[208:209], v[188:189], v[212:215] cbsz:4 abid:0
    s_nop 1
    v_mfma_f32_4x4x4_16b_bf16 v[212:215], v[208:209], v[190:191], v[212:215] cbsz:4 abid:4
    s_nop 1
    v_mfma_f32_4x4x4_16b_bf16 v[212:215], v[208:209], v[192:193], v[212:215] cbsz:4 abid:8
    s_nop 1
    v_mfma_f32_4x4x4_16b_bf16 v[212:215], v[208:209], v[194:195], v[212:215] cbsz:4 abid:12
    s_nop 4
    v_cvt_pk_bf16_f32 v246, v212, v212
    ds_write_b16 v240, v246
L_store:
    s_add_u32 s66, s52, 8320
    v_lshl_add_u32 v247, v0, 4, s66
    ds_read_b128 v[148:151], v247
    s_waitcnt lgkmcnt(0)
    global_store_dwordx4 v243, v[148:151], s[18:19] sc0 sc1
L_end:
    s_endpgm
L_general:
    s_waitcnt vmcnt(0)
    ds_read_b128 v[44:47], v246 offset:20480
    ds_read_b128 v[48:51], v246 offset:21504
    ds_read_b128 v[88:91], v246 offset:22528
    ds_read_b128 v[52:55], v246 offset:40960
    ds_read_b128 v[56:59], v246 offset:41984
    ds_read_b128 v[92:95], v246 offset:43008
    ds_read_b128 v[60:63], v246 offset:61440
    ds_read_b128 v[64:67], v246 offset:62464
    ds_read_b128 v[96:99], v246 offset:63488
    ds_read_u16 v224, v238 offset:0
    ds_read_u16 v225, v238 offset:8
    ds_read_u16 v226, v238 offset:64
    ds_read_u16 v227, v238 offset:72
    s_mov_b32 s20, s6
    s_and_b32 s21, s7, 0xffff
    s_or_b32 s21, s21, 0x800000
    s_mov_b32 s22, 200
    s_mov_b32 s23, 0x20000
    s_sub_u32 s40, s20, 1056
    s_subb_u32 s41, s21, 0
    s_mov_b32 s42, 200
    s_mov_b32 s43, 0x20000
    s_movk_i32 s31, 25600
    s_mov_b32 s60, 7
    s_mov_b64 s[56:57], 0
    s_mov_b64 s[58:59], 0
    v_mov_b32 v148, -1
    v_mov_b32 v149, -1
    v_mov_b32 v150, -1
    v_mov_b32 v151, -1
    s_add_u32 s66, s52, 18432
    v_add_u32 v152, s66, v2
    ds_write_b128 v152, v[148:151]
    ds_write_b128 v152, v[148:151] offset:1024
    s_add_u32 s64, s52, 18448
    s_bfm_b64 s[28:29], 50, 0
    s_mul_i32 s66, s53, 800
    v_add_u32 v247, s66, v2
    s_mov_b64 exec, s[28:29]
    global_load_dwordx4 v[100:103], v247, s[8:9]
    v_add_u32 v247, 1638400, v247
    global_load_dwordx4 v[104:107], v247, s[8:9]
    v_add_u32 v247, 1638400, v247
    global_load_dwordx4 v[108:111], v247, s[8:9]
    v_add_u32 v247, 1638400, v247
    global_load_dwordx4 v[112:115], v247, s[8:9]
    v_add_u32 v247, 1638400, v247
    s_mov_b64 exec, -1
    v_cmp_lt_u32 vcc, 24, v0
    s_nop 1
    v_cndmask_b32 v145, 0, 1, vcc
    v_mul_u32_u24 v142, 25, v145
    v_sub_u32 v142, v0, v142
    v_mul_u32_u24 v142, 0x80008, v142
    v_add_u32 v141, 0x10000, v142
    v_add_u32 v143, 0x50004, v142
    v_add_u32 v144, 0x70006, v142
    v_add_u32 v142, 0x30002, v142
    s_waitcnt vmcnt(0)
    s_mov_b64 exec, s[28:29]
    v_cmp_neq_f16_sdwa s[68:69], v100, 0 src0_sel:WORD_0 src1_sel:WORD_0
    v_cmp_neq_f16_sdwa s[70:71], v100, 0 src0_sel:WORD_1 src1_sel:WORD_0
    v_cmp_neq_f16_sdwa s[72:73], v101, 0 src0_sel:WORD_0 src1_sel:WORD_0
    v_cmp_neq_f16_sdwa s[74:75], v101, 0 src0_sel:WORD_1 src1_sel:WORD_0
    v_cmp_neq_f16_sdwa s[76:77], v102, 0 src0_sel:WORD_0 src1_sel:WORD_0
    v_cmp_neq_f16_sdwa s[78:79], v102, 0 src0_sel:WORD_1 src1_sel:WORD_0
    v_cmp_neq_f16_sdwa s[80:81], v103, 0 src0_sel:WORD_0 src1_sel:WORD_0
    v_cmp_neq_f16_sdwa s[82:83], v103, 0 src0_sel:WORD_1 src1_sel:WORD_0
    s_mov_b64 exec, -1
    v_mov_b32 v132, s64
    v_mbcnt_lo_u32_b32 v132, s68, v132
    v_mbcnt_hi_u32_b32 v132, s69, v132
    v_mbcnt_lo_u32_b32 v132, s70, v132
    v_mbcnt_hi_u32_b32 v132, s71, v132
    v_mbcnt_lo_u32_b32 v132, s72, v132
    v_mbcnt_hi_u32_b32 v132, s73, v132
    v_mbcnt_lo_u32_b32 v132, s74, v132
    v_mbcnt_hi_u32_b32 v132, s75, v132
    v_mbcnt_lo_u32_b32 v132, s76, v132
    v_mbcnt_hi_u32_b32 v132, s77, v132
    v_mbcnt_lo_u32_b32 v132, s78, v132
    v_mbcnt_hi_u32_b32 v132, s79, v132
    v_mbcnt_lo_u32_b32 v132, s80, v132
    v_mbcnt_hi_u32_b32 v132, s81, v132
    v_mbcnt_lo_u32_b32 v132, s82, v132
    v_mbcnt_hi_u32_b32 v132, s83, v132
    s_add_u32 s55, s64, 16
    v_readlane_b32 s66, v132, 25
    v_readlane_b32 s67, v132, 63
    s_add_u32 s64, s66, 15
    s_and_b32 s64, s64, -16
    s_max_u32 s64, s64, s55
    s_sub_u32 s66, s64, s66
    v_mad_u32_u24 v132, v145, s66, v132
    s_lshr_b32 s95, s64, 4
    s_bitset1_b64 s[56:57], s95
    v_addc_co_u32 v133, vcc, 0, v132, s[68:69]
    v_addc_co_u32 v134, vcc, 0, v133, s[70:71]
    v_addc_co_u32 v135, vcc, 0, v134, s[72:73]
    v_addc_co_u32 v136, vcc, 0, v135, s[74:75]
    v_addc_co_u32 v137, vcc, 0, v136, s[76:77]
    v_addc_co_u32 v138, vcc, 0, v137, s[78:79]
    v_addc_co_u32 v139, vcc, 0, v138, s[80:81]
    s_add_u32 s67, s67, s66
    s_add_u32 s67, s67, 15
    s_and_b32 s67, s67, -16
    s_add_u32 s64, s64, 16
    s_max_u32 s64, s64, s67
    s_mov_b64 exec, s[68:69]
    ds_write_b8 v132, v141
    s_mov_b64 exec, s[70:71]
    ds_write_b8_d16_hi v133, v141
    s_mov_b64 exec, s[72:73]
    ds_write_b8 v134, v142
    s_mov_b64 exec, s[74:75]
    ds_write_b8_d16_hi v135, v142
    s_mov_b64 exec, s[76:77]
    ds_write_b8 v136, v143
    s_mov_b64 exec, s[78:79]
    ds_write_b8_d16_hi v137, v143
    s_mov_b64 exec, s[80:81]
    ds_write_b8 v138, v144
    s_mov_b64 exec, s[82:83]
    ds_write_b8_d16_hi v139, v144
    s_mov_b64 exec, -1
    s_lshr_b32 s95, s64, 4
    s_bitset1_b64 s[56:57], s95
    s_mov_b64 exec, s[28:29]
    v_cmp_neq_f16_sdwa s[68:69], v104, 0 src0_sel:WORD_0 src1_sel:WORD_0
    v_cmp_neq_f16_sdwa s[70:71], v104, 0 src0_sel:WORD_1 src1_sel:WORD_0
    v_cmp_neq_f16_sdwa s[72:73], v105, 0 src0_sel:WORD_0 src1_sel:WORD_0
    v_cmp_neq_f16_sdwa s[74:75], v105, 0 src0_sel:WORD_1 src1_sel:WORD_0
    v_cmp_neq_f16_sdwa s[76:77], v106, 0 src0_sel:WORD_0 src1_sel:WORD_0
    v_cmp_neq_f16_sdwa s[78:79], v106, 0 src0_sel:WORD_1 src1_sel:WORD_0
    v_cmp_neq_f16_sdwa s[80:81], v107, 0 src0_sel:WORD_0 src1_sel:WORD_0
    v_cmp_neq_f16_sdwa s[82:83], v107, 0 src0_sel:WORD_1 src1_sel:WORD_0
    s_mov_b64 exec, -1
    v_mov_b32 v132, s64
    v_mbcnt_lo_u32_b32 v132, s68, v132
    v_mbcnt_hi_u32_b32 v132, s69, v132
    v_mbcnt_lo_u32_b32 v132, s70, v132
    v_mbcnt_hi_u32_b32 v132, s71, v132
    v_mbcnt_lo_u32_b32 v132, s72, v132
    v_mbcnt_hi_u32_b32 v132, s73, v132
    v_mbcnt_lo_u32_b32 v132, s74, v132
    v_mbcnt_hi_u32_b32 v132, s75, v132
    v_mbcnt_lo_u32_b32 v132, s76, v132
    v_mbcnt_hi_u32_b32 v132, s77, v132
    v_mbcnt_lo_u32_b32 v132, s78, v132
    v_mbcnt_hi_u32_b32 v132, s79, v132
    v_mbcnt_lo_u32_b32 v132, s80, v132
    v_mbcnt_hi_u32_b32 v132, s81, v132
    v_mbcnt_lo_u32_b32 v132, s82, v132
    v_mbcnt_hi_u32_b32 v132, s83, v132
    s_add_u32 s55, s64, 16
    v_readlane_b32 s66, v132, 25
    v_readlane_b32 s67, v132, 63
    s_add_u32 s64, s66, 15
    s_and_b32 s64, s64, -16
    s_max_u32 s64, s64, s55
    s_sub_u32 s66, s64, s66
    v_mad_u32_u24 v132, v145, s66, v132
    s_lshr_b32 s95, s64, 4
    s_bitset1_b64 s[56:57], s95
    v_addc_co_u32 v133, vcc, 0, v132, s[68:69]
    v_addc_co_u32 v134, vcc, 0, v133, s[70:71]
    v_addc_co_u32 v135, vcc, 0, v134, s[72:73]
    v_addc_co_u32 v136, vcc, 0, v135, s[74:75]
    v_addc_co_u32 v137, vcc, 0, v136, s[76:77]
    v_addc_co_u32 v138, vcc, 0, v137, s[78:79]
    v_addc_co_u32 v139, vcc, 0, v138, s[80:81]
    s_add_u32 s67, s67, s66
    s_add_u32 s67, s67, 15
    s_and_b32 s67, s67, -16
    s_add_u32 s64, s64, 16
    s_max_u32 s64, s64, s67
    s_mov_b64 exec, s[68:69]
    ds_write_b8 v132, v141
    s_mov_b64 exec, s[70:71]
    ds_write_b8_d16_hi v133, v141
    s_mov_b64 exec, s[72:73]
    ds_write_b8 v134, v142
    s_mov_b64 exec, s[74:75]
    ds_write_b8_d16_hi v135, v142
    s_mov_b64 exec, s[76:77]
    ds_write_b8 v136, v143
    s_mov_b64 exec, s[78:79]
    ds_write_b8_d16_hi v137, v143
    s_mov_b64 exec, s[80:81]
    ds_write_b8 v138, v144
    s_mov_b64 exec, s[82:83]
    ds_write_b8_d16_hi v139, v144
    s_mov_b64 exec, -1
    s_lshr_b32 s95, s64, 4
    s_bitset1_b64 s[56:57], s95
    s_mov_b64 exec, s[28:29]
    v_cmp_neq_f16_sdwa s[68:69], v108, 0 src0_sel:WORD_0 src1_sel:WORD_0
    v_cmp_neq_f16_sdwa s[70:71], v108, 0 src0_sel:WORD_1 src1_sel:WORD_0
    v_cmp_neq_f16_sdwa s[72:73], v109, 0 src0_sel:WORD_0 src1_sel:WORD_0
    v_cmp_neq_f16_sdwa s[74:75], v109, 0 src0_sel:WORD_1 src1_sel:WORD_0
    v_cmp_neq_f16_sdwa s[76:77], v110, 0 src0_sel:WORD_0 src1_sel:WORD_0
    v_cmp_neq_f16_sdwa s[78:79], v110, 0 src0_sel:WORD_1 src1_sel:WORD_0
    v_cmp_neq_f16_sdwa s[80:81], v111, 0 src0_sel:WORD_0 src1_sel:WORD_0
    v_cmp_neq_f16_sdwa s[82:83], v111, 0 src0_sel:WORD_1 src1_sel:WORD_0
    s_mov_b64 exec, -1
    v_mov_b32 v132, s64
    v_mbcnt_lo_u32_b32 v132, s68, v132
    v_mbcnt_hi_u32_b32 v132, s69, v132
    v_mbcnt_lo_u32_b32 v132, s70, v132
    v_mbcnt_hi_u32_b32 v132, s71, v132
    v_mbcnt_lo_u32_b32 v132, s72, v132
    v_mbcnt_hi_u32_b32 v132, s73, v132
    v_mbcnt_lo_u32_b32 v132, s74, v132
    v_mbcnt_hi_u32_b32 v132, s75, v132
    v_mbcnt_lo_u32_b32 v132, s76, v132
    v_mbcnt_hi_u32_b32 v132, s77, v132
    v_mbcnt_lo_u32_b32 v132, s78, v132
    v_mbcnt_hi_u32_b32 v132, s79, v132
    v_mbcnt_lo_u32_b32 v132, s80, v132
    v_mbcnt_hi_u32_b32 v132, s81, v132
    v_mbcnt_lo_u32_b32 v132, s82, v132
    v_mbcnt_hi_u32_b32 v132, s83, v132
    s_add_u32 s55, s64, 16
    v_readlane_b32 s66, v132, 25
    v_readlane_b32 s67, v132, 63
    s_add_u32 s64, s66, 15
    s_and_b32 s64, s64, -16
    s_max_u32 s64, s64, s55
    s_sub_u32 s66, s64, s66
    v_mad_u32_u24 v132, v145, s66, v132
    s_lshr_b32 s95, s64, 4
    s_lshl_b64 s[86:87], 1, s95
    s_bitcmp1_b32 s64, 10
    s_cselect_b64 s[88:89], 0, s[86:87]
    s_cselect_b64 s[90:91], s[86:87], 0
    s_or_b64 s[56:57], s[56:57], s[88:89]
    s_or_b64 s[58:59], s[58:59], s[90:91]
    v_addc_co_u32 v133, vcc, 0, v132, s[68:69]
    v_addc_co_u32 v134, vcc, 0, v133, s[70:71]
    v_addc_co_u32 v135, vcc, 0, v134, s[72:73]
    v_addc_co_u32 v136, vcc, 0, v135, s[74:75]
    v_addc_co_u32 v137, vcc, 0, v136, s[76:77]
    v_addc_co_u32 v138, vcc, 0, v137, s[78:79]
    v_addc_co_u32 v139, vcc, 0, v138, s[80:81]
    s_add_u32 s67, s67, s66
    s_add_u32 s67, s67, 15
    s_and_b32 s67, s67, -16
    s_add_u32 s64, s64, 16
    s_max_u32 s64, s64, s67
    s_mov_b64 exec, s[68:69]
    ds_write_b8 v132, v141
    s_mov_b64 exec, s[70:71]
    ds_write_b8_d16_hi v133, v141
    s_mov_b64 exec, s[72:73]
    ds_write_b8 v134, v142
    s_mov_b64 exec, s[74:75]
    ds_write_b8_d16_hi v135, v142
    s_mov_b64 exec, s[76:77]
    ds_write_b8 v136, v143
    s_mov_b64 exec, s[78:79]
    ds_write_b8_d16_hi v137, v143
    s_mov_b64 exec, s[80:81]
    ds_write_b8 v138, v144
    s_mov_b64 exec, s[82:83]
    ds_write_b8_d16_hi v139, v144
    s_mov_b64 exec, -1
    s_lshr_b32 s95, s64, 4
    s_lshl_b64 s[86:87], 1, s95
    s_bitcmp1_b32 s64, 10
    s_cselect_b64 s[88:89], 0, s[86:87]
    s_cselect_b64 s[90:91], s[86:87], 0
    s_or_b64 s[56:57], s[56:57], s[88:89]
    s_or_b64 s[58:59], s[58:59], s[90:91]
    s_mov_b64 exec, s[28:29]
    v_cmp_neq_f16_sdwa s[68:69], v112, 0 src0_sel:WORD_0 src1_sel:WORD_0
    v_cmp_neq_f16_sdwa s[70:71], v112, 0 src0_sel:WORD_1 src1_sel:WORD_0
    v_cmp_neq_f16_sdwa s[72:73], v113, 0 src0_sel:WORD_0 src1_sel:WORD_0
    v_cmp_neq_f16_sdwa s[74:75], v113, 0 src0_sel:WORD_1 src1_sel:WORD_0
    v_cmp_neq_f16_sdwa s[76:77], v114, 0 src0_sel:WORD_0 src1_sel:WORD_0
    v_cmp_neq_f16_sdwa s[78:79], v114, 0 src0_sel:WORD_1 src1_sel:WORD_0
    v_cmp_neq_f16_sdwa s[80:81], v115, 0 src0_sel:WORD_0 src1_sel:WORD_0
    v_cmp_neq_f16_sdwa s[82:83], v115, 0 src0_sel:WORD_1 src1_sel:WORD_0
    s_mov_b64 exec, -1
    v_mov_b32 v132, s64
    v_mbcnt_lo_u32_b32 v132, s68, v132
    v_mbcnt_hi_u32_b32 v132, s69, v132
    v_mbcnt_lo_u32_b32 v132, s70, v132
    v_mbcnt_hi_u32_b32 v132, s71, v132
    v_mbcnt_lo_u32_b32 v132, s72, v132
    v_mbcnt_hi_u32_b32 v132, s73, v132
    v_mbcnt_lo_u32_b32 v132, s74, v132
    v_mbcnt_hi_u32_b32 v132, s75, v132
    v_mbcnt_lo_u32_b32 v132, s76, v132
    v_mbcnt_hi_u32_b32 v132, s77, v132
    v_mbcnt_lo_u32_b32 v132, s78, v132
    v_mbcnt_hi_u32_b32 v132, s79, v132
    v_mbcnt_lo_u32_b32 v132, s80, v132
    v_mbcnt_hi_u32_b32 v132, s81, v132
    v_mbcnt_lo_u32_b32 v132, s82, v132
    v_mbcnt_hi_u32_b32 v132, s83, v132
    s_add_u32 s55, s64, 16
    v_readlane_b32 s66, v132, 25
    v_readlane_b32 s67, v132, 63
    s_add_u32 s64, s66, 15
    s_and_b32 s64, s64, -16
    s_max_u32 s64, s64, s55
    s_sub_u32 s66, s64, s66
    v_mad_u32_u24 v132, v145, s66, v132
    s_lshr_b32 s95, s64, 4
    s_lshl_b64 s[86:87], 1, s95
    s_bitcmp1_b32 s64, 10
    s_cselect_b64 s[88:89], 0, s[86:87]
    s_cselect_b64 s[90:91], s[86:87], 0
    s_or_b64 s[56:57], s[56:57], s[88:89]
    s_or_b64 s[58:59], s[58:59], s[90:91]
    v_addc_co_u32 v133, vcc, 0, v132, s[68:69]
    v_addc_co_u32 v134, vcc, 0, v133, s[70:71]
    v_addc_co_u32 v135, vcc, 0, v134, s[72:73]
    v_addc_co_u32 v136, vcc, 0, v135, s[74:75]
    v_addc_co_u32 v137, vcc, 0, v136, s[76:77]
    v_addc_co_u32 v138, vcc, 0, v137, s[78:79]
    v_addc_co_u32 v139, vcc, 0, v138, s[80:81]
    s_add_u32 s67, s67, s66
    s_add_u32 s67, s67, 15
    s_and_b32 s67, s67, -16
    s_add_u32 s64, s64, 16
    s_max_u32 s64, s64, s67
    s_mov_b64 exec, s[68:69]
    ds_write_b8 v132, v141
    s_mov_b64 exec, s[70:71]
    ds_write_b8_d16_hi v133, v141
    s_mov_b64 exec, s[72:73]
    ds_write_b8 v134, v142
    s_mov_b64 exec, s[74:75]
    ds_write_b8_d16_hi v135, v142
    s_mov_b64 exec, s[76:77]
    ds_write_b8 v136, v143
    s_mov_b64 exec, s[78:79]
    ds_write_b8_d16_hi v137, v143
    s_mov_b64 exec, s[80:81]
    ds_write_b8 v138, v144
    s_mov_b64 exec, s[82:83]
    ds_write_b8_d16_hi v139, v144
    s_mov_b64 exec, -1
    s_lshr_b32 s95, s64, 4
    s_lshl_b64 s[86:87], 1, s95
    s_bitcmp1_b32 s64, 10
    s_cselect_b64 s[88:89], 0, s[86:87]
    s_cselect_b64 s[90:91], s[86:87], 0
    s_or_b64 s[56:57], s[56:57], s[88:89]
    s_or_b64 s[58:59], s[58:59], s[90:91]
    s_mov_b32 s94, 0
    s_mov_b64 s[84:85], -1
    s_branch L_listed
Ls_loop:
    ds_read_u8 v230, v237 offset:64
    ds_read_u8 v232, v237 offset:72
    v_mfma_f32_16x16x32_bf16 v[208:211], v[136:139], v[200:203], v[208:211]
Ls_mid:
    s_bitcmp1_b32 s36, 0
    s_cbranch_scc1 Ls_ev0
Ls_evd0:
    ds_read_b32 v246, v244 offset:0
    s_waitcnt lgkmcnt(0)
    v_bfe_u32 v247, v246, 0, 8
    v_lshlrev_b32 v247, 1, v247
    v_bfe_u32 v248, v246, 8, 8
    v_lshlrev_b32 v248, 1, v248
    v_bfe_u32 v249, v246, 16, 8
    v_lshlrev_b32 v249, 1, v249
    v_bfe_u32 v250, v246, 24, 8
    v_lshlrev_b32 v250, 1, v250
    buffer_load_ushort v247, v247, s[24:27], 0 offen
    buffer_load_ushort v248, v248, s[24:27], 0 offen
    buffer_load_ushort v249, v249, s[24:27], 0 offen
    buffer_load_ushort v250, v250, s[24:27], 0 offen
    s_waitcnt vmcnt(0)
    v_lshlrev_b32 v247, 16, v247
    v_mul_f32 v208, v208, v247
    v_lshlrev_b32 v248, 16, v248
    v_mul_f32 v209, v209, v248
    v_lshlrev_b32 v249, 16, v249
    v_mul_f32 v210, v210, v249
    v_lshlrev_b32 v250, 16, v250
    v_mul_f32 v211, v211, v250
    s_mov_b64 exec, 1
    ds_add_rtn_u32 v1, v2, v3
    s_mov_b64 exec, -1
    v_exp_f32 v132, v148
    v_exp_f32 v133, v149
    v_exp_f32 v134, v150
    v_exp_f32 v135, v151
    v_exp_f32 v136, v152
    v_exp_f32 v137, v153
    v_mfma_f32_4x4x4_16b_bf16 v[132:135], v[228:229], v[228:229], v[132:135]
    v_cvt_pk_bf16_f32 v208, v208, v209
    v_cvt_pk_bf16_f32 v209, v210, v211
    s_waitcnt lgkmcnt(2)
    v_mfma_f32_16x16x32_bf16 v[148:151], v[100:103], v[180:183], v[164:167]
    v_exp_f32 v138, v154
    v_mfma_f32_4x4x4_16b_bf16 v[212:215], v[208:209], v[188:189], v[212:215] cbsz:4 abid:0
    ds_read_b64_tr_b16 v[188:189], v236 offset:0
    v_exp_f32 v139, v155
    v_mfma_f32_16x16x32_bf16 v[152:155], v[108:111], v[180:183], v[168:171]
    v_exp_f32 v140, v156
    v_mfma_f32_4x4x4_16b_bf16 v[212:215], v[208:209], v[190:191], v[212:215] cbsz:4 abid:4
    ds_read_b64_tr_b16 v[190:191], v236 offset:512
    v_mfma_f32_4x4x4_16b_bf16 v[136:139], v[228:229], v[228:229], v[136:139]
    v_rcp_f32 v132, v132
    v_mfma_f32_4x4x4_16b_bf16 v[212:215], v[208:209], v[192:193], v[212:215] cbsz:4 abid:8
    ds_read_b64_tr_b16 v[192:193], v236 offset:1056
    v_exp_f32 v141, v157
    v_mfma_f32_16x16x32_bf16 v[148:151], v[104:107], v[184:187], v[148:151]
    v_rcp_f32 v133, v133
    v_mfma_f32_4x4x4_16b_bf16 v[212:215], v[208:209], v[194:195], v[212:215] cbsz:4 abid:12
    ds_read_b64_tr_b16 v[194:195], v236 offset:1568
    v_exp_f32 v142, v158
    v_mfma_f32_16x16x32_bf16 v[152:155], v[112:115], v[184:187], v[152:155]
    v_rcp_f32 v134, v134
    v_exp_f32 v143, v159
    v_rcp_f32 v135, v135
    v_cvt_pk_bf16_f32 v132, v132, v133
    v_mfma_f32_4x4x4_16b_bf16 v[140:143], v[228:229], v[228:229], v[140:143]
    v_exp_f32 v144, v160
    v_mfma_f32_16x16x32_bf16 v[156:159], v[116:119], v[180:183], v[172:175]
    v_rcp_f32 v136, v136
    v_cvt_pk_bf16_f32 v133, v134, v135
    s_add_u32 m0, s52, 0
    s_waitcnt lgkmcnt(0)
    buffer_load_dwordx4 v[230:231], s[20:23], 0 idxen offen nt lds
    v_exp_f32 v145, v161
    buffer_load_dwordx4 v[232:233], s[40:43], 0 idxen offen offset:1056 nt lds
    v_rcp_f32 v137, v137
    v_exp_f32 v146, v162
    v_rcp_f32 v138, v138
    v_cvt_pk_bf16_f32 v134, v136, v137
    v_exp_f32 v147, v163
    v_mfma_f32_16x16x32_bf16 v[160:163], v[124:127], v[180:183], v[176:179]
    v_readfirstlane_b32 s66, v1
    s_setprio 0
    s_xor_b32 s66, s66, s33
    s_cmp_gt_i32 s66, 0
    s_cbranch_scc0 Ls_lo0
    s_setprio 1
Ls_lo0:
    v_rcp_f32 v139, v139
    v_mfma_f32_4x4x4_16b_bf16 v[144:147], v[228:229], v[228:229], v[144:147]
    v_mfma_f32_16x16x32_bf16 v[156:159], v[120:123], v[184:187], v[156:159]
    v_rcp_f32 v140, v140
    v_mfma_f32_16x16x32_bf16 v[160:163], v[128:131], v[184:187], v[160:163]
    v_rcp_f32 v141, v141
    v_cvt_pk_bf16_f32 v135, v138, v139
    s_waitcnt vmcnt(4)
    ds_read_b128 v[180:183], v234 offset:4160
    ds_read_b128 v[184:187], v235 offset:4160
    v_rcp_f32 v142, v142
    v_cvt_pk_bf16_f32 v136, v140, v141
    v_mfma_f32_16x16x32_bf16 v[208:211], v[132:135], v[196:199], v[204:207]
    v_rcp_f32 v143, v143
    v_rcp_f32 v144, v144
    v_cvt_pk_bf16_f32 v137, v142, v143
    v_rcp_f32 v145, v145
    v_rcp_f32 v146, v146
    v_rcp_f32 v147, v147
    v_cvt_pk_bf16_f32 v138, v144, v145
    v_cvt_pk_bf16_f32 v139, v146, v147
    ds_read_u8 v230, v237 offset:80
    ds_read_u8 v232, v237 offset:88
    v_mfma_f32_16x16x32_bf16 v[208:211], v[136:139], v[200:203], v[208:211]
    s_bitcmp1_b32 s36, 1
    s_cbranch_scc1 Ls_ev1
Ls_evd1:
    ds_read_b32 v246, v244 offset:16
    s_waitcnt lgkmcnt(0)
    v_bfe_u32 v247, v246, 0, 8
    v_lshlrev_b32 v247, 1, v247
    v_bfe_u32 v248, v246, 8, 8
    v_lshlrev_b32 v248, 1, v248
    v_bfe_u32 v249, v246, 16, 8
    v_lshlrev_b32 v249, 1, v249
    v_bfe_u32 v250, v246, 24, 8
    v_lshlrev_b32 v250, 1, v250
    buffer_load_ushort v247, v247, s[24:27], 0 offen
    buffer_load_ushort v248, v248, s[24:27], 0 offen
    buffer_load_ushort v249, v249, s[24:27], 0 offen
    buffer_load_ushort v250, v250, s[24:27], 0 offen
    s_waitcnt vmcnt(0)
    v_lshlrev_b32 v247, 16, v247
    v_mul_f32 v208, v208, v247
    v_lshlrev_b32 v248, 16, v248
    v_mul_f32 v209, v209, v248
    v_lshlrev_b32 v249, 16, v249
    v_mul_f32 v210, v210, v249
    v_lshlrev_b32 v250, 16, v250
    v_mul_f32 v211, v211, v250
    v_exp_f32 v132, v148
    v_exp_f32 v133, v149
    v_exp_f32 v134, v150
    v_exp_f32 v135, v151
    v_exp_f32 v136, v152
    v_exp_f32 v137, v153
    v_mfma_f32_4x4x4_16b_bf16 v[132:135], v[228:229], v[228:229], v[132:135]
    v_cvt_pk_bf16_f32 v208, v208, v209
    v_cvt_pk_bf16_f32 v209, v210, v211
    s_waitcnt lgkmcnt(2)
    v_mfma_f32_16x16x32_bf16 v[148:151], v[100:103], v[180:183], v[164:167]
    v_exp_f32 v138, v154
    v_mfma_f32_4x4x4_16b_bf16 v[212:215], v[208:209], v[188:189], v[212:215] cbsz:4 abid:0
    ds_read_b64_tr_b16 v[188:189], v236 offset:2080
    v_exp_f32 v139, v155
    v_mfma_f32_16x16x32_bf16 v[152:155], v[108:111], v[180:183], v[168:171]
    v_exp_f32 v140, v156
    v_mfma_f32_4x4x4_16b_bf16 v[212:215], v[208:209], v[190:191], v[212:215] cbsz:4 abid:4
    ds_read_b64_tr_b16 v[190:191], v236 offset:2592
    v_mfma_f32_4x4x4_16b_bf16 v[136:139], v[228:229], v[228:229], v[136:139]
    v_rcp_f32 v132, v132
    v_mfma_f32_4x4x4_16b_bf16 v[212:215], v[208:209], v[192:193], v[212:215] cbsz:4 abid:8
    ds_read_b64_tr_b16 v[192:193], v236 offset:3136
    v_exp_f32 v141, v157
    v_mfma_f32_16x16x32_bf16 v[148:151], v[104:107], v[184:187], v[148:151]
    v_rcp_f32 v133, v133
    v_mfma_f32_4x4x4_16b_bf16 v[212:215], v[208:209], v[194:195], v[212:215] cbsz:4 abid:12
    ds_read_b64_tr_b16 v[194:195], v236 offset:3648
    v_exp_f32 v142, v158
    v_mfma_f32_16x16x32_bf16 v[152:155], v[112:115], v[184:187], v[152:155]
    v_rcp_f32 v134, v134
    v_exp_f32 v143, v159
    v_rcp_f32 v135, v135
    v_cvt_pk_bf16_f32 v132, v132, v133
    v_mfma_f32_4x4x4_16b_bf16 v[140:143], v[228:229], v[228:229], v[140:143]
    v_exp_f32 v144, v160
    v_mfma_f32_16x16x32_bf16 v[156:159], v[116:119], v[180:183], v[172:175]
    v_rcp_f32 v136, v136
    v_cvt_pk_bf16_f32 v133, v134, v135
    s_add_u32 m0, s52, 2080
    s_waitcnt lgkmcnt(0)
    buffer_load_dwordx4 v[230:231], s[20:23], 0 idxen offen nt lds
    v_exp_f32 v145, v161
    buffer_load_dwordx4 v[232:233], s[40:43], 0 idxen offen offset:1056 nt lds
    v_rcp_f32 v137, v137
    v_exp_f32 v146, v162
    v_rcp_f32 v138, v138
    v_cvt_pk_bf16_f32 v134, v136, v137
    v_exp_f32 v147, v163
    v_mfma_f32_16x16x32_bf16 v[160:163], v[124:127], v[180:183], v[176:179]
    v_rcp_f32 v139, v139
    v_mfma_f32_4x4x4_16b_bf16 v[144:147], v[228:229], v[228:229], v[144:147]
    v_mfma_f32_16x16x32_bf16 v[156:159], v[120:123], v[184:187], v[156:159]
    v_rcp_f32 v140, v140
    v_mfma_f32_16x16x32_bf16 v[160:163], v[128:131], v[184:187], v[160:163]
    v_rcp_f32 v141, v141
    v_cvt_pk_bf16_f32 v135, v138, v139
    s_waitcnt vmcnt(4)
    ds_read_b128 v[180:183], v234 offset:6240
    ds_read_b128 v[184:187], v235 offset:6240
    v_rcp_f32 v142, v142
    v_cvt_pk_bf16_f32 v136, v140, v141
    v_mfma_f32_16x16x32_bf16 v[208:211], v[132:135], v[196:199], v[204:207]
    v_rcp_f32 v143, v143
    v_rcp_f32 v144, v144
    v_cvt_pk_bf16_f32 v137, v142, v143
    v_rcp_f32 v145, v145
    v_rcp_f32 v146, v146
    v_rcp_f32 v147, v147
    v_cvt_pk_bf16_f32 v138, v144, v145
    v_cvt_pk_bf16_f32 v139, v146, v147
    ds_read_u8 v230, v237 offset:96
    ds_read_u8 v232, v237 offset:104
    v_mfma_f32_16x16x32_bf16 v[208:211], v[136:139], v[200:203], v[208:211]
    s_bitcmp1_b32 s36, 2
    s_cbranch_scc1 Ls_ev2
Ls_evd2:
    ds_read_b32 v246, v244 offset:32
    s_waitcnt lgkmcnt(0)
    v_bfe_u32 v247, v246, 0, 8
    v_lshlrev_b32 v247, 1, v247
    v_bfe_u32 v248, v246, 8, 8
    v_lshlrev_b32 v248, 1, v248
    v_bfe_u32 v249, v246, 16, 8
    v_lshlrev_b32 v249, 1, v249
    v_bfe_u32 v250, v246, 24, 8
    v_lshlrev_b32 v250, 1, v250
    buffer_load_ushort v247, v247, s[24:27], 0 offen
    buffer_load_ushort v248, v248, s[24:27], 0 offen
    buffer_load_ushort v249, v249, s[24:27], 0 offen
    buffer_load_ushort v250, v250, s[24:27], 0 offen
    s_waitcnt vmcnt(0)
    v_lshlrev_b32 v247, 16, v247
    v_mul_f32 v208, v208, v247
    v_lshlrev_b32 v248, 16, v248
    v_mul_f32 v209, v209, v248
    v_lshlrev_b32 v249, 16, v249
    v_mul_f32 v210, v210, v249
    v_lshlrev_b32 v250, 16, v250
    v_mul_f32 v211, v211, v250
    v_exp_f32 v132, v148
    v_exp_f32 v133, v149
    v_exp_f32 v134, v150
    v_exp_f32 v135, v151
    v_exp_f32 v136, v152
    v_exp_f32 v137, v153
    v_mfma_f32_4x4x4_16b_bf16 v[132:135], v[228:229], v[228:229], v[132:135]
    v_cvt_pk_bf16_f32 v208, v208, v209
    v_cvt_pk_bf16_f32 v209, v210, v211
    s_waitcnt lgkmcnt(2)
    v_mfma_f32_16x16x32_bf16 v[148:151], v[100:103], v[180:183], v[164:167]
    v_exp_f32 v138, v154
    v_mfma_f32_4x4x4_16b_bf16 v[212:215], v[208:209], v[188:189], v[212:215] cbsz:4 abid:0
    ds_read_b64_tr_b16 v[188:189], v236 offset:4160
    v_exp_f32 v139, v155
    v_mfma_f32_16x16x32_bf16 v[152:155], v[108:111], v[180:183], v[168:171]
    v_exp_f32 v140, v156
    v_mfma_f32_4x4x4_16b_bf16 v[212:215], v[208:209], v[190:191], v[212:215] cbsz:4 abid:4
    ds_read_b64_tr_b16 v[190:191], v236 offset:4672
    v_mfma_f32_4x4x4_16b_bf16 v[136:139], v[228:229], v[228:229], v[136:139]
    v_rcp_f32 v132, v132
    v_mfma_f32_4x4x4_16b_bf16 v[212:215], v[208:209], v[192:193], v[212:215] cbsz:4 abid:8
    ds_read_b64_tr_b16 v[192:193], v236 offset:5216
    v_exp_f32 v141, v157
    v_mfma_f32_16x16x32_bf16 v[148:151], v[104:107], v[184:187], v[148:151]
    v_rcp_f32 v133, v133
    v_mfma_f32_4x4x4_16b_bf16 v[212:215], v[208:209], v[194:195], v[212:215] cbsz:4 abid:12
    ds_read_b64_tr_b16 v[194:195], v236 offset:5728
    v_exp_f32 v142, v158
    v_mfma_f32_16x16x32_bf16 v[152:155], v[112:115], v[184:187], v[152:155]
    v_rcp_f32 v134, v134
    v_exp_f32 v143, v159
    v_rcp_f32 v135, v135
    v_cvt_pk_bf16_f32 v132, v132, v133
    v_mfma_f32_4x4x4_16b_bf16 v[140:143], v[228:229], v[228:229], v[140:143]
    v_exp_f32 v144, v160
    v_mfma_f32_16x16x32_bf16 v[156:159], v[116:119], v[180:183], v[172:175]
    v_rcp_f32 v136, v136
    v_cvt_pk_bf16_f32 v133, v134, v135
    s_add_u32 m0, s52, 4160
    s_waitcnt lgkmcnt(0)
    buffer_load_dwordx4 v[230:231], s[20:23], 0 idxen offen nt lds
    v_exp_f32 v145, v161
    buffer_load_dwordx4 v[232:233], s[40:43], 0 idxen offen offset:1056 nt lds
    v_rcp_f32 v137, v137
    v_exp_f32 v146, v162
    v_rcp_f32 v138, v138
    v_cvt_pk_bf16_f32 v134, v136, v137
    v_exp_f32 v147, v163
    v_mfma_f32_16x16x32_bf16 v[160:163], v[124:127], v[180:183], v[176:179]
    v_rcp_f32 v139, v139
    v_mfma_f32_4x4x4_16b_bf16 v[144:147], v[228:229], v[228:229], v[144:147]
    v_mfma_f32_16x16x32_bf16 v[156:159], v[120:123], v[184:187], v[156:159]
    v_rcp_f32 v140, v140
    v_mfma_f32_16x16x32_bf16 v[160:163], v[128:131], v[184:187], v[160:163]
    v_rcp_f32 v141, v141
    v_cvt_pk_bf16_f32 v135, v138, v139
    s_waitcnt vmcnt(4)
    ds_read_b128 v[180:183], v234 offset:0
    ds_read_b128 v[184:187], v235 offset:0
    v_rcp_f32 v142, v142
    v_cvt_pk_bf16_f32 v136, v140, v141
    v_mfma_f32_16x16x32_bf16 v[208:211], v[132:135], v[196:199], v[204:207]
    v_rcp_f32 v143, v143
    v_rcp_f32 v144, v144
    v_cvt_pk_bf16_f32 v137, v142, v143
    v_rcp_f32 v145, v145
    v_rcp_f32 v146, v146
    v_rcp_f32 v147, v147
    v_cvt_pk_bf16_f32 v138, v144, v145
    v_cvt_pk_bf16_f32 v139, v146, v147
    ds_read_u8 v230, v237 offset:112
    ds_read_u8 v232, v237 offset:120
    v_mfma_f32_16x16x32_bf16 v[208:211], v[136:139], v[200:203], v[208:211]
    s_bitcmp1_b32 s36, 3
    s_cbranch_scc1 Ls_ev3
Ls_evd3:
    ds_read_b32 v246, v244 offset:48
    s_waitcnt lgkmcnt(0)
    v_bfe_u32 v247, v246, 0, 8
    v_lshlrev_b32 v247, 1, v247
    v_bfe_u32 v248, v246, 8, 8
    v_lshlrev_b32 v248, 1, v248
    v_bfe_u32 v249, v246, 16, 8
    v_lshlrev_b32 v249, 1, v249
    v_bfe_u32 v250, v246, 24, 8
    v_lshlrev_b32 v250, 1, v250
    buffer_load_ushort v247, v247, s[24:27], 0 offen
    buffer_load_ushort v248, v248, s[24:27], 0 offen
    buffer_load_ushort v249, v249, s[24:27], 0 offen
    buffer_load_ushort v250, v250, s[24:27], 0 offen
    s_waitcnt vmcnt(0)
    v_lshlrev_b32 v247, 16, v247
    v_mul_f32 v208, v208, v247
    v_lshlrev_b32 v248, 16, v248
    v_mul_f32 v209, v209, v248
    v_lshlrev_b32 v249, 16, v249
    v_mul_f32 v210, v210, v249
    v_lshlrev_b32 v250, 16, v250
    v_mul_f32 v211, v211, v250
    v_exp_f32 v132, v148
    v_exp_f32 v133, v149
    v_exp_f32 v134, v150
    v_exp_f32 v135, v151
    v_exp_f32 v136, v152
    v_exp_f32 v137, v153
    v_mfma_f32_4x4x4_16b_bf16 v[132:135], v[228:229], v[228:229], v[132:135]
    v_cvt_pk_bf16_f32 v208, v208, v209
    v_cvt_pk_bf16_f32 v209, v210, v211
    s_waitcnt lgkmcnt(2)
    v_mfma_f32_16x16x32_bf16 v[148:151], v[100:103], v[180:183], v[164:167]
    v_exp_f32 v138, v154
    v_mfma_f32_4x4x4_16b_bf16 v[212:215], v[208:209], v[188:189], v[212:215] cbsz:4 abid:0
    ds_read_b64_tr_b16 v[188:189], v236 offset:6240
    v_exp_f32 v139, v155
    v_mfma_f32_16x16x32_bf16 v[152:155], v[108:111], v[180:183], v[168:171]
    v_exp_f32 v140, v156
    v_mfma_f32_4x4x4_16b_bf16 v[212:215], v[208:209], v[190:191], v[212:215] cbsz:4 abid:4
    ds_read_b64_tr_b16 v[190:191], v236 offset:6752
    v_mfma_f32_4x4x4_16b_bf16 v[136:139], v[228:229], v[228:229], v[136:139]
    v_rcp_f32 v132, v132
    v_mfma_f32_4x4x4_16b_bf16 v[212:215], v[208:209], v[192:193], v[212:215] cbsz:4 abid:8
    ds_read_b64_tr_b16 v[192:193], v236 offset:7296
    v_exp_f32 v141, v157
    v_mfma_f32_16x16x32_bf16 v[148:151], v[104:107], v[184:187], v[148:151]
    v_rcp_f32 v133, v133
    v_mfma_f32_4x4x4_16b_bf16 v[212:215], v[208:209], v[194:195], v[212:215] cbsz:4 abid:12
    ds_read_b64_tr_b16 v[194:195], v236 offset:7808
    v_exp_f32 v142, v158
    v_mfma_f32_16x16x32_bf16 v[152:155], v[112:115], v[184:187], v[152:155]
    v_rcp_f32 v134, v134
    v_exp_f32 v143, v159
    v_rcp_f32 v135, v135
    v_cvt_pk_bf16_f32 v132, v132, v133
    v_mfma_f32_4x4x4_16b_bf16 v[140:143], v[228:229], v[228:229], v[140:143]
    v_exp_f32 v144, v160
    v_mfma_f32_16x16x32_bf16 v[156:159], v[116:119], v[180:183], v[172:175]
    v_rcp_f32 v136, v136
    v_cvt_pk_bf16_f32 v133, v134, v135
    s_add_u32 m0, s52, 6240
    s_waitcnt lgkmcnt(0)
    buffer_load_dwordx4 v[230:231], s[20:23], 0 idxen offen nt lds
    v_exp_f32 v145, v161
    buffer_load_dwordx4 v[232:233], s[40:43], 0 idxen offen offset:1056 nt lds
    v_rcp_f32 v137, v137
    v_exp_f32 v146, v162
    v_rcp_f32 v138, v138
    v_cvt_pk_bf16_f32 v134, v136, v137
    v_exp_f32 v147, v163
    v_mfma_f32_16x16x32_bf16 v[160:163], v[124:127], v[180:183], v[176:179]
    v_rcp_f32 v139, v139
    v_mfma_f32_4x4x4_16b_bf16 v[144:147], v[228:229], v[228:229], v[144:147]
    v_mfma_f32_16x16x32_bf16 v[156:159], v[120:123], v[184:187], v[156:159]
    v_rcp_f32 v140, v140
    v_mfma_f32_16x16x32_bf16 v[160:163], v[128:131], v[184:187], v[160:163]
    v_rcp_f32 v141, v141
    v_cvt_pk_bf16_f32 v135, v138, v139
    s_waitcnt vmcnt(4)
    ds_read_b128 v[180:183], v234 offset:2080
    ds_read_b128 v[184:187], v235 offset:2080
    v_rcp_f32 v142, v142
    v_cvt_pk_bf16_f32 v136, v140, v141
    v_mfma_f32_16x16x32_bf16 v[208:211], v[132:135], v[196:199], v[204:207]
    v_rcp_f32 v143, v143
    s_lshr_b64 s[56:57], s[56:57], 4
    s_lshl_b64 s[86:87], s[58:59], 60
    s_or_b64 s[56:57], s[56:57], s[86:87]
    s_lshr_b64 s[58:59], s[58:59], 4
    s_lshr_b64 s[86:87], s[56:57], 2
    s_lshr_b64 s[36:37], s[56:57], 5
    s_or_b32 s36, s36, s86
    s_or_b32 s36, s36, s56
    v_add_u32 v237, 64, v237
    v_add_u32 v244, 64, v244
    v_rcp_f32 v144, v144
    v_cvt_pk_bf16_f32 v137, v142, v143
    v_rcp_f32 v145, v145
    v_rcp_f32 v146, v146
    v_rcp_f32 v147, v147
    v_cvt_pk_bf16_f32 v138, v144, v145
    v_cvt_pk_bf16_f32 v139, v146, v147
    s_branch Ls_loop
Ls_ev0:
    s_bitcmp0_b64 s[56:57], 0
    s_cbranch_scc1 Ls_nf0
    v_cvt_pk_bf16_f32 v246, v212, v212
    v_mov_b32 v212, 0
    ds_write_b16 v240, v246
    v_add_u32 v240, 128, v240
    s_add_u32 s24, s24, s32
    s_addc_u32 s25, s25, 0
    s_xor_b32 s32, s32, 0x18ffe0
Ls_nf0:
    s_bitcmp0_b64 s[56:57], 5
    s_cbranch_scc1 Ls_na0
    s_sub_u32 s60, s60, 1
    s_cselect_b32 s31, 0, s31
    s_add_u32 s20, s20, s31
    s_addc_u32 s21, s21, 0
    s_add_u32 s40, s40, s31
    s_addc_u32 s41, s41, 0
    s_xor_b32 s31, s31, 0x63ff800
Ls_na0:
    s_bitcmp0_b64 s[56:57], 2
    s_cbranch_scc1 Ls_evd0
    s_sub_u32 s61, s61, 1
    s_cbranch_scc1 Ls_last0
    v_mul_u32_u24 v216, v224, v241
    v_mul_u32_u24 v217, v224, v242
    v_mul_u32_u24 v218, v225, v241
    v_mul_u32_u24 v219, v225, v242
    v_mul_u32_u24 v220, v226, v241
    v_mul_u32_u24 v221, v226, v242
    v_mul_u32_u24 v222, v227, v241
    v_mul_u32_u24 v223, v227, v242
    v_add_u32 v238, 128, v238
    ds_read_b128 v[164:167], v239
    v_mfma_f32_4x4x4_16b_bf16 v[132:135], v[216:217], v[68:69], v[4:7]
    ds_read_b128 v[168:171], v239 offset:64
    ds_read_b128 v[172:175], v239 offset:128
    v_mfma_f32_4x4x4_16b_bf16 v[136:139], v[218:219], v[70:71], v[8:11]
    ds_read_b128 v[176:179], v239 offset:192
    ds_read_u16 v224, v238
    v_mfma_f32_4x4x4_16b_bf16 v[140:143], v[220:221], v[72:73], v[12:15]
    ds_read_u16 v225, v238 offset:8
    ds_read_u16 v226, v238 offset:64
    v_mfma_f32_4x4x4_16b_bf16 v[144:147], v[222:223], v[74:75], v[16:19]
    ds_read_u16 v227, v238 offset:72
    v_add_u32 v239, 272, v239
    v_mfma_f32_4x4x4_16b_bf16 v[246:249], v[216:217], v[76:77], v[20:23]
    v_cvt_pk_bf16_f32 v100, v132, v133
    v_cvt_pk_bf16_f32 v101, v134, v135
    v_mfma_f32_4x4x4_16b_bf16 v[250:253], v[218:219], v[78:79], v[24:27]
    v_cvt_pk_bf16_f32 v102, v136, v137
    v_cvt_pk_bf16_f32 v103, v138, v139
    v_mfma_f32_4x4x4_16b_bf16 v[132:135], v[220:221], v[80:81], v[28:31]
    v_cvt_pk_bf16_f32 v104, v140, v141
    v_cvt_pk_bf16_f32 v105, v142, v143
    v_mfma_f32_4x4x4_16b_bf16 v[136:139], v[222:223], v[82:83], v[32:35]
    v_cvt_pk_bf16_f32 v106, v144, v145
    v_cvt_pk_bf16_f32 v107, v146, v147
    v_mfma_f32_4x4x4_16b_bf16 v[140:143], v[216:217], v[84:85], v[36:39]
    v_cvt_pk_bf16_f32 v108, v246, v247
    v_cvt_pk_bf16_f32 v109, v248, v249
    v_mfma_f32_4x4x4_16b_bf16 v[144:147], v[218:219], v[86:87], v[40:43]
    v_cvt_pk_bf16_f32 v110, v250, v251
    v_cvt_pk_bf16_f32 v111, v252, v253
    v_mfma_f32_4x4x4_16b_bf16 v[246:249], v[220:221], v[88:89], v[44:47]
    v_cvt_pk_bf16_f32 v112, v132, v133
    v_cvt_pk_bf16_f32 v113, v134, v135
    v_mfma_f32_4x4x4_16b_bf16 v[250:253], v[222:223], v[90:91], v[48:51]
    v_cvt_pk_bf16_f32 v114, v136, v137
    v_cvt_pk_bf16_f32 v115, v138, v139
    v_mfma_f32_4x4x4_16b_bf16 v[132:135], v[216:217], v[92:93], v[52:55]
    v_cvt_pk_bf16_f32 v116, v140, v141
    v_cvt_pk_bf16_f32 v117, v142, v143
    v_mfma_f32_4x4x4_16b_bf16 v[136:139], v[218:219], v[94:95], v[56:59]
    v_cvt_pk_bf16_f32 v118, v144, v145
    v_cvt_pk_bf16_f32 v119, v146, v147
    v_mfma_f32_4x4x4_16b_bf16 v[140:143], v[220:221], v[96:97], v[60:63]
    v_cvt_pk_bf16_f32 v120, v246, v247
    v_cvt_pk_bf16_f32 v121, v248, v249
    v_mfma_f32_4x4x4_16b_bf16 v[144:147], v[222:223], v[98:99], v[64:67]
    v_cvt_pk_bf16_f32 v122, v250, v251
    v_cvt_pk_bf16_f32 v123, v252, v253
    v_cvt_pk_bf16_f32 v124, v132, v133
    v_cvt_pk_bf16_f32 v125, v134, v135
    v_cvt_pk_bf16_f32 v126, v136, v137
    v_cvt_pk_bf16_f32 v127, v138, v139
    v_cvt_pk_bf16_f32 v128, v140, v141
    v_cvt_pk_bf16_f32 v129, v142, v143
    v_cvt_pk_bf16_f32 v130, v144, v145
    v_cvt_pk_bf16_f32 v131, v146, v147
    s_waitcnt lgkmcnt(0)
    s_branch Ls_evd0
Ls_ev1:
    s_bitcmp0_b64 s[56:57], 1
    s_cbranch_scc1 Ls_nf1
    v_cvt_pk_bf16_f32 v246, v212, v212
    v_mov_b32 v212, 0
    ds_write_b16 v240, v246
    v_add_u32 v240, 128, v240
    s_add_u32 s24, s24, s32
    s_addc_u32 s25, s25, 0
    s_xor_b32 s32, s32, 0x18ffe0
Ls_nf1:
    s_bitcmp0_b64 s[56:57], 6
    s_cbranch_scc1 Ls_na1
    s_sub_u32 s60, s60, 1
    s_cselect_b32 s31, 0, s31
    s_add_u32 s20, s20, s31
    s_addc_u32 s21, s21, 0
    s_add_u32 s40, s40, s31
    s_addc_u32 s41, s41, 0
    s_xor_b32 s31, s31, 0x63ff800
Ls_na1:
    s_bitcmp0_b64 s[56:57], 3
    s_cbranch_scc1 Ls_evd1
    s_sub_u32 s61, s61, 1
    s_cbranch_scc1 Ls_last1
    v_mul_u32_u24 v216, v224, v241
    v_mul_u32_u24 v217, v224, v242
    v_mul_u32_u24 v218, v225, v241
    v_mul_u32_u24 v219, v225, v242
    v_mul_u32_u24 v220, v226, v241
    v_mul_u32_u24 v221, v226, v242
    v_mul_u32_u24 v222, v227, v241
    v_mul_u32_u24 v223, v227, v242
    v_add_u32 v238, 128, v238
    ds_read_b128 v[164:167], v239
    v_mfma_f32_4x4x4_16b_bf16 v[132:135], v[216:217], v[68:69], v[4:7]
    ds_read_b128 v[168:171], v239 offset:64
    ds_read_b128 v[172:175], v239 offset:128
    v_mfma_f32_4x4x4_16b_bf16 v[136:139], v[218:219], v[70:71], v[8:11]
    ds_read_b128 v[176:179], v239 offset:192
    ds_read_u16 v224, v238
    v_mfma_f32_4x4x4_16b_bf16 v[140:143], v[220:221], v[72:73], v[12:15]
    ds_read_u16 v225, v238 offset:8
    ds_read_u16 v226, v238 offset:64
    v_mfma_f32_4x4x4_16b_bf16 v[144:147], v[222:223], v[74:75], v[16:19]
    ds_read_u16 v227, v238 offset:72
    v_add_u32 v239, 272, v239
    v_mfma_f32_4x4x4_16b_bf16 v[246:249], v[216:217], v[76:77], v[20:23]
    v_cvt_pk_bf16_f32 v100, v132, v133
    v_cvt_pk_bf16_f32 v101, v134, v135
    v_mfma_f32_4x4x4_16b_bf16 v[250:253], v[218:219], v[78:79], v[24:27]
    v_cvt_pk_bf16_f32 v102, v136, v137
    v_cvt_pk_bf16_f32 v103, v138, v139
    v_mfma_f32_4x4x4_16b_bf16 v[132:135], v[220:221], v[80:81], v[28:31]
    v_cvt_pk_bf16_f32 v104, v140, v141
    v_cvt_pk_bf16_f32 v105, v142, v143
    v_mfma_f32_4x4x4_16b_bf16 v[136:139], v[222:223], v[82:83], v[32:35]
    v_cvt_pk_bf16_f32 v106, v144, v145
    v_cvt_pk_bf16_f32 v107, v146, v147
    v_mfma_f32_4x4x4_16b_bf16 v[140:143], v[216:217], v[84:85], v[36:39]
    v_cvt_pk_bf16_f32 v108, v246, v247
    v_cvt_pk_bf16_f32 v109, v248, v249
    v_mfma_f32_4x4x4_16b_bf16 v[144:147], v[218:219], v[86:87], v[40:43]
    v_cvt_pk_bf16_f32 v110, v250, v251
    v_cvt_pk_bf16_f32 v111, v252, v253
    v_mfma_f32_4x4x4_16b_bf16 v[246:249], v[220:221], v[88:89], v[44:47]
    v_cvt_pk_bf16_f32 v112, v132, v133
    v_cvt_pk_bf16_f32 v113, v134, v135
    v_mfma_f32_4x4x4_16b_bf16 v[250:253], v[222:223], v[90:91], v[48:51]
    v_cvt_pk_bf16_f32 v114, v136, v137
    v_cvt_pk_bf16_f32 v115, v138, v139
    v_mfma_f32_4x4x4_16b_bf16 v[132:135], v[216:217], v[92:93], v[52:55]
    v_cvt_pk_bf16_f32 v116, v140, v141
    v_cvt_pk_bf16_f32 v117, v142, v143
    v_mfma_f32_4x4x4_16b_bf16 v[136:139], v[218:219], v[94:95], v[56:59]
    v_cvt_pk_bf16_f32 v118, v144, v145
    v_cvt_pk_bf16_f32 v119, v146, v147
    v_mfma_f32_4x4x4_16b_bf16 v[140:143], v[220:221], v[96:97], v[60:63]
    v_cvt_pk_bf16_f32 v120, v246, v247
    v_cvt_pk_bf16_f32 v121, v248, v249
    v_mfma_f32_4x4x4_16b_bf16 v[144:147], v[222:223], v[98:99], v[64:67]
    v_cvt_pk_bf16_f32 v122, v250, v251
    v_cvt_pk_bf16_f32 v123, v252, v253
    v_cvt_pk_bf16_f32 v124, v132, v133
    v_cvt_pk_bf16_f32 v125, v134, v135
    v_cvt_pk_bf16_f32 v126, v136, v137
    v_cvt_pk_bf16_f32 v127, v138, v139
    v_cvt_pk_bf16_f32 v128, v140, v141
    v_cvt_pk_bf16_f32 v129, v142, v143
    v_cvt_pk_bf16_f32 v130, v144, v145
    v_cvt_pk_bf16_f32 v131, v146, v147
    s_waitcnt lgkmcnt(0)
    s_branch Ls_evd1
Ls_ev2:
    s_bitcmp0_b64 s[56:57], 2
    s_cbranch_scc1 Ls_nf2
    v_cvt_pk_bf16_f32 v246, v212, v212
    v_mov_b32 v212, 0
    ds_write_b16 v240, v246
    v_add_u32 v240, 128, v240
    s_add_u32 s24, s24, s32
    s_addc_u32 s25, s25, 0
    s_xor_b32 s32, s32, 0x18ffe0
Ls_nf2:
    s_bitcmp0_b64 s[56:57], 7
    s_cbranch_scc1 Ls_na2
    s_sub_u32 s60, s60, 1
    s_cselect_b32 s31, 0, s31
    s_add_u32 s20, s20, s31
    s_addc_u32 s21, s21, 0
    s_add_u32 s40, s40, s31
    s_addc_u32 s41, s41, 0
    s_xor_b32 s31, s31, 0x63ff800
Ls_na2:
    s_bitcmp0_b64 s[56:57], 4
    s_cbranch_scc1 Ls_evd2
    s_sub_u32 s61, s61, 1
    s_cbranch_scc1 Ls_last2
    v_mul_u32_u24 v216, v224, v241
    v_mul_u32_u24 v217, v224, v242
    v_mul_u32_u24 v218, v225, v241
    v_mul_u32_u24 v219, v225, v242
    v_mul_u32_u24 v220, v226, v241
    v_mul_u32_u24 v221, v226, v242
    v_mul_u32_u24 v222, v227, v241
    v_mul_u32_u24 v223, v227, v242
    v_add_u32 v238, 128, v238
    ds_read_b128 v[164:167], v239
    v_mfma_f32_4x4x4_16b_bf16 v[132:135], v[216:217], v[68:69], v[4:7]
    ds_read_b128 v[168:171], v239 offset:64
    ds_read_b128 v[172:175], v239 offset:128
    v_mfma_f32_4x4x4_16b_bf16 v[136:139], v[218:219], v[70:71], v[8:11]
    ds_read_b128 v[176:179], v239 offset:192
    ds_read_u16 v224, v238
    v_mfma_f32_4x4x4_16b_bf16 v[140:143], v[220:221], v[72:73], v[12:15]
    ds_read_u16 v225, v238 offset:8
    ds_read_u16 v226, v238 offset:64
    v_mfma_f32_4x4x4_16b_bf16 v[144:147], v[222:223], v[74:75], v[16:19]
    ds_read_u16 v227, v238 offset:72
    v_add_u32 v239, 272, v239
    v_mfma_f32_4x4x4_16b_bf16 v[246:249], v[216:217], v[76:77], v[20:23]
    v_cvt_pk_bf16_f32 v100, v132, v133
    v_cvt_pk_bf16_f32 v101, v134, v135
    v_mfma_f32_4x4x4_16b_bf16 v[250:253], v[218:219], v[78:79], v[24:27]
    v_cvt_pk_bf16_f32 v102, v136, v137
    v_cvt_pk_bf16_f32 v103, v138, v139
    v_mfma_f32_4x4x4_16b_bf16 v[132:135], v[220:221], v[80:81], v[28:31]
    v_cvt_pk_bf16_f32 v104, v140, v141
    v_cvt_pk_bf16_f32 v105, v142, v143
    v_mfma_f32_4x4x4_16b_bf16 v[136:139], v[222:223], v[82:83], v[32:35]
    v_cvt_pk_bf16_f32 v106, v144, v145
    v_cvt_pk_bf16_f32 v107, v146, v147
    v_mfma_f32_4x4x4_16b_bf16 v[140:143], v[216:217], v[84:85], v[36:39]
    v_cvt_pk_bf16_f32 v108, v246, v247
    v_cvt_pk_bf16_f32 v109, v248, v249
    v_mfma_f32_4x4x4_16b_bf16 v[144:147], v[218:219], v[86:87], v[40:43]
    v_cvt_pk_bf16_f32 v110, v250, v251
    v_cvt_pk_bf16_f32 v111, v252, v253
    v_mfma_f32_4x4x4_16b_bf16 v[246:249], v[220:221], v[88:89], v[44:47]
    v_cvt_pk_bf16_f32 v112, v132, v133
    v_cvt_pk_bf16_f32 v113, v134, v135
    v_mfma_f32_4x4x4_16b_bf16 v[250:253], v[222:223], v[90:91], v[48:51]
    v_cvt_pk_bf16_f32 v114, v136, v137
    v_cvt_pk_bf16_f32 v115, v138, v139
    v_mfma_f32_4x4x4_16b_bf16 v[132:135], v[216:217], v[92:93], v[52:55]
    v_cvt_pk_bf16_f32 v116, v140, v141
    v_cvt_pk_bf16_f32 v117, v142, v143
    v_mfma_f32_4x4x4_16b_bf16 v[136:139], v[218:219], v[94:95], v[56:59]
    v_cvt_pk_bf16_f32 v118, v144, v145
    v_cvt_pk_bf16_f32 v119, v146, v147
    v_mfma_f32_4x4x4_16b_bf16 v[140:143], v[220:221], v[96:97], v[60:63]
    v_cvt_pk_bf16_f32 v120, v246, v247
    v_cvt_pk_bf16_f32 v121, v248, v249
    v_mfma_f32_4x4x4_16b_bf16 v[144:147], v[222:223], v[98:99], v[64:67]
    v_cvt_pk_bf16_f32 v122, v250, v251
    v_cvt_pk_bf16_f32 v123, v252, v253
    v_cvt_pk_bf16_f32 v124, v132, v133
    v_cvt_pk_bf16_f32 v125, v134, v135
    v_cvt_pk_bf16_f32 v126, v136, v137
    v_cvt_pk_bf16_f32 v127, v138, v139
    v_cvt_pk_bf16_f32 v128, v140, v141
    v_cvt_pk_bf16_f32 v129, v142, v143
    v_cvt_pk_bf16_f32 v130, v144, v145
    v_cvt_pk_bf16_f32 v131, v146, v147
    s_waitcnt lgkmcnt(0)
    s_branch Ls_evd2
Ls_ev3:
    s_bitcmp0_b64 s[56:57], 3
    s_cbranch_scc1 Ls_nf3
    v_cvt_pk_bf16_f32 v246, v212, v212
    v_mov_b32 v212, 0
    ds_write_b16 v240, v246
    v_add_u32 v240, 128, v240
    s_add_u32 s24, s24, s32
    s_addc_u32 s25, s25, 0
    s_xor_b32 s32, s32, 0x18ffe0
Ls_nf3:
    s_bitcmp0_b64 s[56:57], 8
    s_cbranch_scc1 Ls_na3
    s_sub_u32 s60, s60, 1
    s_cselect_b32 s31, 0, s31
    s_add_u32 s20, s20, s31
    s_addc_u32 s21, s21, 0
    s_add_u32 s40, s40, s31
    s_addc_u32 s41, s41, 0
    s_xor_b32 s31, s31, 0x63ff800
Ls_na3:
    s_bitcmp0_b64 s[56:57], 5
    s_cbranch_scc1 Ls_evd3
    s_sub_u32 s61, s61, 1
    s_cbranch_scc1 Ls_last3
    v_mul_u32_u24 v216, v224, v241
    v_mul_u32_u24 v217, v224, v242
    v_mul_u32_u24 v218, v225, v241
    v_mul_u32_u24 v219, v225, v242
    v_mul_u32_u24 v220, v226, v241
    v_mul_u32_u24 v221, v226, v242
    v_mul_u32_u24 v222, v227, v241
    v_mul_u32_u24 v223, v227, v242
    v_add_u32 v238, 128, v238
    ds_read_b128 v[164:167], v239
    v_mfma_f32_4x4x4_16b_bf16 v[132:135], v[216:217], v[68:69], v[4:7]
    ds_read_b128 v[168:171], v239 offset:64
    ds_read_b128 v[172:175], v239 offset:128
    v_mfma_f32_4x4x4_16b_bf16 v[136:139], v[218:219], v[70:71], v[8:11]
    ds_read_b128 v[176:179], v239 offset:192
    ds_read_u16 v224, v238
    v_mfma_f32_4x4x4_16b_bf16 v[140:143], v[220:221], v[72:73], v[12:15]
    ds_read_u16 v225, v238 offset:8
    ds_read_u16 v226, v238 offset:64
    v_mfma_f32_4x4x4_16b_bf16 v[144:147], v[222:223], v[74:75], v[16:19]
    ds_read_u16 v227, v238 offset:72
    v_add_u32 v239, 272, v239
    v_mfma_f32_4x4x4_16b_bf16 v[246:249], v[216:217], v[76:77], v[20:23]
    v_cvt_pk_bf16_f32 v100, v132, v133
    v_cvt_pk_bf16_f32 v101, v134, v135
    v_mfma_f32_4x4x4_16b_bf16 v[250:253], v[218:219], v[78:79], v[24:27]
    v_cvt_pk_bf16_f32 v102, v136, v137
    v_cvt_pk_bf16_f32 v103, v138, v139
    v_mfma_f32_4x4x4_16b_bf16 v[132:135], v[220:221], v[80:81], v[28:31]
    v_cvt_pk_bf16_f32 v104, v140, v141
    v_cvt_pk_bf16_f32 v105, v142, v143
    v_mfma_f32_4x4x4_16b_bf16 v[136:139], v[222:223], v[82:83], v[32:35]
    v_cvt_pk_bf16_f32 v106, v144, v145
    v_cvt_pk_bf16_f32 v107, v146, v147
    v_mfma_f32_4x4x4_16b_bf16 v[140:143], v[216:217], v[84:85], v[36:39]
    v_cvt_pk_bf16_f32 v108, v246, v247
    v_cvt_pk_bf16_f32 v109, v248, v249
    v_mfma_f32_4x4x4_16b_bf16 v[144:147], v[218:219], v[86:87], v[40:43]
    v_cvt_pk_bf16_f32 v110, v250, v251
    v_cvt_pk_bf16_f32 v111, v252, v253
    v_mfma_f32_4x4x4_16b_bf16 v[246:249], v[220:221], v[88:89], v[44:47]
    v_cvt_pk_bf16_f32 v112, v132, v133
    v_cvt_pk_bf16_f32 v113, v134, v135
    v_mfma_f32_4x4x4_16b_bf16 v[250:253], v[222:223], v[90:91], v[48:51]
    v_cvt_pk_bf16_f32 v114, v136, v137
    v_cvt_pk_bf16_f32 v115, v138, v139
    v_mfma_f32_4x4x4_16b_bf16 v[132:135], v[216:217], v[92:93], v[52:55]
    v_cvt_pk_bf16_f32 v116, v140, v141
    v_cvt_pk_bf16_f32 v117, v142, v143
    v_mfma_f32_4x4x4_16b_bf16 v[136:139], v[218:219], v[94:95], v[56:59]
    v_cvt_pk_bf16_f32 v118, v144, v145
    v_cvt_pk_bf16_f32 v119, v146, v147
    v_mfma_f32_4x4x4_16b_bf16 v[140:143], v[220:221], v[96:97], v[60:63]
    v_cvt_pk_bf16_f32 v120, v246, v247
    v_cvt_pk_bf16_f32 v121, v248, v249
    v_mfma_f32_4x4x4_16b_bf16 v[144:147], v[222:223], v[98:99], v[64:67]
    v_cvt_pk_bf16_f32 v122, v250, v251
    v_cvt_pk_bf16_f32 v123, v252, v253
    v_cvt_pk_bf16_f32 v124, v132, v133
    v_cvt_pk_bf16_f32 v125, v134, v135
    v_cvt_pk_bf16_f32 v126, v136, v137
    v_cvt_pk_bf16_f32 v127, v138, v139
    v_cvt_pk_bf16_f32 v128, v140, v141
    v_cvt_pk_bf16_f32 v129, v142, v143
    v_cvt_pk_bf16_f32 v130, v144, v145
    v_cvt_pk_bf16_f32 v131, v146, v147
    s_waitcnt lgkmcnt(0)
    s_branch Ls_evd3
Ls_last0:
    s_branch Ls_tail
Ls_last1:
    v_add_u32 v236, 2080, v236
    s_lshr_b64 s[56:57], s[56:57], 1
    v_add_u32 v244, 16, v244
    s_branch Ls_tail
Ls_last2:
    v_add_u32 v236, 4160, v236
    s_lshr_b64 s[56:57], s[56:57], 2
    v_add_u32 v244, 32, v244
    s_branch Ls_tail
Ls_last3:
    v_add_u32 v236, 6240, v236
    s_lshr_b64 s[56:57], s[56:57], 3
    v_add_u32 v244, 48, v244
Ls_tail:
    ds_read_b32 v246, v244 offset:0
    s_waitcnt lgkmcnt(0)
    v_bfe_u32 v247, v246, 0, 8
    v_lshlrev_b32 v247, 1, v247
    v_bfe_u32 v248, v246, 8, 8
    v_lshlrev_b32 v248, 1, v248
    v_bfe_u32 v249, v246, 16, 8
    v_lshlrev_b32 v249, 1, v249
    v_bfe_u32 v250, v246, 24, 8
    v_lshlrev_b32 v250, 1, v250
    buffer_load_ushort v247, v247, s[24:27], 0 offen
    buffer_load_ushort v248, v248, s[24:27], 0 offen
    buffer_load_ushort v249, v249, s[24:27], 0 offen
    buffer_load_ushort v250, v250, s[24:27], 0 offen
    s_waitcnt vmcnt(0)
    v_lshlrev_b32 v247, 16, v247
    v_mul_f32 v208, v208, v247
    v_lshlrev_b32 v248, 16, v248
    v_mul_f32 v209, v209, v248
    v_lshlrev_b32 v249, 16, v249
    v_mul_f32 v210, v210, v249
    v_lshlrev_b32 v250, 16, v250
    v_mul_f32 v211, v211, v250
    v_exp_f32 v132, v148
    v_exp_f32 v133, v149
    v_exp_f32 v134, v150
    v_exp_f32 v135, v151
    v_exp_f32 v136, v152
    v_exp_f32 v137, v153
    v_mfma_f32_4x4x4_16b_bf16 v[132:135], v[228:229], v[228:229], v[132:135]
    v_cvt_pk_bf16_f32 v208, v208, v209
    v_cvt_pk_bf16_f32 v209, v210, v211
    v_exp_f32 v138, v154
    s_nop 0
    v_mfma_f32_4x4x4_16b_bf16 v[212:215], v[208:209], v[188:189], v[212:215] cbsz:4 abid:0
    ds_read_b64_tr_b16 v[188:189], v236 offset:0
    v_exp_f32 v139, v155
    v_exp_f32 v140, v156
    v_mfma_f32_4x4x4_16b_bf16 v[212:215], v[208:209], v[190:191], v[212:215] cbsz:4 abid:4
    ds_read_b64_tr_b16 v[190:191], v236 offset:512
    v_mfma_f32_4x4x4_16b_bf16 v[136:139], v[228:229], v[228:229], v[136:139]
    v_rcp_f32 v132, v132
    v_mfma_f32_4x4x4_16b_bf16 v[212:215], v[208:209], v[192:193], v[212:215] cbsz:4 abid:8
    ds_read_b64_tr_b16 v[192:193], v236 offset:1056
    v_exp_f32 v141, v157
    v_rcp_f32 v133, v133
    v_mfma_f32_4x4x4_16b_bf16 v[212:215], v[208:209], v[194:195], v[212:215] cbsz:4 abid:12
    ds_read_b64_tr_b16 v[194:195], v236 offset:1568
    v_exp_f32 v142, v158
    v_rcp_f32 v134, v134
    v_exp_f32 v143, v159
    v_rcp_f32 v135, v135
    v_cvt_pk_bf16_f32 v132, v132, v133
    v_mfma_f32_4x4x4_16b_bf16 v[140:143], v[228:229], v[228:229], v[140:143]
    v_exp_f32 v144, v160
    v_rcp_f32 v136, v136
    v_cvt_pk_bf16_f32 v133, v134, v135
    s_bitcmp0_b64 s[56:57], 1
    s_cbranch_scc1 Ls_tnf
    v_cvt_pk_bf16_f32 v246, v212, v212
    v_mov_b32 v212, 0
    ds_write_b16 v240, v246
    v_add_u32 v240, 128, v240
    s_add_u32 s24, s24, s32
    s_addc_u32 s25, s25, 0
    s_xor_b32 s32, s32, 0x18ffe0
Ls_tnf:
    s_waitcnt lgkmcnt(0)
    v_exp_f32 v145, v161
    v_rcp_f32 v137, v137
    v_exp_f32 v146, v162
    v_rcp_f32 v138, v138
    v_cvt_pk_bf16_f32 v134, v136, v137
    v_exp_f32 v147, v163
    v_rcp_f32 v139, v139
    s_nop 0
    v_mfma_f32_4x4x4_16b_bf16 v[144:147], v[228:229], v[228:229], v[144:147]
    v_rcp_f32 v140, v140
    v_rcp_f32 v141, v141
    v_cvt_pk_bf16_f32 v135, v138, v139
    v_rcp_f32 v142, v142
    v_cvt_pk_bf16_f32 v136, v140, v141
    v_mfma_f32_16x16x32_bf16 v[208:211], v[132:135], v[196:199], v[204:207]
    v_rcp_f32 v143, v143
    v_rcp_f32 v144, v144
    v_cvt_pk_bf16_f32 v137, v142, v143
    v_rcp_f32 v145, v145
    v_rcp_f32 v146, v146
    v_rcp_f32 v147, v147
    v_cvt_pk_bf16_f32 v138, v144, v145
    v_cvt_pk_bf16_f32 v139, v146, v147
    s_nop 1
    v_mfma_f32_16x16x32_bf16 v[208:211], v[136:139], v[200:203], v[208:211]
    ds_read_b32 v246, v244 offset:16
    s_waitcnt lgkmcnt(0)
    v_bfe_u32 v247, v246, 0, 8
    v_lshlrev_b32 v247, 1, v247
    v_bfe_u32 v248, v246, 8, 8
    v_lshlrev_b32 v248, 1, v248
    v_bfe_u32 v249, v246, 16, 8
    v_lshlrev_b32 v249, 1, v249
    v_bfe_u32 v250, v246, 24, 8
    v_lshlrev_b32 v250, 1, v250
    buffer_load_ushort v247, v247, s[24:27], 0 offen
    buffer_load_ushort v248, v248, s[24:27], 0 offen
    buffer_load_ushort v249, v249, s[24:27], 0 offen
    buffer_load_ushort v250, v250, s[24:27], 0 offen
    s_waitcnt vmcnt(0)
    v_lshlrev_b32 v247, 16, v247
    v_mul_f32 v208, v208, v247
    v_lshlrev_b32 v248, 16, v248
    v_mul_f32 v209, v209, v248
    v_lshlrev_b32 v249, 16, v249
    v_mul_f32 v210, v210, v249
    v_lshlrev_b32 v250, 16, v250
    v_mul_f32 v211, v211, v250
    v_cvt_pk_bf16_f32 v208, v208, v209
    v_cvt_pk_bf16_f32 v209, v210, v211
    s_nop 1
    v_mfma_f32_4x4x4_16b_bf16 v[212:215], v[208:209], v[188:189], v[212:215] cbsz:4 abid:0
    s_nop 1
    v_mfma_f32_4x4x4_16b_bf16 v[212:215], v[208:209], v[190:191], v[212:215] cbsz:4 abid:4
    s_nop 1
    v_mfma_f32_4x4x4_16b_bf16 v[212:215], v[208:209], v[192:193], v[212:215] cbsz:4 abid:8
    s_nop 1
    v_mfma_f32_4x4x4_16b_bf16 v[212:215], v[208:209], v[194:195], v[212:215] cbsz:4 abid:12
    s_nop 4
    v_cvt_pk_bf16_f32 v246, v212, v212
    ds_write_b16 v240, v246
    s_branch L_store
.section .rodata,"a"
.p2align 6
.amdhsa_kernel standalone__sequential_behavior_din__recsys_kernel
  .amdhsa_next_free_vgpr 256
  .amdhsa_next_free_sgpr 102
  .amdhsa_accum_offset 256
  .amdhsa_group_segment_fixed_size 0
  .amdhsa_kernarg_size 80
  .amdhsa_user_sgpr_count 2
  .amdhsa_user_sgpr_kernarg_segment_ptr 1
  .amdhsa_system_sgpr_workgroup_id_x 1
.end_amdhsa_kernel
```

```asm
; @launch grid=(256,1,1) block=(512,1,1) lds=163840
.amdgcn_target "amdgcn-amd-amdhsa--gfx950"
.text
.globl standalone__sequential_behavior_din__recsys_kernel
.p2align 8
.type standalone__sequential_behavior_din__recsys_kernel,@function
standalone__sequential_behavior_din__recsys_kernel:
    s_load_dwordx16 s[4:19], s[0:1], 0
    s_cmp_ge_u32 s2, 256
    s_cbranch_scc1 L_end
    v_lshrrev_b32 v1, 6, v0
    v_and_b32 v0, 63, v0
    v_readfirstlane_b32 s54, v1
    s_lshl_b32 s53, s2, 3
    v_lshlrev_b32 v2, 4, v0
    v_lshrrev_b32 v1, 4, v0
    v_and_b32 v3, 0xf0, v2
    v_lshlrev_b32 v3, 2, v3
    v_lshl_add_u32 v130, v1, 4, v3
    v_bfrev_b32 v3, 1
    s_add_u32 s53, s53, s54
    s_movk_i32 s66, 800
    v_cmp_gt_u32 vcc, s66, v130
    s_mul_i32 s93, s53, 800
    s_mul_i32 s52, s54, 20480
    s_mov_b64 s[28:29], vcc
    v_cndmask_b32 v3, v3, v130, vcc
    v_and_b32 v248, 16, v0
    v_lshlrev_b32 v246, 1, v248
    v_xor_b32 v246, v246, v2
    s_lshl_b32 s67, s54, 12
    s_add_u32 m0, s52, 4160
    s_mov_b32 s26, 6553600
    s_mov_b32 s27, 0x20000
    s_waitcnt lgkmcnt(0)
    s_mov_b32 s24, s8
    s_and_b32 s25, s9, 0xffff
    buffer_load_dwordx4 v[100:103], v3, s[24:27], s93 offen nt
    s_add_u32 s10, s10, s67
    s_addc_u32 s11, s11, 0
    v_xor_b32 v247, 64, v246
    global_load_lds_dwordx4 v246, s[10:11] offset:0
    global_load_lds_dwordx4 v247, s[10:11] offset:1024
    global_load_lds_dwordx4 v246, s[10:11] offset:2048
    global_load_lds_dwordx4 v247, s[10:11] offset:3072
    s_load_dword s30, s[16:17], 0
    v_and_b32 v243, 0xf0, v2
    v_lshl_add_u32 v243, v1, 19, v243
    s_lshl_b32 s66, s53, 8
    s_add_u32 m0, s52, 8320
    v_add_u32 v243, s66, v243
    s_and_b32 s67, s54, 3
    global_load_lds_dwordx4 v243, s[4:5] nt
    s_lshl_b32 s66, s67, 5
    v_lshl_add_u32 v249, v1, 3, s66
    global_load_dwordx2 v[96:97], v249, s[12:13]
    v_and_b32 v250, 3, v0
    s_mul_i32 s66, s53, 51200
    s_add_u32 s6, s6, s66
    s_addc_u32 s7, s7, 0
    s_mov_b32 s20, s6
    s_and_b32 s21, s7, 0xffff
    s_or_b32 s21, s21, 0x800000
    s_mov_b32 s22, 200
    s_mov_b32 s23, 0x20000
    s_sub_u32 s40, s20, 1056
    s_subb_u32 s41, s21, 0
    s_mov_b32 s42, 200
    s_mov_b32 s43, 0x20000
    s_movk_i32 s31, 25600
    s_mov_b32 s60, 7
    s_mov_b64 s[56:57], 0
    s_mov_b64 s[58:59], 0
    v_mov_b32 v148, -1
    v_mov_b32 v149, -1
    v_mov_b32 v150, -1
    v_mov_b32 v151, -1
    s_add_u32 s66, s52, 18432
    v_add_u32 v152, s66, v2
    ds_write_b128 v152, v[148:151]
    ds_write_b128 v152, v[148:151] offset:1024
    s_add_u32 s64, s52, 18448
    v_mov_b32 v153, -1
    v_mov_b32 v154, -1
    v_mov_b32 v155, -1
    v_lshrrev_b32 v237, 3, v0
    v_add_u32 v237, s64, v237
    v_lshl_add_u32 v244, v1, 2, s66
    v_and_b32 v231, 0x70, v2
    v_lshlrev_b32 v248, 2, v248
    v_xor_b32 v231, v231, v248
    v_mov_b32 v233, v231
    s_movk_i32 s66, 400
    v_cmp_le_u32 vcc, s66, v130
    v_lshrrev_b32 v126, 1, v130
    s_movk_i32 s66, -200
    v_cndmask_b32 v130, 0, 1, vcc
    v_mad_i32_i24 v126, v130, s66, v126
    v_mul_u32_u24 v127, 0x10001, v126
    v_add_u32 v126, 0x10000, v127
    v_add_u32 v128, 0x50004, v127
    v_add_u32 v129, 0x70006, v127
    v_add_u32 v127, 0x30002, v127
    v_mov_b32 v131, 0xbfe0bfe0
    s_mov_b32 s86, 0xfff0ffff
    s_mov_b32 s87, 0xf000ff00
    s_mov_b32 s88, 0xff00fff0
    s_mov_b32 s89, 0xf000
    s_mov_b32 s90, 0xf0000f
    s_mov_b32 s91, 0xf0000f00
    s_mov_b32 s84, 0x11111113
    s_mov_b32 s85, 0x11111111
    v_cndmask_b32 v116, 0, v131, s[86:87]
    v_cndmask_b32 v120, 0, v131, s[88:89]
    v_cndmask_b32 v117, 0, v131, s[86:87]
    v_cndmask_b32 v121, 0, v131, s[88:89]
    v_cndmask_b32 v122, 0, v131, s[84:85]
    v_cndmask_b32 v123, 0, v131, s[84:85]
    v_cndmask_b32 v124, 0, v131, s[84:85]
    v_cndmask_b32 v125, 0, v131, s[84:85]
    v_lshlrev_b32 v246, 4, v250
    v_sub_u32 v246, 48, v246
    s_mov_b32 s86, 0xbfe0bfe0
    s_mov_b32 s87, 0xf0bfe0
    v_lshrrev_b64 v[118:119], v246, s[86:87]
    v_mov_b32 v131, 0
    s_mov_b64 s[84:85], 0
    v_cndmask_b32 v118, v120, v118, s[90:91]
    v_cndmask_b32 v119, v121, v119, s[90:91]
    s_mov_b32 s61, 7
    s_mov_b32 s92, 0xbfb8aa3b
    v_and_b32 v251, 15, v0
    v_bfe_u32 v252, v0, 2, 2
    v_lshlrev_b32 v253, 3, v250
    v_lshl_add_u32 v253, v252, 7, v253
    v_and_b32 v246, 24, v0
    v_lshlrev_b32 v246, 2, v246
    v_xor_b32 v246, v253, v246
    v_lshl_add_u32 v246, v1, 10, v246
    s_lshl_b32 s66, s67, 5
    v_xor_b32 v66, s66, v246
    v_add_u32 v66, 45120, v66
    s_lshr_b32 s66, s54, 1
    s_lshl_b32 s66, s66, 5
    v_xor_b32 v64, s66, v246
    s_and_b32 s66, s54, 1
    s_mul_i32 s66, s66, 20480
    s_add_u32 s66, s66, 4160
    v_add_u32 v64, s66, v64
    v_add_u32 v65, 81920, v64
    s_and_b32 s66, s54, 4
    v_lshrrev_b32 v246, 3, v251
    v_add_u32 v246, s66, v246
    v_mul_u32_u24 v246, 20480, v246
    v_lshl_add_u32 v246, v1, 4, v246
    v_and_b32 v247, 7, v0
    v_lshl_add_u32 v67, v247, 7, v246
    v_and_b32 v247, 1, v0
    v_lshlrev_b32 v247, 4, v247
    v_lshlrev_b32 v247, v247, 1
    v_cmp_gt_u32 vcc, 2, v250
    v_mov_b32 v229, 0
    v_mov_b32 v228, 0x3f80
    v_cndmask_b32 v241, 0, v247, vcc
    v_cmp_eq_u32 vcc, 0, v251
    v_sub_u32 v242, v247, v241
    v_mul_u32_u24 v218, 0x3f80, v241
    v_cndmask_b32 v220, 0, -1, vcc
    v_mul_u32_u24 v219, 0x3f80, v242
    s_and_b32 s66, s54, 3
    s_lshl_b32 s66, s66, 6
    s_add_u32 s66, s66, 9344
    v_and_b32 v247, 7, v0
    v_mul_u32_u24 v247, 144, v247
    v_add3_u32 v98, v67, v247, s66
    s_and_b32 s66, s54, 3
    s_mul_i32 s66, s66, 20480
    s_add_u32 s66, s66, 14592
    v_mov_b32 v221, s66
    s_cmp_ge_u32 s54, 4
    s_cselect_b32 s33, -1, 0
    ds_write_b32 v221, v229
    v_and_b32 v247, 8, v0
    v_lshlrev_b32 v247, 2, v247
    v_lshl_add_u32 v247, v251, 7, v247
    v_add_u32 v247, s52, v247
    v_and_b32 v248, 2, v0
    v_lshlrev_b32 v248, 1, v248
    v_xor_b32 v248, v248, v1
    v_lshl_add_u32 v234, v248, 4, v247
    v_xor_b32 v248, 4, v248
    v_lshl_add_u32 v235, v248, 4, v247
    v_and_b32 v247, 8, v0
    v_lshlrev_b32 v247, 3, v247
    v_lshl_add_u32 v248, v1, 5, v253
    v_xor_b32 v248, v248, v247
    v_add_u32 v236, s52, v248
    s_add_u32 s66, s52, 8320
    v_lshl_add_u32 v238, v250, 1, s66
    v_lshl_add_u32 v238, v1, 4, v238
    v_lshl_add_u32 v240, v0, 1, s66
    s_add_u32 s66, s52, 9344
    v_lshl_add_u32 v239, v1, 4, s66
    v_mov_b32 v188, 0
    v_mov_b32 v189, 0
    v_mov_b32 v190, 0
    v_mov_b32 v191, 0
    v_mov_b32 v192, 0
    v_mov_b32 v193, 0
    v_mov_b32 v194, 0
    v_mov_b32 v195, 0
    v_mov_b32 v208, 0
    v_mov_b32 v212, 0
    v_mov_b32 v209, 0
    v_mov_b32 v213, 0
    v_mov_b32 v210, 0
    v_mov_b32 v214, 0
    v_mov_b32 v211, 0
    v_mov_b32 v215, 0
    s_add_u32 s93, s93, 1638400
    buffer_load_dwordx4 v[104:107], v3, s[24:27], s93 offen nt
    s_add_u32 s93, s93, 1638400
    buffer_load_dwordx4 v[108:111], v3, s[24:27], s93 offen nt
    s_add_u32 s93, s93, 1638400
    buffer_load_dwordx4 v[112:115], v3, s[24:27], s93 offen nt
    v_lshlrev_b32 v249, 3, v1
    v_lshl_add_u32 v249, v250, 5, v249
    global_load_dwordx2 v[216:217], v249, s[14:15]
    s_cmp_ge_u32 s54, 4
    s_cbranch_scc1 L_young1
    s_waitcnt vmcnt(10) lgkmcnt(0)
    s_call_b64 s[62:63], L_fp
    s_waitcnt vmcnt(9)
    s_branch L_old1
L_young1:
    s_waitcnt vmcnt(5)
L_old1:
    s_waitcnt lgkmcnt(0)
    s_barrier
    ds_read_b64_tr_b16 v[16:17], v66 offset:0
    ds_read_b64_tr_b16 v[18:19], v66 offset:512
    ds_read_b64_tr_b16 v[20:21], v66 offset:20480
    ds_read_b64_tr_b16 v[22:23], v66 offset:20992
    ds_read_b64_tr_b16 v[24:25], v66 offset:40960
    ds_read_b64_tr_b16 v[26:27], v66 offset:41472
    ds_read_b64_tr_b16 v[28:29], v66 offset:61440
    ds_read_b64_tr_b16 v[30:31], v66 offset:61952
    ds_read_b128 v[32:35], v67 offset:8320
    ds_read_b128 v[36:39], v67 offset:8384
    ds_read_b128 v[40:43], v67 offset:49280
    ds_read_b128 v[44:47], v67 offset:49344
    ds_read_b64_tr_b16 v[4:5], v64 offset:0
    ds_read_b64_tr_b16 v[8:9], v65 offset:0
    ds_read_b64_tr_b16 v[12:13], v65 offset:40960
    ds_read_b64_tr_b16 v[6:7], v64 offset:512
    ds_read_b64_tr_b16 v[10:11], v65 offset:512
    ds_read_b64_tr_b16 v[14:15], v65 offset:41472
    s_cmp_ge_u32 s54, 4
    s_cbranch_scc1 L_young2
    s_waitcnt vmcnt(8)
    s_branch L_old2
L_young2:
    s_waitcnt vmcnt(4)
L_old2:
    v_lshlrev_b32 v48, 16, v96
    v_and_b32 v49, 0xffff0000, v96
    v_lshlrev_b32 v50, 16, v97
    v_and_b32 v51, 0xffff0000, v97
    s_lshl_b32 s30, s30, 16
    v_and_b32 v204, s30, v220
    v_and_b32 v205, s30, v220
    v_and_b32 v206, s30, v220
    v_and_b32 v207, s30, v220
    s_waitcnt lgkmcnt(0)
    v_xor_b32 v24, 0x80008000, v24
    v_xor_b32 v25, 0x80008000, v25
    v_xor_b32 v26, 0x80008000, v26
    v_xor_b32 v27, 0x80008000, v27
    v_xor_b32 v28, 0x80008000, v28
    v_xor_b32 v29, 0x80008000, v29
    v_xor_b32 v30, 0x80008000, v30
    v_xor_b32 v31, 0x80008000, v31
    v_mfma_f32_4x4x4_16b_bf16 v[56:59], v[218:219], v[4:5], 0
    v_mfma_f32_4x4x4_16b_bf16 v[68:71], v[218:219], v[12:13], 0
    v_mfma_f32_4x4x4_16b_bf16 v[60:63], v[218:219], v[6:7], 0
    v_mfma_f32_4x4x4_16b_bf16 v[72:75], v[218:219], v[14:15], 0
    v_mfma_f32_4x4x4_16b_bf16 v[56:59], v[218:219], v[8:9], v[56:59]
    v_mfma_f32_4x4x4_16b_bf16 v[60:63], v[218:219], v[10:11], v[60:63]
    v_mfma_f32_16x16x32_bf16 v[52:55], v[16:19], v[40:43], v[48:51]
    v_mfma_f32_16x16x32_bf16 v[52:55], v[20:23], v[44:47], v[52:55]
    v_mfma_f32_16x16x32_bf16 v[52:55], v[24:27], v[40:43], v[52:55]
    v_mfma_f32_16x16x32_bf16 v[52:55], v[28:31], v[44:47], v[52:55]
    v_mfma_f32_16x16x32_bf16 v[48:51], v[16:19], v[32:35], v[48:51]
    v_mfma_f32_16x16x32_bf16 v[48:51], v[20:23], v[36:39], v[48:51]
    v_mfma_f32_16x16x32_bf16 v[48:51], v[24:27], v[32:35], v[48:51]
    v_mfma_f32_16x16x32_bf16 v[48:51], v[28:31], v[36:39], v[48:51]
    v_mul_f32 v56, s92, v56
    v_mul_f32 v57, s92, v57
    v_mul_f32 v58, s92, v58
    v_mul_f32 v59, s92, v59
    v_mul_f32 v60, s92, v60
    v_mul_f32 v61, s92, v61
    v_mul_f32 v62, s92, v62
    v_mul_f32 v63, s92, v63
    v_mul_f32 v68, s92, v68
    v_mul_f32 v69, s92, v69
    v_mul_f32 v70, s92, v70
    v_mul_f32 v71, s92, v71
    v_mul_f32 v72, s92, v72
    v_mul_f32 v73, s92, v73
    v_mul_f32 v74, s92, v74
    v_mul_f32 v75, s92, v75
    s_add_u32 s66, s52, 11520
    v_add_u32 v3, s66, v2
    v_cvt_pk_bf16_f32 v68, v68, v69
    v_cvt_pk_bf16_f32 v69, v70, v71
    v_cvt_pk_bf16_f32 v70, v72, v73
    v_cvt_pk_bf16_f32 v71, v74, v75
    v_mul_f32 v48, s92, v48
    v_mul_f32 v49, s92, v49
    v_mul_f32 v50, s92, v50
    v_mul_f32 v51, s92, v51
    v_mul_f32 v52, s92, v52
    v_mul_f32 v53, s92, v53
    v_mul_f32 v54, s92, v54
    v_mul_f32 v55, s92, v55
    ds_write_b128 v3, v[56:59]
    ds_write_b128 v3, v[60:63] offset:1024
    ds_write_b128 v3, v[68:71] offset:2048
    ds_write_b128 v98, v[48:51]
    ds_write_b128 v98, v[52:55] offset:40960
    v_add_u32 v3, 11520, v2
    v_add_u32 v246, 81920, v3
    s_waitcnt lgkmcnt(0)
    s_barrier
    s_cmp_ge_u32 s54, 4
    s_cbranch_scc0 L_old3
    s_call_b64 s[62:63], L_fp
    s_branch L_yng3
L_old3:
    s_call_b64 s[62:63], L_t23
L_yng3:
    ds_read_b128 v[4:7], v3 offset:0
    ds_read_b128 v[8:11], v3 offset:1024
    ds_read_b128 v[68:71], v3 offset:2048
    ds_read_b128 v[12:15], v3 offset:20480
    ds_read_b128 v[16:19], v3 offset:21504
    ds_read_b128 v[72:75], v3 offset:22528
    ds_read_b128 v[20:23], v3 offset:40960
    ds_read_b128 v[24:27], v3 offset:41984
    ds_read_b128 v[76:79], v3 offset:43008
    s_waitcnt vmcnt(4)
    v_mfma_i32_16x16x64_i8 v[172:175], v[122:125], v[104:107], 0
    v_mfma_i32_16x16x64_i8 v[176:179], v[122:125], v[108:111], 0
    v_mfma_i32_16x16x64_i8 v[180:183], v[122:125], v[112:115], 0
    v_and_b32 v160, 0x800080, v104
    v_mul_u32_u24 v160, 0x7f, v160
    v_bitop3_b32 v131, v104, v160, v131 bitop3:0xbe
    v_and_b32 v161, 0x800080, v105
    v_mul_u32_u24 v161, 0x7f, v161
    v_bitop3_b32 v131, v105, v161, v131 bitop3:0xbe
    v_and_b32 v160, 0x800080, v106
    v_mul_u32_u24 v160, 0x7f, v160
    v_bitop3_b32 v131, v106, v160, v131 bitop3:0xbe
    v_mov_b32_dpp v184, v172 row_shr:1 row_mask:0xf bank_mask:0xf bound_ctrl:0
    v_mov_b32_dpp v185, v176 row_shr:1 row_mask:0xf bank_mask:0xf bound_ctrl:0
    v_mov_b32_dpp v186, v180 row_shr:1 row_mask:0xf bank_mask:0xf bound_ctrl:0
    v_add_u32_dpp v184, v184, v184 row_shr:1 row_mask:0xf bank_mask:0xf bound_ctrl:0
    v_add_u32_dpp v185, v185, v185 row_shr:1 row_mask:0xf bank_mask:0xf bound_ctrl:0
    v_add_u32_dpp v186, v186, v186 row_shr:1 row_mask:0xf bank_mask:0xf bound_ctrl:0
    v_add_u32_dpp v184, v184, v184 row_shr:2 row_mask:0xf bank_mask:0xf bound_ctrl:0
    v_add_u32_dpp v185, v185, v185 row_shr:2 row_mask:0xf bank_mask:0xf bound_ctrl:0
    v_add_u32_dpp v186, v186, v186 row_shr:2 row_mask:0xf bank_mask:0xf bound_ctrl:0
    v_add_u32_dpp v184, v184, v184 row_shr:4 row_mask:0xf bank_mask:0xf bound_ctrl:0
    v_add_u32_dpp v185, v185, v185 row_shr:4 row_mask:0xf bank_mask:0xf bound_ctrl:0
    v_add_u32_dpp v186, v186, v186 row_shr:4 row_mask:0xf bank_mask:0xf bound_ctrl:0
    v_add_u32_dpp v184, v184, v184 row_shr:8 row_mask:0xf bank_mask:0xf bound_ctrl:0
    v_add_u32_dpp v185, v185, v185 row_shr:8 row_mask:0xf bank_mask:0xf bound_ctrl:0
    v_add_u32_dpp v186, v186, v186 row_shr:8 row_mask:0xf bank_mask:0xf bound_ctrl:0
    ds_read_b128 v[28:31], v3 offset:61440
    ds_read_b128 v[32:35], v3 offset:62464
    ds_read_b128 v[80:83], v3 offset:63488
    ds_read_b128 v[36:39], v246 offset:0
    ds_read_b128 v[40:43], v246 offset:1024
    ds_read_b128 v[84:87], v246 offset:2048
    v_and_b32 v161, 0x800080, v107
    v_mul_u32_u24 v161, 0x7f, v161
    v_bitop3_b32 v131, v107, v161, v131 bitop3:0xbe
    v_and_b32 v160, 0x800080, v108
    v_mul_u32_u24 v160, 0x7f, v160
    v_bitop3_b32 v131, v108, v160, v131 bitop3:0xbe
    v_and_b32 v161, 0x800080, v109
    v_mul_u32_u24 v161, 0x7f, v161
    v_bitop3_b32 v131, v109, v161, v131 bitop3:0xbe
    v_and_b32 v160, 0x800080, v110
    v_mul_u32_u24 v160, 0x7f, v160
    v_bitop3_b32 v131, v110, v160, v131 bitop3:0xbe
    v_and_b32 v161, 0x800080, v111
    v_mul_u32_u24 v161, 0x7f, v161
    v_bitop3_b32 v131, v111, v161, v131 bitop3:0xbe
    v_and_b32 v160, 0x800080, v112
    v_mul_u32_u24 v160, 0x7f, v160
    v_bitop3_b32 v131, v112, v160, v131 bitop3:0xbe
    v_and_b32 v161, 0x800080, v113
    v_mul_u32_u24 v161, 0x7f, v161
    v_bitop3_b32 v131, v113, v161, v131 bitop3:0xbe
    v_and_b32 v160, 0x800080, v114
    v_mul_u32_u24 v160, 0x7f, v160
    v_bitop3_b32 v131, v114, v160, v131 bitop3:0xbe
    v_and_b32 v161, 0x800080, v115
    v_mul_u32_u24 v161, 0x7f, v161
    v_bitop3_b32 v131, v115, v161, v131 bitop3:0xbe
    v_cmp_ne_u32 vcc, 0, v131
    v_readlane_b32 s68, v184, 6
    v_readlane_b32 s69, v173, 6
    v_readlane_b32 s70, v184, 15
    v_readlane_b32 s72, v185, 6
    v_readlane_b32 s73, v177, 6
    v_readlane_b32 s74, v185, 15
    v_readlane_b32 s76, v186, 6
    v_readlane_b32 s77, v181, 6
    v_readlane_b32 s78, v186, 15
    s_cbranch_vccnz L_general
    s_add_u32 s66, s68, s69
    s_add_u32 s66, s66, s64
    s_add_u32 s67, s66, 15
    s_and_b32 s67, s67, -16
    s_add_u32 s55, s64, 16
    s_max_u32 s67, s67, s55
    s_sub_u32 s66, s67, s66
    v_mad_u32_u24 v184, v130, s66, v184
    s_sub_u32 s55, s64, 2048
    v_add_u32 v172, s55, v184
    v_add_u32 v173, s55, v184
    v_add_u32 v174, s55, v184
    v_add_u32 v175, s55, v184
    s_add_u32 s64, s64, s70
    s_add_u32 s64, s64, s66
    v_mfma_i32_16x16x64_i8 v[132:135], v[118:121], v[104:107], v[172:175]
    v_mfma_i32_16x16x64_i8 v[136:139], v[116:119], v[104:107], v[172:175]
    s_add_u32 s64, s64, 15
    s_and_b32 s64, s64, -16
    s_add_u32 s55, s67, 16
    s_max_u32 s64, s64, s55
    s_lshr_b32 s95, s67, 4
    s_bitset1_b64 s[56:57], s95
    s_lshr_b32 s95, s64, 4
    s_bitset1_b64 s[56:57], s95
    s_add_u32 s66, s72, s73
    s_add_u32 s66, s66, s64
    s_add_u32 s67, s66, 15
    s_and_b32 s67, s67, -16
    s_add_u32 s55, s64, 16
    s_max_u32 s67, s67, s55
    s_sub_u32 s66, s67, s66
    v_mad_u32_u24 v185, v130, s66, v185
    s_sub_u32 s55, s64, 2048
    v_add_u32 v176, s55, v185
    v_add_u32 v177, s55, v185
    v_add_u32 v178, s55, v185
    v_add_u32 v179, s55, v185
    s_add_u32 s64, s64, s74
    s_add_u32 s64, s64, s66
    v_mfma_i32_16x16x64_i8 v[140:143], v[118:121], v[108:111], v[176:179]
    v_mfma_i32_16x16x64_i8 v[144:147], v[116:119], v[108:111], v[176:179]
    s_add_u32 s64, s64, 15
    s_and_b32 s64, s64, -16
    s_add_u32 s55, s67, 16
    s_max_u32 s64, s64, s55
    s_lshr_b32 s95, s67, 4
    s_lshl_b64 s[86:87], 1, s95
    s_bitcmp1_b32 s67, 10
    s_cselect_b64 s[88:89], 0, s[86:87]
    s_cselect_b64 s[90:91], s[86:87], 0
    s_or_b64 s[56:57], s[56:57], s[88:89]
    s_or_b64 s[58:59], s[58:59], s[90:91]
    s_lshr_b32 s95, s64, 4
    s_lshl_b64 s[86:87], 1, s95
    s_bitcmp1_b32 s64, 10
    s_cselect_b64 s[88:89], 0, s[86:87]
    s_cselect_b64 s[90:91], s[86:87], 0
    s_or_b64 s[56:57], s[56:57], s[88:89]
    s_or_b64 s[58:59], s[58:59], s[90:91]
    ds_write_b8 v132, v126
    ds_write_b8_d16_hi v133, v126
    ds_write_b8 v134, v127
    ds_write_b8_d16_hi v135, v127
    ds_write_b8 v136, v128
    ds_write_b8_d16_hi v137, v128
    ds_write_b8 v138, v129
    ds_write_b8_d16_hi v139, v129
    s_add_u32 s66, s76, s77
    s_add_u32 s66, s66, s64
    s_add_u32 s67, s66, 15
    s_and_b32 s67, s67, -16
    s_add_u32 s55, s64, 16
    s_max_u32 s67, s67, s55
    s_sub_u32 s66, s67, s66
    v_mad_u32_u24 v186, v130, s66, v186
    s_sub_u32 s55, s64, 2048
    v_add_u32 v180, s55, v186
    v_add_u32 v181, s55, v186
    v_add_u32 v182, s55, v186
    v_add_u32 v183, s55, v186
    s_add_u32 s64, s64, s78
    s_add_u32 s64, s64, s66
    v_mfma_i32_16x16x64_i8 v[164:167], v[118:121], v[112:115], v[180:183]
    v_mfma_i32_16x16x64_i8 v[168:171], v[116:119], v[112:115], v[180:183]
    s_add_u32 s64, s64, 15
    s_and_b32 s64, s64, -16
    s_add_u32 s55, s67, 16
    s_max_u32 s64, s64, s55
    s_lshr_b32 s95, s67, 4
    s_lshl_b64 s[86:87], 1, s95
    s_bitcmp1_b32 s67, 10
    s_cselect_b64 s[88:89], 0, s[86:87]
    s_cselect_b64 s[90:91], s[86:87], 0
    s_or_b64 s[56:57], s[56:57], s[88:89]
    s_or_b64 s[58:59], s[58:59], s[90:91]
    s_lshr_b32 s95, s64, 4
    s_lshl_b64 s[86:87], 1, s95
    s_bitcmp1_b32 s64, 10
    s_cselect_b64 s[88:89], 0, s[86:87]
    s_cselect_b64 s[90:91], s[86:87], 0
    s_or_b64 s[56:57], s[56:57], s[88:89]
    s_or_b64 s[58:59], s[58:59], s[90:91]
    ds_write_b8 v140, v126
    ds_write_b8_d16_hi v141, v126
    ds_write_b8 v142, v127
    ds_write_b8_d16_hi v143, v127
    ds_write_b8 v144, v128
    ds_write_b8_d16_hi v145, v128
    ds_write_b8 v146, v129
    ds_write_b8_d16_hi v147, v129
    ds_read_b128 v[44:47], v246 offset:20480
    ds_read_b128 v[48:51], v246 offset:21504
    ds_read_b128 v[88:91], v246 offset:22528
    ds_read_b128 v[52:55], v246 offset:40960
    ds_read_b128 v[56:59], v246 offset:41984
    ds_read_b128 v[92:95], v246 offset:43008
    ds_read_b128 v[60:63], v246 offset:61440
    ds_read_b128 v[64:67], v246 offset:62464
    ds_read_b128 v[96:99], v246 offset:63488
    ds_read_u16 v224, v238 offset:0
    ds_read_u16 v225, v238 offset:8
    ds_read_u16 v226, v238 offset:64
    ds_read_u16 v227, v238 offset:72
    ds_write_b8 v164, v126
    ds_write_b8_d16_hi v165, v126
    ds_write_b8 v166, v127
    ds_write_b8_d16_hi v167, v127
    ds_write_b8 v168, v128
    ds_write_b8_d16_hi v169, v128
    ds_write_b8 v170, v129
    ds_write_b8_d16_hi v171, v129
    s_cmp_ge_u32 s54, 4
    s_cbranch_scc0 L_old3b
    s_call_b64 s[62:63], L_t23
L_old3b:
L_listed:
    s_sub_u32 s66, s64, s52
    s_sub_u32 s66, s66, 18448
    s_lshr_b32 s66, s66, 3
    s_xor_b32 s66, s66, s33
    s_sub_u32 s66, s66, s33
    s_sub_u32 s66, s66, 1
    s_xor_b32 s67, 0xfffffff8, s33
    s_sub_u32 s67, s67, s33
    v_mov_b32 v2, v221
    v_mov_b32 v1, s66
    v_mov_b32 v3, s67
    s_mov_b64 exec, 1
    ds_add_u32 v2, v1
    s_mov_b64 exec, -1
    s_cmp_eq_u32 s94, 1
    s_cbranch_scc1 L_nolate
    ds_read_u8 v148, v237 offset:0
    ds_read_u8 v149, v237 offset:8
    ds_read_u8 v150, v237 offset:16
    ds_read_u8 v151, v237 offset:24
    ds_read_u8 v152, v237 offset:32
    ds_read_u8 v153, v237 offset:40
    ds_read_u8 v154, v237 offset:48
    ds_read_u8 v155, v237 offset:56
    s_waitcnt lgkmcnt(0)
    s_add_u32 m0, s52, 0
    v_mov_b32 v230, v148
    v_mov_b32 v232, v149
    buffer_load_dwordx4 v[230:231], s[20:23], 0 idxen offen nt lds
    buffer_load_dwordx4 v[232:233], s[40:43], 0 idxen offen offset:1056 nt lds
    s_bitcmp0_b64 s[56:57], 2
    s_cbranch_scc1 L_noadvl1
    s_sub_u32 s60, s60, 1
    s_cselect_b32 s31, 0, s31
    s_add_u32 s20, s20, s31
    s_addc_u32 s21, s21, 0
    s_add_u32 s40, s40, s31
    s_addc_u32 s41, s41, 0
    s_xor_b32 s31, s31, 0x63ff800
L_noadvl1:
    s_add_u32 m0, s52, 2080
    v_mov_b32 v230, v150
    v_mov_b32 v232, v151
    buffer_load_dwordx4 v[230:231], s[20:23], 0 idxen offen nt lds
    buffer_load_dwordx4 v[232:233], s[40:43], 0 idxen offen offset:1056 nt lds
    s_bitcmp0_b64 s[56:57], 3
    s_cbranch_scc1 L_noadvl2
    s_sub_u32 s60, s60, 1
    s_cselect_b32 s31, 0, s31
    s_add_u32 s20, s20, s31
    s_addc_u32 s21, s21, 0
    s_add_u32 s40, s40, s31
    s_addc_u32 s41, s41, 0
    s_xor_b32 s31, s31, 0x63ff800
L_noadvl2:
    s_add_u32 m0, s52, 4160
    v_mov_b32 v230, v152
    v_mov_b32 v232, v153
    buffer_load_dwordx4 v[230:231], s[20:23], 0 idxen offen nt lds
    buffer_load_dwordx4 v[232:233], s[40:43], 0 idxen offen offset:1056 nt lds
    s_bitcmp0_b64 s[56:57], 4
    s_cbranch_scc1 L_noadvl3
    s_sub_u32 s60, s60, 1
    s_cselect_b32 s31, 0, s31
    s_add_u32 s20, s20, s31
    s_addc_u32 s21, s21, 0
    s_add_u32 s40, s40, s31
    s_addc_u32 s41, s41, 0
    s_xor_b32 s31, s31, 0x63ff800
L_noadvl3:
    s_add_u32 m0, s52, 6240
    v_mov_b32 v230, v154
    v_mov_b32 v232, v155
    buffer_load_dwordx4 v[230:231], s[20:23], 0 idxen offen nt lds
    buffer_load_dwordx4 v[232:233], s[40:43], 0 idxen offen offset:1056 nt lds
L_nolate:
    v_and_b32_dpp v196, v216, v220 quad_perm:[0,0,0,0] row_mask:0xf bank_mask:0xf
    v_and_b32_dpp v197, v217, v220 quad_perm:[0,0,0,0] row_mask:0xf bank_mask:0xf
    v_and_b32_dpp v198, v216, v220 quad_perm:[1,1,1,1] row_mask:0xf bank_mask:0xf
    v_and_b32_dpp v199, v217, v220 quad_perm:[1,1,1,1] row_mask:0xf bank_mask:0xf
    v_and_b32_dpp v200, v216, v220 quad_perm:[2,2,2,2] row_mask:0xf bank_mask:0xf
    v_and_b32_dpp v201, v217, v220 quad_perm:[2,2,2,2] row_mask:0xf bank_mask:0xf
    v_and_b32_dpp v202, v216, v220 quad_perm:[3,3,3,3] row_mask:0xf bank_mask:0xf
    v_and_b32_dpp v203, v217, v220 quad_perm:[3,3,3,3] row_mask:0xf bank_mask:0xf
    s_waitcnt vmcnt(6) lgkmcnt(0)
    ds_read_b128 v[180:183], v234 offset:0
    ds_read_b128 v[184:187], v235 offset:0
    v_mul_u32_u24 v216, v224, v241
    v_mul_u32_u24 v217, v224, v242
    v_mul_u32_u24 v218, v225, v241
    v_mul_u32_u24 v219, v225, v242
    v_mul_u32_u24 v220, v226, v241
    v_mul_u32_u24 v221, v226, v242
    v_mul_u32_u24 v222, v227, v241
    v_mul_u32_u24 v223, v227, v242
    v_add_u32 v238, 128, v238
    ds_read_b128 v[164:167], v239
    v_mfma_f32_4x4x4_16b_bf16 v[132:135], v[216:217], v[68:69], v[4:7]
    ds_read_b128 v[168:171], v239 offset:64
    ds_read_b128 v[172:175], v239 offset:128
    v_mfma_f32_4x4x4_16b_bf16 v[136:139], v[218:219], v[70:71], v[8:11]
    ds_read_b128 v[176:179], v239 offset:192
    ds_read_u16 v224, v238
    v_mfma_f32_4x4x4_16b_bf16 v[140:143], v[220:221], v[72:73], v[12:15]
    ds_read_u16 v225, v238 offset:8
    ds_read_u16 v226, v238 offset:64
    v_mfma_f32_4x4x4_16b_bf16 v[144:147], v[222:223], v[74:75], v[16:19]
    ds_read_u16 v227, v238 offset:72
    v_add_u32 v239, 272, v239
    v_mfma_f32_4x4x4_16b_bf16 v[246:249], v[216:217], v[76:77], v[20:23]
    v_cvt_pk_bf16_f32 v100, v132, v133
    v_cvt_pk_bf16_f32 v101, v134, v135
    v_mfma_f32_4x4x4_16b_bf16 v[250:253], v[218:219], v[78:79], v[24:27]
    v_cvt_pk_bf16_f32 v102, v136, v137
    v_cvt_pk_bf16_f32 v103, v138, v139
    v_mfma_f32_4x4x4_16b_bf16 v[132:135], v[220:221], v[80:81], v[28:31]
    v_cvt_pk_bf16_f32 v104, v140, v141
    v_cvt_pk_bf16_f32 v105, v142, v143
    v_mfma_f32_4x4x4_16b_bf16 v[136:139], v[222:223], v[82:83], v[32:35]
    v_cvt_pk_bf16_f32 v106, v144, v145
    v_cvt_pk_bf16_f32 v107, v146, v147
    v_mfma_f32_4x4x4_16b_bf16 v[140:143], v[216:217], v[84:85], v[36:39]
    v_cvt_pk_bf16_f32 v108, v246, v247
    v_cvt_pk_bf16_f32 v109, v248, v249
    v_mfma_f32_4x4x4_16b_bf16 v[144:147], v[218:219], v[86:87], v[40:43]
    v_cvt_pk_bf16_f32 v110, v250, v251
    v_cvt_pk_bf16_f32 v111, v252, v253
    v_mfma_f32_4x4x4_16b_bf16 v[246:249], v[220:221], v[88:89], v[44:47]
    v_cvt_pk_bf16_f32 v112, v132, v133
    v_cvt_pk_bf16_f32 v113, v134, v135
    v_mfma_f32_4x4x4_16b_bf16 v[250:253], v[222:223], v[90:91], v[48:51]
    v_cvt_pk_bf16_f32 v114, v136, v137
    v_cvt_pk_bf16_f32 v115, v138, v139
    v_mfma_f32_4x4x4_16b_bf16 v[132:135], v[216:217], v[92:93], v[52:55]
    v_cvt_pk_bf16_f32 v116, v140, v141
    v_cvt_pk_bf16_f32 v117, v142, v143
    v_mfma_f32_4x4x4_16b_bf16 v[136:139], v[218:219], v[94:95], v[56:59]
    v_cvt_pk_bf16_f32 v118, v144, v145
    v_cvt_pk_bf16_f32 v119, v146, v147
    v_mfma_f32_4x4x4_16b_bf16 v[140:143], v[220:221], v[96:97], v[60:63]
    v_cvt_pk_bf16_f32 v120, v246, v247
    v_cvt_pk_bf16_f32 v121, v248, v249
    v_mfma_f32_4x4x4_16b_bf16 v[144:147], v[222:223], v[98:99], v[64:67]
    v_cvt_pk_bf16_f32 v122, v250, v251
    v_cvt_pk_bf16_f32 v123, v252, v253
    v_cvt_pk_bf16_f32 v124, v132, v133
    v_cvt_pk_bf16_f32 v125, v134, v135
    v_cvt_pk_bf16_f32 v126, v136, v137
    v_cvt_pk_bf16_f32 v127, v138, v139
    v_cvt_pk_bf16_f32 v128, v140, v141
    v_cvt_pk_bf16_f32 v129, v142, v143
    v_cvt_pk_bf16_f32 v130, v144, v145
    v_cvt_pk_bf16_f32 v131, v146, v147
    s_waitcnt lgkmcnt(0)
    v_mfma_f32_16x16x32_bf16 v[148:151], v[100:103], v[180:183], v[164:167]
    v_mfma_f32_16x16x32_bf16 v[148:151], v[104:107], v[184:187], v[148:151]
    v_mfma_f32_16x16x32_bf16 v[152:155], v[108:111], v[180:183], v[168:171]
    v_mfma_f32_16x16x32_bf16 v[152:155], v[112:115], v[184:187], v[152:155]
    v_mfma_f32_16x16x32_bf16 v[156:159], v[116:119], v[180:183], v[172:175]
    v_mfma_f32_16x16x32_bf16 v[156:159], v[120:123], v[184:187], v[156:159]
    v_mfma_f32_16x16x32_bf16 v[160:163], v[124:127], v[180:183], v[176:179]
    v_mfma_f32_16x16x32_bf16 v[160:163], v[128:131], v[184:187], v[160:163]
    s_waitcnt vmcnt(4)
    ds_read_b128 v[180:183], v234 offset:2080
    ds_read_b128 v[184:187], v235 offset:2080
    ds_read_u8 v230, v237 offset:64
    ds_read_u8 v232, v237 offset:72
    s_lshr_b64 s[86:87], s[56:57], 2
    s_lshr_b64 s[36:37], s[56:57], 5
    s_or_b32 s36, s36, s86
    s_or_b32 s36, s36, s56
    s_cmp_lg_u64 s[84:85], 0
    s_cbranch_scc0 Lf_mid
    s_mul_i32 s66, s53, 800
    s_add_u32 s8, s8, s66
    s_addc_u32 s9, s9, 0
    s_mov_b32 s24, s8
    s_and_b32 s25, s9, 0xffff
    s_mov_b32 s26, 400
    s_mov_b32 s27, 0x20000
    s_movk_i32 s32, 400
    s_branch Ls_mid
L_fp:
    v_mfma_i32_16x16x64_i8 v[172:175], v[122:125], v[100:103], 0
    v_and_b32 v160, 0x800080, v100
    v_mul_u32_u24 v160, 0x7f, v160
    v_bitop3_b32 v131, v100, v160, v131 bitop3:0xbe
    v_and_b32 v161, 0x800080, v101
    v_mul_u32_u24 v161, 0x7f, v161
    v_bitop3_b32 v131, v101, v161, v131 bitop3:0xbe
    v_and_b32 v160, 0x800080, v102
    v_mul_u32_u24 v160, 0x7f, v160
    v_mov_b32_dpp v184, v172 row_shr:1 row_mask:0xf bank_mask:0xf bound_ctrl:0
    v_bitop3_b32 v131, v102, v160, v131 bitop3:0xbe
    s_nop 0
    v_add_u32_dpp v184, v184, v184 row_shr:1 row_mask:0xf bank_mask:0xf bound_ctrl:0
    v_and_b32 v161, 0x800080, v103
    s_nop 0
    v_add_u32_dpp v184, v184, v184 row_shr:2 row_mask:0xf bank_mask:0xf bound_ctrl:0
    v_mul_u32_u24 v161, 0x7f, v161
    s_nop 0
    v_add_u32_dpp v184, v184, v184 row_shr:4 row_mask:0xf bank_mask:0xf bound_ctrl:0
    v_bitop3_b32 v131, v103, v161, v131 bitop3:0xbe
    s_nop 0
    v_add_u32_dpp v184, v184, v184 row_shr:8 row_mask:0xf bank_mask:0xf bound_ctrl:0
    v_cmp_ne_u32 vcc, 0, v131
    v_readlane_b32 s68, v184, 6
    v_readlane_b32 s69, v173, 6
    v_readlane_b32 s70, v184, 15
    s_mov_b32 s94, 0
    s_cbranch_vccnz L_late
    s_add_u32 s66, s68, s69
    s_add_u32 s66, s66, s64
    s_add_u32 s67, s66, 15
    s_and_b32 s67, s67, -16
    s_add_u32 s55, s64, 16
    s_max_u32 s67, s67, s55
    s_sub_u32 s66, s67, s66
    v_mad_u32_u24 v184, v130, s66, v184
    s_sub_u32 s55, s64, 2048
    v_add_u32 v172, s55, v184
    v_add_u32 v173, s55, v184
    v_add_u32 v174, s55, v184
    v_add_u32 v175, s55, v184
    s_add_u32 s64, s64, s70
    s_add_u32 s64, s64, s66
    v_mfma_i32_16x16x64_i8 v[132:135], v[118:121], v[100:103], v[172:175]
    v_mfma_i32_16x16x64_i8 v[136:139], v[116:119], v[100:103], v[172:175]
    s_add_u32 s64, s64, 15
    s_and_b32 s64, s64, -16
    s_add_u32 s55, s67, 16
    s_max_u32 s64, s64, s55
    s_lshr_b32 s95, s67, 4
    s_bitset1_b64 s[56:57], s95
    s_lshr_b32 s95, s64, 4
    s_bitset1_b64 s[56:57], s95
    s_add_u32 s66, s52, 18512
    s_cmp_ge_u32 s64, s66
    ds_write_b8 v132, v126
    ds_write_b8_d16_hi v133, v126
    ds_write_b8 v134, v127
    ds_write_b8_d16_hi v135, v127
    ds_write_b8 v136, v128
    ds_write_b8_d16_hi v137, v128
    ds_write_b8 v138, v129
    ds_write_b8_d16_hi v139, v129
    s_cbranch_scc0 L_late
    s_mov_b32 s94, 1
    ds_read_u8 v148, v237 offset:0
    ds_read_u8 v149, v237 offset:8
    ds_read_u8 v150, v237 offset:16
    ds_read_u8 v151, v237 offset:24
    ds_read_u8 v152, v237 offset:32
    ds_read_u8 v153, v237 offset:40
    ds_read_u8 v154, v237 offset:48
    ds_read_u8 v155, v237 offset:56
    s_waitcnt lgkmcnt(0)
    s_add_u32 m0, s52, 0
    v_mov_b32 v230, v148
    v_mov_b32 v232, v149
    buffer_load_dwordx4 v[230:231], s[20:23], 0 idxen offen nt lds
    buffer_load_dwordx4 v[232:233], s[40:43], 0 idxen offen offset:1056 nt lds
    s_bitcmp0_b64 s[56:57], 2
    s_cbranch_scc1 L_noadve1
    s_sub_u32 s60, s60, 1
    s_cselect_b32 s31, 0, s31
    s_add_u32 s20, s20, s31
    s_addc_u32 s21, s21, 0
    s_add_u32 s40, s40, s31
    s_addc_u32 s41, s41, 0
    s_xor_b32 s31, s31, 0x63ff800
L_noadve1:
    s_add_u32 m0, s52, 2080
    v_mov_b32 v230, v150
    v_mov_b32 v232, v151
    buffer_load_dwordx4 v[230:231], s[20:23], 0 idxen offen nt lds
    buffer_load_dwordx4 v[232:233], s[40:43], 0 idxen offen offset:1056 nt lds
    s_setpc_b64 s[62:63]
L_late:
    s_waitcnt vmcnt(0)
    s_setpc_b64 s[62:63]
L_t23:
    s_cmp_eq_u32 s94, 0
    s_cbranch_scc1 L_skip2
    s_bitcmp0_b64 s[56:57], 3
    s_cbranch_scc1 L_noadve2
    s_sub_u32 s60, s60, 1
    s_cselect_b32 s31, 0, s31
    s_add_u32 s20, s20, s31
    s_addc_u32 s21, s21, 0
    s_add_u32 s40, s40, s31
    s_addc_u32 s41, s41, 0
    s_xor_b32 s31, s31, 0x63ff800
L_noadve2:
    s_add_u32 m0, s52, 4160
    v_mov_b32 v230, v152
    v_mov_b32 v232, v153
    buffer_load_dwordx4 v[230:231], s[20:23], 0 idxen offen nt lds
    buffer_load_dwordx4 v[232:233], s[40:43], 0 idxen offen offset:1056 nt lds
    s_bitcmp0_b64 s[56:57], 4
    s_cbranch_scc1 L_noadve3
    s_sub_u32 s60, s60, 1
    s_cselect_b32 s31, 0, s31
    s_add_u32 s20, s20, s31
    s_addc_u32 s21, s21, 0
    s_add_u32 s40, s40, s31
    s_addc_u32 s41, s41, 0
    s_xor_b32 s31, s31, 0x63ff800
L_noadve3:
    s_add_u32 m0, s52, 6240
    v_mov_b32 v230, v154
    v_mov_b32 v232, v155
    buffer_load_dwordx4 v[230:231], s[20:23], 0 idxen offen nt lds
    buffer_load_dwordx4 v[232:233], s[40:43], 0 idxen offen offset:1056 nt lds
L_skip2:
    s_setpc_b64 s[62:63]
Lf_loop:
    ds_read_u8 v230, v237 offset:64
    ds_read_u8 v232, v237 offset:72
    v_mfma_f32_16x16x32_bf16 v[208:211], v[136:139], v[200:203], v[208:211]
Lf_mid:
    s_bitcmp1_b32 s36, 0
    s_cbranch_scc1 Lf_ev0
Lf_evd0:
    s_mov_b64 exec, 1
    ds_add_rtn_u32 v1, v2, v3
    s_mov_b64 exec, -1
    v_exp_f32 v132, v148
    v_exp_f32 v133, v149
    v_exp_f32 v134, v150
    v_exp_f32 v135, v151
    v_exp_f32 v136, v152
    v_exp_f32 v137, v153
    v_mfma_f32_4x4x4_16b_bf16 v[132:135], v[228:229], v[228:229], v[132:135]
    v_cvt_pk_bf16_f32 v208, v208, v209
    v_cvt_pk_bf16_f32 v209, v210, v211
    s_waitcnt lgkmcnt(2)
    v_mfma_f32_16x16x32_bf16 v[148:151], v[100:103], v[180:183], v[164:167]
    v_exp_f32 v138, v154
    v_mfma_f32_4x4x4_16b_bf16 v[212:215], v[208:209], v[188:189], v[212:215] cbsz:4 abid:0
    ds_read_b64_tr_b16 v[188:189], v236 offset:0
    v_exp_f32 v139, v155
    v_mfma_f32_16x16x32_bf16 v[152:155], v[108:111], v[180:183], v[168:171]
    v_exp_f32 v140, v156
    v_mfma_f32_4x4x4_16b_bf16 v[212:215], v[208:209], v[190:191], v[212:215] cbsz:4 abid:4
    ds_read_b64_tr_b16 v[190:191], v236 offset:512
    v_mfma_f32_4x4x4_16b_bf16 v[136:139], v[228:229], v[228:229], v[136:139]
    v_rcp_f32 v132, v132
    v_mfma_f32_4x4x4_16b_bf16 v[212:215], v[208:209], v[192:193], v[212:215] cbsz:4 abid:8
    ds_read_b64_tr_b16 v[192:193], v236 offset:1056
    v_exp_f32 v141, v157
    v_mfma_f32_16x16x32_bf16 v[148:151], v[104:107], v[184:187], v[148:151]
    v_rcp_f32 v133, v133
    v_mfma_f32_4x4x4_16b_bf16 v[212:215], v[208:209], v[194:195], v[212:215] cbsz:4 abid:12
    ds_read_b64_tr_b16 v[194:195], v236 offset:1568
    v_exp_f32 v142, v158
    v_mfma_f32_16x16x32_bf16 v[152:155], v[112:115], v[184:187], v[152:155]
    v_rcp_f32 v134, v134
    v_exp_f32 v143, v159
    v_rcp_f32 v135, v135
    v_cvt_pk_bf16_f32 v132, v132, v133
    v_mfma_f32_4x4x4_16b_bf16 v[140:143], v[228:229], v[228:229], v[140:143]
    v_exp_f32 v144, v160
    v_mfma_f32_16x16x32_bf16 v[156:159], v[116:119], v[180:183], v[172:175]
    v_rcp_f32 v136, v136
    v_cvt_pk_bf16_f32 v133, v134, v135
    s_add_u32 m0, s52, 0
    s_waitcnt lgkmcnt(0)
    buffer_load_dwordx4 v[230:231], s[20:23], 0 idxen offen nt lds
    v_exp_f32 v145, v161
    buffer_load_dwordx4 v[232:233], s[40:43], 0 idxen offen offset:1056 nt lds
    v_rcp_f32 v137, v137
    v_exp_f32 v146, v162
    v_rcp_f32 v138, v138
    v_cvt_pk_bf16_f32 v134, v136, v137
    v_exp_f32 v147, v163
    v_mfma_f32_16x16x32_bf16 v[160:163], v[124:127], v[180:183], v[176:179]
    v_readfirstlane_b32 s66, v1
    s_setprio 0
    s_xor_b32 s66, s66, s33
    s_cmp_gt_i32 s66, 0
    s_cbranch_scc0 Lf_lo0
    s_setprio 1
Lf_lo0:
    v_rcp_f32 v139, v139
    v_mfma_f32_4x4x4_16b_bf16 v[144:147], v[228:229], v[228:229], v[144:147]
    v_mfma_f32_16x16x32_bf16 v[156:159], v[120:123], v[184:187], v[156:159]
    v_rcp_f32 v140, v140
    v_mfma_f32_16x16x32_bf16 v[160:163], v[128:131], v[184:187], v[160:163]
    v_rcp_f32 v141, v141
    v_cvt_pk_bf16_f32 v135, v138, v139
    s_waitcnt vmcnt(4)
    ds_read_b128 v[180:183], v234 offset:4160
    ds_read_b128 v[184:187], v235 offset:4160
    v_rcp_f32 v142, v142
    v_cvt_pk_bf16_f32 v136, v140, v141
    v_mfma_f32_16x16x32_bf16 v[208:211], v[132:135], v[196:199], v[204:207]
    v_rcp_f32 v143, v143
    v_rcp_f32 v144, v144
    v_cvt_pk_bf16_f32 v137, v142, v143
    v_rcp_f32 v145, v145
    v_rcp_f32 v146, v146
    v_rcp_f32 v147, v147
    v_cvt_pk_bf16_f32 v138, v144, v145
    v_cvt_pk_bf16_f32 v139, v146, v147
    ds_read_u8 v230, v237 offset:80
    ds_read_u8 v232, v237 offset:88
    v_mfma_f32_16x16x32_bf16 v[208:211], v[136:139], v[200:203], v[208:211]
    s_bitcmp1_b32 s36, 1
    s_cbranch_scc1 Lf_ev1
Lf_evd1:
    v_exp_f32 v132, v148
    v_exp_f32 v133, v149
    v_exp_f32 v134, v150
    v_exp_f32 v135, v151
    v_exp_f32 v136, v152
    v_exp_f32 v137, v153
    v_mfma_f32_4x4x4_16b_bf16 v[132:135], v[228:229], v[228:229], v[132:135]
    v_cvt_pk_bf16_f32 v208, v208, v209
    v_cvt_pk_bf16_f32 v209, v210, v211
    s_waitcnt lgkmcnt(2)
    v_mfma_f32_16x16x32_bf16 v[148:151], v[100:103], v[180:183], v[164:167]
    v_exp_f32 v138, v154
    v_mfma_f32_4x4x4_16b_bf16 v[212:215], v[208:209], v[188:189], v[212:215] cbsz:4 abid:0
    ds_read_b64_tr_b16 v[188:189], v236 offset:2080
    v_exp_f32 v139, v155
    v_mfma_f32_16x16x32_bf16 v[152:155], v[108:111], v[180:183], v[168:171]
    v_exp_f32 v140, v156
    v_mfma_f32_4x4x4_16b_bf16 v[212:215], v[208:209], v[190:191], v[212:215] cbsz:4 abid:4
    ds_read_b64_tr_b16 v[190:191], v236 offset:2592
    v_mfma_f32_4x4x4_16b_bf16 v[136:139], v[228:229], v[228:229], v[136:139]
    v_rcp_f32 v132, v132
    v_mfma_f32_4x4x4_16b_bf16 v[212:215], v[208:209], v[192:193], v[212:215] cbsz:4 abid:8
    ds_read_b64_tr_b16 v[192:193], v236 offset:3136
    v_exp_f32 v141, v157
    v_mfma_f32_16x16x32_bf16 v[148:151], v[104:107], v[184:187], v[148:151]
    v_rcp_f32 v133, v133
    v_mfma_f32_4x4x4_16b_bf16 v[212:215], v[208:209], v[194:195], v[212:215] cbsz:4 abid:12
    ds_read_b64_tr_b16 v[194:195], v236 offset:3648
    v_exp_f32 v142, v158
    v_mfma_f32_16x16x32_bf16 v[152:155], v[112:115], v[184:187], v[152:155]
    v_rcp_f32 v134, v134
    v_exp_f32 v143, v159
    v_rcp_f32 v135, v135
    v_cvt_pk_bf16_f32 v132, v132, v133
    v_mfma_f32_4x4x4_16b_bf16 v[140:143], v[228:229], v[228:229], v[140:143]
    v_exp_f32 v144, v160
    v_mfma_f32_16x16x32_bf16 v[156:159], v[116:119], v[180:183], v[172:175]
    v_rcp_f32 v136, v136
    v_cvt_pk_bf16_f32 v133, v134, v135
    s_add_u32 m0, s52, 2080
    s_waitcnt lgkmcnt(0)
    buffer_load_dwordx4 v[230:231], s[20:23], 0 idxen offen nt lds
    v_exp_f32 v145, v161
    buffer_load_dwordx4 v[232:233], s[40:43], 0 idxen offen offset:1056 nt lds
    v_rcp_f32 v137, v137
    v_exp_f32 v146, v162
    v_rcp_f32 v138, v138
    v_cvt_pk_bf16_f32 v134, v136, v137
    v_exp_f32 v147, v163
    v_mfma_f32_16x16x32_bf16 v[160:163], v[124:127], v[180:183], v[176:179]
    v_rcp_f32 v139, v139
    v_mfma_f32_4x4x4_16b_bf16 v[144:147], v[228:229], v[228:229], v[144:147]
    v_mfma_f32_16x16x32_bf16 v[156:159], v[120:123], v[184:187], v[156:159]
    v_rcp_f32 v140, v140
    v_mfma_f32_16x16x32_bf16 v[160:163], v[128:131], v[184:187], v[160:163]
    v_rcp_f32 v141, v141
    v_cvt_pk_bf16_f32 v135, v138, v139
    s_waitcnt vmcnt(4)
    ds_read_b128 v[180:183], v234 offset:6240
    ds_read_b128 v[184:187], v235 offset:6240
    v_rcp_f32 v142, v142
    v_cvt_pk_bf16_f32 v136, v140, v141
    v_mfma_f32_16x16x32_bf16 v[208:211], v[132:135], v[196:199], v[204:207]
    v_rcp_f32 v143, v143
    v_rcp_f32 v144, v144
    v_cvt_pk_bf16_f32 v137, v142, v143
    v_rcp_f32 v145, v145
    v_rcp_f32 v146, v146
    v_rcp_f32 v147, v147
    v_cvt_pk_bf16_f32 v138, v144, v145
    v_cvt_pk_bf16_f32 v139, v146, v147
    ds_read_u8 v230, v237 offset:96
    ds_read_u8 v232, v237 offset:104
    v_mfma_f32_16x16x32_bf16 v[208:211], v[136:139], v[200:203], v[208:211]
    s_bitcmp1_b32 s36, 2
    s_cbranch_scc1 Lf_ev2
Lf_evd2:
    v_exp_f32 v132, v148
    v_exp_f32 v133, v149
    v_exp_f32 v134, v150
    v_exp_f32 v135, v151
    v_exp_f32 v136, v152
    v_exp_f32 v137, v153
    v_mfma_f32_4x4x4_16b_bf16 v[132:135], v[228:229], v[228:229], v[132:135]
    v_cvt_pk_bf16_f32 v208, v208, v209
    v_cvt_pk_bf16_f32 v209, v210, v211
    s_waitcnt lgkmcnt(2)
    v_mfma_f32_16x16x32_bf16 v[148:151], v[100:103], v[180:183], v[164:167]
    v_exp_f32 v138, v154
    v_mfma_f32_4x4x4_16b_bf16 v[212:215], v[208:209], v[188:189], v[212:215] cbsz:4 abid:0
    ds_read_b64_tr_b16 v[188:189], v236 offset:4160
    v_exp_f32 v139, v155
    v_mfma_f32_16x16x32_bf16 v[152:155], v[108:111], v[180:183], v[168:171]
    v_exp_f32 v140, v156
    v_mfma_f32_4x4x4_16b_bf16 v[212:215], v[208:209], v[190:191], v[212:215] cbsz:4 abid:4
    ds_read_b64_tr_b16 v[190:191], v236 offset:4672
    v_mfma_f32_4x4x4_16b_bf16 v[136:139], v[228:229], v[228:229], v[136:139]
    v_rcp_f32 v132, v132
    v_mfma_f32_4x4x4_16b_bf16 v[212:215], v[208:209], v[192:193], v[212:215] cbsz:4 abid:8
    ds_read_b64_tr_b16 v[192:193], v236 offset:5216
    v_exp_f32 v141, v157
    v_mfma_f32_16x16x32_bf16 v[148:151], v[104:107], v[184:187], v[148:151]
    v_rcp_f32 v133, v133
    v_mfma_f32_4x4x4_16b_bf16 v[212:215], v[208:209], v[194:195], v[212:215] cbsz:4 abid:12
    ds_read_b64_tr_b16 v[194:195], v236 offset:5728
    v_exp_f32 v142, v158
    v_mfma_f32_16x16x32_bf16 v[152:155], v[112:115], v[184:187], v[152:155]
    v_rcp_f32 v134, v134
    v_exp_f32 v143, v159
    v_rcp_f32 v135, v135
    v_cvt_pk_bf16_f32 v132, v132, v133
    v_mfma_f32_4x4x4_16b_bf16 v[140:143], v[228:229], v[228:229], v[140:143]
    v_exp_f32 v144, v160
    v_mfma_f32_16x16x32_bf16 v[156:159], v[116:119], v[180:183], v[172:175]
    v_rcp_f32 v136, v136
    v_cvt_pk_bf16_f32 v133, v134, v135
    s_add_u32 m0, s52, 4160
    s_waitcnt lgkmcnt(0)
    buffer_load_dwordx4 v[230:231], s[20:23], 0 idxen offen nt lds
    v_exp_f32 v145, v161
    buffer_load_dwordx4 v[232:233], s[40:43], 0 idxen offen offset:1056 nt lds
    v_rcp_f32 v137, v137
    v_exp_f32 v146, v162
    v_rcp_f32 v138, v138
    v_cvt_pk_bf16_f32 v134, v136, v137
    v_exp_f32 v147, v163
    v_mfma_f32_16x16x32_bf16 v[160:163], v[124:127], v[180:183], v[176:179]
    v_rcp_f32 v139, v139
    v_mfma_f32_4x4x4_16b_bf16 v[144:147], v[228:229], v[228:229], v[144:147]
    v_mfma_f32_16x16x32_bf16 v[156:159], v[120:123], v[184:187], v[156:159]
    v_rcp_f32 v140, v140
    v_mfma_f32_16x16x32_bf16 v[160:163], v[128:131], v[184:187], v[160:163]
    v_rcp_f32 v141, v141
    v_cvt_pk_bf16_f32 v135, v138, v139
    s_waitcnt vmcnt(4)
    ds_read_b128 v[180:183], v234 offset:0
    ds_read_b128 v[184:187], v235 offset:0
    v_rcp_f32 v142, v142
    v_cvt_pk_bf16_f32 v136, v140, v141
    v_mfma_f32_16x16x32_bf16 v[208:211], v[132:135], v[196:199], v[204:207]
    v_rcp_f32 v143, v143
    v_rcp_f32 v144, v144
    v_cvt_pk_bf16_f32 v137, v142, v143
    v_rcp_f32 v145, v145
    v_rcp_f32 v146, v146
    v_rcp_f32 v147, v147
    v_cvt_pk_bf16_f32 v138, v144, v145
    v_cvt_pk_bf16_f32 v139, v146, v147
    ds_read_u8 v230, v237 offset:112
    ds_read_u8 v232, v237 offset:120
    v_mfma_f32_16x16x32_bf16 v[208:211], v[136:139], v[200:203], v[208:211]
    s_bitcmp1_b32 s36, 3
    s_cbranch_scc1 Lf_ev3
Lf_evd3:
    v_exp_f32 v132, v148
    v_exp_f32 v133, v149
    v_exp_f32 v134, v150
    v_exp_f32 v135, v151
    v_exp_f32 v136, v152
    v_exp_f32 v137, v153
    v_mfma_f32_4x4x4_16b_bf16 v[132:135], v[228:229], v[228:229], v[132:135]
    v_cvt_pk_bf16_f32 v208, v208, v209
    v_cvt_pk_bf16_f32 v209, v210, v211
    s_waitcnt lgkmcnt(2)
    v_mfma_f32_16x16x32_bf16 v[148:151], v[100:103], v[180:183], v[164:167]
    v_exp_f32 v138, v154
    v_mfma_f32_4x4x4_16b_bf16 v[212:215], v[208:209], v[188:189], v[212:215] cbsz:4 abid:0
    ds_read_b64_tr_b16 v[188:189], v236 offset:6240
    v_exp_f32 v139, v155
    v_mfma_f32_16x16x32_bf16 v[152:155], v[108:111], v[180:183], v[168:171]
    v_exp_f32 v140, v156
    v_mfma_f32_4x4x4_16b_bf16 v[212:215], v[208:209], v[190:191], v[212:215] cbsz:4 abid:4
    ds_read_b64_tr_b16 v[190:191], v236 offset:6752
    v_mfma_f32_4x4x4_16b_bf16 v[136:139], v[228:229], v[228:229], v[136:139]
    v_rcp_f32 v132, v132
    v_mfma_f32_4x4x4_16b_bf16 v[212:215], v[208:209], v[192:193], v[212:215] cbsz:4 abid:8
    ds_read_b64_tr_b16 v[192:193], v236 offset:7296
    v_exp_f32 v141, v157
    v_mfma_f32_16x16x32_bf16 v[148:151], v[104:107], v[184:187], v[148:151]
    v_rcp_f32 v133, v133
    v_mfma_f32_4x4x4_16b_bf16 v[212:215], v[208:209], v[194:195], v[212:215] cbsz:4 abid:12
    ds_read_b64_tr_b16 v[194:195], v236 offset:7808
    v_exp_f32 v142, v158
    v_mfma_f32_16x16x32_bf16 v[152:155], v[112:115], v[184:187], v[152:155]
    v_rcp_f32 v134, v134
    v_exp_f32 v143, v159
    v_rcp_f32 v135, v135
    v_cvt_pk_bf16_f32 v132, v132, v133
    v_mfma_f32_4x4x4_16b_bf16 v[140:143], v[228:229], v[228:229], v[140:143]
    v_exp_f32 v144, v160
    v_mfma_f32_16x16x32_bf16 v[156:159], v[116:119], v[180:183], v[172:175]
    v_rcp_f32 v136, v136
    v_cvt_pk_bf16_f32 v133, v134, v135
    s_add_u32 m0, s52, 6240
    s_waitcnt lgkmcnt(0)
    buffer_load_dwordx4 v[230:231], s[20:23], 0 idxen offen nt lds
    v_exp_f32 v145, v161
    buffer_load_dwordx4 v[232:233], s[40:43], 0 idxen offen offset:1056 nt lds
    v_rcp_f32 v137, v137
    v_exp_f32 v146, v162
    v_rcp_f32 v138, v138
    v_cvt_pk_bf16_f32 v134, v136, v137
    v_exp_f32 v147, v163
    v_mfma_f32_16x16x32_bf16 v[160:163], v[124:127], v[180:183], v[176:179]
    v_rcp_f32 v139, v139
    v_mfma_f32_4x4x4_16b_bf16 v[144:147], v[228:229], v[228:229], v[144:147]
    v_mfma_f32_16x16x32_bf16 v[156:159], v[120:123], v[184:187], v[156:159]
    v_rcp_f32 v140, v140
    v_mfma_f32_16x16x32_bf16 v[160:163], v[128:131], v[184:187], v[160:163]
    v_rcp_f32 v141, v141
    v_cvt_pk_bf16_f32 v135, v138, v139
    s_waitcnt vmcnt(4)
    ds_read_b128 v[180:183], v234 offset:2080
    ds_read_b128 v[184:187], v235 offset:2080
    v_rcp_f32 v142, v142
    v_cvt_pk_bf16_f32 v136, v140, v141
    v_mfma_f32_16x16x32_bf16 v[208:211], v[132:135], v[196:199], v[204:207]
    v_rcp_f32 v143, v143
    s_lshr_b64 s[56:57], s[56:57], 4
    s_lshl_b64 s[86:87], s[58:59], 60
    s_or_b64 s[56:57], s[56:57], s[86:87]
    s_lshr_b64 s[58:59], s[58:59], 4
    s_lshr_b64 s[86:87], s[56:57], 2
    s_lshr_b64 s[36:37], s[56:57], 5
    s_or_b32 s36, s36, s86
    s_or_b32 s36, s36, s56
    v_add_u32 v237, 64, v237
    v_rcp_f32 v144, v144
    v_cvt_pk_bf16_f32 v137, v142, v143
    v_rcp_f32 v145, v145
    v_rcp_f32 v146, v146
    v_rcp_f32 v147, v147
    v_cvt_pk_bf16_f32 v138, v144, v145
    v_cvt_pk_bf16_f32 v139, v146, v147
    s_branch Lf_loop
Lf_ev0:
    s_bitcmp0_b64 s[56:57], 0
    s_cbranch_scc1 Lf_nf0
    v_cvt_pk_bf16_f32 v246, v212, v212
    v_mov_b32 v212, 0
    ds_write_b16 v240, v246
    v_add_u32 v240, 128, v240
Lf_nf0:
    s_bitcmp0_b64 s[56:57], 5
    s_cbranch_scc1 Lf_na0
    s_sub_u32 s60, s60, 1
    s_cselect_b32 s31, 0, s31
    s_add_u32 s20, s20, s31
    s_addc_u32 s21, s21, 0
    s_add_u32 s40, s40, s31
    s_addc_u32 s41, s41, 0
    s_xor_b32 s31, s31, 0x63ff800
Lf_na0:
    s_bitcmp0_b64 s[56:57], 2
    s_cbranch_scc1 Lf_evd0
Lf_e10:
    s_sub_u32 s61, s61, 1
    s_cbranch_scc1 Lf_last0
    v_mul_u32_u24 v216, v224, v241
    v_mul_u32_u24 v217, v224, v242
    v_mul_u32_u24 v218, v225, v241
    v_mul_u32_u24 v219, v225, v242
    v_mul_u32_u24 v220, v226, v241
    v_mul_u32_u24 v221, v226, v242
    v_mul_u32_u24 v222, v227, v241
    v_mul_u32_u24 v223, v227, v242
    v_add_u32 v238, 128, v238
    ds_read_b128 v[164:167], v239
    v_mfma_f32_4x4x4_16b_bf16 v[132:135], v[216:217], v[68:69], v[4:7]
    ds_read_b128 v[168:171], v239 offset:64
    ds_read_b128 v[172:175], v239 offset:128
    v_mfma_f32_4x4x4_16b_bf16 v[136:139], v[218:219], v[70:71], v[8:11]
    ds_read_b128 v[176:179], v239 offset:192
    ds_read_u16 v224, v238
    v_mfma_f32_4x4x4_16b_bf16 v[140:143], v[220:221], v[72:73], v[12:15]
    ds_read_u16 v225, v238 offset:8
    ds_read_u16 v226, v238 offset:64
    v_mfma_f32_4x4x4_16b_bf16 v[144:147], v[222:223], v[74:75], v[16:19]
    ds_read_u16 v227, v238 offset:72
    v_add_u32 v239, 272, v239
    v_mfma_f32_4x4x4_16b_bf16 v[246:249], v[216:217], v[76:77], v[20:23]
    v_cvt_pk_bf16_f32 v100, v132, v133
    v_cvt_pk_bf16_f32 v101, v134, v135
    v_mfma_f32_4x4x4_16b_bf16 v[250:253], v[218:219], v[78:79], v[24:27]
    v_cvt_pk_bf16_f32 v102, v136, v137
    v_cvt_pk_bf16_f32 v103, v138, v139
    v_mfma_f32_4x4x4_16b_bf16 v[132:135], v[220:221], v[80:81], v[28:31]
    v_cvt_pk_bf16_f32 v104, v140, v141
    v_cvt_pk_bf16_f32 v105, v142, v143
    v_mfma_f32_4x4x4_16b_bf16 v[136:139], v[222:223], v[82:83], v[32:35]
    v_cvt_pk_bf16_f32 v106, v144, v145
    v_cvt_pk_bf16_f32 v107, v146, v147
    v_mfma_f32_4x4x4_16b_bf16 v[140:143], v[216:217], v[84:85], v[36:39]
    v_cvt_pk_bf16_f32 v108, v246, v247
    v_cvt_pk_bf16_f32 v109, v248, v249
    v_mfma_f32_4x4x4_16b_bf16 v[144:147], v[218:219], v[86:87], v[40:43]
    v_cvt_pk_bf16_f32 v110, v250, v251
    v_cvt_pk_bf16_f32 v111, v252, v253
    v_mfma_f32_4x4x4_16b_bf16 v[246:249], v[220:221], v[88:89], v[44:47]
    v_cvt_pk_bf16_f32 v112, v132, v133
    v_cvt_pk_bf16_f32 v113, v134, v135
    v_mfma_f32_4x4x4_16b_bf16 v[250:253], v[222:223], v[90:91], v[48:51]
    v_cvt_pk_bf16_f32 v114, v136, v137
    v_cvt_pk_bf16_f32 v115, v138, v139
    v_mfma_f32_4x4x4_16b_bf16 v[132:135], v[216:217], v[92:93], v[52:55]
    v_cvt_pk_bf16_f32 v116, v140, v141
    v_cvt_pk_bf16_f32 v117, v142, v143
    v_mfma_f32_4x4x4_16b_bf16 v[136:139], v[218:219], v[94:95], v[56:59]
    v_cvt_pk_bf16_f32 v118, v144, v145
    v_cvt_pk_bf16_f32 v119, v146, v147
    v_mfma_f32_4x4x4_16b_bf16 v[140:143], v[220:221], v[96:97], v[60:63]
    v_cvt_pk_bf16_f32 v120, v246, v247
    v_cvt_pk_bf16_f32 v121, v248, v249
    v_mfma_f32_4x4x4_16b_bf16 v[144:147], v[222:223], v[98:99], v[64:67]
    v_cvt_pk_bf16_f32 v122, v250, v251
    v_cvt_pk_bf16_f32 v123, v252, v253
    v_cvt_pk_bf16_f32 v124, v132, v133
    v_cvt_pk_bf16_f32 v125, v134, v135
    v_cvt_pk_bf16_f32 v126, v136, v137
    v_cvt_pk_bf16_f32 v127, v138, v139
    v_cvt_pk_bf16_f32 v128, v140, v141
    v_cvt_pk_bf16_f32 v129, v142, v143
    v_cvt_pk_bf16_f32 v130, v144, v145
    v_cvt_pk_bf16_f32 v131, v146, v147
    s_waitcnt lgkmcnt(0)
    s_branch Lf_evd0
Lf_ev1:
    s_bitcmp0_b64 s[56:57], 1
    s_cbranch_scc1 Lf_nf1
    v_cvt_pk_bf16_f32 v246, v212, v212
    v_mov_b32 v212, 0
    ds_write_b16 v240, v246
    v_add_u32 v240, 128, v240
Lf_nf1:
    s_bitcmp0_b64 s[56:57], 6
    s_cbranch_scc1 Lf_na1
    s_sub_u32 s60, s60, 1
    s_cselect_b32 s31, 0, s31
    s_add_u32 s20, s20, s31
    s_addc_u32 s21, s21, 0
    s_add_u32 s40, s40, s31
    s_addc_u32 s41, s41, 0
    s_xor_b32 s31, s31, 0x63ff800
Lf_na1:
    s_bitcmp0_b64 s[56:57], 3
    s_cbranch_scc1 Lf_evd1
Lf_e11:
    s_sub_u32 s61, s61, 1
    s_cbranch_scc1 Lf_last1
    v_mul_u32_u24 v216, v224, v241
    v_mul_u32_u24 v217, v224, v242
    v_mul_u32_u24 v218, v225, v241
    v_mul_u32_u24 v219, v225, v242
    v_mul_u32_u24 v220, v226, v241
    v_mul_u32_u24 v221, v226, v242
    v_mul_u32_u24 v222, v227, v241
    v_mul_u32_u24 v223, v227, v242
    v_add_u32 v238, 128, v238
    ds_read_b128 v[164:167], v239
    v_mfma_f32_4x4x4_16b_bf16 v[132:135], v[216:217], v[68:69], v[4:7]
    ds_read_b128 v[168:171], v239 offset:64
    ds_read_b128 v[172:175], v239 offset:128
    v_mfma_f32_4x4x4_16b_bf16 v[136:139], v[218:219], v[70:71], v[8:11]
    ds_read_b128 v[176:179], v239 offset:192
    ds_read_u16 v224, v238
    v_mfma_f32_4x4x4_16b_bf16 v[140:143], v[220:221], v[72:73], v[12:15]
    ds_read_u16 v225, v238 offset:8
    ds_read_u16 v226, v238 offset:64
    v_mfma_f32_4x4x4_16b_bf16 v[144:147], v[222:223], v[74:75], v[16:19]
    ds_read_u16 v227, v238 offset:72
    v_add_u32 v239, 272, v239
    v_mfma_f32_4x4x4_16b_bf16 v[246:249], v[216:217], v[76:77], v[20:23]
    v_cvt_pk_bf16_f32 v100, v132, v133
    v_cvt_pk_bf16_f32 v101, v134, v135
    v_mfma_f32_4x4x4_16b_bf16 v[250:253], v[218:219], v[78:79], v[24:27]
    v_cvt_pk_bf16_f32 v102, v136, v137
    v_cvt_pk_bf16_f32 v103, v138, v139
    v_mfma_f32_4x4x4_16b_bf16 v[132:135], v[220:221], v[80:81], v[28:31]
    v_cvt_pk_bf16_f32 v104, v140, v141
    v_cvt_pk_bf16_f32 v105, v142, v143
    v_mfma_f32_4x4x4_16b_bf16 v[136:139], v[222:223], v[82:83], v[32:35]
    v_cvt_pk_bf16_f32 v106, v144, v145
    v_cvt_pk_bf16_f32 v107, v146, v147
    v_mfma_f32_4x4x4_16b_bf16 v[140:143], v[216:217], v[84:85], v[36:39]
    v_cvt_pk_bf16_f32 v108, v246, v247
    v_cvt_pk_bf16_f32 v109, v248, v249
    v_mfma_f32_4x4x4_16b_bf16 v[144:147], v[218:219], v[86:87], v[40:43]
    v_cvt_pk_bf16_f32 v110, v250, v251
    v_cvt_pk_bf16_f32 v111, v252, v253
    v_mfma_f32_4x4x4_16b_bf16 v[246:249], v[220:221], v[88:89], v[44:47]
    v_cvt_pk_bf16_f32 v112, v132, v133
    v_cvt_pk_bf16_f32 v113, v134, v135
    v_mfma_f32_4x4x4_16b_bf16 v[250:253], v[222:223], v[90:91], v[48:51]
    v_cvt_pk_bf16_f32 v114, v136, v137
    v_cvt_pk_bf16_f32 v115, v138, v139
    v_mfma_f32_4x4x4_16b_bf16 v[132:135], v[216:217], v[92:93], v[52:55]
    v_cvt_pk_bf16_f32 v116, v140, v141
    v_cvt_pk_bf16_f32 v117, v142, v143
    v_mfma_f32_4x4x4_16b_bf16 v[136:139], v[218:219], v[94:95], v[56:59]
    v_cvt_pk_bf16_f32 v118, v144, v145
    v_cvt_pk_bf16_f32 v119, v146, v147
    v_mfma_f32_4x4x4_16b_bf16 v[140:143], v[220:221], v[96:97], v[60:63]
    v_cvt_pk_bf16_f32 v120, v246, v247
    v_cvt_pk_bf16_f32 v121, v248, v249
    v_mfma_f32_4x4x4_16b_bf16 v[144:147], v[222:223], v[98:99], v[64:67]
    v_cvt_pk_bf16_f32 v122, v250, v251
    v_cvt_pk_bf16_f32 v123, v252, v253
    v_cvt_pk_bf16_f32 v124, v132, v133
    v_cvt_pk_bf16_f32 v125, v134, v135
    v_cvt_pk_bf16_f32 v126, v136, v137
    v_cvt_pk_bf16_f32 v127, v138, v139
    v_cvt_pk_bf16_f32 v128, v140, v141
    v_cvt_pk_bf16_f32 v129, v142, v143
    v_cvt_pk_bf16_f32 v130, v144, v145
    v_cvt_pk_bf16_f32 v131, v146, v147
    s_waitcnt lgkmcnt(0)
    s_branch Lf_evd1
Lf_ev2:
    s_bitcmp0_b64 s[56:57], 2
    s_cbranch_scc1 Lf_nf2
    v_cvt_pk_bf16_f32 v246, v212, v212
    v_mov_b32 v212, 0
    ds_write_b16 v240, v246
    v_add_u32 v240, 128, v240
Lf_nf2:
    s_bitcmp0_b64 s[56:57], 7
    s_cbranch_scc1 Lf_na2
    s_sub_u32 s60, s60, 1
    s_cselect_b32 s31, 0, s31
    s_add_u32 s20, s20, s31
    s_addc_u32 s21, s21, 0
    s_add_u32 s40, s40, s31
    s_addc_u32 s41, s41, 0
    s_xor_b32 s31, s31, 0x63ff800
Lf_na2:
    s_bitcmp0_b64 s[56:57], 4
    s_cbranch_scc1 Lf_evd2
Lf_e12:
    s_sub_u32 s61, s61, 1
    s_cbranch_scc1 Lf_last2
    v_mul_u32_u24 v216, v224, v241
    v_mul_u32_u24 v217, v224, v242
    v_mul_u32_u24 v218, v225, v241
    v_mul_u32_u24 v219, v225, v242
    v_mul_u32_u24 v220, v226, v241
    v_mul_u32_u24 v221, v226, v242
    v_mul_u32_u24 v222, v227, v241
    v_mul_u32_u24 v223, v227, v242
    v_add_u32 v238, 128, v238
    ds_read_b128 v[164:167], v239
    v_mfma_f32_4x4x4_16b_bf16 v[132:135], v[216:217], v[68:69], v[4:7]
    ds_read_b128 v[168:171], v239 offset:64
    ds_read_b128 v[172:175], v239 offset:128
    v_mfma_f32_4x4x4_16b_bf16 v[136:139], v[218:219], v[70:71], v[8:11]
    ds_read_b128 v[176:179], v239 offset:192
    ds_read_u16 v224, v238
    v_mfma_f32_4x4x4_16b_bf16 v[140:143], v[220:221], v[72:73], v[12:15]
    ds_read_u16 v225, v238 offset:8
    ds_read_u16 v226, v238 offset:64
    v_mfma_f32_4x4x4_16b_bf16 v[144:147], v[222:223], v[74:75], v[16:19]
    ds_read_u16 v227, v238 offset:72
    v_add_u32 v239, 272, v239
    v_mfma_f32_4x4x4_16b_bf16 v[246:249], v[216:217], v[76:77], v[20:23]
    v_cvt_pk_bf16_f32 v100, v132, v133
    v_cvt_pk_bf16_f32 v101, v134, v135
    v_mfma_f32_4x4x4_16b_bf16 v[250:253], v[218:219], v[78:79], v[24:27]
    v_cvt_pk_bf16_f32 v102, v136, v137
    v_cvt_pk_bf16_f32 v103, v138, v139
    v_mfma_f32_4x4x4_16b_bf16 v[132:135], v[220:221], v[80:81], v[28:31]
    v_cvt_pk_bf16_f32 v104, v140, v141
    v_cvt_pk_bf16_f32 v105, v142, v143
    v_mfma_f32_4x4x4_16b_bf16 v[136:139], v[222:223], v[82:83], v[32:35]
    v_cvt_pk_bf16_f32 v106, v144, v145
    v_cvt_pk_bf16_f32 v107, v146, v147
    v_mfma_f32_4x4x4_16b_bf16 v[140:143], v[216:217], v[84:85], v[36:39]
    v_cvt_pk_bf16_f32 v108, v246, v247
    v_cvt_pk_bf16_f32 v109, v248, v249
    v_mfma_f32_4x4x4_16b_bf16 v[144:147], v[218:219], v[86:87], v[40:43]
    v_cvt_pk_bf16_f32 v110, v250, v251
    v_cvt_pk_bf16_f32 v111, v252, v253
    v_mfma_f32_4x4x4_16b_bf16 v[246:249], v[220:221], v[88:89], v[44:47]
    v_cvt_pk_bf16_f32 v112, v132, v133
    v_cvt_pk_bf16_f32 v113, v134, v135
    v_mfma_f32_4x4x4_16b_bf16 v[250:253], v[222:223], v[90:91], v[48:51]
    v_cvt_pk_bf16_f32 v114, v136, v137
    v_cvt_pk_bf16_f32 v115, v138, v139
    v_mfma_f32_4x4x4_16b_bf16 v[132:135], v[216:217], v[92:93], v[52:55]
    v_cvt_pk_bf16_f32 v116, v140, v141
    v_cvt_pk_bf16_f32 v117, v142, v143
    v_mfma_f32_4x4x4_16b_bf16 v[136:139], v[218:219], v[94:95], v[56:59]
    v_cvt_pk_bf16_f32 v118, v144, v145
    v_cvt_pk_bf16_f32 v119, v146, v147
    v_mfma_f32_4x4x4_16b_bf16 v[140:143], v[220:221], v[96:97], v[60:63]
    v_cvt_pk_bf16_f32 v120, v246, v247
    v_cvt_pk_bf16_f32 v121, v248, v249
    v_mfma_f32_4x4x4_16b_bf16 v[144:147], v[222:223], v[98:99], v[64:67]
    v_cvt_pk_bf16_f32 v122, v250, v251
    v_cvt_pk_bf16_f32 v123, v252, v253
    v_cvt_pk_bf16_f32 v124, v132, v133
    v_cvt_pk_bf16_f32 v125, v134, v135
    v_cvt_pk_bf16_f32 v126, v136, v137
    v_cvt_pk_bf16_f32 v127, v138, v139
    v_cvt_pk_bf16_f32 v128, v140, v141
    v_cvt_pk_bf16_f32 v129, v142, v143
    v_cvt_pk_bf16_f32 v130, v144, v145
    v_cvt_pk_bf16_f32 v131, v146, v147
    s_waitcnt lgkmcnt(0)
    s_branch Lf_evd2
Lf_ev3:
    s_bitcmp0_b64 s[56:57], 3
    s_cbranch_scc1 Lf_nf3
    v_cvt_pk_bf16_f32 v246, v212, v212
    v_mov_b32 v212, 0
    ds_write_b16 v240, v246
    v_add_u32 v240, 128, v240
Lf_nf3:
    s_bitcmp0_b64 s[56:57], 8
    s_cbranch_scc1 Lf_na3
    s_sub_u32 s60, s60, 1
    s_cselect_b32 s31, 0, s31
    s_add_u32 s20, s20, s31
    s_addc_u32 s21, s21, 0
    s_add_u32 s40, s40, s31
    s_addc_u32 s41, s41, 0
    s_xor_b32 s31, s31, 0x63ff800
Lf_na3:
    s_bitcmp0_b64 s[56:57], 5
    s_cbranch_scc1 Lf_evd3
Lf_e13:
    s_sub_u32 s61, s61, 1
    s_cbranch_scc1 Lf_last3
    v_mul_u32_u24 v216, v224, v241
    v_mul_u32_u24 v217, v224, v242
    v_mul_u32_u24 v218, v225, v241
    v_mul_u32_u24 v219, v225, v242
    v_mul_u32_u24 v220, v226, v241
    v_mul_u32_u24 v221, v226, v242
    v_mul_u32_u24 v222, v227, v241
    v_mul_u32_u24 v223, v227, v242
    v_add_u32 v238, 128, v238
    ds_read_b128 v[164:167], v239
    v_mfma_f32_4x4x4_16b_bf16 v[132:135], v[216:217], v[68:69], v[4:7]
    ds_read_b128 v[168:171], v239 offset:64
    ds_read_b128 v[172:175], v239 offset:128
    v_mfma_f32_4x4x4_16b_bf16 v[136:139], v[218:219], v[70:71], v[8:11]
    ds_read_b128 v[176:179], v239 offset:192
    ds_read_u16 v224, v238
    v_mfma_f32_4x4x4_16b_bf16 v[140:143], v[220:221], v[72:73], v[12:15]
    ds_read_u16 v225, v238 offset:8
    ds_read_u16 v226, v238 offset:64
    v_mfma_f32_4x4x4_16b_bf16 v[144:147], v[222:223], v[74:75], v[16:19]
    ds_read_u16 v227, v238 offset:72
    v_add_u32 v239, 272, v239
    v_mfma_f32_4x4x4_16b_bf16 v[246:249], v[216:217], v[76:77], v[20:23]
    v_cvt_pk_bf16_f32 v100, v132, v133
    v_cvt_pk_bf16_f32 v101, v134, v135
    v_mfma_f32_4x4x4_16b_bf16 v[250:253], v[218:219], v[78:79], v[24:27]
    v_cvt_pk_bf16_f32 v102, v136, v137
    v_cvt_pk_bf16_f32 v103, v138, v139
    v_mfma_f32_4x4x4_16b_bf16 v[132:135], v[220:221], v[80:81], v[28:31]
    v_cvt_pk_bf16_f32 v104, v140, v141
    v_cvt_pk_bf16_f32 v105, v142, v143
    v_mfma_f32_4x4x4_16b_bf16 v[136:139], v[222:223], v[82:83], v[32:35]
    v_cvt_pk_bf16_f32 v106, v144, v145
    v_cvt_pk_bf16_f32 v107, v146, v147
    v_mfma_f32_4x4x4_16b_bf16 v[140:143], v[216:217], v[84:85], v[36:39]
    v_cvt_pk_bf16_f32 v108, v246, v247
    v_cvt_pk_bf16_f32 v109, v248, v249
    v_mfma_f32_4x4x4_16b_bf16 v[144:147], v[218:219], v[86:87], v[40:43]
    v_cvt_pk_bf16_f32 v110, v250, v251
    v_cvt_pk_bf16_f32 v111, v252, v253
    v_mfma_f32_4x4x4_16b_bf16 v[246:249], v[220:221], v[88:89], v[44:47]
    v_cvt_pk_bf16_f32 v112, v132, v133
    v_cvt_pk_bf16_f32 v113, v134, v135
    v_mfma_f32_4x4x4_16b_bf16 v[250:253], v[222:223], v[90:91], v[48:51]
    v_cvt_pk_bf16_f32 v114, v136, v137
    v_cvt_pk_bf16_f32 v115, v138, v139
    v_mfma_f32_4x4x4_16b_bf16 v[132:135], v[216:217], v[92:93], v[52:55]
    v_cvt_pk_bf16_f32 v116, v140, v141
    v_cvt_pk_bf16_f32 v117, v142, v143
    v_mfma_f32_4x4x4_16b_bf16 v[136:139], v[218:219], v[94:95], v[56:59]
    v_cvt_pk_bf16_f32 v118, v144, v145
    v_cvt_pk_bf16_f32 v119, v146, v147
    v_mfma_f32_4x4x4_16b_bf16 v[140:143], v[220:221], v[96:97], v[60:63]
    v_cvt_pk_bf16_f32 v120, v246, v247
    v_cvt_pk_bf16_f32 v121, v248, v249
    v_mfma_f32_4x4x4_16b_bf16 v[144:147], v[222:223], v[98:99], v[64:67]
    v_cvt_pk_bf16_f32 v122, v250, v251
    v_cvt_pk_bf16_f32 v123, v252, v253
    v_cvt_pk_bf16_f32 v124, v132, v133
    v_cvt_pk_bf16_f32 v125, v134, v135
    v_cvt_pk_bf16_f32 v126, v136, v137
    v_cvt_pk_bf16_f32 v127, v138, v139
    v_cvt_pk_bf16_f32 v128, v140, v141
    v_cvt_pk_bf16_f32 v129, v142, v143
    v_cvt_pk_bf16_f32 v130, v144, v145
    v_cvt_pk_bf16_f32 v131, v146, v147
    s_waitcnt lgkmcnt(0)
    s_branch Lf_evd3
Lf_last0:
    s_branch Lf_tail
Lf_last1:
    v_add_u32 v236, 2080, v236
    s_lshr_b64 s[56:57], s[56:57], 1
    s_branch Lf_tail
Lf_last2:
    v_add_u32 v236, 4160, v236
    s_lshr_b64 s[56:57], s[56:57], 2
    s_branch Lf_tail
Lf_last3:
    v_add_u32 v236, 6240, v236
    s_lshr_b64 s[56:57], s[56:57], 3
Lf_tail:
    v_exp_f32 v132, v148
    v_exp_f32 v133, v149
    v_exp_f32 v134, v150
    v_exp_f32 v135, v151
    v_exp_f32 v136, v152
    v_exp_f32 v137, v153
    v_mfma_f32_4x4x4_16b_bf16 v[132:135], v[228:229], v[228:229], v[132:135]
    v_cvt_pk_bf16_f32 v208, v208, v209
    v_cvt_pk_bf16_f32 v209, v210, v211
    v_exp_f32 v138, v154
    s_nop 0
    v_mfma_f32_4x4x4_16b_bf16 v[212:215], v[208:209], v[188:189], v[212:215] cbsz:4 abid:0
    ds_read_b64_tr_b16 v[188:189], v236 offset:0
    v_exp_f32 v139, v155
    v_exp_f32 v140, v156
    v_mfma_f32_4x4x4_16b_bf16 v[212:215], v[208:209], v[190:191], v[212:215] cbsz:4 abid:4
    ds_read_b64_tr_b16 v[190:191], v236 offset:512
    v_mfma_f32_4x4x4_16b_bf16 v[136:139], v[228:229], v[228:229], v[136:139]
    v_rcp_f32 v132, v132
    v_mfma_f32_4x4x4_16b_bf16 v[212:215], v[208:209], v[192:193], v[212:215] cbsz:4 abid:8
    ds_read_b64_tr_b16 v[192:193], v236 offset:1056
    v_exp_f32 v141, v157
    v_rcp_f32 v133, v133
    v_mfma_f32_4x4x4_16b_bf16 v[212:215], v[208:209], v[194:195], v[212:215] cbsz:4 abid:12
    ds_read_b64_tr_b16 v[194:195], v236 offset:1568
    v_exp_f32 v142, v158
    v_rcp_f32 v134, v134
    v_exp_f32 v143, v159
    v_rcp_f32 v135, v135
    v_cvt_pk_bf16_f32 v132, v132, v133
    v_mfma_f32_4x4x4_16b_bf16 v[140:143], v[228:229], v[228:229], v[140:143]
    v_exp_f32 v144, v160
    v_rcp_f32 v136, v136
    v_cvt_pk_bf16_f32 v133, v134, v135
    s_bitcmp0_b64 s[56:57], 1
    s_cbranch_scc1 Lf_tnf
    v_cvt_pk_bf16_f32 v246, v212, v212
    v_mov_b32 v212, 0
    ds_write_b16 v240, v246
    v_add_u32 v240, 128, v240
Lf_tnf:
    s_waitcnt lgkmcnt(0)
    v_exp_f32 v145, v161
    v_rcp_f32 v137, v137
    v_exp_f32 v146, v162
    v_rcp_f32 v138, v138
    v_cvt_pk_bf16_f32 v134, v136, v137
    v_exp_f32 v147, v163
    v_rcp_f32 v139, v139
    s_nop 0
    v_mfma_f32_4x4x4_16b_bf16 v[144:147], v[228:229], v[228:229], v[144:147]
    v_rcp_f32 v140, v140
    v_rcp_f32 v141, v141
    v_cvt_pk_bf16_f32 v135, v138, v139
    v_rcp_f32 v142, v142
    v_cvt_pk_bf16_f32 v136, v140, v141
    v_mfma_f32_16x16x32_bf16 v[208:211], v[132:135], v[196:199], v[204:207]
    v_rcp_f32 v143, v143
    v_rcp_f32 v144, v144
    v_cvt_pk_bf16_f32 v137, v142, v143
    v_rcp_f32 v145, v145
    v_rcp_f32 v146, v146
    v_rcp_f32 v147, v147
    v_cvt_pk_bf16_f32 v138, v144, v145
    v_cvt_pk_bf16_f32 v139, v146, v147
    s_nop 1
    v_mfma_f32_16x16x32_bf16 v[208:211], v[136:139], v[200:203], v[208:211]
    s_nop 7
    v_cvt_pk_bf16_f32 v208, v208, v209
    v_cvt_pk_bf16_f32 v209, v210, v211
    s_nop 1
    v_mfma_f32_4x4x4_16b_bf16 v[212:215], v[208:209], v[188:189], v[212:215] cbsz:4 abid:0
    s_nop 1
    v_mfma_f32_4x4x4_16b_bf16 v[212:215], v[208:209], v[190:191], v[212:215] cbsz:4 abid:4
    s_nop 1
    v_mfma_f32_4x4x4_16b_bf16 v[212:215], v[208:209], v[192:193], v[212:215] cbsz:4 abid:8
    s_nop 1
    v_mfma_f32_4x4x4_16b_bf16 v[212:215], v[208:209], v[194:195], v[212:215] cbsz:4 abid:12
    s_nop 4
    v_cvt_pk_bf16_f32 v246, v212, v212
    ds_write_b16 v240, v246
L_store:
    s_add_u32 s66, s52, 8320
    v_lshl_add_u32 v247, v0, 4, s66
    ds_read_b128 v[148:151], v247
    s_waitcnt lgkmcnt(0)
    global_store_dwordx4 v243, v[148:151], s[18:19] sc0 sc1
L_end:
    s_endpgm
L_general:
    s_waitcnt vmcnt(0)
    ds_read_b128 v[44:47], v246 offset:20480
    ds_read_b128 v[48:51], v246 offset:21504
    ds_read_b128 v[88:91], v246 offset:22528
    ds_read_b128 v[52:55], v246 offset:40960
    ds_read_b128 v[56:59], v246 offset:41984
    ds_read_b128 v[92:95], v246 offset:43008
    ds_read_b128 v[60:63], v246 offset:61440
    ds_read_b128 v[64:67], v246 offset:62464
    ds_read_b128 v[96:99], v246 offset:63488
    ds_read_u16 v224, v238 offset:0
    ds_read_u16 v225, v238 offset:8
    ds_read_u16 v226, v238 offset:64
    ds_read_u16 v227, v238 offset:72
    s_mov_b32 s20, s6
    s_and_b32 s21, s7, 0xffff
    s_or_b32 s21, s21, 0x800000
    s_mov_b32 s22, 200
    s_mov_b32 s23, 0x20000
    s_sub_u32 s40, s20, 1056
    s_subb_u32 s41, s21, 0
    s_mov_b32 s42, 200
    s_mov_b32 s43, 0x20000
    s_movk_i32 s31, 25600
    s_mov_b32 s60, 7
    s_mov_b64 s[56:57], 0
    s_mov_b64 s[58:59], 0
    v_mov_b32 v148, -1
    v_mov_b32 v149, -1
    v_mov_b32 v150, -1
    v_mov_b32 v151, -1
    s_add_u32 s66, s52, 18432
    v_add_u32 v152, s66, v2
    ds_write_b128 v152, v[148:151]
    ds_write_b128 v152, v[148:151] offset:1024
    s_add_u32 s64, s52, 18448
    s_bfm_b64 s[28:29], 50, 0
    s_mul_i32 s66, s53, 800
    v_add_u32 v247, s66, v2
    s_mov_b64 exec, s[28:29]
    global_load_dwordx4 v[100:103], v247, s[8:9]
    v_add_u32 v247, 1638400, v247
    global_load_dwordx4 v[104:107], v247, s[8:9]
    v_add_u32 v247, 1638400, v247
    global_load_dwordx4 v[108:111], v247, s[8:9]
    v_add_u32 v247, 1638400, v247
    global_load_dwordx4 v[112:115], v247, s[8:9]
    v_add_u32 v247, 1638400, v247
    s_mov_b64 exec, -1
    v_cmp_lt_u32 vcc, 24, v0
    s_nop 1
    v_cndmask_b32 v145, 0, 1, vcc
    v_mul_u32_u24 v142, 25, v145
    v_sub_u32 v142, v0, v142
    v_mul_u32_u24 v142, 0x80008, v142
    v_add_u32 v141, 0x10000, v142
    v_add_u32 v143, 0x50004, v142
    v_add_u32 v144, 0x70006, v142
    v_add_u32 v142, 0x30002, v142
    s_waitcnt vmcnt(0)
    s_mov_b64 exec, s[28:29]
    v_cmp_neq_f16_sdwa s[68:69], v100, 0 src0_sel:WORD_0 src1_sel:WORD_0
    v_cmp_neq_f16_sdwa s[70:71], v100, 0 src0_sel:WORD_1 src1_sel:WORD_0
    v_cmp_neq_f16_sdwa s[72:73], v101, 0 src0_sel:WORD_0 src1_sel:WORD_0
    v_cmp_neq_f16_sdwa s[74:75], v101, 0 src0_sel:WORD_1 src1_sel:WORD_0
    v_cmp_neq_f16_sdwa s[76:77], v102, 0 src0_sel:WORD_0 src1_sel:WORD_0
    v_cmp_neq_f16_sdwa s[78:79], v102, 0 src0_sel:WORD_1 src1_sel:WORD_0
    v_cmp_neq_f16_sdwa s[80:81], v103, 0 src0_sel:WORD_0 src1_sel:WORD_0
    v_cmp_neq_f16_sdwa s[82:83], v103, 0 src0_sel:WORD_1 src1_sel:WORD_0
    s_mov_b64 exec, -1
    v_mov_b32 v132, s64
    v_mbcnt_lo_u32_b32 v132, s68, v132
    v_mbcnt_hi_u32_b32 v132, s69, v132
    v_mbcnt_lo_u32_b32 v132, s70, v132
    v_mbcnt_hi_u32_b32 v132, s71, v132
    v_mbcnt_lo_u32_b32 v132, s72, v132
    v_mbcnt_hi_u32_b32 v132, s73, v132
    v_mbcnt_lo_u32_b32 v132, s74, v132
    v_mbcnt_hi_u32_b32 v132, s75, v132
    v_mbcnt_lo_u32_b32 v132, s76, v132
    v_mbcnt_hi_u32_b32 v132, s77, v132
    v_mbcnt_lo_u32_b32 v132, s78, v132
    v_mbcnt_hi_u32_b32 v132, s79, v132
    v_mbcnt_lo_u32_b32 v132, s80, v132
    v_mbcnt_hi_u32_b32 v132, s81, v132
    v_mbcnt_lo_u32_b32 v132, s82, v132
    v_mbcnt_hi_u32_b32 v132, s83, v132
    s_add_u32 s55, s64, 16
    v_readlane_b32 s66, v132, 25
    v_readlane_b32 s67, v132, 63
    s_add_u32 s64, s66, 15
    s_and_b32 s64, s64, -16
    s_max_u32 s64, s64, s55
    s_sub_u32 s66, s64, s66
    v_mad_u32_u24 v132, v145, s66, v132
    s_mov_b32 s55, s64
    v_addc_co_u32 v133, vcc, 0, v132, s[68:69]
    v_addc_co_u32 v134, vcc, 0, v133, s[70:71]
    v_addc_co_u32 v135, vcc, 0, v134, s[72:73]
    v_addc_co_u32 v136, vcc, 0, v135, s[74:75]
    v_addc_co_u32 v137, vcc, 0, v136, s[76:77]
    v_addc_co_u32 v138, vcc, 0, v137, s[78:79]
    v_addc_co_u32 v139, vcc, 0, v138, s[80:81]
    s_add_u32 s67, s67, s66
    s_add_u32 s67, s67, 15
    s_and_b32 s67, s67, -16
    s_add_u32 s64, s64, 16
    s_max_u32 s64, s64, s67
    s_mov_b64 exec, s[68:69]
    ds_write_b8 v132, v141
    s_mov_b64 exec, s[70:71]
    ds_write_b8_d16_hi v133, v141
    s_mov_b64 exec, s[72:73]
    ds_write_b8 v134, v142
    s_mov_b64 exec, s[74:75]
    ds_write_b8_d16_hi v135, v142
    s_mov_b64 exec, s[76:77]
    ds_write_b8 v136, v143
    s_mov_b64 exec, s[78:79]
    ds_write_b8_d16_hi v137, v143
    s_mov_b64 exec, s[80:81]
    ds_write_b8 v138, v144
    s_mov_b64 exec, s[82:83]
    ds_write_b8_d16_hi v139, v144
    s_mov_b64 exec, -1
    s_lshr_b32 s95, s55, 4
    s_bitset1_b64 s[56:57], s95
    s_lshr_b32 s95, s64, 4
    s_bitset1_b64 s[56:57], s95
    s_mov_b64 exec, s[28:29]
    v_cmp_neq_f16_sdwa s[68:69], v104, 0 src0_sel:WORD_0 src1_sel:WORD_0
    v_cmp_neq_f16_sdwa s[70:71], v104, 0 src0_sel:WORD_1 src1_sel:WORD_0
    v_cmp_neq_f16_sdwa s[72:73], v105, 0 src0_sel:WORD_0 src1_sel:WORD_0
    v_cmp_neq_f16_sdwa s[74:75], v105, 0 src0_sel:WORD_1 src1_sel:WORD_0
    v_cmp_neq_f16_sdwa s[76:77], v106, 0 src0_sel:WORD_0 src1_sel:WORD_0
    v_cmp_neq_f16_sdwa s[78:79], v106, 0 src0_sel:WORD_1 src1_sel:WORD_0
    v_cmp_neq_f16_sdwa s[80:81], v107, 0 src0_sel:WORD_0 src1_sel:WORD_0
    v_cmp_neq_f16_sdwa s[82:83], v107, 0 src0_sel:WORD_1 src1_sel:WORD_0
    s_mov_b64 exec, -1
    v_mov_b32 v132, s64
    v_mbcnt_lo_u32_b32 v132, s68, v132
    v_mbcnt_hi_u32_b32 v132, s69, v132
    v_mbcnt_lo_u32_b32 v132, s70, v132
    v_mbcnt_hi_u32_b32 v132, s71, v132
    v_mbcnt_lo_u32_b32 v132, s72, v132
    v_mbcnt_hi_u32_b32 v132, s73, v132
    v_mbcnt_lo_u32_b32 v132, s74, v132
    v_mbcnt_hi_u32_b32 v132, s75, v132
    v_mbcnt_lo_u32_b32 v132, s76, v132
    v_mbcnt_hi_u32_b32 v132, s77, v132
    v_mbcnt_lo_u32_b32 v132, s78, v132
    v_mbcnt_hi_u32_b32 v132, s79, v132
    v_mbcnt_lo_u32_b32 v132, s80, v132
    v_mbcnt_hi_u32_b32 v132, s81, v132
    v_mbcnt_lo_u32_b32 v132, s82, v132
    v_mbcnt_hi_u32_b32 v132, s83, v132
    s_add_u32 s55, s64, 16
    v_readlane_b32 s66, v132, 25
    v_readlane_b32 s67, v132, 63
    s_add_u32 s64, s66, 15
    s_and_b32 s64, s64, -16
    s_max_u32 s64, s64, s55
    s_sub_u32 s66, s64, s66
    v_mad_u32_u24 v132, v145, s66, v132
    s_mov_b32 s55, s64
    v_addc_co_u32 v133, vcc, 0, v132, s[68:69]
    v_addc_co_u32 v134, vcc, 0, v133, s[70:71]
    v_addc_co_u32 v135, vcc, 0, v134, s[72:73]
    v_addc_co_u32 v136, vcc, 0, v135, s[74:75]
    v_addc_co_u32 v137, vcc, 0, v136, s[76:77]
    v_addc_co_u32 v138, vcc, 0, v137, s[78:79]
    v_addc_co_u32 v139, vcc, 0, v138, s[80:81]
    s_add_u32 s67, s67, s66
    s_add_u32 s67, s67, 15
    s_and_b32 s67, s67, -16
    s_add_u32 s64, s64, 16
    s_max_u32 s64, s64, s67
    s_mov_b64 exec, s[68:69]
    ds_write_b8 v132, v141
    s_mov_b64 exec, s[70:71]
    ds_write_b8_d16_hi v133, v141
    s_mov_b64 exec, s[72:73]
    ds_write_b8 v134, v142
    s_mov_b64 exec, s[74:75]
    ds_write_b8_d16_hi v135, v142
    s_mov_b64 exec, s[76:77]
    ds_write_b8 v136, v143
    s_mov_b64 exec, s[78:79]
    ds_write_b8_d16_hi v137, v143
    s_mov_b64 exec, s[80:81]
    ds_write_b8 v138, v144
    s_mov_b64 exec, s[82:83]
    ds_write_b8_d16_hi v139, v144
    s_mov_b64 exec, -1
    s_lshr_b32 s95, s55, 4
    s_bitset1_b64 s[56:57], s95
    s_lshr_b32 s95, s64, 4
    s_bitset1_b64 s[56:57], s95
    s_mov_b64 exec, s[28:29]
    v_cmp_neq_f16_sdwa s[68:69], v108, 0 src0_sel:WORD_0 src1_sel:WORD_0
    v_cmp_neq_f16_sdwa s[70:71], v108, 0 src0_sel:WORD_1 src1_sel:WORD_0
    v_cmp_neq_f16_sdwa s[72:73], v109, 0 src0_sel:WORD_0 src1_sel:WORD_0
    v_cmp_neq_f16_sdwa s[74:75], v109, 0 src0_sel:WORD_1 src1_sel:WORD_0
    v_cmp_neq_f16_sdwa s[76:77], v110, 0 src0_sel:WORD_0 src1_sel:WORD_0
    v_cmp_neq_f16_sdwa s[78:79], v110, 0 src0_sel:WORD_1 src1_sel:WORD_0
    v_cmp_neq_f16_sdwa s[80:81], v111, 0 src0_sel:WORD_0 src1_sel:WORD_0
    v_cmp_neq_f16_sdwa s[82:83], v111, 0 src0_sel:WORD_1 src1_sel:WORD_0
    s_mov_b64 exec, -1
    v_mov_b32 v132, s64
    v_mbcnt_lo_u32_b32 v132, s68, v132
    v_mbcnt_hi_u32_b32 v132, s69, v132
    v_mbcnt_lo_u32_b32 v132, s70, v132
    v_mbcnt_hi_u32_b32 v132, s71, v132
    v_mbcnt_lo_u32_b32 v132, s72, v132
    v_mbcnt_hi_u32_b32 v132, s73, v132
    v_mbcnt_lo_u32_b32 v132, s74, v132
    v_mbcnt_hi_u32_b32 v132, s75, v132
    v_mbcnt_lo_u32_b32 v132, s76, v132
    v_mbcnt_hi_u32_b32 v132, s77, v132
    v_mbcnt_lo_u32_b32 v132, s78, v132
    v_mbcnt_hi_u32_b32 v132, s79, v132
    v_mbcnt_lo_u32_b32 v132, s80, v132
    v_mbcnt_hi_u32_b32 v132, s81, v132
    v_mbcnt_lo_u32_b32 v132, s82, v132
    v_mbcnt_hi_u32_b32 v132, s83, v132
    s_add_u32 s55, s64, 16
    v_readlane_b32 s66, v132, 25
    v_readlane_b32 s67, v132, 63
    s_add_u32 s64, s66, 15
    s_and_b32 s64, s64, -16
    s_max_u32 s64, s64, s55
    s_sub_u32 s66, s64, s66
    v_mad_u32_u24 v132, v145, s66, v132
    s_mov_b32 s55, s64
    v_addc_co_u32 v133, vcc, 0, v132, s[68:69]
    v_addc_co_u32 v134, vcc, 0, v133, s[70:71]
    v_addc_co_u32 v135, vcc, 0, v134, s[72:73]
    v_addc_co_u32 v136, vcc, 0, v135, s[74:75]
    v_addc_co_u32 v137, vcc, 0, v136, s[76:77]
    v_addc_co_u32 v138, vcc, 0, v137, s[78:79]
    v_addc_co_u32 v139, vcc, 0, v138, s[80:81]
    s_add_u32 s67, s67, s66
    s_add_u32 s67, s67, 15
    s_and_b32 s67, s67, -16
    s_add_u32 s64, s64, 16
    s_max_u32 s64, s64, s67
    s_mov_b64 exec, s[68:69]
    ds_write_b8 v132, v141
    s_mov_b64 exec, s[70:71]
    ds_write_b8_d16_hi v133, v141
    s_mov_b64 exec, s[72:73]
    ds_write_b8 v134, v142
    s_mov_b64 exec, s[74:75]
    ds_write_b8_d16_hi v135, v142
    s_mov_b64 exec, s[76:77]
    ds_write_b8 v136, v143
    s_mov_b64 exec, s[78:79]
    ds_write_b8_d16_hi v137, v143
    s_mov_b64 exec, s[80:81]
    ds_write_b8 v138, v144
    s_mov_b64 exec, s[82:83]
    ds_write_b8_d16_hi v139, v144
    s_mov_b64 exec, -1
    s_lshr_b32 s95, s55, 4
    s_lshl_b64 s[86:87], 1, s95
    s_bitcmp1_b32 s55, 10
    s_cselect_b64 s[88:89], 0, s[86:87]
    s_cselect_b64 s[90:91], s[86:87], 0
    s_or_b64 s[56:57], s[56:57], s[88:89]
    s_or_b64 s[58:59], s[58:59], s[90:91]
    s_lshr_b32 s95, s64, 4
    s_lshl_b64 s[86:87], 1, s95
    s_bitcmp1_b32 s64, 10
    s_cselect_b64 s[88:89], 0, s[86:87]
    s_cselect_b64 s[90:91], s[86:87], 0
    s_or_b64 s[56:57], s[56:57], s[88:89]
    s_or_b64 s[58:59], s[58:59], s[90:91]
    s_mov_b64 exec, s[28:29]
    v_cmp_neq_f16_sdwa s[68:69], v112, 0 src0_sel:WORD_0 src1_sel:WORD_0
    v_cmp_neq_f16_sdwa s[70:71], v112, 0 src0_sel:WORD_1 src1_sel:WORD_0
    v_cmp_neq_f16_sdwa s[72:73], v113, 0 src0_sel:WORD_0 src1_sel:WORD_0
    v_cmp_neq_f16_sdwa s[74:75], v113, 0 src0_sel:WORD_1 src1_sel:WORD_0
    v_cmp_neq_f16_sdwa s[76:77], v114, 0 src0_sel:WORD_0 src1_sel:WORD_0
    v_cmp_neq_f16_sdwa s[78:79], v114, 0 src0_sel:WORD_1 src1_sel:WORD_0
    v_cmp_neq_f16_sdwa s[80:81], v115, 0 src0_sel:WORD_0 src1_sel:WORD_0
    v_cmp_neq_f16_sdwa s[82:83], v115, 0 src0_sel:WORD_1 src1_sel:WORD_0
    s_mov_b64 exec, -1
    v_mov_b32 v132, s64
    v_mbcnt_lo_u32_b32 v132, s68, v132
    v_mbcnt_hi_u32_b32 v132, s69, v132
    v_mbcnt_lo_u32_b32 v132, s70, v132
    v_mbcnt_hi_u32_b32 v132, s71, v132
    v_mbcnt_lo_u32_b32 v132, s72, v132
    v_mbcnt_hi_u32_b32 v132, s73, v132
    v_mbcnt_lo_u32_b32 v132, s74, v132
    v_mbcnt_hi_u32_b32 v132, s75, v132
    v_mbcnt_lo_u32_b32 v132, s76, v132
    v_mbcnt_hi_u32_b32 v132, s77, v132
    v_mbcnt_lo_u32_b32 v132, s78, v132
    v_mbcnt_hi_u32_b32 v132, s79, v132
    v_mbcnt_lo_u32_b32 v132, s80, v132
    v_mbcnt_hi_u32_b32 v132, s81, v132
    v_mbcnt_lo_u32_b32 v132, s82, v132
    v_mbcnt_hi_u32_b32 v132, s83, v132
    s_add_u32 s55, s64, 16
    v_readlane_b32 s66, v132, 25
    v_readlane_b32 s67, v132, 63
    s_add_u32 s64, s66, 15
    s_and_b32 s64, s64, -16
    s_max_u32 s64, s64, s55
    s_sub_u32 s66, s64, s66
    v_mad_u32_u24 v132, v145, s66, v132
    s_mov_b32 s55, s64
    v_addc_co_u32 v133, vcc, 0, v132, s[68:69]
    v_addc_co_u32 v134, vcc, 0, v133, s[70:71]
    v_addc_co_u32 v135, vcc, 0, v134, s[72:73]
    v_addc_co_u32 v136, vcc, 0, v135, s[74:75]
    v_addc_co_u32 v137, vcc, 0, v136, s[76:77]
    v_addc_co_u32 v138, vcc, 0, v137, s[78:79]
    v_addc_co_u32 v139, vcc, 0, v138, s[80:81]
    s_add_u32 s67, s67, s66
    s_add_u32 s67, s67, 15
    s_and_b32 s67, s67, -16
    s_add_u32 s64, s64, 16
    s_max_u32 s64, s64, s67
    s_mov_b64 exec, s[68:69]
    ds_write_b8 v132, v141
    s_mov_b64 exec, s[70:71]
    ds_write_b8_d16_hi v133, v141
    s_mov_b64 exec, s[72:73]
    ds_write_b8 v134, v142
    s_mov_b64 exec, s[74:75]
    ds_write_b8_d16_hi v135, v142
    s_mov_b64 exec, s[76:77]
    ds_write_b8 v136, v143
    s_mov_b64 exec, s[78:79]
    ds_write_b8_d16_hi v137, v143
    s_mov_b64 exec, s[80:81]
    ds_write_b8 v138, v144
    s_mov_b64 exec, s[82:83]
    ds_write_b8_d16_hi v139, v144
    s_mov_b64 exec, -1
    s_lshr_b32 s95, s55, 4
    s_lshl_b64 s[86:87], 1, s95
    s_bitcmp1_b32 s55, 10
    s_cselect_b64 s[88:89], 0, s[86:87]
    s_cselect_b64 s[90:91], s[86:87], 0
    s_or_b64 s[56:57], s[56:57], s[88:89]
    s_or_b64 s[58:59], s[58:59], s[90:91]
    s_lshr_b32 s95, s64, 4
    s_lshl_b64 s[86:87], 1, s95
    s_bitcmp1_b32 s64, 10
    s_cselect_b64 s[88:89], 0, s[86:87]
    s_cselect_b64 s[90:91], s[86:87], 0
    s_or_b64 s[56:57], s[56:57], s[88:89]
    s_or_b64 s[58:59], s[58:59], s[90:91]
    s_mov_b32 s94, 0
    s_mov_b64 s[84:85], -1
    s_branch L_listed
Ls_loop:
    ds_read_u8 v230, v237 offset:64
    ds_read_u8 v232, v237 offset:72
    v_mfma_f32_16x16x32_bf16 v[208:211], v[136:139], v[200:203], v[208:211]
Ls_mid:
    s_bitcmp1_b32 s36, 0
    s_cbranch_scc1 Ls_ev0
Ls_evd0:
    ds_read_b32 v246, v244 offset:0
    s_waitcnt lgkmcnt(0)
    v_bfe_u32 v247, v246, 0, 8
    v_lshlrev_b32 v247, 1, v247
    v_bfe_u32 v248, v246, 8, 8
    v_lshlrev_b32 v248, 1, v248
    v_bfe_u32 v249, v246, 16, 8
    v_lshlrev_b32 v249, 1, v249
    v_bfe_u32 v250, v246, 24, 8
    v_lshlrev_b32 v250, 1, v250
    buffer_load_ushort v247, v247, s[24:27], 0 offen
    buffer_load_ushort v248, v248, s[24:27], 0 offen
    buffer_load_ushort v249, v249, s[24:27], 0 offen
    buffer_load_ushort v250, v250, s[24:27], 0 offen
    s_waitcnt vmcnt(0)
    v_lshlrev_b32 v247, 16, v247
    v_mul_f32 v208, v208, v247
    v_lshlrev_b32 v248, 16, v248
    v_mul_f32 v209, v209, v248
    v_lshlrev_b32 v249, 16, v249
    v_mul_f32 v210, v210, v249
    v_lshlrev_b32 v250, 16, v250
    v_mul_f32 v211, v211, v250
    s_mov_b64 exec, 1
    ds_add_rtn_u32 v1, v2, v3
    s_mov_b64 exec, -1
    v_exp_f32 v132, v148
    v_exp_f32 v133, v149
    v_exp_f32 v134, v150
    v_exp_f32 v135, v151
    v_exp_f32 v136, v152
    v_exp_f32 v137, v153
    v_mfma_f32_4x4x4_16b_bf16 v[132:135], v[228:229], v[228:229], v[132:135]
    v_cvt_pk_bf16_f32 v208, v208, v209
    v_cvt_pk_bf16_f32 v209, v210, v211
    s_waitcnt lgkmcnt(2)
    v_mfma_f32_16x16x32_bf16 v[148:151], v[100:103], v[180:183], v[164:167]
    v_exp_f32 v138, v154
    v_mfma_f32_4x4x4_16b_bf16 v[212:215], v[208:209], v[188:189], v[212:215] cbsz:4 abid:0
    ds_read_b64_tr_b16 v[188:189], v236 offset:0
    v_exp_f32 v139, v155
    v_mfma_f32_16x16x32_bf16 v[152:155], v[108:111], v[180:183], v[168:171]
    v_exp_f32 v140, v156
    v_mfma_f32_4x4x4_16b_bf16 v[212:215], v[208:209], v[190:191], v[212:215] cbsz:4 abid:4
    ds_read_b64_tr_b16 v[190:191], v236 offset:512
    v_mfma_f32_4x4x4_16b_bf16 v[136:139], v[228:229], v[228:229], v[136:139]
    v_rcp_f32 v132, v132
    v_mfma_f32_4x4x4_16b_bf16 v[212:215], v[208:209], v[192:193], v[212:215] cbsz:4 abid:8
    ds_read_b64_tr_b16 v[192:193], v236 offset:1056
    v_exp_f32 v141, v157
    v_mfma_f32_16x16x32_bf16 v[148:151], v[104:107], v[184:187], v[148:151]
    v_rcp_f32 v133, v133
    v_mfma_f32_4x4x4_16b_bf16 v[212:215], v[208:209], v[194:195], v[212:215] cbsz:4 abid:12
    ds_read_b64_tr_b16 v[194:195], v236 offset:1568
    v_exp_f32 v142, v158
    v_mfma_f32_16x16x32_bf16 v[152:155], v[112:115], v[184:187], v[152:155]
    v_rcp_f32 v134, v134
    v_exp_f32 v143, v159
    v_rcp_f32 v135, v135
    v_cvt_pk_bf16_f32 v132, v132, v133
    v_mfma_f32_4x4x4_16b_bf16 v[140:143], v[228:229], v[228:229], v[140:143]
    v_exp_f32 v144, v160
    v_mfma_f32_16x16x32_bf16 v[156:159], v[116:119], v[180:183], v[172:175]
    v_rcp_f32 v136, v136
    v_cvt_pk_bf16_f32 v133, v134, v135
    s_add_u32 m0, s52, 0
    s_waitcnt lgkmcnt(0)
    buffer_load_dwordx4 v[230:231], s[20:23], 0 idxen offen nt lds
    v_exp_f32 v145, v161
    buffer_load_dwordx4 v[232:233], s[40:43], 0 idxen offen offset:1056 nt lds
    v_rcp_f32 v137, v137
    v_exp_f32 v146, v162
    v_rcp_f32 v138, v138
    v_cvt_pk_bf16_f32 v134, v136, v137
    v_exp_f32 v147, v163
    v_mfma_f32_16x16x32_bf16 v[160:163], v[124:127], v[180:183], v[176:179]
    v_readfirstlane_b32 s66, v1
    s_setprio 0
    s_xor_b32 s66, s66, s33
    s_cmp_gt_i32 s66, 0
    s_cbranch_scc0 Ls_lo0
    s_setprio 1
Ls_lo0:
    v_rcp_f32 v139, v139
    v_mfma_f32_4x4x4_16b_bf16 v[144:147], v[228:229], v[228:229], v[144:147]
    v_mfma_f32_16x16x32_bf16 v[156:159], v[120:123], v[184:187], v[156:159]
    v_rcp_f32 v140, v140
    v_mfma_f32_16x16x32_bf16 v[160:163], v[128:131], v[184:187], v[160:163]
    v_rcp_f32 v141, v141
    v_cvt_pk_bf16_f32 v135, v138, v139
    s_waitcnt vmcnt(4)
    ds_read_b128 v[180:183], v234 offset:4160
    ds_read_b128 v[184:187], v235 offset:4160
    v_rcp_f32 v142, v142
    v_cvt_pk_bf16_f32 v136, v140, v141
    v_mfma_f32_16x16x32_bf16 v[208:211], v[132:135], v[196:199], v[204:207]
    v_rcp_f32 v143, v143
    v_rcp_f32 v144, v144
    v_cvt_pk_bf16_f32 v137, v142, v143
    v_rcp_f32 v145, v145
    v_rcp_f32 v146, v146
    v_rcp_f32 v147, v147
    v_cvt_pk_bf16_f32 v138, v144, v145
    v_cvt_pk_bf16_f32 v139, v146, v147
    ds_read_u8 v230, v237 offset:80
    ds_read_u8 v232, v237 offset:88
    v_mfma_f32_16x16x32_bf16 v[208:211], v[136:139], v[200:203], v[208:211]
    s_bitcmp1_b32 s36, 1
    s_cbranch_scc1 Ls_ev1
Ls_evd1:
    ds_read_b32 v246, v244 offset:16
    s_waitcnt lgkmcnt(0)
    v_bfe_u32 v247, v246, 0, 8
    v_lshlrev_b32 v247, 1, v247
    v_bfe_u32 v248, v246, 8, 8
    v_lshlrev_b32 v248, 1, v248
    v_bfe_u32 v249, v246, 16, 8
    v_lshlrev_b32 v249, 1, v249
    v_bfe_u32 v250, v246, 24, 8
    v_lshlrev_b32 v250, 1, v250
    buffer_load_ushort v247, v247, s[24:27], 0 offen
    buffer_load_ushort v248, v248, s[24:27], 0 offen
    buffer_load_ushort v249, v249, s[24:27], 0 offen
    buffer_load_ushort v250, v250, s[24:27], 0 offen
    s_waitcnt vmcnt(0)
    v_lshlrev_b32 v247, 16, v247
    v_mul_f32 v208, v208, v247
    v_lshlrev_b32 v248, 16, v248
    v_mul_f32 v209, v209, v248
    v_lshlrev_b32 v249, 16, v249
    v_mul_f32 v210, v210, v249
    v_lshlrev_b32 v250, 16, v250
    v_mul_f32 v211, v211, v250
    v_exp_f32 v132, v148
    v_exp_f32 v133, v149
    v_exp_f32 v134, v150
    v_exp_f32 v135, v151
    v_exp_f32 v136, v152
    v_exp_f32 v137, v153
    v_mfma_f32_4x4x4_16b_bf16 v[132:135], v[228:229], v[228:229], v[132:135]
    v_cvt_pk_bf16_f32 v208, v208, v209
    v_cvt_pk_bf16_f32 v209, v210, v211
    s_waitcnt lgkmcnt(2)
    v_mfma_f32_16x16x32_bf16 v[148:151], v[100:103], v[180:183], v[164:167]
    v_exp_f32 v138, v154
    v_mfma_f32_4x4x4_16b_bf16 v[212:215], v[208:209], v[188:189], v[212:215] cbsz:4 abid:0
    ds_read_b64_tr_b16 v[188:189], v236 offset:2080
    v_exp_f32 v139, v155
    v_mfma_f32_16x16x32_bf16 v[152:155], v[108:111], v[180:183], v[168:171]
    v_exp_f32 v140, v156
    v_mfma_f32_4x4x4_16b_bf16 v[212:215], v[208:209], v[190:191], v[212:215] cbsz:4 abid:4
    ds_read_b64_tr_b16 v[190:191], v236 offset:2592
    v_mfma_f32_4x4x4_16b_bf16 v[136:139], v[228:229], v[228:229], v[136:139]
    v_rcp_f32 v132, v132
    v_mfma_f32_4x4x4_16b_bf16 v[212:215], v[208:209], v[192:193], v[212:215] cbsz:4 abid:8
    ds_read_b64_tr_b16 v[192:193], v236 offset:3136
    v_exp_f32 v141, v157
    v_mfma_f32_16x16x32_bf16 v[148:151], v[104:107], v[184:187], v[148:151]
    v_rcp_f32 v133, v133
    v_mfma_f32_4x4x4_16b_bf16 v[212:215], v[208:209], v[194:195], v[212:215] cbsz:4 abid:12
    ds_read_b64_tr_b16 v[194:195], v236 offset:3648
    v_exp_f32 v142, v158
    v_mfma_f32_16x16x32_bf16 v[152:155], v[112:115], v[184:187], v[152:155]
    v_rcp_f32 v134, v134
    v_exp_f32 v143, v159
    v_rcp_f32 v135, v135
    v_cvt_pk_bf16_f32 v132, v132, v133
    v_mfma_f32_4x4x4_16b_bf16 v[140:143], v[228:229], v[228:229], v[140:143]
    v_exp_f32 v144, v160
    v_mfma_f32_16x16x32_bf16 v[156:159], v[116:119], v[180:183], v[172:175]
    v_rcp_f32 v136, v136
    v_cvt_pk_bf16_f32 v133, v134, v135
    s_add_u32 m0, s52, 2080
    s_waitcnt lgkmcnt(0)
    buffer_load_dwordx4 v[230:231], s[20:23], 0 idxen offen nt lds
    v_exp_f32 v145, v161
    buffer_load_dwordx4 v[232:233], s[40:43], 0 idxen offen offset:1056 nt lds
    v_rcp_f32 v137, v137
    v_exp_f32 v146, v162
    v_rcp_f32 v138, v138
    v_cvt_pk_bf16_f32 v134, v136, v137
    v_exp_f32 v147, v163
    v_mfma_f32_16x16x32_bf16 v[160:163], v[124:127], v[180:183], v[176:179]
    v_rcp_f32 v139, v139
    v_mfma_f32_4x4x4_16b_bf16 v[144:147], v[228:229], v[228:229], v[144:147]
    v_mfma_f32_16x16x32_bf16 v[156:159], v[120:123], v[184:187], v[156:159]
    v_rcp_f32 v140, v140
    v_mfma_f32_16x16x32_bf16 v[160:163], v[128:131], v[184:187], v[160:163]
    v_rcp_f32 v141, v141
    v_cvt_pk_bf16_f32 v135, v138, v139
    s_waitcnt vmcnt(4)
    ds_read_b128 v[180:183], v234 offset:6240
    ds_read_b128 v[184:187], v235 offset:6240
    v_rcp_f32 v142, v142
    v_cvt_pk_bf16_f32 v136, v140, v141
    v_mfma_f32_16x16x32_bf16 v[208:211], v[132:135], v[196:199], v[204:207]
    v_rcp_f32 v143, v143
    v_rcp_f32 v144, v144
    v_cvt_pk_bf16_f32 v137, v142, v143
    v_rcp_f32 v145, v145
    v_rcp_f32 v146, v146
    v_rcp_f32 v147, v147
    v_cvt_pk_bf16_f32 v138, v144, v145
    v_cvt_pk_bf16_f32 v139, v146, v147
    ds_read_u8 v230, v237 offset:96
    ds_read_u8 v232, v237 offset:104
    v_mfma_f32_16x16x32_bf16 v[208:211], v[136:139], v[200:203], v[208:211]
    s_bitcmp1_b32 s36, 2
    s_cbranch_scc1 Ls_ev2
Ls_evd2:
    ds_read_b32 v246, v244 offset:32
    s_waitcnt lgkmcnt(0)
    v_bfe_u32 v247, v246, 0, 8
    v_lshlrev_b32 v247, 1, v247
    v_bfe_u32 v248, v246, 8, 8
    v_lshlrev_b32 v248, 1, v248
    v_bfe_u32 v249, v246, 16, 8
    v_lshlrev_b32 v249, 1, v249
    v_bfe_u32 v250, v246, 24, 8
    v_lshlrev_b32 v250, 1, v250
    buffer_load_ushort v247, v247, s[24:27], 0 offen
    buffer_load_ushort v248, v248, s[24:27], 0 offen
    buffer_load_ushort v249, v249, s[24:27], 0 offen
    buffer_load_ushort v250, v250, s[24:27], 0 offen
    s_waitcnt vmcnt(0)
    v_lshlrev_b32 v247, 16, v247
    v_mul_f32 v208, v208, v247
    v_lshlrev_b32 v248, 16, v248
    v_mul_f32 v209, v209, v248
    v_lshlrev_b32 v249, 16, v249
    v_mul_f32 v210, v210, v249
    v_lshlrev_b32 v250, 16, v250
    v_mul_f32 v211, v211, v250
    v_exp_f32 v132, v148
    v_exp_f32 v133, v149
    v_exp_f32 v134, v150
    v_exp_f32 v135, v151
    v_exp_f32 v136, v152
    v_exp_f32 v137, v153
    v_mfma_f32_4x4x4_16b_bf16 v[132:135], v[228:229], v[228:229], v[132:135]
    v_cvt_pk_bf16_f32 v208, v208, v209
    v_cvt_pk_bf16_f32 v209, v210, v211
    s_waitcnt lgkmcnt(2)
    v_mfma_f32_16x16x32_bf16 v[148:151], v[100:103], v[180:183], v[164:167]
    v_exp_f32 v138, v154
    v_mfma_f32_4x4x4_16b_bf16 v[212:215], v[208:209], v[188:189], v[212:215] cbsz:4 abid:0
    ds_read_b64_tr_b16 v[188:189], v236 offset:4160
    v_exp_f32 v139, v155
    v_mfma_f32_16x16x32_bf16 v[152:155], v[108:111], v[180:183], v[168:171]
    v_exp_f32 v140, v156
    v_mfma_f32_4x4x4_16b_bf16 v[212:215], v[208:209], v[190:191], v[212:215] cbsz:4 abid:4
    ds_read_b64_tr_b16 v[190:191], v236 offset:4672
    v_mfma_f32_4x4x4_16b_bf16 v[136:139], v[228:229], v[228:229], v[136:139]
    v_rcp_f32 v132, v132
    v_mfma_f32_4x4x4_16b_bf16 v[212:215], v[208:209], v[192:193], v[212:215] cbsz:4 abid:8
    ds_read_b64_tr_b16 v[192:193], v236 offset:5216
    v_exp_f32 v141, v157
    v_mfma_f32_16x16x32_bf16 v[148:151], v[104:107], v[184:187], v[148:151]
    v_rcp_f32 v133, v133
    v_mfma_f32_4x4x4_16b_bf16 v[212:215], v[208:209], v[194:195], v[212:215] cbsz:4 abid:12
    ds_read_b64_tr_b16 v[194:195], v236 offset:5728
    v_exp_f32 v142, v158
    v_mfma_f32_16x16x32_bf16 v[152:155], v[112:115], v[184:187], v[152:155]
    v_rcp_f32 v134, v134
    v_exp_f32 v143, v159
    v_rcp_f32 v135, v135
    v_cvt_pk_bf16_f32 v132, v132, v133
    v_mfma_f32_4x4x4_16b_bf16 v[140:143], v[228:229], v[228:229], v[140:143]
    v_exp_f32 v144, v160
    v_mfma_f32_16x16x32_bf16 v[156:159], v[116:119], v[180:183], v[172:175]
    v_rcp_f32 v136, v136
    v_cvt_pk_bf16_f32 v133, v134, v135
    s_add_u32 m0, s52, 4160
    s_waitcnt lgkmcnt(0)
    buffer_load_dwordx4 v[230:231], s[20:23], 0 idxen offen nt lds
    v_exp_f32 v145, v161
    buffer_load_dwordx4 v[232:233], s[40:43], 0 idxen offen offset:1056 nt lds
    v_rcp_f32 v137, v137
    v_exp_f32 v146, v162
    v_rcp_f32 v138, v138
    v_cvt_pk_bf16_f32 v134, v136, v137
    v_exp_f32 v147, v163
    v_mfma_f32_16x16x32_bf16 v[160:163], v[124:127], v[180:183], v[176:179]
    v_rcp_f32 v139, v139
    v_mfma_f32_4x4x4_16b_bf16 v[144:147], v[228:229], v[228:229], v[144:147]
    v_mfma_f32_16x16x32_bf16 v[156:159], v[120:123], v[184:187], v[156:159]
    v_rcp_f32 v140, v140
    v_mfma_f32_16x16x32_bf16 v[160:163], v[128:131], v[184:187], v[160:163]
    v_rcp_f32 v141, v141
    v_cvt_pk_bf16_f32 v135, v138, v139
    s_waitcnt vmcnt(4)
    ds_read_b128 v[180:183], v234 offset:0
    ds_read_b128 v[184:187], v235 offset:0
    v_rcp_f32 v142, v142
    v_cvt_pk_bf16_f32 v136, v140, v141
    v_mfma_f32_16x16x32_bf16 v[208:211], v[132:135], v[196:199], v[204:207]
    v_rcp_f32 v143, v143
    v_rcp_f32 v144, v144
    v_cvt_pk_bf16_f32 v137, v142, v143
    v_rcp_f32 v145, v145
    v_rcp_f32 v146, v146
    v_rcp_f32 v147, v147
    v_cvt_pk_bf16_f32 v138, v144, v145
    v_cvt_pk_bf16_f32 v139, v146, v147
    ds_read_u8 v230, v237 offset:112
    ds_read_u8 v232, v237 offset:120
    v_mfma_f32_16x16x32_bf16 v[208:211], v[136:139], v[200:203], v[208:211]
    s_bitcmp1_b32 s36, 3
    s_cbranch_scc1 Ls_ev3
Ls_evd3:
    ds_read_b32 v246, v244 offset:48
    s_waitcnt lgkmcnt(0)
    v_bfe_u32 v247, v246, 0, 8
    v_lshlrev_b32 v247, 1, v247
    v_bfe_u32 v248, v246, 8, 8
    v_lshlrev_b32 v248, 1, v248
    v_bfe_u32 v249, v246, 16, 8
    v_lshlrev_b32 v249, 1, v249
    v_bfe_u32 v250, v246, 24, 8
    v_lshlrev_b32 v250, 1, v250
    buffer_load_ushort v247, v247, s[24:27], 0 offen
    buffer_load_ushort v248, v248, s[24:27], 0 offen
    buffer_load_ushort v249, v249, s[24:27], 0 offen
    buffer_load_ushort v250, v250, s[24:27], 0 offen
    s_waitcnt vmcnt(0)
    v_lshlrev_b32 v247, 16, v247
    v_mul_f32 v208, v208, v247
    v_lshlrev_b32 v248, 16, v248
    v_mul_f32 v209, v209, v248
    v_lshlrev_b32 v249, 16, v249
    v_mul_f32 v210, v210, v249
    v_lshlrev_b32 v250, 16, v250
    v_mul_f32 v211, v211, v250
    v_exp_f32 v132, v148
    v_exp_f32 v133, v149
    v_exp_f32 v134, v150
    v_exp_f32 v135, v151
    v_exp_f32 v136, v152
    v_exp_f32 v137, v153
    v_mfma_f32_4x4x4_16b_bf16 v[132:135], v[228:229], v[228:229], v[132:135]
    v_cvt_pk_bf16_f32 v208, v208, v209
    v_cvt_pk_bf16_f32 v209, v210, v211
    s_waitcnt lgkmcnt(2)
    v_mfma_f32_16x16x32_bf16 v[148:151], v[100:103], v[180:183], v[164:167]
    v_exp_f32 v138, v154
    v_mfma_f32_4x4x4_16b_bf16 v[212:215], v[208:209], v[188:189], v[212:215] cbsz:4 abid:0
    ds_read_b64_tr_b16 v[188:189], v236 offset:6240
    v_exp_f32 v139, v155
    v_mfma_f32_16x16x32_bf16 v[152:155], v[108:111], v[180:183], v[168:171]
    v_exp_f32 v140, v156
    v_mfma_f32_4x4x4_16b_bf16 v[212:215], v[208:209], v[190:191], v[212:215] cbsz:4 abid:4
    ds_read_b64_tr_b16 v[190:191], v236 offset:6752
    v_mfma_f32_4x4x4_16b_bf16 v[136:139], v[228:229], v[228:229], v[136:139]
    v_rcp_f32 v132, v132
    v_mfma_f32_4x4x4_16b_bf16 v[212:215], v[208:209], v[192:193], v[212:215] cbsz:4 abid:8
    ds_read_b64_tr_b16 v[192:193], v236 offset:7296
    v_exp_f32 v141, v157
    v_mfma_f32_16x16x32_bf16 v[148:151], v[104:107], v[184:187], v[148:151]
    v_rcp_f32 v133, v133
    v_mfma_f32_4x4x4_16b_bf16 v[212:215], v[208:209], v[194:195], v[212:215] cbsz:4 abid:12
    ds_read_b64_tr_b16 v[194:195], v236 offset:7808
    v_exp_f32 v142, v158
    v_mfma_f32_16x16x32_bf16 v[152:155], v[112:115], v[184:187], v[152:155]
    v_rcp_f32 v134, v134
    v_exp_f32 v143, v159
    v_rcp_f32 v135, v135
    v_cvt_pk_bf16_f32 v132, v132, v133
    v_mfma_f32_4x4x4_16b_bf16 v[140:143], v[228:229], v[228:229], v[140:143]
    v_exp_f32 v144, v160
    v_mfma_f32_16x16x32_bf16 v[156:159], v[116:119], v[180:183], v[172:175]
    v_rcp_f32 v136, v136
    v_cvt_pk_bf16_f32 v133, v134, v135
    s_add_u32 m0, s52, 6240
    s_waitcnt lgkmcnt(0)
    buffer_load_dwordx4 v[230:231], s[20:23], 0 idxen offen nt lds
    v_exp_f32 v145, v161
    buffer_load_dwordx4 v[232:233], s[40:43], 0 idxen offen offset:1056 nt lds
    v_rcp_f32 v137, v137
    v_exp_f32 v146, v162
    v_rcp_f32 v138, v138
    v_cvt_pk_bf16_f32 v134, v136, v137
    v_exp_f32 v147, v163
    v_mfma_f32_16x16x32_bf16 v[160:163], v[124:127], v[180:183], v[176:179]
    v_rcp_f32 v139, v139
    v_mfma_f32_4x4x4_16b_bf16 v[144:147], v[228:229], v[228:229], v[144:147]
    v_mfma_f32_16x16x32_bf16 v[156:159], v[120:123], v[184:187], v[156:159]
    v_rcp_f32 v140, v140
    v_mfma_f32_16x16x32_bf16 v[160:163], v[128:131], v[184:187], v[160:163]
    v_rcp_f32 v141, v141
    v_cvt_pk_bf16_f32 v135, v138, v139
    s_waitcnt vmcnt(4)
    ds_read_b128 v[180:183], v234 offset:2080
    ds_read_b128 v[184:187], v235 offset:2080
    v_rcp_f32 v142, v142
    v_cvt_pk_bf16_f32 v136, v140, v141
    v_mfma_f32_16x16x32_bf16 v[208:211], v[132:135], v[196:199], v[204:207]
    v_rcp_f32 v143, v143
    s_lshr_b64 s[56:57], s[56:57], 4
    s_lshl_b64 s[86:87], s[58:59], 60
    s_or_b64 s[56:57], s[56:57], s[86:87]
    s_lshr_b64 s[58:59], s[58:59], 4
    s_lshr_b64 s[86:87], s[56:57], 2
    s_lshr_b64 s[36:37], s[56:57], 5
    s_or_b32 s36, s36, s86
    s_or_b32 s36, s36, s56
    v_add_u32 v237, 64, v237
    v_add_u32 v244, 64, v244
    v_rcp_f32 v144, v144
    v_cvt_pk_bf16_f32 v137, v142, v143
    v_rcp_f32 v145, v145
    v_rcp_f32 v146, v146
    v_rcp_f32 v147, v147
    v_cvt_pk_bf16_f32 v138, v144, v145
    v_cvt_pk_bf16_f32 v139, v146, v147
    s_branch Ls_loop
Ls_ev0:
    s_bitcmp0_b64 s[56:57], 0
    s_cbranch_scc1 Ls_nf0
    v_cvt_pk_bf16_f32 v246, v212, v212
    v_mov_b32 v212, 0
    ds_write_b16 v240, v246
    v_add_u32 v240, 128, v240
    s_add_u32 s24, s24, s32
    s_addc_u32 s25, s25, 0
    s_xor_b32 s32, s32, 0x18ffe0
Ls_nf0:
    s_bitcmp0_b64 s[56:57], 5
    s_cbranch_scc1 Ls_na0
    s_sub_u32 s60, s60, 1
    s_cselect_b32 s31, 0, s31
    s_add_u32 s20, s20, s31
    s_addc_u32 s21, s21, 0
    s_add_u32 s40, s40, s31
    s_addc_u32 s41, s41, 0
    s_xor_b32 s31, s31, 0x63ff800
Ls_na0:
    s_bitcmp0_b64 s[56:57], 2
    s_cbranch_scc1 Ls_evd0
Ls_e10:
    s_sub_u32 s61, s61, 1
    s_cbranch_scc1 Ls_last0
    v_mul_u32_u24 v216, v224, v241
    v_mul_u32_u24 v217, v224, v242
    v_mul_u32_u24 v218, v225, v241
    v_mul_u32_u24 v219, v225, v242
    v_mul_u32_u24 v220, v226, v241
    v_mul_u32_u24 v221, v226, v242
    v_mul_u32_u24 v222, v227, v241
    v_mul_u32_u24 v223, v227, v242
    v_add_u32 v238, 128, v238
    ds_read_b128 v[164:167], v239
    v_mfma_f32_4x4x4_16b_bf16 v[132:135], v[216:217], v[68:69], v[4:7]
    ds_read_b128 v[168:171], v239 offset:64
    ds_read_b128 v[172:175], v239 offset:128
    v_mfma_f32_4x4x4_16b_bf16 v[136:139], v[218:219], v[70:71], v[8:11]
    ds_read_b128 v[176:179], v239 offset:192
    ds_read_u16 v224, v238
    v_mfma_f32_4x4x4_16b_bf16 v[140:143], v[220:221], v[72:73], v[12:15]
    ds_read_u16 v225, v238 offset:8
    ds_read_u16 v226, v238 offset:64
    v_mfma_f32_4x4x4_16b_bf16 v[144:147], v[222:223], v[74:75], v[16:19]
    ds_read_u16 v227, v238 offset:72
    v_add_u32 v239, 272, v239
    v_mfma_f32_4x4x4_16b_bf16 v[246:249], v[216:217], v[76:77], v[20:23]
    v_cvt_pk_bf16_f32 v100, v132, v133
    v_cvt_pk_bf16_f32 v101, v134, v135
    v_mfma_f32_4x4x4_16b_bf16 v[250:253], v[218:219], v[78:79], v[24:27]
    v_cvt_pk_bf16_f32 v102, v136, v137
    v_cvt_pk_bf16_f32 v103, v138, v139
    v_mfma_f32_4x4x4_16b_bf16 v[132:135], v[220:221], v[80:81], v[28:31]
    v_cvt_pk_bf16_f32 v104, v140, v141
    v_cvt_pk_bf16_f32 v105, v142, v143
    v_mfma_f32_4x4x4_16b_bf16 v[136:139], v[222:223], v[82:83], v[32:35]
    v_cvt_pk_bf16_f32 v106, v144, v145
    v_cvt_pk_bf16_f32 v107, v146, v147
    v_mfma_f32_4x4x4_16b_bf16 v[140:143], v[216:217], v[84:85], v[36:39]
    v_cvt_pk_bf16_f32 v108, v246, v247
    v_cvt_pk_bf16_f32 v109, v248, v249
    v_mfma_f32_4x4x4_16b_bf16 v[144:147], v[218:219], v[86:87], v[40:43]
    v_cvt_pk_bf16_f32 v110, v250, v251
    v_cvt_pk_bf16_f32 v111, v252, v253
    v_mfma_f32_4x4x4_16b_bf16 v[246:249], v[220:221], v[88:89], v[44:47]
    v_cvt_pk_bf16_f32 v112, v132, v133
    v_cvt_pk_bf16_f32 v113, v134, v135
    v_mfma_f32_4x4x4_16b_bf16 v[250:253], v[222:223], v[90:91], v[48:51]
    v_cvt_pk_bf16_f32 v114, v136, v137
    v_cvt_pk_bf16_f32 v115, v138, v139
    v_mfma_f32_4x4x4_16b_bf16 v[132:135], v[216:217], v[92:93], v[52:55]
    v_cvt_pk_bf16_f32 v116, v140, v141
    v_cvt_pk_bf16_f32 v117, v142, v143
    v_mfma_f32_4x4x4_16b_bf16 v[136:139], v[218:219], v[94:95], v[56:59]
    v_cvt_pk_bf16_f32 v118, v144, v145
    v_cvt_pk_bf16_f32 v119, v146, v147
    v_mfma_f32_4x4x4_16b_bf16 v[140:143], v[220:221], v[96:97], v[60:63]
    v_cvt_pk_bf16_f32 v120, v246, v247
    v_cvt_pk_bf16_f32 v121, v248, v249
    v_mfma_f32_4x4x4_16b_bf16 v[144:147], v[222:223], v[98:99], v[64:67]
    v_cvt_pk_bf16_f32 v122, v250, v251
    v_cvt_pk_bf16_f32 v123, v252, v253
    v_cvt_pk_bf16_f32 v124, v132, v133
    v_cvt_pk_bf16_f32 v125, v134, v135
    v_cvt_pk_bf16_f32 v126, v136, v137
    v_cvt_pk_bf16_f32 v127, v138, v139
    v_cvt_pk_bf16_f32 v128, v140, v141
    v_cvt_pk_bf16_f32 v129, v142, v143
    v_cvt_pk_bf16_f32 v130, v144, v145
    v_cvt_pk_bf16_f32 v131, v146, v147
    s_waitcnt lgkmcnt(0)
    s_branch Ls_evd0
Ls_ev1:
    s_bitcmp0_b64 s[56:57], 1
    s_cbranch_scc1 Ls_nf1
    v_cvt_pk_bf16_f32 v246, v212, v212
    v_mov_b32 v212, 0
    ds_write_b16 v240, v246
    v_add_u32 v240, 128, v240
    s_add_u32 s24, s24, s32
    s_addc_u32 s25, s25, 0
    s_xor_b32 s32, s32, 0x18ffe0
Ls_nf1:
    s_bitcmp0_b64 s[56:57], 6
    s_cbranch_scc1 Ls_na1
    s_sub_u32 s60, s60, 1
    s_cselect_b32 s31, 0, s31
    s_add_u32 s20, s20, s31
    s_addc_u32 s21, s21, 0
    s_add_u32 s40, s40, s31
    s_addc_u32 s41, s41, 0
    s_xor_b32 s31, s31, 0x63ff800
Ls_na1:
    s_bitcmp0_b64 s[56:57], 3
    s_cbranch_scc1 Ls_evd1
Ls_e11:
    s_sub_u32 s61, s61, 1
    s_cbranch_scc1 Ls_last1
    v_mul_u32_u24 v216, v224, v241
    v_mul_u32_u24 v217, v224, v242
    v_mul_u32_u24 v218, v225, v241
    v_mul_u32_u24 v219, v225, v242
    v_mul_u32_u24 v220, v226, v241
    v_mul_u32_u24 v221, v226, v242
    v_mul_u32_u24 v222, v227, v241
    v_mul_u32_u24 v223, v227, v242
    v_add_u32 v238, 128, v238
    ds_read_b128 v[164:167], v239
    v_mfma_f32_4x4x4_16b_bf16 v[132:135], v[216:217], v[68:69], v[4:7]
    ds_read_b128 v[168:171], v239 offset:64
    ds_read_b128 v[172:175], v239 offset:128
    v_mfma_f32_4x4x4_16b_bf16 v[136:139], v[218:219], v[70:71], v[8:11]
    ds_read_b128 v[176:179], v239 offset:192
    ds_read_u16 v224, v238
    v_mfma_f32_4x4x4_16b_bf16 v[140:143], v[220:221], v[72:73], v[12:15]
    ds_read_u16 v225, v238 offset:8
    ds_read_u16 v226, v238 offset:64
    v_mfma_f32_4x4x4_16b_bf16 v[144:147], v[222:223], v[74:75], v[16:19]
    ds_read_u16 v227, v238 offset:72
    v_add_u32 v239, 272, v239
    v_mfma_f32_4x4x4_16b_bf16 v[246:249], v[216:217], v[76:77], v[20:23]
    v_cvt_pk_bf16_f32 v100, v132, v133
    v_cvt_pk_bf16_f32 v101, v134, v135
    v_mfma_f32_4x4x4_16b_bf16 v[250:253], v[218:219], v[78:79], v[24:27]
    v_cvt_pk_bf16_f32 v102, v136, v137
    v_cvt_pk_bf16_f32 v103, v138, v139
    v_mfma_f32_4x4x4_16b_bf16 v[132:135], v[220:221], v[80:81], v[28:31]
    v_cvt_pk_bf16_f32 v104, v140, v141
    v_cvt_pk_bf16_f32 v105, v142, v143
    v_mfma_f32_4x4x4_16b_bf16 v[136:139], v[222:223], v[82:83], v[32:35]
    v_cvt_pk_bf16_f32 v106, v144, v145
    v_cvt_pk_bf16_f32 v107, v146, v147
    v_mfma_f32_4x4x4_16b_bf16 v[140:143], v[216:217], v[84:85], v[36:39]
    v_cvt_pk_bf16_f32 v108, v246, v247
    v_cvt_pk_bf16_f32 v109, v248, v249
    v_mfma_f32_4x4x4_16b_bf16 v[144:147], v[218:219], v[86:87], v[40:43]
    v_cvt_pk_bf16_f32 v110, v250, v251
    v_cvt_pk_bf16_f32 v111, v252, v253
    v_mfma_f32_4x4x4_16b_bf16 v[246:249], v[220:221], v[88:89], v[44:47]
    v_cvt_pk_bf16_f32 v112, v132, v133
    v_cvt_pk_bf16_f32 v113, v134, v135
    v_mfma_f32_4x4x4_16b_bf16 v[250:253], v[222:223], v[90:91], v[48:51]
    v_cvt_pk_bf16_f32 v114, v136, v137
    v_cvt_pk_bf16_f32 v115, v138, v139
    v_mfma_f32_4x4x4_16b_bf16 v[132:135], v[216:217], v[92:93], v[52:55]
    v_cvt_pk_bf16_f32 v116, v140, v141
    v_cvt_pk_bf16_f32 v117, v142, v143
    v_mfma_f32_4x4x4_16b_bf16 v[136:139], v[218:219], v[94:95], v[56:59]
    v_cvt_pk_bf16_f32 v118, v144, v145
    v_cvt_pk_bf16_f32 v119, v146, v147
    v_mfma_f32_4x4x4_16b_bf16 v[140:143], v[220:221], v[96:97], v[60:63]
    v_cvt_pk_bf16_f32 v120, v246, v247
    v_cvt_pk_bf16_f32 v121, v248, v249
    v_mfma_f32_4x4x4_16b_bf16 v[144:147], v[222:223], v[98:99], v[64:67]
    v_cvt_pk_bf16_f32 v122, v250, v251
    v_cvt_pk_bf16_f32 v123, v252, v253
    v_cvt_pk_bf16_f32 v124, v132, v133
    v_cvt_pk_bf16_f32 v125, v134, v135
    v_cvt_pk_bf16_f32 v126, v136, v137
    v_cvt_pk_bf16_f32 v127, v138, v139
    v_cvt_pk_bf16_f32 v128, v140, v141
    v_cvt_pk_bf16_f32 v129, v142, v143
    v_cvt_pk_bf16_f32 v130, v144, v145
    v_cvt_pk_bf16_f32 v131, v146, v147
    s_waitcnt lgkmcnt(0)
    s_branch Ls_evd1
Ls_ev2:
    s_bitcmp0_b64 s[56:57], 2
    s_cbranch_scc1 Ls_nf2
    v_cvt_pk_bf16_f32 v246, v212, v212
    v_mov_b32 v212, 0
    ds_write_b16 v240, v246
    v_add_u32 v240, 128, v240
    s_add_u32 s24, s24, s32
    s_addc_u32 s25, s25, 0
    s_xor_b32 s32, s32, 0x18ffe0
Ls_nf2:
    s_bitcmp0_b64 s[56:57], 7
    s_cbranch_scc1 Ls_na2
    s_sub_u32 s60, s60, 1
    s_cselect_b32 s31, 0, s31
    s_add_u32 s20, s20, s31
    s_addc_u32 s21, s21, 0
    s_add_u32 s40, s40, s31
    s_addc_u32 s41, s41, 0
    s_xor_b32 s31, s31, 0x63ff800
Ls_na2:
    s_bitcmp0_b64 s[56:57], 4
    s_cbranch_scc1 Ls_evd2
Ls_e12:
    s_sub_u32 s61, s61, 1
    s_cbranch_scc1 Ls_last2
    v_mul_u32_u24 v216, v224, v241
    v_mul_u32_u24 v217, v224, v242
    v_mul_u32_u24 v218, v225, v241
    v_mul_u32_u24 v219, v225, v242
    v_mul_u32_u24 v220, v226, v241
    v_mul_u32_u24 v221, v226, v242
    v_mul_u32_u24 v222, v227, v241
    v_mul_u32_u24 v223, v227, v242
    v_add_u32 v238, 128, v238
    ds_read_b128 v[164:167], v239
    v_mfma_f32_4x4x4_16b_bf16 v[132:135], v[216:217], v[68:69], v[4:7]
    ds_read_b128 v[168:171], v239 offset:64
    ds_read_b128 v[172:175], v239 offset:128
    v_mfma_f32_4x4x4_16b_bf16 v[136:139], v[218:219], v[70:71], v[8:11]
    ds_read_b128 v[176:179], v239 offset:192
    ds_read_u16 v224, v238
    v_mfma_f32_4x4x4_16b_bf16 v[140:143], v[220:221], v[72:73], v[12:15]
    ds_read_u16 v225, v238 offset:8
    ds_read_u16 v226, v238 offset:64
    v_mfma_f32_4x4x4_16b_bf16 v[144:147], v[222:223], v[74:75], v[16:19]
    ds_read_u16 v227, v238 offset:72
    v_add_u32 v239, 272, v239
    v_mfma_f32_4x4x4_16b_bf16 v[246:249], v[216:217], v[76:77], v[20:23]
    v_cvt_pk_bf16_f32 v100, v132, v133
    v_cvt_pk_bf16_f32 v101, v134, v135
    v_mfma_f32_4x4x4_16b_bf16 v[250:253], v[218:219], v[78:79], v[24:27]
    v_cvt_pk_bf16_f32 v102, v136, v137
    v_cvt_pk_bf16_f32 v103, v138, v139
    v_mfma_f32_4x4x4_16b_bf16 v[132:135], v[220:221], v[80:81], v[28:31]
    v_cvt_pk_bf16_f32 v104, v140, v141
    v_cvt_pk_bf16_f32 v105, v142, v143
    v_mfma_f32_4x4x4_16b_bf16 v[136:139], v[222:223], v[82:83], v[32:35]
    v_cvt_pk_bf16_f32 v106, v144, v145
    v_cvt_pk_bf16_f32 v107, v146, v147
    v_mfma_f32_4x4x4_16b_bf16 v[140:143], v[216:217], v[84:85], v[36:39]
    v_cvt_pk_bf16_f32 v108, v246, v247
    v_cvt_pk_bf16_f32 v109, v248, v249
    v_mfma_f32_4x4x4_16b_bf16 v[144:147], v[218:219], v[86:87], v[40:43]
    v_cvt_pk_bf16_f32 v110, v250, v251
    v_cvt_pk_bf16_f32 v111, v252, v253
    v_mfma_f32_4x4x4_16b_bf16 v[246:249], v[220:221], v[88:89], v[44:47]
    v_cvt_pk_bf16_f32 v112, v132, v133
    v_cvt_pk_bf16_f32 v113, v134, v135
    v_mfma_f32_4x4x4_16b_bf16 v[250:253], v[222:223], v[90:91], v[48:51]
    v_cvt_pk_bf16_f32 v114, v136, v137
    v_cvt_pk_bf16_f32 v115, v138, v139
    v_mfma_f32_4x4x4_16b_bf16 v[132:135], v[216:217], v[92:93], v[52:55]
    v_cvt_pk_bf16_f32 v116, v140, v141
    v_cvt_pk_bf16_f32 v117, v142, v143
    v_mfma_f32_4x4x4_16b_bf16 v[136:139], v[218:219], v[94:95], v[56:59]
    v_cvt_pk_bf16_f32 v118, v144, v145
    v_cvt_pk_bf16_f32 v119, v146, v147
    v_mfma_f32_4x4x4_16b_bf16 v[140:143], v[220:221], v[96:97], v[60:63]
    v_cvt_pk_bf16_f32 v120, v246, v247
    v_cvt_pk_bf16_f32 v121, v248, v249
    v_mfma_f32_4x4x4_16b_bf16 v[144:147], v[222:223], v[98:99], v[64:67]
    v_cvt_pk_bf16_f32 v122, v250, v251
    v_cvt_pk_bf16_f32 v123, v252, v253
    v_cvt_pk_bf16_f32 v124, v132, v133
    v_cvt_pk_bf16_f32 v125, v134, v135
    v_cvt_pk_bf16_f32 v126, v136, v137
    v_cvt_pk_bf16_f32 v127, v138, v139
    v_cvt_pk_bf16_f32 v128, v140, v141
    v_cvt_pk_bf16_f32 v129, v142, v143
    v_cvt_pk_bf16_f32 v130, v144, v145
    v_cvt_pk_bf16_f32 v131, v146, v147
    s_waitcnt lgkmcnt(0)
    s_branch Ls_evd2
Ls_ev3:
    s_bitcmp0_b64 s[56:57], 3
    s_cbranch_scc1 Ls_nf3
    v_cvt_pk_bf16_f32 v246, v212, v212
    v_mov_b32 v212, 0
    ds_write_b16 v240, v246
    v_add_u32 v240, 128, v240
    s_add_u32 s24, s24, s32
    s_addc_u32 s25, s25, 0
    s_xor_b32 s32, s32, 0x18ffe0
Ls_nf3:
    s_bitcmp0_b64 s[56:57], 8
    s_cbranch_scc1 Ls_na3
    s_sub_u32 s60, s60, 1
    s_cselect_b32 s31, 0, s31
    s_add_u32 s20, s20, s31
    s_addc_u32 s21, s21, 0
    s_add_u32 s40, s40, s31
    s_addc_u32 s41, s41, 0
    s_xor_b32 s31, s31, 0x63ff800
Ls_na3:
    s_bitcmp0_b64 s[56:57], 5
    s_cbranch_scc1 Ls_evd3
Ls_e13:
    s_sub_u32 s61, s61, 1
    s_cbranch_scc1 Ls_last3
    v_mul_u32_u24 v216, v224, v241
    v_mul_u32_u24 v217, v224, v242
    v_mul_u32_u24 v218, v225, v241
    v_mul_u32_u24 v219, v225, v242
    v_mul_u32_u24 v220, v226, v241
    v_mul_u32_u24 v221, v226, v242
    v_mul_u32_u24 v222, v227, v241
    v_mul_u32_u24 v223, v227, v242
    v_add_u32 v238, 128, v238
    ds_read_b128 v[164:167], v239
    v_mfma_f32_4x4x4_16b_bf16 v[132:135], v[216:217], v[68:69], v[4:7]
    ds_read_b128 v[168:171], v239 offset:64
    ds_read_b128 v[172:175], v239 offset:128
    v_mfma_f32_4x4x4_16b_bf16 v[136:139], v[218:219], v[70:71], v[8:11]
    ds_read_b128 v[176:179], v239 offset:192
    ds_read_u16 v224, v238
    v_mfma_f32_4x4x4_16b_bf16 v[140:143], v[220:221], v[72:73], v[12:15]
    ds_read_u16 v225, v238 offset:8
    ds_read_u16 v226, v238 offset:64
    v_mfma_f32_4x4x4_16b_bf16 v[144:147], v[222:223], v[74:75], v[16:19]
    ds_read_u16 v227, v238 offset:72
    v_add_u32 v239, 272, v239
    v_mfma_f32_4x4x4_16b_bf16 v[246:249], v[216:217], v[76:77], v[20:23]
    v_cvt_pk_bf16_f32 v100, v132, v133
    v_cvt_pk_bf16_f32 v101, v134, v135
    v_mfma_f32_4x4x4_16b_bf16 v[250:253], v[218:219], v[78:79], v[24:27]
    v_cvt_pk_bf16_f32 v102, v136, v137
    v_cvt_pk_bf16_f32 v103, v138, v139
    v_mfma_f32_4x4x4_16b_bf16 v[132:135], v[220:221], v[80:81], v[28:31]
    v_cvt_pk_bf16_f32 v104, v140, v141
    v_cvt_pk_bf16_f32 v105, v142, v143
    v_mfma_f32_4x4x4_16b_bf16 v[136:139], v[222:223], v[82:83], v[32:35]
    v_cvt_pk_bf16_f32 v106, v144, v145
    v_cvt_pk_bf16_f32 v107, v146, v147
    v_mfma_f32_4x4x4_16b_bf16 v[140:143], v[216:217], v[84:85], v[36:39]
    v_cvt_pk_bf16_f32 v108, v246, v247
    v_cvt_pk_bf16_f32 v109, v248, v249
    v_mfma_f32_4x4x4_16b_bf16 v[144:147], v[218:219], v[86:87], v[40:43]
    v_cvt_pk_bf16_f32 v110, v250, v251
    v_cvt_pk_bf16_f32 v111, v252, v253
    v_mfma_f32_4x4x4_16b_bf16 v[246:249], v[220:221], v[88:89], v[44:47]
    v_cvt_pk_bf16_f32 v112, v132, v133
    v_cvt_pk_bf16_f32 v113, v134, v135
    v_mfma_f32_4x4x4_16b_bf16 v[250:253], v[222:223], v[90:91], v[48:51]
    v_cvt_pk_bf16_f32 v114, v136, v137
    v_cvt_pk_bf16_f32 v115, v138, v139
    v_mfma_f32_4x4x4_16b_bf16 v[132:135], v[216:217], v[92:93], v[52:55]
    v_cvt_pk_bf16_f32 v116, v140, v141
    v_cvt_pk_bf16_f32 v117, v142, v143
    v_mfma_f32_4x4x4_16b_bf16 v[136:139], v[218:219], v[94:95], v[56:59]
    v_cvt_pk_bf16_f32 v118, v144, v145
    v_cvt_pk_bf16_f32 v119, v146, v147
    v_mfma_f32_4x4x4_16b_bf16 v[140:143], v[220:221], v[96:97], v[60:63]
    v_cvt_pk_bf16_f32 v120, v246, v247
    v_cvt_pk_bf16_f32 v121, v248, v249
    v_mfma_f32_4x4x4_16b_bf16 v[144:147], v[222:223], v[98:99], v[64:67]
    v_cvt_pk_bf16_f32 v122, v250, v251
    v_cvt_pk_bf16_f32 v123, v252, v253
    v_cvt_pk_bf16_f32 v124, v132, v133
    v_cvt_pk_bf16_f32 v125, v134, v135
    v_cvt_pk_bf16_f32 v126, v136, v137
    v_cvt_pk_bf16_f32 v127, v138, v139
    v_cvt_pk_bf16_f32 v128, v140, v141
    v_cvt_pk_bf16_f32 v129, v142, v143
    v_cvt_pk_bf16_f32 v130, v144, v145
    v_cvt_pk_bf16_f32 v131, v146, v147
    s_waitcnt lgkmcnt(0)
    s_branch Ls_evd3
Ls_last0:
    s_branch Ls_tail
Ls_last1:
    v_add_u32 v236, 2080, v236
    s_lshr_b64 s[56:57], s[56:57], 1
    v_add_u32 v244, 16, v244
    s_branch Ls_tail
Ls_last2:
    v_add_u32 v236, 4160, v236
    s_lshr_b64 s[56:57], s[56:57], 2
    v_add_u32 v244, 32, v244
    s_branch Ls_tail
Ls_last3:
    v_add_u32 v236, 6240, v236
    s_lshr_b64 s[56:57], s[56:57], 3
    v_add_u32 v244, 48, v244
Ls_tail:
    ds_read_b32 v246, v244 offset:0
    s_waitcnt lgkmcnt(0)
    v_bfe_u32 v247, v246, 0, 8
    v_lshlrev_b32 v247, 1, v247
    v_bfe_u32 v248, v246, 8, 8
    v_lshlrev_b32 v248, 1, v248
    v_bfe_u32 v249, v246, 16, 8
    v_lshlrev_b32 v249, 1, v249
    v_bfe_u32 v250, v246, 24, 8
    v_lshlrev_b32 v250, 1, v250
    buffer_load_ushort v247, v247, s[24:27], 0 offen
    buffer_load_ushort v248, v248, s[24:27], 0 offen
    buffer_load_ushort v249, v249, s[24:27], 0 offen
    buffer_load_ushort v250, v250, s[24:27], 0 offen
    s_waitcnt vmcnt(0)
    v_lshlrev_b32 v247, 16, v247
    v_mul_f32 v208, v208, v247
    v_lshlrev_b32 v248, 16, v248
    v_mul_f32 v209, v209, v248
    v_lshlrev_b32 v249, 16, v249
    v_mul_f32 v210, v210, v249
    v_lshlrev_b32 v250, 16, v250
    v_mul_f32 v211, v211, v250
    v_exp_f32 v132, v148
    v_exp_f32 v133, v149
    v_exp_f32 v134, v150
    v_exp_f32 v135, v151
    v_exp_f32 v136, v152
    v_exp_f32 v137, v153
    v_mfma_f32_4x4x4_16b_bf16 v[132:135], v[228:229], v[228:229], v[132:135]
    v_cvt_pk_bf16_f32 v208, v208, v209
    v_cvt_pk_bf16_f32 v209, v210, v211
    v_exp_f32 v138, v154
    s_nop 0
    v_mfma_f32_4x4x4_16b_bf16 v[212:215], v[208:209], v[188:189], v[212:215] cbsz:4 abid:0
    ds_read_b64_tr_b16 v[188:189], v236 offset:0
    v_exp_f32 v139, v155
    v_exp_f32 v140, v156
    v_mfma_f32_4x4x4_16b_bf16 v[212:215], v[208:209], v[190:191], v[212:215] cbsz:4 abid:4
    ds_read_b64_tr_b16 v[190:191], v236 offset:512
    v_mfma_f32_4x4x4_16b_bf16 v[136:139], v[228:229], v[228:229], v[136:139]
    v_rcp_f32 v132, v132
    v_mfma_f32_4x4x4_16b_bf16 v[212:215], v[208:209], v[192:193], v[212:215] cbsz:4 abid:8
    ds_read_b64_tr_b16 v[192:193], v236 offset:1056
    v_exp_f32 v141, v157
    v_rcp_f32 v133, v133
    v_mfma_f32_4x4x4_16b_bf16 v[212:215], v[208:209], v[194:195], v[212:215] cbsz:4 abid:12
    ds_read_b64_tr_b16 v[194:195], v236 offset:1568
    v_exp_f32 v142, v158
    v_rcp_f32 v134, v134
    v_exp_f32 v143, v159
    v_rcp_f32 v135, v135
    v_cvt_pk_bf16_f32 v132, v132, v133
    v_mfma_f32_4x4x4_16b_bf16 v[140:143], v[228:229], v[228:229], v[140:143]
    v_exp_f32 v144, v160
    v_rcp_f32 v136, v136
    v_cvt_pk_bf16_f32 v133, v134, v135
    s_bitcmp0_b64 s[56:57], 1
    s_cbranch_scc1 Ls_tnf
    v_cvt_pk_bf16_f32 v246, v212, v212
    v_mov_b32 v212, 0
    ds_write_b16 v240, v246
    v_add_u32 v240, 128, v240
    s_add_u32 s24, s24, s32
    s_addc_u32 s25, s25, 0
    s_xor_b32 s32, s32, 0x18ffe0
Ls_tnf:
    s_waitcnt lgkmcnt(0)
    v_exp_f32 v145, v161
    v_rcp_f32 v137, v137
    v_exp_f32 v146, v162
    v_rcp_f32 v138, v138
    v_cvt_pk_bf16_f32 v134, v136, v137
    v_exp_f32 v147, v163
    v_rcp_f32 v139, v139
    s_nop 0
    v_mfma_f32_4x4x4_16b_bf16 v[144:147], v[228:229], v[228:229], v[144:147]
    v_rcp_f32 v140, v140
    v_rcp_f32 v141, v141
    v_cvt_pk_bf16_f32 v135, v138, v139
    v_rcp_f32 v142, v142
    v_cvt_pk_bf16_f32 v136, v140, v141
    v_mfma_f32_16x16x32_bf16 v[208:211], v[132:135], v[196:199], v[204:207]
    v_rcp_f32 v143, v143
    v_rcp_f32 v144, v144
    v_cvt_pk_bf16_f32 v137, v142, v143
    v_rcp_f32 v145, v145
    v_rcp_f32 v146, v146
    v_rcp_f32 v147, v147
    v_cvt_pk_bf16_f32 v138, v144, v145
    v_cvt_pk_bf16_f32 v139, v146, v147
    s_nop 1
    v_mfma_f32_16x16x32_bf16 v[208:211], v[136:139], v[200:203], v[208:211]
    ds_read_b32 v246, v244 offset:16
    s_waitcnt lgkmcnt(0)
    v_bfe_u32 v247, v246, 0, 8
    v_lshlrev_b32 v247, 1, v247
    v_bfe_u32 v248, v246, 8, 8
    v_lshlrev_b32 v248, 1, v248
    v_bfe_u32 v249, v246, 16, 8
    v_lshlrev_b32 v249, 1, v249
    v_bfe_u32 v250, v246, 24, 8
    v_lshlrev_b32 v250, 1, v250
    buffer_load_ushort v247, v247, s[24:27], 0 offen
    buffer_load_ushort v248, v248, s[24:27], 0 offen
    buffer_load_ushort v249, v249, s[24:27], 0 offen
    buffer_load_ushort v250, v250, s[24:27], 0 offen
    s_waitcnt vmcnt(0)
    v_lshlrev_b32 v247, 16, v247
    v_mul_f32 v208, v208, v247
    v_lshlrev_b32 v248, 16, v248
    v_mul_f32 v209, v209, v248
    v_lshlrev_b32 v249, 16, v249
    v_mul_f32 v210, v210, v249
    v_lshlrev_b32 v250, 16, v250
    v_mul_f32 v211, v211, v250
    v_cvt_pk_bf16_f32 v208, v208, v209
    v_cvt_pk_bf16_f32 v209, v210, v211
    s_nop 1
    v_mfma_f32_4x4x4_16b_bf16 v[212:215], v[208:209], v[188:189], v[212:215] cbsz:4 abid:0
    s_nop 1
    v_mfma_f32_4x4x4_16b_bf16 v[212:215], v[208:209], v[190:191], v[212:215] cbsz:4 abid:4
    s_nop 1
    v_mfma_f32_4x4x4_16b_bf16 v[212:215], v[208:209], v[192:193], v[212:215] cbsz:4 abid:8
    s_nop 1
    v_mfma_f32_4x4x4_16b_bf16 v[212:215], v[208:209], v[194:195], v[212:215] cbsz:4 abid:12
    s_nop 4
    v_cvt_pk_bf16_f32 v246, v212, v212
    ds_write_b16 v240, v246
    s_branch L_store
.section .rodata,"a"
.p2align 6
.amdhsa_kernel standalone__sequential_behavior_din__recsys_kernel
  .amdhsa_next_free_vgpr 256
  .amdhsa_next_free_sgpr 102
  .amdhsa_accum_offset 256
  .amdhsa_group_segment_fixed_size 0
  .amdhsa_kernarg_size 80
  .amdhsa_user_sgpr_count 2
  .amdhsa_user_sgpr_kernarg_segment_ptr 1
  .amdhsa_system_sgpr_workgroup_id_x 1
.end_amdhsa_kernel
```

```asm
; @launch grid=(256,1,1) block=(512,1,1) lds=163840
.amdgcn_target "amdgcn-amd-amdhsa--gfx950"
.text
.globl standalone__sequential_behavior_din__recsys_kernel
.p2align 8
.type standalone__sequential_behavior_din__recsys_kernel,@function
standalone__sequential_behavior_din__recsys_kernel:
    s_load_dwordx16 s[4:19], s[0:1], 0
    s_cmp_ge_u32 s2, 256
    s_cbranch_scc1 L_end
    v_lshrrev_b32 v1, 6, v0
    v_and_b32 v0, 63, v0
    v_readfirstlane_b32 s54, v1
    s_lshl_b32 s53, s2, 3
    v_lshlrev_b32 v2, 4, v0
    v_lshrrev_b32 v1, 4, v0
    v_and_b32 v3, 0xf0, v2
    v_lshlrev_b32 v3, 2, v3
    v_lshl_add_u32 v130, v1, 4, v3
    v_bfrev_b32 v3, 1
    s_add_u32 s53, s53, s54
    s_movk_i32 s66, 800
    v_cmp_gt_u32 vcc, s66, v130
    s_mul_i32 s93, s53, 800
    s_mul_i32 s52, s54, 20480
    s_mov_b64 s[28:29], vcc
    v_cndmask_b32 v3, v3, v130, vcc
    v_and_b32 v248, 16, v0
    v_lshlrev_b32 v246, 1, v248
    v_xor_b32 v246, v246, v2
    s_lshl_b32 s67, s54, 12
    s_add_u32 m0, s52, 4160
    s_mov_b32 s26, 6553600
    s_mov_b32 s27, 0x20000
    s_waitcnt lgkmcnt(0)
    s_mov_b32 s24, s8
    s_and_b32 s25, s9, 0xffff
    buffer_load_dwordx4 v[100:103], v3, s[24:27], s93 offen nt
    s_add_u32 s10, s10, s67
    s_addc_u32 s11, s11, 0
    v_xor_b32 v247, 64, v246
    global_load_lds_dwordx4 v246, s[10:11] offset:0
    global_load_lds_dwordx4 v247, s[10:11] offset:1024
    global_load_lds_dwordx4 v246, s[10:11] offset:2048
    global_load_lds_dwordx4 v247, s[10:11] offset:3072
    s_load_dword s30, s[16:17], 0
    v_and_b32 v243, 0xf0, v2
    v_lshl_add_u32 v243, v1, 19, v243
    s_lshl_b32 s66, s53, 8
    s_add_u32 m0, s52, 8320
    v_add_u32 v243, s66, v243
    s_and_b32 s67, s54, 3
    global_load_lds_dwordx4 v243, s[4:5] nt
    s_lshl_b32 s66, s67, 5
    v_lshl_add_u32 v249, v1, 3, s66
    global_load_dwordx2 v[96:97], v249, s[12:13]
    v_and_b32 v250, 3, v0
    s_mov_b32 s20, s6
    s_and_b32 s21, s7, 0xffff
    s_or_b32 s21, s21, 0x800000
    s_mov_b32 s22, 200
    s_mov_b32 s23, 0x20000
    s_sub_u32 s40, s20, 1056
    s_subb_u32 s41, s21, 0
    s_mov_b32 s42, 200
    s_mov_b32 s43, 0x20000
    s_mul_i32 s35, s53, 51200
    s_movk_i32 s31, 25600
    s_mov_b64 s[56:57], 0
    s_mov_b64 s[58:59], 0
    v_mov_b32 v148, -1
    v_mov_b32 v149, -1
    v_mov_b32 v150, -1
    v_mov_b32 v151, -1
    s_add_u32 s66, s52, 18432
    v_add_u32 v152, s66, v2
    ds_write_b128 v152, v[148:151]
    ds_write_b128 v152, v[148:151] offset:1024
    s_add_u32 s64, s52, 18448
    v_mov_b32 v153, -1
    v_mov_b32 v154, -1
    v_mov_b32 v155, -1
    v_lshrrev_b32 v237, 3, v0
    v_add_u32 v237, s64, v237
    v_lshl_add_u32 v244, v1, 2, s66
    v_and_b32 v231, 0x70, v2
    v_lshlrev_b32 v248, 2, v248
    v_xor_b32 v231, v231, v248
    v_mov_b32 v233, v231
    s_movk_i32 s66, 400
    v_cmp_le_u32 vcc, s66, v130
    v_lshrrev_b32 v126, 1, v130
    s_movk_i32 s66, -200
    v_cndmask_b32 v130, 0, 1, vcc
    v_mad_i32_i24 v126, v130, s66, v126
    v_mul_u32_u24 v127, 0x10001, v126
    v_add_u32 v126, 0x10000, v127
    v_add_u32 v128, 0x50004, v127
    v_add_u32 v129, 0x70006, v127
    v_add_u32 v127, 0x30002, v127
    v_mov_b32 v131, 0xbfe0bfe0
    s_mov_b32 s86, 0xfff0ffff
    s_mov_b32 s87, 0xf000ff00
    s_mov_b32 s88, 0xff00fff0
    s_mov_b32 s89, 0xf000
    s_mov_b32 s90, 0xf0000f
    s_mov_b32 s91, 0xf0000f00
    s_mov_b32 s84, 0x11111113
    s_mov_b32 s85, 0x11111111
    v_cndmask_b32 v116, 0, v131, s[86:87]
    v_cndmask_b32 v120, 0, v131, s[88:89]
    v_cndmask_b32 v117, 0, v131, s[86:87]
    v_cndmask_b32 v121, 0, v131, s[88:89]
    v_cndmask_b32 v122, 0, v131, s[84:85]
    v_cndmask_b32 v123, 0, v131, s[84:85]
    v_cndmask_b32 v124, 0, v131, s[84:85]
    v_cndmask_b32 v125, 0, v131, s[84:85]
    v_lshlrev_b32 v246, 4, v250
    v_sub_u32 v246, 48, v246
    s_mov_b32 s86, 0xbfe0bfe0
    s_mov_b32 s87, 0xf0bfe0
    v_lshrrev_b64 v[118:119], v246, s[86:87]
    v_mov_b32 v131, 0
    s_mov_b64 s[84:85], 0
    v_cndmask_b32 v118, v120, v118, s[90:91]
    v_cndmask_b32 v119, v121, v119, s[90:91]
    s_mov_b32 s61, 7
    s_mov_b32 s92, 0xbfb8aa3b
    v_and_b32 v251, 15, v0
    v_bfe_u32 v252, v0, 2, 2
    v_lshlrev_b32 v253, 3, v250
    v_lshl_add_u32 v253, v252, 7, v253
    v_and_b32 v246, 24, v0
    v_lshlrev_b32 v246, 2, v246
    v_xor_b32 v246, v253, v246
    v_lshl_add_u32 v246, v1, 10, v246
    s_lshl_b32 s66, s67, 5
    v_xor_b32 v66, s66, v246
    v_add_u32 v66, 45120, v66
    s_lshr_b32 s66, s54, 1
    s_lshl_b32 s66, s66, 5
    v_xor_b32 v64, s66, v246
    s_and_b32 s66, s54, 1
    s_mul_i32 s66, s66, 20480
    s_add_u32 s66, s66, 4160
    v_add_u32 v64, s66, v64
    v_add_u32 v65, 81920, v64
    s_and_b32 s66, s54, 4
    v_lshrrev_b32 v246, 3, v251
    v_add_u32 v246, s66, v246
    v_mul_u32_u24 v246, 20480, v246
    v_lshl_add_u32 v246, v1, 4, v246
    v_and_b32 v247, 7, v0
    v_lshl_add_u32 v67, v247, 7, v246
    v_and_b32 v247, 1, v0
    v_lshlrev_b32 v247, 4, v247
    v_lshlrev_b32 v247, v247, 1
    v_cmp_gt_u32 vcc, 2, v250
    v_mov_b32 v229, 0
    v_mov_b32 v228, 0x3f80
    v_cndmask_b32 v241, 0, v247, vcc
    v_cmp_eq_u32 vcc, 0, v251
    v_sub_u32 v242, v247, v241
    v_mul_u32_u24 v218, 0x3f80, v241
    v_cndmask_b32 v220, 0, -1, vcc
    v_mul_u32_u24 v219, 0x3f80, v242
    s_and_b32 s66, s54, 3
    s_lshl_b32 s66, s66, 6
    s_add_u32 s66, s66, 9344
    v_and_b32 v247, 7, v0
    v_mul_u32_u24 v247, 144, v247
    v_add3_u32 v98, v67, v247, s66
    s_add_u32 s66, s52, 14592
    v_lshl_add_u32 v221, v0, 2, s66
    ds_write_b32 v221, v229
    s_xor_b32 s66, s54, 4
    s_mul_i32 s66, s66, 20480
    s_add_u32 s66, s66, 14592
    v_writelane_b32 v221, s66, 1
    v_and_b32 v247, 8, v0
    v_lshlrev_b32 v247, 2, v247
    v_lshl_add_u32 v247, v251, 7, v247
    v_add_u32 v247, s52, v247
    v_and_b32 v248, 2, v0
    v_lshlrev_b32 v248, 1, v248
    v_xor_b32 v248, v248, v1
    v_lshl_add_u32 v234, v248, 4, v247
    v_xor_b32 v248, 4, v248
    v_lshl_add_u32 v235, v248, 4, v247
    v_and_b32 v247, 8, v0
    v_lshlrev_b32 v247, 3, v247
    v_lshl_add_u32 v248, v1, 5, v253
    v_xor_b32 v248, v248, v247
    v_add_u32 v236, s52, v248
    s_add_u32 s66, s52, 8320
    v_lshl_add_u32 v238, v250, 1, s66
    v_lshl_add_u32 v238, v1, 4, v238
    v_lshl_add_u32 v240, v0, 1, s66
    s_add_u32 s66, s52, 9344
    v_lshl_add_u32 v239, v1, 4, s66
    v_mov_b32 v188, 0
    v_mov_b32 v189, 0
    v_mov_b32 v190, 0
    v_mov_b32 v191, 0
    v_mov_b32 v192, 0
    v_mov_b32 v193, 0
    v_mov_b32 v194, 0
    v_mov_b32 v195, 0
    v_mov_b32 v208, 0
    v_mov_b32 v212, 0
    v_mov_b32 v209, 0
    v_mov_b32 v213, 0
    v_mov_b32 v210, 0
    v_mov_b32 v214, 0
    v_mov_b32 v211, 0
    v_mov_b32 v215, 0
    s_add_u32 s93, s93, 1638400
    buffer_load_dwordx4 v[104:107], v3, s[24:27], s93 offen nt
    s_add_u32 s93, s93, 1638400
    buffer_load_dwordx4 v[108:111], v3, s[24:27], s93 offen nt
    s_add_u32 s93, s93, 1638400
    buffer_load_dwordx4 v[112:115], v3, s[24:27], s93 offen nt
    v_lshlrev_b32 v249, 3, v1
    v_lshl_add_u32 v249, v250, 5, v249
    global_load_dwordx2 v[216:217], v249, s[14:15]
    s_cmp_ge_u32 s54, 4
    s_cbranch_scc1 L_young1
    s_waitcnt vmcnt(10) lgkmcnt(0)
    s_call_b64 s[62:63], L_fp
    s_waitcnt vmcnt(9)
    s_branch L_old1
L_young1:
    s_waitcnt vmcnt(5)
L_old1:
    s_waitcnt lgkmcnt(0)
    s_barrier
    ds_read_b64_tr_b16 v[16:17], v66 offset:0
    ds_read_b64_tr_b16 v[18:19], v66 offset:512
    ds_read_b64_tr_b16 v[20:21], v66 offset:20480
    ds_read_b64_tr_b16 v[22:23], v66 offset:20992
    ds_read_b64_tr_b16 v[24:25], v66 offset:40960
    ds_read_b64_tr_b16 v[26:27], v66 offset:41472
    ds_read_b64_tr_b16 v[28:29], v66 offset:61440
    ds_read_b64_tr_b16 v[30:31], v66 offset:61952
    ds_read_b128 v[32:35], v67 offset:8320
    ds_read_b128 v[36:39], v67 offset:8384
    ds_read_b128 v[40:43], v67 offset:49280
    ds_read_b128 v[44:47], v67 offset:49344
    ds_read_b64_tr_b16 v[4:5], v64 offset:0
    ds_read_b64_tr_b16 v[8:9], v65 offset:0
    ds_read_b64_tr_b16 v[12:13], v65 offset:40960
    ds_read_b64_tr_b16 v[6:7], v64 offset:512
    ds_read_b64_tr_b16 v[10:11], v65 offset:512
    ds_read_b64_tr_b16 v[14:15], v65 offset:41472
    s_cmp_ge_u32 s54, 4
    s_cbranch_scc1 L_young2
    s_waitcnt vmcnt(8)
    s_branch L_old2
L_young2:
    s_waitcnt vmcnt(4)
L_old2:
    v_lshlrev_b32 v48, 16, v96
    v_and_b32 v49, 0xffff0000, v96
    v_lshlrev_b32 v50, 16, v97
    v_and_b32 v51, 0xffff0000, v97
    s_lshl_b32 s30, s30, 16
    v_and_b32 v204, s30, v220
    v_and_b32 v205, s30, v220
    v_and_b32 v206, s30, v220
    v_and_b32 v207, s30, v220
    s_waitcnt lgkmcnt(0)
    v_xor_b32 v24, 0x80008000, v24
    v_xor_b32 v25, 0x80008000, v25
    v_xor_b32 v26, 0x80008000, v26
    v_xor_b32 v27, 0x80008000, v27
    v_xor_b32 v28, 0x80008000, v28
    v_xor_b32 v29, 0x80008000, v29
    v_xor_b32 v30, 0x80008000, v30
    v_xor_b32 v31, 0x80008000, v31
    v_mfma_f32_4x4x4_16b_bf16 v[56:59], v[218:219], v[4:5], 0
    v_mfma_f32_4x4x4_16b_bf16 v[68:71], v[218:219], v[12:13], 0
    v_mfma_f32_4x4x4_16b_bf16 v[60:63], v[218:219], v[6:7], 0
    v_mfma_f32_4x4x4_16b_bf16 v[72:75], v[218:219], v[14:15], 0
    v_mfma_f32_4x4x4_16b_bf16 v[56:59], v[218:219], v[8:9], v[56:59]
    v_mfma_f32_4x4x4_16b_bf16 v[60:63], v[218:219], v[10:11], v[60:63]
    v_mfma_f32_16x16x32_bf16 v[52:55], v[16:19], v[40:43], v[48:51]
    v_mfma_f32_16x16x32_bf16 v[52:55], v[20:23], v[44:47], v[52:55]
    v_mfma_f32_16x16x32_bf16 v[52:55], v[24:27], v[40:43], v[52:55]
    v_mfma_f32_16x16x32_bf16 v[52:55], v[28:31], v[44:47], v[52:55]
    v_mfma_f32_16x16x32_bf16 v[48:51], v[16:19], v[32:35], v[48:51]
    v_mfma_f32_16x16x32_bf16 v[48:51], v[20:23], v[36:39], v[48:51]
    v_mfma_f32_16x16x32_bf16 v[48:51], v[24:27], v[32:35], v[48:51]
    v_mfma_f32_16x16x32_bf16 v[48:51], v[28:31], v[36:39], v[48:51]
    v_mul_f32 v56, s92, v56
    v_mul_f32 v57, s92, v57
    v_mul_f32 v58, s92, v58
    v_mul_f32 v59, s92, v59
    v_mul_f32 v60, s92, v60
    v_mul_f32 v61, s92, v61
    v_mul_f32 v62, s92, v62
    v_mul_f32 v63, s92, v63
    v_mul_f32 v68, s92, v68
    v_mul_f32 v69, s92, v69
    v_mul_f32 v70, s92, v70
    v_mul_f32 v71, s92, v71
    v_mul_f32 v72, s92, v72
    v_mul_f32 v73, s92, v73
    v_mul_f32 v74, s92, v74
    v_mul_f32 v75, s92, v75
    s_add_u32 s66, s52, 11520
    v_add_u32 v3, s66, v2
    v_cvt_pk_bf16_f32 v68, v68, v69
    v_cvt_pk_bf16_f32 v69, v70, v71
    v_cvt_pk_bf16_f32 v70, v72, v73
    v_cvt_pk_bf16_f32 v71, v74, v75
    v_mul_f32 v48, s92, v48
    v_mul_f32 v49, s92, v49
    v_mul_f32 v50, s92, v50
    v_mul_f32 v51, s92, v51
    v_mul_f32 v52, s92, v52
    v_mul_f32 v53, s92, v53
    v_mul_f32 v54, s92, v54
    v_mul_f32 v55, s92, v55
    ds_write_b128 v3, v[56:59]
    ds_write_b128 v3, v[60:63] offset:1024
    ds_write_b128 v3, v[68:71] offset:2048
    ds_write_b128 v98, v[48:51]
    ds_write_b128 v98, v[52:55] offset:40960
    v_add_u32 v3, 11520, v2
    v_add_u32 v246, 81920, v3
    s_waitcnt lgkmcnt(0)
    s_barrier
    s_cmp_ge_u32 s54, 4
    s_cbranch_scc0 L_old3
    s_call_b64 s[62:63], L_fp
    s_branch L_yng3
L_old3:
    s_call_b64 s[62:63], L_t23
L_yng3:
    ds_read_b128 v[4:7], v3 offset:0
    ds_read_b128 v[8:11], v3 offset:1024
    ds_read_b128 v[68:71], v3 offset:2048
    ds_read_b128 v[12:15], v3 offset:20480
    ds_read_b128 v[16:19], v3 offset:21504
    ds_read_b128 v[72:75], v3 offset:22528
    ds_read_b128 v[20:23], v3 offset:40960
    ds_read_b128 v[24:27], v3 offset:41984
    ds_read_b128 v[76:79], v3 offset:43008
    s_waitcnt vmcnt(4)
    v_mfma_i32_16x16x64_i8 v[172:175], v[122:125], v[104:107], 0
    v_mfma_i32_16x16x64_i8 v[176:179], v[122:125], v[108:111], 0
    v_mfma_i32_16x16x64_i8 v[180:183], v[122:125], v[112:115], 0
    v_and_b32 v160, 0x800080, v104
    v_mul_u32_u24 v160, 0x7f, v160
    v_bitop3_b32 v131, v104, v160, v131 bitop3:0xbe
    v_and_b32 v161, 0x800080, v105
    v_mul_u32_u24 v161, 0x7f, v161
    v_bitop3_b32 v131, v105, v161, v131 bitop3:0xbe
    v_and_b32 v160, 0x800080, v106
    v_mul_u32_u24 v160, 0x7f, v160
    v_bitop3_b32 v131, v106, v160, v131 bitop3:0xbe
    v_mov_b32_dpp v184, v172 row_shr:1 row_mask:0xf bank_mask:0xf bound_ctrl:0
    v_mov_b32_dpp v185, v176 row_shr:1 row_mask:0xf bank_mask:0xf bound_ctrl:0
    v_mov_b32_dpp v186, v180 row_shr:1 row_mask:0xf bank_mask:0xf bound_ctrl:0
    v_add_u32_dpp v184, v184, v184 row_shr:1 row_mask:0xf bank_mask:0xf bound_ctrl:0
    v_add_u32_dpp v185, v185, v185 row_shr:1 row_mask:0xf bank_mask:0xf bound_ctrl:0
    v_add_u32_dpp v186, v186, v186 row_shr:1 row_mask:0xf bank_mask:0xf bound_ctrl:0
    v_add_u32_dpp v184, v184, v184 row_shr:2 row_mask:0xf bank_mask:0xf bound_ctrl:0
    v_add_u32_dpp v185, v185, v185 row_shr:2 row_mask:0xf bank_mask:0xf bound_ctrl:0
    v_add_u32_dpp v186, v186, v186 row_shr:2 row_mask:0xf bank_mask:0xf bound_ctrl:0
    v_add_u32_dpp v184, v184, v184 row_shr:4 row_mask:0xf bank_mask:0xf bound_ctrl:0
    v_add_u32_dpp v185, v185, v185 row_shr:4 row_mask:0xf bank_mask:0xf bound_ctrl:0
    v_add_u32_dpp v186, v186, v186 row_shr:4 row_mask:0xf bank_mask:0xf bound_ctrl:0
    v_add_u32_dpp v184, v184, v184 row_shr:8 row_mask:0xf bank_mask:0xf bound_ctrl:0
    v_add_u32_dpp v185, v185, v185 row_shr:8 row_mask:0xf bank_mask:0xf bound_ctrl:0
    v_add_u32_dpp v186, v186, v186 row_shr:8 row_mask:0xf bank_mask:0xf bound_ctrl:0
    ds_read_b128 v[28:31], v3 offset:61440
    ds_read_b128 v[32:35], v3 offset:62464
    ds_read_b128 v[80:83], v3 offset:63488
    ds_read_b128 v[36:39], v246 offset:0
    ds_read_b128 v[40:43], v246 offset:1024
    ds_read_b128 v[84:87], v246 offset:2048
    v_and_b32 v161, 0x800080, v107
    v_mul_u32_u24 v161, 0x7f, v161
    v_bitop3_b32 v131, v107, v161, v131 bitop3:0xbe
    v_and_b32 v160, 0x800080, v108
    v_mul_u32_u24 v160, 0x7f, v160
    v_bitop3_b32 v131, v108, v160, v131 bitop3:0xbe
    v_and_b32 v161, 0x800080, v109
    v_mul_u32_u24 v161, 0x7f, v161
    v_bitop3_b32 v131, v109, v161, v131 bitop3:0xbe
    v_and_b32 v160, 0x800080, v110
    v_mul_u32_u24 v160, 0x7f, v160
    v_bitop3_b32 v131, v110, v160, v131 bitop3:0xbe
    v_and_b32 v161, 0x800080, v111
    v_mul_u32_u24 v161, 0x7f, v161
    v_bitop3_b32 v131, v111, v161, v131 bitop3:0xbe
    v_and_b32 v160, 0x800080, v112
    v_mul_u32_u24 v160, 0x7f, v160
    v_bitop3_b32 v131, v112, v160, v131 bitop3:0xbe
    v_and_b32 v161, 0x800080, v113
    v_mul_u32_u24 v161, 0x7f, v161
    v_bitop3_b32 v131, v113, v161, v131 bitop3:0xbe
    v_and_b32 v160, 0x800080, v114
    v_mul_u32_u24 v160, 0x7f, v160
    v_bitop3_b32 v131, v114, v160, v131 bitop3:0xbe
    v_and_b32 v161, 0x800080, v115
    v_mul_u32_u24 v161, 0x7f, v161
    v_bitop3_b32 v131, v115, v161, v131 bitop3:0xbe
    v_cmp_ne_u32 vcc, 0, v131
    v_readlane_b32 s68, v184, 6
    v_readlane_b32 s69, v173, 6
    v_readlane_b32 s70, v184, 15
    v_readlane_b32 s72, v185, 6
    v_readlane_b32 s73, v177, 6
    v_readlane_b32 s74, v185, 15
    v_readlane_b32 s76, v186, 6
    v_readlane_b32 s77, v181, 6
    v_readlane_b32 s78, v186, 15
    s_cbranch_vccnz L_general
    s_add_u32 s66, s68, s69
    s_add_u32 s66, s66, s64
    s_add_u32 s67, s66, 15
    s_and_b32 s67, s67, -16
    s_add_u32 s55, s64, 16
    s_max_u32 s67, s67, s55
    s_sub_u32 s66, s67, s66
    v_mad_u32_u24 v184, v130, s66, v184
    s_sub_u32 s55, s64, 2048
    v_add_u32 v172, s55, v184
    v_add_u32 v173, s55, v184
    v_add_u32 v174, s55, v184
    v_add_u32 v175, s55, v184
    s_add_u32 s64, s64, s70
    s_add_u32 s64, s64, s66
    v_mfma_i32_16x16x64_i8 v[132:135], v[118:121], v[104:107], v[172:175]
    v_mfma_i32_16x16x64_i8 v[136:139], v[116:119], v[104:107], v[172:175]
    s_add_u32 s64, s64, 15
    s_and_b32 s64, s64, -16
    s_add_u32 s55, s67, 16
    s_max_u32 s64, s64, s55
    s_lshr_b32 s95, s67, 4
    s_bitset1_b64 s[56:57], s95
    s_lshr_b32 s95, s64, 4
    s_bitset1_b64 s[56:57], s95
    s_add_u32 s66, s72, s73
    s_add_u32 s66, s66, s64
    s_add_u32 s67, s66, 15
    s_and_b32 s67, s67, -16
    s_add_u32 s55, s64, 16
    s_max_u32 s67, s67, s55
    s_sub_u32 s66, s67, s66
    v_mad_u32_u24 v185, v130, s66, v185
    s_sub_u32 s55, s64, 2048
    v_add_u32 v176, s55, v185
    v_add_u32 v177, s55, v185
    v_add_u32 v178, s55, v185
    v_add_u32 v179, s55, v185
    s_add_u32 s64, s64, s74
    s_add_u32 s64, s64, s66
    v_mfma_i32_16x16x64_i8 v[140:143], v[118:121], v[108:111], v[176:179]
    v_mfma_i32_16x16x64_i8 v[144:147], v[116:119], v[108:111], v[176:179]
    s_add_u32 s64, s64, 15
    s_and_b32 s64, s64, -16
    s_add_u32 s55, s67, 16
    s_max_u32 s64, s64, s55
    s_lshr_b32 s95, s67, 4
    s_lshl_b64 s[86:87], 1, s95
    s_bitcmp1_b32 s67, 10
    s_cselect_b64 s[88:89], 0, s[86:87]
    s_cselect_b64 s[90:91], s[86:87], 0
    s_or_b64 s[56:57], s[56:57], s[88:89]
    s_or_b64 s[58:59], s[58:59], s[90:91]
    s_lshr_b32 s95, s64, 4
    s_lshl_b64 s[86:87], 1, s95
    s_bitcmp1_b32 s64, 10
    s_cselect_b64 s[88:89], 0, s[86:87]
    s_cselect_b64 s[90:91], s[86:87], 0
    s_or_b64 s[56:57], s[56:57], s[88:89]
    s_or_b64 s[58:59], s[58:59], s[90:91]
    ds_write_b8 v132, v126
    ds_write_b8_d16_hi v133, v126
    ds_write_b8 v134, v127
    ds_write_b8_d16_hi v135, v127
    ds_write_b8 v136, v128
    ds_write_b8_d16_hi v137, v128
    ds_write_b8 v138, v129
    ds_write_b8_d16_hi v139, v129
    s_add_u32 s66, s76, s77
    s_add_u32 s66, s66, s64
    s_add_u32 s67, s66, 15
    s_and_b32 s67, s67, -16
    s_add_u32 s55, s64, 16
    s_max_u32 s67, s67, s55
    s_sub_u32 s66, s67, s66
    v_mad_u32_u24 v186, v130, s66, v186
    s_sub_u32 s55, s64, 2048
    v_add_u32 v180, s55, v186
    v_add_u32 v181, s55, v186
    v_add_u32 v182, s55, v186
    v_add_u32 v183, s55, v186
    s_add_u32 s64, s64, s78
    s_add_u32 s64, s64, s66
    v_mfma_i32_16x16x64_i8 v[164:167], v[118:121], v[112:115], v[180:183]
    v_mfma_i32_16x16x64_i8 v[168:171], v[116:119], v[112:115], v[180:183]
    s_add_u32 s64, s64, 15
    s_and_b32 s64, s64, -16
    s_add_u32 s55, s67, 16
    s_max_u32 s64, s64, s55
    s_lshr_b32 s95, s67, 4
    s_lshl_b64 s[86:87], 1, s95
    s_bitcmp1_b32 s67, 10
    s_cselect_b64 s[88:89], 0, s[86:87]
    s_cselect_b64 s[90:91], s[86:87], 0
    s_or_b64 s[56:57], s[56:57], s[88:89]
    s_or_b64 s[58:59], s[58:59], s[90:91]
    s_lshr_b32 s95, s64, 4
    s_lshl_b64 s[86:87], 1, s95
    s_bitcmp1_b32 s64, 10
    s_cselect_b64 s[88:89], 0, s[86:87]
    s_cselect_b64 s[90:91], s[86:87], 0
    s_or_b64 s[56:57], s[56:57], s[88:89]
    s_or_b64 s[58:59], s[58:59], s[90:91]
    ds_write_b8 v140, v126
    ds_write_b8_d16_hi v141, v126
    ds_write_b8 v142, v127
    ds_write_b8_d16_hi v143, v127
    ds_write_b8 v144, v128
    ds_write_b8_d16_hi v145, v128
    ds_write_b8 v146, v129
    ds_write_b8_d16_hi v147, v129
    ds_read_b128 v[44:47], v246 offset:20480
    ds_read_b128 v[48:51], v246 offset:21504
    ds_read_b128 v[88:91], v246 offset:22528
    ds_read_b128 v[52:55], v246 offset:40960
    ds_read_b128 v[56:59], v246 offset:41984
    ds_read_b128 v[92:95], v246 offset:43008
    ds_read_b128 v[60:63], v246 offset:61440
    ds_read_b128 v[64:67], v246 offset:62464
    ds_read_b128 v[96:99], v246 offset:63488
    ds_read_u16 v224, v238 offset:0
    ds_read_u16 v225, v238 offset:8
    ds_read_u16 v226, v238 offset:64
    ds_read_u16 v227, v238 offset:72
    ds_write_b8 v164, v126
    ds_write_b8_d16_hi v165, v126
    ds_write_b8 v166, v127
    ds_write_b8_d16_hi v167, v127
    ds_write_b8 v168, v128
    ds_write_b8_d16_hi v169, v128
    ds_write_b8 v170, v129
    ds_write_b8_d16_hi v171, v129
    s_cmp_ge_u32 s54, 4
    s_cbranch_scc0 L_old3b
    s_call_b64 s[62:63], L_t23
L_old3b:
L_listed:
    s_sub_u32 s66, s64, s52
    s_sub_u32 s66, s66, 18448
    s_lshr_b32 s66, s66, 3
    s_lshr_b32 s67, s54, 2
    s_mul_i32 s67, s67, 2
    s_add_u32 s66, s66, s67
    s_sub_u32 s67, 0, s66
    v_mov_b32 v2, v221
    v_mov_b32 v1, s66
    v_mov_b32 v3, -8
    v_writelane_b32 v1, s67, 1
    v_writelane_b32 v3, 8, 1
    ds_add_u32 v2, v1
    s_cmp_eq_u32 s94, 1
    s_cbranch_scc1 L_nolate
    ds_read_u8 v148, v237 offset:0
    ds_read_u8 v149, v237 offset:8
    ds_read_u8 v150, v237 offset:16
    ds_read_u8 v151, v237 offset:24
    ds_read_u8 v152, v237 offset:32
    ds_read_u8 v153, v237 offset:40
    ds_read_u8 v154, v237 offset:48
    ds_read_u8 v155, v237 offset:56
    s_waitcnt lgkmcnt(0)
    s_add_u32 m0, s52, 0
    v_mov_b32 v230, v148
    v_mov_b32 v232, v149
    buffer_load_dwordx4 v[230:231], s[20:23], s35 idxen offen nt lds
    buffer_load_dwordx4 v[232:233], s[40:43], s35 idxen offen offset:1056 nt lds
    s_bitcmp0_b64 s[56:57], 2
    s_cbranch_scc1 L_noadvl1
    s_add_u32 s35, s35, s31
    s_xor_b32 s31, s31, 0x63ff800
L_noadvl1:
    s_add_u32 m0, s52, 2080
    v_mov_b32 v230, v150
    v_mov_b32 v232, v151
    buffer_load_dwordx4 v[230:231], s[20:23], s35 idxen offen nt lds
    buffer_load_dwordx4 v[232:233], s[40:43], s35 idxen offen offset:1056 nt lds
    s_bitcmp0_b64 s[56:57], 3
    s_cbranch_scc1 L_noadvl2
    s_add_u32 s35, s35, s31
    s_xor_b32 s31, s31, 0x63ff800
L_noadvl2:
    s_add_u32 m0, s52, 4160
    v_mov_b32 v230, v152
    v_mov_b32 v232, v153
    buffer_load_dwordx4 v[230:231], s[20:23], s35 idxen offen nt lds
    buffer_load_dwordx4 v[232:233], s[40:43], s35 idxen offen offset:1056 nt lds
    s_bitcmp0_b64 s[56:57], 4
    s_cbranch_scc1 L_noadvl3
    s_add_u32 s35, s35, s31
    s_xor_b32 s31, s31, 0x63ff800
L_noadvl3:
    s_add_u32 m0, s52, 6240
    v_mov_b32 v230, v154
    v_mov_b32 v232, v155
    buffer_load_dwordx4 v[230:231], s[20:23], s35 idxen offen nt lds
    buffer_load_dwordx4 v[232:233], s[40:43], s35 idxen offen offset:1056 nt lds
L_nolate:
    v_and_b32_dpp v196, v216, v220 quad_perm:[0,0,0,0] row_mask:0xf bank_mask:0xf
    v_and_b32_dpp v197, v217, v220 quad_perm:[0,0,0,0] row_mask:0xf bank_mask:0xf
    v_and_b32_dpp v198, v216, v220 quad_perm:[1,1,1,1] row_mask:0xf bank_mask:0xf
    v_and_b32_dpp v199, v217, v220 quad_perm:[1,1,1,1] row_mask:0xf bank_mask:0xf
    v_and_b32_dpp v200, v216, v220 quad_perm:[2,2,2,2] row_mask:0xf bank_mask:0xf
    v_and_b32_dpp v201, v217, v220 quad_perm:[2,2,2,2] row_mask:0xf bank_mask:0xf
    v_and_b32_dpp v202, v216, v220 quad_perm:[3,3,3,3] row_mask:0xf bank_mask:0xf
    v_and_b32_dpp v203, v217, v220 quad_perm:[3,3,3,3] row_mask:0xf bank_mask:0xf
    s_waitcnt vmcnt(6) lgkmcnt(0)
    ds_read_b128 v[180:183], v234 offset:0
    ds_read_b128 v[184:187], v235 offset:0
    v_mul_u32_u24 v216, v224, v241
    v_mul_u32_u24 v217, v224, v242
    v_mul_u32_u24 v218, v225, v241
    v_mul_u32_u24 v219, v225, v242
    v_mul_u32_u24 v220, v226, v241
    v_mul_u32_u24 v221, v226, v242
    v_mul_u32_u24 v222, v227, v241
    v_mul_u32_u24 v223, v227, v242
    v_add_u32 v238, 128, v238
    ds_read_b128 v[164:167], v239
    v_mfma_f32_4x4x4_16b_bf16 v[132:135], v[216:217], v[68:69], v[4:7]
    ds_read_b128 v[168:171], v239 offset:64
    ds_read_b128 v[172:175], v239 offset:128
    v_mfma_f32_4x4x4_16b_bf16 v[136:139], v[218:219], v[70:71], v[8:11]
    ds_read_b128 v[176:179], v239 offset:192
    ds_read_u16 v224, v238
    v_mfma_f32_4x4x4_16b_bf16 v[140:143], v[220:221], v[72:73], v[12:15]
    ds_read_u16 v225, v238 offset:8
    ds_read_u16 v226, v238 offset:64
    v_mfma_f32_4x4x4_16b_bf16 v[144:147], v[222:223], v[74:75], v[16:19]
    ds_read_u16 v227, v238 offset:72
    v_add_u32 v239, 272, v239
    v_mfma_f32_4x4x4_16b_bf16 v[246:249], v[216:217], v[76:77], v[20:23]
    v_cvt_pk_bf16_f32 v100, v132, v133
    v_cvt_pk_bf16_f32 v101, v134, v135
    v_mfma_f32_4x4x4_16b_bf16 v[250:253], v[218:219], v[78:79], v[24:27]
    v_cvt_pk_bf16_f32 v102, v136, v137
    v_cvt_pk_bf16_f32 v103, v138, v139
    v_mfma_f32_4x4x4_16b_bf16 v[132:135], v[220:221], v[80:81], v[28:31]
    v_cvt_pk_bf16_f32 v104, v140, v141
    v_cvt_pk_bf16_f32 v105, v142, v143
    v_mfma_f32_4x4x4_16b_bf16 v[136:139], v[222:223], v[82:83], v[32:35]
    v_cvt_pk_bf16_f32 v106, v144, v145
    v_cvt_pk_bf16_f32 v107, v146, v147
    v_mfma_f32_4x4x4_16b_bf16 v[140:143], v[216:217], v[84:85], v[36:39]
    v_cvt_pk_bf16_f32 v108, v246, v247
    v_cvt_pk_bf16_f32 v109, v248, v249
    v_mfma_f32_4x4x4_16b_bf16 v[144:147], v[218:219], v[86:87], v[40:43]
    v_cvt_pk_bf16_f32 v110, v250, v251
    v_cvt_pk_bf16_f32 v111, v252, v253
    v_mfma_f32_4x4x4_16b_bf16 v[246:249], v[220:221], v[88:89], v[44:47]
    v_cvt_pk_bf16_f32 v112, v132, v133
    v_cvt_pk_bf16_f32 v113, v134, v135
    v_mfma_f32_4x4x4_16b_bf16 v[250:253], v[222:223], v[90:91], v[48:51]
    v_cvt_pk_bf16_f32 v114, v136, v137
    v_cvt_pk_bf16_f32 v115, v138, v139
    v_mfma_f32_4x4x4_16b_bf16 v[132:135], v[216:217], v[92:93], v[52:55]
    v_cvt_pk_bf16_f32 v116, v140, v141
    v_cvt_pk_bf16_f32 v117, v142, v143
    v_mfma_f32_4x4x4_16b_bf16 v[136:139], v[218:219], v[94:95], v[56:59]
    v_cvt_pk_bf16_f32 v118, v144, v145
    v_cvt_pk_bf16_f32 v119, v146, v147
    v_mfma_f32_4x4x4_16b_bf16 v[140:143], v[220:221], v[96:97], v[60:63]
    v_cvt_pk_bf16_f32 v120, v246, v247
    v_cvt_pk_bf16_f32 v121, v248, v249
    v_mfma_f32_4x4x4_16b_bf16 v[144:147], v[222:223], v[98:99], v[64:67]
    v_cvt_pk_bf16_f32 v122, v250, v251
    v_cvt_pk_bf16_f32 v123, v252, v253
    v_cvt_pk_bf16_f32 v124, v132, v133
    v_cvt_pk_bf16_f32 v125, v134, v135
    v_cvt_pk_bf16_f32 v126, v136, v137
    v_cvt_pk_bf16_f32 v127, v138, v139
    v_cvt_pk_bf16_f32 v128, v140, v141
    v_cvt_pk_bf16_f32 v129, v142, v143
    v_cvt_pk_bf16_f32 v130, v144, v145
    v_cvt_pk_bf16_f32 v131, v146, v147
    s_waitcnt lgkmcnt(0)
    v_mfma_f32_16x16x32_bf16 v[148:151], v[100:103], v[180:183], v[164:167]
    v_mfma_f32_16x16x32_bf16 v[148:151], v[104:107], v[184:187], v[148:151]
    v_mfma_f32_16x16x32_bf16 v[152:155], v[108:111], v[180:183], v[168:171]
    v_mfma_f32_16x16x32_bf16 v[152:155], v[112:115], v[184:187], v[152:155]
    v_mfma_f32_16x16x32_bf16 v[156:159], v[116:119], v[180:183], v[172:175]
    v_mfma_f32_16x16x32_bf16 v[156:159], v[120:123], v[184:187], v[156:159]
    v_mfma_f32_16x16x32_bf16 v[160:163], v[124:127], v[180:183], v[176:179]
    v_mfma_f32_16x16x32_bf16 v[160:163], v[128:131], v[184:187], v[160:163]
    s_waitcnt vmcnt(4)
    ds_read_b128 v[180:183], v234 offset:2080
    ds_read_b128 v[184:187], v235 offset:2080
    ds_read_u8 v230, v237 offset:64
    ds_read_u8 v232, v237 offset:72
    s_lshr_b64 s[86:87], s[56:57], 2
    s_lshr_b64 s[36:37], s[56:57], 5
    s_or_b32 s36, s36, s86
    s_or_b32 s36, s36, s56
    s_cmp_lg_u64 s[84:85], 0
    s_cbranch_scc0 Lf_mid
    s_mul_i32 s66, s53, 800
    s_add_u32 s8, s8, s66
    s_addc_u32 s9, s9, 0
    s_mov_b32 s24, s8
    s_and_b32 s25, s9, 0xffff
    s_mov_b32 s26, 400
    s_mov_b32 s27, 0x20000
    s_movk_i32 s32, 400
    s_branch Ls_mid
L_fp:
    v_mfma_i32_16x16x64_i8 v[172:175], v[122:125], v[100:103], 0
    v_and_b32 v160, 0x800080, v100
    v_mul_u32_u24 v160, 0x7f, v160
    v_bitop3_b32 v131, v100, v160, v131 bitop3:0xbe
    v_and_b32 v161, 0x800080, v101
    v_mul_u32_u24 v161, 0x7f, v161
    v_bitop3_b32 v131, v101, v161, v131 bitop3:0xbe
    v_and_b32 v160, 0x800080, v102
    v_mul_u32_u24 v160, 0x7f, v160
    v_mov_b32_dpp v184, v172 row_shr:1 row_mask:0xf bank_mask:0xf bound_ctrl:0
    v_bitop3_b32 v131, v102, v160, v131 bitop3:0xbe
    s_nop 0
    v_add_u32_dpp v184, v184, v184 row_shr:1 row_mask:0xf bank_mask:0xf bound_ctrl:0
    v_and_b32 v161, 0x800080, v103
    s_nop 0
    v_add_u32_dpp v184, v184, v184 row_shr:2 row_mask:0xf bank_mask:0xf bound_ctrl:0
    v_mul_u32_u24 v161, 0x7f, v161
    s_nop 0
    v_add_u32_dpp v184, v184, v184 row_shr:4 row_mask:0xf bank_mask:0xf bound_ctrl:0
    v_bitop3_b32 v131, v103, v161, v131 bitop3:0xbe
    s_nop 0
    v_add_u32_dpp v184, v184, v184 row_shr:8 row_mask:0xf bank_mask:0xf bound_ctrl:0
    v_cmp_ne_u32 vcc, 0, v131
    v_readlane_b32 s68, v184, 6
    v_readlane_b32 s69, v173, 6
    v_readlane_b32 s70, v184, 15
    s_mov_b32 s94, 0
    s_cbranch_vccnz L_late
    s_add_u32 s66, s68, s69
    s_add_u32 s66, s66, s64
    s_add_u32 s67, s66, 15
    s_and_b32 s67, s67, -16
    s_add_u32 s55, s64, 16
    s_max_u32 s67, s67, s55
    s_sub_u32 s66, s67, s66
    v_mad_u32_u24 v184, v130, s66, v184
    s_sub_u32 s55, s64, 2048
    v_add_u32 v172, s55, v184
    v_add_u32 v173, s55, v184
    v_add_u32 v174, s55, v184
    v_add_u32 v175, s55, v184
    s_add_u32 s64, s64, s70
    s_add_u32 s64, s64, s66
    v_mfma_i32_16x16x64_i8 v[132:135], v[118:121], v[100:103], v[172:175]
    v_mfma_i32_16x16x64_i8 v[136:139], v[116:119], v[100:103], v[172:175]
    s_add_u32 s64, s64, 15
    s_and_b32 s64, s64, -16
    s_add_u32 s55, s67, 16
    s_max_u32 s64, s64, s55
    s_lshr_b32 s95, s67, 4
    s_bitset1_b64 s[56:57], s95
    s_lshr_b32 s95, s64, 4
    s_bitset1_b64 s[56:57], s95
    s_add_u32 s66, s52, 18512
    s_cmp_ge_u32 s64, s66
    ds_write_b8 v132, v126
    ds_write_b8_d16_hi v133, v126
    ds_write_b8 v134, v127
    ds_write_b8_d16_hi v135, v127
    ds_write_b8 v136, v128
    ds_write_b8_d16_hi v137, v128
    ds_write_b8 v138, v129
    ds_write_b8_d16_hi v139, v129
    s_cbranch_scc0 L_late
    s_mov_b32 s94, 1
    ds_read_u8 v148, v237 offset:0
    ds_read_u8 v149, v237 offset:8
    ds_read_u8 v150, v237 offset:16
    ds_read_u8 v151, v237 offset:24
    ds_read_u8 v152, v237 offset:32
    ds_read_u8 v153, v237 offset:40
    ds_read_u8 v154, v237 offset:48
    ds_read_u8 v155, v237 offset:56
    s_waitcnt lgkmcnt(0)
    s_add_u32 m0, s52, 0
    v_mov_b32 v230, v148
    v_mov_b32 v232, v149
    buffer_load_dwordx4 v[230:231], s[20:23], s35 idxen offen nt lds
    buffer_load_dwordx4 v[232:233], s[40:43], s35 idxen offen offset:1056 nt lds
    s_bitcmp0_b64 s[56:57], 2
    s_cbranch_scc1 L_noadve1
    s_add_u32 s35, s35, s31
    s_xor_b32 s31, s31, 0x63ff800
L_noadve1:
    s_add_u32 m0, s52, 2080
    v_mov_b32 v230, v150
    v_mov_b32 v232, v151
    buffer_load_dwordx4 v[230:231], s[20:23], s35 idxen offen nt lds
    buffer_load_dwordx4 v[232:233], s[40:43], s35 idxen offen offset:1056 nt lds
    s_setpc_b64 s[62:63]
L_late:
    s_waitcnt vmcnt(0)
    s_setpc_b64 s[62:63]
L_t23:
    s_cmp_eq_u32 s94, 0
    s_cbranch_scc1 L_skip2
    s_bitcmp0_b64 s[56:57], 3
    s_cbranch_scc1 L_noadve2
    s_add_u32 s35, s35, s31
    s_xor_b32 s31, s31, 0x63ff800
L_noadve2:
    s_add_u32 m0, s52, 4160
    v_mov_b32 v230, v152
    v_mov_b32 v232, v153
    buffer_load_dwordx4 v[230:231], s[20:23], s35 idxen offen nt lds
    buffer_load_dwordx4 v[232:233], s[40:43], s35 idxen offen offset:1056 nt lds
    s_bitcmp0_b64 s[56:57], 4
    s_cbranch_scc1 L_noadve3
    s_add_u32 s35, s35, s31
    s_xor_b32 s31, s31, 0x63ff800
L_noadve3:
    s_add_u32 m0, s52, 6240
    v_mov_b32 v230, v154
    v_mov_b32 v232, v155
    buffer_load_dwordx4 v[230:231], s[20:23], s35 idxen offen nt lds
    buffer_load_dwordx4 v[232:233], s[40:43], s35 idxen offen offset:1056 nt lds
L_skip2:
    s_setpc_b64 s[62:63]
Lf_loop:
    ds_read_u8 v230, v237 offset:64
    ds_read_u8 v232, v237 offset:72
    v_mfma_f32_16x16x32_bf16 v[208:211], v[136:139], v[200:203], v[208:211]
Lf_mid:
    s_bitcmp1_b32 s36, 0
    s_cbranch_scc1 Lf_ev0
Lf_evd0:
    ds_add_rtn_u32 v1, v2, v3
    v_exp_f32 v132, v148
    v_exp_f32 v133, v149
    v_exp_f32 v134, v150
    v_exp_f32 v135, v151
    v_exp_f32 v136, v152
    v_exp_f32 v137, v153
    v_mfma_f32_4x4x4_16b_bf16 v[132:135], v[228:229], v[228:229], v[132:135]
    v_cvt_pk_bf16_f32 v208, v208, v209
    v_cvt_pk_bf16_f32 v209, v210, v211
    s_waitcnt lgkmcnt(2)
    v_mfma_f32_16x16x32_bf16 v[148:151], v[100:103], v[180:183], v[164:167]
    v_exp_f32 v138, v154
    v_mfma_f32_4x4x4_16b_bf16 v[212:215], v[208:209], v[188:189], v[212:215] cbsz:4 abid:0
    ds_read_b64_tr_b16 v[188:189], v236 offset:0
    v_exp_f32 v139, v155
    v_mfma_f32_16x16x32_bf16 v[152:155], v[108:111], v[180:183], v[168:171]
    v_exp_f32 v140, v156
    v_mfma_f32_4x4x4_16b_bf16 v[212:215], v[208:209], v[190:191], v[212:215] cbsz:4 abid:4
    ds_read_b64_tr_b16 v[190:191], v236 offset:512
    v_mfma_f32_4x4x4_16b_bf16 v[136:139], v[228:229], v[228:229], v[136:139]
    v_rcp_f32 v132, v132
    v_mfma_f32_4x4x4_16b_bf16 v[212:215], v[208:209], v[192:193], v[212:215] cbsz:4 abid:8
    ds_read_b64_tr_b16 v[192:193], v236 offset:1056
    v_exp_f32 v141, v157
    v_mfma_f32_16x16x32_bf16 v[148:151], v[104:107], v[184:187], v[148:151]
    v_rcp_f32 v133, v133
    v_mfma_f32_4x4x4_16b_bf16 v[212:215], v[208:209], v[194:195], v[212:215] cbsz:4 abid:12
    ds_read_b64_tr_b16 v[194:195], v236 offset:1568
    v_exp_f32 v142, v158
    v_mfma_f32_16x16x32_bf16 v[152:155], v[112:115], v[184:187], v[152:155]
    v_rcp_f32 v134, v134
    v_exp_f32 v143, v159
    v_rcp_f32 v135, v135
    v_cvt_pk_bf16_f32 v132, v132, v133
    v_mfma_f32_4x4x4_16b_bf16 v[140:143], v[228:229], v[228:229], v[140:143]
    v_exp_f32 v144, v160
    v_mfma_f32_16x16x32_bf16 v[156:159], v[116:119], v[180:183], v[172:175]
    v_rcp_f32 v136, v136
    v_cvt_pk_bf16_f32 v133, v134, v135
    s_add_u32 m0, s52, 0
    s_waitcnt lgkmcnt(0)
    buffer_load_dwordx4 v[230:231], s[20:23], s35 idxen offen nt lds
    v_exp_f32 v145, v161
    buffer_load_dwordx4 v[232:233], s[40:43], s35 idxen offen offset:1056 nt lds
    v_rcp_f32 v137, v137
    v_exp_f32 v146, v162
    v_rcp_f32 v138, v138
    v_cvt_pk_bf16_f32 v134, v136, v137
    v_exp_f32 v147, v163
    v_mfma_f32_16x16x32_bf16 v[160:163], v[124:127], v[180:183], v[176:179]
    v_readfirstlane_b32 s66, v1
    s_setprio 0
    s_cmp_gt_i32 s66, 0
    s_cbranch_scc0 Lf_lo0
    s_setprio 1
Lf_lo0:
    v_rcp_f32 v139, v139
    v_mfma_f32_4x4x4_16b_bf16 v[144:147], v[228:229], v[228:229], v[144:147]
    v_mfma_f32_16x16x32_bf16 v[156:159], v[120:123], v[184:187], v[156:159]
    v_rcp_f32 v140, v140
    v_mfma_f32_16x16x32_bf16 v[160:163], v[128:131], v[184:187], v[160:163]
    v_rcp_f32 v141, v141
    v_cvt_pk_bf16_f32 v135, v138, v139
    s_waitcnt vmcnt(4)
    ds_read_b128 v[180:183], v234 offset:4160
    ds_read_b128 v[184:187], v235 offset:4160
    v_rcp_f32 v142, v142
    v_cvt_pk_bf16_f32 v136, v140, v141
    v_mfma_f32_16x16x32_bf16 v[208:211], v[132:135], v[196:199], v[204:207]
    v_rcp_f32 v143, v143
    v_rcp_f32 v144, v144
    v_cvt_pk_bf16_f32 v137, v142, v143
    v_rcp_f32 v145, v145
    v_rcp_f32 v146, v146
    v_rcp_f32 v147, v147
    v_cvt_pk_bf16_f32 v138, v144, v145
    v_cvt_pk_bf16_f32 v139, v146, v147
    ds_read_u8 v230, v237 offset:80
    ds_read_u8 v232, v237 offset:88
    v_mfma_f32_16x16x32_bf16 v[208:211], v[136:139], v[200:203], v[208:211]
    s_bitcmp1_b32 s36, 1
    s_cbranch_scc1 Lf_ev1
Lf_evd1:
    v_exp_f32 v132, v148
    v_exp_f32 v133, v149
    v_exp_f32 v134, v150
    v_exp_f32 v135, v151
    v_exp_f32 v136, v152
    v_exp_f32 v137, v153
    v_mfma_f32_4x4x4_16b_bf16 v[132:135], v[228:229], v[228:229], v[132:135]
    v_cvt_pk_bf16_f32 v208, v208, v209
    v_cvt_pk_bf16_f32 v209, v210, v211
    s_waitcnt lgkmcnt(2)
    v_mfma_f32_16x16x32_bf16 v[148:151], v[100:103], v[180:183], v[164:167]
    v_exp_f32 v138, v154
    v_mfma_f32_4x4x4_16b_bf16 v[212:215], v[208:209], v[188:189], v[212:215] cbsz:4 abid:0
    ds_read_b64_tr_b16 v[188:189], v236 offset:2080
    v_exp_f32 v139, v155
    v_mfma_f32_16x16x32_bf16 v[152:155], v[108:111], v[180:183], v[168:171]
    v_exp_f32 v140, v156
    v_mfma_f32_4x4x4_16b_bf16 v[212:215], v[208:209], v[190:191], v[212:215] cbsz:4 abid:4
    ds_read_b64_tr_b16 v[190:191], v236 offset:2592
    v_mfma_f32_4x4x4_16b_bf16 v[136:139], v[228:229], v[228:229], v[136:139]
    v_rcp_f32 v132, v132
    v_mfma_f32_4x4x4_16b_bf16 v[212:215], v[208:209], v[192:193], v[212:215] cbsz:4 abid:8
    ds_read_b64_tr_b16 v[192:193], v236 offset:3136
    v_exp_f32 v141, v157
    v_mfma_f32_16x16x32_bf16 v[148:151], v[104:107], v[184:187], v[148:151]
    v_rcp_f32 v133, v133
    v_mfma_f32_4x4x4_16b_bf16 v[212:215], v[208:209], v[194:195], v[212:215] cbsz:4 abid:12
    ds_read_b64_tr_b16 v[194:195], v236 offset:3648
    v_exp_f32 v142, v158
    v_mfma_f32_16x16x32_bf16 v[152:155], v[112:115], v[184:187], v[152:155]
    v_rcp_f32 v134, v134
    v_exp_f32 v143, v159
    v_rcp_f32 v135, v135
    v_cvt_pk_bf16_f32 v132, v132, v133
    v_mfma_f32_4x4x4_16b_bf16 v[140:143], v[228:229], v[228:229], v[140:143]
    v_exp_f32 v144, v160
    v_mfma_f32_16x16x32_bf16 v[156:159], v[116:119], v[180:183], v[172:175]
    v_rcp_f32 v136, v136
    v_cvt_pk_bf16_f32 v133, v134, v135
    s_add_u32 m0, s52, 2080
    s_waitcnt lgkmcnt(0)
    buffer_load_dwordx4 v[230:231], s[20:23], s35 idxen offen nt lds
    v_exp_f32 v145, v161
    buffer_load_dwordx4 v[232:233], s[40:43], s35 idxen offen offset:1056 nt lds
    v_rcp_f32 v137, v137
    v_exp_f32 v146, v162
    v_rcp_f32 v138, v138
    v_cvt_pk_bf16_f32 v134, v136, v137
    v_exp_f32 v147, v163
    v_mfma_f32_16x16x32_bf16 v[160:163], v[124:127], v[180:183], v[176:179]
    v_rcp_f32 v139, v139
    v_mfma_f32_4x4x4_16b_bf16 v[144:147], v[228:229], v[228:229], v[144:147]
    v_mfma_f32_16x16x32_bf16 v[156:159], v[120:123], v[184:187], v[156:159]
    v_rcp_f32 v140, v140
    v_mfma_f32_16x16x32_bf16 v[160:163], v[128:131], v[184:187], v[160:163]
    v_rcp_f32 v141, v141
    v_cvt_pk_bf16_f32 v135, v138, v139
    s_waitcnt vmcnt(4)
    ds_read_b128 v[180:183], v234 offset:6240
    ds_read_b128 v[184:187], v235 offset:6240
    v_rcp_f32 v142, v142
    v_cvt_pk_bf16_f32 v136, v140, v141
    v_mfma_f32_16x16x32_bf16 v[208:211], v[132:135], v[196:199], v[204:207]
    v_rcp_f32 v143, v143
    v_rcp_f32 v144, v144
    v_cvt_pk_bf16_f32 v137, v142, v143
    v_rcp_f32 v145, v145
    v_rcp_f32 v146, v146
    v_rcp_f32 v147, v147
    v_cvt_pk_bf16_f32 v138, v144, v145
    v_cvt_pk_bf16_f32 v139, v146, v147
    ds_read_u8 v230, v237 offset:96
    ds_read_u8 v232, v237 offset:104
    v_mfma_f32_16x16x32_bf16 v[208:211], v[136:139], v[200:203], v[208:211]
    s_bitcmp1_b32 s36, 2
    s_cbranch_scc1 Lf_ev2
Lf_evd2:
    v_exp_f32 v132, v148
    v_exp_f32 v133, v149
    v_exp_f32 v134, v150
    v_exp_f32 v135, v151
    v_exp_f32 v136, v152
    v_exp_f32 v137, v153
    v_mfma_f32_4x4x4_16b_bf16 v[132:135], v[228:229], v[228:229], v[132:135]
    v_cvt_pk_bf16_f32 v208, v208, v209
    v_cvt_pk_bf16_f32 v209, v210, v211
    s_waitcnt lgkmcnt(2)
    v_mfma_f32_16x16x32_bf16 v[148:151], v[100:103], v[180:183], v[164:167]
    v_exp_f32 v138, v154
    v_mfma_f32_4x4x4_16b_bf16 v[212:215], v[208:209], v[188:189], v[212:215] cbsz:4 abid:0
    ds_read_b64_tr_b16 v[188:189], v236 offset:4160
    v_exp_f32 v139, v155
    v_mfma_f32_16x16x32_bf16 v[152:155], v[108:111], v[180:183], v[168:171]
    v_exp_f32 v140, v156
    v_mfma_f32_4x4x4_16b_bf16 v[212:215], v[208:209], v[190:191], v[212:215] cbsz:4 abid:4
    ds_read_b64_tr_b16 v[190:191], v236 offset:4672
    v_mfma_f32_4x4x4_16b_bf16 v[136:139], v[228:229], v[228:229], v[136:139]
    v_rcp_f32 v132, v132
    v_mfma_f32_4x4x4_16b_bf16 v[212:215], v[208:209], v[192:193], v[212:215] cbsz:4 abid:8
    ds_read_b64_tr_b16 v[192:193], v236 offset:5216
    v_exp_f32 v141, v157
    v_mfma_f32_16x16x32_bf16 v[148:151], v[104:107], v[184:187], v[148:151]
    v_rcp_f32 v133, v133
    v_mfma_f32_4x4x4_16b_bf16 v[212:215], v[208:209], v[194:195], v[212:215] cbsz:4 abid:12
    ds_read_b64_tr_b16 v[194:195], v236 offset:5728
    v_exp_f32 v142, v158
    v_mfma_f32_16x16x32_bf16 v[152:155], v[112:115], v[184:187], v[152:155]
    v_rcp_f32 v134, v134
    v_exp_f32 v143, v159
    v_rcp_f32 v135, v135
    v_cvt_pk_bf16_f32 v132, v132, v133
    v_mfma_f32_4x4x4_16b_bf16 v[140:143], v[228:229], v[228:229], v[140:143]
    v_exp_f32 v144, v160
    v_mfma_f32_16x16x32_bf16 v[156:159], v[116:119], v[180:183], v[172:175]
    v_rcp_f32 v136, v136
    v_cvt_pk_bf16_f32 v133, v134, v135
    s_add_u32 m0, s52, 4160
    s_waitcnt lgkmcnt(0)
    buffer_load_dwordx4 v[230:231], s[20:23], s35 idxen offen nt lds
    v_exp_f32 v145, v161
    buffer_load_dwordx4 v[232:233], s[40:43], s35 idxen offen offset:1056 nt lds
    v_rcp_f32 v137, v137
    v_exp_f32 v146, v162
    v_rcp_f32 v138, v138
    v_cvt_pk_bf16_f32 v134, v136, v137
    v_exp_f32 v147, v163
    v_mfma_f32_16x16x32_bf16 v[160:163], v[124:127], v[180:183], v[176:179]
    v_rcp_f32 v139, v139
    v_mfma_f32_4x4x4_16b_bf16 v[144:147], v[228:229], v[228:229], v[144:147]
    v_mfma_f32_16x16x32_bf16 v[156:159], v[120:123], v[184:187], v[156:159]
    v_rcp_f32 v140, v140
    v_mfma_f32_16x16x32_bf16 v[160:163], v[128:131], v[184:187], v[160:163]
    v_rcp_f32 v141, v141
    v_cvt_pk_bf16_f32 v135, v138, v139
    s_waitcnt vmcnt(4)
    ds_read_b128 v[180:183], v234 offset:0
    ds_read_b128 v[184:187], v235 offset:0
    v_rcp_f32 v142, v142
    v_cvt_pk_bf16_f32 v136, v140, v141
    v_mfma_f32_16x16x32_bf16 v[208:211], v[132:135], v[196:199], v[204:207]
    v_rcp_f32 v143, v143
    v_rcp_f32 v144, v144
    v_cvt_pk_bf16_f32 v137, v142, v143
    v_rcp_f32 v145, v145
    v_rcp_f32 v146, v146
    v_rcp_f32 v147, v147
    v_cvt_pk_bf16_f32 v138, v144, v145
    v_cvt_pk_bf16_f32 v139, v146, v147
    ds_read_u8 v230, v237 offset:112
    ds_read_u8 v232, v237 offset:120
    v_mfma_f32_16x16x32_bf16 v[208:211], v[136:139], v[200:203], v[208:211]
    s_bitcmp1_b32 s36, 3
    s_cbranch_scc1 Lf_ev3
Lf_evd3:
    v_exp_f32 v132, v148
    v_exp_f32 v133, v149
    v_exp_f32 v134, v150
    v_exp_f32 v135, v151
    v_exp_f32 v136, v152
    v_exp_f32 v137, v153
    v_mfma_f32_4x4x4_16b_bf16 v[132:135], v[228:229], v[228:229], v[132:135]
    v_cvt_pk_bf16_f32 v208, v208, v209
    v_cvt_pk_bf16_f32 v209, v210, v211
    s_waitcnt lgkmcnt(2)
    v_mfma_f32_16x16x32_bf16 v[148:151], v[100:103], v[180:183], v[164:167]
    v_exp_f32 v138, v154
    v_mfma_f32_4x4x4_16b_bf16 v[212:215], v[208:209], v[188:189], v[212:215] cbsz:4 abid:0
    ds_read_b64_tr_b16 v[188:189], v236 offset:6240
    v_exp_f32 v139, v155
    v_mfma_f32_16x16x32_bf16 v[152:155], v[108:111], v[180:183], v[168:171]
    v_exp_f32 v140, v156
    v_mfma_f32_4x4x4_16b_bf16 v[212:215], v[208:209], v[190:191], v[212:215] cbsz:4 abid:4
    ds_read_b64_tr_b16 v[190:191], v236 offset:6752
    v_mfma_f32_4x4x4_16b_bf16 v[136:139], v[228:229], v[228:229], v[136:139]
    v_rcp_f32 v132, v132
    v_mfma_f32_4x4x4_16b_bf16 v[212:215], v[208:209], v[192:193], v[212:215] cbsz:4 abid:8
    ds_read_b64_tr_b16 v[192:193], v236 offset:7296
    v_exp_f32 v141, v157
    v_mfma_f32_16x16x32_bf16 v[148:151], v[104:107], v[184:187], v[148:151]
    v_rcp_f32 v133, v133
    v_mfma_f32_4x4x4_16b_bf16 v[212:215], v[208:209], v[194:195], v[212:215] cbsz:4 abid:12
    ds_read_b64_tr_b16 v[194:195], v236 offset:7808
    v_exp_f32 v142, v158
    v_mfma_f32_16x16x32_bf16 v[152:155], v[112:115], v[184:187], v[152:155]
    v_rcp_f32 v134, v134
    v_exp_f32 v143, v159
    v_rcp_f32 v135, v135
    v_cvt_pk_bf16_f32 v132, v132, v133
    v_mfma_f32_4x4x4_16b_bf16 v[140:143], v[228:229], v[228:229], v[140:143]
    v_exp_f32 v144, v160
    v_mfma_f32_16x16x32_bf16 v[156:159], v[116:119], v[180:183], v[172:175]
    v_rcp_f32 v136, v136
    v_cvt_pk_bf16_f32 v133, v134, v135
    s_add_u32 m0, s52, 6240
    s_waitcnt lgkmcnt(0)
    buffer_load_dwordx4 v[230:231], s[20:23], s35 idxen offen nt lds
    v_exp_f32 v145, v161
    buffer_load_dwordx4 v[232:233], s[40:43], s35 idxen offen offset:1056 nt lds
    v_rcp_f32 v137, v137
    v_exp_f32 v146, v162
    v_rcp_f32 v138, v138
    v_cvt_pk_bf16_f32 v134, v136, v137
    v_exp_f32 v147, v163
    v_mfma_f32_16x16x32_bf16 v[160:163], v[124:127], v[180:183], v[176:179]
    v_rcp_f32 v139, v139
    v_mfma_f32_4x4x4_16b_bf16 v[144:147], v[228:229], v[228:229], v[144:147]
    v_mfma_f32_16x16x32_bf16 v[156:159], v[120:123], v[184:187], v[156:159]
    v_rcp_f32 v140, v140
    v_mfma_f32_16x16x32_bf16 v[160:163], v[128:131], v[184:187], v[160:163]
    v_rcp_f32 v141, v141
    v_cvt_pk_bf16_f32 v135, v138, v139
    s_waitcnt vmcnt(4)
    ds_read_b128 v[180:183], v234 offset:2080
    ds_read_b128 v[184:187], v235 offset:2080
    v_rcp_f32 v142, v142
    v_cvt_pk_bf16_f32 v136, v140, v141
    v_mfma_f32_16x16x32_bf16 v[208:211], v[132:135], v[196:199], v[204:207]
    v_rcp_f32 v143, v143
    s_lshr_b64 s[56:57], s[56:57], 4
    s_lshl_b64 s[86:87], s[58:59], 60
    s_or_b64 s[56:57], s[56:57], s[86:87]
    s_lshr_b64 s[58:59], s[58:59], 4
    s_lshr_b64 s[86:87], s[56:57], 2
    s_lshr_b64 s[36:37], s[56:57], 5
    s_or_b32 s36, s36, s86
    s_or_b32 s36, s36, s56
    v_add_u32 v237, 64, v237
    v_rcp_f32 v144, v144
    v_cvt_pk_bf16_f32 v137, v142, v143
    v_rcp_f32 v145, v145
    v_rcp_f32 v146, v146
    v_rcp_f32 v147, v147
    v_cvt_pk_bf16_f32 v138, v144, v145
    v_cvt_pk_bf16_f32 v139, v146, v147
    s_branch Lf_loop
Lf_ev0:
    s_bitcmp0_b64 s[56:57], 0
    s_cbranch_scc1 Lf_nf0
    v_cvt_pk_bf16_f32 v246, v212, v212
    v_mov_b32 v212, 0
    ds_write_b16 v240, v246
    v_add_u32 v240, 128, v240
Lf_nf0:
    s_bitcmp0_b64 s[56:57], 5
    s_cbranch_scc1 Lf_na0
    s_add_u32 s35, s35, s31
    s_xor_b32 s31, s31, 0x63ff800
Lf_na0:
    s_bitcmp0_b64 s[56:57], 2
    s_cbranch_scc1 Lf_evd0
Lf_e10:
    s_sub_u32 s61, s61, 1
    s_cbranch_scc1 Lf_last0
    v_mul_u32_u24 v216, v224, v241
    v_mul_u32_u24 v217, v224, v242
    v_mul_u32_u24 v218, v225, v241
    v_mul_u32_u24 v219, v225, v242
    v_mul_u32_u24 v220, v226, v241
    v_mul_u32_u24 v221, v226, v242
    v_mul_u32_u24 v222, v227, v241
    v_mul_u32_u24 v223, v227, v242
    v_add_u32 v238, 128, v238
    ds_read_b128 v[164:167], v239
    v_mfma_f32_4x4x4_16b_bf16 v[132:135], v[216:217], v[68:69], v[4:7]
    ds_read_b128 v[168:171], v239 offset:64
    ds_read_b128 v[172:175], v239 offset:128
    v_mfma_f32_4x4x4_16b_bf16 v[136:139], v[218:219], v[70:71], v[8:11]
    ds_read_b128 v[176:179], v239 offset:192
    ds_read_u16 v224, v238
    v_mfma_f32_4x4x4_16b_bf16 v[140:143], v[220:221], v[72:73], v[12:15]
    ds_read_u16 v225, v238 offset:8
    ds_read_u16 v226, v238 offset:64
    v_mfma_f32_4x4x4_16b_bf16 v[144:147], v[222:223], v[74:75], v[16:19]
    ds_read_u16 v227, v238 offset:72
    v_add_u32 v239, 272, v239
    v_mfma_f32_4x4x4_16b_bf16 v[246:249], v[216:217], v[76:77], v[20:23]
    v_cvt_pk_bf16_f32 v100, v132, v133
    v_cvt_pk_bf16_f32 v101, v134, v135
    v_mfma_f32_4x4x4_16b_bf16 v[250:253], v[218:219], v[78:79], v[24:27]
    v_cvt_pk_bf16_f32 v102, v136, v137
    v_cvt_pk_bf16_f32 v103, v138, v139
    v_mfma_f32_4x4x4_16b_bf16 v[132:135], v[220:221], v[80:81], v[28:31]
    v_cvt_pk_bf16_f32 v104, v140, v141
    v_cvt_pk_bf16_f32 v105, v142, v143
    v_mfma_f32_4x4x4_16b_bf16 v[136:139], v[222:223], v[82:83], v[32:35]
    v_cvt_pk_bf16_f32 v106, v144, v145
    v_cvt_pk_bf16_f32 v107, v146, v147
    v_mfma_f32_4x4x4_16b_bf16 v[140:143], v[216:217], v[84:85], v[36:39]
    v_cvt_pk_bf16_f32 v108, v246, v247
    v_cvt_pk_bf16_f32 v109, v248, v249
    v_mfma_f32_4x4x4_16b_bf16 v[144:147], v[218:219], v[86:87], v[40:43]
    v_cvt_pk_bf16_f32 v110, v250, v251
    v_cvt_pk_bf16_f32 v111, v252, v253
    v_mfma_f32_4x4x4_16b_bf16 v[246:249], v[220:221], v[88:89], v[44:47]
    v_cvt_pk_bf16_f32 v112, v132, v133
    v_cvt_pk_bf16_f32 v113, v134, v135
    v_mfma_f32_4x4x4_16b_bf16 v[250:253], v[222:223], v[90:91], v[48:51]
    v_cvt_pk_bf16_f32 v114, v136, v137
    v_cvt_pk_bf16_f32 v115, v138, v139
    v_mfma_f32_4x4x4_16b_bf16 v[132:135], v[216:217], v[92:93], v[52:55]
    v_cvt_pk_bf16_f32 v116, v140, v141
    v_cvt_pk_bf16_f32 v117, v142, v143
    v_mfma_f32_4x4x4_16b_bf16 v[136:139], v[218:219], v[94:95], v[56:59]
    v_cvt_pk_bf16_f32 v118, v144, v145
    v_cvt_pk_bf16_f32 v119, v146, v147
    v_mfma_f32_4x4x4_16b_bf16 v[140:143], v[220:221], v[96:97], v[60:63]
    v_cvt_pk_bf16_f32 v120, v246, v247
    v_cvt_pk_bf16_f32 v121, v248, v249
    v_mfma_f32_4x4x4_16b_bf16 v[144:147], v[222:223], v[98:99], v[64:67]
    v_cvt_pk_bf16_f32 v122, v250, v251
    v_cvt_pk_bf16_f32 v123, v252, v253
    v_cvt_pk_bf16_f32 v124, v132, v133
    v_cvt_pk_bf16_f32 v125, v134, v135
    v_cvt_pk_bf16_f32 v126, v136, v137
    v_cvt_pk_bf16_f32 v127, v138, v139
    v_cvt_pk_bf16_f32 v128, v140, v141
    v_cvt_pk_bf16_f32 v129, v142, v143
    v_cvt_pk_bf16_f32 v130, v144, v145
    v_cvt_pk_bf16_f32 v131, v146, v147
    s_waitcnt lgkmcnt(0)
    s_branch Lf_evd0
Lf_ev1:
    s_bitcmp0_b64 s[56:57], 1
    s_cbranch_scc1 Lf_nf1
    v_cvt_pk_bf16_f32 v246, v212, v212
    v_mov_b32 v212, 0
    ds_write_b16 v240, v246
    v_add_u32 v240, 128, v240
Lf_nf1:
    s_bitcmp0_b64 s[56:57], 6
    s_cbranch_scc1 Lf_na1
    s_add_u32 s35, s35, s31
    s_xor_b32 s31, s31, 0x63ff800
Lf_na1:
    s_bitcmp0_b64 s[56:57], 3
    s_cbranch_scc1 Lf_evd1
Lf_e11:
    s_sub_u32 s61, s61, 1
    s_cbranch_scc1 Lf_last1
    v_mul_u32_u24 v216, v224, v241
    v_mul_u32_u24 v217, v224, v242
    v_mul_u32_u24 v218, v225, v241
    v_mul_u32_u24 v219, v225, v242
    v_mul_u32_u24 v220, v226, v241
    v_mul_u32_u24 v221, v226, v242
    v_mul_u32_u24 v222, v227, v241
    v_mul_u32_u24 v223, v227, v242
    v_add_u32 v238, 128, v238
    ds_read_b128 v[164:167], v239
    v_mfma_f32_4x4x4_16b_bf16 v[132:135], v[216:217], v[68:69], v[4:7]
    ds_read_b128 v[168:171], v239 offset:64
    ds_read_b128 v[172:175], v239 offset:128
    v_mfma_f32_4x4x4_16b_bf16 v[136:139], v[218:219], v[70:71], v[8:11]
    ds_read_b128 v[176:179], v239 offset:192
    ds_read_u16 v224, v238
    v_mfma_f32_4x4x4_16b_bf16 v[140:143], v[220:221], v[72:73], v[12:15]
    ds_read_u16 v225, v238 offset:8
    ds_read_u16 v226, v238 offset:64
    v_mfma_f32_4x4x4_16b_bf16 v[144:147], v[222:223], v[74:75], v[16:19]
    ds_read_u16 v227, v238 offset:72
    v_add_u32 v239, 272, v239
    v_mfma_f32_4x4x4_16b_bf16 v[246:249], v[216:217], v[76:77], v[20:23]
    v_cvt_pk_bf16_f32 v100, v132, v133
    v_cvt_pk_bf16_f32 v101, v134, v135
    v_mfma_f32_4x4x4_16b_bf16 v[250:253], v[218:219], v[78:79], v[24:27]
    v_cvt_pk_bf16_f32 v102, v136, v137
    v_cvt_pk_bf16_f32 v103, v138, v139
    v_mfma_f32_4x4x4_16b_bf16 v[132:135], v[220:221], v[80:81], v[28:31]
    v_cvt_pk_bf16_f32 v104, v140, v141
    v_cvt_pk_bf16_f32 v105, v142, v143
    v_mfma_f32_4x4x4_16b_bf16 v[136:139], v[222:223], v[82:83], v[32:35]
    v_cvt_pk_bf16_f32 v106, v144, v145
    v_cvt_pk_bf16_f32 v107, v146, v147
    v_mfma_f32_4x4x4_16b_bf16 v[140:143], v[216:217], v[84:85], v[36:39]
    v_cvt_pk_bf16_f32 v108, v246, v247
    v_cvt_pk_bf16_f32 v109, v248, v249
    v_mfma_f32_4x4x4_16b_bf16 v[144:147], v[218:219], v[86:87], v[40:43]
    v_cvt_pk_bf16_f32 v110, v250, v251
    v_cvt_pk_bf16_f32 v111, v252, v253
    v_mfma_f32_4x4x4_16b_bf16 v[246:249], v[220:221], v[88:89], v[44:47]
    v_cvt_pk_bf16_f32 v112, v132, v133
    v_cvt_pk_bf16_f32 v113, v134, v135
    v_mfma_f32_4x4x4_16b_bf16 v[250:253], v[222:223], v[90:91], v[48:51]
    v_cvt_pk_bf16_f32 v114, v136, v137
    v_cvt_pk_bf16_f32 v115, v138, v139
    v_mfma_f32_4x4x4_16b_bf16 v[132:135], v[216:217], v[92:93], v[52:55]
    v_cvt_pk_bf16_f32 v116, v140, v141
    v_cvt_pk_bf16_f32 v117, v142, v143
    v_mfma_f32_4x4x4_16b_bf16 v[136:139], v[218:219], v[94:95], v[56:59]
    v_cvt_pk_bf16_f32 v118, v144, v145
    v_cvt_pk_bf16_f32 v119, v146, v147
    v_mfma_f32_4x4x4_16b_bf16 v[140:143], v[220:221], v[96:97], v[60:63]
    v_cvt_pk_bf16_f32 v120, v246, v247
    v_cvt_pk_bf16_f32 v121, v248, v249
    v_mfma_f32_4x4x4_16b_bf16 v[144:147], v[222:223], v[98:99], v[64:67]
    v_cvt_pk_bf16_f32 v122, v250, v251
    v_cvt_pk_bf16_f32 v123, v252, v253
    v_cvt_pk_bf16_f32 v124, v132, v133
    v_cvt_pk_bf16_f32 v125, v134, v135
    v_cvt_pk_bf16_f32 v126, v136, v137
    v_cvt_pk_bf16_f32 v127, v138, v139
    v_cvt_pk_bf16_f32 v128, v140, v141
    v_cvt_pk_bf16_f32 v129, v142, v143
    v_cvt_pk_bf16_f32 v130, v144, v145
    v_cvt_pk_bf16_f32 v131, v146, v147
    s_waitcnt lgkmcnt(0)
    s_branch Lf_evd1
Lf_ev2:
    s_bitcmp0_b64 s[56:57], 2
    s_cbranch_scc1 Lf_nf2
    v_cvt_pk_bf16_f32 v246, v212, v212
    v_mov_b32 v212, 0
    ds_write_b16 v240, v246
    v_add_u32 v240, 128, v240
Lf_nf2:
    s_bitcmp0_b64 s[56:57], 7
    s_cbranch_scc1 Lf_na2
    s_add_u32 s35, s35, s31
    s_xor_b32 s31, s31, 0x63ff800
Lf_na2:
    s_bitcmp0_b64 s[56:57], 4
    s_cbranch_scc1 Lf_evd2
Lf_e12:
    s_sub_u32 s61, s61, 1
    s_cbranch_scc1 Lf_last2
    v_mul_u32_u24 v216, v224, v241
    v_mul_u32_u24 v217, v224, v242
    v_mul_u32_u24 v218, v225, v241
    v_mul_u32_u24 v219, v225, v242
    v_mul_u32_u24 v220, v226, v241
    v_mul_u32_u24 v221, v226, v242
    v_mul_u32_u24 v222, v227, v241
    v_mul_u32_u24 v223, v227, v242
    v_add_u32 v238, 128, v238
    ds_read_b128 v[164:167], v239
    v_mfma_f32_4x4x4_16b_bf16 v[132:135], v[216:217], v[68:69], v[4:7]
    ds_read_b128 v[168:171], v239 offset:64
    ds_read_b128 v[172:175], v239 offset:128
    v_mfma_f32_4x4x4_16b_bf16 v[136:139], v[218:219], v[70:71], v[8:11]
    ds_read_b128 v[176:179], v239 offset:192
    ds_read_u16 v224, v238
    v_mfma_f32_4x4x4_16b_bf16 v[140:143], v[220:221], v[72:73], v[12:15]
    ds_read_u16 v225, v238 offset:8
    ds_read_u16 v226, v238 offset:64
    v_mfma_f32_4x4x4_16b_bf16 v[144:147], v[222:223], v[74:75], v[16:19]
    ds_read_u16 v227, v238 offset:72
    v_add_u32 v239, 272, v239
    v_mfma_f32_4x4x4_16b_bf16 v[246:249], v[216:217], v[76:77], v[20:23]
    v_cvt_pk_bf16_f32 v100, v132, v133
    v_cvt_pk_bf16_f32 v101, v134, v135
    v_mfma_f32_4x4x4_16b_bf16 v[250:253], v[218:219], v[78:79], v[24:27]
    v_cvt_pk_bf16_f32 v102, v136, v137
    v_cvt_pk_bf16_f32 v103, v138, v139
    v_mfma_f32_4x4x4_16b_bf16 v[132:135], v[220:221], v[80:81], v[28:31]
    v_cvt_pk_bf16_f32 v104, v140, v141
    v_cvt_pk_bf16_f32 v105, v142, v143
    v_mfma_f32_4x4x4_16b_bf16 v[136:139], v[222:223], v[82:83], v[32:35]
    v_cvt_pk_bf16_f32 v106, v144, v145
    v_cvt_pk_bf16_f32 v107, v146, v147
    v_mfma_f32_4x4x4_16b_bf16 v[140:143], v[216:217], v[84:85], v[36:39]
    v_cvt_pk_bf16_f32 v108, v246, v247
    v_cvt_pk_bf16_f32 v109, v248, v249
    v_mfma_f32_4x4x4_16b_bf16 v[144:147], v[218:219], v[86:87], v[40:43]
    v_cvt_pk_bf16_f32 v110, v250, v251
    v_cvt_pk_bf16_f32 v111, v252, v253
    v_mfma_f32_4x4x4_16b_bf16 v[246:249], v[220:221], v[88:89], v[44:47]
    v_cvt_pk_bf16_f32 v112, v132, v133
    v_cvt_pk_bf16_f32 v113, v134, v135
    v_mfma_f32_4x4x4_16b_bf16 v[250:253], v[222:223], v[90:91], v[48:51]
    v_cvt_pk_bf16_f32 v114, v136, v137
    v_cvt_pk_bf16_f32 v115, v138, v139
    v_mfma_f32_4x4x4_16b_bf16 v[132:135], v[216:217], v[92:93], v[52:55]
    v_cvt_pk_bf16_f32 v116, v140, v141
    v_cvt_pk_bf16_f32 v117, v142, v143
    v_mfma_f32_4x4x4_16b_bf16 v[136:139], v[218:219], v[94:95], v[56:59]
    v_cvt_pk_bf16_f32 v118, v144, v145
    v_cvt_pk_bf16_f32 v119, v146, v147
    v_mfma_f32_4x4x4_16b_bf16 v[140:143], v[220:221], v[96:97], v[60:63]
    v_cvt_pk_bf16_f32 v120, v246, v247
    v_cvt_pk_bf16_f32 v121, v248, v249
    v_mfma_f32_4x4x4_16b_bf16 v[144:147], v[222:223], v[98:99], v[64:67]
    v_cvt_pk_bf16_f32 v122, v250, v251
    v_cvt_pk_bf16_f32 v123, v252, v253
    v_cvt_pk_bf16_f32 v124, v132, v133
    v_cvt_pk_bf16_f32 v125, v134, v135
    v_cvt_pk_bf16_f32 v126, v136, v137
    v_cvt_pk_bf16_f32 v127, v138, v139
    v_cvt_pk_bf16_f32 v128, v140, v141
    v_cvt_pk_bf16_f32 v129, v142, v143
    v_cvt_pk_bf16_f32 v130, v144, v145
    v_cvt_pk_bf16_f32 v131, v146, v147
    s_waitcnt lgkmcnt(0)
    s_branch Lf_evd2
Lf_ev3:
    s_bitcmp0_b64 s[56:57], 3
    s_cbranch_scc1 Lf_nf3
    v_cvt_pk_bf16_f32 v246, v212, v212
    v_mov_b32 v212, 0
    ds_write_b16 v240, v246
    v_add_u32 v240, 128, v240
Lf_nf3:
    s_bitcmp0_b64 s[56:57], 8
    s_cbranch_scc1 Lf_na3
    s_add_u32 s35, s35, s31
    s_xor_b32 s31, s31, 0x63ff800
Lf_na3:
    s_bitcmp0_b64 s[56:57], 5
    s_cbranch_scc1 Lf_evd3
Lf_e13:
    s_sub_u32 s61, s61, 1
    s_cbranch_scc1 Lf_last3
    v_mul_u32_u24 v216, v224, v241
    v_mul_u32_u24 v217, v224, v242
    v_mul_u32_u24 v218, v225, v241
    v_mul_u32_u24 v219, v225, v242
    v_mul_u32_u24 v220, v226, v241
    v_mul_u32_u24 v221, v226, v242
    v_mul_u32_u24 v222, v227, v241
    v_mul_u32_u24 v223, v227, v242
    v_add_u32 v238, 128, v238
    ds_read_b128 v[164:167], v239
    v_mfma_f32_4x4x4_16b_bf16 v[132:135], v[216:217], v[68:69], v[4:7]
    ds_read_b128 v[168:171], v239 offset:64
    ds_read_b128 v[172:175], v239 offset:128
    v_mfma_f32_4x4x4_16b_bf16 v[136:139], v[218:219], v[70:71], v[8:11]
    ds_read_b128 v[176:179], v239 offset:192
    ds_read_u16 v224, v238
    v_mfma_f32_4x4x4_16b_bf16 v[140:143], v[220:221], v[72:73], v[12:15]
    ds_read_u16 v225, v238 offset:8
    ds_read_u16 v226, v238 offset:64
    v_mfma_f32_4x4x4_16b_bf16 v[144:147], v[222:223], v[74:75], v[16:19]
    ds_read_u16 v227, v238 offset:72
    v_add_u32 v239, 272, v239
    v_mfma_f32_4x4x4_16b_bf16 v[246:249], v[216:217], v[76:77], v[20:23]
    v_cvt_pk_bf16_f32 v100, v132, v133
    v_cvt_pk_bf16_f32 v101, v134, v135
    v_mfma_f32_4x4x4_16b_bf16 v[250:253], v[218:219], v[78:79], v[24:27]
    v_cvt_pk_bf16_f32 v102, v136, v137
    v_cvt_pk_bf16_f32 v103, v138, v139
    v_mfma_f32_4x4x4_16b_bf16 v[132:135], v[220:221], v[80:81], v[28:31]
    v_cvt_pk_bf16_f32 v104, v140, v141
    v_cvt_pk_bf16_f32 v105, v142, v143
    v_mfma_f32_4x4x4_16b_bf16 v[136:139], v[222:223], v[82:83], v[32:35]
    v_cvt_pk_bf16_f32 v106, v144, v145
    v_cvt_pk_bf16_f32 v107, v146, v147
    v_mfma_f32_4x4x4_16b_bf16 v[140:143], v[216:217], v[84:85], v[36:39]
    v_cvt_pk_bf16_f32 v108, v246, v247
    v_cvt_pk_bf16_f32 v109, v248, v249
    v_mfma_f32_4x4x4_16b_bf16 v[144:147], v[218:219], v[86:87], v[40:43]
    v_cvt_pk_bf16_f32 v110, v250, v251
    v_cvt_pk_bf16_f32 v111, v252, v253
    v_mfma_f32_4x4x4_16b_bf16 v[246:249], v[220:221], v[88:89], v[44:47]
    v_cvt_pk_bf16_f32 v112, v132, v133
    v_cvt_pk_bf16_f32 v113, v134, v135
    v_mfma_f32_4x4x4_16b_bf16 v[250:253], v[222:223], v[90:91], v[48:51]
    v_cvt_pk_bf16_f32 v114, v136, v137
    v_cvt_pk_bf16_f32 v115, v138, v139
    v_mfma_f32_4x4x4_16b_bf16 v[132:135], v[216:217], v[92:93], v[52:55]
    v_cvt_pk_bf16_f32 v116, v140, v141
    v_cvt_pk_bf16_f32 v117, v142, v143
    v_mfma_f32_4x4x4_16b_bf16 v[136:139], v[218:219], v[94:95], v[56:59]
    v_cvt_pk_bf16_f32 v118, v144, v145
    v_cvt_pk_bf16_f32 v119, v146, v147
    v_mfma_f32_4x4x4_16b_bf16 v[140:143], v[220:221], v[96:97], v[60:63]
    v_cvt_pk_bf16_f32 v120, v246, v247
    v_cvt_pk_bf16_f32 v121, v248, v249
    v_mfma_f32_4x4x4_16b_bf16 v[144:147], v[222:223], v[98:99], v[64:67]
    v_cvt_pk_bf16_f32 v122, v250, v251
    v_cvt_pk_bf16_f32 v123, v252, v253
    v_cvt_pk_bf16_f32 v124, v132, v133
    v_cvt_pk_bf16_f32 v125, v134, v135
    v_cvt_pk_bf16_f32 v126, v136, v137
    v_cvt_pk_bf16_f32 v127, v138, v139
    v_cvt_pk_bf16_f32 v128, v140, v141
    v_cvt_pk_bf16_f32 v129, v142, v143
    v_cvt_pk_bf16_f32 v130, v144, v145
    v_cvt_pk_bf16_f32 v131, v146, v147
    s_waitcnt lgkmcnt(0)
    s_branch Lf_evd3
Lf_last0:
    s_branch Lf_tail
Lf_last1:
    v_add_u32 v236, 2080, v236
    s_lshr_b64 s[56:57], s[56:57], 1
    s_branch Lf_tail
Lf_last2:
    v_add_u32 v236, 4160, v236
    s_lshr_b64 s[56:57], s[56:57], 2
    s_branch Lf_tail
Lf_last3:
    v_add_u32 v236, 6240, v236
    s_lshr_b64 s[56:57], s[56:57], 3
Lf_tail:
    v_exp_f32 v132, v148
    v_exp_f32 v133, v149
    v_exp_f32 v134, v150
    v_exp_f32 v135, v151
    v_exp_f32 v136, v152
    v_exp_f32 v137, v153
    v_mfma_f32_4x4x4_16b_bf16 v[132:135], v[228:229], v[228:229], v[132:135]
    v_cvt_pk_bf16_f32 v208, v208, v209
    v_cvt_pk_bf16_f32 v209, v210, v211
    v_exp_f32 v138, v154
    s_nop 0
    v_mfma_f32_4x4x4_16b_bf16 v[212:215], v[208:209], v[188:189], v[212:215] cbsz:4 abid:0
    ds_read_b64_tr_b16 v[188:189], v236 offset:0
    v_exp_f32 v139, v155
    v_exp_f32 v140, v156
    v_mfma_f32_4x4x4_16b_bf16 v[212:215], v[208:209], v[190:191], v[212:215] cbsz:4 abid:4
    ds_read_b64_tr_b16 v[190:191], v236 offset:512
    v_mfma_f32_4x4x4_16b_bf16 v[136:139], v[228:229], v[228:229], v[136:139]
    v_rcp_f32 v132, v132
    v_mfma_f32_4x4x4_16b_bf16 v[212:215], v[208:209], v[192:193], v[212:215] cbsz:4 abid:8
    ds_read_b64_tr_b16 v[192:193], v236 offset:1056
    v_exp_f32 v141, v157
    v_rcp_f32 v133, v133
    v_mfma_f32_4x4x4_16b_bf16 v[212:215], v[208:209], v[194:195], v[212:215] cbsz:4 abid:12
    ds_read_b64_tr_b16 v[194:195], v236 offset:1568
    v_exp_f32 v142, v158
    v_rcp_f32 v134, v134
    v_exp_f32 v143, v159
    v_rcp_f32 v135, v135
    v_cvt_pk_bf16_f32 v132, v132, v133
    v_mfma_f32_4x4x4_16b_bf16 v[140:143], v[228:229], v[228:229], v[140:143]
    v_exp_f32 v144, v160
    v_rcp_f32 v136, v136
    v_cvt_pk_bf16_f32 v133, v134, v135
    s_bitcmp0_b64 s[56:57], 1
    s_cbranch_scc1 Lf_tnf
    v_cvt_pk_bf16_f32 v246, v212, v212
    v_mov_b32 v212, 0
    ds_write_b16 v240, v246
    v_add_u32 v240, 128, v240
Lf_tnf:
    s_waitcnt lgkmcnt(0)
    v_exp_f32 v145, v161
    v_rcp_f32 v137, v137
    v_exp_f32 v146, v162
    v_rcp_f32 v138, v138
    v_cvt_pk_bf16_f32 v134, v136, v137
    v_exp_f32 v147, v163
    v_rcp_f32 v139, v139
    s_nop 0
    v_mfma_f32_4x4x4_16b_bf16 v[144:147], v[228:229], v[228:229], v[144:147]
    v_rcp_f32 v140, v140
    v_rcp_f32 v141, v141
    v_cvt_pk_bf16_f32 v135, v138, v139
    v_rcp_f32 v142, v142
    v_cvt_pk_bf16_f32 v136, v140, v141
    v_mfma_f32_16x16x32_bf16 v[208:211], v[132:135], v[196:199], v[204:207]
    v_rcp_f32 v143, v143
    v_rcp_f32 v144, v144
    v_cvt_pk_bf16_f32 v137, v142, v143
    v_rcp_f32 v145, v145
    v_rcp_f32 v146, v146
    v_rcp_f32 v147, v147
    v_cvt_pk_bf16_f32 v138, v144, v145
    v_cvt_pk_bf16_f32 v139, v146, v147
    s_nop 1
    v_mfma_f32_16x16x32_bf16 v[208:211], v[136:139], v[200:203], v[208:211]
    s_nop 7
    v_cvt_pk_bf16_f32 v208, v208, v209
    v_cvt_pk_bf16_f32 v209, v210, v211
    s_nop 1
    v_mfma_f32_4x4x4_16b_bf16 v[212:215], v[208:209], v[188:189], v[212:215] cbsz:4 abid:0
    s_nop 1
    v_mfma_f32_4x4x4_16b_bf16 v[212:215], v[208:209], v[190:191], v[212:215] cbsz:4 abid:4
    s_nop 1
    v_mfma_f32_4x4x4_16b_bf16 v[212:215], v[208:209], v[192:193], v[212:215] cbsz:4 abid:8
    s_nop 1
    v_mfma_f32_4x4x4_16b_bf16 v[212:215], v[208:209], v[194:195], v[212:215] cbsz:4 abid:12
    s_nop 4
    v_cvt_pk_bf16_f32 v246, v212, v212
    ds_write_b16 v240, v246
L_store:
    s_add_u32 s66, s52, 8320
    v_lshl_add_u32 v247, v0, 4, s66
    ds_read_b128 v[148:151], v247
    s_waitcnt lgkmcnt(0)
    global_store_dwordx4 v243, v[148:151], s[18:19] sc0 sc1
L_end:
    s_endpgm
L_general:
    s_waitcnt vmcnt(0)
    ds_read_b128 v[44:47], v246 offset:20480
    ds_read_b128 v[48:51], v246 offset:21504
    ds_read_b128 v[88:91], v246 offset:22528
    ds_read_b128 v[52:55], v246 offset:40960
    ds_read_b128 v[56:59], v246 offset:41984
    ds_read_b128 v[92:95], v246 offset:43008
    ds_read_b128 v[60:63], v246 offset:61440
    ds_read_b128 v[64:67], v246 offset:62464
    ds_read_b128 v[96:99], v246 offset:63488
    ds_read_u16 v224, v238 offset:0
    ds_read_u16 v225, v238 offset:8
    ds_read_u16 v226, v238 offset:64
    ds_read_u16 v227, v238 offset:72
    s_mul_i32 s35, s53, 51200
    s_movk_i32 s31, 25600
    s_mov_b64 s[56:57], 0
    s_mov_b64 s[58:59], 0
    v_mov_b32 v148, -1
    v_mov_b32 v149, -1
    v_mov_b32 v150, -1
    v_mov_b32 v151, -1
    s_add_u32 s66, s52, 18432
    v_add_u32 v152, s66, v2
    ds_write_b128 v152, v[148:151]
    ds_write_b128 v152, v[148:151] offset:1024
    s_add_u32 s64, s52, 18448
    s_bfm_b64 s[28:29], 50, 0
    s_mul_i32 s66, s53, 800
    v_add_u32 v247, s66, v2
    s_mov_b64 exec, s[28:29]
    global_load_dwordx4 v[100:103], v247, s[8:9]
    v_add_u32 v247, 1638400, v247
    global_load_dwordx4 v[104:107], v247, s[8:9]
    v_add_u32 v247, 1638400, v247
    global_load_dwordx4 v[108:111], v247, s[8:9]
    v_add_u32 v247, 1638400, v247
    global_load_dwordx4 v[112:115], v247, s[8:9]
    v_add_u32 v247, 1638400, v247
    s_mov_b64 exec, -1
    v_cmp_lt_u32 vcc, 24, v0
    s_nop 1
    v_cndmask_b32 v145, 0, 1, vcc
    v_mul_u32_u24 v142, 25, v145
    v_sub_u32 v142, v0, v142
    v_mul_u32_u24 v142, 0x80008, v142
    v_add_u32 v141, 0x10000, v142
    v_add_u32 v143, 0x50004, v142
    v_add_u32 v144, 0x70006, v142
    v_add_u32 v142, 0x30002, v142
    s_waitcnt vmcnt(0)
    s_mov_b64 exec, s[28:29]
    v_cmp_neq_f16_sdwa s[68:69], v100, 0 src0_sel:WORD_0 src1_sel:WORD_0
    v_cmp_neq_f16_sdwa s[70:71], v100, 0 src0_sel:WORD_1 src1_sel:WORD_0
    v_cmp_neq_f16_sdwa s[72:73], v101, 0 src0_sel:WORD_0 src1_sel:WORD_0
    v_cmp_neq_f16_sdwa s[74:75], v101, 0 src0_sel:WORD_1 src1_sel:WORD_0
    v_cmp_neq_f16_sdwa s[76:77], v102, 0 src0_sel:WORD_0 src1_sel:WORD_0
    v_cmp_neq_f16_sdwa s[78:79], v102, 0 src0_sel:WORD_1 src1_sel:WORD_0
    v_cmp_neq_f16_sdwa s[80:81], v103, 0 src0_sel:WORD_0 src1_sel:WORD_0
    v_cmp_neq_f16_sdwa s[82:83], v103, 0 src0_sel:WORD_1 src1_sel:WORD_0
    s_mov_b64 exec, -1
    v_mov_b32 v132, s64
    v_mbcnt_lo_u32_b32 v132, s68, v132
    v_mbcnt_hi_u32_b32 v132, s69, v132
    v_mbcnt_lo_u32_b32 v132, s70, v132
    v_mbcnt_hi_u32_b32 v132, s71, v132
    v_mbcnt_lo_u32_b32 v132, s72, v132
    v_mbcnt_hi_u32_b32 v132, s73, v132
    v_mbcnt_lo_u32_b32 v132, s74, v132
    v_mbcnt_hi_u32_b32 v132, s75, v132
    v_mbcnt_lo_u32_b32 v132, s76, v132
    v_mbcnt_hi_u32_b32 v132, s77, v132
    v_mbcnt_lo_u32_b32 v132, s78, v132
    v_mbcnt_hi_u32_b32 v132, s79, v132
    v_mbcnt_lo_u32_b32 v132, s80, v132
    v_mbcnt_hi_u32_b32 v132, s81, v132
    v_mbcnt_lo_u32_b32 v132, s82, v132
    v_mbcnt_hi_u32_b32 v132, s83, v132
    s_add_u32 s55, s64, 16
    v_readlane_b32 s66, v132, 25
    v_readlane_b32 s67, v132, 63
    s_add_u32 s64, s66, 15
    s_and_b32 s64, s64, -16
    s_max_u32 s64, s64, s55
    s_sub_u32 s66, s64, s66
    v_mad_u32_u24 v132, v145, s66, v132
    s_mov_b32 s55, s64
    v_addc_co_u32 v133, vcc, 0, v132, s[68:69]
    v_addc_co_u32 v134, vcc, 0, v133, s[70:71]
    v_addc_co_u32 v135, vcc, 0, v134, s[72:73]
    v_addc_co_u32 v136, vcc, 0, v135, s[74:75]
    v_addc_co_u32 v137, vcc, 0, v136, s[76:77]
    v_addc_co_u32 v138, vcc, 0, v137, s[78:79]
    v_addc_co_u32 v139, vcc, 0, v138, s[80:81]
    s_add_u32 s67, s67, s66
    s_add_u32 s67, s67, 15
    s_and_b32 s67, s67, -16
    s_add_u32 s64, s64, 16
    s_max_u32 s64, s64, s67
    s_mov_b64 exec, s[68:69]
    ds_write_b8 v132, v141
    s_mov_b64 exec, s[70:71]
    ds_write_b8_d16_hi v133, v141
    s_mov_b64 exec, s[72:73]
    ds_write_b8 v134, v142
    s_mov_b64 exec, s[74:75]
    ds_write_b8_d16_hi v135, v142
    s_mov_b64 exec, s[76:77]
    ds_write_b8 v136, v143
    s_mov_b64 exec, s[78:79]
    ds_write_b8_d16_hi v137, v143
    s_mov_b64 exec, s[80:81]
    ds_write_b8 v138, v144
    s_mov_b64 exec, s[82:83]
    ds_write_b8_d16_hi v139, v144
    s_mov_b64 exec, -1
    s_lshr_b32 s95, s55, 4
    s_bitset1_b64 s[56:57], s95
    s_lshr_b32 s95, s64, 4
    s_bitset1_b64 s[56:57], s95
    s_mov_b64 exec, s[28:29]
    v_cmp_neq_f16_sdwa s[68:69], v104, 0 src0_sel:WORD_0 src1_sel:WORD_0
    v_cmp_neq_f16_sdwa s[70:71], v104, 0 src0_sel:WORD_1 src1_sel:WORD_0
    v_cmp_neq_f16_sdwa s[72:73], v105, 0 src0_sel:WORD_0 src1_sel:WORD_0
    v_cmp_neq_f16_sdwa s[74:75], v105, 0 src0_sel:WORD_1 src1_sel:WORD_0
    v_cmp_neq_f16_sdwa s[76:77], v106, 0 src0_sel:WORD_0 src1_sel:WORD_0
    v_cmp_neq_f16_sdwa s[78:79], v106, 0 src0_sel:WORD_1 src1_sel:WORD_0
    v_cmp_neq_f16_sdwa s[80:81], v107, 0 src0_sel:WORD_0 src1_sel:WORD_0
    v_cmp_neq_f16_sdwa s[82:83], v107, 0 src0_sel:WORD_1 src1_sel:WORD_0
    s_mov_b64 exec, -1
    v_mov_b32 v132, s64
    v_mbcnt_lo_u32_b32 v132, s68, v132
    v_mbcnt_hi_u32_b32 v132, s69, v132
    v_mbcnt_lo_u32_b32 v132, s70, v132
    v_mbcnt_hi_u32_b32 v132, s71, v132
    v_mbcnt_lo_u32_b32 v132, s72, v132
    v_mbcnt_hi_u32_b32 v132, s73, v132
    v_mbcnt_lo_u32_b32 v132, s74, v132
    v_mbcnt_hi_u32_b32 v132, s75, v132
    v_mbcnt_lo_u32_b32 v132, s76, v132
    v_mbcnt_hi_u32_b32 v132, s77, v132
    v_mbcnt_lo_u32_b32 v132, s78, v132
    v_mbcnt_hi_u32_b32 v132, s79, v132
    v_mbcnt_lo_u32_b32 v132, s80, v132
    v_mbcnt_hi_u32_b32 v132, s81, v132
    v_mbcnt_lo_u32_b32 v132, s82, v132
    v_mbcnt_hi_u32_b32 v132, s83, v132
    s_add_u32 s55, s64, 16
    v_readlane_b32 s66, v132, 25
    v_readlane_b32 s67, v132, 63
    s_add_u32 s64, s66, 15
    s_and_b32 s64, s64, -16
    s_max_u32 s64, s64, s55
    s_sub_u32 s66, s64, s66
    v_mad_u32_u24 v132, v145, s66, v132
    s_mov_b32 s55, s64
    v_addc_co_u32 v133, vcc, 0, v132, s[68:69]
    v_addc_co_u32 v134, vcc, 0, v133, s[70:71]
    v_addc_co_u32 v135, vcc, 0, v134, s[72:73]
    v_addc_co_u32 v136, vcc, 0, v135, s[74:75]
    v_addc_co_u32 v137, vcc, 0, v136, s[76:77]
    v_addc_co_u32 v138, vcc, 0, v137, s[78:79]
    v_addc_co_u32 v139, vcc, 0, v138, s[80:81]
    s_add_u32 s67, s67, s66
    s_add_u32 s67, s67, 15
    s_and_b32 s67, s67, -16
    s_add_u32 s64, s64, 16
    s_max_u32 s64, s64, s67
    s_mov_b64 exec, s[68:69]
    ds_write_b8 v132, v141
    s_mov_b64 exec, s[70:71]
    ds_write_b8_d16_hi v133, v141
    s_mov_b64 exec, s[72:73]
    ds_write_b8 v134, v142
    s_mov_b64 exec, s[74:75]
    ds_write_b8_d16_hi v135, v142
    s_mov_b64 exec, s[76:77]
    ds_write_b8 v136, v143
    s_mov_b64 exec, s[78:79]
    ds_write_b8_d16_hi v137, v143
    s_mov_b64 exec, s[80:81]
    ds_write_b8 v138, v144
    s_mov_b64 exec, s[82:83]
    ds_write_b8_d16_hi v139, v144
    s_mov_b64 exec, -1
    s_lshr_b32 s95, s55, 4
    s_bitset1_b64 s[56:57], s95
    s_lshr_b32 s95, s64, 4
    s_bitset1_b64 s[56:57], s95
    s_mov_b64 exec, s[28:29]
    v_cmp_neq_f16_sdwa s[68:69], v108, 0 src0_sel:WORD_0 src1_sel:WORD_0
    v_cmp_neq_f16_sdwa s[70:71], v108, 0 src0_sel:WORD_1 src1_sel:WORD_0
    v_cmp_neq_f16_sdwa s[72:73], v109, 0 src0_sel:WORD_0 src1_sel:WORD_0
    v_cmp_neq_f16_sdwa s[74:75], v109, 0 src0_sel:WORD_1 src1_sel:WORD_0
    v_cmp_neq_f16_sdwa s[76:77], v110, 0 src0_sel:WORD_0 src1_sel:WORD_0
    v_cmp_neq_f16_sdwa s[78:79], v110, 0 src0_sel:WORD_1 src1_sel:WORD_0
    v_cmp_neq_f16_sdwa s[80:81], v111, 0 src0_sel:WORD_0 src1_sel:WORD_0
    v_cmp_neq_f16_sdwa s[82:83], v111, 0 src0_sel:WORD_1 src1_sel:WORD_0
    s_mov_b64 exec, -1
    v_mov_b32 v132, s64
    v_mbcnt_lo_u32_b32 v132, s68, v132
    v_mbcnt_hi_u32_b32 v132, s69, v132
    v_mbcnt_lo_u32_b32 v132, s70, v132
    v_mbcnt_hi_u32_b32 v132, s71, v132
    v_mbcnt_lo_u32_b32 v132, s72, v132
    v_mbcnt_hi_u32_b32 v132, s73, v132
    v_mbcnt_lo_u32_b32 v132, s74, v132
    v_mbcnt_hi_u32_b32 v132, s75, v132
    v_mbcnt_lo_u32_b32 v132, s76, v132
    v_mbcnt_hi_u32_b32 v132, s77, v132
    v_mbcnt_lo_u32_b32 v132, s78, v132
    v_mbcnt_hi_u32_b32 v132, s79, v132
    v_mbcnt_lo_u32_b32 v132, s80, v132
    v_mbcnt_hi_u32_b32 v132, s81, v132
    v_mbcnt_lo_u32_b32 v132, s82, v132
    v_mbcnt_hi_u32_b32 v132, s83, v132
    s_add_u32 s55, s64, 16
    v_readlane_b32 s66, v132, 25
    v_readlane_b32 s67, v132, 63
    s_add_u32 s64, s66, 15
    s_and_b32 s64, s64, -16
    s_max_u32 s64, s64, s55
    s_sub_u32 s66, s64, s66
    v_mad_u32_u24 v132, v145, s66, v132
    s_mov_b32 s55, s64
    v_addc_co_u32 v133, vcc, 0, v132, s[68:69]
    v_addc_co_u32 v134, vcc, 0, v133, s[70:71]
    v_addc_co_u32 v135, vcc, 0, v134, s[72:73]
    v_addc_co_u32 v136, vcc, 0, v135, s[74:75]
    v_addc_co_u32 v137, vcc, 0, v136, s[76:77]
    v_addc_co_u32 v138, vcc, 0, v137, s[78:79]
    v_addc_co_u32 v139, vcc, 0, v138, s[80:81]
    s_add_u32 s67, s67, s66
    s_add_u32 s67, s67, 15
    s_and_b32 s67, s67, -16
    s_add_u32 s64, s64, 16
    s_max_u32 s64, s64, s67
    s_mov_b64 exec, s[68:69]
    ds_write_b8 v132, v141
    s_mov_b64 exec, s[70:71]
    ds_write_b8_d16_hi v133, v141
    s_mov_b64 exec, s[72:73]
    ds_write_b8 v134, v142
    s_mov_b64 exec, s[74:75]
    ds_write_b8_d16_hi v135, v142
    s_mov_b64 exec, s[76:77]
    ds_write_b8 v136, v143
    s_mov_b64 exec, s[78:79]
    ds_write_b8_d16_hi v137, v143
    s_mov_b64 exec, s[80:81]
    ds_write_b8 v138, v144
    s_mov_b64 exec, s[82:83]
    ds_write_b8_d16_hi v139, v144
    s_mov_b64 exec, -1
    s_lshr_b32 s95, s55, 4
    s_lshl_b64 s[86:87], 1, s95
    s_bitcmp1_b32 s55, 10
    s_cselect_b64 s[88:89], 0, s[86:87]
    s_cselect_b64 s[90:91], s[86:87], 0
    s_or_b64 s[56:57], s[56:57], s[88:89]
    s_or_b64 s[58:59], s[58:59], s[90:91]
    s_lshr_b32 s95, s64, 4
    s_lshl_b64 s[86:87], 1, s95
    s_bitcmp1_b32 s64, 10
    s_cselect_b64 s[88:89], 0, s[86:87]
    s_cselect_b64 s[90:91], s[86:87], 0
    s_or_b64 s[56:57], s[56:57], s[88:89]
    s_or_b64 s[58:59], s[58:59], s[90:91]
    s_mov_b64 exec, s[28:29]
    v_cmp_neq_f16_sdwa s[68:69], v112, 0 src0_sel:WORD_0 src1_sel:WORD_0
    v_cmp_neq_f16_sdwa s[70:71], v112, 0 src0_sel:WORD_1 src1_sel:WORD_0
    v_cmp_neq_f16_sdwa s[72:73], v113, 0 src0_sel:WORD_0 src1_sel:WORD_0
    v_cmp_neq_f16_sdwa s[74:75], v113, 0 src0_sel:WORD_1 src1_sel:WORD_0
    v_cmp_neq_f16_sdwa s[76:77], v114, 0 src0_sel:WORD_0 src1_sel:WORD_0
    v_cmp_neq_f16_sdwa s[78:79], v114, 0 src0_sel:WORD_1 src1_sel:WORD_0
    v_cmp_neq_f16_sdwa s[80:81], v115, 0 src0_sel:WORD_0 src1_sel:WORD_0
    v_cmp_neq_f16_sdwa s[82:83], v115, 0 src0_sel:WORD_1 src1_sel:WORD_0
    s_mov_b64 exec, -1
    v_mov_b32 v132, s64
    v_mbcnt_lo_u32_b32 v132, s68, v132
    v_mbcnt_hi_u32_b32 v132, s69, v132
    v_mbcnt_lo_u32_b32 v132, s70, v132
    v_mbcnt_hi_u32_b32 v132, s71, v132
    v_mbcnt_lo_u32_b32 v132, s72, v132
    v_mbcnt_hi_u32_b32 v132, s73, v132
    v_mbcnt_lo_u32_b32 v132, s74, v132
    v_mbcnt_hi_u32_b32 v132, s75, v132
    v_mbcnt_lo_u32_b32 v132, s76, v132
    v_mbcnt_hi_u32_b32 v132, s77, v132
    v_mbcnt_lo_u32_b32 v132, s78, v132
    v_mbcnt_hi_u32_b32 v132, s79, v132
    v_mbcnt_lo_u32_b32 v132, s80, v132
    v_mbcnt_hi_u32_b32 v132, s81, v132
    v_mbcnt_lo_u32_b32 v132, s82, v132
    v_mbcnt_hi_u32_b32 v132, s83, v132
    s_add_u32 s55, s64, 16
    v_readlane_b32 s66, v132, 25
    v_readlane_b32 s67, v132, 63
    s_add_u32 s64, s66, 15
    s_and_b32 s64, s64, -16
    s_max_u32 s64, s64, s55
    s_sub_u32 s66, s64, s66
    v_mad_u32_u24 v132, v145, s66, v132
    s_mov_b32 s55, s64
    v_addc_co_u32 v133, vcc, 0, v132, s[68:69]
    v_addc_co_u32 v134, vcc, 0, v133, s[70:71]
    v_addc_co_u32 v135, vcc, 0, v134, s[72:73]
    v_addc_co_u32 v136, vcc, 0, v135, s[74:75]
    v_addc_co_u32 v137, vcc, 0, v136, s[76:77]
    v_addc_co_u32 v138, vcc, 0, v137, s[78:79]
    v_addc_co_u32 v139, vcc, 0, v138, s[80:81]
    s_add_u32 s67, s67, s66
    s_add_u32 s67, s67, 15
    s_and_b32 s67, s67, -16
    s_add_u32 s64, s64, 16
    s_max_u32 s64, s64, s67
    s_mov_b64 exec, s[68:69]
    ds_write_b8 v132, v141
    s_mov_b64 exec, s[70:71]
    ds_write_b8_d16_hi v133, v141
    s_mov_b64 exec, s[72:73]
    ds_write_b8 v134, v142
    s_mov_b64 exec, s[74:75]
    ds_write_b8_d16_hi v135, v142
    s_mov_b64 exec, s[76:77]
    ds_write_b8 v136, v143
    s_mov_b64 exec, s[78:79]
    ds_write_b8_d16_hi v137, v143
    s_mov_b64 exec, s[80:81]
    ds_write_b8 v138, v144
    s_mov_b64 exec, s[82:83]
    ds_write_b8_d16_hi v139, v144
    s_mov_b64 exec, -1
    s_lshr_b32 s95, s55, 4
    s_lshl_b64 s[86:87], 1, s95
    s_bitcmp1_b32 s55, 10
    s_cselect_b64 s[88:89], 0, s[86:87]
    s_cselect_b64 s[90:91], s[86:87], 0
    s_or_b64 s[56:57], s[56:57], s[88:89]
    s_or_b64 s[58:59], s[58:59], s[90:91]
    s_lshr_b32 s95, s64, 4
    s_lshl_b64 s[86:87], 1, s95
    s_bitcmp1_b32 s64, 10
    s_cselect_b64 s[88:89], 0, s[86:87]
    s_cselect_b64 s[90:91], s[86:87], 0
    s_or_b64 s[56:57], s[56:57], s[88:89]
    s_or_b64 s[58:59], s[58:59], s[90:91]
    s_mov_b32 s94, 0
    s_mov_b64 s[84:85], -1
    s_branch L_listed
Ls_loop:
    ds_read_u8 v230, v237 offset:64
    ds_read_u8 v232, v237 offset:72
    v_mfma_f32_16x16x32_bf16 v[208:211], v[136:139], v[200:203], v[208:211]
Ls_mid:
    s_bitcmp1_b32 s36, 0
    s_cbranch_scc1 Ls_ev0
Ls_evd0:
    ds_read_b32 v246, v244 offset:0
    s_waitcnt lgkmcnt(0)
    v_bfe_u32 v247, v246, 0, 8
    v_lshlrev_b32 v247, 1, v247
    v_bfe_u32 v248, v246, 8, 8
    v_lshlrev_b32 v248, 1, v248
    v_bfe_u32 v249, v246, 16, 8
    v_lshlrev_b32 v249, 1, v249
    v_bfe_u32 v250, v246, 24, 8
    v_lshlrev_b32 v250, 1, v250
    buffer_load_ushort v247, v247, s[24:27], 0 offen
    buffer_load_ushort v248, v248, s[24:27], 0 offen
    buffer_load_ushort v249, v249, s[24:27], 0 offen
    buffer_load_ushort v250, v250, s[24:27], 0 offen
    s_waitcnt vmcnt(0)
    v_lshlrev_b32 v247, 16, v247
    v_mul_f32 v208, v208, v247
    v_lshlrev_b32 v248, 16, v248
    v_mul_f32 v209, v209, v248
    v_lshlrev_b32 v249, 16, v249
    v_mul_f32 v210, v210, v249
    v_lshlrev_b32 v250, 16, v250
    v_mul_f32 v211, v211, v250
    ds_add_rtn_u32 v1, v2, v3
    v_exp_f32 v132, v148
    v_exp_f32 v133, v149
    v_exp_f32 v134, v150
    v_exp_f32 v135, v151
    v_exp_f32 v136, v152
    v_exp_f32 v137, v153
    v_mfma_f32_4x4x4_16b_bf16 v[132:135], v[228:229], v[228:229], v[132:135]
    v_cvt_pk_bf16_f32 v208, v208, v209
    v_cvt_pk_bf16_f32 v209, v210, v211
    s_waitcnt lgkmcnt(2)
    v_mfma_f32_16x16x32_bf16 v[148:151], v[100:103], v[180:183], v[164:167]
    v_exp_f32 v138, v154
    v_mfma_f32_4x4x4_16b_bf16 v[212:215], v[208:209], v[188:189], v[212:215] cbsz:4 abid:0
    ds_read_b64_tr_b16 v[188:189], v236 offset:0
    v_exp_f32 v139, v155
    v_mfma_f32_16x16x32_bf16 v[152:155], v[108:111], v[180:183], v[168:171]
    v_exp_f32 v140, v156
    v_mfma_f32_4x4x4_16b_bf16 v[212:215], v[208:209], v[190:191], v[212:215] cbsz:4 abid:4
    ds_read_b64_tr_b16 v[190:191], v236 offset:512
    v_mfma_f32_4x4x4_16b_bf16 v[136:139], v[228:229], v[228:229], v[136:139]
    v_rcp_f32 v132, v132
    v_mfma_f32_4x4x4_16b_bf16 v[212:215], v[208:209], v[192:193], v[212:215] cbsz:4 abid:8
    ds_read_b64_tr_b16 v[192:193], v236 offset:1056
    v_exp_f32 v141, v157
    v_mfma_f32_16x16x32_bf16 v[148:151], v[104:107], v[184:187], v[148:151]
    v_rcp_f32 v133, v133
    v_mfma_f32_4x4x4_16b_bf16 v[212:215], v[208:209], v[194:195], v[212:215] cbsz:4 abid:12
    ds_read_b64_tr_b16 v[194:195], v236 offset:1568
    v_exp_f32 v142, v158
    v_mfma_f32_16x16x32_bf16 v[152:155], v[112:115], v[184:187], v[152:155]
    v_rcp_f32 v134, v134
    v_exp_f32 v143, v159
    v_rcp_f32 v135, v135
    v_cvt_pk_bf16_f32 v132, v132, v133
    v_mfma_f32_4x4x4_16b_bf16 v[140:143], v[228:229], v[228:229], v[140:143]
    v_exp_f32 v144, v160
    v_mfma_f32_16x16x32_bf16 v[156:159], v[116:119], v[180:183], v[172:175]
    v_rcp_f32 v136, v136
    v_cvt_pk_bf16_f32 v133, v134, v135
    s_add_u32 m0, s52, 0
    s_waitcnt lgkmcnt(0)
    buffer_load_dwordx4 v[230:231], s[20:23], s35 idxen offen nt lds
    v_exp_f32 v145, v161
    buffer_load_dwordx4 v[232:233], s[40:43], s35 idxen offen offset:1056 nt lds
    v_rcp_f32 v137, v137
    v_exp_f32 v146, v162
    v_rcp_f32 v138, v138
    v_cvt_pk_bf16_f32 v134, v136, v137
    v_exp_f32 v147, v163
    v_mfma_f32_16x16x32_bf16 v[160:163], v[124:127], v[180:183], v[176:179]
    v_readfirstlane_b32 s66, v1
    s_setprio 0
    s_cmp_gt_i32 s66, 0
    s_cbranch_scc0 Ls_lo0
    s_setprio 1
Ls_lo0:
    v_rcp_f32 v139, v139
    v_mfma_f32_4x4x4_16b_bf16 v[144:147], v[228:229], v[228:229], v[144:147]
    v_mfma_f32_16x16x32_bf16 v[156:159], v[120:123], v[184:187], v[156:159]
    v_rcp_f32 v140, v140
    v_mfma_f32_16x16x32_bf16 v[160:163], v[128:131], v[184:187], v[160:163]
    v_rcp_f32 v141, v141
    v_cvt_pk_bf16_f32 v135, v138, v139
    s_waitcnt vmcnt(4)
    ds_read_b128 v[180:183], v234 offset:4160
    ds_read_b128 v[184:187], v235 offset:4160
    v_rcp_f32 v142, v142
    v_cvt_pk_bf16_f32 v136, v140, v141
    v_mfma_f32_16x16x32_bf16 v[208:211], v[132:135], v[196:199], v[204:207]
    v_rcp_f32 v143, v143
    v_rcp_f32 v144, v144
    v_cvt_pk_bf16_f32 v137, v142, v143
    v_rcp_f32 v145, v145
    v_rcp_f32 v146, v146
    v_rcp_f32 v147, v147
    v_cvt_pk_bf16_f32 v138, v144, v145
    v_cvt_pk_bf16_f32 v139, v146, v147
    ds_read_u8 v230, v237 offset:80
    ds_read_u8 v232, v237 offset:88
    v_mfma_f32_16x16x32_bf16 v[208:211], v[136:139], v[200:203], v[208:211]
    s_bitcmp1_b32 s36, 1
    s_cbranch_scc1 Ls_ev1
Ls_evd1:
    ds_read_b32 v246, v244 offset:16
    s_waitcnt lgkmcnt(0)
    v_bfe_u32 v247, v246, 0, 8
    v_lshlrev_b32 v247, 1, v247
    v_bfe_u32 v248, v246, 8, 8
    v_lshlrev_b32 v248, 1, v248
    v_bfe_u32 v249, v246, 16, 8
    v_lshlrev_b32 v249, 1, v249
    v_bfe_u32 v250, v246, 24, 8
    v_lshlrev_b32 v250, 1, v250
    buffer_load_ushort v247, v247, s[24:27], 0 offen
    buffer_load_ushort v248, v248, s[24:27], 0 offen
    buffer_load_ushort v249, v249, s[24:27], 0 offen
    buffer_load_ushort v250, v250, s[24:27], 0 offen
    s_waitcnt vmcnt(0)
    v_lshlrev_b32 v247, 16, v247
    v_mul_f32 v208, v208, v247
    v_lshlrev_b32 v248, 16, v248
    v_mul_f32 v209, v209, v248
    v_lshlrev_b32 v249, 16, v249
    v_mul_f32 v210, v210, v249
    v_lshlrev_b32 v250, 16, v250
    v_mul_f32 v211, v211, v250
    v_exp_f32 v132, v148
    v_exp_f32 v133, v149
    v_exp_f32 v134, v150
    v_exp_f32 v135, v151
    v_exp_f32 v136, v152
    v_exp_f32 v137, v153
    v_mfma_f32_4x4x4_16b_bf16 v[132:135], v[228:229], v[228:229], v[132:135]
    v_cvt_pk_bf16_f32 v208, v208, v209
    v_cvt_pk_bf16_f32 v209, v210, v211
    s_waitcnt lgkmcnt(2)
    v_mfma_f32_16x16x32_bf16 v[148:151], v[100:103], v[180:183], v[164:167]
    v_exp_f32 v138, v154
    v_mfma_f32_4x4x4_16b_bf16 v[212:215], v[208:209], v[188:189], v[212:215] cbsz:4 abid:0
    ds_read_b64_tr_b16 v[188:189], v236 offset:2080
    v_exp_f32 v139, v155
    v_mfma_f32_16x16x32_bf16 v[152:155], v[108:111], v[180:183], v[168:171]
    v_exp_f32 v140, v156
    v_mfma_f32_4x4x4_16b_bf16 v[212:215], v[208:209], v[190:191], v[212:215] cbsz:4 abid:4
    ds_read_b64_tr_b16 v[190:191], v236 offset:2592
    v_mfma_f32_4x4x4_16b_bf16 v[136:139], v[228:229], v[228:229], v[136:139]
    v_rcp_f32 v132, v132
    v_mfma_f32_4x4x4_16b_bf16 v[212:215], v[208:209], v[192:193], v[212:215] cbsz:4 abid:8
    ds_read_b64_tr_b16 v[192:193], v236 offset:3136
    v_exp_f32 v141, v157
    v_mfma_f32_16x16x32_bf16 v[148:151], v[104:107], v[184:187], v[148:151]
    v_rcp_f32 v133, v133
    v_mfma_f32_4x4x4_16b_bf16 v[212:215], v[208:209], v[194:195], v[212:215] cbsz:4 abid:12
    ds_read_b64_tr_b16 v[194:195], v236 offset:3648
    v_exp_f32 v142, v158
    v_mfma_f32_16x16x32_bf16 v[152:155], v[112:115], v[184:187], v[152:155]
    v_rcp_f32 v134, v134
    v_exp_f32 v143, v159
    v_rcp_f32 v135, v135
    v_cvt_pk_bf16_f32 v132, v132, v133
    v_mfma_f32_4x4x4_16b_bf16 v[140:143], v[228:229], v[228:229], v[140:143]
    v_exp_f32 v144, v160
    v_mfma_f32_16x16x32_bf16 v[156:159], v[116:119], v[180:183], v[172:175]
    v_rcp_f32 v136, v136
    v_cvt_pk_bf16_f32 v133, v134, v135
    s_add_u32 m0, s52, 2080
    s_waitcnt lgkmcnt(0)
    buffer_load_dwordx4 v[230:231], s[20:23], s35 idxen offen nt lds
    v_exp_f32 v145, v161
    buffer_load_dwordx4 v[232:233], s[40:43], s35 idxen offen offset:1056 nt lds
    v_rcp_f32 v137, v137
    v_exp_f32 v146, v162
    v_rcp_f32 v138, v138
    v_cvt_pk_bf16_f32 v134, v136, v137
    v_exp_f32 v147, v163
    v_mfma_f32_16x16x32_bf16 v[160:163], v[124:127], v[180:183], v[176:179]
    v_rcp_f32 v139, v139
    v_mfma_f32_4x4x4_16b_bf16 v[144:147], v[228:229], v[228:229], v[144:147]
    v_mfma_f32_16x16x32_bf16 v[156:159], v[120:123], v[184:187], v[156:159]
    v_rcp_f32 v140, v140
    v_mfma_f32_16x16x32_bf16 v[160:163], v[128:131], v[184:187], v[160:163]
    v_rcp_f32 v141, v141
    v_cvt_pk_bf16_f32 v135, v138, v139
    s_waitcnt vmcnt(4)
    ds_read_b128 v[180:183], v234 offset:6240
    ds_read_b128 v[184:187], v235 offset:6240
    v_rcp_f32 v142, v142
    v_cvt_pk_bf16_f32 v136, v140, v141
    v_mfma_f32_16x16x32_bf16 v[208:211], v[132:135], v[196:199], v[204:207]
    v_rcp_f32 v143, v143
    v_rcp_f32 v144, v144
    v_cvt_pk_bf16_f32 v137, v142, v143
    v_rcp_f32 v145, v145
    v_rcp_f32 v146, v146
    v_rcp_f32 v147, v147
    v_cvt_pk_bf16_f32 v138, v144, v145
    v_cvt_pk_bf16_f32 v139, v146, v147
    ds_read_u8 v230, v237 offset:96
    ds_read_u8 v232, v237 offset:104
    v_mfma_f32_16x16x32_bf16 v[208:211], v[136:139], v[200:203], v[208:211]
    s_bitcmp1_b32 s36, 2
    s_cbranch_scc1 Ls_ev2
Ls_evd2:
    ds_read_b32 v246, v244 offset:32
    s_waitcnt lgkmcnt(0)
    v_bfe_u32 v247, v246, 0, 8
    v_lshlrev_b32 v247, 1, v247
    v_bfe_u32 v248, v246, 8, 8
    v_lshlrev_b32 v248, 1, v248
    v_bfe_u32 v249, v246, 16, 8
    v_lshlrev_b32 v249, 1, v249
    v_bfe_u32 v250, v246, 24, 8
    v_lshlrev_b32 v250, 1, v250
    buffer_load_ushort v247, v247, s[24:27], 0 offen
    buffer_load_ushort v248, v248, s[24:27], 0 offen
    buffer_load_ushort v249, v249, s[24:27], 0 offen
    buffer_load_ushort v250, v250, s[24:27], 0 offen
    s_waitcnt vmcnt(0)
    v_lshlrev_b32 v247, 16, v247
    v_mul_f32 v208, v208, v247
    v_lshlrev_b32 v248, 16, v248
    v_mul_f32 v209, v209, v248
    v_lshlrev_b32 v249, 16, v249
    v_mul_f32 v210, v210, v249
    v_lshlrev_b32 v250, 16, v250
    v_mul_f32 v211, v211, v250
    v_exp_f32 v132, v148
    v_exp_f32 v133, v149
    v_exp_f32 v134, v150
    v_exp_f32 v135, v151
    v_exp_f32 v136, v152
    v_exp_f32 v137, v153
    v_mfma_f32_4x4x4_16b_bf16 v[132:135], v[228:229], v[228:229], v[132:135]
    v_cvt_pk_bf16_f32 v208, v208, v209
    v_cvt_pk_bf16_f32 v209, v210, v211
    s_waitcnt lgkmcnt(2)
    v_mfma_f32_16x16x32_bf16 v[148:151], v[100:103], v[180:183], v[164:167]
    v_exp_f32 v138, v154
    v_mfma_f32_4x4x4_16b_bf16 v[212:215], v[208:209], v[188:189], v[212:215] cbsz:4 abid:0
    ds_read_b64_tr_b16 v[188:189], v236 offset:4160
    v_exp_f32 v139, v155
    v_mfma_f32_16x16x32_bf16 v[152:155], v[108:111], v[180:183], v[168:171]
    v_exp_f32 v140, v156
    v_mfma_f32_4x4x4_16b_bf16 v[212:215], v[208:209], v[190:191], v[212:215] cbsz:4 abid:4
    ds_read_b64_tr_b16 v[190:191], v236 offset:4672
    v_mfma_f32_4x4x4_16b_bf16 v[136:139], v[228:229], v[228:229], v[136:139]
    v_rcp_f32 v132, v132
    v_mfma_f32_4x4x4_16b_bf16 v[212:215], v[208:209], v[192:193], v[212:215] cbsz:4 abid:8
    ds_read_b64_tr_b16 v[192:193], v236 offset:5216
    v_exp_f32 v141, v157
    v_mfma_f32_16x16x32_bf16 v[148:151], v[104:107], v[184:187], v[148:151]
    v_rcp_f32 v133, v133
    v_mfma_f32_4x4x4_16b_bf16 v[212:215], v[208:209], v[194:195], v[212:215] cbsz:4 abid:12
    ds_read_b64_tr_b16 v[194:195], v236 offset:5728
    v_exp_f32 v142, v158
    v_mfma_f32_16x16x32_bf16 v[152:155], v[112:115], v[184:187], v[152:155]
    v_rcp_f32 v134, v134
    v_exp_f32 v143, v159
    v_rcp_f32 v135, v135
    v_cvt_pk_bf16_f32 v132, v132, v133
    v_mfma_f32_4x4x4_16b_bf16 v[140:143], v[228:229], v[228:229], v[140:143]
    v_exp_f32 v144, v160
    v_mfma_f32_16x16x32_bf16 v[156:159], v[116:119], v[180:183], v[172:175]
    v_rcp_f32 v136, v136
    v_cvt_pk_bf16_f32 v133, v134, v135
    s_add_u32 m0, s52, 4160
    s_waitcnt lgkmcnt(0)
    buffer_load_dwordx4 v[230:231], s[20:23], s35 idxen offen nt lds
    v_exp_f32 v145, v161
    buffer_load_dwordx4 v[232:233], s[40:43], s35 idxen offen offset:1056 nt lds
    v_rcp_f32 v137, v137
    v_exp_f32 v146, v162
    v_rcp_f32 v138, v138
    v_cvt_pk_bf16_f32 v134, v136, v137
    v_exp_f32 v147, v163
    v_mfma_f32_16x16x32_bf16 v[160:163], v[124:127], v[180:183], v[176:179]
    v_rcp_f32 v139, v139
    v_mfma_f32_4x4x4_16b_bf16 v[144:147], v[228:229], v[228:229], v[144:147]
    v_mfma_f32_16x16x32_bf16 v[156:159], v[120:123], v[184:187], v[156:159]
    v_rcp_f32 v140, v140
    v_mfma_f32_16x16x32_bf16 v[160:163], v[128:131], v[184:187], v[160:163]
    v_rcp_f32 v141, v141
    v_cvt_pk_bf16_f32 v135, v138, v139
    s_waitcnt vmcnt(4)
    ds_read_b128 v[180:183], v234 offset:0
    ds_read_b128 v[184:187], v235 offset:0
    v_rcp_f32 v142, v142
    v_cvt_pk_bf16_f32 v136, v140, v141
    v_mfma_f32_16x16x32_bf16 v[208:211], v[132:135], v[196:199], v[204:207]
    v_rcp_f32 v143, v143
    v_rcp_f32 v144, v144
    v_cvt_pk_bf16_f32 v137, v142, v143
    v_rcp_f32 v145, v145
    v_rcp_f32 v146, v146
    v_rcp_f32 v147, v147
    v_cvt_pk_bf16_f32 v138, v144, v145
    v_cvt_pk_bf16_f32 v139, v146, v147
    ds_read_u8 v230, v237 offset:112
    ds_read_u8 v232, v237 offset:120
    v_mfma_f32_16x16x32_bf16 v[208:211], v[136:139], v[200:203], v[208:211]
    s_bitcmp1_b32 s36, 3
    s_cbranch_scc1 Ls_ev3
Ls_evd3:
    ds_read_b32 v246, v244 offset:48
    s_waitcnt lgkmcnt(0)
    v_bfe_u32 v247, v246, 0, 8
    v_lshlrev_b32 v247, 1, v247
    v_bfe_u32 v248, v246, 8, 8
    v_lshlrev_b32 v248, 1, v248
    v_bfe_u32 v249, v246, 16, 8
    v_lshlrev_b32 v249, 1, v249
    v_bfe_u32 v250, v246, 24, 8
    v_lshlrev_b32 v250, 1, v250
    buffer_load_ushort v247, v247, s[24:27], 0 offen
    buffer_load_ushort v248, v248, s[24:27], 0 offen
    buffer_load_ushort v249, v249, s[24:27], 0 offen
    buffer_load_ushort v250, v250, s[24:27], 0 offen
    s_waitcnt vmcnt(0)
    v_lshlrev_b32 v247, 16, v247
    v_mul_f32 v208, v208, v247
    v_lshlrev_b32 v248, 16, v248
    v_mul_f32 v209, v209, v248
    v_lshlrev_b32 v249, 16, v249
    v_mul_f32 v210, v210, v249
    v_lshlrev_b32 v250, 16, v250
    v_mul_f32 v211, v211, v250
    v_exp_f32 v132, v148
    v_exp_f32 v133, v149
    v_exp_f32 v134, v150
    v_exp_f32 v135, v151
    v_exp_f32 v136, v152
    v_exp_f32 v137, v153
    v_mfma_f32_4x4x4_16b_bf16 v[132:135], v[228:229], v[228:229], v[132:135]
    v_cvt_pk_bf16_f32 v208, v208, v209
    v_cvt_pk_bf16_f32 v209, v210, v211
    s_waitcnt lgkmcnt(2)
    v_mfma_f32_16x16x32_bf16 v[148:151], v[100:103], v[180:183], v[164:167]
    v_exp_f32 v138, v154
    v_mfma_f32_4x4x4_16b_bf16 v[212:215], v[208:209], v[188:189], v[212:215] cbsz:4 abid:0
    ds_read_b64_tr_b16 v[188:189], v236 offset:6240
    v_exp_f32 v139, v155
    v_mfma_f32_16x16x32_bf16 v[152:155], v[108:111], v[180:183], v[168:171]
    v_exp_f32 v140, v156
    v_mfma_f32_4x4x4_16b_bf16 v[212:215], v[208:209], v[190:191], v[212:215] cbsz:4 abid:4
    ds_read_b64_tr_b16 v[190:191], v236 offset:6752
    v_mfma_f32_4x4x4_16b_bf16 v[136:139], v[228:229], v[228:229], v[136:139]
    v_rcp_f32 v132, v132
    v_mfma_f32_4x4x4_16b_bf16 v[212:215], v[208:209], v[192:193], v[212:215] cbsz:4 abid:8
    ds_read_b64_tr_b16 v[192:193], v236 offset:7296
    v_exp_f32 v141, v157
    v_mfma_f32_16x16x32_bf16 v[148:151], v[104:107], v[184:187], v[148:151]
    v_rcp_f32 v133, v133
    v_mfma_f32_4x4x4_16b_bf16 v[212:215], v[208:209], v[194:195], v[212:215] cbsz:4 abid:12
    ds_read_b64_tr_b16 v[194:195], v236 offset:7808
    v_exp_f32 v142, v158
    v_mfma_f32_16x16x32_bf16 v[152:155], v[112:115], v[184:187], v[152:155]
    v_rcp_f32 v134, v134
    v_exp_f32 v143, v159
    v_rcp_f32 v135, v135
    v_cvt_pk_bf16_f32 v132, v132, v133
    v_mfma_f32_4x4x4_16b_bf16 v[140:143], v[228:229], v[228:229], v[140:143]
    v_exp_f32 v144, v160
    v_mfma_f32_16x16x32_bf16 v[156:159], v[116:119], v[180:183], v[172:175]
    v_rcp_f32 v136, v136
    v_cvt_pk_bf16_f32 v133, v134, v135
    s_add_u32 m0, s52, 6240
    s_waitcnt lgkmcnt(0)
    buffer_load_dwordx4 v[230:231], s[20:23], s35 idxen offen nt lds
    v_exp_f32 v145, v161
    buffer_load_dwordx4 v[232:233], s[40:43], s35 idxen offen offset:1056 nt lds
    v_rcp_f32 v137, v137
    v_exp_f32 v146, v162
    v_rcp_f32 v138, v138
    v_cvt_pk_bf16_f32 v134, v136, v137
    v_exp_f32 v147, v163
    v_mfma_f32_16x16x32_bf16 v[160:163], v[124:127], v[180:183], v[176:179]
    v_rcp_f32 v139, v139
    v_mfma_f32_4x4x4_16b_bf16 v[144:147], v[228:229], v[228:229], v[144:147]
    v_mfma_f32_16x16x32_bf16 v[156:159], v[120:123], v[184:187], v[156:159]
    v_rcp_f32 v140, v140
    v_mfma_f32_16x16x32_bf16 v[160:163], v[128:131], v[184:187], v[160:163]
    v_rcp_f32 v141, v141
    v_cvt_pk_bf16_f32 v135, v138, v139
    s_waitcnt vmcnt(4)
    ds_read_b128 v[180:183], v234 offset:2080
    ds_read_b128 v[184:187], v235 offset:2080
    v_rcp_f32 v142, v142
    v_cvt_pk_bf16_f32 v136, v140, v141
    v_mfma_f32_16x16x32_bf16 v[208:211], v[132:135], v[196:199], v[204:207]
    v_rcp_f32 v143, v143
    s_lshr_b64 s[56:57], s[56:57], 4
    s_lshl_b64 s[86:87], s[58:59], 60
    s_or_b64 s[56:57], s[56:57], s[86:87]
    s_lshr_b64 s[58:59], s[58:59], 4
    s_lshr_b64 s[86:87], s[56:57], 2
    s_lshr_b64 s[36:37], s[56:57], 5
    s_or_b32 s36, s36, s86
    s_or_b32 s36, s36, s56
    v_add_u32 v237, 64, v237
    v_add_u32 v244, 64, v244
    v_rcp_f32 v144, v144
    v_cvt_pk_bf16_f32 v137, v142, v143
    v_rcp_f32 v145, v145
    v_rcp_f32 v146, v146
    v_rcp_f32 v147, v147
    v_cvt_pk_bf16_f32 v138, v144, v145
    v_cvt_pk_bf16_f32 v139, v146, v147
    s_branch Ls_loop
Ls_ev0:
    s_bitcmp0_b64 s[56:57], 0
    s_cbranch_scc1 Ls_nf0
    v_cvt_pk_bf16_f32 v246, v212, v212
    v_mov_b32 v212, 0
    ds_write_b16 v240, v246
    v_add_u32 v240, 128, v240
    s_add_u32 s24, s24, s32
    s_addc_u32 s25, s25, 0
    s_xor_b32 s32, s32, 0x18ffe0
Ls_nf0:
    s_bitcmp0_b64 s[56:57], 5
    s_cbranch_scc1 Ls_na0
    s_add_u32 s35, s35, s31
    s_xor_b32 s31, s31, 0x63ff800
Ls_na0:
    s_bitcmp0_b64 s[56:57], 2
    s_cbranch_scc1 Ls_evd0
Ls_e10:
    s_sub_u32 s61, s61, 1
    s_cbranch_scc1 Ls_last0
    v_mul_u32_u24 v216, v224, v241
    v_mul_u32_u24 v217, v224, v242
    v_mul_u32_u24 v218, v225, v241
    v_mul_u32_u24 v219, v225, v242
    v_mul_u32_u24 v220, v226, v241
    v_mul_u32_u24 v221, v226, v242
    v_mul_u32_u24 v222, v227, v241
    v_mul_u32_u24 v223, v227, v242
    v_add_u32 v238, 128, v238
    ds_read_b128 v[164:167], v239
    v_mfma_f32_4x4x4_16b_bf16 v[132:135], v[216:217], v[68:69], v[4:7]
    ds_read_b128 v[168:171], v239 offset:64
    ds_read_b128 v[172:175], v239 offset:128
    v_mfma_f32_4x4x4_16b_bf16 v[136:139], v[218:219], v[70:71], v[8:11]
    ds_read_b128 v[176:179], v239 offset:192
    ds_read_u16 v224, v238
    v_mfma_f32_4x4x4_16b_bf16 v[140:143], v[220:221], v[72:73], v[12:15]
    ds_read_u16 v225, v238 offset:8
    ds_read_u16 v226, v238 offset:64
    v_mfma_f32_4x4x4_16b_bf16 v[144:147], v[222:223], v[74:75], v[16:19]
    ds_read_u16 v227, v238 offset:72
    v_add_u32 v239, 272, v239
    v_mfma_f32_4x4x4_16b_bf16 v[246:249], v[216:217], v[76:77], v[20:23]
    v_cvt_pk_bf16_f32 v100, v132, v133
    v_cvt_pk_bf16_f32 v101, v134, v135
    v_mfma_f32_4x4x4_16b_bf16 v[250:253], v[218:219], v[78:79], v[24:27]
    v_cvt_pk_bf16_f32 v102, v136, v137
    v_cvt_pk_bf16_f32 v103, v138, v139
    v_mfma_f32_4x4x4_16b_bf16 v[132:135], v[220:221], v[80:81], v[28:31]
    v_cvt_pk_bf16_f32 v104, v140, v141
    v_cvt_pk_bf16_f32 v105, v142, v143
    v_mfma_f32_4x4x4_16b_bf16 v[136:139], v[222:223], v[82:83], v[32:35]
    v_cvt_pk_bf16_f32 v106, v144, v145
    v_cvt_pk_bf16_f32 v107, v146, v147
    v_mfma_f32_4x4x4_16b_bf16 v[140:143], v[216:217], v[84:85], v[36:39]
    v_cvt_pk_bf16_f32 v108, v246, v247
    v_cvt_pk_bf16_f32 v109, v248, v249
    v_mfma_f32_4x4x4_16b_bf16 v[144:147], v[218:219], v[86:87], v[40:43]
    v_cvt_pk_bf16_f32 v110, v250, v251
    v_cvt_pk_bf16_f32 v111, v252, v253
    v_mfma_f32_4x4x4_16b_bf16 v[246:249], v[220:221], v[88:89], v[44:47]
    v_cvt_pk_bf16_f32 v112, v132, v133
    v_cvt_pk_bf16_f32 v113, v134, v135
    v_mfma_f32_4x4x4_16b_bf16 v[250:253], v[222:223], v[90:91], v[48:51]
    v_cvt_pk_bf16_f32 v114, v136, v137
    v_cvt_pk_bf16_f32 v115, v138, v139
    v_mfma_f32_4x4x4_16b_bf16 v[132:135], v[216:217], v[92:93], v[52:55]
    v_cvt_pk_bf16_f32 v116, v140, v141
    v_cvt_pk_bf16_f32 v117, v142, v143
    v_mfma_f32_4x4x4_16b_bf16 v[136:139], v[218:219], v[94:95], v[56:59]
    v_cvt_pk_bf16_f32 v118, v144, v145
    v_cvt_pk_bf16_f32 v119, v146, v147
    v_mfma_f32_4x4x4_16b_bf16 v[140:143], v[220:221], v[96:97], v[60:63]
    v_cvt_pk_bf16_f32 v120, v246, v247
    v_cvt_pk_bf16_f32 v121, v248, v249
    v_mfma_f32_4x4x4_16b_bf16 v[144:147], v[222:223], v[98:99], v[64:67]
    v_cvt_pk_bf16_f32 v122, v250, v251
    v_cvt_pk_bf16_f32 v123, v252, v253
    v_cvt_pk_bf16_f32 v124, v132, v133
    v_cvt_pk_bf16_f32 v125, v134, v135
    v_cvt_pk_bf16_f32 v126, v136, v137
    v_cvt_pk_bf16_f32 v127, v138, v139
    v_cvt_pk_bf16_f32 v128, v140, v141
    v_cvt_pk_bf16_f32 v129, v142, v143
    v_cvt_pk_bf16_f32 v130, v144, v145
    v_cvt_pk_bf16_f32 v131, v146, v147
    s_waitcnt lgkmcnt(0)
    s_branch Ls_evd0
Ls_ev1:
    s_bitcmp0_b64 s[56:57], 1
    s_cbranch_scc1 Ls_nf1
    v_cvt_pk_bf16_f32 v246, v212, v212
    v_mov_b32 v212, 0
    ds_write_b16 v240, v246
    v_add_u32 v240, 128, v240
    s_add_u32 s24, s24, s32
    s_addc_u32 s25, s25, 0
    s_xor_b32 s32, s32, 0x18ffe0
Ls_nf1:
    s_bitcmp0_b64 s[56:57], 6
    s_cbranch_scc1 Ls_na1
    s_add_u32 s35, s35, s31
    s_xor_b32 s31, s31, 0x63ff800
Ls_na1:
    s_bitcmp0_b64 s[56:57], 3
    s_cbranch_scc1 Ls_evd1
Ls_e11:
    s_sub_u32 s61, s61, 1
    s_cbranch_scc1 Ls_last1
    v_mul_u32_u24 v216, v224, v241
    v_mul_u32_u24 v217, v224, v242
    v_mul_u32_u24 v218, v225, v241
    v_mul_u32_u24 v219, v225, v242
    v_mul_u32_u24 v220, v226, v241
    v_mul_u32_u24 v221, v226, v242
    v_mul_u32_u24 v222, v227, v241
    v_mul_u32_u24 v223, v227, v242
    v_add_u32 v238, 128, v238
    ds_read_b128 v[164:167], v239
    v_mfma_f32_4x4x4_16b_bf16 v[132:135], v[216:217], v[68:69], v[4:7]
    ds_read_b128 v[168:171], v239 offset:64
    ds_read_b128 v[172:175], v239 offset:128
    v_mfma_f32_4x4x4_16b_bf16 v[136:139], v[218:219], v[70:71], v[8:11]
    ds_read_b128 v[176:179], v239 offset:192
    ds_read_u16 v224, v238
    v_mfma_f32_4x4x4_16b_bf16 v[140:143], v[220:221], v[72:73], v[12:15]
    ds_read_u16 v225, v238 offset:8
    ds_read_u16 v226, v238 offset:64
    v_mfma_f32_4x4x4_16b_bf16 v[144:147], v[222:223], v[74:75], v[16:19]
    ds_read_u16 v227, v238 offset:72
    v_add_u32 v239, 272, v239
    v_mfma_f32_4x4x4_16b_bf16 v[246:249], v[216:217], v[76:77], v[20:23]
    v_cvt_pk_bf16_f32 v100, v132, v133
    v_cvt_pk_bf16_f32 v101, v134, v135
    v_mfma_f32_4x4x4_16b_bf16 v[250:253], v[218:219], v[78:79], v[24:27]
    v_cvt_pk_bf16_f32 v102, v136, v137
    v_cvt_pk_bf16_f32 v103, v138, v139
    v_mfma_f32_4x4x4_16b_bf16 v[132:135], v[220:221], v[80:81], v[28:31]
    v_cvt_pk_bf16_f32 v104, v140, v141
    v_cvt_pk_bf16_f32 v105, v142, v143
    v_mfma_f32_4x4x4_16b_bf16 v[136:139], v[222:223], v[82:83], v[32:35]
    v_cvt_pk_bf16_f32 v106, v144, v145
    v_cvt_pk_bf16_f32 v107, v146, v147
    v_mfma_f32_4x4x4_16b_bf16 v[140:143], v[216:217], v[84:85], v[36:39]
    v_cvt_pk_bf16_f32 v108, v246, v247
    v_cvt_pk_bf16_f32 v109, v248, v249
    v_mfma_f32_4x4x4_16b_bf16 v[144:147], v[218:219], v[86:87], v[40:43]
    v_cvt_pk_bf16_f32 v110, v250, v251
    v_cvt_pk_bf16_f32 v111, v252, v253
    v_mfma_f32_4x4x4_16b_bf16 v[246:249], v[220:221], v[88:89], v[44:47]
    v_cvt_pk_bf16_f32 v112, v132, v133
    v_cvt_pk_bf16_f32 v113, v134, v135
    v_mfma_f32_4x4x4_16b_bf16 v[250:253], v[222:223], v[90:91], v[48:51]
    v_cvt_pk_bf16_f32 v114, v136, v137
    v_cvt_pk_bf16_f32 v115, v138, v139
    v_mfma_f32_4x4x4_16b_bf16 v[132:135], v[216:217], v[92:93], v[52:55]
    v_cvt_pk_bf16_f32 v116, v140, v141
    v_cvt_pk_bf16_f32 v117, v142, v143
    v_mfma_f32_4x4x4_16b_bf16 v[136:139], v[218:219], v[94:95], v[56:59]
    v_cvt_pk_bf16_f32 v118, v144, v145
    v_cvt_pk_bf16_f32 v119, v146, v147
    v_mfma_f32_4x4x4_16b_bf16 v[140:143], v[220:221], v[96:97], v[60:63]
    v_cvt_pk_bf16_f32 v120, v246, v247
    v_cvt_pk_bf16_f32 v121, v248, v249
    v_mfma_f32_4x4x4_16b_bf16 v[144:147], v[222:223], v[98:99], v[64:67]
    v_cvt_pk_bf16_f32 v122, v250, v251
    v_cvt_pk_bf16_f32 v123, v252, v253
    v_cvt_pk_bf16_f32 v124, v132, v133
    v_cvt_pk_bf16_f32 v125, v134, v135
    v_cvt_pk_bf16_f32 v126, v136, v137
    v_cvt_pk_bf16_f32 v127, v138, v139
    v_cvt_pk_bf16_f32 v128, v140, v141
    v_cvt_pk_bf16_f32 v129, v142, v143
    v_cvt_pk_bf16_f32 v130, v144, v145
    v_cvt_pk_bf16_f32 v131, v146, v147
    s_waitcnt lgkmcnt(0)
    s_branch Ls_evd1
Ls_ev2:
    s_bitcmp0_b64 s[56:57], 2
    s_cbranch_scc1 Ls_nf2
    v_cvt_pk_bf16_f32 v246, v212, v212
    v_mov_b32 v212, 0
    ds_write_b16 v240, v246
    v_add_u32 v240, 128, v240
    s_add_u32 s24, s24, s32
    s_addc_u32 s25, s25, 0
    s_xor_b32 s32, s32, 0x18ffe0
Ls_nf2:
    s_bitcmp0_b64 s[56:57], 7
    s_cbranch_scc1 Ls_na2
    s_add_u32 s35, s35, s31
    s_xor_b32 s31, s31, 0x63ff800
Ls_na2:
    s_bitcmp0_b64 s[56:57], 4
    s_cbranch_scc1 Ls_evd2
Ls_e12:
    s_sub_u32 s61, s61, 1
    s_cbranch_scc1 Ls_last2
    v_mul_u32_u24 v216, v224, v241
    v_mul_u32_u24 v217, v224, v242
    v_mul_u32_u24 v218, v225, v241
    v_mul_u32_u24 v219, v225, v242
    v_mul_u32_u24 v220, v226, v241
    v_mul_u32_u24 v221, v226, v242
    v_mul_u32_u24 v222, v227, v241
    v_mul_u32_u24 v223, v227, v242
    v_add_u32 v238, 128, v238
    ds_read_b128 v[164:167], v239
    v_mfma_f32_4x4x4_16b_bf16 v[132:135], v[216:217], v[68:69], v[4:7]
    ds_read_b128 v[168:171], v239 offset:64
    ds_read_b128 v[172:175], v239 offset:128
    v_mfma_f32_4x4x4_16b_bf16 v[136:139], v[218:219], v[70:71], v[8:11]
    ds_read_b128 v[176:179], v239 offset:192
    ds_read_u16 v224, v238
    v_mfma_f32_4x4x4_16b_bf16 v[140:143], v[220:221], v[72:73], v[12:15]
    ds_read_u16 v225, v238 offset:8
    ds_read_u16 v226, v238 offset:64
    v_mfma_f32_4x4x4_16b_bf16 v[144:147], v[222:223], v[74:75], v[16:19]
    ds_read_u16 v227, v238 offset:72
    v_add_u32 v239, 272, v239
    v_mfma_f32_4x4x4_16b_bf16 v[246:249], v[216:217], v[76:77], v[20:23]
    v_cvt_pk_bf16_f32 v100, v132, v133
    v_cvt_pk_bf16_f32 v101, v134, v135
    v_mfma_f32_4x4x4_16b_bf16 v[250:253], v[218:219], v[78:79], v[24:27]
    v_cvt_pk_bf16_f32 v102, v136, v137
    v_cvt_pk_bf16_f32 v103, v138, v139
    v_mfma_f32_4x4x4_16b_bf16 v[132:135], v[220:221], v[80:81], v[28:31]
    v_cvt_pk_bf16_f32 v104, v140, v141
    v_cvt_pk_bf16_f32 v105, v142, v143
    v_mfma_f32_4x4x4_16b_bf16 v[136:139], v[222:223], v[82:83], v[32:35]
    v_cvt_pk_bf16_f32 v106, v144, v145
    v_cvt_pk_bf16_f32 v107, v146, v147
    v_mfma_f32_4x4x4_16b_bf16 v[140:143], v[216:217], v[84:85], v[36:39]
    v_cvt_pk_bf16_f32 v108, v246, v247
    v_cvt_pk_bf16_f32 v109, v248, v249
    v_mfma_f32_4x4x4_16b_bf16 v[144:147], v[218:219], v[86:87], v[40:43]
    v_cvt_pk_bf16_f32 v110, v250, v251
    v_cvt_pk_bf16_f32 v111, v252, v253
    v_mfma_f32_4x4x4_16b_bf16 v[246:249], v[220:221], v[88:89], v[44:47]
    v_cvt_pk_bf16_f32 v112, v132, v133
    v_cvt_pk_bf16_f32 v113, v134, v135
    v_mfma_f32_4x4x4_16b_bf16 v[250:253], v[222:223], v[90:91], v[48:51]
    v_cvt_pk_bf16_f32 v114, v136, v137
    v_cvt_pk_bf16_f32 v115, v138, v139
    v_mfma_f32_4x4x4_16b_bf16 v[132:135], v[216:217], v[92:93], v[52:55]
    v_cvt_pk_bf16_f32 v116, v140, v141
    v_cvt_pk_bf16_f32 v117, v142, v143
    v_mfma_f32_4x4x4_16b_bf16 v[136:139], v[218:219], v[94:95], v[56:59]
    v_cvt_pk_bf16_f32 v118, v144, v145
    v_cvt_pk_bf16_f32 v119, v146, v147
    v_mfma_f32_4x4x4_16b_bf16 v[140:143], v[220:221], v[96:97], v[60:63]
    v_cvt_pk_bf16_f32 v120, v246, v247
    v_cvt_pk_bf16_f32 v121, v248, v249
    v_mfma_f32_4x4x4_16b_bf16 v[144:147], v[222:223], v[98:99], v[64:67]
    v_cvt_pk_bf16_f32 v122, v250, v251
    v_cvt_pk_bf16_f32 v123, v252, v253
    v_cvt_pk_bf16_f32 v124, v132, v133
    v_cvt_pk_bf16_f32 v125, v134, v135
    v_cvt_pk_bf16_f32 v126, v136, v137
    v_cvt_pk_bf16_f32 v127, v138, v139
    v_cvt_pk_bf16_f32 v128, v140, v141
    v_cvt_pk_bf16_f32 v129, v142, v143
    v_cvt_pk_bf16_f32 v130, v144, v145
    v_cvt_pk_bf16_f32 v131, v146, v147
    s_waitcnt lgkmcnt(0)
    s_branch Ls_evd2
Ls_ev3:
    s_bitcmp0_b64 s[56:57], 3
    s_cbranch_scc1 Ls_nf3
    v_cvt_pk_bf16_f32 v246, v212, v212
    v_mov_b32 v212, 0
    ds_write_b16 v240, v246
    v_add_u32 v240, 128, v240
    s_add_u32 s24, s24, s32
    s_addc_u32 s25, s25, 0
    s_xor_b32 s32, s32, 0x18ffe0
Ls_nf3:
    s_bitcmp0_b64 s[56:57], 8
    s_cbranch_scc1 Ls_na3
    s_add_u32 s35, s35, s31
    s_xor_b32 s31, s31, 0x63ff800
Ls_na3:
    s_bitcmp0_b64 s[56:57], 5
    s_cbranch_scc1 Ls_evd3
Ls_e13:
    s_sub_u32 s61, s61, 1
    s_cbranch_scc1 Ls_last3
    v_mul_u32_u24 v216, v224, v241
    v_mul_u32_u24 v217, v224, v242
    v_mul_u32_u24 v218, v225, v241
    v_mul_u32_u24 v219, v225, v242
    v_mul_u32_u24 v220, v226, v241
    v_mul_u32_u24 v221, v226, v242
    v_mul_u32_u24 v222, v227, v241
    v_mul_u32_u24 v223, v227, v242
    v_add_u32 v238, 128, v238
    ds_read_b128 v[164:167], v239
    v_mfma_f32_4x4x4_16b_bf16 v[132:135], v[216:217], v[68:69], v[4:7]
    ds_read_b128 v[168:171], v239 offset:64
    ds_read_b128 v[172:175], v239 offset:128
    v_mfma_f32_4x4x4_16b_bf16 v[136:139], v[218:219], v[70:71], v[8:11]
    ds_read_b128 v[176:179], v239 offset:192
    ds_read_u16 v224, v238
    v_mfma_f32_4x4x4_16b_bf16 v[140:143], v[220:221], v[72:73], v[12:15]
    ds_read_u16 v225, v238 offset:8
    ds_read_u16 v226, v238 offset:64
    v_mfma_f32_4x4x4_16b_bf16 v[144:147], v[222:223], v[74:75], v[16:19]
    ds_read_u16 v227, v238 offset:72
    v_add_u32 v239, 272, v239
    v_mfma_f32_4x4x4_16b_bf16 v[246:249], v[216:217], v[76:77], v[20:23]
    v_cvt_pk_bf16_f32 v100, v132, v133
    v_cvt_pk_bf16_f32 v101, v134, v135
    v_mfma_f32_4x4x4_16b_bf16 v[250:253], v[218:219], v[78:79], v[24:27]
    v_cvt_pk_bf16_f32 v102, v136, v137
    v_cvt_pk_bf16_f32 v103, v138, v139
    v_mfma_f32_4x4x4_16b_bf16 v[132:135], v[220:221], v[80:81], v[28:31]
    v_cvt_pk_bf16_f32 v104, v140, v141
    v_cvt_pk_bf16_f32 v105, v142, v143
    v_mfma_f32_4x4x4_16b_bf16 v[136:139], v[222:223], v[82:83], v[32:35]
    v_cvt_pk_bf16_f32 v106, v144, v145
    v_cvt_pk_bf16_f32 v107, v146, v147
    v_mfma_f32_4x4x4_16b_bf16 v[140:143], v[216:217], v[84:85], v[36:39]
    v_cvt_pk_bf16_f32 v108, v246, v247
    v_cvt_pk_bf16_f32 v109, v248, v249
    v_mfma_f32_4x4x4_16b_bf16 v[144:147], v[218:219], v[86:87], v[40:43]
    v_cvt_pk_bf16_f32 v110, v250, v251
    v_cvt_pk_bf16_f32 v111, v252, v253
    v_mfma_f32_4x4x4_16b_bf16 v[246:249], v[220:221], v[88:89], v[44:47]
    v_cvt_pk_bf16_f32 v112, v132, v133
    v_cvt_pk_bf16_f32 v113, v134, v135
    v_mfma_f32_4x4x4_16b_bf16 v[250:253], v[222:223], v[90:91], v[48:51]
    v_cvt_pk_bf16_f32 v114, v136, v137
    v_cvt_pk_bf16_f32 v115, v138, v139
    v_mfma_f32_4x4x4_16b_bf16 v[132:135], v[216:217], v[92:93], v[52:55]
    v_cvt_pk_bf16_f32 v116, v140, v141
    v_cvt_pk_bf16_f32 v117, v142, v143
    v_mfma_f32_4x4x4_16b_bf16 v[136:139], v[218:219], v[94:95], v[56:59]
    v_cvt_pk_bf16_f32 v118, v144, v145
    v_cvt_pk_bf16_f32 v119, v146, v147
    v_mfma_f32_4x4x4_16b_bf16 v[140:143], v[220:221], v[96:97], v[60:63]
    v_cvt_pk_bf16_f32 v120, v246, v247
    v_cvt_pk_bf16_f32 v121, v248, v249
    v_mfma_f32_4x4x4_16b_bf16 v[144:147], v[222:223], v[98:99], v[64:67]
    v_cvt_pk_bf16_f32 v122, v250, v251
    v_cvt_pk_bf16_f32 v123, v252, v253
    v_cvt_pk_bf16_f32 v124, v132, v133
    v_cvt_pk_bf16_f32 v125, v134, v135
    v_cvt_pk_bf16_f32 v126, v136, v137
    v_cvt_pk_bf16_f32 v127, v138, v139
    v_cvt_pk_bf16_f32 v128, v140, v141
    v_cvt_pk_bf16_f32 v129, v142, v143
    v_cvt_pk_bf16_f32 v130, v144, v145
    v_cvt_pk_bf16_f32 v131, v146, v147
    s_waitcnt lgkmcnt(0)
    s_branch Ls_evd3
Ls_last0:
    s_branch Ls_tail
Ls_last1:
    v_add_u32 v236, 2080, v236
    s_lshr_b64 s[56:57], s[56:57], 1
    v_add_u32 v244, 16, v244
    s_branch Ls_tail
Ls_last2:
    v_add_u32 v236, 4160, v236
    s_lshr_b64 s[56:57], s[56:57], 2
    v_add_u32 v244, 32, v244
    s_branch Ls_tail
Ls_last3:
    v_add_u32 v236, 6240, v236
    s_lshr_b64 s[56:57], s[56:57], 3
    v_add_u32 v244, 48, v244
Ls_tail:
    ds_read_b32 v246, v244 offset:0
    s_waitcnt lgkmcnt(0)
    v_bfe_u32 v247, v246, 0, 8
    v_lshlrev_b32 v247, 1, v247
    v_bfe_u32 v248, v246, 8, 8
    v_lshlrev_b32 v248, 1, v248
    v_bfe_u32 v249, v246, 16, 8
    v_lshlrev_b32 v249, 1, v249
    v_bfe_u32 v250, v246, 24, 8
    v_lshlrev_b32 v250, 1, v250
    buffer_load_ushort v247, v247, s[24:27], 0 offen
    buffer_load_ushort v248, v248, s[24:27], 0 offen
    buffer_load_ushort v249, v249, s[24:27], 0 offen
    buffer_load_ushort v250, v250, s[24:27], 0 offen
    s_waitcnt vmcnt(0)
    v_lshlrev_b32 v247, 16, v247
    v_mul_f32 v208, v208, v247
    v_lshlrev_b32 v248, 16, v248
    v_mul_f32 v209, v209, v248
    v_lshlrev_b32 v249, 16, v249
    v_mul_f32 v210, v210, v249
    v_lshlrev_b32 v250, 16, v250
    v_mul_f32 v211, v211, v250
    v_exp_f32 v132, v148
    v_exp_f32 v133, v149
    v_exp_f32 v134, v150
    v_exp_f32 v135, v151
    v_exp_f32 v136, v152
    v_exp_f32 v137, v153
    v_mfma_f32_4x4x4_16b_bf16 v[132:135], v[228:229], v[228:229], v[132:135]
    v_cvt_pk_bf16_f32 v208, v208, v209
    v_cvt_pk_bf16_f32 v209, v210, v211
    v_exp_f32 v138, v154
    s_nop 0
    v_mfma_f32_4x4x4_16b_bf16 v[212:215], v[208:209], v[188:189], v[212:215] cbsz:4 abid:0
    ds_read_b64_tr_b16 v[188:189], v236 offset:0
    v_exp_f32 v139, v155
    v_exp_f32 v140, v156
    v_mfma_f32_4x4x4_16b_bf16 v[212:215], v[208:209], v[190:191], v[212:215] cbsz:4 abid:4
    ds_read_b64_tr_b16 v[190:191], v236 offset:512
    v_mfma_f32_4x4x4_16b_bf16 v[136:139], v[228:229], v[228:229], v[136:139]
    v_rcp_f32 v132, v132
    v_mfma_f32_4x4x4_16b_bf16 v[212:215], v[208:209], v[192:193], v[212:215] cbsz:4 abid:8
    ds_read_b64_tr_b16 v[192:193], v236 offset:1056
    v_exp_f32 v141, v157
    v_rcp_f32 v133, v133
    v_mfma_f32_4x4x4_16b_bf16 v[212:215], v[208:209], v[194:195], v[212:215] cbsz:4 abid:12
    ds_read_b64_tr_b16 v[194:195], v236 offset:1568
    v_exp_f32 v142, v158
    v_rcp_f32 v134, v134
    v_exp_f32 v143, v159
    v_rcp_f32 v135, v135
    v_cvt_pk_bf16_f32 v132, v132, v133
    v_mfma_f32_4x4x4_16b_bf16 v[140:143], v[228:229], v[228:229], v[140:143]
    v_exp_f32 v144, v160
    v_rcp_f32 v136, v136
    v_cvt_pk_bf16_f32 v133, v134, v135
    s_bitcmp0_b64 s[56:57], 1
    s_cbranch_scc1 Ls_tnf
    v_cvt_pk_bf16_f32 v246, v212, v212
    v_mov_b32 v212, 0
    ds_write_b16 v240, v246
    v_add_u32 v240, 128, v240
    s_add_u32 s24, s24, s32
    s_addc_u32 s25, s25, 0
    s_xor_b32 s32, s32, 0x18ffe0
Ls_tnf:
    s_waitcnt lgkmcnt(0)
    v_exp_f32 v145, v161
    v_rcp_f32 v137, v137
    v_exp_f32 v146, v162
    v_rcp_f32 v138, v138
    v_cvt_pk_bf16_f32 v134, v136, v137
    v_exp_f32 v147, v163
    v_rcp_f32 v139, v139
    s_nop 0
    v_mfma_f32_4x4x4_16b_bf16 v[144:147], v[228:229], v[228:229], v[144:147]
    v_rcp_f32 v140, v140
    v_rcp_f32 v141, v141
    v_cvt_pk_bf16_f32 v135, v138, v139
    v_rcp_f32 v142, v142
    v_cvt_pk_bf16_f32 v136, v140, v141
    v_mfma_f32_16x16x32_bf16 v[208:211], v[132:135], v[196:199], v[204:207]
    v_rcp_f32 v143, v143
    v_rcp_f32 v144, v144
    v_cvt_pk_bf16_f32 v137, v142, v143
    v_rcp_f32 v145, v145
    v_rcp_f32 v146, v146
    v_rcp_f32 v147, v147
    v_cvt_pk_bf16_f32 v138, v144, v145
    v_cvt_pk_bf16_f32 v139, v146, v147
    s_nop 1
    v_mfma_f32_16x16x32_bf16 v[208:211], v[136:139], v[200:203], v[208:211]
    ds_read_b32 v246, v244 offset:16
    s_waitcnt lgkmcnt(0)
    v_bfe_u32 v247, v246, 0, 8
    v_lshlrev_b32 v247, 1, v247
    v_bfe_u32 v248, v246, 8, 8
    v_lshlrev_b32 v248, 1, v248
    v_bfe_u32 v249, v246, 16, 8
    v_lshlrev_b32 v249, 1, v249
    v_bfe_u32 v250, v246, 24, 8
    v_lshlrev_b32 v250, 1, v250
    buffer_load_ushort v247, v247, s[24:27], 0 offen
    buffer_load_ushort v248, v248, s[24:27], 0 offen
    buffer_load_ushort v249, v249, s[24:27], 0 offen
    buffer_load_ushort v250, v250, s[24:27], 0 offen
    s_waitcnt vmcnt(0)
    v_lshlrev_b32 v247, 16, v247
    v_mul_f32 v208, v208, v247
    v_lshlrev_b32 v248, 16, v248
    v_mul_f32 v209, v209, v248
    v_lshlrev_b32 v249, 16, v249
    v_mul_f32 v210, v210, v249
    v_lshlrev_b32 v250, 16, v250
    v_mul_f32 v211, v211, v250
    v_cvt_pk_bf16_f32 v208, v208, v209
    v_cvt_pk_bf16_f32 v209, v210, v211
    s_nop 1
    v_mfma_f32_4x4x4_16b_bf16 v[212:215], v[208:209], v[188:189], v[212:215] cbsz:4 abid:0
    s_nop 1
    v_mfma_f32_4x4x4_16b_bf16 v[212:215], v[208:209], v[190:191], v[212:215] cbsz:4 abid:4
    s_nop 1
    v_mfma_f32_4x4x4_16b_bf16 v[212:215], v[208:209], v[192:193], v[212:215] cbsz:4 abid:8
    s_nop 1
    v_mfma_f32_4x4x4_16b_bf16 v[212:215], v[208:209], v[194:195], v[212:215] cbsz:4 abid:12
    s_nop 4
    v_cvt_pk_bf16_f32 v246, v212, v212
    ds_write_b16 v240, v246
    s_branch L_store
.section .rodata,"a"
.p2align 6
.amdhsa_kernel standalone__sequential_behavior_din__recsys_kernel
  .amdhsa_next_free_vgpr 256
  .amdhsa_next_free_sgpr 102
  .amdhsa_accum_offset 256
  .amdhsa_group_segment_fixed_size 0
  .amdhsa_kernarg_size 80
  .amdhsa_user_sgpr_count 2
  .amdhsa_user_sgpr_kernarg_segment_ptr 1
  .amdhsa_system_sgpr_workgroup_id_x 1
.end_amdhsa_kernel
```

```asm
; @launch grid=(256,1,1) block=(512,1,1) lds=163840
.amdgcn_target "amdgcn-amd-amdhsa--gfx950"
.text
.globl standalone__sequential_behavior_din__recsys_kernel
.p2align 8
.type standalone__sequential_behavior_din__recsys_kernel,@function
standalone__sequential_behavior_din__recsys_kernel:
    s_load_dwordx16 s[4:19], s[0:1], 0
    s_cmp_ge_u32 s2, 256
    s_cbranch_scc1 L_end
    v_lshrrev_b32 v1, 6, v0
    v_and_b32 v0, 63, v0
    v_readfirstlane_b32 s54, v1
    s_lshl_b32 s53, s2, 3
    v_lshlrev_b32 v2, 4, v0
    v_lshrrev_b32 v1, 4, v0
    v_and_b32 v3, 0xf0, v2
    v_lshlrev_b32 v3, 2, v3
    v_lshl_add_u32 v130, v1, 4, v3
    v_bfrev_b32 v3, 1
    s_add_u32 s53, s53, s54
    s_movk_i32 s66, 800
    v_cmp_gt_u32 vcc, s66, v130
    s_mul_i32 s93, s53, 800
    s_mul_i32 s52, s54, 20480
    s_mov_b64 s[28:29], vcc
    v_cndmask_b32 v3, v3, v130, vcc
    v_and_b32 v248, 16, v0
    v_lshlrev_b32 v246, 1, v248
    v_xor_b32 v246, v246, v2
    s_lshl_b32 s67, s54, 12
    s_add_u32 m0, s52, 4160
    s_mov_b32 s26, 6553600
    s_mov_b32 s27, 0x20000
    s_waitcnt lgkmcnt(0)
    s_mov_b32 s24, s8
    s_and_b32 s25, s9, 0xffff
    s_cmp_ge_u32 s54, 4
    s_cbranch_scc1 L_young0
    buffer_load_dwordx4 v[100:103], v3, s[24:27], s93 offen nt
L_young0:
    s_add_u32 s10, s10, s67
    s_addc_u32 s11, s11, 0
    v_xor_b32 v247, 64, v246
    global_load_lds_dwordx4 v246, s[10:11] offset:0
    global_load_lds_dwordx4 v247, s[10:11] offset:1024
    global_load_lds_dwordx4 v246, s[10:11] offset:2048
    global_load_lds_dwordx4 v247, s[10:11] offset:3072
    s_load_dword s30, s[16:17], 0
    v_and_b32 v243, 0xf0, v2
    v_lshl_add_u32 v243, v1, 19, v243
    s_lshl_b32 s66, s53, 8
    s_add_u32 m0, s52, 8320
    v_add_u32 v243, s66, v243
    s_and_b32 s67, s54, 3
    global_load_lds_dwordx4 v243, s[4:5] nt
    v_and_b32 v250, 3, v0
    s_mov_b32 s20, s6
    s_and_b32 s21, s7, 0xffff
    s_or_b32 s21, s21, 0x800000
    s_mov_b32 s22, 200
    s_mov_b32 s23, 0x20000
    s_sub_u32 s40, s20, 1056
    s_subb_u32 s41, s21, 0
    s_mov_b32 s42, 200
    s_mov_b32 s43, 0x20000
    s_mul_i32 s35, s53, 51200
    s_movk_i32 s31, 25600
    s_mov_b64 s[56:57], 0
    s_mov_b64 s[58:59], 0
    v_mov_b32 v148, -1
    v_mov_b32 v149, -1
    v_mov_b32 v150, -1
    v_mov_b32 v151, -1
    s_add_u32 s66, s52, 18432
    v_add_u32 v152, s66, v2
    ds_write_b128 v152, v[148:151]
    ds_write_b128 v152, v[148:151] offset:1024
    s_add_u32 s64, s52, 18448
    v_mov_b32 v153, -1
    v_mov_b32 v154, -1
    v_mov_b32 v155, -1
    v_lshrrev_b32 v237, 3, v0
    v_add_u32 v237, s64, v237
    v_lshl_add_u32 v244, v1, 2, s66
    v_and_b32 v231, 0x70, v2
    v_lshlrev_b32 v248, 2, v248
    v_xor_b32 v231, v231, v248
    v_mov_b32 v233, v231
    s_movk_i32 s66, 400
    v_cmp_le_u32 vcc, s66, v130
    v_lshrrev_b32 v126, 1, v130
    s_movk_i32 s66, -200
    v_cndmask_b32 v130, 0, 1, vcc
    v_mad_i32_i24 v126, v130, s66, v126
    v_mul_u32_u24 v127, 0x10001, v126
    v_add_u32 v126, 0x10000, v127
    v_add_u32 v128, 0x50004, v127
    v_add_u32 v129, 0x70006, v127
    v_add_u32 v127, 0x30002, v127
    v_mov_b32 v131, 0xbfe0bfe0
    s_mov_b32 s86, 0xfff0ffff
    s_mov_b32 s87, 0xf000ff00
    s_mov_b32 s88, 0xff00fff0
    s_mov_b32 s89, 0xf000
    s_mov_b32 s90, 0xf0000f
    s_mov_b32 s91, 0xf0000f00
    s_mov_b32 s84, 0x11111113
    s_mov_b32 s85, 0x11111111
    v_cndmask_b32 v116, 0, v131, s[86:87]
    v_cndmask_b32 v120, 0, v131, s[88:89]
    v_cndmask_b32 v117, 0, v131, s[86:87]
    v_cndmask_b32 v121, 0, v131, s[88:89]
    v_cndmask_b32 v122, 0, v131, s[84:85]
    v_cndmask_b32 v123, 0, v131, s[84:85]
    v_cndmask_b32 v124, 0, v131, s[84:85]
    v_cndmask_b32 v125, 0, v131, s[84:85]
    v_lshlrev_b32 v246, 4, v250
    v_sub_u32 v246, 48, v246
    s_mov_b32 s86, 0xbfe0bfe0
    s_mov_b32 s87, 0xf0bfe0
    v_lshrrev_b64 v[118:119], v246, s[86:87]
    v_mov_b32 v131, 0
    s_mov_b64 s[84:85], 0
    v_cndmask_b32 v118, v120, v118, s[90:91]
    v_cndmask_b32 v119, v121, v119, s[90:91]
    s_mov_b32 s61, 7
    s_mov_b32 s92, 0xbfb8aa3b
    v_and_b32 v251, 15, v0
    v_bfe_u32 v252, v0, 2, 2
    v_lshlrev_b32 v253, 3, v250
    v_lshl_add_u32 v253, v252, 7, v253
    v_and_b32 v246, 24, v0
    v_lshlrev_b32 v246, 2, v246
    v_xor_b32 v246, v253, v246
    v_lshl_add_u32 v246, v1, 10, v246
    s_lshl_b32 s66, s67, 5
    v_xor_b32 v66, s66, v246
    v_add_u32 v66, 45120, v66
    s_lshr_b32 s66, s54, 1
    s_lshl_b32 s66, s66, 5
    v_xor_b32 v64, s66, v246
    s_and_b32 s66, s54, 1
    s_mul_i32 s66, s66, 20480
    s_add_u32 s66, s66, 4160
    v_add_u32 v64, s66, v64
    v_add_u32 v65, 81920, v64
    s_and_b32 s66, s54, 4
    v_lshrrev_b32 v246, 3, v251
    v_add_u32 v246, s66, v246
    v_mul_u32_u24 v246, 20480, v246
    v_lshl_add_u32 v246, v1, 4, v246
    v_and_b32 v247, 7, v0
    v_lshl_add_u32 v67, v247, 7, v246
    v_and_b32 v247, 1, v0
    v_lshlrev_b32 v247, 4, v247
    v_lshlrev_b32 v247, v247, 1
    v_cmp_gt_u32 vcc, 2, v250
    v_mov_b32 v229, 0
    v_mov_b32 v228, 0x3f80
    v_cndmask_b32 v241, 0, v247, vcc
    v_cmp_eq_u32 vcc, 0, v251
    v_sub_u32 v242, v247, v241
    v_mul_u32_u24 v218, 0x3f80, v241
    v_cndmask_b32 v220, 0, -1, vcc
    v_mul_u32_u24 v219, 0x3f80, v242
    s_and_b32 s66, s54, 3
    s_lshl_b32 s66, s66, 6
    s_add_u32 s66, s66, 9344
    v_and_b32 v247, 7, v0
    v_mul_u32_u24 v247, 144, v247
    v_add3_u32 v98, v67, v247, s66
    s_add_u32 s66, s52, 14592
    v_lshl_add_u32 v221, v0, 2, s66
    ds_write_b32 v221, v229
    s_xor_b32 s66, s54, 4
    s_mul_i32 s66, s66, 20480
    s_add_u32 s66, s66, 14592
    v_writelane_b32 v221, s66, 1
    v_and_b32 v247, 8, v0
    v_lshlrev_b32 v247, 2, v247
    v_lshl_add_u32 v247, v251, 7, v247
    v_add_u32 v247, s52, v247
    v_and_b32 v248, 2, v0
    v_lshlrev_b32 v248, 1, v248
    v_xor_b32 v248, v248, v1
    v_lshl_add_u32 v234, v248, 4, v247
    v_xor_b32 v248, 4, v248
    v_lshl_add_u32 v235, v248, 4, v247
    v_and_b32 v247, 8, v0
    v_lshlrev_b32 v247, 3, v247
    v_lshl_add_u32 v248, v1, 5, v253
    v_xor_b32 v248, v248, v247
    v_add_u32 v236, s52, v248
    s_add_u32 s66, s52, 8320
    v_lshl_add_u32 v238, v250, 1, s66
    v_lshl_add_u32 v238, v1, 4, v238
    v_lshl_add_u32 v240, v0, 1, s66
    s_add_u32 s66, s52, 9344
    v_lshl_add_u32 v239, v1, 4, s66
    v_mov_b32 v188, 0
    v_mov_b32 v189, 0
    v_mov_b32 v190, 0
    v_mov_b32 v191, 0
    v_mov_b32 v192, 0
    v_mov_b32 v193, 0
    v_mov_b32 v194, 0
    v_mov_b32 v195, 0
    v_mov_b32 v208, 0
    v_mov_b32 v212, 0
    v_mov_b32 v209, 0
    v_mov_b32 v213, 0
    v_mov_b32 v210, 0
    v_mov_b32 v214, 0
    v_mov_b32 v211, 0
    v_mov_b32 v215, 0
    s_and_b32 s66, s54, 3
    s_lshl_b32 s66, s66, 5
    v_lshl_add_u32 v249, v1, 3, s66
    global_load_dwordx2 v[96:97], v249, s[12:13]
    s_cmp_ge_u32 s54, 4
    s_cbranch_scc0 L_old3z
    buffer_load_dwordx4 v[100:103], v3, s[24:27], s93 offen nt
L_old3z:
    s_cmp_ge_u32 s54, 4
    s_cbranch_scc1 L_young1
    s_waitcnt vmcnt(6) lgkmcnt(0)
    s_call_b64 s[62:63], L_fp
    s_waitcnt vmcnt(5)
    s_branch L_old1
L_young1:
    s_waitcnt vmcnt(2)
L_old1:
    s_waitcnt lgkmcnt(0)
    s_barrier
    ds_read_b64_tr_b16 v[16:17], v66 offset:0
    ds_read_b64_tr_b16 v[18:19], v66 offset:512
    ds_read_b64_tr_b16 v[20:21], v66 offset:20480
    ds_read_b64_tr_b16 v[22:23], v66 offset:20992
    ds_read_b64_tr_b16 v[24:25], v66 offset:40960
    ds_read_b64_tr_b16 v[26:27], v66 offset:41472
    ds_read_b64_tr_b16 v[28:29], v66 offset:61440
    ds_read_b64_tr_b16 v[30:31], v66 offset:61952
    ds_read_b128 v[32:35], v67 offset:8320
    ds_read_b128 v[36:39], v67 offset:8384
    ds_read_b128 v[40:43], v67 offset:49280
    ds_read_b128 v[44:47], v67 offset:49344
    ds_read_b64_tr_b16 v[4:5], v64 offset:0
    ds_read_b64_tr_b16 v[8:9], v65 offset:0
    ds_read_b64_tr_b16 v[12:13], v65 offset:40960
    ds_read_b64_tr_b16 v[6:7], v64 offset:512
    ds_read_b64_tr_b16 v[10:11], v65 offset:512
    ds_read_b64_tr_b16 v[14:15], v65 offset:41472
    s_cmp_ge_u32 s54, 4
    s_cbranch_scc1 L_young2
    s_waitcnt vmcnt(4)
    s_branch L_old2
L_young2:
    s_waitcnt vmcnt(1)
L_old2:
    s_add_u32 s93, s93, 1638400
    buffer_load_dwordx4 v[104:107], v3, s[24:27], s93 offen nt
    s_add_u32 s93, s93, 1638400
    buffer_load_dwordx4 v[108:111], v3, s[24:27], s93 offen nt
    s_add_u32 s93, s93, 1638400
    buffer_load_dwordx4 v[112:115], v3, s[24:27], s93 offen nt
    v_lshlrev_b32 v249, 3, v1
    v_lshl_add_u32 v249, v250, 5, v249
    global_load_dwordx2 v[216:217], v249, s[14:15]
    v_lshlrev_b32 v48, 16, v96
    v_and_b32 v49, 0xffff0000, v96
    v_lshlrev_b32 v50, 16, v97
    v_and_b32 v51, 0xffff0000, v97
    s_lshl_b32 s30, s30, 16
    v_and_b32 v204, s30, v220
    v_and_b32 v205, s30, v220
    v_and_b32 v206, s30, v220
    v_and_b32 v207, s30, v220
    s_waitcnt lgkmcnt(0)
    v_xor_b32 v24, 0x80008000, v24
    v_xor_b32 v25, 0x80008000, v25
    v_xor_b32 v26, 0x80008000, v26
    v_xor_b32 v27, 0x80008000, v27
    v_xor_b32 v28, 0x80008000, v28
    v_xor_b32 v29, 0x80008000, v29
    v_xor_b32 v30, 0x80008000, v30
    v_xor_b32 v31, 0x80008000, v31
    v_mfma_f32_4x4x4_16b_bf16 v[56:59], v[218:219], v[4:5], 0
    v_mfma_f32_4x4x4_16b_bf16 v[68:71], v[218:219], v[12:13], 0
    v_mfma_f32_4x4x4_16b_bf16 v[60:63], v[218:219], v[6:7], 0
    v_mfma_f32_4x4x4_16b_bf16 v[72:75], v[218:219], v[14:15], 0
    v_mfma_f32_4x4x4_16b_bf16 v[56:59], v[218:219], v[8:9], v[56:59]
    v_mfma_f32_4x4x4_16b_bf16 v[60:63], v[218:219], v[10:11], v[60:63]
    v_mfma_f32_16x16x32_bf16 v[52:55], v[16:19], v[40:43], v[48:51]
    v_mfma_f32_16x16x32_bf16 v[52:55], v[20:23], v[44:47], v[52:55]
    v_mfma_f32_16x16x32_bf16 v[52:55], v[24:27], v[40:43], v[52:55]
    v_mfma_f32_16x16x32_bf16 v[52:55], v[28:31], v[44:47], v[52:55]
    v_mfma_f32_16x16x32_bf16 v[48:51], v[16:19], v[32:35], v[48:51]
    v_mfma_f32_16x16x32_bf16 v[48:51], v[20:23], v[36:39], v[48:51]
    v_mfma_f32_16x16x32_bf16 v[48:51], v[24:27], v[32:35], v[48:51]
    v_mfma_f32_16x16x32_bf16 v[48:51], v[28:31], v[36:39], v[48:51]
    v_mul_f32 v56, s92, v56
    v_mul_f32 v57, s92, v57
    v_mul_f32 v58, s92, v58
    v_mul_f32 v59, s92, v59
    v_mul_f32 v60, s92, v60
    v_mul_f32 v61, s92, v61
    v_mul_f32 v62, s92, v62
    v_mul_f32 v63, s92, v63
    v_mul_f32 v68, s92, v68
    v_mul_f32 v69, s92, v69
    v_mul_f32 v70, s92, v70
    v_mul_f32 v71, s92, v71
    v_mul_f32 v72, s92, v72
    v_mul_f32 v73, s92, v73
    v_mul_f32 v74, s92, v74
    v_mul_f32 v75, s92, v75
    s_add_u32 s66, s52, 11520
    v_add_u32 v3, s66, v2
    v_cvt_pk_bf16_f32 v68, v68, v69
    v_cvt_pk_bf16_f32 v69, v70, v71
    v_cvt_pk_bf16_f32 v70, v72, v73
    v_cvt_pk_bf16_f32 v71, v74, v75
    v_mul_f32 v48, s92, v48
    v_mul_f32 v49, s92, v49
    v_mul_f32 v50, s92, v50
    v_mul_f32 v51, s92, v51
    v_mul_f32 v52, s92, v52
    v_mul_f32 v53, s92, v53
    v_mul_f32 v54, s92, v54
    v_mul_f32 v55, s92, v55
    ds_write_b128 v3, v[56:59]
    ds_write_b128 v3, v[60:63] offset:1024
    ds_write_b128 v3, v[68:71] offset:2048
    ds_write_b128 v98, v[48:51]
    ds_write_b128 v98, v[52:55] offset:40960
    v_add_u32 v3, 11520, v2
    v_add_u32 v246, 81920, v3
    s_waitcnt lgkmcnt(0)
    s_barrier
    s_cmp_ge_u32 s54, 4
    s_cbranch_scc0 L_old3
    s_waitcnt vmcnt(4)
    s_call_b64 s[62:63], L_fp
    s_branch L_yng3
L_old3:
    s_call_b64 s[62:63], L_t23
L_yng3:
    ds_read_b128 v[4:7], v3 offset:0
    ds_read_b128 v[8:11], v3 offset:1024
    ds_read_b128 v[68:71], v3 offset:2048
    ds_read_b128 v[12:15], v3 offset:20480
    ds_read_b128 v[16:19], v3 offset:21504
    ds_read_b128 v[72:75], v3 offset:22528
    ds_read_b128 v[20:23], v3 offset:40960
    ds_read_b128 v[24:27], v3 offset:41984
    ds_read_b128 v[76:79], v3 offset:43008
    s_waitcnt vmcnt(4)
    v_mfma_i32_16x16x64_i8 v[172:175], v[122:125], v[104:107], 0
    v_mfma_i32_16x16x64_i8 v[176:179], v[122:125], v[108:111], 0
    v_mfma_i32_16x16x64_i8 v[180:183], v[122:125], v[112:115], 0
    v_and_b32 v160, 0x800080, v104
    v_mul_u32_u24 v160, 0x7f, v160
    v_bitop3_b32 v131, v104, v160, v131 bitop3:0xbe
    v_and_b32 v161, 0x800080, v105
    v_mul_u32_u24 v161, 0x7f, v161
    v_bitop3_b32 v131, v105, v161, v131 bitop3:0xbe
    v_and_b32 v160, 0x800080, v106
    v_mul_u32_u24 v160, 0x7f, v160
    v_bitop3_b32 v131, v106, v160, v131 bitop3:0xbe
    v_mov_b32_dpp v184, v172 row_shr:1 row_mask:0xf bank_mask:0xf bound_ctrl:0
    v_mov_b32_dpp v185, v176 row_shr:1 row_mask:0xf bank_mask:0xf bound_ctrl:0
    v_mov_b32_dpp v186, v180 row_shr:1 row_mask:0xf bank_mask:0xf bound_ctrl:0
    v_add_u32_dpp v184, v184, v184 row_shr:1 row_mask:0xf bank_mask:0xf bound_ctrl:0
    v_add_u32_dpp v185, v185, v185 row_shr:1 row_mask:0xf bank_mask:0xf bound_ctrl:0
    v_add_u32_dpp v186, v186, v186 row_shr:1 row_mask:0xf bank_mask:0xf bound_ctrl:0
    v_add_u32_dpp v184, v184, v184 row_shr:2 row_mask:0xf bank_mask:0xf bound_ctrl:0
    v_add_u32_dpp v185, v185, v185 row_shr:2 row_mask:0xf bank_mask:0xf bound_ctrl:0
    v_add_u32_dpp v186, v186, v186 row_shr:2 row_mask:0xf bank_mask:0xf bound_ctrl:0
    v_add_u32_dpp v184, v184, v184 row_shr:4 row_mask:0xf bank_mask:0xf bound_ctrl:0
    v_add_u32_dpp v185, v185, v185 row_shr:4 row_mask:0xf bank_mask:0xf bound_ctrl:0
    v_add_u32_dpp v186, v186, v186 row_shr:4 row_mask:0xf bank_mask:0xf bound_ctrl:0
    v_add_u32_dpp v184, v184, v184 row_shr:8 row_mask:0xf bank_mask:0xf bound_ctrl:0
    v_add_u32_dpp v185, v185, v185 row_shr:8 row_mask:0xf bank_mask:0xf bound_ctrl:0
    v_add_u32_dpp v186, v186, v186 row_shr:8 row_mask:0xf bank_mask:0xf bound_ctrl:0
    ds_read_b128 v[28:31], v3 offset:61440
    ds_read_b128 v[32:35], v3 offset:62464
    ds_read_b128 v[80:83], v3 offset:63488
    ds_read_b128 v[36:39], v246 offset:0
    ds_read_b128 v[40:43], v246 offset:1024
    ds_read_b128 v[84:87], v246 offset:2048
    v_and_b32 v161, 0x800080, v107
    v_mul_u32_u24 v161, 0x7f, v161
    v_bitop3_b32 v131, v107, v161, v131 bitop3:0xbe
    v_and_b32 v160, 0x800080, v108
    v_mul_u32_u24 v160, 0x7f, v160
    v_bitop3_b32 v131, v108, v160, v131 bitop3:0xbe
    v_and_b32 v161, 0x800080, v109
    v_mul_u32_u24 v161, 0x7f, v161
    v_bitop3_b32 v131, v109, v161, v131 bitop3:0xbe
    v_and_b32 v160, 0x800080, v110
    v_mul_u32_u24 v160, 0x7f, v160
    v_bitop3_b32 v131, v110, v160, v131 bitop3:0xbe
    v_and_b32 v161, 0x800080, v111
    v_mul_u32_u24 v161, 0x7f, v161
    v_bitop3_b32 v131, v111, v161, v131 bitop3:0xbe
    v_and_b32 v160, 0x800080, v112
    v_mul_u32_u24 v160, 0x7f, v160
    v_bitop3_b32 v131, v112, v160, v131 bitop3:0xbe
    v_and_b32 v161, 0x800080, v113
    v_mul_u32_u24 v161, 0x7f, v161
    v_bitop3_b32 v131, v113, v161, v131 bitop3:0xbe
    v_and_b32 v160, 0x800080, v114
    v_mul_u32_u24 v160, 0x7f, v160
    v_bitop3_b32 v131, v114, v160, v131 bitop3:0xbe
    v_and_b32 v161, 0x800080, v115
    v_mul_u32_u24 v161, 0x7f, v161
    v_bitop3_b32 v131, v115, v161, v131 bitop3:0xbe
    v_cmp_ne_u32 vcc, 0, v131
    v_readlane_b32 s68, v184, 6
    v_readlane_b32 s69, v173, 6
    v_readlane_b32 s70, v184, 15
    v_readlane_b32 s72, v185, 6
    v_readlane_b32 s73, v177, 6
    v_readlane_b32 s74, v185, 15
    v_readlane_b32 s76, v186, 6
    v_readlane_b32 s77, v181, 6
    v_readlane_b32 s78, v186, 15
    s_cbranch_vccnz L_general
    s_add_u32 s66, s68, s69
    s_add_u32 s66, s66, s64
    s_add_u32 s67, s66, 15
    s_and_b32 s67, s67, -16
    s_add_u32 s55, s64, 16
    s_max_u32 s67, s67, s55
    s_sub_u32 s66, s67, s66
    v_mad_u32_u24 v184, v130, s66, v184
    s_sub_u32 s55, s64, 2048
    v_add_u32 v172, s55, v184
    v_add_u32 v173, s55, v184
    v_add_u32 v174, s55, v184
    v_add_u32 v175, s55, v184
    s_add_u32 s64, s64, s70
    s_add_u32 s64, s64, s66
    v_mfma_i32_16x16x64_i8 v[132:135], v[118:121], v[104:107], v[172:175]
    v_mfma_i32_16x16x64_i8 v[136:139], v[116:119], v[104:107], v[172:175]
    s_add_u32 s64, s64, 15
    s_and_b32 s64, s64, -16
    s_add_u32 s55, s67, 16
    s_max_u32 s64, s64, s55
    s_lshr_b32 s95, s67, 4
    s_bitset1_b64 s[56:57], s95
    s_lshr_b32 s95, s64, 4
    s_bitset1_b64 s[56:57], s95
    s_add_u32 s66, s72, s73
    s_add_u32 s66, s66, s64
    s_add_u32 s67, s66, 15
    s_and_b32 s67, s67, -16
    s_add_u32 s55, s64, 16
    s_max_u32 s67, s67, s55
    s_sub_u32 s66, s67, s66
    v_mad_u32_u24 v185, v130, s66, v185
    s_sub_u32 s55, s64, 2048
    v_add_u32 v176, s55, v185
    v_add_u32 v177, s55, v185
    v_add_u32 v178, s55, v185
    v_add_u32 v179, s55, v185
    s_add_u32 s64, s64, s74
    s_add_u32 s64, s64, s66
    v_mfma_i32_16x16x64_i8 v[140:143], v[118:121], v[108:111], v[176:179]
    v_mfma_i32_16x16x64_i8 v[144:147], v[116:119], v[108:111], v[176:179]
    s_add_u32 s64, s64, 15
    s_and_b32 s64, s64, -16
    s_add_u32 s55, s67, 16
    s_max_u32 s64, s64, s55
    s_lshr_b32 s95, s67, 4
    s_lshl_b64 s[86:87], 1, s95
    s_bitcmp1_b32 s67, 10
    s_cselect_b64 s[88:89], 0, s[86:87]
    s_cselect_b64 s[90:91], s[86:87], 0
    s_or_b64 s[56:57], s[56:57], s[88:89]
    s_or_b64 s[58:59], s[58:59], s[90:91]
    s_lshr_b32 s95, s64, 4
    s_lshl_b64 s[86:87], 1, s95
    s_bitcmp1_b32 s64, 10
    s_cselect_b64 s[88:89], 0, s[86:87]
    s_cselect_b64 s[90:91], s[86:87], 0
    s_or_b64 s[56:57], s[56:57], s[88:89]
    s_or_b64 s[58:59], s[58:59], s[90:91]
    ds_write_b8 v132, v126
    ds_write_b8_d16_hi v133, v126
    ds_write_b8 v134, v127
    ds_write_b8_d16_hi v135, v127
    ds_write_b8 v136, v128
    ds_write_b8_d16_hi v137, v128
    ds_write_b8 v138, v129
    ds_write_b8_d16_hi v139, v129
    s_add_u32 s66, s76, s77
    s_add_u32 s66, s66, s64
    s_add_u32 s67, s66, 15
    s_and_b32 s67, s67, -16
    s_add_u32 s55, s64, 16
    s_max_u32 s67, s67, s55
    s_sub_u32 s66, s67, s66
    v_mad_u32_u24 v186, v130, s66, v186
    s_sub_u32 s55, s64, 2048
    v_add_u32 v180, s55, v186
    v_add_u32 v181, s55, v186
    v_add_u32 v182, s55, v186
    v_add_u32 v183, s55, v186
    s_add_u32 s64, s64, s78
    s_add_u32 s64, s64, s66
    v_mfma_i32_16x16x64_i8 v[164:167], v[118:121], v[112:115], v[180:183]
    v_mfma_i32_16x16x64_i8 v[168:171], v[116:119], v[112:115], v[180:183]
    s_add_u32 s64, s64, 15
    s_and_b32 s64, s64, -16
    s_add_u32 s55, s67, 16
    s_max_u32 s64, s64, s55
    s_lshr_b32 s95, s67, 4
    s_lshl_b64 s[86:87], 1, s95
    s_bitcmp1_b32 s67, 10
    s_cselect_b64 s[88:89], 0, s[86:87]
    s_cselect_b64 s[90:91], s[86:87], 0
    s_or_b64 s[56:57], s[56:57], s[88:89]
    s_or_b64 s[58:59], s[58:59], s[90:91]
    s_lshr_b32 s95, s64, 4
    s_lshl_b64 s[86:87], 1, s95
    s_bitcmp1_b32 s64, 10
    s_cselect_b64 s[88:89], 0, s[86:87]
    s_cselect_b64 s[90:91], s[86:87], 0
    s_or_b64 s[56:57], s[56:57], s[88:89]
    s_or_b64 s[58:59], s[58:59], s[90:91]
    ds_write_b8 v140, v126
    ds_write_b8_d16_hi v141, v126
    ds_write_b8 v142, v127
    ds_write_b8_d16_hi v143, v127
    ds_write_b8 v144, v128
    ds_write_b8_d16_hi v145, v128
    ds_write_b8 v146, v129
    ds_write_b8_d16_hi v147, v129
    ds_read_b128 v[44:47], v246 offset:20480
    ds_read_b128 v[48:51], v246 offset:21504
    ds_read_b128 v[88:91], v246 offset:22528
    ds_read_b128 v[52:55], v246 offset:40960
    ds_read_b128 v[56:59], v246 offset:41984
    ds_read_b128 v[92:95], v246 offset:43008
    ds_read_b128 v[60:63], v246 offset:61440
    ds_read_b128 v[64:67], v246 offset:62464
    ds_read_b128 v[96:99], v246 offset:63488
    ds_read_u16 v224, v238 offset:0
    ds_read_u16 v225, v238 offset:8
    ds_read_u16 v226, v238 offset:64
    ds_read_u16 v227, v238 offset:72
    ds_write_b8 v164, v126
    ds_write_b8_d16_hi v165, v126
    ds_write_b8 v166, v127
    ds_write_b8_d16_hi v167, v127
    ds_write_b8 v168, v128
    ds_write_b8_d16_hi v169, v128
    ds_write_b8 v170, v129
    ds_write_b8_d16_hi v171, v129
    s_cmp_ge_u32 s54, 4
    s_cbranch_scc0 L_old3b
    s_call_b64 s[62:63], L_t23
L_old3b:
L_listed:
    s_sub_u32 s66, s64, s52
    s_sub_u32 s66, s66, 18448
    s_lshr_b32 s66, s66, 3
    s_lshr_b32 s67, s54, 2
    s_mul_i32 s67, s67, 2
    s_add_u32 s66, s66, s67
    s_sub_u32 s67, 0, s66
    v_mov_b32 v2, v221
    v_mov_b32 v1, s66
    v_mov_b32 v3, -8
    v_writelane_b32 v1, s67, 1
    v_writelane_b32 v3, 8, 1
    ds_add_u32 v2, v1
    s_cmp_eq_u32 s94, 1
    s_cbranch_scc1 L_nolate
    ds_read_u8 v148, v237 offset:0
    ds_read_u8 v149, v237 offset:8
    ds_read_u8 v150, v237 offset:16
    ds_read_u8 v151, v237 offset:24
    ds_read_u8 v152, v237 offset:32
    ds_read_u8 v153, v237 offset:40
    ds_read_u8 v154, v237 offset:48
    ds_read_u8 v155, v237 offset:56
    s_waitcnt lgkmcnt(0)
    s_add_u32 m0, s52, 0
    v_mov_b32 v230, v148
    v_mov_b32 v232, v149
    buffer_load_dwordx4 v[230:231], s[20:23], s35 idxen offen nt lds
    buffer_load_dwordx4 v[232:233], s[40:43], s35 idxen offen offset:1056 nt lds
    s_bitcmp0_b64 s[56:57], 2
    s_cbranch_scc1 L_noadvl1
    s_add_u32 s35, s35, s31
    s_min_u32 s35, s35, 419404800
    s_xor_b32 s31, s31, 0x63ff800
L_noadvl1:
    s_add_u32 m0, s52, 2080
    v_mov_b32 v230, v150
    v_mov_b32 v232, v151
    buffer_load_dwordx4 v[230:231], s[20:23], s35 idxen offen nt lds
    buffer_load_dwordx4 v[232:233], s[40:43], s35 idxen offen offset:1056 nt lds
    s_bitcmp0_b64 s[56:57], 3
    s_cbranch_scc1 L_noadvl2
    s_add_u32 s35, s35, s31
    s_min_u32 s35, s35, 419404800
    s_xor_b32 s31, s31, 0x63ff800
L_noadvl2:
    s_add_u32 m0, s52, 4160
    v_mov_b32 v230, v152
    v_mov_b32 v232, v153
    buffer_load_dwordx4 v[230:231], s[20:23], s35 idxen offen nt lds
    buffer_load_dwordx4 v[232:233], s[40:43], s35 idxen offen offset:1056 nt lds
    s_bitcmp0_b64 s[56:57], 4
    s_cbranch_scc1 L_noadvl3
    s_add_u32 s35, s35, s31
    s_min_u32 s35, s35, 419404800
    s_xor_b32 s31, s31, 0x63ff800
L_noadvl3:
    s_add_u32 m0, s52, 6240
    v_mov_b32 v230, v154
    v_mov_b32 v232, v155
    buffer_load_dwordx4 v[230:231], s[20:23], s35 idxen offen nt lds
    buffer_load_dwordx4 v[232:233], s[40:43], s35 idxen offen offset:1056 nt lds
L_nolate:
    v_and_b32_dpp v196, v216, v220 quad_perm:[0,0,0,0] row_mask:0xf bank_mask:0xf
    v_and_b32_dpp v197, v217, v220 quad_perm:[0,0,0,0] row_mask:0xf bank_mask:0xf
    v_and_b32_dpp v198, v216, v220 quad_perm:[1,1,1,1] row_mask:0xf bank_mask:0xf
    v_and_b32_dpp v199, v217, v220 quad_perm:[1,1,1,1] row_mask:0xf bank_mask:0xf
    v_and_b32_dpp v200, v216, v220 quad_perm:[2,2,2,2] row_mask:0xf bank_mask:0xf
    v_and_b32_dpp v201, v217, v220 quad_perm:[2,2,2,2] row_mask:0xf bank_mask:0xf
    v_and_b32_dpp v202, v216, v220 quad_perm:[3,3,3,3] row_mask:0xf bank_mask:0xf
    v_and_b32_dpp v203, v217, v220 quad_perm:[3,3,3,3] row_mask:0xf bank_mask:0xf
    s_waitcnt vmcnt(6) lgkmcnt(0)
    ds_read_b128 v[180:183], v234 offset:0
    ds_read_b128 v[184:187], v235 offset:0
    v_mul_u32_u24 v216, v224, v241
    v_mul_u32_u24 v217, v224, v242
    v_mul_u32_u24 v218, v225, v241
    v_mul_u32_u24 v219, v225, v242
    v_mul_u32_u24 v220, v226, v241
    v_mul_u32_u24 v221, v226, v242
    v_mul_u32_u24 v222, v227, v241
    v_mul_u32_u24 v223, v227, v242
    v_add_u32 v238, 128, v238
    ds_read_b128 v[164:167], v239
    v_mfma_f32_4x4x4_16b_bf16 v[132:135], v[216:217], v[68:69], v[4:7]
    ds_read_b128 v[168:171], v239 offset:64
    ds_read_b128 v[172:175], v239 offset:128
    v_mfma_f32_4x4x4_16b_bf16 v[136:139], v[218:219], v[70:71], v[8:11]
    ds_read_b128 v[176:179], v239 offset:192
    ds_read_u16 v224, v238
    v_mfma_f32_4x4x4_16b_bf16 v[140:143], v[220:221], v[72:73], v[12:15]
    ds_read_u16 v225, v238 offset:8
    ds_read_u16 v226, v238 offset:64
    v_mfma_f32_4x4x4_16b_bf16 v[144:147], v[222:223], v[74:75], v[16:19]
    ds_read_u16 v227, v238 offset:72
    v_add_u32 v239, 272, v239
    v_mfma_f32_4x4x4_16b_bf16 v[246:249], v[216:217], v[76:77], v[20:23]
    v_cvt_pk_bf16_f32 v100, v132, v133
    v_cvt_pk_bf16_f32 v101, v134, v135
    v_mfma_f32_4x4x4_16b_bf16 v[250:253], v[218:219], v[78:79], v[24:27]
    v_cvt_pk_bf16_f32 v102, v136, v137
    v_cvt_pk_bf16_f32 v103, v138, v139
    v_mfma_f32_4x4x4_16b_bf16 v[132:135], v[220:221], v[80:81], v[28:31]
    v_cvt_pk_bf16_f32 v104, v140, v141
    v_cvt_pk_bf16_f32 v105, v142, v143
    v_mfma_f32_4x4x4_16b_bf16 v[136:139], v[222:223], v[82:83], v[32:35]
    v_cvt_pk_bf16_f32 v106, v144, v145
    v_cvt_pk_bf16_f32 v107, v146, v147
    v_mfma_f32_4x4x4_16b_bf16 v[140:143], v[216:217], v[84:85], v[36:39]
    v_cvt_pk_bf16_f32 v108, v246, v247
    v_cvt_pk_bf16_f32 v109, v248, v249
    v_mfma_f32_4x4x4_16b_bf16 v[144:147], v[218:219], v[86:87], v[40:43]
    v_cvt_pk_bf16_f32 v110, v250, v251
    v_cvt_pk_bf16_f32 v111, v252, v253
    v_mfma_f32_4x4x4_16b_bf16 v[246:249], v[220:221], v[88:89], v[44:47]
    v_cvt_pk_bf16_f32 v112, v132, v133
    v_cvt_pk_bf16_f32 v113, v134, v135
    v_mfma_f32_4x4x4_16b_bf16 v[250:253], v[222:223], v[90:91], v[48:51]
    v_cvt_pk_bf16_f32 v114, v136, v137
    v_cvt_pk_bf16_f32 v115, v138, v139
    v_mfma_f32_4x4x4_16b_bf16 v[132:135], v[216:217], v[92:93], v[52:55]
    v_cvt_pk_bf16_f32 v116, v140, v141
    v_cvt_pk_bf16_f32 v117, v142, v143
    v_mfma_f32_4x4x4_16b_bf16 v[136:139], v[218:219], v[94:95], v[56:59]
    v_cvt_pk_bf16_f32 v118, v144, v145
    v_cvt_pk_bf16_f32 v119, v146, v147
    v_mfma_f32_4x4x4_16b_bf16 v[140:143], v[220:221], v[96:97], v[60:63]
    v_cvt_pk_bf16_f32 v120, v246, v247
    v_cvt_pk_bf16_f32 v121, v248, v249
    v_mfma_f32_4x4x4_16b_bf16 v[144:147], v[222:223], v[98:99], v[64:67]
    v_cvt_pk_bf16_f32 v122, v250, v251
    v_cvt_pk_bf16_f32 v123, v252, v253
    v_cvt_pk_bf16_f32 v124, v132, v133
    v_cvt_pk_bf16_f32 v125, v134, v135
    v_cvt_pk_bf16_f32 v126, v136, v137
    v_cvt_pk_bf16_f32 v127, v138, v139
    v_cvt_pk_bf16_f32 v128, v140, v141
    v_cvt_pk_bf16_f32 v129, v142, v143
    v_cvt_pk_bf16_f32 v130, v144, v145
    v_cvt_pk_bf16_f32 v131, v146, v147
    s_waitcnt lgkmcnt(0)
    v_mfma_f32_16x16x32_bf16 v[148:151], v[100:103], v[180:183], v[164:167]
    v_mfma_f32_16x16x32_bf16 v[148:151], v[104:107], v[184:187], v[148:151]
    v_mfma_f32_16x16x32_bf16 v[152:155], v[108:111], v[180:183], v[168:171]
    v_mfma_f32_16x16x32_bf16 v[152:155], v[112:115], v[184:187], v[152:155]
    v_mfma_f32_16x16x32_bf16 v[156:159], v[116:119], v[180:183], v[172:175]
    v_mfma_f32_16x16x32_bf16 v[156:159], v[120:123], v[184:187], v[156:159]
    v_mfma_f32_16x16x32_bf16 v[160:163], v[124:127], v[180:183], v[176:179]
    v_mfma_f32_16x16x32_bf16 v[160:163], v[128:131], v[184:187], v[160:163]
    s_waitcnt vmcnt(4)
    ds_read_b128 v[180:183], v234 offset:2080
    ds_read_b128 v[184:187], v235 offset:2080
    ds_read_u8 v230, v237 offset:64
    ds_read_u8 v232, v237 offset:72
    s_lshr_b64 s[86:87], s[56:57], 2
    s_lshr_b64 s[36:37], s[56:57], 5
    s_or_b32 s36, s36, s86
    s_or_b32 s36, s36, s56
    s_cmp_lg_u64 s[84:85], 0
    s_cbranch_scc0 Lf_mid
    s_mul_i32 s66, s53, 800
    s_add_u32 s8, s8, s66
    s_addc_u32 s9, s9, 0
    s_mov_b32 s24, s8
    s_and_b32 s25, s9, 0xffff
    s_mov_b32 s26, 400
    s_mov_b32 s27, 0x20000
    s_movk_i32 s32, 400
    s_branch Ls_mid
L_fp:
    v_mfma_i32_16x16x64_i8 v[172:175], v[122:125], v[100:103], 0
    v_and_b32 v160, 0x800080, v100
    v_mul_u32_u24 v160, 0x7f, v160
    v_bitop3_b32 v131, v100, v160, v131 bitop3:0xbe
    v_and_b32 v161, 0x800080, v101
    v_mul_u32_u24 v161, 0x7f, v161
    v_bitop3_b32 v131, v101, v161, v131 bitop3:0xbe
    v_and_b32 v160, 0x800080, v102
    v_mul_u32_u24 v160, 0x7f, v160
    v_mov_b32_dpp v184, v172 row_shr:1 row_mask:0xf bank_mask:0xf bound_ctrl:0
    v_bitop3_b32 v131, v102, v160, v131 bitop3:0xbe
    s_nop 0
    v_add_u32_dpp v184, v184, v184 row_shr:1 row_mask:0xf bank_mask:0xf bound_ctrl:0
    v_and_b32 v161, 0x800080, v103
    s_nop 0
    v_add_u32_dpp v184, v184, v184 row_shr:2 row_mask:0xf bank_mask:0xf bound_ctrl:0
    v_mul_u32_u24 v161, 0x7f, v161
    s_nop 0
    v_add_u32_dpp v184, v184, v184 row_shr:4 row_mask:0xf bank_mask:0xf bound_ctrl:0
    v_bitop3_b32 v131, v103, v161, v131 bitop3:0xbe
    s_nop 0
    v_add_u32_dpp v184, v184, v184 row_shr:8 row_mask:0xf bank_mask:0xf bound_ctrl:0
    v_cmp_ne_u32 vcc, 0, v131
    v_readlane_b32 s68, v184, 6
    v_readlane_b32 s69, v173, 6
    v_readlane_b32 s70, v184, 15
    s_mov_b32 s94, 0
    s_cbranch_vccnz L_late
    s_add_u32 s66, s68, s69
    s_add_u32 s66, s66, s64
    s_add_u32 s67, s66, 15
    s_and_b32 s67, s67, -16
    s_add_u32 s55, s64, 16
    s_max_u32 s67, s67, s55
    s_sub_u32 s66, s67, s66
    v_mad_u32_u24 v184, v130, s66, v184
    s_sub_u32 s55, s64, 2048
    v_add_u32 v172, s55, v184
    v_add_u32 v173, s55, v184
    v_add_u32 v174, s55, v184
    v_add_u32 v175, s55, v184
    s_add_u32 s64, s64, s70
    s_add_u32 s64, s64, s66
    v_mfma_i32_16x16x64_i8 v[132:135], v[118:121], v[100:103], v[172:175]
    v_mfma_i32_16x16x64_i8 v[136:139], v[116:119], v[100:103], v[172:175]
    s_add_u32 s64, s64, 15
    s_and_b32 s64, s64, -16
    s_add_u32 s55, s67, 16
    s_max_u32 s64, s64, s55
    s_lshr_b32 s95, s67, 4
    s_bitset1_b64 s[56:57], s95
    s_lshr_b32 s95, s64, 4
    s_bitset1_b64 s[56:57], s95
    s_add_u32 s66, s52, 18512
    s_cmp_ge_u32 s64, s66
    ds_write_b8 v132, v126
    ds_write_b8_d16_hi v133, v126
    ds_write_b8 v134, v127
    ds_write_b8_d16_hi v135, v127
    ds_write_b8 v136, v128
    ds_write_b8_d16_hi v137, v128
    ds_write_b8 v138, v129
    ds_write_b8_d16_hi v139, v129
    s_cbranch_scc0 L_late
    s_mov_b32 s94, 1
    ds_read_u8 v148, v237 offset:0
    ds_read_u8 v149, v237 offset:8
    ds_read_u8 v150, v237 offset:16
    ds_read_u8 v151, v237 offset:24
    ds_read_u8 v152, v237 offset:32
    ds_read_u8 v153, v237 offset:40
    ds_read_u8 v154, v237 offset:48
    ds_read_u8 v155, v237 offset:56
    s_waitcnt lgkmcnt(0)
    s_add_u32 m0, s52, 0
    v_mov_b32 v230, v148
    v_mov_b32 v232, v149
    buffer_load_dwordx4 v[230:231], s[20:23], s35 idxen offen nt lds
    buffer_load_dwordx4 v[232:233], s[40:43], s35 idxen offen offset:1056 nt lds
    s_bitcmp0_b64 s[56:57], 2
    s_cbranch_scc1 L_noadve1
    s_add_u32 s35, s35, s31
    s_min_u32 s35, s35, 419404800
    s_xor_b32 s31, s31, 0x63ff800
L_noadve1:
    s_add_u32 m0, s52, 2080
    v_mov_b32 v230, v150
    v_mov_b32 v232, v151
    buffer_load_dwordx4 v[230:231], s[20:23], s35 idxen offen nt lds
    buffer_load_dwordx4 v[232:233], s[40:43], s35 idxen offen offset:1056 nt lds
    s_setpc_b64 s[62:63]
L_late:
    s_waitcnt vmcnt(0)
    s_setpc_b64 s[62:63]
L_t23:
    s_cmp_eq_u32 s94, 0
    s_cbranch_scc1 L_skip23
    s_bitcmp0_b64 s[56:57], 3
    s_cbranch_scc1 L_noadve2
    s_add_u32 s35, s35, s31
    s_min_u32 s35, s35, 419404800
    s_xor_b32 s31, s31, 0x63ff800
L_noadve2:
    s_add_u32 m0, s52, 4160
    v_mov_b32 v230, v152
    v_mov_b32 v232, v153
    buffer_load_dwordx4 v[230:231], s[20:23], s35 idxen offen nt lds
    buffer_load_dwordx4 v[232:233], s[40:43], s35 idxen offen offset:1056 nt lds
    s_bitcmp0_b64 s[56:57], 4
    s_cbranch_scc1 L_noadve3
    s_add_u32 s35, s35, s31
    s_min_u32 s35, s35, 419404800
    s_xor_b32 s31, s31, 0x63ff800
L_noadve3:
    s_add_u32 m0, s52, 6240
    v_mov_b32 v230, v154
    v_mov_b32 v232, v155
    buffer_load_dwordx4 v[230:231], s[20:23], s35 idxen offen nt lds
    buffer_load_dwordx4 v[232:233], s[40:43], s35 idxen offen offset:1056 nt lds
    s_setpc_b64 s[62:63]
L_skip23:
    s_waitcnt vmcnt(0)
    s_setpc_b64 s[62:63]
Lf_loop:
    ds_read_u8 v230, v237 offset:64
    ds_read_u8 v232, v237 offset:72
    v_mfma_f32_16x16x32_bf16 v[208:211], v[136:139], v[200:203], v[208:211]
Lf_mid:
    s_bitcmp1_b32 s36, 0
    s_cbranch_scc1 Lf_ev0
Lf_evd0:
    ds_add_rtn_u32 v1, v2, v3
    v_exp_f32 v132, v148
    v_exp_f32 v133, v149
    v_exp_f32 v134, v150
    v_exp_f32 v135, v151
    v_exp_f32 v136, v152
    v_exp_f32 v137, v153
    v_mfma_f32_4x4x4_16b_bf16 v[132:135], v[228:229], v[228:229], v[132:135]
    v_cvt_pk_bf16_f32 v208, v208, v209
    v_cvt_pk_bf16_f32 v209, v210, v211
    s_waitcnt lgkmcnt(2)
    v_mfma_f32_16x16x32_bf16 v[148:151], v[100:103], v[180:183], v[164:167]
    v_exp_f32 v138, v154
    v_mfma_f32_4x4x4_16b_bf16 v[212:215], v[208:209], v[188:189], v[212:215] cbsz:4 abid:0
    ds_read_b64_tr_b16 v[188:189], v236 offset:0
    v_exp_f32 v139, v155
    v_mfma_f32_16x16x32_bf16 v[152:155], v[108:111], v[180:183], v[168:171]
    v_exp_f32 v140, v156
    v_mfma_f32_4x4x4_16b_bf16 v[212:215], v[208:209], v[190:191], v[212:215] cbsz:4 abid:4
    ds_read_b64_tr_b16 v[190:191], v236 offset:512
    v_mfma_f32_4x4x4_16b_bf16 v[136:139], v[228:229], v[228:229], v[136:139]
    v_rcp_f32 v132, v132
    v_mfma_f32_4x4x4_16b_bf16 v[212:215], v[208:209], v[192:193], v[212:215] cbsz:4 abid:8
    ds_read_b64_tr_b16 v[192:193], v236 offset:1056
    v_exp_f32 v141, v157
    v_mfma_f32_16x16x32_bf16 v[148:151], v[104:107], v[184:187], v[148:151]
    v_rcp_f32 v133, v133
    v_mfma_f32_4x4x4_16b_bf16 v[212:215], v[208:209], v[194:195], v[212:215] cbsz:4 abid:12
    ds_read_b64_tr_b16 v[194:195], v236 offset:1568
    v_exp_f32 v142, v158
    v_mfma_f32_16x16x32_bf16 v[152:155], v[112:115], v[184:187], v[152:155]
    v_rcp_f32 v134, v134
    v_exp_f32 v143, v159
    v_rcp_f32 v135, v135
    v_cvt_pk_bf16_f32 v132, v132, v133
    v_mfma_f32_4x4x4_16b_bf16 v[140:143], v[228:229], v[228:229], v[140:143]
    v_exp_f32 v144, v160
    v_mfma_f32_16x16x32_bf16 v[156:159], v[116:119], v[180:183], v[172:175]
    v_rcp_f32 v136, v136
    v_cvt_pk_bf16_f32 v133, v134, v135
    s_add_u32 m0, s52, 0
    s_waitcnt lgkmcnt(0)
    buffer_load_dwordx4 v[230:231], s[20:23], s35 idxen offen nt lds
    v_exp_f32 v145, v161
    buffer_load_dwordx4 v[232:233], s[40:43], s35 idxen offen offset:1056 nt lds
    v_rcp_f32 v137, v137
    v_exp_f32 v146, v162
    v_rcp_f32 v138, v138
    v_cvt_pk_bf16_f32 v134, v136, v137
    v_exp_f32 v147, v163
    v_mfma_f32_16x16x32_bf16 v[160:163], v[124:127], v[180:183], v[176:179]
    v_readfirstlane_b32 s66, v1
    s_setprio 0
    s_cmp_gt_i32 s66, 0
    s_cbranch_scc0 Lf_lo0
    s_setprio 1
Lf_lo0:
    v_rcp_f32 v139, v139
    v_mfma_f32_4x4x4_16b_bf16 v[144:147], v[228:229], v[228:229], v[144:147]
    v_mfma_f32_16x16x32_bf16 v[156:159], v[120:123], v[184:187], v[156:159]
    v_rcp_f32 v140, v140
    v_mfma_f32_16x16x32_bf16 v[160:163], v[128:131], v[184:187], v[160:163]
    v_rcp_f32 v141, v141
    v_cvt_pk_bf16_f32 v135, v138, v139
    s_waitcnt vmcnt(4)
    ds_read_b128 v[180:183], v234 offset:4160
    ds_read_b128 v[184:187], v235 offset:4160
    v_rcp_f32 v142, v142
    v_cvt_pk_bf16_f32 v136, v140, v141
    v_mfma_f32_16x16x32_bf16 v[208:211], v[132:135], v[196:199], v[204:207]
    v_rcp_f32 v143, v143
    v_rcp_f32 v144, v144
    v_cvt_pk_bf16_f32 v137, v142, v143
    v_rcp_f32 v145, v145
    v_rcp_f32 v146, v146
    v_rcp_f32 v147, v147
    v_cvt_pk_bf16_f32 v138, v144, v145
    v_cvt_pk_bf16_f32 v139, v146, v147
    ds_read_u8 v230, v237 offset:80
    ds_read_u8 v232, v237 offset:88
    v_mfma_f32_16x16x32_bf16 v[208:211], v[136:139], v[200:203], v[208:211]
    s_bitcmp1_b32 s36, 1
    s_cbranch_scc1 Lf_ev1
Lf_evd1:
    v_exp_f32 v132, v148
    v_exp_f32 v133, v149
    v_exp_f32 v134, v150
    v_exp_f32 v135, v151
    v_exp_f32 v136, v152
    v_exp_f32 v137, v153
    v_mfma_f32_4x4x4_16b_bf16 v[132:135], v[228:229], v[228:229], v[132:135]
    v_cvt_pk_bf16_f32 v208, v208, v209
    v_cvt_pk_bf16_f32 v209, v210, v211
    s_waitcnt lgkmcnt(2)
    v_mfma_f32_16x16x32_bf16 v[148:151], v[100:103], v[180:183], v[164:167]
    v_exp_f32 v138, v154
    v_mfma_f32_4x4x4_16b_bf16 v[212:215], v[208:209], v[188:189], v[212:215] cbsz:4 abid:0
    ds_read_b64_tr_b16 v[188:189], v236 offset:2080
    v_exp_f32 v139, v155
    v_mfma_f32_16x16x32_bf16 v[152:155], v[108:111], v[180:183], v[168:171]
    v_exp_f32 v140, v156
    v_mfma_f32_4x4x4_16b_bf16 v[212:215], v[208:209], v[190:191], v[212:215] cbsz:4 abid:4
    ds_read_b64_tr_b16 v[190:191], v236 offset:2592
    v_mfma_f32_4x4x4_16b_bf16 v[136:139], v[228:229], v[228:229], v[136:139]
    v_rcp_f32 v132, v132
    v_mfma_f32_4x4x4_16b_bf16 v[212:215], v[208:209], v[192:193], v[212:215] cbsz:4 abid:8
    ds_read_b64_tr_b16 v[192:193], v236 offset:3136
    v_exp_f32 v141, v157
    v_mfma_f32_16x16x32_bf16 v[148:151], v[104:107], v[184:187], v[148:151]
    v_rcp_f32 v133, v133
    v_mfma_f32_4x4x4_16b_bf16 v[212:215], v[208:209], v[194:195], v[212:215] cbsz:4 abid:12
    ds_read_b64_tr_b16 v[194:195], v236 offset:3648
    v_exp_f32 v142, v158
    v_mfma_f32_16x16x32_bf16 v[152:155], v[112:115], v[184:187], v[152:155]
    v_rcp_f32 v134, v134
    v_exp_f32 v143, v159
    v_rcp_f32 v135, v135
    v_cvt_pk_bf16_f32 v132, v132, v133
    v_mfma_f32_4x4x4_16b_bf16 v[140:143], v[228:229], v[228:229], v[140:143]
    v_exp_f32 v144, v160
    v_mfma_f32_16x16x32_bf16 v[156:159], v[116:119], v[180:183], v[172:175]
    v_rcp_f32 v136, v136
    v_cvt_pk_bf16_f32 v133, v134, v135
    s_add_u32 m0, s52, 2080
    s_waitcnt lgkmcnt(0)
    buffer_load_dwordx4 v[230:231], s[20:23], s35 idxen offen nt lds
    v_exp_f32 v145, v161
    buffer_load_dwordx4 v[232:233], s[40:43], s35 idxen offen offset:1056 nt lds
    v_rcp_f32 v137, v137
    v_exp_f32 v146, v162
    v_rcp_f32 v138, v138
    v_cvt_pk_bf16_f32 v134, v136, v137
    v_exp_f32 v147, v163
    v_mfma_f32_16x16x32_bf16 v[160:163], v[124:127], v[180:183], v[176:179]
    v_rcp_f32 v139, v139
    v_mfma_f32_4x4x4_16b_bf16 v[144:147], v[228:229], v[228:229], v[144:147]
    v_mfma_f32_16x16x32_bf16 v[156:159], v[120:123], v[184:187], v[156:159]
    v_rcp_f32 v140, v140
    v_mfma_f32_16x16x32_bf16 v[160:163], v[128:131], v[184:187], v[160:163]
    v_rcp_f32 v141, v141
    v_cvt_pk_bf16_f32 v135, v138, v139
    s_waitcnt vmcnt(4)
    ds_read_b128 v[180:183], v234 offset:6240
    ds_read_b128 v[184:187], v235 offset:6240
    v_rcp_f32 v142, v142
    v_cvt_pk_bf16_f32 v136, v140, v141
    v_mfma_f32_16x16x32_bf16 v[208:211], v[132:135], v[196:199], v[204:207]
    v_rcp_f32 v143, v143
    v_rcp_f32 v144, v144
    v_cvt_pk_bf16_f32 v137, v142, v143
    v_rcp_f32 v145, v145
    v_rcp_f32 v146, v146
    v_rcp_f32 v147, v147
    v_cvt_pk_bf16_f32 v138, v144, v145
    v_cvt_pk_bf16_f32 v139, v146, v147
    ds_read_u8 v230, v237 offset:96
    ds_read_u8 v232, v237 offset:104
    v_mfma_f32_16x16x32_bf16 v[208:211], v[136:139], v[200:203], v[208:211]
    s_bitcmp1_b32 s36, 2
    s_cbranch_scc1 Lf_ev2
Lf_evd2:
    v_exp_f32 v132, v148
    v_exp_f32 v133, v149
    v_exp_f32 v134, v150
    v_exp_f32 v135, v151
    v_exp_f32 v136, v152
    v_exp_f32 v137, v153
    v_mfma_f32_4x4x4_16b_bf16 v[132:135], v[228:229], v[228:229], v[132:135]
    v_cvt_pk_bf16_f32 v208, v208, v209
    v_cvt_pk_bf16_f32 v209, v210, v211
    s_waitcnt lgkmcnt(2)
    v_mfma_f32_16x16x32_bf16 v[148:151], v[100:103], v[180:183], v[164:167]
    v_exp_f32 v138, v154
    v_mfma_f32_4x4x4_16b_bf16 v[212:215], v[208:209], v[188:189], v[212:215] cbsz:4 abid:0
    ds_read_b64_tr_b16 v[188:189], v236 offset:4160
    v_exp_f32 v139, v155
    v_mfma_f32_16x16x32_bf16 v[152:155], v[108:111], v[180:183], v[168:171]
    v_exp_f32 v140, v156
    v_mfma_f32_4x4x4_16b_bf16 v[212:215], v[208:209], v[190:191], v[212:215] cbsz:4 abid:4
    ds_read_b64_tr_b16 v[190:191], v236 offset:4672
    v_mfma_f32_4x4x4_16b_bf16 v[136:139], v[228:229], v[228:229], v[136:139]
    v_rcp_f32 v132, v132
    v_mfma_f32_4x4x4_16b_bf16 v[212:215], v[208:209], v[192:193], v[212:215] cbsz:4 abid:8
    ds_read_b64_tr_b16 v[192:193], v236 offset:5216
    v_exp_f32 v141, v157
    v_mfma_f32_16x16x32_bf16 v[148:151], v[104:107], v[184:187], v[148:151]
    v_rcp_f32 v133, v133
    v_mfma_f32_4x4x4_16b_bf16 v[212:215], v[208:209], v[194:195], v[212:215] cbsz:4 abid:12
    ds_read_b64_tr_b16 v[194:195], v236 offset:5728
    v_exp_f32 v142, v158
    v_mfma_f32_16x16x32_bf16 v[152:155], v[112:115], v[184:187], v[152:155]
    v_rcp_f32 v134, v134
    v_exp_f32 v143, v159
    v_rcp_f32 v135, v135
    v_cvt_pk_bf16_f32 v132, v132, v133
    v_mfma_f32_4x4x4_16b_bf16 v[140:143], v[228:229], v[228:229], v[140:143]
    v_exp_f32 v144, v160
    v_mfma_f32_16x16x32_bf16 v[156:159], v[116:119], v[180:183], v[172:175]
    v_rcp_f32 v136, v136
    v_cvt_pk_bf16_f32 v133, v134, v135
    s_add_u32 m0, s52, 4160
    s_waitcnt lgkmcnt(0)
    buffer_load_dwordx4 v[230:231], s[20:23], s35 idxen offen nt lds
    v_exp_f32 v145, v161
    buffer_load_dwordx4 v[232:233], s[40:43], s35 idxen offen offset:1056 nt lds
    v_rcp_f32 v137, v137
    v_exp_f32 v146, v162
    v_rcp_f32 v138, v138
    v_cvt_pk_bf16_f32 v134, v136, v137
    v_exp_f32 v147, v163
    v_mfma_f32_16x16x32_bf16 v[160:163], v[124:127], v[180:183], v[176:179]
    v_rcp_f32 v139, v139
    v_mfma_f32_4x4x4_16b_bf16 v[144:147], v[228:229], v[228:229], v[144:147]
    v_mfma_f32_16x16x32_bf16 v[156:159], v[120:123], v[184:187], v[156:159]
    v_rcp_f32 v140, v140
    v_mfma_f32_16x16x32_bf16 v[160:163], v[128:131], v[184:187], v[160:163]
    v_rcp_f32 v141, v141
    v_cvt_pk_bf16_f32 v135, v138, v139
    s_waitcnt vmcnt(4)
    ds_read_b128 v[180:183], v234 offset:0
    ds_read_b128 v[184:187], v235 offset:0
    v_rcp_f32 v142, v142
    v_cvt_pk_bf16_f32 v136, v140, v141
    v_mfma_f32_16x16x32_bf16 v[208:211], v[132:135], v[196:199], v[204:207]
    v_rcp_f32 v143, v143
    v_rcp_f32 v144, v144
    v_cvt_pk_bf16_f32 v137, v142, v143
    v_rcp_f32 v145, v145
    v_rcp_f32 v146, v146
    v_rcp_f32 v147, v147
    v_cvt_pk_bf16_f32 v138, v144, v145
    v_cvt_pk_bf16_f32 v139, v146, v147
    ds_read_u8 v230, v237 offset:112
    ds_read_u8 v232, v237 offset:120
    v_mfma_f32_16x16x32_bf16 v[208:211], v[136:139], v[200:203], v[208:211]
    s_bitcmp1_b32 s36, 3
    s_cbranch_scc1 Lf_ev3
Lf_evd3:
    v_exp_f32 v132, v148
    v_exp_f32 v133, v149
    v_exp_f32 v134, v150
    v_exp_f32 v135, v151
    v_exp_f32 v136, v152
    v_exp_f32 v137, v153
    v_mfma_f32_4x4x4_16b_bf16 v[132:135], v[228:229], v[228:229], v[132:135]
    v_cvt_pk_bf16_f32 v208, v208, v209
    v_cvt_pk_bf16_f32 v209, v210, v211
    s_waitcnt lgkmcnt(2)
    v_mfma_f32_16x16x32_bf16 v[148:151], v[100:103], v[180:183], v[164:167]
    v_exp_f32 v138, v154
    v_mfma_f32_4x4x4_16b_bf16 v[212:215], v[208:209], v[188:189], v[212:215] cbsz:4 abid:0
    ds_read_b64_tr_b16 v[188:189], v236 offset:6240
    v_exp_f32 v139, v155
    v_mfma_f32_16x16x32_bf16 v[152:155], v[108:111], v[180:183], v[168:171]
    v_exp_f32 v140, v156
    v_mfma_f32_4x4x4_16b_bf16 v[212:215], v[208:209], v[190:191], v[212:215] cbsz:4 abid:4
    ds_read_b64_tr_b16 v[190:191], v236 offset:6752
    v_mfma_f32_4x4x4_16b_bf16 v[136:139], v[228:229], v[228:229], v[136:139]
    v_rcp_f32 v132, v132
    v_mfma_f32_4x4x4_16b_bf16 v[212:215], v[208:209], v[192:193], v[212:215] cbsz:4 abid:8
    ds_read_b64_tr_b16 v[192:193], v236 offset:7296
    v_exp_f32 v141, v157
    v_mfma_f32_16x16x32_bf16 v[148:151], v[104:107], v[184:187], v[148:151]
    v_rcp_f32 v133, v133
    v_mfma_f32_4x4x4_16b_bf16 v[212:215], v[208:209], v[194:195], v[212:215] cbsz:4 abid:12
    ds_read_b64_tr_b16 v[194:195], v236 offset:7808
    v_exp_f32 v142, v158
    v_mfma_f32_16x16x32_bf16 v[152:155], v[112:115], v[184:187], v[152:155]
    v_rcp_f32 v134, v134
    v_exp_f32 v143, v159
    v_rcp_f32 v135, v135
    v_cvt_pk_bf16_f32 v132, v132, v133
    v_mfma_f32_4x4x4_16b_bf16 v[140:143], v[228:229], v[228:229], v[140:143]
    v_exp_f32 v144, v160
    v_mfma_f32_16x16x32_bf16 v[156:159], v[116:119], v[180:183], v[172:175]
    v_rcp_f32 v136, v136
    v_cvt_pk_bf16_f32 v133, v134, v135
    s_add_u32 m0, s52, 6240
    s_waitcnt lgkmcnt(0)
    buffer_load_dwordx4 v[230:231], s[20:23], s35 idxen offen nt lds
    v_exp_f32 v145, v161
    buffer_load_dwordx4 v[232:233], s[40:43], s35 idxen offen offset:1056 nt lds
    v_rcp_f32 v137, v137
    v_exp_f32 v146, v162
    v_rcp_f32 v138, v138
    v_cvt_pk_bf16_f32 v134, v136, v137
    v_exp_f32 v147, v163
    v_mfma_f32_16x16x32_bf16 v[160:163], v[124:127], v[180:183], v[176:179]
    v_rcp_f32 v139, v139
    v_mfma_f32_4x4x4_16b_bf16 v[144:147], v[228:229], v[228:229], v[144:147]
    v_mfma_f32_16x16x32_bf16 v[156:159], v[120:123], v[184:187], v[156:159]
    v_rcp_f32 v140, v140
    v_mfma_f32_16x16x32_bf16 v[160:163], v[128:131], v[184:187], v[160:163]
    v_rcp_f32 v141, v141
    v_cvt_pk_bf16_f32 v135, v138, v139
    s_waitcnt vmcnt(4)
    ds_read_b128 v[180:183], v234 offset:2080
    ds_read_b128 v[184:187], v235 offset:2080
    v_rcp_f32 v142, v142
    v_cvt_pk_bf16_f32 v136, v140, v141
    v_mfma_f32_16x16x32_bf16 v[208:211], v[132:135], v[196:199], v[204:207]
    v_rcp_f32 v143, v143
    s_lshr_b64 s[56:57], s[56:57], 4
    s_lshl_b64 s[86:87], s[58:59], 60
    s_or_b64 s[56:57], s[56:57], s[86:87]
    s_lshr_b64 s[58:59], s[58:59], 4
    s_lshr_b64 s[86:87], s[56:57], 2
    s_lshr_b64 s[36:37], s[56:57], 5
    s_or_b32 s36, s36, s86
    s_or_b32 s36, s36, s56
    v_add_u32 v237, 64, v237
    v_rcp_f32 v144, v144
    v_cvt_pk_bf16_f32 v137, v142, v143
    v_rcp_f32 v145, v145
    v_rcp_f32 v146, v146
    v_rcp_f32 v147, v147
    v_cvt_pk_bf16_f32 v138, v144, v145
    v_cvt_pk_bf16_f32 v139, v146, v147
    s_branch Lf_loop
Lf_ev0:
    s_bitcmp0_b64 s[56:57], 0
    s_cbranch_scc1 Lf_nf0
    v_cvt_pk_bf16_f32 v246, v212, v212
    v_mov_b32 v212, 0
    ds_write_b16 v240, v246
    v_add_u32 v240, 128, v240
Lf_nf0:
    s_bitcmp0_b64 s[56:57], 5
    s_cbranch_scc1 Lf_na0
    s_add_u32 s35, s35, s31
    s_min_u32 s35, s35, 419404800
    s_xor_b32 s31, s31, 0x63ff800
Lf_na0:
    s_bitcmp0_b64 s[56:57], 2
    s_cbranch_scc1 Lf_evd0
Lf_e10:
    s_sub_u32 s61, s61, 1
    s_cbranch_scc1 Lf_last0
    v_mul_u32_u24 v216, v224, v241
    v_mul_u32_u24 v217, v224, v242
    v_mul_u32_u24 v218, v225, v241
    v_mul_u32_u24 v219, v225, v242
    v_mul_u32_u24 v220, v226, v241
    v_mul_u32_u24 v221, v226, v242
    v_mul_u32_u24 v222, v227, v241
    v_mul_u32_u24 v223, v227, v242
    v_add_u32 v238, 128, v238
    ds_read_b128 v[164:167], v239
    v_mfma_f32_4x4x4_16b_bf16 v[132:135], v[216:217], v[68:69], v[4:7]
    ds_read_b128 v[168:171], v239 offset:64
    ds_read_b128 v[172:175], v239 offset:128
    v_mfma_f32_4x4x4_16b_bf16 v[136:139], v[218:219], v[70:71], v[8:11]
    ds_read_b128 v[176:179], v239 offset:192
    ds_read_u16 v224, v238
    v_mfma_f32_4x4x4_16b_bf16 v[140:143], v[220:221], v[72:73], v[12:15]
    ds_read_u16 v225, v238 offset:8
    ds_read_u16 v226, v238 offset:64
    v_mfma_f32_4x4x4_16b_bf16 v[144:147], v[222:223], v[74:75], v[16:19]
    ds_read_u16 v227, v238 offset:72
    v_add_u32 v239, 272, v239
    v_mfma_f32_4x4x4_16b_bf16 v[246:249], v[216:217], v[76:77], v[20:23]
    v_cvt_pk_bf16_f32 v100, v132, v133
    v_cvt_pk_bf16_f32 v101, v134, v135
    v_mfma_f32_4x4x4_16b_bf16 v[250:253], v[218:219], v[78:79], v[24:27]
    v_cvt_pk_bf16_f32 v102, v136, v137
    v_cvt_pk_bf16_f32 v103, v138, v139
    v_mfma_f32_4x4x4_16b_bf16 v[132:135], v[220:221], v[80:81], v[28:31]
    v_cvt_pk_bf16_f32 v104, v140, v141
    v_cvt_pk_bf16_f32 v105, v142, v143
    v_mfma_f32_4x4x4_16b_bf16 v[136:139], v[222:223], v[82:83], v[32:35]
    v_cvt_pk_bf16_f32 v106, v144, v145
    v_cvt_pk_bf16_f32 v107, v146, v147
    v_mfma_f32_4x4x4_16b_bf16 v[140:143], v[216:217], v[84:85], v[36:39]
    v_cvt_pk_bf16_f32 v108, v246, v247
    v_cvt_pk_bf16_f32 v109, v248, v249
    v_mfma_f32_4x4x4_16b_bf16 v[144:147], v[218:219], v[86:87], v[40:43]
    v_cvt_pk_bf16_f32 v110, v250, v251
    v_cvt_pk_bf16_f32 v111, v252, v253
    v_mfma_f32_4x4x4_16b_bf16 v[246:249], v[220:221], v[88:89], v[44:47]
    v_cvt_pk_bf16_f32 v112, v132, v133
    v_cvt_pk_bf16_f32 v113, v134, v135
    v_mfma_f32_4x4x4_16b_bf16 v[250:253], v[222:223], v[90:91], v[48:51]
    v_cvt_pk_bf16_f32 v114, v136, v137
    v_cvt_pk_bf16_f32 v115, v138, v139
    v_mfma_f32_4x4x4_16b_bf16 v[132:135], v[216:217], v[92:93], v[52:55]
    v_cvt_pk_bf16_f32 v116, v140, v141
    v_cvt_pk_bf16_f32 v117, v142, v143
    v_mfma_f32_4x4x4_16b_bf16 v[136:139], v[218:219], v[94:95], v[56:59]
    v_cvt_pk_bf16_f32 v118, v144, v145
    v_cvt_pk_bf16_f32 v119, v146, v147
    v_mfma_f32_4x4x4_16b_bf16 v[140:143], v[220:221], v[96:97], v[60:63]
    v_cvt_pk_bf16_f32 v120, v246, v247
    v_cvt_pk_bf16_f32 v121, v248, v249
    v_mfma_f32_4x4x4_16b_bf16 v[144:147], v[222:223], v[98:99], v[64:67]
    v_cvt_pk_bf16_f32 v122, v250, v251
    v_cvt_pk_bf16_f32 v123, v252, v253
    v_cvt_pk_bf16_f32 v124, v132, v133
    v_cvt_pk_bf16_f32 v125, v134, v135
    v_cvt_pk_bf16_f32 v126, v136, v137
    v_cvt_pk_bf16_f32 v127, v138, v139
    v_cvt_pk_bf16_f32 v128, v140, v141
    v_cvt_pk_bf16_f32 v129, v142, v143
    v_cvt_pk_bf16_f32 v130, v144, v145
    v_cvt_pk_bf16_f32 v131, v146, v147
    s_waitcnt lgkmcnt(0)
    s_branch Lf_evd0
Lf_ev1:
    s_bitcmp0_b64 s[56:57], 1
    s_cbranch_scc1 Lf_nf1
    v_cvt_pk_bf16_f32 v246, v212, v212
    v_mov_b32 v212, 0
    ds_write_b16 v240, v246
    v_add_u32 v240, 128, v240
Lf_nf1:
    s_bitcmp0_b64 s[56:57], 6
    s_cbranch_scc1 Lf_na1
    s_add_u32 s35, s35, s31
    s_min_u32 s35, s35, 419404800
    s_xor_b32 s31, s31, 0x63ff800
Lf_na1:
    s_bitcmp0_b64 s[56:57], 3
    s_cbranch_scc1 Lf_evd1
Lf_e11:
    s_sub_u32 s61, s61, 1
    s_cbranch_scc1 Lf_last1
    v_mul_u32_u24 v216, v224, v241
    v_mul_u32_u24 v217, v224, v242
    v_mul_u32_u24 v218, v225, v241
    v_mul_u32_u24 v219, v225, v242
    v_mul_u32_u24 v220, v226, v241
    v_mul_u32_u24 v221, v226, v242
    v_mul_u32_u24 v222, v227, v241
    v_mul_u32_u24 v223, v227, v242
    v_add_u32 v238, 128, v238
    ds_read_b128 v[164:167], v239
    v_mfma_f32_4x4x4_16b_bf16 v[132:135], v[216:217], v[68:69], v[4:7]
    ds_read_b128 v[168:171], v239 offset:64
    ds_read_b128 v[172:175], v239 offset:128
    v_mfma_f32_4x4x4_16b_bf16 v[136:139], v[218:219], v[70:71], v[8:11]
    ds_read_b128 v[176:179], v239 offset:192
    ds_read_u16 v224, v238
    v_mfma_f32_4x4x4_16b_bf16 v[140:143], v[220:221], v[72:73], v[12:15]
    ds_read_u16 v225, v238 offset:8
    ds_read_u16 v226, v238 offset:64
    v_mfma_f32_4x4x4_16b_bf16 v[144:147], v[222:223], v[74:75], v[16:19]
    ds_read_u16 v227, v238 offset:72
    v_add_u32 v239, 272, v239
    v_mfma_f32_4x4x4_16b_bf16 v[246:249], v[216:217], v[76:77], v[20:23]
    v_cvt_pk_bf16_f32 v100, v132, v133
    v_cvt_pk_bf16_f32 v101, v134, v135
    v_mfma_f32_4x4x4_16b_bf16 v[250:253], v[218:219], v[78:79], v[24:27]
    v_cvt_pk_bf16_f32 v102, v136, v137
    v_cvt_pk_bf16_f32 v103, v138, v139
    v_mfma_f32_4x4x4_16b_bf16 v[132:135], v[220:221], v[80:81], v[28:31]
    v_cvt_pk_bf16_f32 v104, v140, v141
    v_cvt_pk_bf16_f32 v105, v142, v143
    v_mfma_f32_4x4x4_16b_bf16 v[136:139], v[222:223], v[82:83], v[32:35]
    v_cvt_pk_bf16_f32 v106, v144, v145
    v_cvt_pk_bf16_f32 v107, v146, v147
    v_mfma_f32_4x4x4_16b_bf16 v[140:143], v[216:217], v[84:85], v[36:39]
    v_cvt_pk_bf16_f32 v108, v246, v247
    v_cvt_pk_bf16_f32 v109, v248, v249
    v_mfma_f32_4x4x4_16b_bf16 v[144:147], v[218:219], v[86:87], v[40:43]
    v_cvt_pk_bf16_f32 v110, v250, v251
    v_cvt_pk_bf16_f32 v111, v252, v253
    v_mfma_f32_4x4x4_16b_bf16 v[246:249], v[220:221], v[88:89], v[44:47]
    v_cvt_pk_bf16_f32 v112, v132, v133
    v_cvt_pk_bf16_f32 v113, v134, v135
    v_mfma_f32_4x4x4_16b_bf16 v[250:253], v[222:223], v[90:91], v[48:51]
    v_cvt_pk_bf16_f32 v114, v136, v137
    v_cvt_pk_bf16_f32 v115, v138, v139
    v_mfma_f32_4x4x4_16b_bf16 v[132:135], v[216:217], v[92:93], v[52:55]
    v_cvt_pk_bf16_f32 v116, v140, v141
    v_cvt_pk_bf16_f32 v117, v142, v143
    v_mfma_f32_4x4x4_16b_bf16 v[136:139], v[218:219], v[94:95], v[56:59]
    v_cvt_pk_bf16_f32 v118, v144, v145
    v_cvt_pk_bf16_f32 v119, v146, v147
    v_mfma_f32_4x4x4_16b_bf16 v[140:143], v[220:221], v[96:97], v[60:63]
    v_cvt_pk_bf16_f32 v120, v246, v247
    v_cvt_pk_bf16_f32 v121, v248, v249
    v_mfma_f32_4x4x4_16b_bf16 v[144:147], v[222:223], v[98:99], v[64:67]
    v_cvt_pk_bf16_f32 v122, v250, v251
    v_cvt_pk_bf16_f32 v123, v252, v253
    v_cvt_pk_bf16_f32 v124, v132, v133
    v_cvt_pk_bf16_f32 v125, v134, v135
    v_cvt_pk_bf16_f32 v126, v136, v137
    v_cvt_pk_bf16_f32 v127, v138, v139
    v_cvt_pk_bf16_f32 v128, v140, v141
    v_cvt_pk_bf16_f32 v129, v142, v143
    v_cvt_pk_bf16_f32 v130, v144, v145
    v_cvt_pk_bf16_f32 v131, v146, v147
    s_waitcnt lgkmcnt(0)
    s_branch Lf_evd1
Lf_ev2:
    s_bitcmp0_b64 s[56:57], 2
    s_cbranch_scc1 Lf_nf2
    v_cvt_pk_bf16_f32 v246, v212, v212
    v_mov_b32 v212, 0
    ds_write_b16 v240, v246
    v_add_u32 v240, 128, v240
Lf_nf2:
    s_bitcmp0_b64 s[56:57], 7
    s_cbranch_scc1 Lf_na2
    s_add_u32 s35, s35, s31
    s_min_u32 s35, s35, 419404800
    s_xor_b32 s31, s31, 0x63ff800
Lf_na2:
    s_bitcmp0_b64 s[56:57], 4
    s_cbranch_scc1 Lf_evd2
Lf_e12:
    s_sub_u32 s61, s61, 1
    s_cbranch_scc1 Lf_last2
    v_mul_u32_u24 v216, v224, v241
    v_mul_u32_u24 v217, v224, v242
    v_mul_u32_u24 v218, v225, v241
    v_mul_u32_u24 v219, v225, v242
    v_mul_u32_u24 v220, v226, v241
    v_mul_u32_u24 v221, v226, v242
    v_mul_u32_u24 v222, v227, v241
    v_mul_u32_u24 v223, v227, v242
    v_add_u32 v238, 128, v238
    ds_read_b128 v[164:167], v239
    v_mfma_f32_4x4x4_16b_bf16 v[132:135], v[216:217], v[68:69], v[4:7]
    ds_read_b128 v[168:171], v239 offset:64
    ds_read_b128 v[172:175], v239 offset:128
    v_mfma_f32_4x4x4_16b_bf16 v[136:139], v[218:219], v[70:71], v[8:11]
    ds_read_b128 v[176:179], v239 offset:192
    ds_read_u16 v224, v238
    v_mfma_f32_4x4x4_16b_bf16 v[140:143], v[220:221], v[72:73], v[12:15]
    ds_read_u16 v225, v238 offset:8
    ds_read_u16 v226, v238 offset:64
    v_mfma_f32_4x4x4_16b_bf16 v[144:147], v[222:223], v[74:75], v[16:19]
    ds_read_u16 v227, v238 offset:72
    v_add_u32 v239, 272, v239
    v_mfma_f32_4x4x4_16b_bf16 v[246:249], v[216:217], v[76:77], v[20:23]
    v_cvt_pk_bf16_f32 v100, v132, v133
    v_cvt_pk_bf16_f32 v101, v134, v135
    v_mfma_f32_4x4x4_16b_bf16 v[250:253], v[218:219], v[78:79], v[24:27]
    v_cvt_pk_bf16_f32 v102, v136, v137
    v_cvt_pk_bf16_f32 v103, v138, v139
    v_mfma_f32_4x4x4_16b_bf16 v[132:135], v[220:221], v[80:81], v[28:31]
    v_cvt_pk_bf16_f32 v104, v140, v141
    v_cvt_pk_bf16_f32 v105, v142, v143
    v_mfma_f32_4x4x4_16b_bf16 v[136:139], v[222:223], v[82:83], v[32:35]
    v_cvt_pk_bf16_f32 v106, v144, v145
    v_cvt_pk_bf16_f32 v107, v146, v147
    v_mfma_f32_4x4x4_16b_bf16 v[140:143], v[216:217], v[84:85], v[36:39]
    v_cvt_pk_bf16_f32 v108, v246, v247
    v_cvt_pk_bf16_f32 v109, v248, v249
    v_mfma_f32_4x4x4_16b_bf16 v[144:147], v[218:219], v[86:87], v[40:43]
    v_cvt_pk_bf16_f32 v110, v250, v251
    v_cvt_pk_bf16_f32 v111, v252, v253
    v_mfma_f32_4x4x4_16b_bf16 v[246:249], v[220:221], v[88:89], v[44:47]
    v_cvt_pk_bf16_f32 v112, v132, v133
    v_cvt_pk_bf16_f32 v113, v134, v135
    v_mfma_f32_4x4x4_16b_bf16 v[250:253], v[222:223], v[90:91], v[48:51]
    v_cvt_pk_bf16_f32 v114, v136, v137
    v_cvt_pk_bf16_f32 v115, v138, v139
    v_mfma_f32_4x4x4_16b_bf16 v[132:135], v[216:217], v[92:93], v[52:55]
    v_cvt_pk_bf16_f32 v116, v140, v141
    v_cvt_pk_bf16_f32 v117, v142, v143
    v_mfma_f32_4x4x4_16b_bf16 v[136:139], v[218:219], v[94:95], v[56:59]
    v_cvt_pk_bf16_f32 v118, v144, v145
    v_cvt_pk_bf16_f32 v119, v146, v147
    v_mfma_f32_4x4x4_16b_bf16 v[140:143], v[220:221], v[96:97], v[60:63]
    v_cvt_pk_bf16_f32 v120, v246, v247
    v_cvt_pk_bf16_f32 v121, v248, v249
    v_mfma_f32_4x4x4_16b_bf16 v[144:147], v[222:223], v[98:99], v[64:67]
    v_cvt_pk_bf16_f32 v122, v250, v251
    v_cvt_pk_bf16_f32 v123, v252, v253
    v_cvt_pk_bf16_f32 v124, v132, v133
    v_cvt_pk_bf16_f32 v125, v134, v135
    v_cvt_pk_bf16_f32 v126, v136, v137
    v_cvt_pk_bf16_f32 v127, v138, v139
    v_cvt_pk_bf16_f32 v128, v140, v141
    v_cvt_pk_bf16_f32 v129, v142, v143
    v_cvt_pk_bf16_f32 v130, v144, v145
    v_cvt_pk_bf16_f32 v131, v146, v147
    s_waitcnt lgkmcnt(0)
    s_branch Lf_evd2
Lf_ev3:
    s_bitcmp0_b64 s[56:57], 3
    s_cbranch_scc1 Lf_nf3
    v_cvt_pk_bf16_f32 v246, v212, v212
    v_mov_b32 v212, 0
    ds_write_b16 v240, v246
    v_add_u32 v240, 128, v240
Lf_nf3:
    s_bitcmp0_b64 s[56:57], 8
    s_cbranch_scc1 Lf_na3
    s_add_u32 s35, s35, s31
    s_min_u32 s35, s35, 419404800
    s_xor_b32 s31, s31, 0x63ff800
Lf_na3:
    s_bitcmp0_b64 s[56:57], 5
    s_cbranch_scc1 Lf_evd3
Lf_e13:
    s_sub_u32 s61, s61, 1
    s_cbranch_scc1 Lf_last3
    v_mul_u32_u24 v216, v224, v241
    v_mul_u32_u24 v217, v224, v242
    v_mul_u32_u24 v218, v225, v241
    v_mul_u32_u24 v219, v225, v242
    v_mul_u32_u24 v220, v226, v241
    v_mul_u32_u24 v221, v226, v242
    v_mul_u32_u24 v222, v227, v241
    v_mul_u32_u24 v223, v227, v242
    v_add_u32 v238, 128, v238
    ds_read_b128 v[164:167], v239
    v_mfma_f32_4x4x4_16b_bf16 v[132:135], v[216:217], v[68:69], v[4:7]
    ds_read_b128 v[168:171], v239 offset:64
    ds_read_b128 v[172:175], v239 offset:128
    v_mfma_f32_4x4x4_16b_bf16 v[136:139], v[218:219], v[70:71], v[8:11]
    ds_read_b128 v[176:179], v239 offset:192
    ds_read_u16 v224, v238
    v_mfma_f32_4x4x4_16b_bf16 v[140:143], v[220:221], v[72:73], v[12:15]
    ds_read_u16 v225, v238 offset:8
    ds_read_u16 v226, v238 offset:64
    v_mfma_f32_4x4x4_16b_bf16 v[144:147], v[222:223], v[74:75], v[16:19]
    ds_read_u16 v227, v238 offset:72
    v_add_u32 v239, 272, v239
    v_mfma_f32_4x4x4_16b_bf16 v[246:249], v[216:217], v[76:77], v[20:23]
    v_cvt_pk_bf16_f32 v100, v132, v133
    v_cvt_pk_bf16_f32 v101, v134, v135
    v_mfma_f32_4x4x4_16b_bf16 v[250:253], v[218:219], v[78:79], v[24:27]
    v_cvt_pk_bf16_f32 v102, v136, v137
    v_cvt_pk_bf16_f32 v103, v138, v139
    v_mfma_f32_4x4x4_16b_bf16 v[132:135], v[220:221], v[80:81], v[28:31]
    v_cvt_pk_bf16_f32 v104, v140, v141
    v_cvt_pk_bf16_f32 v105, v142, v143
    v_mfma_f32_4x4x4_16b_bf16 v[136:139], v[222:223], v[82:83], v[32:35]
    v_cvt_pk_bf16_f32 v106, v144, v145
    v_cvt_pk_bf16_f32 v107, v146, v147
    v_mfma_f32_4x4x4_16b_bf16 v[140:143], v[216:217], v[84:85], v[36:39]
    v_cvt_pk_bf16_f32 v108, v246, v247
    v_cvt_pk_bf16_f32 v109, v248, v249
    v_mfma_f32_4x4x4_16b_bf16 v[144:147], v[218:219], v[86:87], v[40:43]
    v_cvt_pk_bf16_f32 v110, v250, v251
    v_cvt_pk_bf16_f32 v111, v252, v253
    v_mfma_f32_4x4x4_16b_bf16 v[246:249], v[220:221], v[88:89], v[44:47]
    v_cvt_pk_bf16_f32 v112, v132, v133
    v_cvt_pk_bf16_f32 v113, v134, v135
    v_mfma_f32_4x4x4_16b_bf16 v[250:253], v[222:223], v[90:91], v[48:51]
    v_cvt_pk_bf16_f32 v114, v136, v137
    v_cvt_pk_bf16_f32 v115, v138, v139
    v_mfma_f32_4x4x4_16b_bf16 v[132:135], v[216:217], v[92:93], v[52:55]
    v_cvt_pk_bf16_f32 v116, v140, v141
    v_cvt_pk_bf16_f32 v117, v142, v143
    v_mfma_f32_4x4x4_16b_bf16 v[136:139], v[218:219], v[94:95], v[56:59]
    v_cvt_pk_bf16_f32 v118, v144, v145
    v_cvt_pk_bf16_f32 v119, v146, v147
    v_mfma_f32_4x4x4_16b_bf16 v[140:143], v[220:221], v[96:97], v[60:63]
    v_cvt_pk_bf16_f32 v120, v246, v247
    v_cvt_pk_bf16_f32 v121, v248, v249
    v_mfma_f32_4x4x4_16b_bf16 v[144:147], v[222:223], v[98:99], v[64:67]
    v_cvt_pk_bf16_f32 v122, v250, v251
    v_cvt_pk_bf16_f32 v123, v252, v253
    v_cvt_pk_bf16_f32 v124, v132, v133
    v_cvt_pk_bf16_f32 v125, v134, v135
    v_cvt_pk_bf16_f32 v126, v136, v137
    v_cvt_pk_bf16_f32 v127, v138, v139
    v_cvt_pk_bf16_f32 v128, v140, v141
    v_cvt_pk_bf16_f32 v129, v142, v143
    v_cvt_pk_bf16_f32 v130, v144, v145
    v_cvt_pk_bf16_f32 v131, v146, v147
    s_waitcnt lgkmcnt(0)
    s_branch Lf_evd3
Lf_last0:
    s_branch Lf_tail
Lf_last1:
    v_add_u32 v236, 2080, v236
    s_lshr_b64 s[56:57], s[56:57], 1
    s_branch Lf_tail
Lf_last2:
    v_add_u32 v236, 4160, v236
    s_lshr_b64 s[56:57], s[56:57], 2
    s_branch Lf_tail
Lf_last3:
    v_add_u32 v236, 6240, v236
    s_lshr_b64 s[56:57], s[56:57], 3
Lf_tail:
    v_exp_f32 v132, v148
    v_exp_f32 v133, v149
    v_exp_f32 v134, v150
    v_exp_f32 v135, v151
    v_exp_f32 v136, v152
    v_exp_f32 v137, v153
    v_mfma_f32_4x4x4_16b_bf16 v[132:135], v[228:229], v[228:229], v[132:135]
    v_cvt_pk_bf16_f32 v208, v208, v209
    v_cvt_pk_bf16_f32 v209, v210, v211
    v_exp_f32 v138, v154
    s_nop 0
    v_mfma_f32_4x4x4_16b_bf16 v[212:215], v[208:209], v[188:189], v[212:215] cbsz:4 abid:0
    ds_read_b64_tr_b16 v[188:189], v236 offset:0
    v_exp_f32 v139, v155
    v_exp_f32 v140, v156
    v_mfma_f32_4x4x4_16b_bf16 v[212:215], v[208:209], v[190:191], v[212:215] cbsz:4 abid:4
    ds_read_b64_tr_b16 v[190:191], v236 offset:512
    v_mfma_f32_4x4x4_16b_bf16 v[136:139], v[228:229], v[228:229], v[136:139]
    v_rcp_f32 v132, v132
    v_mfma_f32_4x4x4_16b_bf16 v[212:215], v[208:209], v[192:193], v[212:215] cbsz:4 abid:8
    ds_read_b64_tr_b16 v[192:193], v236 offset:1056
    v_exp_f32 v141, v157
    v_rcp_f32 v133, v133
    v_mfma_f32_4x4x4_16b_bf16 v[212:215], v[208:209], v[194:195], v[212:215] cbsz:4 abid:12
    ds_read_b64_tr_b16 v[194:195], v236 offset:1568
    v_exp_f32 v142, v158
    v_rcp_f32 v134, v134
    v_exp_f32 v143, v159
    v_rcp_f32 v135, v135
    v_cvt_pk_bf16_f32 v132, v132, v133
    v_mfma_f32_4x4x4_16b_bf16 v[140:143], v[228:229], v[228:229], v[140:143]
    v_exp_f32 v144, v160
    v_rcp_f32 v136, v136
    v_cvt_pk_bf16_f32 v133, v134, v135
    s_bitcmp0_b64 s[56:57], 1
    s_cbranch_scc1 Lf_tnf
    v_cvt_pk_bf16_f32 v246, v212, v212
    v_mov_b32 v212, 0
    ds_write_b16 v240, v246
    v_add_u32 v240, 128, v240
Lf_tnf:
    s_waitcnt lgkmcnt(0)
    v_exp_f32 v145, v161
    v_rcp_f32 v137, v137
    v_exp_f32 v146, v162
    v_rcp_f32 v138, v138
    v_cvt_pk_bf16_f32 v134, v136, v137
    v_exp_f32 v147, v163
    v_rcp_f32 v139, v139
    s_nop 0
    v_mfma_f32_4x4x4_16b_bf16 v[144:147], v[228:229], v[228:229], v[144:147]
    v_rcp_f32 v140, v140
    v_rcp_f32 v141, v141
    v_cvt_pk_bf16_f32 v135, v138, v139
    v_rcp_f32 v142, v142
    v_cvt_pk_bf16_f32 v136, v140, v141
    v_mfma_f32_16x16x32_bf16 v[208:211], v[132:135], v[196:199], v[204:207]
    v_rcp_f32 v143, v143
    v_rcp_f32 v144, v144
    v_cvt_pk_bf16_f32 v137, v142, v143
    v_rcp_f32 v145, v145
    v_rcp_f32 v146, v146
    v_rcp_f32 v147, v147
    v_cvt_pk_bf16_f32 v138, v144, v145
    v_cvt_pk_bf16_f32 v139, v146, v147
    s_nop 1
    v_mfma_f32_16x16x32_bf16 v[208:211], v[136:139], v[200:203], v[208:211]
    s_nop 7
    v_cvt_pk_bf16_f32 v208, v208, v209
    v_cvt_pk_bf16_f32 v209, v210, v211
    s_nop 1
    v_mfma_f32_4x4x4_16b_bf16 v[212:215], v[208:209], v[188:189], v[212:215] cbsz:4 abid:0
    s_nop 1
    v_mfma_f32_4x4x4_16b_bf16 v[212:215], v[208:209], v[190:191], v[212:215] cbsz:4 abid:4
    s_nop 1
    v_mfma_f32_4x4x4_16b_bf16 v[212:215], v[208:209], v[192:193], v[212:215] cbsz:4 abid:8
    s_nop 1
    v_mfma_f32_4x4x4_16b_bf16 v[212:215], v[208:209], v[194:195], v[212:215] cbsz:4 abid:12
    s_nop 4
    v_cvt_pk_bf16_f32 v246, v212, v212
    ds_write_b16 v240, v246
L_store:
    s_add_u32 s66, s52, 8320
    v_lshl_add_u32 v247, v0, 4, s66
    ds_read_b128 v[148:151], v247
    s_waitcnt lgkmcnt(0)
    global_store_dwordx4 v243, v[148:151], s[18:19] sc0 sc1
L_end:
    s_endpgm
L_general:
    s_waitcnt vmcnt(0)
    ds_read_b128 v[44:47], v246 offset:20480
    ds_read_b128 v[48:51], v246 offset:21504
    ds_read_b128 v[88:91], v246 offset:22528
    ds_read_b128 v[52:55], v246 offset:40960
    ds_read_b128 v[56:59], v246 offset:41984
    ds_read_b128 v[92:95], v246 offset:43008
    ds_read_b128 v[60:63], v246 offset:61440
    ds_read_b128 v[64:67], v246 offset:62464
    ds_read_b128 v[96:99], v246 offset:63488
    ds_read_u16 v224, v238 offset:0
    ds_read_u16 v225, v238 offset:8
    ds_read_u16 v226, v238 offset:64
    ds_read_u16 v227, v238 offset:72
    s_mul_i32 s35, s53, 51200
    s_movk_i32 s31, 25600
    s_mov_b64 s[56:57], 0
    s_mov_b64 s[58:59], 0
    v_mov_b32 v148, -1
    v_mov_b32 v149, -1
    v_mov_b32 v150, -1
    v_mov_b32 v151, -1
    s_add_u32 s66, s52, 18432
    v_add_u32 v152, s66, v2
    ds_write_b128 v152, v[148:151]
    ds_write_b128 v152, v[148:151] offset:1024
    s_add_u32 s64, s52, 18448
    s_bfm_b64 s[28:29], 50, 0
    s_mul_i32 s66, s53, 800
    v_add_u32 v247, s66, v2
    s_mov_b64 exec, s[28:29]
    global_load_dwordx4 v[100:103], v247, s[8:9]
    v_add_u32 v247, 1638400, v247
    global_load_dwordx4 v[104:107], v247, s[8:9]
    v_add_u32 v247, 1638400, v247
    global_load_dwordx4 v[108:111], v247, s[8:9]
    v_add_u32 v247, 1638400, v247
    global_load_dwordx4 v[112:115], v247, s[8:9]
    v_add_u32 v247, 1638400, v247
    s_mov_b64 exec, -1
    v_cmp_lt_u32 vcc, 24, v0
    s_nop 1
    v_cndmask_b32 v145, 0, 1, vcc
    v_mul_u32_u24 v142, 25, v145
    v_sub_u32 v142, v0, v142
    v_mul_u32_u24 v142, 0x80008, v142
    v_add_u32 v141, 0x10000, v142
    v_add_u32 v143, 0x50004, v142
    v_add_u32 v144, 0x70006, v142
    v_add_u32 v142, 0x30002, v142
    s_waitcnt vmcnt(0)
    s_mov_b64 exec, s[28:29]
    v_cmp_neq_f16_sdwa s[68:69], v100, 0 src0_sel:WORD_0 src1_sel:WORD_0
    v_cmp_neq_f16_sdwa s[70:71], v100, 0 src0_sel:WORD_1 src1_sel:WORD_0
    v_cmp_neq_f16_sdwa s[72:73], v101, 0 src0_sel:WORD_0 src1_sel:WORD_0
    v_cmp_neq_f16_sdwa s[74:75], v101, 0 src0_sel:WORD_1 src1_sel:WORD_0
    v_cmp_neq_f16_sdwa s[76:77], v102, 0 src0_sel:WORD_0 src1_sel:WORD_0
    v_cmp_neq_f16_sdwa s[78:79], v102, 0 src0_sel:WORD_1 src1_sel:WORD_0
    v_cmp_neq_f16_sdwa s[80:81], v103, 0 src0_sel:WORD_0 src1_sel:WORD_0
    v_cmp_neq_f16_sdwa s[82:83], v103, 0 src0_sel:WORD_1 src1_sel:WORD_0
    s_mov_b64 exec, -1
    v_mov_b32 v132, s64
    v_mbcnt_lo_u32_b32 v132, s68, v132
    v_mbcnt_hi_u32_b32 v132, s69, v132
    v_mbcnt_lo_u32_b32 v132, s70, v132
    v_mbcnt_hi_u32_b32 v132, s71, v132
    v_mbcnt_lo_u32_b32 v132, s72, v132
    v_mbcnt_hi_u32_b32 v132, s73, v132
    v_mbcnt_lo_u32_b32 v132, s74, v132
    v_mbcnt_hi_u32_b32 v132, s75, v132
    v_mbcnt_lo_u32_b32 v132, s76, v132
    v_mbcnt_hi_u32_b32 v132, s77, v132
    v_mbcnt_lo_u32_b32 v132, s78, v132
    v_mbcnt_hi_u32_b32 v132, s79, v132
    v_mbcnt_lo_u32_b32 v132, s80, v132
    v_mbcnt_hi_u32_b32 v132, s81, v132
    v_mbcnt_lo_u32_b32 v132, s82, v132
    v_mbcnt_hi_u32_b32 v132, s83, v132
    s_add_u32 s55, s64, 16
    v_readlane_b32 s66, v132, 25
    v_readlane_b32 s67, v132, 63
    s_add_u32 s64, s66, 15
    s_and_b32 s64, s64, -16
    s_max_u32 s64, s64, s55
    s_sub_u32 s66, s64, s66
    v_mad_u32_u24 v132, v145, s66, v132
    s_mov_b32 s55, s64
    v_addc_co_u32 v133, vcc, 0, v132, s[68:69]
    v_addc_co_u32 v134, vcc, 0, v133, s[70:71]
    v_addc_co_u32 v135, vcc, 0, v134, s[72:73]
    v_addc_co_u32 v136, vcc, 0, v135, s[74:75]
    v_addc_co_u32 v137, vcc, 0, v136, s[76:77]
    v_addc_co_u32 v138, vcc, 0, v137, s[78:79]
    v_addc_co_u32 v139, vcc, 0, v138, s[80:81]
    s_add_u32 s67, s67, s66
    s_add_u32 s67, s67, 15
    s_and_b32 s67, s67, -16
    s_add_u32 s64, s64, 16
    s_max_u32 s64, s64, s67
    s_mov_b64 exec, s[68:69]
    ds_write_b8 v132, v141
    s_mov_b64 exec, s[70:71]
    ds_write_b8_d16_hi v133, v141
    s_mov_b64 exec, s[72:73]
    ds_write_b8 v134, v142
    s_mov_b64 exec, s[74:75]
    ds_write_b8_d16_hi v135, v142
    s_mov_b64 exec, s[76:77]
    ds_write_b8 v136, v143
    s_mov_b64 exec, s[78:79]
    ds_write_b8_d16_hi v137, v143
    s_mov_b64 exec, s[80:81]
    ds_write_b8 v138, v144
    s_mov_b64 exec, s[82:83]
    ds_write_b8_d16_hi v139, v144
    s_mov_b64 exec, -1
    s_lshr_b32 s95, s55, 4
    s_bitset1_b64 s[56:57], s95
    s_lshr_b32 s95, s64, 4
    s_bitset1_b64 s[56:57], s95
    s_mov_b64 exec, s[28:29]
    v_cmp_neq_f16_sdwa s[68:69], v104, 0 src0_sel:WORD_0 src1_sel:WORD_0
    v_cmp_neq_f16_sdwa s[70:71], v104, 0 src0_sel:WORD_1 src1_sel:WORD_0
    v_cmp_neq_f16_sdwa s[72:73], v105, 0 src0_sel:WORD_0 src1_sel:WORD_0
    v_cmp_neq_f16_sdwa s[74:75], v105, 0 src0_sel:WORD_1 src1_sel:WORD_0
    v_cmp_neq_f16_sdwa s[76:77], v106, 0 src0_sel:WORD_0 src1_sel:WORD_0
    v_cmp_neq_f16_sdwa s[78:79], v106, 0 src0_sel:WORD_1 src1_sel:WORD_0
    v_cmp_neq_f16_sdwa s[80:81], v107, 0 src0_sel:WORD_0 src1_sel:WORD_0
    v_cmp_neq_f16_sdwa s[82:83], v107, 0 src0_sel:WORD_1 src1_sel:WORD_0
    s_mov_b64 exec, -1
    v_mov_b32 v132, s64
    v_mbcnt_lo_u32_b32 v132, s68, v132
    v_mbcnt_hi_u32_b32 v132, s69, v132
    v_mbcnt_lo_u32_b32 v132, s70, v132
    v_mbcnt_hi_u32_b32 v132, s71, v132
    v_mbcnt_lo_u32_b32 v132, s72, v132
    v_mbcnt_hi_u32_b32 v132, s73, v132
    v_mbcnt_lo_u32_b32 v132, s74, v132
    v_mbcnt_hi_u32_b32 v132, s75, v132
    v_mbcnt_lo_u32_b32 v132, s76, v132
    v_mbcnt_hi_u32_b32 v132, s77, v132
    v_mbcnt_lo_u32_b32 v132, s78, v132
    v_mbcnt_hi_u32_b32 v132, s79, v132
    v_mbcnt_lo_u32_b32 v132, s80, v132
    v_mbcnt_hi_u32_b32 v132, s81, v132
    v_mbcnt_lo_u32_b32 v132, s82, v132
    v_mbcnt_hi_u32_b32 v132, s83, v132
    s_add_u32 s55, s64, 16
    v_readlane_b32 s66, v132, 25
    v_readlane_b32 s67, v132, 63
    s_add_u32 s64, s66, 15
    s_and_b32 s64, s64, -16
    s_max_u32 s64, s64, s55
    s_sub_u32 s66, s64, s66
    v_mad_u32_u24 v132, v145, s66, v132
    s_mov_b32 s55, s64
    v_addc_co_u32 v133, vcc, 0, v132, s[68:69]
    v_addc_co_u32 v134, vcc, 0, v133, s[70:71]
    v_addc_co_u32 v135, vcc, 0, v134, s[72:73]
    v_addc_co_u32 v136, vcc, 0, v135, s[74:75]
    v_addc_co_u32 v137, vcc, 0, v136, s[76:77]
    v_addc_co_u32 v138, vcc, 0, v137, s[78:79]
    v_addc_co_u32 v139, vcc, 0, v138, s[80:81]
    s_add_u32 s67, s67, s66
    s_add_u32 s67, s67, 15
    s_and_b32 s67, s67, -16
    s_add_u32 s64, s64, 16
    s_max_u32 s64, s64, s67
    s_mov_b64 exec, s[68:69]
    ds_write_b8 v132, v141
    s_mov_b64 exec, s[70:71]
    ds_write_b8_d16_hi v133, v141
    s_mov_b64 exec, s[72:73]
    ds_write_b8 v134, v142
    s_mov_b64 exec, s[74:75]
    ds_write_b8_d16_hi v135, v142
    s_mov_b64 exec, s[76:77]
    ds_write_b8 v136, v143
    s_mov_b64 exec, s[78:79]
    ds_write_b8_d16_hi v137, v143
    s_mov_b64 exec, s[80:81]
    ds_write_b8 v138, v144
    s_mov_b64 exec, s[82:83]
    ds_write_b8_d16_hi v139, v144
    s_mov_b64 exec, -1
    s_lshr_b32 s95, s55, 4
    s_bitset1_b64 s[56:57], s95
    s_lshr_b32 s95, s64, 4
    s_bitset1_b64 s[56:57], s95
    s_mov_b64 exec, s[28:29]
    v_cmp_neq_f16_sdwa s[68:69], v108, 0 src0_sel:WORD_0 src1_sel:WORD_0
    v_cmp_neq_f16_sdwa s[70:71], v108, 0 src0_sel:WORD_1 src1_sel:WORD_0
    v_cmp_neq_f16_sdwa s[72:73], v109, 0 src0_sel:WORD_0 src1_sel:WORD_0
    v_cmp_neq_f16_sdwa s[74:75], v109, 0 src0_sel:WORD_1 src1_sel:WORD_0
    v_cmp_neq_f16_sdwa s[76:77], v110, 0 src0_sel:WORD_0 src1_sel:WORD_0
    v_cmp_neq_f16_sdwa s[78:79], v110, 0 src0_sel:WORD_1 src1_sel:WORD_0
    v_cmp_neq_f16_sdwa s[80:81], v111, 0 src0_sel:WORD_0 src1_sel:WORD_0
    v_cmp_neq_f16_sdwa s[82:83], v111, 0 src0_sel:WORD_1 src1_sel:WORD_0
    s_mov_b64 exec, -1
    v_mov_b32 v132, s64
    v_mbcnt_lo_u32_b32 v132, s68, v132
    v_mbcnt_hi_u32_b32 v132, s69, v132
    v_mbcnt_lo_u32_b32 v132, s70, v132
    v_mbcnt_hi_u32_b32 v132, s71, v132
    v_mbcnt_lo_u32_b32 v132, s72, v132
    v_mbcnt_hi_u32_b32 v132, s73, v132
    v_mbcnt_lo_u32_b32 v132, s74, v132
    v_mbcnt_hi_u32_b32 v132, s75, v132
    v_mbcnt_lo_u32_b32 v132, s76, v132
    v_mbcnt_hi_u32_b32 v132, s77, v132
    v_mbcnt_lo_u32_b32 v132, s78, v132
    v_mbcnt_hi_u32_b32 v132, s79, v132
    v_mbcnt_lo_u32_b32 v132, s80, v132
    v_mbcnt_hi_u32_b32 v132, s81, v132
    v_mbcnt_lo_u32_b32 v132, s82, v132
    v_mbcnt_hi_u32_b32 v132, s83, v132
    s_add_u32 s55, s64, 16
    v_readlane_b32 s66, v132, 25
    v_readlane_b32 s67, v132, 63
    s_add_u32 s64, s66, 15
    s_and_b32 s64, s64, -16
    s_max_u32 s64, s64, s55
    s_sub_u32 s66, s64, s66
    v_mad_u32_u24 v132, v145, s66, v132
    s_mov_b32 s55, s64
    v_addc_co_u32 v133, vcc, 0, v132, s[68:69]
    v_addc_co_u32 v134, vcc, 0, v133, s[70:71]
    v_addc_co_u32 v135, vcc, 0, v134, s[72:73]
    v_addc_co_u32 v136, vcc, 0, v135, s[74:75]
    v_addc_co_u32 v137, vcc, 0, v136, s[76:77]
    v_addc_co_u32 v138, vcc, 0, v137, s[78:79]
    v_addc_co_u32 v139, vcc, 0, v138, s[80:81]
    s_add_u32 s67, s67, s66
    s_add_u32 s67, s67, 15
    s_and_b32 s67, s67, -16
    s_add_u32 s64, s64, 16
    s_max_u32 s64, s64, s67
    s_mov_b64 exec, s[68:69]
    ds_write_b8 v132, v141
    s_mov_b64 exec, s[70:71]
    ds_write_b8_d16_hi v133, v141
    s_mov_b64 exec, s[72:73]
    ds_write_b8 v134, v142
    s_mov_b64 exec, s[74:75]
    ds_write_b8_d16_hi v135, v142
    s_mov_b64 exec, s[76:77]
    ds_write_b8 v136, v143
    s_mov_b64 exec, s[78:79]
    ds_write_b8_d16_hi v137, v143
    s_mov_b64 exec, s[80:81]
    ds_write_b8 v138, v144
    s_mov_b64 exec, s[82:83]
    ds_write_b8_d16_hi v139, v144
    s_mov_b64 exec, -1
    s_lshr_b32 s95, s55, 4
    s_lshl_b64 s[86:87], 1, s95
    s_bitcmp1_b32 s55, 10
    s_cselect_b64 s[88:89], 0, s[86:87]
    s_cselect_b64 s[90:91], s[86:87], 0
    s_or_b64 s[56:57], s[56:57], s[88:89]
    s_or_b64 s[58:59], s[58:59], s[90:91]
    s_lshr_b32 s95, s64, 4
    s_lshl_b64 s[86:87], 1, s95
    s_bitcmp1_b32 s64, 10
    s_cselect_b64 s[88:89], 0, s[86:87]
    s_cselect_b64 s[90:91], s[86:87], 0
    s_or_b64 s[56:57], s[56:57], s[88:89]
    s_or_b64 s[58:59], s[58:59], s[90:91]
    s_mov_b64 exec, s[28:29]
    v_cmp_neq_f16_sdwa s[68:69], v112, 0 src0_sel:WORD_0 src1_sel:WORD_0
    v_cmp_neq_f16_sdwa s[70:71], v112, 0 src0_sel:WORD_1 src1_sel:WORD_0
    v_cmp_neq_f16_sdwa s[72:73], v113, 0 src0_sel:WORD_0 src1_sel:WORD_0
    v_cmp_neq_f16_sdwa s[74:75], v113, 0 src0_sel:WORD_1 src1_sel:WORD_0
    v_cmp_neq_f16_sdwa s[76:77], v114, 0 src0_sel:WORD_0 src1_sel:WORD_0
    v_cmp_neq_f16_sdwa s[78:79], v114, 0 src0_sel:WORD_1 src1_sel:WORD_0
    v_cmp_neq_f16_sdwa s[80:81], v115, 0 src0_sel:WORD_0 src1_sel:WORD_0
    v_cmp_neq_f16_sdwa s[82:83], v115, 0 src0_sel:WORD_1 src1_sel:WORD_0
    s_mov_b64 exec, -1
    v_mov_b32 v132, s64
    v_mbcnt_lo_u32_b32 v132, s68, v132
    v_mbcnt_hi_u32_b32 v132, s69, v132
    v_mbcnt_lo_u32_b32 v132, s70, v132
    v_mbcnt_hi_u32_b32 v132, s71, v132
    v_mbcnt_lo_u32_b32 v132, s72, v132
    v_mbcnt_hi_u32_b32 v132, s73, v132
    v_mbcnt_lo_u32_b32 v132, s74, v132
    v_mbcnt_hi_u32_b32 v132, s75, v132
    v_mbcnt_lo_u32_b32 v132, s76, v132
    v_mbcnt_hi_u32_b32 v132, s77, v132
    v_mbcnt_lo_u32_b32 v132, s78, v132
    v_mbcnt_hi_u32_b32 v132, s79, v132
    v_mbcnt_lo_u32_b32 v132, s80, v132
    v_mbcnt_hi_u32_b32 v132, s81, v132
    v_mbcnt_lo_u32_b32 v132, s82, v132
    v_mbcnt_hi_u32_b32 v132, s83, v132
    s_add_u32 s55, s64, 16
    v_readlane_b32 s66, v132, 25
    v_readlane_b32 s67, v132, 63
    s_add_u32 s64, s66, 15
    s_and_b32 s64, s64, -16
    s_max_u32 s64, s64, s55
    s_sub_u32 s66, s64, s66
    v_mad_u32_u24 v132, v145, s66, v132
    s_mov_b32 s55, s64
    v_addc_co_u32 v133, vcc, 0, v132, s[68:69]
    v_addc_co_u32 v134, vcc, 0, v133, s[70:71]
    v_addc_co_u32 v135, vcc, 0, v134, s[72:73]
    v_addc_co_u32 v136, vcc, 0, v135, s[74:75]
    v_addc_co_u32 v137, vcc, 0, v136, s[76:77]
    v_addc_co_u32 v138, vcc, 0, v137, s[78:79]
    v_addc_co_u32 v139, vcc, 0, v138, s[80:81]
    s_add_u32 s67, s67, s66
    s_add_u32 s67, s67, 15
    s_and_b32 s67, s67, -16
    s_add_u32 s64, s64, 16
    s_max_u32 s64, s64, s67
    s_mov_b64 exec, s[68:69]
    ds_write_b8 v132, v141
    s_mov_b64 exec, s[70:71]
    ds_write_b8_d16_hi v133, v141
    s_mov_b64 exec, s[72:73]
    ds_write_b8 v134, v142
    s_mov_b64 exec, s[74:75]
    ds_write_b8_d16_hi v135, v142
    s_mov_b64 exec, s[76:77]
    ds_write_b8 v136, v143
    s_mov_b64 exec, s[78:79]
    ds_write_b8_d16_hi v137, v143
    s_mov_b64 exec, s[80:81]
    ds_write_b8 v138, v144
    s_mov_b64 exec, s[82:83]
    ds_write_b8_d16_hi v139, v144
    s_mov_b64 exec, -1
    s_lshr_b32 s95, s55, 4
    s_lshl_b64 s[86:87], 1, s95
    s_bitcmp1_b32 s55, 10
    s_cselect_b64 s[88:89], 0, s[86:87]
    s_cselect_b64 s[90:91], s[86:87], 0
    s_or_b64 s[56:57], s[56:57], s[88:89]
    s_or_b64 s[58:59], s[58:59], s[90:91]
    s_lshr_b32 s95, s64, 4
    s_lshl_b64 s[86:87], 1, s95
    s_bitcmp1_b32 s64, 10
    s_cselect_b64 s[88:89], 0, s[86:87]
    s_cselect_b64 s[90:91], s[86:87], 0
    s_or_b64 s[56:57], s[56:57], s[88:89]
    s_or_b64 s[58:59], s[58:59], s[90:91]
    s_mov_b32 s94, 0
    s_mov_b64 s[84:85], -1
    s_branch L_listed
Ls_loop:
    ds_read_u8 v230, v237 offset:64
    ds_read_u8 v232, v237 offset:72
    v_mfma_f32_16x16x32_bf16 v[208:211], v[136:139], v[200:203], v[208:211]
Ls_mid:
    s_bitcmp1_b32 s36, 0
    s_cbranch_scc1 Ls_ev0
Ls_evd0:
    ds_read_b32 v246, v244 offset:0
    s_waitcnt lgkmcnt(0)
    v_bfe_u32 v247, v246, 0, 8
    v_lshlrev_b32 v247, 1, v247
    v_bfe_u32 v248, v246, 8, 8
    v_lshlrev_b32 v248, 1, v248
    v_bfe_u32 v249, v246, 16, 8
    v_lshlrev_b32 v249, 1, v249
    v_bfe_u32 v250, v246, 24, 8
    v_lshlrev_b32 v250, 1, v250
    buffer_load_ushort v247, v247, s[24:27], 0 offen
    buffer_load_ushort v248, v248, s[24:27], 0 offen
    buffer_load_ushort v249, v249, s[24:27], 0 offen
    buffer_load_ushort v250, v250, s[24:27], 0 offen
    s_waitcnt vmcnt(0)
    v_lshlrev_b32 v247, 16, v247
    v_mul_f32 v208, v208, v247
    v_lshlrev_b32 v248, 16, v248
    v_mul_f32 v209, v209, v248
    v_lshlrev_b32 v249, 16, v249
    v_mul_f32 v210, v210, v249
    v_lshlrev_b32 v250, 16, v250
    v_mul_f32 v211, v211, v250
    ds_add_rtn_u32 v1, v2, v3
    v_exp_f32 v132, v148
    v_exp_f32 v133, v149
    v_exp_f32 v134, v150
    v_exp_f32 v135, v151
    v_exp_f32 v136, v152
    v_exp_f32 v137, v153
    v_mfma_f32_4x4x4_16b_bf16 v[132:135], v[228:229], v[228:229], v[132:135]
    v_cvt_pk_bf16_f32 v208, v208, v209
    v_cvt_pk_bf16_f32 v209, v210, v211
    s_waitcnt lgkmcnt(2)
    v_mfma_f32_16x16x32_bf16 v[148:151], v[100:103], v[180:183], v[164:167]
    v_exp_f32 v138, v154
    v_mfma_f32_4x4x4_16b_bf16 v[212:215], v[208:209], v[188:189], v[212:215] cbsz:4 abid:0
    ds_read_b64_tr_b16 v[188:189], v236 offset:0
    v_exp_f32 v139, v155
    v_mfma_f32_16x16x32_bf16 v[152:155], v[108:111], v[180:183], v[168:171]
    v_exp_f32 v140, v156
    v_mfma_f32_4x4x4_16b_bf16 v[212:215], v[208:209], v[190:191], v[212:215] cbsz:4 abid:4
    ds_read_b64_tr_b16 v[190:191], v236 offset:512
    v_mfma_f32_4x4x4_16b_bf16 v[136:139], v[228:229], v[228:229], v[136:139]
    v_rcp_f32 v132, v132
    v_mfma_f32_4x4x4_16b_bf16 v[212:215], v[208:209], v[192:193], v[212:215] cbsz:4 abid:8
    ds_read_b64_tr_b16 v[192:193], v236 offset:1056
    v_exp_f32 v141, v157
    v_mfma_f32_16x16x32_bf16 v[148:151], v[104:107], v[184:187], v[148:151]
    v_rcp_f32 v133, v133
    v_mfma_f32_4x4x4_16b_bf16 v[212:215], v[208:209], v[194:195], v[212:215] cbsz:4 abid:12
    ds_read_b64_tr_b16 v[194:195], v236 offset:1568
    v_exp_f32 v142, v158
    v_mfma_f32_16x16x32_bf16 v[152:155], v[112:115], v[184:187], v[152:155]
    v_rcp_f32 v134, v134
    v_exp_f32 v143, v159
    v_rcp_f32 v135, v135
    v_cvt_pk_bf16_f32 v132, v132, v133
    v_mfma_f32_4x4x4_16b_bf16 v[140:143], v[228:229], v[228:229], v[140:143]
    v_exp_f32 v144, v160
    v_mfma_f32_16x16x32_bf16 v[156:159], v[116:119], v[180:183], v[172:175]
    v_rcp_f32 v136, v136
    v_cvt_pk_bf16_f32 v133, v134, v135
    s_add_u32 m0, s52, 0
    s_waitcnt lgkmcnt(0)
    buffer_load_dwordx4 v[230:231], s[20:23], s35 idxen offen nt lds
    v_exp_f32 v145, v161
    buffer_load_dwordx4 v[232:233], s[40:43], s35 idxen offen offset:1056 nt lds
    v_rcp_f32 v137, v137
    v_exp_f32 v146, v162
    v_rcp_f32 v138, v138
    v_cvt_pk_bf16_f32 v134, v136, v137
    v_exp_f32 v147, v163
    v_mfma_f32_16x16x32_bf16 v[160:163], v[124:127], v[180:183], v[176:179]
    v_readfirstlane_b32 s66, v1
    s_setprio 0
    s_cmp_gt_i32 s66, 0
    s_cbranch_scc0 Ls_lo0
    s_setprio 1
Ls_lo0:
    v_rcp_f32 v139, v139
    v_mfma_f32_4x4x4_16b_bf16 v[144:147], v[228:229], v[228:229], v[144:147]
    v_mfma_f32_16x16x32_bf16 v[156:159], v[120:123], v[184:187], v[156:159]
    v_rcp_f32 v140, v140
    v_mfma_f32_16x16x32_bf16 v[160:163], v[128:131], v[184:187], v[160:163]
    v_rcp_f32 v141, v141
    v_cvt_pk_bf16_f32 v135, v138, v139
    s_waitcnt vmcnt(4)
    ds_read_b128 v[180:183], v234 offset:4160
    ds_read_b128 v[184:187], v235 offset:4160
    v_rcp_f32 v142, v142
    v_cvt_pk_bf16_f32 v136, v140, v141
    v_mfma_f32_16x16x32_bf16 v[208:211], v[132:135], v[196:199], v[204:207]
    v_rcp_f32 v143, v143
    v_rcp_f32 v144, v144
    v_cvt_pk_bf16_f32 v137, v142, v143
    v_rcp_f32 v145, v145
    v_rcp_f32 v146, v146
    v_rcp_f32 v147, v147
    v_cvt_pk_bf16_f32 v138, v144, v145
    v_cvt_pk_bf16_f32 v139, v146, v147
    ds_read_u8 v230, v237 offset:80
    ds_read_u8 v232, v237 offset:88
    v_mfma_f32_16x16x32_bf16 v[208:211], v[136:139], v[200:203], v[208:211]
    s_bitcmp1_b32 s36, 1
    s_cbranch_scc1 Ls_ev1
Ls_evd1:
    ds_read_b32 v246, v244 offset:16
    s_waitcnt lgkmcnt(0)
    v_bfe_u32 v247, v246, 0, 8
    v_lshlrev_b32 v247, 1, v247
    v_bfe_u32 v248, v246, 8, 8
    v_lshlrev_b32 v248, 1, v248
    v_bfe_u32 v249, v246, 16, 8
    v_lshlrev_b32 v249, 1, v249
    v_bfe_u32 v250, v246, 24, 8
    v_lshlrev_b32 v250, 1, v250
    buffer_load_ushort v247, v247, s[24:27], 0 offen
    buffer_load_ushort v248, v248, s[24:27], 0 offen
    buffer_load_ushort v249, v249, s[24:27], 0 offen
    buffer_load_ushort v250, v250, s[24:27], 0 offen
    s_waitcnt vmcnt(0)
    v_lshlrev_b32 v247, 16, v247
    v_mul_f32 v208, v208, v247
    v_lshlrev_b32 v248, 16, v248
    v_mul_f32 v209, v209, v248
    v_lshlrev_b32 v249, 16, v249
    v_mul_f32 v210, v210, v249
    v_lshlrev_b32 v250, 16, v250
    v_mul_f32 v211, v211, v250
    v_exp_f32 v132, v148
    v_exp_f32 v133, v149
    v_exp_f32 v134, v150
    v_exp_f32 v135, v151
    v_exp_f32 v136, v152
    v_exp_f32 v137, v153
    v_mfma_f32_4x4x4_16b_bf16 v[132:135], v[228:229], v[228:229], v[132:135]
    v_cvt_pk_bf16_f32 v208, v208, v209
    v_cvt_pk_bf16_f32 v209, v210, v211
    s_waitcnt lgkmcnt(2)
    v_mfma_f32_16x16x32_bf16 v[148:151], v[100:103], v[180:183], v[164:167]
    v_exp_f32 v138, v154
    v_mfma_f32_4x4x4_16b_bf16 v[212:215], v[208:209], v[188:189], v[212:215] cbsz:4 abid:0
    ds_read_b64_tr_b16 v[188:189], v236 offset:2080
    v_exp_f32 v139, v155
    v_mfma_f32_16x16x32_bf16 v[152:155], v[108:111], v[180:183], v[168:171]
    v_exp_f32 v140, v156
    v_mfma_f32_4x4x4_16b_bf16 v[212:215], v[208:209], v[190:191], v[212:215] cbsz:4 abid:4
    ds_read_b64_tr_b16 v[190:191], v236 offset:2592
    v_mfma_f32_4x4x4_16b_bf16 v[136:139], v[228:229], v[228:229], v[136:139]
    v_rcp_f32 v132, v132
    v_mfma_f32_4x4x4_16b_bf16 v[212:215], v[208:209], v[192:193], v[212:215] cbsz:4 abid:8
    ds_read_b64_tr_b16 v[192:193], v236 offset:3136
    v_exp_f32 v141, v157
    v_mfma_f32_16x16x32_bf16 v[148:151], v[104:107], v[184:187], v[148:151]
    v_rcp_f32 v133, v133
    v_mfma_f32_4x4x4_16b_bf16 v[212:215], v[208:209], v[194:195], v[212:215] cbsz:4 abid:12
    ds_read_b64_tr_b16 v[194:195], v236 offset:3648
    v_exp_f32 v142, v158
    v_mfma_f32_16x16x32_bf16 v[152:155], v[112:115], v[184:187], v[152:155]
    v_rcp_f32 v134, v134
    v_exp_f32 v143, v159
    v_rcp_f32 v135, v135
    v_cvt_pk_bf16_f32 v132, v132, v133
    v_mfma_f32_4x4x4_16b_bf16 v[140:143], v[228:229], v[228:229], v[140:143]
    v_exp_f32 v144, v160
    v_mfma_f32_16x16x32_bf16 v[156:159], v[116:119], v[180:183], v[172:175]
    v_rcp_f32 v136, v136
    v_cvt_pk_bf16_f32 v133, v134, v135
    s_add_u32 m0, s52, 2080
    s_waitcnt lgkmcnt(0)
    buffer_load_dwordx4 v[230:231], s[20:23], s35 idxen offen nt lds
    v_exp_f32 v145, v161
    buffer_load_dwordx4 v[232:233], s[40:43], s35 idxen offen offset:1056 nt lds
    v_rcp_f32 v137, v137
    v_exp_f32 v146, v162
    v_rcp_f32 v138, v138
    v_cvt_pk_bf16_f32 v134, v136, v137
    v_exp_f32 v147, v163
    v_mfma_f32_16x16x32_bf16 v[160:163], v[124:127], v[180:183], v[176:179]
    v_rcp_f32 v139, v139
    v_mfma_f32_4x4x4_16b_bf16 v[144:147], v[228:229], v[228:229], v[144:147]
    v_mfma_f32_16x16x32_bf16 v[156:159], v[120:123], v[184:187], v[156:159]
    v_rcp_f32 v140, v140
    v_mfma_f32_16x16x32_bf16 v[160:163], v[128:131], v[184:187], v[160:163]
    v_rcp_f32 v141, v141
    v_cvt_pk_bf16_f32 v135, v138, v139
    s_waitcnt vmcnt(4)
    ds_read_b128 v[180:183], v234 offset:6240
    ds_read_b128 v[184:187], v235 offset:6240
    v_rcp_f32 v142, v142
    v_cvt_pk_bf16_f32 v136, v140, v141
    v_mfma_f32_16x16x32_bf16 v[208:211], v[132:135], v[196:199], v[204:207]
    v_rcp_f32 v143, v143
    v_rcp_f32 v144, v144
    v_cvt_pk_bf16_f32 v137, v142, v143
    v_rcp_f32 v145, v145
    v_rcp_f32 v146, v146
    v_rcp_f32 v147, v147
    v_cvt_pk_bf16_f32 v138, v144, v145
    v_cvt_pk_bf16_f32 v139, v146, v147
    ds_read_u8 v230, v237 offset:96
    ds_read_u8 v232, v237 offset:104
    v_mfma_f32_16x16x32_bf16 v[208:211], v[136:139], v[200:203], v[208:211]
    s_bitcmp1_b32 s36, 2
    s_cbranch_scc1 Ls_ev2
Ls_evd2:
    ds_read_b32 v246, v244 offset:32
    s_waitcnt lgkmcnt(0)
    v_bfe_u32 v247, v246, 0, 8
    v_lshlrev_b32 v247, 1, v247
    v_bfe_u32 v248, v246, 8, 8
    v_lshlrev_b32 v248, 1, v248
    v_bfe_u32 v249, v246, 16, 8
    v_lshlrev_b32 v249, 1, v249
    v_bfe_u32 v250, v246, 24, 8
    v_lshlrev_b32 v250, 1, v250
    buffer_load_ushort v247, v247, s[24:27], 0 offen
    buffer_load_ushort v248, v248, s[24:27], 0 offen
    buffer_load_ushort v249, v249, s[24:27], 0 offen
    buffer_load_ushort v250, v250, s[24:27], 0 offen
    s_waitcnt vmcnt(0)
    v_lshlrev_b32 v247, 16, v247
    v_mul_f32 v208, v208, v247
    v_lshlrev_b32 v248, 16, v248
    v_mul_f32 v209, v209, v248
    v_lshlrev_b32 v249, 16, v249
    v_mul_f32 v210, v210, v249
    v_lshlrev_b32 v250, 16, v250
    v_mul_f32 v211, v211, v250
    v_exp_f32 v132, v148
    v_exp_f32 v133, v149
    v_exp_f32 v134, v150
    v_exp_f32 v135, v151
    v_exp_f32 v136, v152
    v_exp_f32 v137, v153
    v_mfma_f32_4x4x4_16b_bf16 v[132:135], v[228:229], v[228:229], v[132:135]
    v_cvt_pk_bf16_f32 v208, v208, v209
    v_cvt_pk_bf16_f32 v209, v210, v211
    s_waitcnt lgkmcnt(2)
    v_mfma_f32_16x16x32_bf16 v[148:151], v[100:103], v[180:183], v[164:167]
    v_exp_f32 v138, v154
    v_mfma_f32_4x4x4_16b_bf16 v[212:215], v[208:209], v[188:189], v[212:215] cbsz:4 abid:0
    ds_read_b64_tr_b16 v[188:189], v236 offset:4160
    v_exp_f32 v139, v155
    v_mfma_f32_16x16x32_bf16 v[152:155], v[108:111], v[180:183], v[168:171]
    v_exp_f32 v140, v156
    v_mfma_f32_4x4x4_16b_bf16 v[212:215], v[208:209], v[190:191], v[212:215] cbsz:4 abid:4
    ds_read_b64_tr_b16 v[190:191], v236 offset:4672
    v_mfma_f32_4x4x4_16b_bf16 v[136:139], v[228:229], v[228:229], v[136:139]
    v_rcp_f32 v132, v132
    v_mfma_f32_4x4x4_16b_bf16 v[212:215], v[208:209], v[192:193], v[212:215] cbsz:4 abid:8
    ds_read_b64_tr_b16 v[192:193], v236 offset:5216
    v_exp_f32 v141, v157
    v_mfma_f32_16x16x32_bf16 v[148:151], v[104:107], v[184:187], v[148:151]
    v_rcp_f32 v133, v133
    v_mfma_f32_4x4x4_16b_bf16 v[212:215], v[208:209], v[194:195], v[212:215] cbsz:4 abid:12
    ds_read_b64_tr_b16 v[194:195], v236 offset:5728
    v_exp_f32 v142, v158
    v_mfma_f32_16x16x32_bf16 v[152:155], v[112:115], v[184:187], v[152:155]
    v_rcp_f32 v134, v134
    v_exp_f32 v143, v159
    v_rcp_f32 v135, v135
    v_cvt_pk_bf16_f32 v132, v132, v133
    v_mfma_f32_4x4x4_16b_bf16 v[140:143], v[228:229], v[228:229], v[140:143]
    v_exp_f32 v144, v160
    v_mfma_f32_16x16x32_bf16 v[156:159], v[116:119], v[180:183], v[172:175]
    v_rcp_f32 v136, v136
    v_cvt_pk_bf16_f32 v133, v134, v135
    s_add_u32 m0, s52, 4160
    s_waitcnt lgkmcnt(0)
    buffer_load_dwordx4 v[230:231], s[20:23], s35 idxen offen nt lds
    v_exp_f32 v145, v161
    buffer_load_dwordx4 v[232:233], s[40:43], s35 idxen offen offset:1056 nt lds
    v_rcp_f32 v137, v137
    v_exp_f32 v146, v162
    v_rcp_f32 v138, v138
    v_cvt_pk_bf16_f32 v134, v136, v137
    v_exp_f32 v147, v163
    v_mfma_f32_16x16x32_bf16 v[160:163], v[124:127], v[180:183], v[176:179]
    v_rcp_f32 v139, v139
    v_mfma_f32_4x4x4_16b_bf16 v[144:147], v[228:229], v[228:229], v[144:147]
    v_mfma_f32_16x16x32_bf16 v[156:159], v[120:123], v[184:187], v[156:159]
    v_rcp_f32 v140, v140
    v_mfma_f32_16x16x32_bf16 v[160:163], v[128:131], v[184:187], v[160:163]
    v_rcp_f32 v141, v141
    v_cvt_pk_bf16_f32 v135, v138, v139
    s_waitcnt vmcnt(4)
    ds_read_b128 v[180:183], v234 offset:0
    ds_read_b128 v[184:187], v235 offset:0
    v_rcp_f32 v142, v142
    v_cvt_pk_bf16_f32 v136, v140, v141
    v_mfma_f32_16x16x32_bf16 v[208:211], v[132:135], v[196:199], v[204:207]
    v_rcp_f32 v143, v143
    v_rcp_f32 v144, v144
    v_cvt_pk_bf16_f32 v137, v142, v143
    v_rcp_f32 v145, v145
    v_rcp_f32 v146, v146
    v_rcp_f32 v147, v147
    v_cvt_pk_bf16_f32 v138, v144, v145
    v_cvt_pk_bf16_f32 v139, v146, v147
    ds_read_u8 v230, v237 offset:112
    ds_read_u8 v232, v237 offset:120
    v_mfma_f32_16x16x32_bf16 v[208:211], v[136:139], v[200:203], v[208:211]
    s_bitcmp1_b32 s36, 3
    s_cbranch_scc1 Ls_ev3
Ls_evd3:
    ds_read_b32 v246, v244 offset:48
    s_waitcnt lgkmcnt(0)
    v_bfe_u32 v247, v246, 0, 8
    v_lshlrev_b32 v247, 1, v247
    v_bfe_u32 v248, v246, 8, 8
    v_lshlrev_b32 v248, 1, v248
    v_bfe_u32 v249, v246, 16, 8
    v_lshlrev_b32 v249, 1, v249
    v_bfe_u32 v250, v246, 24, 8
    v_lshlrev_b32 v250, 1, v250
    buffer_load_ushort v247, v247, s[24:27], 0 offen
    buffer_load_ushort v248, v248, s[24:27], 0 offen
    buffer_load_ushort v249, v249, s[24:27], 0 offen
    buffer_load_ushort v250, v250, s[24:27], 0 offen
    s_waitcnt vmcnt(0)
    v_lshlrev_b32 v247, 16, v247
    v_mul_f32 v208, v208, v247
    v_lshlrev_b32 v248, 16, v248
    v_mul_f32 v209, v209, v248
    v_lshlrev_b32 v249, 16, v249
    v_mul_f32 v210, v210, v249
    v_lshlrev_b32 v250, 16, v250
    v_mul_f32 v211, v211, v250
    v_exp_f32 v132, v148
    v_exp_f32 v133, v149
    v_exp_f32 v134, v150
    v_exp_f32 v135, v151
    v_exp_f32 v136, v152
    v_exp_f32 v137, v153
    v_mfma_f32_4x4x4_16b_bf16 v[132:135], v[228:229], v[228:229], v[132:135]
    v_cvt_pk_bf16_f32 v208, v208, v209
    v_cvt_pk_bf16_f32 v209, v210, v211
    s_waitcnt lgkmcnt(2)
    v_mfma_f32_16x16x32_bf16 v[148:151], v[100:103], v[180:183], v[164:167]
    v_exp_f32 v138, v154
    v_mfma_f32_4x4x4_16b_bf16 v[212:215], v[208:209], v[188:189], v[212:215] cbsz:4 abid:0
    ds_read_b64_tr_b16 v[188:189], v236 offset:6240
    v_exp_f32 v139, v155
    v_mfma_f32_16x16x32_bf16 v[152:155], v[108:111], v[180:183], v[168:171]
    v_exp_f32 v140, v156
    v_mfma_f32_4x4x4_16b_bf16 v[212:215], v[208:209], v[190:191], v[212:215] cbsz:4 abid:4
    ds_read_b64_tr_b16 v[190:191], v236 offset:6752
    v_mfma_f32_4x4x4_16b_bf16 v[136:139], v[228:229], v[228:229], v[136:139]
    v_rcp_f32 v132, v132
    v_mfma_f32_4x4x4_16b_bf16 v[212:215], v[208:209], v[192:193], v[212:215] cbsz:4 abid:8
    ds_read_b64_tr_b16 v[192:193], v236 offset:7296
    v_exp_f32 v141, v157
    v_mfma_f32_16x16x32_bf16 v[148:151], v[104:107], v[184:187], v[148:151]
    v_rcp_f32 v133, v133
    v_mfma_f32_4x4x4_16b_bf16 v[212:215], v[208:209], v[194:195], v[212:215] cbsz:4 abid:12
    ds_read_b64_tr_b16 v[194:195], v236 offset:7808
    v_exp_f32 v142, v158
    v_mfma_f32_16x16x32_bf16 v[152:155], v[112:115], v[184:187], v[152:155]
    v_rcp_f32 v134, v134
    v_exp_f32 v143, v159
    v_rcp_f32 v135, v135
    v_cvt_pk_bf16_f32 v132, v132, v133
    v_mfma_f32_4x4x4_16b_bf16 v[140:143], v[228:229], v[228:229], v[140:143]
    v_exp_f32 v144, v160
    v_mfma_f32_16x16x32_bf16 v[156:159], v[116:119], v[180:183], v[172:175]
    v_rcp_f32 v136, v136
    v_cvt_pk_bf16_f32 v133, v134, v135
    s_add_u32 m0, s52, 6240
    s_waitcnt lgkmcnt(0)
    buffer_load_dwordx4 v[230:231], s[20:23], s35 idxen offen nt lds
    v_exp_f32 v145, v161
    buffer_load_dwordx4 v[232:233], s[40:43], s35 idxen offen offset:1056 nt lds
    v_rcp_f32 v137, v137
    v_exp_f32 v146, v162
    v_rcp_f32 v138, v138
    v_cvt_pk_bf16_f32 v134, v136, v137
    v_exp_f32 v147, v163
    v_mfma_f32_16x16x32_bf16 v[160:163], v[124:127], v[180:183], v[176:179]
    v_rcp_f32 v139, v139
    v_mfma_f32_4x4x4_16b_bf16 v[144:147], v[228:229], v[228:229], v[144:147]
    v_mfma_f32_16x16x32_bf16 v[156:159], v[120:123], v[184:187], v[156:159]
    v_rcp_f32 v140, v140
    v_mfma_f32_16x16x32_bf16 v[160:163], v[128:131], v[184:187], v[160:163]
    v_rcp_f32 v141, v141
    v_cvt_pk_bf16_f32 v135, v138, v139
    s_waitcnt vmcnt(4)
    ds_read_b128 v[180:183], v234 offset:2080
    ds_read_b128 v[184:187], v235 offset:2080
    v_rcp_f32 v142, v142
    v_cvt_pk_bf16_f32 v136, v140, v141
    v_mfma_f32_16x16x32_bf16 v[208:211], v[132:135], v[196:199], v[204:207]
    v_rcp_f32 v143, v143
    s_lshr_b64 s[56:57], s[56:57], 4
    s_lshl_b64 s[86:87], s[58:59], 60
    s_or_b64 s[56:57], s[56:57], s[86:87]
    s_lshr_b64 s[58:59], s[58:59], 4
    s_lshr_b64 s[86:87], s[56:57], 2
    s_lshr_b64 s[36:37], s[56:57], 5
    s_or_b32 s36, s36, s86
    s_or_b32 s36, s36, s56
    v_add_u32 v237, 64, v237
    v_add_u32 v244, 64, v244
    v_rcp_f32 v144, v144
    v_cvt_pk_bf16_f32 v137, v142, v143
    v_rcp_f32 v145, v145
    v_rcp_f32 v146, v146
    v_rcp_f32 v147, v147
    v_cvt_pk_bf16_f32 v138, v144, v145
    v_cvt_pk_bf16_f32 v139, v146, v147
    s_branch Ls_loop
Ls_ev0:
    s_bitcmp0_b64 s[56:57], 0
    s_cbranch_scc1 Ls_nf0
    v_cvt_pk_bf16_f32 v246, v212, v212
    v_mov_b32 v212, 0
    ds_write_b16 v240, v246
    v_add_u32 v240, 128, v240
    s_add_u32 s24, s24, s32
    s_addc_u32 s25, s25, 0
    s_xor_b32 s32, s32, 0x18ffe0
Ls_nf0:
    s_bitcmp0_b64 s[56:57], 5
    s_cbranch_scc1 Ls_na0
    s_add_u32 s35, s35, s31
    s_min_u32 s35, s35, 419404800
    s_xor_b32 s31, s31, 0x63ff800
Ls_na0:
    s_bitcmp0_b64 s[56:57], 2
    s_cbranch_scc1 Ls_evd0
Ls_e10:
    s_sub_u32 s61, s61, 1
    s_cbranch_scc1 Ls_last0
    v_mul_u32_u24 v216, v224, v241
    v_mul_u32_u24 v217, v224, v242
    v_mul_u32_u24 v218, v225, v241
    v_mul_u32_u24 v219, v225, v242
    v_mul_u32_u24 v220, v226, v241
    v_mul_u32_u24 v221, v226, v242
    v_mul_u32_u24 v222, v227, v241
    v_mul_u32_u24 v223, v227, v242
    v_add_u32 v238, 128, v238
    ds_read_b128 v[164:167], v239
    v_mfma_f32_4x4x4_16b_bf16 v[132:135], v[216:217], v[68:69], v[4:7]
    ds_read_b128 v[168:171], v239 offset:64
    ds_read_b128 v[172:175], v239 offset:128
    v_mfma_f32_4x4x4_16b_bf16 v[136:139], v[218:219], v[70:71], v[8:11]
    ds_read_b128 v[176:179], v239 offset:192
    ds_read_u16 v224, v238
    v_mfma_f32_4x4x4_16b_bf16 v[140:143], v[220:221], v[72:73], v[12:15]
    ds_read_u16 v225, v238 offset:8
    ds_read_u16 v226, v238 offset:64
    v_mfma_f32_4x4x4_16b_bf16 v[144:147], v[222:223], v[74:75], v[16:19]
    ds_read_u16 v227, v238 offset:72
    v_add_u32 v239, 272, v239
    v_mfma_f32_4x4x4_16b_bf16 v[246:249], v[216:217], v[76:77], v[20:23]
    v_cvt_pk_bf16_f32 v100, v132, v133
    v_cvt_pk_bf16_f32 v101, v134, v135
    v_mfma_f32_4x4x4_16b_bf16 v[250:253], v[218:219], v[78:79], v[24:27]
    v_cvt_pk_bf16_f32 v102, v136, v137
    v_cvt_pk_bf16_f32 v103, v138, v139
    v_mfma_f32_4x4x4_16b_bf16 v[132:135], v[220:221], v[80:81], v[28:31]
    v_cvt_pk_bf16_f32 v104, v140, v141
    v_cvt_pk_bf16_f32 v105, v142, v143
    v_mfma_f32_4x4x4_16b_bf16 v[136:139], v[222:223], v[82:83], v[32:35]
    v_cvt_pk_bf16_f32 v106, v144, v145
    v_cvt_pk_bf16_f32 v107, v146, v147
    v_mfma_f32_4x4x4_16b_bf16 v[140:143], v[216:217], v[84:85], v[36:39]
    v_cvt_pk_bf16_f32 v108, v246, v247
    v_cvt_pk_bf16_f32 v109, v248, v249
    v_mfma_f32_4x4x4_16b_bf16 v[144:147], v[218:219], v[86:87], v[40:43]
    v_cvt_pk_bf16_f32 v110, v250, v251
    v_cvt_pk_bf16_f32 v111, v252, v253
    v_mfma_f32_4x4x4_16b_bf16 v[246:249], v[220:221], v[88:89], v[44:47]
    v_cvt_pk_bf16_f32 v112, v132, v133
    v_cvt_pk_bf16_f32 v113, v134, v135
    v_mfma_f32_4x4x4_16b_bf16 v[250:253], v[222:223], v[90:91], v[48:51]
    v_cvt_pk_bf16_f32 v114, v136, v137
    v_cvt_pk_bf16_f32 v115, v138, v139
    v_mfma_f32_4x4x4_16b_bf16 v[132:135], v[216:217], v[92:93], v[52:55]
    v_cvt_pk_bf16_f32 v116, v140, v141
    v_cvt_pk_bf16_f32 v117, v142, v143
    v_mfma_f32_4x4x4_16b_bf16 v[136:139], v[218:219], v[94:95], v[56:59]
    v_cvt_pk_bf16_f32 v118, v144, v145
    v_cvt_pk_bf16_f32 v119, v146, v147
    v_mfma_f32_4x4x4_16b_bf16 v[140:143], v[220:221], v[96:97], v[60:63]
    v_cvt_pk_bf16_f32 v120, v246, v247
    v_cvt_pk_bf16_f32 v121, v248, v249
    v_mfma_f32_4x4x4_16b_bf16 v[144:147], v[222:223], v[98:99], v[64:67]
    v_cvt_pk_bf16_f32 v122, v250, v251
    v_cvt_pk_bf16_f32 v123, v252, v253
    v_cvt_pk_bf16_f32 v124, v132, v133
    v_cvt_pk_bf16_f32 v125, v134, v135
    v_cvt_pk_bf16_f32 v126, v136, v137
    v_cvt_pk_bf16_f32 v127, v138, v139
    v_cvt_pk_bf16_f32 v128, v140, v141
    v_cvt_pk_bf16_f32 v129, v142, v143
    v_cvt_pk_bf16_f32 v130, v144, v145
    v_cvt_pk_bf16_f32 v131, v146, v147
    s_waitcnt lgkmcnt(0)
    s_branch Ls_evd0
Ls_ev1:
    s_bitcmp0_b64 s[56:57], 1
    s_cbranch_scc1 Ls_nf1
    v_cvt_pk_bf16_f32 v246, v212, v212
    v_mov_b32 v212, 0
    ds_write_b16 v240, v246
    v_add_u32 v240, 128, v240
    s_add_u32 s24, s24, s32
    s_addc_u32 s25, s25, 0
    s_xor_b32 s32, s32, 0x18ffe0
Ls_nf1:
    s_bitcmp0_b64 s[56:57], 6
    s_cbranch_scc1 Ls_na1
    s_add_u32 s35, s35, s31
    s_min_u32 s35, s35, 419404800
    s_xor_b32 s31, s31, 0x63ff800
Ls_na1:
    s_bitcmp0_b64 s[56:57], 3
    s_cbranch_scc1 Ls_evd1
Ls_e11:
    s_sub_u32 s61, s61, 1
    s_cbranch_scc1 Ls_last1
    v_mul_u32_u24 v216, v224, v241
    v_mul_u32_u24 v217, v224, v242
    v_mul_u32_u24 v218, v225, v241
    v_mul_u32_u24 v219, v225, v242
    v_mul_u32_u24 v220, v226, v241
    v_mul_u32_u24 v221, v226, v242
    v_mul_u32_u24 v222, v227, v241
    v_mul_u32_u24 v223, v227, v242
    v_add_u32 v238, 128, v238
    ds_read_b128 v[164:167], v239
    v_mfma_f32_4x4x4_16b_bf16 v[132:135], v[216:217], v[68:69], v[4:7]
    ds_read_b128 v[168:171], v239 offset:64
    ds_read_b128 v[172:175], v239 offset:128
    v_mfma_f32_4x4x4_16b_bf16 v[136:139], v[218:219], v[70:71], v[8:11]
    ds_read_b128 v[176:179], v239 offset:192
    ds_read_u16 v224, v238
    v_mfma_f32_4x4x4_16b_bf16 v[140:143], v[220:221], v[72:73], v[12:15]
    ds_read_u16 v225, v238 offset:8
    ds_read_u16 v226, v238 offset:64
    v_mfma_f32_4x4x4_16b_bf16 v[144:147], v[222:223], v[74:75], v[16:19]
    ds_read_u16 v227, v238 offset:72
    v_add_u32 v239, 272, v239
    v_mfma_f32_4x4x4_16b_bf16 v[246:249], v[216:217], v[76:77], v[20:23]
    v_cvt_pk_bf16_f32 v100, v132, v133
    v_cvt_pk_bf16_f32 v101, v134, v135
    v_mfma_f32_4x4x4_16b_bf16 v[250:253], v[218:219], v[78:79], v[24:27]
    v_cvt_pk_bf16_f32 v102, v136, v137
    v_cvt_pk_bf16_f32 v103, v138, v139
    v_mfma_f32_4x4x4_16b_bf16 v[132:135], v[220:221], v[80:81], v[28:31]
    v_cvt_pk_bf16_f32 v104, v140, v141
    v_cvt_pk_bf16_f32 v105, v142, v143
    v_mfma_f32_4x4x4_16b_bf16 v[136:139], v[222:223], v[82:83], v[32:35]
    v_cvt_pk_bf16_f32 v106, v144, v145
    v_cvt_pk_bf16_f32 v107, v146, v147
    v_mfma_f32_4x4x4_16b_bf16 v[140:143], v[216:217], v[84:85], v[36:39]
    v_cvt_pk_bf16_f32 v108, v246, v247
    v_cvt_pk_bf16_f32 v109, v248, v249
    v_mfma_f32_4x4x4_16b_bf16 v[144:147], v[218:219], v[86:87], v[40:43]
    v_cvt_pk_bf16_f32 v110, v250, v251
    v_cvt_pk_bf16_f32 v111, v252, v253
    v_mfma_f32_4x4x4_16b_bf16 v[246:249], v[220:221], v[88:89], v[44:47]
    v_cvt_pk_bf16_f32 v112, v132, v133
    v_cvt_pk_bf16_f32 v113, v134, v135
    v_mfma_f32_4x4x4_16b_bf16 v[250:253], v[222:223], v[90:91], v[48:51]
    v_cvt_pk_bf16_f32 v114, v136, v137
    v_cvt_pk_bf16_f32 v115, v138, v139
    v_mfma_f32_4x4x4_16b_bf16 v[132:135], v[216:217], v[92:93], v[52:55]
    v_cvt_pk_bf16_f32 v116, v140, v141
    v_cvt_pk_bf16_f32 v117, v142, v143
    v_mfma_f32_4x4x4_16b_bf16 v[136:139], v[218:219], v[94:95], v[56:59]
    v_cvt_pk_bf16_f32 v118, v144, v145
    v_cvt_pk_bf16_f32 v119, v146, v147
    v_mfma_f32_4x4x4_16b_bf16 v[140:143], v[220:221], v[96:97], v[60:63]
    v_cvt_pk_bf16_f32 v120, v246, v247
    v_cvt_pk_bf16_f32 v121, v248, v249
    v_mfma_f32_4x4x4_16b_bf16 v[144:147], v[222:223], v[98:99], v[64:67]
    v_cvt_pk_bf16_f32 v122, v250, v251
    v_cvt_pk_bf16_f32 v123, v252, v253
    v_cvt_pk_bf16_f32 v124, v132, v133
    v_cvt_pk_bf16_f32 v125, v134, v135
    v_cvt_pk_bf16_f32 v126, v136, v137
    v_cvt_pk_bf16_f32 v127, v138, v139
    v_cvt_pk_bf16_f32 v128, v140, v141
    v_cvt_pk_bf16_f32 v129, v142, v143
    v_cvt_pk_bf16_f32 v130, v144, v145
    v_cvt_pk_bf16_f32 v131, v146, v147
    s_waitcnt lgkmcnt(0)
    s_branch Ls_evd1
Ls_ev2:
    s_bitcmp0_b64 s[56:57], 2
    s_cbranch_scc1 Ls_nf2
    v_cvt_pk_bf16_f32 v246, v212, v212
    v_mov_b32 v212, 0
    ds_write_b16 v240, v246
    v_add_u32 v240, 128, v240
    s_add_u32 s24, s24, s32
    s_addc_u32 s25, s25, 0
    s_xor_b32 s32, s32, 0x18ffe0
Ls_nf2:
    s_bitcmp0_b64 s[56:57], 7
    s_cbranch_scc1 Ls_na2
    s_add_u32 s35, s35, s31
    s_min_u32 s35, s35, 419404800
    s_xor_b32 s31, s31, 0x63ff800
Ls_na2:
    s_bitcmp0_b64 s[56:57], 4
    s_cbranch_scc1 Ls_evd2
Ls_e12:
    s_sub_u32 s61, s61, 1
    s_cbranch_scc1 Ls_last2
    v_mul_u32_u24 v216, v224, v241
    v_mul_u32_u24 v217, v224, v242
    v_mul_u32_u24 v218, v225, v241
    v_mul_u32_u24 v219, v225, v242
    v_mul_u32_u24 v220, v226, v241
    v_mul_u32_u24 v221, v226, v242
    v_mul_u32_u24 v222, v227, v241
    v_mul_u32_u24 v223, v227, v242
    v_add_u32 v238, 128, v238
    ds_read_b128 v[164:167], v239
    v_mfma_f32_4x4x4_16b_bf16 v[132:135], v[216:217], v[68:69], v[4:7]
    ds_read_b128 v[168:171], v239 offset:64
    ds_read_b128 v[172:175], v239 offset:128
    v_mfma_f32_4x4x4_16b_bf16 v[136:139], v[218:219], v[70:71], v[8:11]
    ds_read_b128 v[176:179], v239 offset:192
    ds_read_u16 v224, v238
    v_mfma_f32_4x4x4_16b_bf16 v[140:143], v[220:221], v[72:73], v[12:15]
    ds_read_u16 v225, v238 offset:8
    ds_read_u16 v226, v238 offset:64
    v_mfma_f32_4x4x4_16b_bf16 v[144:147], v[222:223], v[74:75], v[16:19]
    ds_read_u16 v227, v238 offset:72
    v_add_u32 v239, 272, v239
    v_mfma_f32_4x4x4_16b_bf16 v[246:249], v[216:217], v[76:77], v[20:23]
    v_cvt_pk_bf16_f32 v100, v132, v133
    v_cvt_pk_bf16_f32 v101, v134, v135
    v_mfma_f32_4x4x4_16b_bf16 v[250:253], v[218:219], v[78:79], v[24:27]
    v_cvt_pk_bf16_f32 v102, v136, v137
    v_cvt_pk_bf16_f32 v103, v138, v139
    v_mfma_f32_4x4x4_16b_bf16 v[132:135], v[220:221], v[80:81], v[28:31]
    v_cvt_pk_bf16_f32 v104, v140, v141
    v_cvt_pk_bf16_f32 v105, v142, v143
    v_mfma_f32_4x4x4_16b_bf16 v[136:139], v[222:223], v[82:83], v[32:35]
    v_cvt_pk_bf16_f32 v106, v144, v145
    v_cvt_pk_bf16_f32 v107, v146, v147
    v_mfma_f32_4x4x4_16b_bf16 v[140:143], v[216:217], v[84:85], v[36:39]
    v_cvt_pk_bf16_f32 v108, v246, v247
    v_cvt_pk_bf16_f32 v109, v248, v249
    v_mfma_f32_4x4x4_16b_bf16 v[144:147], v[218:219], v[86:87], v[40:43]
    v_cvt_pk_bf16_f32 v110, v250, v251
    v_cvt_pk_bf16_f32 v111, v252, v253
    v_mfma_f32_4x4x4_16b_bf16 v[246:249], v[220:221], v[88:89], v[44:47]
    v_cvt_pk_bf16_f32 v112, v132, v133
    v_cvt_pk_bf16_f32 v113, v134, v135
    v_mfma_f32_4x4x4_16b_bf16 v[250:253], v[222:223], v[90:91], v[48:51]
    v_cvt_pk_bf16_f32 v114, v136, v137
    v_cvt_pk_bf16_f32 v115, v138, v139
    v_mfma_f32_4x4x4_16b_bf16 v[132:135], v[216:217], v[92:93], v[52:55]
    v_cvt_pk_bf16_f32 v116, v140, v141
    v_cvt_pk_bf16_f32 v117, v142, v143
    v_mfma_f32_4x4x4_16b_bf16 v[136:139], v[218:219], v[94:95], v[56:59]
    v_cvt_pk_bf16_f32 v118, v144, v145
    v_cvt_pk_bf16_f32 v119, v146, v147
    v_mfma_f32_4x4x4_16b_bf16 v[140:143], v[220:221], v[96:97], v[60:63]
    v_cvt_pk_bf16_f32 v120, v246, v247
    v_cvt_pk_bf16_f32 v121, v248, v249
    v_mfma_f32_4x4x4_16b_bf16 v[144:147], v[222:223], v[98:99], v[64:67]
    v_cvt_pk_bf16_f32 v122, v250, v251
    v_cvt_pk_bf16_f32 v123, v252, v253
    v_cvt_pk_bf16_f32 v124, v132, v133
    v_cvt_pk_bf16_f32 v125, v134, v135
    v_cvt_pk_bf16_f32 v126, v136, v137
    v_cvt_pk_bf16_f32 v127, v138, v139
    v_cvt_pk_bf16_f32 v128, v140, v141
    v_cvt_pk_bf16_f32 v129, v142, v143
    v_cvt_pk_bf16_f32 v130, v144, v145
    v_cvt_pk_bf16_f32 v131, v146, v147
    s_waitcnt lgkmcnt(0)
    s_branch Ls_evd2
Ls_ev3:
    s_bitcmp0_b64 s[56:57], 3
    s_cbranch_scc1 Ls_nf3
    v_cvt_pk_bf16_f32 v246, v212, v212
    v_mov_b32 v212, 0
    ds_write_b16 v240, v246
    v_add_u32 v240, 128, v240
    s_add_u32 s24, s24, s32
    s_addc_u32 s25, s25, 0
    s_xor_b32 s32, s32, 0x18ffe0
Ls_nf3:
    s_bitcmp0_b64 s[56:57], 8
    s_cbranch_scc1 Ls_na3
    s_add_u32 s35, s35, s31
    s_min_u32 s35, s35, 419404800
    s_xor_b32 s31, s31, 0x63ff800
Ls_na3:
    s_bitcmp0_b64 s[56:57], 5
    s_cbranch_scc1 Ls_evd3
Ls_e13:
    s_sub_u32 s61, s61, 1
    s_cbranch_scc1 Ls_last3
    v_mul_u32_u24 v216, v224, v241
    v_mul_u32_u24 v217, v224, v242
    v_mul_u32_u24 v218, v225, v241
    v_mul_u32_u24 v219, v225, v242
    v_mul_u32_u24 v220, v226, v241
    v_mul_u32_u24 v221, v226, v242
    v_mul_u32_u24 v222, v227, v241
    v_mul_u32_u24 v223, v227, v242
    v_add_u32 v238, 128, v238
    ds_read_b128 v[164:167], v239
    v_mfma_f32_4x4x4_16b_bf16 v[132:135], v[216:217], v[68:69], v[4:7]
    ds_read_b128 v[168:171], v239 offset:64
    ds_read_b128 v[172:175], v239 offset:128
    v_mfma_f32_4x4x4_16b_bf16 v[136:139], v[218:219], v[70:71], v[8:11]
    ds_read_b128 v[176:179], v239 offset:192
    ds_read_u16 v224, v238
    v_mfma_f32_4x4x4_16b_bf16 v[140:143], v[220:221], v[72:73], v[12:15]
    ds_read_u16 v225, v238 offset:8
    ds_read_u16 v226, v238 offset:64
    v_mfma_f32_4x4x4_16b_bf16 v[144:147], v[222:223], v[74:75], v[16:19]
    ds_read_u16 v227, v238 offset:72
    v_add_u32 v239, 272, v239
    v_mfma_f32_4x4x4_16b_bf16 v[246:249], v[216:217], v[76:77], v[20:23]
    v_cvt_pk_bf16_f32 v100, v132, v133
    v_cvt_pk_bf16_f32 v101, v134, v135
    v_mfma_f32_4x4x4_16b_bf16 v[250:253], v[218:219], v[78:79], v[24:27]
    v_cvt_pk_bf16_f32 v102, v136, v137
    v_cvt_pk_bf16_f32 v103, v138, v139
    v_mfma_f32_4x4x4_16b_bf16 v[132:135], v[220:221], v[80:81], v[28:31]
    v_cvt_pk_bf16_f32 v104, v140, v141
    v_cvt_pk_bf16_f32 v105, v142, v143
    v_mfma_f32_4x4x4_16b_bf16 v[136:139], v[222:223], v[82:83], v[32:35]
    v_cvt_pk_bf16_f32 v106, v144, v145
    v_cvt_pk_bf16_f32 v107, v146, v147
    v_mfma_f32_4x4x4_16b_bf16 v[140:143], v[216:217], v[84:85], v[36:39]
    v_cvt_pk_bf16_f32 v108, v246, v247
    v_cvt_pk_bf16_f32 v109, v248, v249
    v_mfma_f32_4x4x4_16b_bf16 v[144:147], v[218:219], v[86:87], v[40:43]
    v_cvt_pk_bf16_f32 v110, v250, v251
    v_cvt_pk_bf16_f32 v111, v252, v253
    v_mfma_f32_4x4x4_16b_bf16 v[246:249], v[220:221], v[88:89], v[44:47]
    v_cvt_pk_bf16_f32 v112, v132, v133
    v_cvt_pk_bf16_f32 v113, v134, v135
    v_mfma_f32_4x4x4_16b_bf16 v[250:253], v[222:223], v[90:91], v[48:51]
    v_cvt_pk_bf16_f32 v114, v136, v137
    v_cvt_pk_bf16_f32 v115, v138, v139
    v_mfma_f32_4x4x4_16b_bf16 v[132:135], v[216:217], v[92:93], v[52:55]
    v_cvt_pk_bf16_f32 v116, v140, v141
    v_cvt_pk_bf16_f32 v117, v142, v143
    v_mfma_f32_4x4x4_16b_bf16 v[136:139], v[218:219], v[94:95], v[56:59]
    v_cvt_pk_bf16_f32 v118, v144, v145
    v_cvt_pk_bf16_f32 v119, v146, v147
    v_mfma_f32_4x4x4_16b_bf16 v[140:143], v[220:221], v[96:97], v[60:63]
    v_cvt_pk_bf16_f32 v120, v246, v247
    v_cvt_pk_bf16_f32 v121, v248, v249
    v_mfma_f32_4x4x4_16b_bf16 v[144:147], v[222:223], v[98:99], v[64:67]
    v_cvt_pk_bf16_f32 v122, v250, v251
    v_cvt_pk_bf16_f32 v123, v252, v253
    v_cvt_pk_bf16_f32 v124, v132, v133
    v_cvt_pk_bf16_f32 v125, v134, v135
    v_cvt_pk_bf16_f32 v126, v136, v137
    v_cvt_pk_bf16_f32 v127, v138, v139
    v_cvt_pk_bf16_f32 v128, v140, v141
    v_cvt_pk_bf16_f32 v129, v142, v143
    v_cvt_pk_bf16_f32 v130, v144, v145
    v_cvt_pk_bf16_f32 v131, v146, v147
    s_waitcnt lgkmcnt(0)
    s_branch Ls_evd3
Ls_last0:
    s_branch Ls_tail
Ls_last1:
    v_add_u32 v236, 2080, v236
    s_lshr_b64 s[56:57], s[56:57], 1
    v_add_u32 v244, 16, v244
    s_branch Ls_tail
Ls_last2:
    v_add_u32 v236, 4160, v236
    s_lshr_b64 s[56:57], s[56:57], 2
    v_add_u32 v244, 32, v244
    s_branch Ls_tail
Ls_last3:
    v_add_u32 v236, 6240, v236
    s_lshr_b64 s[56:57], s[56:57], 3
    v_add_u32 v244, 48, v244
Ls_tail:
    ds_read_b32 v246, v244 offset:0
    s_waitcnt lgkmcnt(0)
    v_bfe_u32 v247, v246, 0, 8
    v_lshlrev_b32 v247, 1, v247
    v_bfe_u32 v248, v246, 8, 8
    v_lshlrev_b32 v248, 1, v248
    v_bfe_u32 v249, v246, 16, 8
    v_lshlrev_b32 v249, 1, v249
    v_bfe_u32 v250, v246, 24, 8
    v_lshlrev_b32 v250, 1, v250
    buffer_load_ushort v247, v247, s[24:27], 0 offen
    buffer_load_ushort v248, v248, s[24:27], 0 offen
    buffer_load_ushort v249, v249, s[24:27], 0 offen
    buffer_load_ushort v250, v250, s[24:27], 0 offen
    s_waitcnt vmcnt(0)
    v_lshlrev_b32 v247, 16, v247
    v_mul_f32 v208, v208, v247
    v_lshlrev_b32 v248, 16, v248
    v_mul_f32 v209, v209, v248
    v_lshlrev_b32 v249, 16, v249
    v_mul_f32 v210, v210, v249
    v_lshlrev_b32 v250, 16, v250
    v_mul_f32 v211, v211, v250
    v_exp_f32 v132, v148
    v_exp_f32 v133, v149
    v_exp_f32 v134, v150
    v_exp_f32 v135, v151
    v_exp_f32 v136, v152
    v_exp_f32 v137, v153
    v_mfma_f32_4x4x4_16b_bf16 v[132:135], v[228:229], v[228:229], v[132:135]
    v_cvt_pk_bf16_f32 v208, v208, v209
    v_cvt_pk_bf16_f32 v209, v210, v211
    v_exp_f32 v138, v154
    s_nop 0
    v_mfma_f32_4x4x4_16b_bf16 v[212:215], v[208:209], v[188:189], v[212:215] cbsz:4 abid:0
    ds_read_b64_tr_b16 v[188:189], v236 offset:0
    v_exp_f32 v139, v155
    v_exp_f32 v140, v156
    v_mfma_f32_4x4x4_16b_bf16 v[212:215], v[208:209], v[190:191], v[212:215] cbsz:4 abid:4
    ds_read_b64_tr_b16 v[190:191], v236 offset:512
    v_mfma_f32_4x4x4_16b_bf16 v[136:139], v[228:229], v[228:229], v[136:139]
    v_rcp_f32 v132, v132
    v_mfma_f32_4x4x4_16b_bf16 v[212:215], v[208:209], v[192:193], v[212:215] cbsz:4 abid:8
    ds_read_b64_tr_b16 v[192:193], v236 offset:1056
    v_exp_f32 v141, v157
    v_rcp_f32 v133, v133
    v_mfma_f32_4x4x4_16b_bf16 v[212:215], v[208:209], v[194:195], v[212:215] cbsz:4 abid:12
    ds_read_b64_tr_b16 v[194:195], v236 offset:1568
    v_exp_f32 v142, v158
    v_rcp_f32 v134, v134
    v_exp_f32 v143, v159
    v_rcp_f32 v135, v135
    v_cvt_pk_bf16_f32 v132, v132, v133
    v_mfma_f32_4x4x4_16b_bf16 v[140:143], v[228:229], v[228:229], v[140:143]
    v_exp_f32 v144, v160
    v_rcp_f32 v136, v136
    v_cvt_pk_bf16_f32 v133, v134, v135
    s_bitcmp0_b64 s[56:57], 1
    s_cbranch_scc1 Ls_tnf
    v_cvt_pk_bf16_f32 v246, v212, v212
    v_mov_b32 v212, 0
    ds_write_b16 v240, v246
    v_add_u32 v240, 128, v240
    s_add_u32 s24, s24, s32
    s_addc_u32 s25, s25, 0
    s_xor_b32 s32, s32, 0x18ffe0
Ls_tnf:
    s_waitcnt lgkmcnt(0)
    v_exp_f32 v145, v161
    v_rcp_f32 v137, v137
    v_exp_f32 v146, v162
    v_rcp_f32 v138, v138
    v_cvt_pk_bf16_f32 v134, v136, v137
    v_exp_f32 v147, v163
    v_rcp_f32 v139, v139
    s_nop 0
    v_mfma_f32_4x4x4_16b_bf16 v[144:147], v[228:229], v[228:229], v[144:147]
    v_rcp_f32 v140, v140
    v_rcp_f32 v141, v141
    v_cvt_pk_bf16_f32 v135, v138, v139
    v_rcp_f32 v142, v142
    v_cvt_pk_bf16_f32 v136, v140, v141
    v_mfma_f32_16x16x32_bf16 v[208:211], v[132:135], v[196:199], v[204:207]
    v_rcp_f32 v143, v143
    v_rcp_f32 v144, v144
    v_cvt_pk_bf16_f32 v137, v142, v143
    v_rcp_f32 v145, v145
    v_rcp_f32 v146, v146
    v_rcp_f32 v147, v147
    v_cvt_pk_bf16_f32 v138, v144, v145
    v_cvt_pk_bf16_f32 v139, v146, v147
    s_nop 1
    v_mfma_f32_16x16x32_bf16 v[208:211], v[136:139], v[200:203], v[208:211]
    ds_read_b32 v246, v244 offset:16
    s_waitcnt lgkmcnt(0)
    v_bfe_u32 v247, v246, 0, 8
    v_lshlrev_b32 v247, 1, v247
    v_bfe_u32 v248, v246, 8, 8
    v_lshlrev_b32 v248, 1, v248
    v_bfe_u32 v249, v246, 16, 8
    v_lshlrev_b32 v249, 1, v249
    v_bfe_u32 v250, v246, 24, 8
    v_lshlrev_b32 v250, 1, v250
    buffer_load_ushort v247, v247, s[24:27], 0 offen
    buffer_load_ushort v248, v248, s[24:27], 0 offen
    buffer_load_ushort v249, v249, s[24:27], 0 offen
    buffer_load_ushort v250, v250, s[24:27], 0 offen
    s_waitcnt vmcnt(0)
    v_lshlrev_b32 v247, 16, v247
    v_mul_f32 v208, v208, v247
    v_lshlrev_b32 v248, 16, v248
    v_mul_f32 v209, v209, v248
    v_lshlrev_b32 v249, 16, v249
    v_mul_f32 v210, v210, v249
    v_lshlrev_b32 v250, 16, v250
    v_mul_f32 v211, v211, v250
    v_cvt_pk_bf16_f32 v208, v208, v209
    v_cvt_pk_bf16_f32 v209, v210, v211
    s_nop 1
    v_mfma_f32_4x4x4_16b_bf16 v[212:215], v[208:209], v[188:189], v[212:215] cbsz:4 abid:0
    s_nop 1
    v_mfma_f32_4x4x4_16b_bf16 v[212:215], v[208:209], v[190:191], v[212:215] cbsz:4 abid:4
    s_nop 1
    v_mfma_f32_4x4x4_16b_bf16 v[212:215], v[208:209], v[192:193], v[212:215] cbsz:4 abid:8
    s_nop 1
    v_mfma_f32_4x4x4_16b_bf16 v[212:215], v[208:209], v[194:195], v[212:215] cbsz:4 abid:12
    s_nop 4
    v_cvt_pk_bf16_f32 v246, v212, v212
    ds_write_b16 v240, v246
    s_branch L_store
.section .rodata,"a"
.p2align 6
.amdhsa_kernel standalone__sequential_behavior_din__recsys_kernel
  .amdhsa_next_free_vgpr 256
  .amdhsa_next_free_sgpr 102
  .amdhsa_accum_offset 256
  .amdhsa_group_segment_fixed_size 0
  .amdhsa_kernarg_size 80
  .amdhsa_user_sgpr_count 2
  .amdhsa_user_sgpr_kernarg_segment_ptr 1
  .amdhsa_system_sgpr_workgroup_id_x 1
.end_amdhsa_kernel
```

```asm
; @launch grid=(256,1,1) block=(512,1,1) lds=163840
.amdgcn_target "amdgcn-amd-amdhsa--gfx950"
.text
.globl standalone__sequential_behavior_din__recsys_kernel
.p2align 8
.type standalone__sequential_behavior_din__recsys_kernel,@function
standalone__sequential_behavior_din__recsys_kernel:
    s_load_dwordx16 s[4:19], s[0:1], 0
    s_cmp_ge_u32 s2, 256
    s_cbranch_scc1 L_end
    v_lshrrev_b32 v1, 6, v0
    v_and_b32 v0, 63, v0
    v_readfirstlane_b32 s54, v1
    s_lshl_b32 s53, s2, 3
    v_lshlrev_b32 v2, 4, v0
    v_lshrrev_b32 v1, 4, v0
    v_and_b32 v3, 0xf0, v2
    v_lshlrev_b32 v3, 2, v3
    v_lshl_add_u32 v130, v1, 4, v3
    v_bfrev_b32 v3, 1
    s_add_u32 s53, s53, s54
    s_movk_i32 s66, 800
    v_cmp_gt_u32 vcc, s66, v130
    s_mul_i32 s93, s53, 800
    s_mul_i32 s52, s54, 20480
    s_mov_b64 s[28:29], vcc
    v_cndmask_b32 v3, v3, v130, vcc
    v_and_b32 v248, 16, v0
    v_lshlrev_b32 v246, 1, v248
    v_xor_b32 v246, v246, v2
    v_and_b32 v243, 0xf0, v2
    v_lshl_add_u32 v243, v1, 19, v243
    s_lshl_b32 s66, s53, 8
    v_add_u32 v243, s66, v243
    s_lshl_b32 s67, s54, 12
    s_add_u32 m0, s52, 8320
    s_mov_b32 s26, 6553600
    s_mov_b32 s27, 0x20000
    s_waitcnt lgkmcnt(0)
    s_mov_b32 s24, s8
    s_and_b32 s25, s9, 0xffff
    s_cmp_ge_u32 s54, 4
    s_cbranch_scc1 L_young0
    buffer_load_dwordx4 v[100:103], v3, s[24:27], s93 offen nt
L_young0:
    global_load_lds_dwordx4 v243, s[4:5] nt
    s_add_u32 m0, s52, 4160
    s_add_u32 s10, s10, s67
    s_addc_u32 s11, s11, 0
    v_xor_b32 v247, 64, v246
    global_load_lds_dwordx4 v246, s[10:11] offset:0
    global_load_lds_dwordx4 v247, s[10:11] offset:1024
    global_load_lds_dwordx4 v246, s[10:11] offset:2048
    global_load_lds_dwordx4 v247, s[10:11] offset:3072
    s_load_dword s30, s[16:17], 0
    s_and_b32 s67, s54, 3
    v_and_b32 v250, 3, v0
    s_mov_b32 s20, s6
    s_and_b32 s21, s7, 0xffff
    s_or_b32 s21, s21, 0x800000
    s_mov_b32 s22, 200
    s_mov_b32 s23, 0x20000
    s_sub_u32 s40, s20, 1056
    s_subb_u32 s41, s21, 0
    s_mov_b32 s42, 200
    s_mov_b32 s43, 0x20000
    s_mul_i32 s35, s53, 51200
    s_movk_i32 s31, 25600
    s_mov_b64 s[56:57], 0
    s_mov_b64 s[58:59], 0
    v_mov_b32 v148, -1
    v_mov_b32 v149, -1
    v_mov_b32 v150, -1
    v_mov_b32 v151, -1
    s_add_u32 s66, s52, 18432
    v_add_u32 v152, s66, v2
    ds_write_b128 v152, v[148:151]
    ds_write_b128 v152, v[148:151] offset:1024
    s_add_u32 s64, s52, 18448
    v_mov_b32 v153, -1
    v_mov_b32 v154, -1
    v_mov_b32 v155, -1
    v_lshrrev_b32 v237, 3, v0
    v_add_u32 v237, s64, v237
    v_lshl_add_u32 v244, v1, 2, s66
    v_and_b32 v231, 0x70, v2
    v_lshlrev_b32 v248, 2, v248
    v_xor_b32 v231, v231, v248
    v_mov_b32 v233, v231
    s_movk_i32 s66, 400
    v_cmp_le_u32 vcc, s66, v130
    v_lshrrev_b32 v126, 1, v130
    s_movk_i32 s66, -200
    v_cndmask_b32 v130, 0, 1, vcc
    v_mad_i32_i24 v126, v130, s66, v126
    v_mul_u32_u24 v127, 0x10001, v126
    v_add_u32 v126, 0x10000, v127
    v_add_u32 v128, 0x50004, v127
    v_add_u32 v129, 0x70006, v127
    v_add_u32 v127, 0x30002, v127
    v_mov_b32 v131, 0xbfe0bfe0
    s_mov_b32 s86, 0xfff0ffff
    s_mov_b32 s87, 0xf000ff00
    s_mov_b32 s88, 0xff00fff0
    s_mov_b32 s89, 0xf000
    s_mov_b32 s90, 0xf0000f
    s_mov_b32 s91, 0xf0000f00
    s_mov_b32 s84, 0x11111113
    s_mov_b32 s85, 0x11111111
    v_cndmask_b32 v116, 0, v131, s[86:87]
    v_cndmask_b32 v120, 0, v131, s[88:89]
    v_cndmask_b32 v117, 0, v131, s[86:87]
    v_cndmask_b32 v121, 0, v131, s[88:89]
    v_cndmask_b32 v122, 0, v131, s[84:85]
    v_cndmask_b32 v123, 0, v131, s[84:85]
    v_cndmask_b32 v124, 0, v131, s[84:85]
    v_cndmask_b32 v125, 0, v131, s[84:85]
    v_lshlrev_b32 v246, 4, v250
    v_sub_u32 v246, 48, v246
    s_mov_b32 s86, 0xbfe0bfe0
    s_mov_b32 s87, 0xf0bfe0
    v_lshrrev_b64 v[118:119], v246, s[86:87]
    v_mov_b32 v131, 0
    s_mov_b64 s[84:85], 0
    v_cndmask_b32 v118, v120, v118, s[90:91]
    v_cndmask_b32 v119, v121, v119, s[90:91]
    s_mov_b32 s61, 7
    s_mov_b32 s92, 0xbfb8aa3b
    v_and_b32 v251, 15, v0
    v_bfe_u32 v252, v0, 2, 2
    v_lshlrev_b32 v253, 3, v250
    v_lshl_add_u32 v253, v252, 7, v253
    v_and_b32 v246, 24, v0
    v_lshlrev_b32 v246, 2, v246
    v_xor_b32 v246, v253, v246
    v_lshl_add_u32 v246, v1, 10, v246
    s_lshl_b32 s66, s67, 5
    v_xor_b32 v66, s66, v246
    v_add_u32 v66, 45120, v66
    s_lshr_b32 s66, s54, 1
    s_lshl_b32 s66, s66, 5
    v_xor_b32 v64, s66, v246
    s_and_b32 s66, s54, 1
    s_mul_i32 s66, s66, 20480
    s_add_u32 s66, s66, 4160
    v_add_u32 v64, s66, v64
    v_add_u32 v65, 81920, v64
    s_and_b32 s66, s54, 4
    v_lshrrev_b32 v246, 3, v251
    v_add_u32 v246, s66, v246
    v_mul_u32_u24 v246, 20480, v246
    v_lshl_add_u32 v246, v1, 4, v246
    v_and_b32 v247, 7, v0
    v_lshl_add_u32 v67, v247, 7, v246
    v_and_b32 v247, 1, v0
    v_lshlrev_b32 v247, 4, v247
    v_lshlrev_b32 v247, v247, 1
    v_cmp_gt_u32 vcc, 2, v250
    v_mov_b32 v229, 0
    v_mov_b32 v228, 0x3f80
    v_cndmask_b32 v241, 0, v247, vcc
    v_cmp_eq_u32 vcc, 0, v251
    v_sub_u32 v242, v247, v241
    v_mul_u32_u24 v218, 0x3f80, v241
    v_cndmask_b32 v220, 0, -1, vcc
    v_mul_u32_u24 v219, 0x3f80, v242
    s_and_b32 s66, s54, 3
    s_lshl_b32 s66, s66, 6
    s_add_u32 s66, s66, 9344
    v_and_b32 v247, 7, v0
    v_mul_u32_u24 v247, 144, v247
    v_add3_u32 v98, v67, v247, s66
    s_add_u32 s66, s52, 14592
    v_lshl_add_u32 v221, v0, 2, s66
    ds_write_b32 v221, v229
    s_xor_b32 s66, s54, 4
    s_mul_i32 s66, s66, 20480
    s_add_u32 s66, s66, 14592
    v_writelane_b32 v221, s66, 1
    v_and_b32 v247, 8, v0
    v_lshlrev_b32 v247, 2, v247
    v_lshl_add_u32 v247, v251, 7, v247
    v_add_u32 v247, s52, v247
    v_and_b32 v248, 2, v0
    v_lshlrev_b32 v248, 1, v248
    v_xor_b32 v248, v248, v1
    v_lshl_add_u32 v234, v248, 4, v247
    v_xor_b32 v248, 4, v248
    v_lshl_add_u32 v235, v248, 4, v247
    v_and_b32 v247, 8, v0
    v_lshlrev_b32 v247, 3, v247
    v_lshl_add_u32 v248, v1, 5, v253
    v_xor_b32 v248, v248, v247
    v_add_u32 v236, s52, v248
    s_add_u32 s66, s52, 8320
    v_lshl_add_u32 v238, v250, 1, s66
    v_lshl_add_u32 v238, v1, 4, v238
    v_lshl_add_u32 v240, v0, 1, s66
    s_add_u32 s66, s52, 9344
    v_lshl_add_u32 v239, v1, 4, s66
    v_mov_b32 v188, 0
    v_mov_b32 v189, 0
    v_mov_b32 v190, 0
    v_mov_b32 v191, 0
    v_mov_b32 v192, 0
    v_mov_b32 v193, 0
    v_mov_b32 v194, 0
    v_mov_b32 v195, 0
    v_mov_b32 v208, 0
    v_mov_b32 v212, 0
    v_mov_b32 v209, 0
    v_mov_b32 v213, 0
    v_mov_b32 v210, 0
    v_mov_b32 v214, 0
    v_mov_b32 v211, 0
    v_mov_b32 v215, 0
    s_and_b32 s66, s54, 3
    s_lshl_b32 s66, s66, 5
    v_lshl_add_u32 v249, v1, 3, s66
    global_load_dwordx2 v[96:97], v249, s[12:13]
    s_cmp_ge_u32 s54, 4
    s_cbranch_scc0 L_old3z
    buffer_load_dwordx4 v[100:103], v3, s[24:27], s93 offen nt
L_old3z:
    s_cmp_ge_u32 s54, 4
    s_cbranch_scc1 L_young1
    s_waitcnt vmcnt(6) lgkmcnt(0)
    s_call_b64 s[62:63], L_fp
    s_waitcnt vmcnt(5)
    s_branch L_old1
L_young1:
    s_waitcnt vmcnt(2)
L_old1:
    s_waitcnt lgkmcnt(0)
    s_barrier
    ds_read_b64_tr_b16 v[16:17], v66 offset:0
    ds_read_b64_tr_b16 v[18:19], v66 offset:512
    ds_read_b64_tr_b16 v[20:21], v66 offset:20480
    ds_read_b64_tr_b16 v[22:23], v66 offset:20992
    ds_read_b64_tr_b16 v[24:25], v66 offset:40960
    ds_read_b64_tr_b16 v[26:27], v66 offset:41472
    ds_read_b64_tr_b16 v[28:29], v66 offset:61440
    ds_read_b64_tr_b16 v[30:31], v66 offset:61952
    ds_read_b128 v[32:35], v67 offset:8320
    ds_read_b128 v[36:39], v67 offset:8384
    ds_read_b128 v[40:43], v67 offset:49280
    ds_read_b128 v[44:47], v67 offset:49344
    ds_read_b64_tr_b16 v[4:5], v64 offset:0
    ds_read_b64_tr_b16 v[8:9], v65 offset:0
    ds_read_b64_tr_b16 v[12:13], v65 offset:40960
    ds_read_b64_tr_b16 v[6:7], v64 offset:512
    ds_read_b64_tr_b16 v[10:11], v65 offset:512
    ds_read_b64_tr_b16 v[14:15], v65 offset:41472
    s_cmp_ge_u32 s54, 4
    s_cbranch_scc1 L_young2
    s_waitcnt vmcnt(4)
    s_branch L_old2
L_young2:
    s_waitcnt vmcnt(1)
L_old2:
    s_add_u32 s93, s93, 1638400
    buffer_load_dwordx4 v[104:107], v3, s[24:27], s93 offen nt
    s_add_u32 s93, s93, 1638400
    buffer_load_dwordx4 v[108:111], v3, s[24:27], s93 offen nt
    s_add_u32 s93, s93, 1638400
    buffer_load_dwordx4 v[112:115], v3, s[24:27], s93 offen nt
    v_lshlrev_b32 v249, 3, v1
    v_lshl_add_u32 v249, v250, 5, v249
    global_load_dwordx2 v[216:217], v249, s[14:15]
    v_lshlrev_b32 v48, 16, v96
    v_and_b32 v49, 0xffff0000, v96
    v_lshlrev_b32 v50, 16, v97
    v_and_b32 v51, 0xffff0000, v97
    s_lshl_b32 s30, s30, 16
    v_and_b32 v204, s30, v220
    v_and_b32 v205, s30, v220
    v_and_b32 v206, s30, v220
    v_and_b32 v207, s30, v220
    s_waitcnt lgkmcnt(0)
    v_xor_b32 v24, 0x80008000, v24
    v_xor_b32 v25, 0x80008000, v25
    v_xor_b32 v26, 0x80008000, v26
    v_xor_b32 v27, 0x80008000, v27
    v_xor_b32 v28, 0x80008000, v28
    v_xor_b32 v29, 0x80008000, v29
    v_xor_b32 v30, 0x80008000, v30
    v_xor_b32 v31, 0x80008000, v31
    v_mfma_f32_4x4x4_16b_bf16 v[56:59], v[218:219], v[4:5], 0
    v_mfma_f32_4x4x4_16b_bf16 v[68:71], v[218:219], v[12:13], 0
    v_mfma_f32_4x4x4_16b_bf16 v[60:63], v[218:219], v[6:7], 0
    v_mfma_f32_4x4x4_16b_bf16 v[72:75], v[218:219], v[14:15], 0
    v_mfma_f32_4x4x4_16b_bf16 v[56:59], v[218:219], v[8:9], v[56:59]
    v_mfma_f32_4x4x4_16b_bf16 v[60:63], v[218:219], v[10:11], v[60:63]
    v_mfma_f32_16x16x32_bf16 v[52:55], v[16:19], v[40:43], v[48:51]
    v_mfma_f32_16x16x32_bf16 v[52:55], v[20:23], v[44:47], v[52:55]
    v_mfma_f32_16x16x32_bf16 v[52:55], v[24:27], v[40:43], v[52:55]
    v_mfma_f32_16x16x32_bf16 v[52:55], v[28:31], v[44:47], v[52:55]
    v_mfma_f32_16x16x32_bf16 v[48:51], v[16:19], v[32:35], v[48:51]
    v_mfma_f32_16x16x32_bf16 v[48:51], v[20:23], v[36:39], v[48:51]
    v_mfma_f32_16x16x32_bf16 v[48:51], v[24:27], v[32:35], v[48:51]
    v_mfma_f32_16x16x32_bf16 v[48:51], v[28:31], v[36:39], v[48:51]
    v_mul_f32 v56, s92, v56
    v_mul_f32 v57, s92, v57
    v_mul_f32 v58, s92, v58
    v_mul_f32 v59, s92, v59
    v_mul_f32 v60, s92, v60
    v_mul_f32 v61, s92, v61
    v_mul_f32 v62, s92, v62
    v_mul_f32 v63, s92, v63
    v_mul_f32 v68, s92, v68
    v_mul_f32 v69, s92, v69
    v_mul_f32 v70, s92, v70
    v_mul_f32 v71, s92, v71
    v_mul_f32 v72, s92, v72
    v_mul_f32 v73, s92, v73
    v_mul_f32 v74, s92, v74
    v_mul_f32 v75, s92, v75
    s_add_u32 s66, s52, 11520
    v_add_u32 v3, s66, v2
    v_cvt_pk_bf16_f32 v68, v68, v69
    v_cvt_pk_bf16_f32 v69, v70, v71
    v_cvt_pk_bf16_f32 v70, v72, v73
    v_cvt_pk_bf16_f32 v71, v74, v75
    v_mul_f32 v48, s92, v48
    v_mul_f32 v49, s92, v49
    v_mul_f32 v50, s92, v50
    v_mul_f32 v51, s92, v51
    v_mul_f32 v52, s92, v52
    v_mul_f32 v53, s92, v53
    v_mul_f32 v54, s92, v54
    v_mul_f32 v55, s92, v55
    ds_write_b128 v3, v[56:59]
    ds_write_b128 v3, v[60:63] offset:1024
    ds_write_b128 v3, v[68:71] offset:2048
    ds_write_b128 v98, v[48:51]
    ds_write_b128 v98, v[52:55] offset:40960
    v_add_u32 v3, 11520, v2
    v_add_u32 v246, 81920, v3
    s_waitcnt lgkmcnt(0)
    s_barrier
    s_cmp_ge_u32 s54, 4
    s_cbranch_scc0 L_old3
    s_waitcnt vmcnt(4)
    s_call_b64 s[62:63], L_fp
    s_branch L_yng3
L_old3:
    s_call_b64 s[62:63], L_t23
L_yng3:
    ds_read_b128 v[4:7], v3 offset:0
    ds_read_b128 v[8:11], v3 offset:1024
    ds_read_b128 v[68:71], v3 offset:2048
    ds_read_b128 v[12:15], v3 offset:20480
    ds_read_b128 v[16:19], v3 offset:21504
    ds_read_b128 v[72:75], v3 offset:22528
    ds_read_b128 v[20:23], v3 offset:40960
    ds_read_b128 v[24:27], v3 offset:41984
    ds_read_b128 v[76:79], v3 offset:43008
    s_waitcnt vmcnt(4)
    v_mfma_i32_16x16x64_i8 v[172:175], v[122:125], v[104:107], 0
    v_mfma_i32_16x16x64_i8 v[176:179], v[122:125], v[108:111], 0
    v_mfma_i32_16x16x64_i8 v[180:183], v[122:125], v[112:115], 0
    v_and_b32 v160, 0x800080, v104
    v_mul_u32_u24 v160, 0x7f, v160
    v_bitop3_b32 v131, v104, v160, v131 bitop3:0xbe
    v_and_b32 v161, 0x800080, v105
    v_mul_u32_u24 v161, 0x7f, v161
    v_bitop3_b32 v131, v105, v161, v131 bitop3:0xbe
    v_and_b32 v160, 0x800080, v106
    v_mul_u32_u24 v160, 0x7f, v160
    v_bitop3_b32 v131, v106, v160, v131 bitop3:0xbe
    v_mov_b32_dpp v184, v172 row_shr:1 row_mask:0xf bank_mask:0xf bound_ctrl:0
    v_mov_b32_dpp v185, v176 row_shr:1 row_mask:0xf bank_mask:0xf bound_ctrl:0
    v_mov_b32_dpp v186, v180 row_shr:1 row_mask:0xf bank_mask:0xf bound_ctrl:0
    v_add_u32_dpp v184, v184, v184 row_shr:1 row_mask:0xf bank_mask:0xf bound_ctrl:0
    v_add_u32_dpp v185, v185, v185 row_shr:1 row_mask:0xf bank_mask:0xf bound_ctrl:0
    v_add_u32_dpp v186, v186, v186 row_shr:1 row_mask:0xf bank_mask:0xf bound_ctrl:0
    v_add_u32_dpp v184, v184, v184 row_shr:2 row_mask:0xf bank_mask:0xf bound_ctrl:0
    v_add_u32_dpp v185, v185, v185 row_shr:2 row_mask:0xf bank_mask:0xf bound_ctrl:0
    v_add_u32_dpp v186, v186, v186 row_shr:2 row_mask:0xf bank_mask:0xf bound_ctrl:0
    v_add_u32_dpp v184, v184, v184 row_shr:4 row_mask:0xf bank_mask:0xf bound_ctrl:0
    v_add_u32_dpp v185, v185, v185 row_shr:4 row_mask:0xf bank_mask:0xf bound_ctrl:0
    v_add_u32_dpp v186, v186, v186 row_shr:4 row_mask:0xf bank_mask:0xf bound_ctrl:0
    v_add_u32_dpp v184, v184, v184 row_shr:8 row_mask:0xf bank_mask:0xf bound_ctrl:0
    v_add_u32_dpp v185, v185, v185 row_shr:8 row_mask:0xf bank_mask:0xf bound_ctrl:0
    v_add_u32_dpp v186, v186, v186 row_shr:8 row_mask:0xf bank_mask:0xf bound_ctrl:0
    ds_read_b128 v[28:31], v3 offset:61440
    ds_read_b128 v[32:35], v3 offset:62464
    ds_read_b128 v[80:83], v3 offset:63488
    ds_read_b128 v[36:39], v246 offset:0
    ds_read_b128 v[40:43], v246 offset:1024
    ds_read_b128 v[84:87], v246 offset:2048
    v_and_b32 v161, 0x800080, v107
    v_mul_u32_u24 v161, 0x7f, v161
    v_bitop3_b32 v131, v107, v161, v131 bitop3:0xbe
    v_and_b32 v160, 0x800080, v108
    v_mul_u32_u24 v160, 0x7f, v160
    v_bitop3_b32 v131, v108, v160, v131 bitop3:0xbe
    v_and_b32 v161, 0x800080, v109
    v_mul_u32_u24 v161, 0x7f, v161
    v_bitop3_b32 v131, v109, v161, v131 bitop3:0xbe
    v_and_b32 v160, 0x800080, v110
    v_mul_u32_u24 v160, 0x7f, v160
    v_bitop3_b32 v131, v110, v160, v131 bitop3:0xbe
    v_and_b32 v161, 0x800080, v111
    v_mul_u32_u24 v161, 0x7f, v161
    v_bitop3_b32 v131, v111, v161, v131 bitop3:0xbe
    v_and_b32 v160, 0x800080, v112
    v_mul_u32_u24 v160, 0x7f, v160
    v_bitop3_b32 v131, v112, v160, v131 bitop3:0xbe
    v_and_b32 v161, 0x800080, v113
    v_mul_u32_u24 v161, 0x7f, v161
    v_bitop3_b32 v131, v113, v161, v131 bitop3:0xbe
    v_and_b32 v160, 0x800080, v114
    v_mul_u32_u24 v160, 0x7f, v160
    v_bitop3_b32 v131, v114, v160, v131 bitop3:0xbe
    v_and_b32 v161, 0x800080, v115
    v_mul_u32_u24 v161, 0x7f, v161
    v_bitop3_b32 v131, v115, v161, v131 bitop3:0xbe
    v_cmp_ne_u32 vcc, 0, v131
    v_readlane_b32 s68, v184, 6
    v_readlane_b32 s69, v173, 6
    v_readlane_b32 s70, v184, 15
    v_readlane_b32 s72, v185, 6
    v_readlane_b32 s73, v177, 6
    v_readlane_b32 s74, v185, 15
    v_readlane_b32 s76, v186, 6
    v_readlane_b32 s77, v181, 6
    v_readlane_b32 s78, v186, 15
    s_cbranch_vccnz L_general
    s_add_u32 s66, s68, s69
    s_add_u32 s66, s66, s64
    s_add_u32 s67, s66, 15
    s_and_b32 s67, s67, -16
    s_add_u32 s55, s64, 16
    s_max_u32 s67, s67, s55
    s_sub_u32 s66, s67, s66
    v_mad_u32_u24 v184, v130, s66, v184
    s_sub_u32 s55, s64, 2048
    v_add_u32 v172, s55, v184
    v_add_u32 v173, s55, v184
    v_add_u32 v174, s55, v184
    v_add_u32 v175, s55, v184
    s_add_u32 s64, s64, s70
    s_add_u32 s64, s64, s66
    v_mfma_i32_16x16x64_i8 v[132:135], v[118:121], v[104:107], v[172:175]
    v_mfma_i32_16x16x64_i8 v[136:139], v[116:119], v[104:107], v[172:175]
    s_add_u32 s64, s64, 15
    s_and_b32 s64, s64, -16
    s_add_u32 s55, s67, 16
    s_max_u32 s64, s64, s55
    s_lshr_b32 s95, s67, 4
    s_bitset1_b64 s[56:57], s95
    s_lshr_b32 s95, s64, 4
    s_bitset1_b64 s[56:57], s95
    s_add_u32 s66, s72, s73
    s_add_u32 s66, s66, s64
    s_add_u32 s67, s66, 15
    s_and_b32 s67, s67, -16
    s_add_u32 s55, s64, 16
    s_max_u32 s67, s67, s55
    s_sub_u32 s66, s67, s66
    v_mad_u32_u24 v185, v130, s66, v185
    s_sub_u32 s55, s64, 2048
    v_add_u32 v176, s55, v185
    v_add_u32 v177, s55, v185
    v_add_u32 v178, s55, v185
    v_add_u32 v179, s55, v185
    s_add_u32 s64, s64, s74
    s_add_u32 s64, s64, s66
    v_mfma_i32_16x16x64_i8 v[140:143], v[118:121], v[108:111], v[176:179]
    v_mfma_i32_16x16x64_i8 v[144:147], v[116:119], v[108:111], v[176:179]
    s_add_u32 s64, s64, 15
    s_and_b32 s64, s64, -16
    s_add_u32 s55, s67, 16
    s_max_u32 s64, s64, s55
    s_lshr_b32 s95, s67, 4
    s_lshl_b64 s[86:87], 1, s95
    s_bitcmp1_b32 s67, 10
    s_cselect_b64 s[88:89], 0, s[86:87]
    s_cselect_b64 s[90:91], s[86:87], 0
    s_or_b64 s[56:57], s[56:57], s[88:89]
    s_or_b64 s[58:59], s[58:59], s[90:91]
    s_lshr_b32 s95, s64, 4
    s_lshl_b64 s[86:87], 1, s95
    s_bitcmp1_b32 s64, 10
    s_cselect_b64 s[88:89], 0, s[86:87]
    s_cselect_b64 s[90:91], s[86:87], 0
    s_or_b64 s[56:57], s[56:57], s[88:89]
    s_or_b64 s[58:59], s[58:59], s[90:91]
    ds_write_b8 v132, v126
    ds_write_b8_d16_hi v133, v126
    ds_write_b8 v134, v127
    ds_write_b8_d16_hi v135, v127
    ds_write_b8 v136, v128
    ds_write_b8_d16_hi v137, v128
    ds_write_b8 v138, v129
    ds_write_b8_d16_hi v139, v129
    s_add_u32 s66, s76, s77
    s_add_u32 s66, s66, s64
    s_add_u32 s67, s66, 15
    s_and_b32 s67, s67, -16
    s_add_u32 s55, s64, 16
    s_max_u32 s67, s67, s55
    s_sub_u32 s66, s67, s66
    v_mad_u32_u24 v186, v130, s66, v186
    s_sub_u32 s55, s64, 2048
    v_add_u32 v180, s55, v186
    v_add_u32 v181, s55, v186
    v_add_u32 v182, s55, v186
    v_add_u32 v183, s55, v186
    s_add_u32 s64, s64, s78
    s_add_u32 s64, s64, s66
    v_mfma_i32_16x16x64_i8 v[164:167], v[118:121], v[112:115], v[180:183]
    v_mfma_i32_16x16x64_i8 v[168:171], v[116:119], v[112:115], v[180:183]
    s_add_u32 s64, s64, 15
    s_and_b32 s64, s64, -16
    s_add_u32 s55, s67, 16
    s_max_u32 s64, s64, s55
    s_lshr_b32 s95, s67, 4
    s_lshl_b64 s[86:87], 1, s95
    s_bitcmp1_b32 s67, 10
    s_cselect_b64 s[88:89], 0, s[86:87]
    s_cselect_b64 s[90:91], s[86:87], 0
    s_or_b64 s[56:57], s[56:57], s[88:89]
    s_or_b64 s[58:59], s[58:59], s[90:91]
    s_lshr_b32 s95, s64, 4
    s_lshl_b64 s[86:87], 1, s95
    s_bitcmp1_b32 s64, 10
    s_cselect_b64 s[88:89], 0, s[86:87]
    s_cselect_b64 s[90:91], s[86:87], 0
    s_or_b64 s[56:57], s[56:57], s[88:89]
    s_or_b64 s[58:59], s[58:59], s[90:91]
    ds_write_b8 v140, v126
    ds_write_b8_d16_hi v141, v126
    ds_write_b8 v142, v127
    ds_write_b8_d16_hi v143, v127
    ds_write_b8 v144, v128
    ds_write_b8_d16_hi v145, v128
    ds_write_b8 v146, v129
    ds_write_b8_d16_hi v147, v129
    ds_read_b128 v[44:47], v246 offset:20480
    ds_read_b128 v[48:51], v246 offset:21504
    ds_read_b128 v[88:91], v246 offset:22528
    ds_read_b128 v[52:55], v246 offset:40960
    ds_read_b128 v[56:59], v246 offset:41984
    ds_read_b128 v[92:95], v246 offset:43008
    ds_read_b128 v[60:63], v246 offset:61440
    ds_read_b128 v[64:67], v246 offset:62464
    ds_read_b128 v[96:99], v246 offset:63488
    ds_read_u16 v224, v238 offset:0
    ds_read_u16 v225, v238 offset:8
    ds_read_u16 v226, v238 offset:64
    ds_read_u16 v227, v238 offset:72
    ds_write_b8 v164, v126
    ds_write_b8_d16_hi v165, v126
    ds_write_b8 v166, v127
    ds_write_b8_d16_hi v167, v127
    ds_write_b8 v168, v128
    ds_write_b8_d16_hi v169, v128
    ds_write_b8 v170, v129
    ds_write_b8_d16_hi v171, v129
    s_cmp_ge_u32 s54, 4
    s_cbranch_scc0 L_old3b
    s_call_b64 s[62:63], L_t23
L_old3b:
L_listed:
    s_sub_u32 s66, s64, s52
    s_sub_u32 s66, s66, 18448
    s_lshr_b32 s66, s66, 3
    s_lshr_b32 s67, s54, 2
    s_mul_i32 s67, s67, 2
    s_add_u32 s66, s66, s67
    s_sub_u32 s67, 0, s66
    v_mov_b32 v2, v221
    v_mov_b32 v1, s66
    v_mov_b32 v3, -8
    v_writelane_b32 v1, s67, 1
    v_writelane_b32 v3, 8, 1
    ds_add_u32 v2, v1
    s_cmp_eq_u32 s94, 1
    s_cbranch_scc1 L_nolate
    ds_read_u8 v148, v237 offset:0
    ds_read_u8 v149, v237 offset:8
    ds_read_u8 v150, v237 offset:16
    ds_read_u8 v151, v237 offset:24
    ds_read_u8 v152, v237 offset:32
    ds_read_u8 v153, v237 offset:40
    ds_read_u8 v154, v237 offset:48
    ds_read_u8 v155, v237 offset:56
    s_waitcnt lgkmcnt(0)
    s_add_u32 m0, s52, 0
    v_mov_b32 v230, v148
    v_mov_b32 v232, v149
    buffer_load_dwordx4 v[230:231], s[20:23], s35 idxen offen nt lds
    buffer_load_dwordx4 v[232:233], s[40:43], s35 idxen offen offset:1056 nt lds
    s_bitcmp0_b64 s[56:57], 2
    s_cbranch_scc1 L_noadvl1
    s_add_u32 s35, s35, s31
    s_min_u32 s35, s35, 419404800
    s_xor_b32 s31, s31, 0x63ff800
L_noadvl1:
    s_add_u32 m0, s52, 2080
    v_mov_b32 v230, v150
    v_mov_b32 v232, v151
    buffer_load_dwordx4 v[230:231], s[20:23], s35 idxen offen nt lds
    buffer_load_dwordx4 v[232:233], s[40:43], s35 idxen offen offset:1056 nt lds
    s_bitcmp0_b64 s[56:57], 3
    s_cbranch_scc1 L_noadvl2
    s_add_u32 s35, s35, s31
    s_min_u32 s35, s35, 419404800
    s_xor_b32 s31, s31, 0x63ff800
L_noadvl2:
    s_add_u32 m0, s52, 4160
    v_mov_b32 v230, v152
    v_mov_b32 v232, v153
    buffer_load_dwordx4 v[230:231], s[20:23], s35 idxen offen nt lds
    buffer_load_dwordx4 v[232:233], s[40:43], s35 idxen offen offset:1056 nt lds
    s_bitcmp0_b64 s[56:57], 4
    s_cbranch_scc1 L_noadvl3
    s_add_u32 s35, s35, s31
    s_min_u32 s35, s35, 419404800
    s_xor_b32 s31, s31, 0x63ff800
L_noadvl3:
    s_add_u32 m0, s52, 6240
    v_mov_b32 v230, v154
    v_mov_b32 v232, v155
    buffer_load_dwordx4 v[230:231], s[20:23], s35 idxen offen nt lds
    buffer_load_dwordx4 v[232:233], s[40:43], s35 idxen offen offset:1056 nt lds
L_nolate:
    v_and_b32_dpp v196, v216, v220 quad_perm:[0,0,0,0] row_mask:0xf bank_mask:0xf
    v_and_b32_dpp v197, v217, v220 quad_perm:[0,0,0,0] row_mask:0xf bank_mask:0xf
    v_and_b32_dpp v198, v216, v220 quad_perm:[1,1,1,1] row_mask:0xf bank_mask:0xf
    v_and_b32_dpp v199, v217, v220 quad_perm:[1,1,1,1] row_mask:0xf bank_mask:0xf
    v_and_b32_dpp v200, v216, v220 quad_perm:[2,2,2,2] row_mask:0xf bank_mask:0xf
    v_and_b32_dpp v201, v217, v220 quad_perm:[2,2,2,2] row_mask:0xf bank_mask:0xf
    v_and_b32_dpp v202, v216, v220 quad_perm:[3,3,3,3] row_mask:0xf bank_mask:0xf
    v_and_b32_dpp v203, v217, v220 quad_perm:[3,3,3,3] row_mask:0xf bank_mask:0xf
    s_waitcnt vmcnt(6) lgkmcnt(0)
    ds_read_b128 v[180:183], v234 offset:0
    ds_read_b128 v[184:187], v235 offset:0
    v_mul_u32_u24 v216, v224, v241
    v_mul_u32_u24 v217, v224, v242
    v_mul_u32_u24 v218, v225, v241
    v_mul_u32_u24 v219, v225, v242
    v_mul_u32_u24 v220, v226, v241
    v_mul_u32_u24 v221, v226, v242
    v_mul_u32_u24 v222, v227, v241
    v_mul_u32_u24 v223, v227, v242
    v_add_u32 v238, 128, v238
    ds_read_b128 v[164:167], v239
    v_mfma_f32_4x4x4_16b_bf16 v[132:135], v[216:217], v[68:69], v[4:7]
    ds_read_b128 v[168:171], v239 offset:64
    ds_read_b128 v[172:175], v239 offset:128
    v_mfma_f32_4x4x4_16b_bf16 v[136:139], v[218:219], v[70:71], v[8:11]
    ds_read_b128 v[176:179], v239 offset:192
    ds_read_u16 v224, v238
    v_mfma_f32_4x4x4_16b_bf16 v[140:143], v[220:221], v[72:73], v[12:15]
    ds_read_u16 v225, v238 offset:8
    ds_read_u16 v226, v238 offset:64
    v_mfma_f32_4x4x4_16b_bf16 v[144:147], v[222:223], v[74:75], v[16:19]
    ds_read_u16 v227, v238 offset:72
    v_add_u32 v239, 272, v239
    v_mfma_f32_4x4x4_16b_bf16 v[246:249], v[216:217], v[76:77], v[20:23]
    v_cvt_pk_bf16_f32 v100, v132, v133
    v_cvt_pk_bf16_f32 v101, v134, v135
    v_mfma_f32_4x4x4_16b_bf16 v[250:253], v[218:219], v[78:79], v[24:27]
    v_cvt_pk_bf16_f32 v102, v136, v137
    v_cvt_pk_bf16_f32 v103, v138, v139
    v_mfma_f32_4x4x4_16b_bf16 v[132:135], v[220:221], v[80:81], v[28:31]
    v_cvt_pk_bf16_f32 v104, v140, v141
    v_cvt_pk_bf16_f32 v105, v142, v143
    v_mfma_f32_4x4x4_16b_bf16 v[136:139], v[222:223], v[82:83], v[32:35]
    v_cvt_pk_bf16_f32 v106, v144, v145
    v_cvt_pk_bf16_f32 v107, v146, v147
    v_mfma_f32_4x4x4_16b_bf16 v[140:143], v[216:217], v[84:85], v[36:39]
    v_cvt_pk_bf16_f32 v108, v246, v247
    v_cvt_pk_bf16_f32 v109, v248, v249
    v_mfma_f32_4x4x4_16b_bf16 v[144:147], v[218:219], v[86:87], v[40:43]
    v_cvt_pk_bf16_f32 v110, v250, v251
    v_cvt_pk_bf16_f32 v111, v252, v253
    v_mfma_f32_4x4x4_16b_bf16 v[246:249], v[220:221], v[88:89], v[44:47]
    v_cvt_pk_bf16_f32 v112, v132, v133
    v_cvt_pk_bf16_f32 v113, v134, v135
    v_mfma_f32_4x4x4_16b_bf16 v[250:253], v[222:223], v[90:91], v[48:51]
    v_cvt_pk_bf16_f32 v114, v136, v137
    v_cvt_pk_bf16_f32 v115, v138, v139
    v_mfma_f32_4x4x4_16b_bf16 v[132:135], v[216:217], v[92:93], v[52:55]
    v_cvt_pk_bf16_f32 v116, v140, v141
    v_cvt_pk_bf16_f32 v117, v142, v143
    v_mfma_f32_4x4x4_16b_bf16 v[136:139], v[218:219], v[94:95], v[56:59]
    v_cvt_pk_bf16_f32 v118, v144, v145
    v_cvt_pk_bf16_f32 v119, v146, v147
    v_mfma_f32_4x4x4_16b_bf16 v[140:143], v[220:221], v[96:97], v[60:63]
    v_cvt_pk_bf16_f32 v120, v246, v247
    v_cvt_pk_bf16_f32 v121, v248, v249
    v_mfma_f32_4x4x4_16b_bf16 v[144:147], v[222:223], v[98:99], v[64:67]
    v_cvt_pk_bf16_f32 v122, v250, v251
    v_cvt_pk_bf16_f32 v123, v252, v253
    v_cvt_pk_bf16_f32 v124, v132, v133
    v_cvt_pk_bf16_f32 v125, v134, v135
    v_cvt_pk_bf16_f32 v126, v136, v137
    v_cvt_pk_bf16_f32 v127, v138, v139
    v_cvt_pk_bf16_f32 v128, v140, v141
    v_cvt_pk_bf16_f32 v129, v142, v143
    v_cvt_pk_bf16_f32 v130, v144, v145
    v_cvt_pk_bf16_f32 v131, v146, v147
    s_waitcnt lgkmcnt(0)
    v_mfma_f32_16x16x32_bf16 v[148:151], v[100:103], v[180:183], v[164:167]
    v_mfma_f32_16x16x32_bf16 v[148:151], v[104:107], v[184:187], v[148:151]
    v_mfma_f32_16x16x32_bf16 v[152:155], v[108:111], v[180:183], v[168:171]
    v_mfma_f32_16x16x32_bf16 v[152:155], v[112:115], v[184:187], v[152:155]
    v_mfma_f32_16x16x32_bf16 v[156:159], v[116:119], v[180:183], v[172:175]
    v_mfma_f32_16x16x32_bf16 v[156:159], v[120:123], v[184:187], v[156:159]
    v_mfma_f32_16x16x32_bf16 v[160:163], v[124:127], v[180:183], v[176:179]
    v_mfma_f32_16x16x32_bf16 v[160:163], v[128:131], v[184:187], v[160:163]
    s_waitcnt vmcnt(4)
    ds_read_b128 v[180:183], v234 offset:2080
    ds_read_b128 v[184:187], v235 offset:2080
    ds_read_u8 v230, v237 offset:64
    ds_read_u8 v232, v237 offset:72
    s_lshr_b64 s[86:87], s[56:57], 2
    s_lshr_b64 s[36:37], s[56:57], 5
    s_or_b32 s36, s36, s86
    s_or_b32 s36, s36, s56
    s_cmp_lg_u64 s[84:85], 0
    s_cbranch_scc0 Lf_mid
    s_mul_i32 s66, s53, 800
    s_add_u32 s8, s8, s66
    s_addc_u32 s9, s9, 0
    s_mov_b32 s24, s8
    s_and_b32 s25, s9, 0xffff
    s_mov_b32 s26, 400
    s_mov_b32 s27, 0x20000
    s_movk_i32 s32, 400
    s_branch Ls_mid
L_fp:
    v_mfma_i32_16x16x64_i8 v[172:175], v[122:125], v[100:103], 0
    v_and_b32 v160, 0x800080, v100
    v_mul_u32_u24 v160, 0x7f, v160
    v_bitop3_b32 v131, v100, v160, v131 bitop3:0xbe
    v_and_b32 v161, 0x800080, v101
    v_mul_u32_u24 v161, 0x7f, v161
    v_bitop3_b32 v131, v101, v161, v131 bitop3:0xbe
    v_and_b32 v160, 0x800080, v102
    v_mul_u32_u24 v160, 0x7f, v160
    v_mov_b32_dpp v184, v172 row_shr:1 row_mask:0xf bank_mask:0xf bound_ctrl:0
    v_bitop3_b32 v131, v102, v160, v131 bitop3:0xbe
    s_nop 0
    v_add_u32_dpp v184, v184, v184 row_shr:1 row_mask:0xf bank_mask:0xf bound_ctrl:0
    v_and_b32 v161, 0x800080, v103
    s_nop 0
    v_add_u32_dpp v184, v184, v184 row_shr:2 row_mask:0xf bank_mask:0xf bound_ctrl:0
    v_mul_u32_u24 v161, 0x7f, v161
    s_nop 0
    v_add_u32_dpp v184, v184, v184 row_shr:4 row_mask:0xf bank_mask:0xf bound_ctrl:0
    v_bitop3_b32 v131, v103, v161, v131 bitop3:0xbe
    s_nop 0
    v_add_u32_dpp v184, v184, v184 row_shr:8 row_mask:0xf bank_mask:0xf bound_ctrl:0
    v_cmp_ne_u32 vcc, 0, v131
    v_readlane_b32 s68, v184, 6
    v_readlane_b32 s69, v173, 6
    v_readlane_b32 s70, v184, 15
    s_mov_b32 s94, 0
    s_cbranch_vccnz L_late
    s_add_u32 s66, s68, s69
    s_add_u32 s66, s66, s64
    s_add_u32 s67, s66, 15
    s_and_b32 s67, s67, -16
    s_add_u32 s55, s64, 16
    s_max_u32 s67, s67, s55
    s_sub_u32 s66, s67, s66
    v_mad_u32_u24 v184, v130, s66, v184
    s_sub_u32 s55, s64, 2048
    v_add_u32 v172, s55, v184
    v_add_u32 v173, s55, v184
    v_add_u32 v174, s55, v184
    v_add_u32 v175, s55, v184
    s_add_u32 s64, s64, s70
    s_add_u32 s64, s64, s66
    v_mfma_i32_16x16x64_i8 v[132:135], v[118:121], v[100:103], v[172:175]
    v_mfma_i32_16x16x64_i8 v[136:139], v[116:119], v[100:103], v[172:175]
    s_add_u32 s64, s64, 15
    s_and_b32 s64, s64, -16
    s_add_u32 s55, s67, 16
    s_max_u32 s64, s64, s55
    s_lshr_b32 s95, s67, 4
    s_bitset1_b64 s[56:57], s95
    s_lshr_b32 s95, s64, 4
    s_bitset1_b64 s[56:57], s95
    s_add_u32 s66, s52, 18512
    s_cmp_ge_u32 s64, s66
    ds_write_b8 v132, v126
    ds_write_b8_d16_hi v133, v126
    ds_write_b8 v134, v127
    ds_write_b8_d16_hi v135, v127
    ds_write_b8 v136, v128
    ds_write_b8_d16_hi v137, v128
    ds_write_b8 v138, v129
    ds_write_b8_d16_hi v139, v129
    s_cbranch_scc0 L_late
    s_mov_b32 s94, 1
    ds_read_u8 v148, v237 offset:0
    ds_read_u8 v149, v237 offset:8
    ds_read_u8 v150, v237 offset:16
    ds_read_u8 v151, v237 offset:24
    ds_read_u8 v152, v237 offset:32
    ds_read_u8 v153, v237 offset:40
    ds_read_u8 v154, v237 offset:48
    ds_read_u8 v155, v237 offset:56
    s_waitcnt lgkmcnt(0)
    s_add_u32 m0, s52, 0
    v_mov_b32 v230, v148
    v_mov_b32 v232, v149
    buffer_load_dwordx4 v[230:231], s[20:23], s35 idxen offen nt lds
    buffer_load_dwordx4 v[232:233], s[40:43], s35 idxen offen offset:1056 nt lds
    s_bitcmp0_b64 s[56:57], 2
    s_cbranch_scc1 L_noadve1
    s_add_u32 s35, s35, s31
    s_min_u32 s35, s35, 419404800
    s_xor_b32 s31, s31, 0x63ff800
L_noadve1:
    s_add_u32 m0, s52, 2080
    v_mov_b32 v230, v150
    v_mov_b32 v232, v151
    buffer_load_dwordx4 v[230:231], s[20:23], s35 idxen offen nt lds
    buffer_load_dwordx4 v[232:233], s[40:43], s35 idxen offen offset:1056 nt lds
    s_setpc_b64 s[62:63]
L_late:
    s_waitcnt vmcnt(0)
    s_setpc_b64 s[62:63]
L_t23:
    s_cmp_eq_u32 s94, 0
    s_cbranch_scc1 L_skip23
    s_bitcmp0_b64 s[56:57], 3
    s_cbranch_scc1 L_noadve2
    s_add_u32 s35, s35, s31
    s_min_u32 s35, s35, 419404800
    s_xor_b32 s31, s31, 0x63ff800
L_noadve2:
    s_add_u32 m0, s52, 4160
    v_mov_b32 v230, v152
    v_mov_b32 v232, v153
    buffer_load_dwordx4 v[230:231], s[20:23], s35 idxen offen nt lds
    buffer_load_dwordx4 v[232:233], s[40:43], s35 idxen offen offset:1056 nt lds
    s_bitcmp0_b64 s[56:57], 4
    s_cbranch_scc1 L_noadve3
    s_add_u32 s35, s35, s31
    s_min_u32 s35, s35, 419404800
    s_xor_b32 s31, s31, 0x63ff800
L_noadve3:
    s_add_u32 m0, s52, 6240
    v_mov_b32 v230, v154
    v_mov_b32 v232, v155
    buffer_load_dwordx4 v[230:231], s[20:23], s35 idxen offen nt lds
    buffer_load_dwordx4 v[232:233], s[40:43], s35 idxen offen offset:1056 nt lds
    s_setpc_b64 s[62:63]
L_skip23:
    s_waitcnt vmcnt(0)
    s_setpc_b64 s[62:63]
Lf_loop:
    ds_read_u8 v230, v237 offset:64
    ds_read_u8 v232, v237 offset:72
    v_mfma_f32_16x16x32_bf16 v[208:211], v[136:139], v[200:203], v[208:211]
Lf_mid:
    s_bitcmp1_b32 s36, 0
    s_cbranch_scc1 Lf_ev0
Lf_evd0:
    ds_add_rtn_u32 v1, v2, v3
    v_exp_f32 v132, v148
    v_exp_f32 v133, v149
    v_exp_f32 v134, v150
    v_exp_f32 v135, v151
    v_exp_f32 v136, v152
    v_exp_f32 v137, v153
    v_mfma_f32_4x4x4_16b_bf16 v[132:135], v[228:229], v[228:229], v[132:135]
    v_cvt_pk_bf16_f32 v208, v208, v209
    v_cvt_pk_bf16_f32 v209, v210, v211
    s_waitcnt lgkmcnt(2)
    v_mfma_f32_16x16x32_bf16 v[148:151], v[100:103], v[180:183], v[164:167]
    v_exp_f32 v138, v154
    v_mfma_f32_4x4x4_16b_bf16 v[212:215], v[208:209], v[188:189], v[212:215] cbsz:4 abid:0
    ds_read_b64_tr_b16 v[188:189], v236 offset:0
    v_exp_f32 v139, v155
    v_mfma_f32_16x16x32_bf16 v[152:155], v[108:111], v[180:183], v[168:171]
    v_exp_f32 v140, v156
    v_mfma_f32_4x4x4_16b_bf16 v[212:215], v[208:209], v[190:191], v[212:215] cbsz:4 abid:4
    ds_read_b64_tr_b16 v[190:191], v236 offset:512
    v_mfma_f32_4x4x4_16b_bf16 v[136:139], v[228:229], v[228:229], v[136:139]
    v_rcp_f32 v132, v132
    v_mfma_f32_4x4x4_16b_bf16 v[212:215], v[208:209], v[192:193], v[212:215] cbsz:4 abid:8
    ds_read_b64_tr_b16 v[192:193], v236 offset:1056
    v_exp_f32 v141, v157
    v_mfma_f32_16x16x32_bf16 v[148:151], v[104:107], v[184:187], v[148:151]
    v_rcp_f32 v133, v133
    v_mfma_f32_4x4x4_16b_bf16 v[212:215], v[208:209], v[194:195], v[212:215] cbsz:4 abid:12
    ds_read_b64_tr_b16 v[194:195], v236 offset:1568
    v_exp_f32 v142, v158
    v_mfma_f32_16x16x32_bf16 v[152:155], v[112:115], v[184:187], v[152:155]
    v_rcp_f32 v134, v134
    v_exp_f32 v143, v159
    v_rcp_f32 v135, v135
    v_cvt_pk_bf16_f32 v132, v132, v133
    v_mfma_f32_4x4x4_16b_bf16 v[140:143], v[228:229], v[228:229], v[140:143]
    v_exp_f32 v144, v160
    v_mfma_f32_16x16x32_bf16 v[156:159], v[116:119], v[180:183], v[172:175]
    v_rcp_f32 v136, v136
    v_cvt_pk_bf16_f32 v133, v134, v135
    s_add_u32 m0, s52, 0
    s_waitcnt lgkmcnt(0)
    buffer_load_dwordx4 v[230:231], s[20:23], s35 idxen offen nt lds
    v_exp_f32 v145, v161
    buffer_load_dwordx4 v[232:233], s[40:43], s35 idxen offen offset:1056 nt lds
    v_rcp_f32 v137, v137
    v_exp_f32 v146, v162
    v_rcp_f32 v138, v138
    v_cvt_pk_bf16_f32 v134, v136, v137
    v_exp_f32 v147, v163
    v_mfma_f32_16x16x32_bf16 v[160:163], v[124:127], v[180:183], v[176:179]
    v_readfirstlane_b32 s66, v1
    s_setprio 0
    s_cmp_gt_i32 s66, 0
    s_cbranch_scc0 Lf_lo0
    s_setprio 1
Lf_lo0:
    v_rcp_f32 v139, v139
    v_mfma_f32_4x4x4_16b_bf16 v[144:147], v[228:229], v[228:229], v[144:147]
    v_mfma_f32_16x16x32_bf16 v[156:159], v[120:123], v[184:187], v[156:159]
    v_rcp_f32 v140, v140
    v_mfma_f32_16x16x32_bf16 v[160:163], v[128:131], v[184:187], v[160:163]
    v_rcp_f32 v141, v141
    v_cvt_pk_bf16_f32 v135, v138, v139
    s_waitcnt vmcnt(4)
    ds_read_b128 v[180:183], v234 offset:4160
    ds_read_b128 v[184:187], v235 offset:4160
    v_rcp_f32 v142, v142
    v_cvt_pk_bf16_f32 v136, v140, v141
    v_mfma_f32_16x16x32_bf16 v[208:211], v[132:135], v[196:199], v[204:207]
    v_rcp_f32 v143, v143
    v_rcp_f32 v144, v144
    v_cvt_pk_bf16_f32 v137, v142, v143
    v_rcp_f32 v145, v145
    v_rcp_f32 v146, v146
    v_rcp_f32 v147, v147
    v_cvt_pk_bf16_f32 v138, v144, v145
    v_cvt_pk_bf16_f32 v139, v146, v147
    ds_read_u8 v230, v237 offset:80
    ds_read_u8 v232, v237 offset:88
    v_mfma_f32_16x16x32_bf16 v[208:211], v[136:139], v[200:203], v[208:211]
    s_bitcmp1_b32 s36, 1
    s_cbranch_scc1 Lf_ev1
Lf_evd1:
    v_exp_f32 v132, v148
    v_exp_f32 v133, v149
    v_exp_f32 v134, v150
    v_exp_f32 v135, v151
    v_exp_f32 v136, v152
    v_exp_f32 v137, v153
    v_mfma_f32_4x4x4_16b_bf16 v[132:135], v[228:229], v[228:229], v[132:135]
    v_cvt_pk_bf16_f32 v208, v208, v209
    v_cvt_pk_bf16_f32 v209, v210, v211
    s_waitcnt lgkmcnt(2)
    v_mfma_f32_16x16x32_bf16 v[148:151], v[100:103], v[180:183], v[164:167]
    v_exp_f32 v138, v154
    v_mfma_f32_4x4x4_16b_bf16 v[212:215], v[208:209], v[188:189], v[212:215] cbsz:4 abid:0
    ds_read_b64_tr_b16 v[188:189], v236 offset:2080
    v_exp_f32 v139, v155
    v_mfma_f32_16x16x32_bf16 v[152:155], v[108:111], v[180:183], v[168:171]
    v_exp_f32 v140, v156
    v_mfma_f32_4x4x4_16b_bf16 v[212:215], v[208:209], v[190:191], v[212:215] cbsz:4 abid:4
    ds_read_b64_tr_b16 v[190:191], v236 offset:2592
    v_mfma_f32_4x4x4_16b_bf16 v[136:139], v[228:229], v[228:229], v[136:139]
    v_rcp_f32 v132, v132
    v_mfma_f32_4x4x4_16b_bf16 v[212:215], v[208:209], v[192:193], v[212:215] cbsz:4 abid:8
    ds_read_b64_tr_b16 v[192:193], v236 offset:3136
    v_exp_f32 v141, v157
    v_mfma_f32_16x16x32_bf16 v[148:151], v[104:107], v[184:187], v[148:151]
    v_rcp_f32 v133, v133
    v_mfma_f32_4x4x4_16b_bf16 v[212:215], v[208:209], v[194:195], v[212:215] cbsz:4 abid:12
    ds_read_b64_tr_b16 v[194:195], v236 offset:3648
    v_exp_f32 v142, v158
    v_mfma_f32_16x16x32_bf16 v[152:155], v[112:115], v[184:187], v[152:155]
    v_rcp_f32 v134, v134
    v_exp_f32 v143, v159
    v_rcp_f32 v135, v135
    v_cvt_pk_bf16_f32 v132, v132, v133
    v_mfma_f32_4x4x4_16b_bf16 v[140:143], v[228:229], v[228:229], v[140:143]
    v_exp_f32 v144, v160
    v_mfma_f32_16x16x32_bf16 v[156:159], v[116:119], v[180:183], v[172:175]
    v_rcp_f32 v136, v136
    v_cvt_pk_bf16_f32 v133, v134, v135
    s_add_u32 m0, s52, 2080
    s_waitcnt lgkmcnt(0)
    buffer_load_dwordx4 v[230:231], s[20:23], s35 idxen offen nt lds
    v_exp_f32 v145, v161
    buffer_load_dwordx4 v[232:233], s[40:43], s35 idxen offen offset:1056 nt lds
    v_rcp_f32 v137, v137
    v_exp_f32 v146, v162
    v_rcp_f32 v138, v138
    v_cvt_pk_bf16_f32 v134, v136, v137
    v_exp_f32 v147, v163
    v_mfma_f32_16x16x32_bf16 v[160:163], v[124:127], v[180:183], v[176:179]
    v_rcp_f32 v139, v139
    v_mfma_f32_4x4x4_16b_bf16 v[144:147], v[228:229], v[228:229], v[144:147]
    v_mfma_f32_16x16x32_bf16 v[156:159], v[120:123], v[184:187], v[156:159]
    v_rcp_f32 v140, v140
    v_mfma_f32_16x16x32_bf16 v[160:163], v[128:131], v[184:187], v[160:163]
    v_rcp_f32 v141, v141
    v_cvt_pk_bf16_f32 v135, v138, v139
    s_waitcnt vmcnt(4)
    ds_read_b128 v[180:183], v234 offset:6240
    ds_read_b128 v[184:187], v235 offset:6240
    v_rcp_f32 v142, v142
    v_cvt_pk_bf16_f32 v136, v140, v141
    v_mfma_f32_16x16x32_bf16 v[208:211], v[132:135], v[196:199], v[204:207]
    v_rcp_f32 v143, v143
    v_rcp_f32 v144, v144
    v_cvt_pk_bf16_f32 v137, v142, v143
    v_rcp_f32 v145, v145
    v_rcp_f32 v146, v146
    v_rcp_f32 v147, v147
    v_cvt_pk_bf16_f32 v138, v144, v145
    v_cvt_pk_bf16_f32 v139, v146, v147
    ds_read_u8 v230, v237 offset:96
    ds_read_u8 v232, v237 offset:104
    v_mfma_f32_16x16x32_bf16 v[208:211], v[136:139], v[200:203], v[208:211]
    s_bitcmp1_b32 s36, 2
    s_cbranch_scc1 Lf_ev2
Lf_evd2:
    v_exp_f32 v132, v148
    v_exp_f32 v133, v149
    v_exp_f32 v134, v150
    v_exp_f32 v135, v151
    v_exp_f32 v136, v152
    v_exp_f32 v137, v153
    v_mfma_f32_4x4x4_16b_bf16 v[132:135], v[228:229], v[228:229], v[132:135]
    v_cvt_pk_bf16_f32 v208, v208, v209
    v_cvt_pk_bf16_f32 v209, v210, v211
    s_waitcnt lgkmcnt(2)
    v_mfma_f32_16x16x32_bf16 v[148:151], v[100:103], v[180:183], v[164:167]
    v_exp_f32 v138, v154
    v_mfma_f32_4x4x4_16b_bf16 v[212:215], v[208:209], v[188:189], v[212:215] cbsz:4 abid:0
    ds_read_b64_tr_b16 v[188:189], v236 offset:4160
    v_exp_f32 v139, v155
    v_mfma_f32_16x16x32_bf16 v[152:155], v[108:111], v[180:183], v[168:171]
    v_exp_f32 v140, v156
    v_mfma_f32_4x4x4_16b_bf16 v[212:215], v[208:209], v[190:191], v[212:215] cbsz:4 abid:4
    ds_read_b64_tr_b16 v[190:191], v236 offset:4672
    v_mfma_f32_4x4x4_16b_bf16 v[136:139], v[228:229], v[228:229], v[136:139]
    v_rcp_f32 v132, v132
    v_mfma_f32_4x4x4_16b_bf16 v[212:215], v[208:209], v[192:193], v[212:215] cbsz:4 abid:8
    ds_read_b64_tr_b16 v[192:193], v236 offset:5216
    v_exp_f32 v141, v157
    v_mfma_f32_16x16x32_bf16 v[148:151], v[104:107], v[184:187], v[148:151]
    v_rcp_f32 v133, v133
    v_mfma_f32_4x4x4_16b_bf16 v[212:215], v[208:209], v[194:195], v[212:215] cbsz:4 abid:12
    ds_read_b64_tr_b16 v[194:195], v236 offset:5728
    v_exp_f32 v142, v158
    v_mfma_f32_16x16x32_bf16 v[152:155], v[112:115], v[184:187], v[152:155]
    v_rcp_f32 v134, v134
    v_exp_f32 v143, v159
    v_rcp_f32 v135, v135
    v_cvt_pk_bf16_f32 v132, v132, v133
    v_mfma_f32_4x4x4_16b_bf16 v[140:143], v[228:229], v[228:229], v[140:143]
    v_exp_f32 v144, v160
    v_mfma_f32_16x16x32_bf16 v[156:159], v[116:119], v[180:183], v[172:175]
    v_rcp_f32 v136, v136
    v_cvt_pk_bf16_f32 v133, v134, v135
    s_add_u32 m0, s52, 4160
    s_waitcnt lgkmcnt(0)
    buffer_load_dwordx4 v[230:231], s[20:23], s35 idxen offen nt lds
    v_exp_f32 v145, v161
    buffer_load_dwordx4 v[232:233], s[40:43], s35 idxen offen offset:1056 nt lds
    v_rcp_f32 v137, v137
    v_exp_f32 v146, v162
    v_rcp_f32 v138, v138
    v_cvt_pk_bf16_f32 v134, v136, v137
    v_exp_f32 v147, v163
    v_mfma_f32_16x16x32_bf16 v[160:163], v[124:127], v[180:183], v[176:179]
    v_rcp_f32 v139, v139
    v_mfma_f32_4x4x4_16b_bf16 v[144:147], v[228:229], v[228:229], v[144:147]
    v_mfma_f32_16x16x32_bf16 v[156:159], v[120:123], v[184:187], v[156:159]
    v_rcp_f32 v140, v140
    v_mfma_f32_16x16x32_bf16 v[160:163], v[128:131], v[184:187], v[160:163]
    v_rcp_f32 v141, v141
    v_cvt_pk_bf16_f32 v135, v138, v139
    s_waitcnt vmcnt(4)
    ds_read_b128 v[180:183], v234 offset:0
    ds_read_b128 v[184:187], v235 offset:0
    v_rcp_f32 v142, v142
    v_cvt_pk_bf16_f32 v136, v140, v141
    v_mfma_f32_16x16x32_bf16 v[208:211], v[132:135], v[196:199], v[204:207]
    v_rcp_f32 v143, v143
    v_rcp_f32 v144, v144
    v_cvt_pk_bf16_f32 v137, v142, v143
    v_rcp_f32 v145, v145
    v_rcp_f32 v146, v146
    v_rcp_f32 v147, v147
    v_cvt_pk_bf16_f32 v138, v144, v145
    v_cvt_pk_bf16_f32 v139, v146, v147
    ds_read_u8 v230, v237 offset:112
    ds_read_u8 v232, v237 offset:120
    v_mfma_f32_16x16x32_bf16 v[208:211], v[136:139], v[200:203], v[208:211]
    s_bitcmp1_b32 s36, 3
    s_cbranch_scc1 Lf_ev3
Lf_evd3:
    v_exp_f32 v132, v148
    v_exp_f32 v133, v149
    v_exp_f32 v134, v150
    v_exp_f32 v135, v151
    v_exp_f32 v136, v152
    v_exp_f32 v137, v153
    v_mfma_f32_4x4x4_16b_bf16 v[132:135], v[228:229], v[228:229], v[132:135]
    v_cvt_pk_bf16_f32 v208, v208, v209
    v_cvt_pk_bf16_f32 v209, v210, v211
    s_waitcnt lgkmcnt(2)
    v_mfma_f32_16x16x32_bf16 v[148:151], v[100:103], v[180:183], v[164:167]
    v_exp_f32 v138, v154
    v_mfma_f32_4x4x4_16b_bf16 v[212:215], v[208:209], v[188:189], v[212:215] cbsz:4 abid:0
    ds_read_b64_tr_b16 v[188:189], v236 offset:6240
    v_exp_f32 v139, v155
    v_mfma_f32_16x16x32_bf16 v[152:155], v[108:111], v[180:183], v[168:171]
    v_exp_f32 v140, v156
    v_mfma_f32_4x4x4_16b_bf16 v[212:215], v[208:209], v[190:191], v[212:215] cbsz:4 abid:4
    ds_read_b64_tr_b16 v[190:191], v236 offset:6752
    v_mfma_f32_4x4x4_16b_bf16 v[136:139], v[228:229], v[228:229], v[136:139]
    v_rcp_f32 v132, v132
    v_mfma_f32_4x4x4_16b_bf16 v[212:215], v[208:209], v[192:193], v[212:215] cbsz:4 abid:8
    ds_read_b64_tr_b16 v[192:193], v236 offset:7296
    v_exp_f32 v141, v157
    v_mfma_f32_16x16x32_bf16 v[148:151], v[104:107], v[184:187], v[148:151]
    v_rcp_f32 v133, v133
    v_mfma_f32_4x4x4_16b_bf16 v[212:215], v[208:209], v[194:195], v[212:215] cbsz:4 abid:12
    ds_read_b64_tr_b16 v[194:195], v236 offset:7808
    v_exp_f32 v142, v158
    v_mfma_f32_16x16x32_bf16 v[152:155], v[112:115], v[184:187], v[152:155]
    v_rcp_f32 v134, v134
    v_exp_f32 v143, v159
    v_rcp_f32 v135, v135
    v_cvt_pk_bf16_f32 v132, v132, v133
    v_mfma_f32_4x4x4_16b_bf16 v[140:143], v[228:229], v[228:229], v[140:143]
    v_exp_f32 v144, v160
    v_mfma_f32_16x16x32_bf16 v[156:159], v[116:119], v[180:183], v[172:175]
    v_rcp_f32 v136, v136
    v_cvt_pk_bf16_f32 v133, v134, v135
    s_add_u32 m0, s52, 6240
    s_waitcnt lgkmcnt(0)
    buffer_load_dwordx4 v[230:231], s[20:23], s35 idxen offen nt lds
    v_exp_f32 v145, v161
    buffer_load_dwordx4 v[232:233], s[40:43], s35 idxen offen offset:1056 nt lds
    v_rcp_f32 v137, v137
    v_exp_f32 v146, v162
    v_rcp_f32 v138, v138
    v_cvt_pk_bf16_f32 v134, v136, v137
    v_exp_f32 v147, v163
    v_mfma_f32_16x16x32_bf16 v[160:163], v[124:127], v[180:183], v[176:179]
    v_rcp_f32 v139, v139
    v_mfma_f32_4x4x4_16b_bf16 v[144:147], v[228:229], v[228:229], v[144:147]
    v_mfma_f32_16x16x32_bf16 v[156:159], v[120:123], v[184:187], v[156:159]
    v_rcp_f32 v140, v140
    v_mfma_f32_16x16x32_bf16 v[160:163], v[128:131], v[184:187], v[160:163]
    v_rcp_f32 v141, v141
    v_cvt_pk_bf16_f32 v135, v138, v139
    s_waitcnt vmcnt(4)
    ds_read_b128 v[180:183], v234 offset:2080
    ds_read_b128 v[184:187], v235 offset:2080
    v_rcp_f32 v142, v142
    v_cvt_pk_bf16_f32 v136, v140, v141
    v_mfma_f32_16x16x32_bf16 v[208:211], v[132:135], v[196:199], v[204:207]
    v_rcp_f32 v143, v143
    s_lshr_b64 s[56:57], s[56:57], 4
    s_lshl_b64 s[86:87], s[58:59], 60
    s_or_b64 s[56:57], s[56:57], s[86:87]
    s_lshr_b64 s[58:59], s[58:59], 4
    s_lshr_b64 s[86:87], s[56:57], 2
    s_lshr_b64 s[36:37], s[56:57], 5
    s_or_b32 s36, s36, s86
    s_or_b32 s36, s36, s56
    v_add_u32 v237, 64, v237
    v_rcp_f32 v144, v144
    v_cvt_pk_bf16_f32 v137, v142, v143
    v_rcp_f32 v145, v145
    v_rcp_f32 v146, v146
    v_rcp_f32 v147, v147
    v_cvt_pk_bf16_f32 v138, v144, v145
    v_cvt_pk_bf16_f32 v139, v146, v147
    s_branch Lf_loop
Lf_ev0:
    s_bitcmp0_b64 s[56:57], 0
    s_cbranch_scc1 Lf_nf0
    v_cvt_pk_bf16_f32 v246, v212, v212
    v_mov_b32 v212, 0
    ds_write_b16 v240, v246
    v_add_u32 v240, 128, v240
Lf_nf0:
    s_bitcmp0_b64 s[56:57], 5
    s_cbranch_scc1 Lf_na0
    s_add_u32 s35, s35, s31
    s_min_u32 s35, s35, 419404800
    s_xor_b32 s31, s31, 0x63ff800
Lf_na0:
    s_bitcmp0_b64 s[56:57], 2
    s_cbranch_scc1 Lf_evd0
Lf_e10:
    s_sub_u32 s61, s61, 1
    s_cbranch_scc1 Lf_last0
    v_mul_u32_u24 v216, v224, v241
    v_mul_u32_u24 v217, v224, v242
    v_mul_u32_u24 v218, v225, v241
    v_mul_u32_u24 v219, v225, v242
    v_mul_u32_u24 v220, v226, v241
    v_mul_u32_u24 v221, v226, v242
    v_mul_u32_u24 v222, v227, v241
    v_mul_u32_u24 v223, v227, v242
    v_add_u32 v238, 128, v238
    ds_read_b128 v[164:167], v239
    v_mfma_f32_4x4x4_16b_bf16 v[132:135], v[216:217], v[68:69], v[4:7]
    ds_read_b128 v[168:171], v239 offset:64
    ds_read_b128 v[172:175], v239 offset:128
    v_mfma_f32_4x4x4_16b_bf16 v[136:139], v[218:219], v[70:71], v[8:11]
    ds_read_b128 v[176:179], v239 offset:192
    ds_read_u16 v224, v238
    v_mfma_f32_4x4x4_16b_bf16 v[140:143], v[220:221], v[72:73], v[12:15]
    ds_read_u16 v225, v238 offset:8
    ds_read_u16 v226, v238 offset:64
    v_mfma_f32_4x4x4_16b_bf16 v[144:147], v[222:223], v[74:75], v[16:19]
    ds_read_u16 v227, v238 offset:72
    v_add_u32 v239, 272, v239
    v_mfma_f32_4x4x4_16b_bf16 v[246:249], v[216:217], v[76:77], v[20:23]
    v_cvt_pk_bf16_f32 v100, v132, v133
    v_cvt_pk_bf16_f32 v101, v134, v135
    v_mfma_f32_4x4x4_16b_bf16 v[250:253], v[218:219], v[78:79], v[24:27]
    v_cvt_pk_bf16_f32 v102, v136, v137
    v_cvt_pk_bf16_f32 v103, v138, v139
    v_mfma_f32_4x4x4_16b_bf16 v[132:135], v[220:221], v[80:81], v[28:31]
    v_cvt_pk_bf16_f32 v104, v140, v141
    v_cvt_pk_bf16_f32 v105, v142, v143
    v_mfma_f32_4x4x4_16b_bf16 v[136:139], v[222:223], v[82:83], v[32:35]
    v_cvt_pk_bf16_f32 v106, v144, v145
    v_cvt_pk_bf16_f32 v107, v146, v147
    v_mfma_f32_4x4x4_16b_bf16 v[140:143], v[216:217], v[84:85], v[36:39]
    v_cvt_pk_bf16_f32 v108, v246, v247
    v_cvt_pk_bf16_f32 v109, v248, v249
    v_mfma_f32_4x4x4_16b_bf16 v[144:147], v[218:219], v[86:87], v[40:43]
    v_cvt_pk_bf16_f32 v110, v250, v251
    v_cvt_pk_bf16_f32 v111, v252, v253
    v_mfma_f32_4x4x4_16b_bf16 v[246:249], v[220:221], v[88:89], v[44:47]
    v_cvt_pk_bf16_f32 v112, v132, v133
    v_cvt_pk_bf16_f32 v113, v134, v135
    v_mfma_f32_4x4x4_16b_bf16 v[250:253], v[222:223], v[90:91], v[48:51]
    v_cvt_pk_bf16_f32 v114, v136, v137
    v_cvt_pk_bf16_f32 v115, v138, v139
    v_mfma_f32_4x4x4_16b_bf16 v[132:135], v[216:217], v[92:93], v[52:55]
    v_cvt_pk_bf16_f32 v116, v140, v141
    v_cvt_pk_bf16_f32 v117, v142, v143
    v_mfma_f32_4x4x4_16b_bf16 v[136:139], v[218:219], v[94:95], v[56:59]
    v_cvt_pk_bf16_f32 v118, v144, v145
    v_cvt_pk_bf16_f32 v119, v146, v147
    v_mfma_f32_4x4x4_16b_bf16 v[140:143], v[220:221], v[96:97], v[60:63]
    v_cvt_pk_bf16_f32 v120, v246, v247
    v_cvt_pk_bf16_f32 v121, v248, v249
    v_mfma_f32_4x4x4_16b_bf16 v[144:147], v[222:223], v[98:99], v[64:67]
    v_cvt_pk_bf16_f32 v122, v250, v251
    v_cvt_pk_bf16_f32 v123, v252, v253
    v_cvt_pk_bf16_f32 v124, v132, v133
    v_cvt_pk_bf16_f32 v125, v134, v135
    v_cvt_pk_bf16_f32 v126, v136, v137
    v_cvt_pk_bf16_f32 v127, v138, v139
    v_cvt_pk_bf16_f32 v128, v140, v141
    v_cvt_pk_bf16_f32 v129, v142, v143
    v_cvt_pk_bf16_f32 v130, v144, v145
    v_cvt_pk_bf16_f32 v131, v146, v147
    s_waitcnt lgkmcnt(0)
    s_branch Lf_evd0
Lf_ev1:
    s_bitcmp0_b64 s[56:57], 1
    s_cbranch_scc1 Lf_nf1
    v_cvt_pk_bf16_f32 v246, v212, v212
    v_mov_b32 v212, 0
    ds_write_b16 v240, v246
    v_add_u32 v240, 128, v240
Lf_nf1:
    s_bitcmp0_b64 s[56:57], 6
    s_cbranch_scc1 Lf_na1
    s_add_u32 s35, s35, s31
    s_min_u32 s35, s35, 419404800
    s_xor_b32 s31, s31, 0x63ff800
Lf_na1:
    s_bitcmp0_b64 s[56:57], 3
    s_cbranch_scc1 Lf_evd1
Lf_e11:
    s_sub_u32 s61, s61, 1
    s_cbranch_scc1 Lf_last1
    v_mul_u32_u24 v216, v224, v241
    v_mul_u32_u24 v217, v224, v242
    v_mul_u32_u24 v218, v225, v241
    v_mul_u32_u24 v219, v225, v242
    v_mul_u32_u24 v220, v226, v241
    v_mul_u32_u24 v221, v226, v242
    v_mul_u32_u24 v222, v227, v241
    v_mul_u32_u24 v223, v227, v242
    v_add_u32 v238, 128, v238
    ds_read_b128 v[164:167], v239
    v_mfma_f32_4x4x4_16b_bf16 v[132:135], v[216:217], v[68:69], v[4:7]
    ds_read_b128 v[168:171], v239 offset:64
    ds_read_b128 v[172:175], v239 offset:128
    v_mfma_f32_4x4x4_16b_bf16 v[136:139], v[218:219], v[70:71], v[8:11]
    ds_read_b128 v[176:179], v239 offset:192
    ds_read_u16 v224, v238
    v_mfma_f32_4x4x4_16b_bf16 v[140:143], v[220:221], v[72:73], v[12:15]
    ds_read_u16 v225, v238 offset:8
    ds_read_u16 v226, v238 offset:64
    v_mfma_f32_4x4x4_16b_bf16 v[144:147], v[222:223], v[74:75], v[16:19]
    ds_read_u16 v227, v238 offset:72
    v_add_u32 v239, 272, v239
    v_mfma_f32_4x4x4_16b_bf16 v[246:249], v[216:217], v[76:77], v[20:23]
    v_cvt_pk_bf16_f32 v100, v132, v133
    v_cvt_pk_bf16_f32 v101, v134, v135
    v_mfma_f32_4x4x4_16b_bf16 v[250:253], v[218:219], v[78:79], v[24:27]
    v_cvt_pk_bf16_f32 v102, v136, v137
    v_cvt_pk_bf16_f32 v103, v138, v139
    v_mfma_f32_4x4x4_16b_bf16 v[132:135], v[220:221], v[80:81], v[28:31]
    v_cvt_pk_bf16_f32 v104, v140, v141
    v_cvt_pk_bf16_f32 v105, v142, v143
    v_mfma_f32_4x4x4_16b_bf16 v[136:139], v[222:223], v[82:83], v[32:35]
    v_cvt_pk_bf16_f32 v106, v144, v145
    v_cvt_pk_bf16_f32 v107, v146, v147
    v_mfma_f32_4x4x4_16b_bf16 v[140:143], v[216:217], v[84:85], v[36:39]
    v_cvt_pk_bf16_f32 v108, v246, v247
    v_cvt_pk_bf16_f32 v109, v248, v249
    v_mfma_f32_4x4x4_16b_bf16 v[144:147], v[218:219], v[86:87], v[40:43]
    v_cvt_pk_bf16_f32 v110, v250, v251
    v_cvt_pk_bf16_f32 v111, v252, v253
    v_mfma_f32_4x4x4_16b_bf16 v[246:249], v[220:221], v[88:89], v[44:47]
    v_cvt_pk_bf16_f32 v112, v132, v133
    v_cvt_pk_bf16_f32 v113, v134, v135
    v_mfma_f32_4x4x4_16b_bf16 v[250:253], v[222:223], v[90:91], v[48:51]
    v_cvt_pk_bf16_f32 v114, v136, v137
    v_cvt_pk_bf16_f32 v115, v138, v139
    v_mfma_f32_4x4x4_16b_bf16 v[132:135], v[216:217], v[92:93], v[52:55]
    v_cvt_pk_bf16_f32 v116, v140, v141
    v_cvt_pk_bf16_f32 v117, v142, v143
    v_mfma_f32_4x4x4_16b_bf16 v[136:139], v[218:219], v[94:95], v[56:59]
    v_cvt_pk_bf16_f32 v118, v144, v145
    v_cvt_pk_bf16_f32 v119, v146, v147
    v_mfma_f32_4x4x4_16b_bf16 v[140:143], v[220:221], v[96:97], v[60:63]
    v_cvt_pk_bf16_f32 v120, v246, v247
    v_cvt_pk_bf16_f32 v121, v248, v249
    v_mfma_f32_4x4x4_16b_bf16 v[144:147], v[222:223], v[98:99], v[64:67]
    v_cvt_pk_bf16_f32 v122, v250, v251
    v_cvt_pk_bf16_f32 v123, v252, v253
    v_cvt_pk_bf16_f32 v124, v132, v133
    v_cvt_pk_bf16_f32 v125, v134, v135
    v_cvt_pk_bf16_f32 v126, v136, v137
    v_cvt_pk_bf16_f32 v127, v138, v139
    v_cvt_pk_bf16_f32 v128, v140, v141
    v_cvt_pk_bf16_f32 v129, v142, v143
    v_cvt_pk_bf16_f32 v130, v144, v145
    v_cvt_pk_bf16_f32 v131, v146, v147
    s_waitcnt lgkmcnt(0)
    s_branch Lf_evd1
Lf_ev2:
    s_bitcmp0_b64 s[56:57], 2
    s_cbranch_scc1 Lf_nf2
    v_cvt_pk_bf16_f32 v246, v212, v212
    v_mov_b32 v212, 0
    ds_write_b16 v240, v246
    v_add_u32 v240, 128, v240
Lf_nf2:
    s_bitcmp0_b64 s[56:57], 7
    s_cbranch_scc1 Lf_na2
    s_add_u32 s35, s35, s31
    s_min_u32 s35, s35, 419404800
    s_xor_b32 s31, s31, 0x63ff800
Lf_na2:
    s_bitcmp0_b64 s[56:57], 4
    s_cbranch_scc1 Lf_evd2
Lf_e12:
    s_sub_u32 s61, s61, 1
    s_cbranch_scc1 Lf_last2
    v_mul_u32_u24 v216, v224, v241
    v_mul_u32_u24 v217, v224, v242
    v_mul_u32_u24 v218, v225, v241
    v_mul_u32_u24 v219, v225, v242
    v_mul_u32_u24 v220, v226, v241
    v_mul_u32_u24 v221, v226, v242
    v_mul_u32_u24 v222, v227, v241
    v_mul_u32_u24 v223, v227, v242
    v_add_u32 v238, 128, v238
    ds_read_b128 v[164:167], v239
    v_mfma_f32_4x4x4_16b_bf16 v[132:135], v[216:217], v[68:69], v[4:7]
    ds_read_b128 v[168:171], v239 offset:64
    ds_read_b128 v[172:175], v239 offset:128
    v_mfma_f32_4x4x4_16b_bf16 v[136:139], v[218:219], v[70:71], v[8:11]
    ds_read_b128 v[176:179], v239 offset:192
    ds_read_u16 v224, v238
    v_mfma_f32_4x4x4_16b_bf16 v[140:143], v[220:221], v[72:73], v[12:15]
    ds_read_u16 v225, v238 offset:8
    ds_read_u16 v226, v238 offset:64
    v_mfma_f32_4x4x4_16b_bf16 v[144:147], v[222:223], v[74:75], v[16:19]
    ds_read_u16 v227, v238 offset:72
    v_add_u32 v239, 272, v239
    v_mfma_f32_4x4x4_16b_bf16 v[246:249], v[216:217], v[76:77], v[20:23]
    v_cvt_pk_bf16_f32 v100, v132, v133
    v_cvt_pk_bf16_f32 v101, v134, v135
    v_mfma_f32_4x4x4_16b_bf16 v[250:253], v[218:219], v[78:79], v[24:27]
    v_cvt_pk_bf16_f32 v102, v136, v137
    v_cvt_pk_bf16_f32 v103, v138, v139
    v_mfma_f32_4x4x4_16b_bf16 v[132:135], v[220:221], v[80:81], v[28:31]
    v_cvt_pk_bf16_f32 v104, v140, v141
    v_cvt_pk_bf16_f32 v105, v142, v143
    v_mfma_f32_4x4x4_16b_bf16 v[136:139], v[222:223], v[82:83], v[32:35]
    v_cvt_pk_bf16_f32 v106, v144, v145
    v_cvt_pk_bf16_f32 v107, v146, v147
    v_mfma_f32_4x4x4_16b_bf16 v[140:143], v[216:217], v[84:85], v[36:39]
    v_cvt_pk_bf16_f32 v108, v246, v247
    v_cvt_pk_bf16_f32 v109, v248, v249
    v_mfma_f32_4x4x4_16b_bf16 v[144:147], v[218:219], v[86:87], v[40:43]
    v_cvt_pk_bf16_f32 v110, v250, v251
    v_cvt_pk_bf16_f32 v111, v252, v253
    v_mfma_f32_4x4x4_16b_bf16 v[246:249], v[220:221], v[88:89], v[44:47]
    v_cvt_pk_bf16_f32 v112, v132, v133
    v_cvt_pk_bf16_f32 v113, v134, v135
    v_mfma_f32_4x4x4_16b_bf16 v[250:253], v[222:223], v[90:91], v[48:51]
    v_cvt_pk_bf16_f32 v114, v136, v137
    v_cvt_pk_bf16_f32 v115, v138, v139
    v_mfma_f32_4x4x4_16b_bf16 v[132:135], v[216:217], v[92:93], v[52:55]
    v_cvt_pk_bf16_f32 v116, v140, v141
    v_cvt_pk_bf16_f32 v117, v142, v143
    v_mfma_f32_4x4x4_16b_bf16 v[136:139], v[218:219], v[94:95], v[56:59]
    v_cvt_pk_bf16_f32 v118, v144, v145
    v_cvt_pk_bf16_f32 v119, v146, v147
    v_mfma_f32_4x4x4_16b_bf16 v[140:143], v[220:221], v[96:97], v[60:63]
    v_cvt_pk_bf16_f32 v120, v246, v247
    v_cvt_pk_bf16_f32 v121, v248, v249
    v_mfma_f32_4x4x4_16b_bf16 v[144:147], v[222:223], v[98:99], v[64:67]
    v_cvt_pk_bf16_f32 v122, v250, v251
    v_cvt_pk_bf16_f32 v123, v252, v253
    v_cvt_pk_bf16_f32 v124, v132, v133
    v_cvt_pk_bf16_f32 v125, v134, v135
    v_cvt_pk_bf16_f32 v126, v136, v137
    v_cvt_pk_bf16_f32 v127, v138, v139
    v_cvt_pk_bf16_f32 v128, v140, v141
    v_cvt_pk_bf16_f32 v129, v142, v143
    v_cvt_pk_bf16_f32 v130, v144, v145
    v_cvt_pk_bf16_f32 v131, v146, v147
    s_waitcnt lgkmcnt(0)
    s_branch Lf_evd2
Lf_ev3:
    s_bitcmp0_b64 s[56:57], 3
    s_cbranch_scc1 Lf_nf3
    v_cvt_pk_bf16_f32 v246, v212, v212
    v_mov_b32 v212, 0
    ds_write_b16 v240, v246
    v_add_u32 v240, 128, v240
Lf_nf3:
    s_bitcmp0_b64 s[56:57], 8
    s_cbranch_scc1 Lf_na3
    s_add_u32 s35, s35, s31
    s_min_u32 s35, s35, 419404800
    s_xor_b32 s31, s31, 0x63ff800
Lf_na3:
    s_bitcmp0_b64 s[56:57], 5
    s_cbranch_scc1 Lf_evd3
Lf_e13:
    s_sub_u32 s61, s61, 1
    s_cbranch_scc1 Lf_last3
    v_mul_u32_u24 v216, v224, v241
    v_mul_u32_u24 v217, v224, v242
    v_mul_u32_u24 v218, v225, v241
    v_mul_u32_u24 v219, v225, v242
    v_mul_u32_u24 v220, v226, v241
    v_mul_u32_u24 v221, v226, v242
    v_mul_u32_u24 v222, v227, v241
    v_mul_u32_u24 v223, v227, v242
    v_add_u32 v238, 128, v238
    ds_read_b128 v[164:167], v239
    v_mfma_f32_4x4x4_16b_bf16 v[132:135], v[216:217], v[68:69], v[4:7]
    ds_read_b128 v[168:171], v239 offset:64
    ds_read_b128 v[172:175], v239 offset:128
    v_mfma_f32_4x4x4_16b_bf16 v[136:139], v[218:219], v[70:71], v[8:11]
    ds_read_b128 v[176:179], v239 offset:192
    ds_read_u16 v224, v238
    v_mfma_f32_4x4x4_16b_bf16 v[140:143], v[220:221], v[72:73], v[12:15]
    ds_read_u16 v225, v238 offset:8
    ds_read_u16 v226, v238 offset:64
    v_mfma_f32_4x4x4_16b_bf16 v[144:147], v[222:223], v[74:75], v[16:19]
    ds_read_u16 v227, v238 offset:72
    v_add_u32 v239, 272, v239
    v_mfma_f32_4x4x4_16b_bf16 v[246:249], v[216:217], v[76:77], v[20:23]
    v_cvt_pk_bf16_f32 v100, v132, v133
    v_cvt_pk_bf16_f32 v101, v134, v135
    v_mfma_f32_4x4x4_16b_bf16 v[250:253], v[218:219], v[78:79], v[24:27]
    v_cvt_pk_bf16_f32 v102, v136, v137
    v_cvt_pk_bf16_f32 v103, v138, v139
    v_mfma_f32_4x4x4_16b_bf16 v[132:135], v[220:221], v[80:81], v[28:31]
    v_cvt_pk_bf16_f32 v104, v140, v141
    v_cvt_pk_bf16_f32 v105, v142, v143
    v_mfma_f32_4x4x4_16b_bf16 v[136:139], v[222:223], v[82:83], v[32:35]
    v_cvt_pk_bf16_f32 v106, v144, v145
    v_cvt_pk_bf16_f32 v107, v146, v147
    v_mfma_f32_4x4x4_16b_bf16 v[140:143], v[216:217], v[84:85], v[36:39]
    v_cvt_pk_bf16_f32 v108, v246, v247
    v_cvt_pk_bf16_f32 v109, v248, v249
    v_mfma_f32_4x4x4_16b_bf16 v[144:147], v[218:219], v[86:87], v[40:43]
    v_cvt_pk_bf16_f32 v110, v250, v251
    v_cvt_pk_bf16_f32 v111, v252, v253
    v_mfma_f32_4x4x4_16b_bf16 v[246:249], v[220:221], v[88:89], v[44:47]
    v_cvt_pk_bf16_f32 v112, v132, v133
    v_cvt_pk_bf16_f32 v113, v134, v135
    v_mfma_f32_4x4x4_16b_bf16 v[250:253], v[222:223], v[90:91], v[48:51]
    v_cvt_pk_bf16_f32 v114, v136, v137
    v_cvt_pk_bf16_f32 v115, v138, v139
    v_mfma_f32_4x4x4_16b_bf16 v[132:135], v[216:217], v[92:93], v[52:55]
    v_cvt_pk_bf16_f32 v116, v140, v141
    v_cvt_pk_bf16_f32 v117, v142, v143
    v_mfma_f32_4x4x4_16b_bf16 v[136:139], v[218:219], v[94:95], v[56:59]
    v_cvt_pk_bf16_f32 v118, v144, v145
    v_cvt_pk_bf16_f32 v119, v146, v147
    v_mfma_f32_4x4x4_16b_bf16 v[140:143], v[220:221], v[96:97], v[60:63]
    v_cvt_pk_bf16_f32 v120, v246, v247
    v_cvt_pk_bf16_f32 v121, v248, v249
    v_mfma_f32_4x4x4_16b_bf16 v[144:147], v[222:223], v[98:99], v[64:67]
    v_cvt_pk_bf16_f32 v122, v250, v251
    v_cvt_pk_bf16_f32 v123, v252, v253
    v_cvt_pk_bf16_f32 v124, v132, v133
    v_cvt_pk_bf16_f32 v125, v134, v135
    v_cvt_pk_bf16_f32 v126, v136, v137
    v_cvt_pk_bf16_f32 v127, v138, v139
    v_cvt_pk_bf16_f32 v128, v140, v141
    v_cvt_pk_bf16_f32 v129, v142, v143
    v_cvt_pk_bf16_f32 v130, v144, v145
    v_cvt_pk_bf16_f32 v131, v146, v147
    s_waitcnt lgkmcnt(0)
    s_branch Lf_evd3
Lf_last0:
    s_branch Lf_tail
Lf_last1:
    v_add_u32 v236, 2080, v236
    s_lshr_b64 s[56:57], s[56:57], 1
    s_branch Lf_tail
Lf_last2:
    v_add_u32 v236, 4160, v236
    s_lshr_b64 s[56:57], s[56:57], 2
    s_branch Lf_tail
Lf_last3:
    v_add_u32 v236, 6240, v236
    s_lshr_b64 s[56:57], s[56:57], 3
Lf_tail:
    v_exp_f32 v132, v148
    v_exp_f32 v133, v149
    v_exp_f32 v134, v150
    v_exp_f32 v135, v151
    v_exp_f32 v136, v152
    v_exp_f32 v137, v153
    v_mfma_f32_4x4x4_16b_bf16 v[132:135], v[228:229], v[228:229], v[132:135]
    v_cvt_pk_bf16_f32 v208, v208, v209
    v_cvt_pk_bf16_f32 v209, v210, v211
    v_exp_f32 v138, v154
    s_nop 0
    v_mfma_f32_4x4x4_16b_bf16 v[212:215], v[208:209], v[188:189], v[212:215] cbsz:4 abid:0
    ds_read_b64_tr_b16 v[188:189], v236 offset:0
    v_exp_f32 v139, v155
    v_exp_f32 v140, v156
    v_mfma_f32_4x4x4_16b_bf16 v[212:215], v[208:209], v[190:191], v[212:215] cbsz:4 abid:4
    ds_read_b64_tr_b16 v[190:191], v236 offset:512
    v_mfma_f32_4x4x4_16b_bf16 v[136:139], v[228:229], v[228:229], v[136:139]
    v_rcp_f32 v132, v132
    v_mfma_f32_4x4x4_16b_bf16 v[212:215], v[208:209], v[192:193], v[212:215] cbsz:4 abid:8
    ds_read_b64_tr_b16 v[192:193], v236 offset:1056
    v_exp_f32 v141, v157
    v_rcp_f32 v133, v133
    v_mfma_f32_4x4x4_16b_bf16 v[212:215], v[208:209], v[194:195], v[212:215] cbsz:4 abid:12
    ds_read_b64_tr_b16 v[194:195], v236 offset:1568
    v_exp_f32 v142, v158
    v_rcp_f32 v134, v134
    v_exp_f32 v143, v159
    v_rcp_f32 v135, v135
    v_cvt_pk_bf16_f32 v132, v132, v133
    v_mfma_f32_4x4x4_16b_bf16 v[140:143], v[228:229], v[228:229], v[140:143]
    v_exp_f32 v144, v160
    v_rcp_f32 v136, v136
    v_cvt_pk_bf16_f32 v133, v134, v135
    s_bitcmp0_b64 s[56:57], 1
    s_cbranch_scc1 Lf_tnf
    v_cvt_pk_bf16_f32 v246, v212, v212
    v_mov_b32 v212, 0
    ds_write_b16 v240, v246
    v_add_u32 v240, 128, v240
Lf_tnf:
    s_waitcnt lgkmcnt(0)
    v_exp_f32 v145, v161
    v_rcp_f32 v137, v137
    v_exp_f32 v146, v162
    v_rcp_f32 v138, v138
    v_cvt_pk_bf16_f32 v134, v136, v137
    v_exp_f32 v147, v163
    v_rcp_f32 v139, v139
    s_nop 0
    v_mfma_f32_4x4x4_16b_bf16 v[144:147], v[228:229], v[228:229], v[144:147]
    v_rcp_f32 v140, v140
    v_rcp_f32 v141, v141
    v_cvt_pk_bf16_f32 v135, v138, v139
    v_rcp_f32 v142, v142
    v_cvt_pk_bf16_f32 v136, v140, v141
    v_mfma_f32_16x16x32_bf16 v[208:211], v[132:135], v[196:199], v[204:207]
    v_rcp_f32 v143, v143
    v_rcp_f32 v144, v144
    v_cvt_pk_bf16_f32 v137, v142, v143
    v_rcp_f32 v145, v145
    v_rcp_f32 v146, v146
    v_rcp_f32 v147, v147
    v_cvt_pk_bf16_f32 v138, v144, v145
    v_cvt_pk_bf16_f32 v139, v146, v147
    s_nop 1
    v_mfma_f32_16x16x32_bf16 v[208:211], v[136:139], v[200:203], v[208:211]
    s_nop 7
    v_cvt_pk_bf16_f32 v208, v208, v209
    v_cvt_pk_bf16_f32 v209, v210, v211
    s_nop 1
    v_mfma_f32_4x4x4_16b_bf16 v[212:215], v[208:209], v[188:189], v[212:215] cbsz:4 abid:0
    s_nop 1
    v_mfma_f32_4x4x4_16b_bf16 v[212:215], v[208:209], v[190:191], v[212:215] cbsz:4 abid:4
    s_nop 1
    v_mfma_f32_4x4x4_16b_bf16 v[212:215], v[208:209], v[192:193], v[212:215] cbsz:4 abid:8
    s_nop 1
    v_mfma_f32_4x4x4_16b_bf16 v[212:215], v[208:209], v[194:195], v[212:215] cbsz:4 abid:12
    s_nop 4
    v_cvt_pk_bf16_f32 v246, v212, v212
    ds_write_b16 v240, v246
L_store:
    s_add_u32 s66, s52, 8320
    v_lshl_add_u32 v247, v0, 4, s66
    ds_read_b128 v[148:151], v247
    s_waitcnt lgkmcnt(0)
    global_store_dwordx4 v243, v[148:151], s[18:19] sc0 sc1
L_end:
    s_endpgm
L_general:
    s_waitcnt vmcnt(0)
    ds_read_b128 v[44:47], v246 offset:20480
    ds_read_b128 v[48:51], v246 offset:21504
    ds_read_b128 v[88:91], v246 offset:22528
    ds_read_b128 v[52:55], v246 offset:40960
    ds_read_b128 v[56:59], v246 offset:41984
    ds_read_b128 v[92:95], v246 offset:43008
    ds_read_b128 v[60:63], v246 offset:61440
    ds_read_b128 v[64:67], v246 offset:62464
    ds_read_b128 v[96:99], v246 offset:63488
    ds_read_u16 v224, v238 offset:0
    ds_read_u16 v225, v238 offset:8
    ds_read_u16 v226, v238 offset:64
    ds_read_u16 v227, v238 offset:72
    s_mul_i32 s35, s53, 51200
    s_movk_i32 s31, 25600
    s_mov_b64 s[56:57], 0
    s_mov_b64 s[58:59], 0
    v_mov_b32 v148, -1
    v_mov_b32 v149, -1
    v_mov_b32 v150, -1
    v_mov_b32 v151, -1
    s_add_u32 s66, s52, 18432
    v_add_u32 v152, s66, v2
    ds_write_b128 v152, v[148:151]
    ds_write_b128 v152, v[148:151] offset:1024
    s_add_u32 s64, s52, 18448
    s_bfm_b64 s[28:29], 50, 0
    s_mul_i32 s66, s53, 800
    v_add_u32 v247, s66, v2
    s_mov_b64 exec, s[28:29]
    global_load_dwordx4 v[100:103], v247, s[8:9]
    v_add_u32 v247, 1638400, v247
    global_load_dwordx4 v[104:107], v247, s[8:9]
    v_add_u32 v247, 1638400, v247
    global_load_dwordx4 v[108:111], v247, s[8:9]
    v_add_u32 v247, 1638400, v247
    global_load_dwordx4 v[112:115], v247, s[8:9]
    v_add_u32 v247, 1638400, v247
    s_mov_b64 exec, -1
    v_cmp_lt_u32 vcc, 24, v0
    s_nop 1
    v_cndmask_b32 v145, 0, 1, vcc
    v_mul_u32_u24 v142, 25, v145
    v_sub_u32 v142, v0, v142
    v_mul_u32_u24 v142, 0x80008, v142
    v_add_u32 v141, 0x10000, v142
    v_add_u32 v143, 0x50004, v142
    v_add_u32 v144, 0x70006, v142
    v_add_u32 v142, 0x30002, v142
    s_waitcnt vmcnt(0)
    s_mov_b64 exec, s[28:29]
    v_cmp_neq_f16_sdwa s[68:69], v100, 0 src0_sel:WORD_0 src1_sel:WORD_0
    v_cmp_neq_f16_sdwa s[70:71], v100, 0 src0_sel:WORD_1 src1_sel:WORD_0
    v_cmp_neq_f16_sdwa s[72:73], v101, 0 src0_sel:WORD_0 src1_sel:WORD_0
    v_cmp_neq_f16_sdwa s[74:75], v101, 0 src0_sel:WORD_1 src1_sel:WORD_0
    v_cmp_neq_f16_sdwa s[76:77], v102, 0 src0_sel:WORD_0 src1_sel:WORD_0
    v_cmp_neq_f16_sdwa s[78:79], v102, 0 src0_sel:WORD_1 src1_sel:WORD_0
    v_cmp_neq_f16_sdwa s[80:81], v103, 0 src0_sel:WORD_0 src1_sel:WORD_0
    v_cmp_neq_f16_sdwa s[82:83], v103, 0 src0_sel:WORD_1 src1_sel:WORD_0
    s_mov_b64 exec, -1
    v_mov_b32 v132, s64
    v_mbcnt_lo_u32_b32 v132, s68, v132
    v_mbcnt_hi_u32_b32 v132, s69, v132
    v_mbcnt_lo_u32_b32 v132, s70, v132
    v_mbcnt_hi_u32_b32 v132, s71, v132
    v_mbcnt_lo_u32_b32 v132, s72, v132
    v_mbcnt_hi_u32_b32 v132, s73, v132
    v_mbcnt_lo_u32_b32 v132, s74, v132
    v_mbcnt_hi_u32_b32 v132, s75, v132
    v_mbcnt_lo_u32_b32 v132, s76, v132
    v_mbcnt_hi_u32_b32 v132, s77, v132
    v_mbcnt_lo_u32_b32 v132, s78, v132
    v_mbcnt_hi_u32_b32 v132, s79, v132
    v_mbcnt_lo_u32_b32 v132, s80, v132
    v_mbcnt_hi_u32_b32 v132, s81, v132
    v_mbcnt_lo_u32_b32 v132, s82, v132
    v_mbcnt_hi_u32_b32 v132, s83, v132
    s_add_u32 s55, s64, 16
    v_readlane_b32 s66, v132, 25
    v_readlane_b32 s67, v132, 63
    s_add_u32 s64, s66, 15
    s_and_b32 s64, s64, -16
    s_max_u32 s64, s64, s55
    s_sub_u32 s66, s64, s66
    v_mad_u32_u24 v132, v145, s66, v132
    s_mov_b32 s55, s64
    v_addc_co_u32 v133, vcc, 0, v132, s[68:69]
    v_addc_co_u32 v134, vcc, 0, v133, s[70:71]
    v_addc_co_u32 v135, vcc, 0, v134, s[72:73]
    v_addc_co_u32 v136, vcc, 0, v135, s[74:75]
    v_addc_co_u32 v137, vcc, 0, v136, s[76:77]
    v_addc_co_u32 v138, vcc, 0, v137, s[78:79]
    v_addc_co_u32 v139, vcc, 0, v138, s[80:81]
    s_add_u32 s67, s67, s66
    s_add_u32 s67, s67, 15
    s_and_b32 s67, s67, -16
    s_add_u32 s64, s64, 16
    s_max_u32 s64, s64, s67
    s_mov_b64 exec, s[68:69]
    ds_write_b8 v132, v141
    s_mov_b64 exec, s[70:71]
    ds_write_b8_d16_hi v133, v141
    s_mov_b64 exec, s[72:73]
    ds_write_b8 v134, v142
    s_mov_b64 exec, s[74:75]
    ds_write_b8_d16_hi v135, v142
    s_mov_b64 exec, s[76:77]
    ds_write_b8 v136, v143
    s_mov_b64 exec, s[78:79]
    ds_write_b8_d16_hi v137, v143
    s_mov_b64 exec, s[80:81]
    ds_write_b8 v138, v144
    s_mov_b64 exec, s[82:83]
    ds_write_b8_d16_hi v139, v144
    s_mov_b64 exec, -1
    s_lshr_b32 s95, s55, 4
    s_bitset1_b64 s[56:57], s95
    s_lshr_b32 s95, s64, 4
    s_bitset1_b64 s[56:57], s95
    s_mov_b64 exec, s[28:29]
    v_cmp_neq_f16_sdwa s[68:69], v104, 0 src0_sel:WORD_0 src1_sel:WORD_0
    v_cmp_neq_f16_sdwa s[70:71], v104, 0 src0_sel:WORD_1 src1_sel:WORD_0
    v_cmp_neq_f16_sdwa s[72:73], v105, 0 src0_sel:WORD_0 src1_sel:WORD_0
    v_cmp_neq_f16_sdwa s[74:75], v105, 0 src0_sel:WORD_1 src1_sel:WORD_0
    v_cmp_neq_f16_sdwa s[76:77], v106, 0 src0_sel:WORD_0 src1_sel:WORD_0
    v_cmp_neq_f16_sdwa s[78:79], v106, 0 src0_sel:WORD_1 src1_sel:WORD_0
    v_cmp_neq_f16_sdwa s[80:81], v107, 0 src0_sel:WORD_0 src1_sel:WORD_0
    v_cmp_neq_f16_sdwa s[82:83], v107, 0 src0_sel:WORD_1 src1_sel:WORD_0
    s_mov_b64 exec, -1
    v_mov_b32 v132, s64
    v_mbcnt_lo_u32_b32 v132, s68, v132
    v_mbcnt_hi_u32_b32 v132, s69, v132
    v_mbcnt_lo_u32_b32 v132, s70, v132
    v_mbcnt_hi_u32_b32 v132, s71, v132
    v_mbcnt_lo_u32_b32 v132, s72, v132
    v_mbcnt_hi_u32_b32 v132, s73, v132
    v_mbcnt_lo_u32_b32 v132, s74, v132
    v_mbcnt_hi_u32_b32 v132, s75, v132
    v_mbcnt_lo_u32_b32 v132, s76, v132
    v_mbcnt_hi_u32_b32 v132, s77, v132
    v_mbcnt_lo_u32_b32 v132, s78, v132
    v_mbcnt_hi_u32_b32 v132, s79, v132
    v_mbcnt_lo_u32_b32 v132, s80, v132
    v_mbcnt_hi_u32_b32 v132, s81, v132
    v_mbcnt_lo_u32_b32 v132, s82, v132
    v_mbcnt_hi_u32_b32 v132, s83, v132
    s_add_u32 s55, s64, 16
    v_readlane_b32 s66, v132, 25
    v_readlane_b32 s67, v132, 63
    s_add_u32 s64, s66, 15
    s_and_b32 s64, s64, -16
    s_max_u32 s64, s64, s55
    s_sub_u32 s66, s64, s66
    v_mad_u32_u24 v132, v145, s66, v132
    s_mov_b32 s55, s64
    v_addc_co_u32 v133, vcc, 0, v132, s[68:69]
    v_addc_co_u32 v134, vcc, 0, v133, s[70:71]
    v_addc_co_u32 v135, vcc, 0, v134, s[72:73]
    v_addc_co_u32 v136, vcc, 0, v135, s[74:75]
    v_addc_co_u32 v137, vcc, 0, v136, s[76:77]
    v_addc_co_u32 v138, vcc, 0, v137, s[78:79]
    v_addc_co_u32 v139, vcc, 0, v138, s[80:81]
    s_add_u32 s67, s67, s66
    s_add_u32 s67, s67, 15
    s_and_b32 s67, s67, -16
    s_add_u32 s64, s64, 16
    s_max_u32 s64, s64, s67
    s_mov_b64 exec, s[68:69]
    ds_write_b8 v132, v141
    s_mov_b64 exec, s[70:71]
    ds_write_b8_d16_hi v133, v141
    s_mov_b64 exec, s[72:73]
    ds_write_b8 v134, v142
    s_mov_b64 exec, s[74:75]
    ds_write_b8_d16_hi v135, v142
    s_mov_b64 exec, s[76:77]
    ds_write_b8 v136, v143
    s_mov_b64 exec, s[78:79]
    ds_write_b8_d16_hi v137, v143
    s_mov_b64 exec, s[80:81]
    ds_write_b8 v138, v144
    s_mov_b64 exec, s[82:83]
    ds_write_b8_d16_hi v139, v144
    s_mov_b64 exec, -1
    s_lshr_b32 s95, s55, 4
    s_bitset1_b64 s[56:57], s95
    s_lshr_b32 s95, s64, 4
    s_bitset1_b64 s[56:57], s95
    s_mov_b64 exec, s[28:29]
    v_cmp_neq_f16_sdwa s[68:69], v108, 0 src0_sel:WORD_0 src1_sel:WORD_0
    v_cmp_neq_f16_sdwa s[70:71], v108, 0 src0_sel:WORD_1 src1_sel:WORD_0
    v_cmp_neq_f16_sdwa s[72:73], v109, 0 src0_sel:WORD_0 src1_sel:WORD_0
    v_cmp_neq_f16_sdwa s[74:75], v109, 0 src0_sel:WORD_1 src1_sel:WORD_0
    v_cmp_neq_f16_sdwa s[76:77], v110, 0 src0_sel:WORD_0 src1_sel:WORD_0
    v_cmp_neq_f16_sdwa s[78:79], v110, 0 src0_sel:WORD_1 src1_sel:WORD_0
    v_cmp_neq_f16_sdwa s[80:81], v111, 0 src0_sel:WORD_0 src1_sel:WORD_0
    v_cmp_neq_f16_sdwa s[82:83], v111, 0 src0_sel:WORD_1 src1_sel:WORD_0
    s_mov_b64 exec, -1
    v_mov_b32 v132, s64
    v_mbcnt_lo_u32_b32 v132, s68, v132
    v_mbcnt_hi_u32_b32 v132, s69, v132
    v_mbcnt_lo_u32_b32 v132, s70, v132
    v_mbcnt_hi_u32_b32 v132, s71, v132
    v_mbcnt_lo_u32_b32 v132, s72, v132
    v_mbcnt_hi_u32_b32 v132, s73, v132
    v_mbcnt_lo_u32_b32 v132, s74, v132
    v_mbcnt_hi_u32_b32 v132, s75, v132
    v_mbcnt_lo_u32_b32 v132, s76, v132
    v_mbcnt_hi_u32_b32 v132, s77, v132
    v_mbcnt_lo_u32_b32 v132, s78, v132
    v_mbcnt_hi_u32_b32 v132, s79, v132
    v_mbcnt_lo_u32_b32 v132, s80, v132
    v_mbcnt_hi_u32_b32 v132, s81, v132
    v_mbcnt_lo_u32_b32 v132, s82, v132
    v_mbcnt_hi_u32_b32 v132, s83, v132
    s_add_u32 s55, s64, 16
    v_readlane_b32 s66, v132, 25
    v_readlane_b32 s67, v132, 63
    s_add_u32 s64, s66, 15
    s_and_b32 s64, s64, -16
    s_max_u32 s64, s64, s55
    s_sub_u32 s66, s64, s66
    v_mad_u32_u24 v132, v145, s66, v132
    s_mov_b32 s55, s64
    v_addc_co_u32 v133, vcc, 0, v132, s[68:69]
    v_addc_co_u32 v134, vcc, 0, v133, s[70:71]
    v_addc_co_u32 v135, vcc, 0, v134, s[72:73]
    v_addc_co_u32 v136, vcc, 0, v135, s[74:75]
    v_addc_co_u32 v137, vcc, 0, v136, s[76:77]
    v_addc_co_u32 v138, vcc, 0, v137, s[78:79]
    v_addc_co_u32 v139, vcc, 0, v138, s[80:81]
    s_add_u32 s67, s67, s66
    s_add_u32 s67, s67, 15
    s_and_b32 s67, s67, -16
    s_add_u32 s64, s64, 16
    s_max_u32 s64, s64, s67
    s_mov_b64 exec, s[68:69]
    ds_write_b8 v132, v141
    s_mov_b64 exec, s[70:71]
    ds_write_b8_d16_hi v133, v141
    s_mov_b64 exec, s[72:73]
    ds_write_b8 v134, v142
    s_mov_b64 exec, s[74:75]
    ds_write_b8_d16_hi v135, v142
    s_mov_b64 exec, s[76:77]
    ds_write_b8 v136, v143
    s_mov_b64 exec, s[78:79]
    ds_write_b8_d16_hi v137, v143
    s_mov_b64 exec, s[80:81]
    ds_write_b8 v138, v144
    s_mov_b64 exec, s[82:83]
    ds_write_b8_d16_hi v139, v144
    s_mov_b64 exec, -1
    s_lshr_b32 s95, s55, 4
    s_lshl_b64 s[86:87], 1, s95
    s_bitcmp1_b32 s55, 10
    s_cselect_b64 s[88:89], 0, s[86:87]
    s_cselect_b64 s[90:91], s[86:87], 0
    s_or_b64 s[56:57], s[56:57], s[88:89]
    s_or_b64 s[58:59], s[58:59], s[90:91]
    s_lshr_b32 s95, s64, 4
    s_lshl_b64 s[86:87], 1, s95
    s_bitcmp1_b32 s64, 10
    s_cselect_b64 s[88:89], 0, s[86:87]
    s_cselect_b64 s[90:91], s[86:87], 0
    s_or_b64 s[56:57], s[56:57], s[88:89]
    s_or_b64 s[58:59], s[58:59], s[90:91]
    s_mov_b64 exec, s[28:29]
    v_cmp_neq_f16_sdwa s[68:69], v112, 0 src0_sel:WORD_0 src1_sel:WORD_0
    v_cmp_neq_f16_sdwa s[70:71], v112, 0 src0_sel:WORD_1 src1_sel:WORD_0
    v_cmp_neq_f16_sdwa s[72:73], v113, 0 src0_sel:WORD_0 src1_sel:WORD_0
    v_cmp_neq_f16_sdwa s[74:75], v113, 0 src0_sel:WORD_1 src1_sel:WORD_0
    v_cmp_neq_f16_sdwa s[76:77], v114, 0 src0_sel:WORD_0 src1_sel:WORD_0
    v_cmp_neq_f16_sdwa s[78:79], v114, 0 src0_sel:WORD_1 src1_sel:WORD_0
    v_cmp_neq_f16_sdwa s[80:81], v115, 0 src0_sel:WORD_0 src1_sel:WORD_0
    v_cmp_neq_f16_sdwa s[82:83], v115, 0 src0_sel:WORD_1 src1_sel:WORD_0
    s_mov_b64 exec, -1
    v_mov_b32 v132, s64
    v_mbcnt_lo_u32_b32 v132, s68, v132
    v_mbcnt_hi_u32_b32 v132, s69, v132
    v_mbcnt_lo_u32_b32 v132, s70, v132
    v_mbcnt_hi_u32_b32 v132, s71, v132
    v_mbcnt_lo_u32_b32 v132, s72, v132
    v_mbcnt_hi_u32_b32 v132, s73, v132
    v_mbcnt_lo_u32_b32 v132, s74, v132
    v_mbcnt_hi_u32_b32 v132, s75, v132
    v_mbcnt_lo_u32_b32 v132, s76, v132
    v_mbcnt_hi_u32_b32 v132, s77, v132
    v_mbcnt_lo_u32_b32 v132, s78, v132
    v_mbcnt_hi_u32_b32 v132, s79, v132
    v_mbcnt_lo_u32_b32 v132, s80, v132
    v_mbcnt_hi_u32_b32 v132, s81, v132
    v_mbcnt_lo_u32_b32 v132, s82, v132
    v_mbcnt_hi_u32_b32 v132, s83, v132
    s_add_u32 s55, s64, 16
    v_readlane_b32 s66, v132, 25
    v_readlane_b32 s67, v132, 63
    s_add_u32 s64, s66, 15
    s_and_b32 s64, s64, -16
    s_max_u32 s64, s64, s55
    s_sub_u32 s66, s64, s66
    v_mad_u32_u24 v132, v145, s66, v132
    s_mov_b32 s55, s64
    v_addc_co_u32 v133, vcc, 0, v132, s[68:69]
    v_addc_co_u32 v134, vcc, 0, v133, s[70:71]
    v_addc_co_u32 v135, vcc, 0, v134, s[72:73]
    v_addc_co_u32 v136, vcc, 0, v135, s[74:75]
    v_addc_co_u32 v137, vcc, 0, v136, s[76:77]
    v_addc_co_u32 v138, vcc, 0, v137, s[78:79]
    v_addc_co_u32 v139, vcc, 0, v138, s[80:81]
    s_add_u32 s67, s67, s66
    s_add_u32 s67, s67, 15
    s_and_b32 s67, s67, -16
    s_add_u32 s64, s64, 16
    s_max_u32 s64, s64, s67
    s_mov_b64 exec, s[68:69]
    ds_write_b8 v132, v141
    s_mov_b64 exec, s[70:71]
    ds_write_b8_d16_hi v133, v141
    s_mov_b64 exec, s[72:73]
    ds_write_b8 v134, v142
    s_mov_b64 exec, s[74:75]
    ds_write_b8_d16_hi v135, v142
    s_mov_b64 exec, s[76:77]
    ds_write_b8 v136, v143
    s_mov_b64 exec, s[78:79]
    ds_write_b8_d16_hi v137, v143
    s_mov_b64 exec, s[80:81]
    ds_write_b8 v138, v144
    s_mov_b64 exec, s[82:83]
    ds_write_b8_d16_hi v139, v144
    s_mov_b64 exec, -1
    s_lshr_b32 s95, s55, 4
    s_lshl_b64 s[86:87], 1, s95
    s_bitcmp1_b32 s55, 10
    s_cselect_b64 s[88:89], 0, s[86:87]
    s_cselect_b64 s[90:91], s[86:87], 0
    s_or_b64 s[56:57], s[56:57], s[88:89]
    s_or_b64 s[58:59], s[58:59], s[90:91]
    s_lshr_b32 s95, s64, 4
    s_lshl_b64 s[86:87], 1, s95
    s_bitcmp1_b32 s64, 10
    s_cselect_b64 s[88:89], 0, s[86:87]
    s_cselect_b64 s[90:91], s[86:87], 0
    s_or_b64 s[56:57], s[56:57], s[88:89]
    s_or_b64 s[58:59], s[58:59], s[90:91]
    s_mov_b32 s94, 0
    s_mov_b64 s[84:85], -1
    s_branch L_listed
Ls_loop:
    ds_read_u8 v230, v237 offset:64
    ds_read_u8 v232, v237 offset:72
    v_mfma_f32_16x16x32_bf16 v[208:211], v[136:139], v[200:203], v[208:211]
Ls_mid:
    s_bitcmp1_b32 s36, 0
    s_cbranch_scc1 Ls_ev0
Ls_evd0:
    ds_read_b32 v246, v244 offset:0
    s_waitcnt lgkmcnt(0)
    v_bfe_u32 v247, v246, 0, 8
    v_lshlrev_b32 v247, 1, v247
    v_bfe_u32 v248, v246, 8, 8
    v_lshlrev_b32 v248, 1, v248
    v_bfe_u32 v249, v246, 16, 8
    v_lshlrev_b32 v249, 1, v249
    v_bfe_u32 v250, v246, 24, 8
    v_lshlrev_b32 v250, 1, v250
    buffer_load_ushort v247, v247, s[24:27], 0 offen
    buffer_load_ushort v248, v248, s[24:27], 0 offen
    buffer_load_ushort v249, v249, s[24:27], 0 offen
    buffer_load_ushort v250, v250, s[24:27], 0 offen
    s_waitcnt vmcnt(0)
    v_lshlrev_b32 v247, 16, v247
    v_mul_f32 v208, v208, v247
    v_lshlrev_b32 v248, 16, v248
    v_mul_f32 v209, v209, v248
    v_lshlrev_b32 v249, 16, v249
    v_mul_f32 v210, v210, v249
    v_lshlrev_b32 v250, 16, v250
    v_mul_f32 v211, v211, v250
    ds_add_rtn_u32 v1, v2, v3
    v_exp_f32 v132, v148
    v_exp_f32 v133, v149
    v_exp_f32 v134, v150
    v_exp_f32 v135, v151
    v_exp_f32 v136, v152
    v_exp_f32 v137, v153
    v_mfma_f32_4x4x4_16b_bf16 v[132:135], v[228:229], v[228:229], v[132:135]
    v_cvt_pk_bf16_f32 v208, v208, v209
    v_cvt_pk_bf16_f32 v209, v210, v211
    s_waitcnt lgkmcnt(2)
    v_mfma_f32_16x16x32_bf16 v[148:151], v[100:103], v[180:183], v[164:167]
    v_exp_f32 v138, v154
    v_mfma_f32_4x4x4_16b_bf16 v[212:215], v[208:209], v[188:189], v[212:215] cbsz:4 abid:0
    ds_read_b64_tr_b16 v[188:189], v236 offset:0
    v_exp_f32 v139, v155
    v_mfma_f32_16x16x32_bf16 v[152:155], v[108:111], v[180:183], v[168:171]
    v_exp_f32 v140, v156
    v_mfma_f32_4x4x4_16b_bf16 v[212:215], v[208:209], v[190:191], v[212:215] cbsz:4 abid:4
    ds_read_b64_tr_b16 v[190:191], v236 offset:512
    v_mfma_f32_4x4x4_16b_bf16 v[136:139], v[228:229], v[228:229], v[136:139]
    v_rcp_f32 v132, v132
    v_mfma_f32_4x4x4_16b_bf16 v[212:215], v[208:209], v[192:193], v[212:215] cbsz:4 abid:8
    ds_read_b64_tr_b16 v[192:193], v236 offset:1056
    v_exp_f32 v141, v157
    v_mfma_f32_16x16x32_bf16 v[148:151], v[104:107], v[184:187], v[148:151]
    v_rcp_f32 v133, v133
    v_mfma_f32_4x4x4_16b_bf16 v[212:215], v[208:209], v[194:195], v[212:215] cbsz:4 abid:12
    ds_read_b64_tr_b16 v[194:195], v236 offset:1568
    v_exp_f32 v142, v158
    v_mfma_f32_16x16x32_bf16 v[152:155], v[112:115], v[184:187], v[152:155]
    v_rcp_f32 v134, v134
    v_exp_f32 v143, v159
    v_rcp_f32 v135, v135
    v_cvt_pk_bf16_f32 v132, v132, v133
    v_mfma_f32_4x4x4_16b_bf16 v[140:143], v[228:229], v[228:229], v[140:143]
    v_exp_f32 v144, v160
    v_mfma_f32_16x16x32_bf16 v[156:159], v[116:119], v[180:183], v[172:175]
    v_rcp_f32 v136, v136
    v_cvt_pk_bf16_f32 v133, v134, v135
    s_add_u32 m0, s52, 0
    s_waitcnt lgkmcnt(0)
    buffer_load_dwordx4 v[230:231], s[20:23], s35 idxen offen nt lds
    v_exp_f32 v145, v161
    buffer_load_dwordx4 v[232:233], s[40:43], s35 idxen offen offset:1056 nt lds
    v_rcp_f32 v137, v137
    v_exp_f32 v146, v162
    v_rcp_f32 v138, v138
    v_cvt_pk_bf16_f32 v134, v136, v137
    v_exp_f32 v147, v163
    v_mfma_f32_16x16x32_bf16 v[160:163], v[124:127], v[180:183], v[176:179]
    v_readfirstlane_b32 s66, v1
    s_setprio 0
    s_cmp_gt_i32 s66, 0
    s_cbranch_scc0 Ls_lo0
    s_setprio 1
Ls_lo0:
    v_rcp_f32 v139, v139
    v_mfma_f32_4x4x4_16b_bf16 v[144:147], v[228:229], v[228:229], v[144:147]
    v_mfma_f32_16x16x32_bf16 v[156:159], v[120:123], v[184:187], v[156:159]
    v_rcp_f32 v140, v140
    v_mfma_f32_16x16x32_bf16 v[160:163], v[128:131], v[184:187], v[160:163]
    v_rcp_f32 v141, v141
    v_cvt_pk_bf16_f32 v135, v138, v139
    s_waitcnt vmcnt(4)
    ds_read_b128 v[180:183], v234 offset:4160
    ds_read_b128 v[184:187], v235 offset:4160
    v_rcp_f32 v142, v142
    v_cvt_pk_bf16_f32 v136, v140, v141
    v_mfma_f32_16x16x32_bf16 v[208:211], v[132:135], v[196:199], v[204:207]
    v_rcp_f32 v143, v143
    v_rcp_f32 v144, v144
    v_cvt_pk_bf16_f32 v137, v142, v143
    v_rcp_f32 v145, v145
    v_rcp_f32 v146, v146
    v_rcp_f32 v147, v147
    v_cvt_pk_bf16_f32 v138, v144, v145
    v_cvt_pk_bf16_f32 v139, v146, v147
    ds_read_u8 v230, v237 offset:80
    ds_read_u8 v232, v237 offset:88
    v_mfma_f32_16x16x32_bf16 v[208:211], v[136:139], v[200:203], v[208:211]
    s_bitcmp1_b32 s36, 1
    s_cbranch_scc1 Ls_ev1
Ls_evd1:
    ds_read_b32 v246, v244 offset:16
    s_waitcnt lgkmcnt(0)
    v_bfe_u32 v247, v246, 0, 8
    v_lshlrev_b32 v247, 1, v247
    v_bfe_u32 v248, v246, 8, 8
    v_lshlrev_b32 v248, 1, v248
    v_bfe_u32 v249, v246, 16, 8
    v_lshlrev_b32 v249, 1, v249
    v_bfe_u32 v250, v246, 24, 8
    v_lshlrev_b32 v250, 1, v250
    buffer_load_ushort v247, v247, s[24:27], 0 offen
    buffer_load_ushort v248, v248, s[24:27], 0 offen
    buffer_load_ushort v249, v249, s[24:27], 0 offen
    buffer_load_ushort v250, v250, s[24:27], 0 offen
    s_waitcnt vmcnt(0)
    v_lshlrev_b32 v247, 16, v247
    v_mul_f32 v208, v208, v247
    v_lshlrev_b32 v248, 16, v248
    v_mul_f32 v209, v209, v248
    v_lshlrev_b32 v249, 16, v249
    v_mul_f32 v210, v210, v249
    v_lshlrev_b32 v250, 16, v250
    v_mul_f32 v211, v211, v250
    v_exp_f32 v132, v148
    v_exp_f32 v133, v149
    v_exp_f32 v134, v150
    v_exp_f32 v135, v151
    v_exp_f32 v136, v152
    v_exp_f32 v137, v153
    v_mfma_f32_4x4x4_16b_bf16 v[132:135], v[228:229], v[228:229], v[132:135]
    v_cvt_pk_bf16_f32 v208, v208, v209
    v_cvt_pk_bf16_f32 v209, v210, v211
    s_waitcnt lgkmcnt(2)
    v_mfma_f32_16x16x32_bf16 v[148:151], v[100:103], v[180:183], v[164:167]
    v_exp_f32 v138, v154
    v_mfma_f32_4x4x4_16b_bf16 v[212:215], v[208:209], v[188:189], v[212:215] cbsz:4 abid:0
    ds_read_b64_tr_b16 v[188:189], v236 offset:2080
    v_exp_f32 v139, v155
    v_mfma_f32_16x16x32_bf16 v[152:155], v[108:111], v[180:183], v[168:171]
    v_exp_f32 v140, v156
    v_mfma_f32_4x4x4_16b_bf16 v[212:215], v[208:209], v[190:191], v[212:215] cbsz:4 abid:4
    ds_read_b64_tr_b16 v[190:191], v236 offset:2592
    v_mfma_f32_4x4x4_16b_bf16 v[136:139], v[228:229], v[228:229], v[136:139]
    v_rcp_f32 v132, v132
    v_mfma_f32_4x4x4_16b_bf16 v[212:215], v[208:209], v[192:193], v[212:215] cbsz:4 abid:8
    ds_read_b64_tr_b16 v[192:193], v236 offset:3136
    v_exp_f32 v141, v157
    v_mfma_f32_16x16x32_bf16 v[148:151], v[104:107], v[184:187], v[148:151]
    v_rcp_f32 v133, v133
    v_mfma_f32_4x4x4_16b_bf16 v[212:215], v[208:209], v[194:195], v[212:215] cbsz:4 abid:12
    ds_read_b64_tr_b16 v[194:195], v236 offset:3648
    v_exp_f32 v142, v158
    v_mfma_f32_16x16x32_bf16 v[152:155], v[112:115], v[184:187], v[152:155]
    v_rcp_f32 v134, v134
    v_exp_f32 v143, v159
    v_rcp_f32 v135, v135
    v_cvt_pk_bf16_f32 v132, v132, v133
    v_mfma_f32_4x4x4_16b_bf16 v[140:143], v[228:229], v[228:229], v[140:143]
    v_exp_f32 v144, v160
    v_mfma_f32_16x16x32_bf16 v[156:159], v[116:119], v[180:183], v[172:175]
    v_rcp_f32 v136, v136
    v_cvt_pk_bf16_f32 v133, v134, v135
    s_add_u32 m0, s52, 2080
    s_waitcnt lgkmcnt(0)
    buffer_load_dwordx4 v[230:231], s[20:23], s35 idxen offen nt lds
    v_exp_f32 v145, v161
    buffer_load_dwordx4 v[232:233], s[40:43], s35 idxen offen offset:1056 nt lds
    v_rcp_f32 v137, v137
    v_exp_f32 v146, v162
    v_rcp_f32 v138, v138
    v_cvt_pk_bf16_f32 v134, v136, v137
    v_exp_f32 v147, v163
    v_mfma_f32_16x16x32_bf16 v[160:163], v[124:127], v[180:183], v[176:179]
    v_rcp_f32 v139, v139
    v_mfma_f32_4x4x4_16b_bf16 v[144:147], v[228:229], v[228:229], v[144:147]
    v_mfma_f32_16x16x32_bf16 v[156:159], v[120:123], v[184:187], v[156:159]
    v_rcp_f32 v140, v140
    v_mfma_f32_16x16x32_bf16 v[160:163], v[128:131], v[184:187], v[160:163]
    v_rcp_f32 v141, v141
    v_cvt_pk_bf16_f32 v135, v138, v139
    s_waitcnt vmcnt(4)
    ds_read_b128 v[180:183], v234 offset:6240
    ds_read_b128 v[184:187], v235 offset:6240
    v_rcp_f32 v142, v142
    v_cvt_pk_bf16_f32 v136, v140, v141
    v_mfma_f32_16x16x32_bf16 v[208:211], v[132:135], v[196:199], v[204:207]
    v_rcp_f32 v143, v143
    v_rcp_f32 v144, v144
    v_cvt_pk_bf16_f32 v137, v142, v143
    v_rcp_f32 v145, v145
    v_rcp_f32 v146, v146
    v_rcp_f32 v147, v147
    v_cvt_pk_bf16_f32 v138, v144, v145
    v_cvt_pk_bf16_f32 v139, v146, v147
    ds_read_u8 v230, v237 offset:96
    ds_read_u8 v232, v237 offset:104
    v_mfma_f32_16x16x32_bf16 v[208:211], v[136:139], v[200:203], v[208:211]
    s_bitcmp1_b32 s36, 2
    s_cbranch_scc1 Ls_ev2
Ls_evd2:
    ds_read_b32 v246, v244 offset:32
    s_waitcnt lgkmcnt(0)
    v_bfe_u32 v247, v246, 0, 8
    v_lshlrev_b32 v247, 1, v247
    v_bfe_u32 v248, v246, 8, 8
    v_lshlrev_b32 v248, 1, v248
    v_bfe_u32 v249, v246, 16, 8
    v_lshlrev_b32 v249, 1, v249
    v_bfe_u32 v250, v246, 24, 8
    v_lshlrev_b32 v250, 1, v250
    buffer_load_ushort v247, v247, s[24:27], 0 offen
    buffer_load_ushort v248, v248, s[24:27], 0 offen
    buffer_load_ushort v249, v249, s[24:27], 0 offen
    buffer_load_ushort v250, v250, s[24:27], 0 offen
    s_waitcnt vmcnt(0)
    v_lshlrev_b32 v247, 16, v247
    v_mul_f32 v208, v208, v247
    v_lshlrev_b32 v248, 16, v248
    v_mul_f32 v209, v209, v248
    v_lshlrev_b32 v249, 16, v249
    v_mul_f32 v210, v210, v249
    v_lshlrev_b32 v250, 16, v250
    v_mul_f32 v211, v211, v250
    v_exp_f32 v132, v148
    v_exp_f32 v133, v149
    v_exp_f32 v134, v150
    v_exp_f32 v135, v151
    v_exp_f32 v136, v152
    v_exp_f32 v137, v153
    v_mfma_f32_4x4x4_16b_bf16 v[132:135], v[228:229], v[228:229], v[132:135]
    v_cvt_pk_bf16_f32 v208, v208, v209
    v_cvt_pk_bf16_f32 v209, v210, v211
    s_waitcnt lgkmcnt(2)
    v_mfma_f32_16x16x32_bf16 v[148:151], v[100:103], v[180:183], v[164:167]
    v_exp_f32 v138, v154
    v_mfma_f32_4x4x4_16b_bf16 v[212:215], v[208:209], v[188:189], v[212:215] cbsz:4 abid:0
    ds_read_b64_tr_b16 v[188:189], v236 offset:4160
    v_exp_f32 v139, v155
    v_mfma_f32_16x16x32_bf16 v[152:155], v[108:111], v[180:183], v[168:171]
    v_exp_f32 v140, v156
    v_mfma_f32_4x4x4_16b_bf16 v[212:215], v[208:209], v[190:191], v[212:215] cbsz:4 abid:4
    ds_read_b64_tr_b16 v[190:191], v236 offset:4672
    v_mfma_f32_4x4x4_16b_bf16 v[136:139], v[228:229], v[228:229], v[136:139]
    v_rcp_f32 v132, v132
    v_mfma_f32_4x4x4_16b_bf16 v[212:215], v[208:209], v[192:193], v[212:215] cbsz:4 abid:8
    ds_read_b64_tr_b16 v[192:193], v236 offset:5216
    v_exp_f32 v141, v157
    v_mfma_f32_16x16x32_bf16 v[148:151], v[104:107], v[184:187], v[148:151]
    v_rcp_f32 v133, v133
    v_mfma_f32_4x4x4_16b_bf16 v[212:215], v[208:209], v[194:195], v[212:215] cbsz:4 abid:12
    ds_read_b64_tr_b16 v[194:195], v236 offset:5728
    v_exp_f32 v142, v158
    v_mfma_f32_16x16x32_bf16 v[152:155], v[112:115], v[184:187], v[152:155]
    v_rcp_f32 v134, v134
    v_exp_f32 v143, v159
    v_rcp_f32 v135, v135
    v_cvt_pk_bf16_f32 v132, v132, v133
    v_mfma_f32_4x4x4_16b_bf16 v[140:143], v[228:229], v[228:229], v[140:143]
    v_exp_f32 v144, v160
    v_mfma_f32_16x16x32_bf16 v[156:159], v[116:119], v[180:183], v[172:175]
    v_rcp_f32 v136, v136
    v_cvt_pk_bf16_f32 v133, v134, v135
    s_add_u32 m0, s52, 4160
    s_waitcnt lgkmcnt(0)
    buffer_load_dwordx4 v[230:231], s[20:23], s35 idxen offen nt lds
    v_exp_f32 v145, v161
    buffer_load_dwordx4 v[232:233], s[40:43], s35 idxen offen offset:1056 nt lds
    v_rcp_f32 v137, v137
    v_exp_f32 v146, v162
    v_rcp_f32 v138, v138
    v_cvt_pk_bf16_f32 v134, v136, v137
    v_exp_f32 v147, v163
    v_mfma_f32_16x16x32_bf16 v[160:163], v[124:127], v[180:183], v[176:179]
    v_rcp_f32 v139, v139
    v_mfma_f32_4x4x4_16b_bf16 v[144:147], v[228:229], v[228:229], v[144:147]
    v_mfma_f32_16x16x32_bf16 v[156:159], v[120:123], v[184:187], v[156:159]
    v_rcp_f32 v140, v140
    v_mfma_f32_16x16x32_bf16 v[160:163], v[128:131], v[184:187], v[160:163]
    v_rcp_f32 v141, v141
    v_cvt_pk_bf16_f32 v135, v138, v139
    s_waitcnt vmcnt(4)
    ds_read_b128 v[180:183], v234 offset:0
    ds_read_b128 v[184:187], v235 offset:0
    v_rcp_f32 v142, v142
    v_cvt_pk_bf16_f32 v136, v140, v141
    v_mfma_f32_16x16x32_bf16 v[208:211], v[132:135], v[196:199], v[204:207]
    v_rcp_f32 v143, v143
    v_rcp_f32 v144, v144
    v_cvt_pk_bf16_f32 v137, v142, v143
    v_rcp_f32 v145, v145
    v_rcp_f32 v146, v146
    v_rcp_f32 v147, v147
    v_cvt_pk_bf16_f32 v138, v144, v145
    v_cvt_pk_bf16_f32 v139, v146, v147
    ds_read_u8 v230, v237 offset:112
    ds_read_u8 v232, v237 offset:120
    v_mfma_f32_16x16x32_bf16 v[208:211], v[136:139], v[200:203], v[208:211]
    s_bitcmp1_b32 s36, 3
    s_cbranch_scc1 Ls_ev3
Ls_evd3:
    ds_read_b32 v246, v244 offset:48
    s_waitcnt lgkmcnt(0)
    v_bfe_u32 v247, v246, 0, 8
    v_lshlrev_b32 v247, 1, v247
    v_bfe_u32 v248, v246, 8, 8
    v_lshlrev_b32 v248, 1, v248
    v_bfe_u32 v249, v246, 16, 8
    v_lshlrev_b32 v249, 1, v249
    v_bfe_u32 v250, v246, 24, 8
    v_lshlrev_b32 v250, 1, v250
    buffer_load_ushort v247, v247, s[24:27], 0 offen
    buffer_load_ushort v248, v248, s[24:27], 0 offen
    buffer_load_ushort v249, v249, s[24:27], 0 offen
    buffer_load_ushort v250, v250, s[24:27], 0 offen
    s_waitcnt vmcnt(0)
    v_lshlrev_b32 v247, 16, v247
    v_mul_f32 v208, v208, v247
    v_lshlrev_b32 v248, 16, v248
    v_mul_f32 v209, v209, v248
    v_lshlrev_b32 v249, 16, v249
    v_mul_f32 v210, v210, v249
    v_lshlrev_b32 v250, 16, v250
    v_mul_f32 v211, v211, v250
    v_exp_f32 v132, v148
    v_exp_f32 v133, v149
    v_exp_f32 v134, v150
    v_exp_f32 v135, v151
    v_exp_f32 v136, v152
    v_exp_f32 v137, v153
    v_mfma_f32_4x4x4_16b_bf16 v[132:135], v[228:229], v[228:229], v[132:135]
    v_cvt_pk_bf16_f32 v208, v208, v209
    v_cvt_pk_bf16_f32 v209, v210, v211
    s_waitcnt lgkmcnt(2)
    v_mfma_f32_16x16x32_bf16 v[148:151], v[100:103], v[180:183], v[164:167]
    v_exp_f32 v138, v154
    v_mfma_f32_4x4x4_16b_bf16 v[212:215], v[208:209], v[188:189], v[212:215] cbsz:4 abid:0
    ds_read_b64_tr_b16 v[188:189], v236 offset:6240
    v_exp_f32 v139, v155
    v_mfma_f32_16x16x32_bf16 v[152:155], v[108:111], v[180:183], v[168:171]
    v_exp_f32 v140, v156
    v_mfma_f32_4x4x4_16b_bf16 v[212:215], v[208:209], v[190:191], v[212:215] cbsz:4 abid:4
    ds_read_b64_tr_b16 v[190:191], v236 offset:6752
    v_mfma_f32_4x4x4_16b_bf16 v[136:139], v[228:229], v[228:229], v[136:139]
    v_rcp_f32 v132, v132
    v_mfma_f32_4x4x4_16b_bf16 v[212:215], v[208:209], v[192:193], v[212:215] cbsz:4 abid:8
    ds_read_b64_tr_b16 v[192:193], v236 offset:7296
    v_exp_f32 v141, v157
    v_mfma_f32_16x16x32_bf16 v[148:151], v[104:107], v[184:187], v[148:151]
    v_rcp_f32 v133, v133
    v_mfma_f32_4x4x4_16b_bf16 v[212:215], v[208:209], v[194:195], v[212:215] cbsz:4 abid:12
    ds_read_b64_tr_b16 v[194:195], v236 offset:7808
    v_exp_f32 v142, v158
    v_mfma_f32_16x16x32_bf16 v[152:155], v[112:115], v[184:187], v[152:155]
    v_rcp_f32 v134, v134
    v_exp_f32 v143, v159
    v_rcp_f32 v135, v135
    v_cvt_pk_bf16_f32 v132, v132, v133
    v_mfma_f32_4x4x4_16b_bf16 v[140:143], v[228:229], v[228:229], v[140:143]
    v_exp_f32 v144, v160
    v_mfma_f32_16x16x32_bf16 v[156:159], v[116:119], v[180:183], v[172:175]
    v_rcp_f32 v136, v136
    v_cvt_pk_bf16_f32 v133, v134, v135
    s_add_u32 m0, s52, 6240
    s_waitcnt lgkmcnt(0)
    buffer_load_dwordx4 v[230:231], s[20:23], s35 idxen offen nt lds
    v_exp_f32 v145, v161
    buffer_load_dwordx4 v[232:233], s[40:43], s35 idxen offen offset:1056 nt lds
    v_rcp_f32 v137, v137
    v_exp_f32 v146, v162
    v_rcp_f32 v138, v138
    v_cvt_pk_bf16_f32 v134, v136, v137
    v_exp_f32 v147, v163
    v_mfma_f32_16x16x32_bf16 v[160:163], v[124:127], v[180:183], v[176:179]
    v_rcp_f32 v139, v139
    v_mfma_f32_4x4x4_16b_bf16 v[144:147], v[228:229], v[228:229], v[144:147]
    v_mfma_f32_16x16x32_bf16 v[156:159], v[120:123], v[184:187], v[156:159]
    v_rcp_f32 v140, v140
    v_mfma_f32_16x16x32_bf16 v[160:163], v[128:131], v[184:187], v[160:163]
    v_rcp_f32 v141, v141
    v_cvt_pk_bf16_f32 v135, v138, v139
    s_waitcnt vmcnt(4)
    ds_read_b128 v[180:183], v234 offset:2080
    ds_read_b128 v[184:187], v235 offset:2080
    v_rcp_f32 v142, v142
    v_cvt_pk_bf16_f32 v136, v140, v141
    v_mfma_f32_16x16x32_bf16 v[208:211], v[132:135], v[196:199], v[204:207]
    v_rcp_f32 v143, v143
    s_lshr_b64 s[56:57], s[56:57], 4
    s_lshl_b64 s[86:87], s[58:59], 60
    s_or_b64 s[56:57], s[56:57], s[86:87]
    s_lshr_b64 s[58:59], s[58:59], 4
    s_lshr_b64 s[86:87], s[56:57], 2
    s_lshr_b64 s[36:37], s[56:57], 5
    s_or_b32 s36, s36, s86
    s_or_b32 s36, s36, s56
    v_add_u32 v237, 64, v237
    v_add_u32 v244, 64, v244
    v_rcp_f32 v144, v144
    v_cvt_pk_bf16_f32 v137, v142, v143
    v_rcp_f32 v145, v145
    v_rcp_f32 v146, v146
    v_rcp_f32 v147, v147
    v_cvt_pk_bf16_f32 v138, v144, v145
    v_cvt_pk_bf16_f32 v139, v146, v147
    s_branch Ls_loop
Ls_ev0:
    s_bitcmp0_b64 s[56:57], 0
    s_cbranch_scc1 Ls_nf0
    v_cvt_pk_bf16_f32 v246, v212, v212
    v_mov_b32 v212, 0
    ds_write_b16 v240, v246
    v_add_u32 v240, 128, v240
    s_add_u32 s24, s24, s32
    s_addc_u32 s25, s25, 0
    s_xor_b32 s32, s32, 0x18ffe0
Ls_nf0:
    s_bitcmp0_b64 s[56:57], 5
    s_cbranch_scc1 Ls_na0
    s_add_u32 s35, s35, s31
    s_min_u32 s35, s35, 419404800
    s_xor_b32 s31, s31, 0x63ff800
Ls_na0:
    s_bitcmp0_b64 s[56:57], 2
    s_cbranch_scc1 Ls_evd0
Ls_e10:
    s_sub_u32 s61, s61, 1
    s_cbranch_scc1 Ls_last0
    v_mul_u32_u24 v216, v224, v241
    v_mul_u32_u24 v217, v224, v242
    v_mul_u32_u24 v218, v225, v241
    v_mul_u32_u24 v219, v225, v242
    v_mul_u32_u24 v220, v226, v241
    v_mul_u32_u24 v221, v226, v242
    v_mul_u32_u24 v222, v227, v241
    v_mul_u32_u24 v223, v227, v242
    v_add_u32 v238, 128, v238
    ds_read_b128 v[164:167], v239
    v_mfma_f32_4x4x4_16b_bf16 v[132:135], v[216:217], v[68:69], v[4:7]
    ds_read_b128 v[168:171], v239 offset:64
    ds_read_b128 v[172:175], v239 offset:128
    v_mfma_f32_4x4x4_16b_bf16 v[136:139], v[218:219], v[70:71], v[8:11]
    ds_read_b128 v[176:179], v239 offset:192
    ds_read_u16 v224, v238
    v_mfma_f32_4x4x4_16b_bf16 v[140:143], v[220:221], v[72:73], v[12:15]
    ds_read_u16 v225, v238 offset:8
    ds_read_u16 v226, v238 offset:64
    v_mfma_f32_4x4x4_16b_bf16 v[144:147], v[222:223], v[74:75], v[16:19]
    ds_read_u16 v227, v238 offset:72
    v_add_u32 v239, 272, v239
    v_mfma_f32_4x4x4_16b_bf16 v[246:249], v[216:217], v[76:77], v[20:23]
    v_cvt_pk_bf16_f32 v100, v132, v133
    v_cvt_pk_bf16_f32 v101, v134, v135
    v_mfma_f32_4x4x4_16b_bf16 v[250:253], v[218:219], v[78:79], v[24:27]
    v_cvt_pk_bf16_f32 v102, v136, v137
    v_cvt_pk_bf16_f32 v103, v138, v139
    v_mfma_f32_4x4x4_16b_bf16 v[132:135], v[220:221], v[80:81], v[28:31]
    v_cvt_pk_bf16_f32 v104, v140, v141
    v_cvt_pk_bf16_f32 v105, v142, v143
    v_mfma_f32_4x4x4_16b_bf16 v[136:139], v[222:223], v[82:83], v[32:35]
    v_cvt_pk_bf16_f32 v106, v144, v145
    v_cvt_pk_bf16_f32 v107, v146, v147
    v_mfma_f32_4x4x4_16b_bf16 v[140:143], v[216:217], v[84:85], v[36:39]
    v_cvt_pk_bf16_f32 v108, v246, v247
    v_cvt_pk_bf16_f32 v109, v248, v249
    v_mfma_f32_4x4x4_16b_bf16 v[144:147], v[218:219], v[86:87], v[40:43]
    v_cvt_pk_bf16_f32 v110, v250, v251
    v_cvt_pk_bf16_f32 v111, v252, v253
    v_mfma_f32_4x4x4_16b_bf16 v[246:249], v[220:221], v[88:89], v[44:47]
    v_cvt_pk_bf16_f32 v112, v132, v133
    v_cvt_pk_bf16_f32 v113, v134, v135
    v_mfma_f32_4x4x4_16b_bf16 v[250:253], v[222:223], v[90:91], v[48:51]
    v_cvt_pk_bf16_f32 v114, v136, v137
    v_cvt_pk_bf16_f32 v115, v138, v139
    v_mfma_f32_4x4x4_16b_bf16 v[132:135], v[216:217], v[92:93], v[52:55]
    v_cvt_pk_bf16_f32 v116, v140, v141
    v_cvt_pk_bf16_f32 v117, v142, v143
    v_mfma_f32_4x4x4_16b_bf16 v[136:139], v[218:219], v[94:95], v[56:59]
    v_cvt_pk_bf16_f32 v118, v144, v145
    v_cvt_pk_bf16_f32 v119, v146, v147
    v_mfma_f32_4x4x4_16b_bf16 v[140:143], v[220:221], v[96:97], v[60:63]
    v_cvt_pk_bf16_f32 v120, v246, v247
    v_cvt_pk_bf16_f32 v121, v248, v249
    v_mfma_f32_4x4x4_16b_bf16 v[144:147], v[222:223], v[98:99], v[64:67]
    v_cvt_pk_bf16_f32 v122, v250, v251
    v_cvt_pk_bf16_f32 v123, v252, v253
    v_cvt_pk_bf16_f32 v124, v132, v133
    v_cvt_pk_bf16_f32 v125, v134, v135
    v_cvt_pk_bf16_f32 v126, v136, v137
    v_cvt_pk_bf16_f32 v127, v138, v139
    v_cvt_pk_bf16_f32 v128, v140, v141
    v_cvt_pk_bf16_f32 v129, v142, v143
    v_cvt_pk_bf16_f32 v130, v144, v145
    v_cvt_pk_bf16_f32 v131, v146, v147
    s_waitcnt lgkmcnt(0)
    s_branch Ls_evd0
Ls_ev1:
    s_bitcmp0_b64 s[56:57], 1
    s_cbranch_scc1 Ls_nf1
    v_cvt_pk_bf16_f32 v246, v212, v212
    v_mov_b32 v212, 0
    ds_write_b16 v240, v246
    v_add_u32 v240, 128, v240
    s_add_u32 s24, s24, s32
    s_addc_u32 s25, s25, 0
    s_xor_b32 s32, s32, 0x18ffe0
Ls_nf1:
    s_bitcmp0_b64 s[56:57], 6
    s_cbranch_scc1 Ls_na1
    s_add_u32 s35, s35, s31
    s_min_u32 s35, s35, 419404800
    s_xor_b32 s31, s31, 0x63ff800
Ls_na1:
    s_bitcmp0_b64 s[56:57], 3
    s_cbranch_scc1 Ls_evd1
Ls_e11:
    s_sub_u32 s61, s61, 1
    s_cbranch_scc1 Ls_last1
    v_mul_u32_u24 v216, v224, v241
    v_mul_u32_u24 v217, v224, v242
    v_mul_u32_u24 v218, v225, v241
    v_mul_u32_u24 v219, v225, v242
    v_mul_u32_u24 v220, v226, v241
    v_mul_u32_u24 v221, v226, v242
    v_mul_u32_u24 v222, v227, v241
    v_mul_u32_u24 v223, v227, v242
    v_add_u32 v238, 128, v238
    ds_read_b128 v[164:167], v239
    v_mfma_f32_4x4x4_16b_bf16 v[132:135], v[216:217], v[68:69], v[4:7]
    ds_read_b128 v[168:171], v239 offset:64
    ds_read_b128 v[172:175], v239 offset:128
    v_mfma_f32_4x4x4_16b_bf16 v[136:139], v[218:219], v[70:71], v[8:11]
    ds_read_b128 v[176:179], v239 offset:192
    ds_read_u16 v224, v238
    v_mfma_f32_4x4x4_16b_bf16 v[140:143], v[220:221], v[72:73], v[12:15]
    ds_read_u16 v225, v238 offset:8
    ds_read_u16 v226, v238 offset:64
    v_mfma_f32_4x4x4_16b_bf16 v[144:147], v[222:223], v[74:75], v[16:19]
    ds_read_u16 v227, v238 offset:72
    v_add_u32 v239, 272, v239
    v_mfma_f32_4x4x4_16b_bf16 v[246:249], v[216:217], v[76:77], v[20:23]
    v_cvt_pk_bf16_f32 v100, v132, v133
    v_cvt_pk_bf16_f32 v101, v134, v135
    v_mfma_f32_4x4x4_16b_bf16 v[250:253], v[218:219], v[78:79], v[24:27]
    v_cvt_pk_bf16_f32 v102, v136, v137
    v_cvt_pk_bf16_f32 v103, v138, v139
    v_mfma_f32_4x4x4_16b_bf16 v[132:135], v[220:221], v[80:81], v[28:31]
    v_cvt_pk_bf16_f32 v104, v140, v141
    v_cvt_pk_bf16_f32 v105, v142, v143
    v_mfma_f32_4x4x4_16b_bf16 v[136:139], v[222:223], v[82:83], v[32:35]
    v_cvt_pk_bf16_f32 v106, v144, v145
    v_cvt_pk_bf16_f32 v107, v146, v147
    v_mfma_f32_4x4x4_16b_bf16 v[140:143], v[216:217], v[84:85], v[36:39]
    v_cvt_pk_bf16_f32 v108, v246, v247
    v_cvt_pk_bf16_f32 v109, v248, v249
    v_mfma_f32_4x4x4_16b_bf16 v[144:147], v[218:219], v[86:87], v[40:43]
    v_cvt_pk_bf16_f32 v110, v250, v251
    v_cvt_pk_bf16_f32 v111, v252, v253
    v_mfma_f32_4x4x4_16b_bf16 v[246:249], v[220:221], v[88:89], v[44:47]
    v_cvt_pk_bf16_f32 v112, v132, v133
    v_cvt_pk_bf16_f32 v113, v134, v135
    v_mfma_f32_4x4x4_16b_bf16 v[250:253], v[222:223], v[90:91], v[48:51]
    v_cvt_pk_bf16_f32 v114, v136, v137
    v_cvt_pk_bf16_f32 v115, v138, v139
    v_mfma_f32_4x4x4_16b_bf16 v[132:135], v[216:217], v[92:93], v[52:55]
    v_cvt_pk_bf16_f32 v116, v140, v141
    v_cvt_pk_bf16_f32 v117, v142, v143
    v_mfma_f32_4x4x4_16b_bf16 v[136:139], v[218:219], v[94:95], v[56:59]
    v_cvt_pk_bf16_f32 v118, v144, v145
    v_cvt_pk_bf16_f32 v119, v146, v147
    v_mfma_f32_4x4x4_16b_bf16 v[140:143], v[220:221], v[96:97], v[60:63]
    v_cvt_pk_bf16_f32 v120, v246, v247
    v_cvt_pk_bf16_f32 v121, v248, v249
    v_mfma_f32_4x4x4_16b_bf16 v[144:147], v[222:223], v[98:99], v[64:67]
    v_cvt_pk_bf16_f32 v122, v250, v251
    v_cvt_pk_bf16_f32 v123, v252, v253
    v_cvt_pk_bf16_f32 v124, v132, v133
    v_cvt_pk_bf16_f32 v125, v134, v135
    v_cvt_pk_bf16_f32 v126, v136, v137
    v_cvt_pk_bf16_f32 v127, v138, v139
    v_cvt_pk_bf16_f32 v128, v140, v141
    v_cvt_pk_bf16_f32 v129, v142, v143
    v_cvt_pk_bf16_f32 v130, v144, v145
    v_cvt_pk_bf16_f32 v131, v146, v147
    s_waitcnt lgkmcnt(0)
    s_branch Ls_evd1
Ls_ev2:
    s_bitcmp0_b64 s[56:57], 2
    s_cbranch_scc1 Ls_nf2
    v_cvt_pk_bf16_f32 v246, v212, v212
    v_mov_b32 v212, 0
    ds_write_b16 v240, v246
    v_add_u32 v240, 128, v240
    s_add_u32 s24, s24, s32
    s_addc_u32 s25, s25, 0
    s_xor_b32 s32, s32, 0x18ffe0
Ls_nf2:
    s_bitcmp0_b64 s[56:57], 7
    s_cbranch_scc1 Ls_na2
    s_add_u32 s35, s35, s31
    s_min_u32 s35, s35, 419404800
    s_xor_b32 s31, s31, 0x63ff800
Ls_na2:
    s_bitcmp0_b64 s[56:57], 4
    s_cbranch_scc1 Ls_evd2
Ls_e12:
    s_sub_u32 s61, s61, 1
    s_cbranch_scc1 Ls_last2
    v_mul_u32_u24 v216, v224, v241
    v_mul_u32_u24 v217, v224, v242
    v_mul_u32_u24 v218, v225, v241
    v_mul_u32_u24 v219, v225, v242
    v_mul_u32_u24 v220, v226, v241
    v_mul_u32_u24 v221, v226, v242
    v_mul_u32_u24 v222, v227, v241
    v_mul_u32_u24 v223, v227, v242
    v_add_u32 v238, 128, v238
    ds_read_b128 v[164:167], v239
    v_mfma_f32_4x4x4_16b_bf16 v[132:135], v[216:217], v[68:69], v[4:7]
    ds_read_b128 v[168:171], v239 offset:64
    ds_read_b128 v[172:175], v239 offset:128
    v_mfma_f32_4x4x4_16b_bf16 v[136:139], v[218:219], v[70:71], v[8:11]
    ds_read_b128 v[176:179], v239 offset:192
    ds_read_u16 v224, v238
    v_mfma_f32_4x4x4_16b_bf16 v[140:143], v[220:221], v[72:73], v[12:15]
    ds_read_u16 v225, v238 offset:8
    ds_read_u16 v226, v238 offset:64
    v_mfma_f32_4x4x4_16b_bf16 v[144:147], v[222:223], v[74:75], v[16:19]
    ds_read_u16 v227, v238 offset:72
    v_add_u32 v239, 272, v239
    v_mfma_f32_4x4x4_16b_bf16 v[246:249], v[216:217], v[76:77], v[20:23]
    v_cvt_pk_bf16_f32 v100, v132, v133
    v_cvt_pk_bf16_f32 v101, v134, v135
    v_mfma_f32_4x4x4_16b_bf16 v[250:253], v[218:219], v[78:79], v[24:27]
    v_cvt_pk_bf16_f32 v102, v136, v137
    v_cvt_pk_bf16_f32 v103, v138, v139
    v_mfma_f32_4x4x4_16b_bf16 v[132:135], v[220:221], v[80:81], v[28:31]
    v_cvt_pk_bf16_f32 v104, v140, v141
    v_cvt_pk_bf16_f32 v105, v142, v143
    v_mfma_f32_4x4x4_16b_bf16 v[136:139], v[222:223], v[82:83], v[32:35]
    v_cvt_pk_bf16_f32 v106, v144, v145
    v_cvt_pk_bf16_f32 v107, v146, v147
    v_mfma_f32_4x4x4_16b_bf16 v[140:143], v[216:217], v[84:85], v[36:39]
    v_cvt_pk_bf16_f32 v108, v246, v247
    v_cvt_pk_bf16_f32 v109, v248, v249
    v_mfma_f32_4x4x4_16b_bf16 v[144:147], v[218:219], v[86:87], v[40:43]
    v_cvt_pk_bf16_f32 v110, v250, v251
    v_cvt_pk_bf16_f32 v111, v252, v253
    v_mfma_f32_4x4x4_16b_bf16 v[246:249], v[220:221], v[88:89], v[44:47]
    v_cvt_pk_bf16_f32 v112, v132, v133
    v_cvt_pk_bf16_f32 v113, v134, v135
    v_mfma_f32_4x4x4_16b_bf16 v[250:253], v[222:223], v[90:91], v[48:51]
    v_cvt_pk_bf16_f32 v114, v136, v137
    v_cvt_pk_bf16_f32 v115, v138, v139
    v_mfma_f32_4x4x4_16b_bf16 v[132:135], v[216:217], v[92:93], v[52:55]
    v_cvt_pk_bf16_f32 v116, v140, v141
    v_cvt_pk_bf16_f32 v117, v142, v143
    v_mfma_f32_4x4x4_16b_bf16 v[136:139], v[218:219], v[94:95], v[56:59]
    v_cvt_pk_bf16_f32 v118, v144, v145
    v_cvt_pk_bf16_f32 v119, v146, v147
    v_mfma_f32_4x4x4_16b_bf16 v[140:143], v[220:221], v[96:97], v[60:63]
    v_cvt_pk_bf16_f32 v120, v246, v247
    v_cvt_pk_bf16_f32 v121, v248, v249
    v_mfma_f32_4x4x4_16b_bf16 v[144:147], v[222:223], v[98:99], v[64:67]
    v_cvt_pk_bf16_f32 v122, v250, v251
    v_cvt_pk_bf16_f32 v123, v252, v253
    v_cvt_pk_bf16_f32 v124, v132, v133
    v_cvt_pk_bf16_f32 v125, v134, v135
    v_cvt_pk_bf16_f32 v126, v136, v137
    v_cvt_pk_bf16_f32 v127, v138, v139
    v_cvt_pk_bf16_f32 v128, v140, v141
    v_cvt_pk_bf16_f32 v129, v142, v143
    v_cvt_pk_bf16_f32 v130, v144, v145
    v_cvt_pk_bf16_f32 v131, v146, v147
    s_waitcnt lgkmcnt(0)
    s_branch Ls_evd2
Ls_ev3:
    s_bitcmp0_b64 s[56:57], 3
    s_cbranch_scc1 Ls_nf3
    v_cvt_pk_bf16_f32 v246, v212, v212
    v_mov_b32 v212, 0
    ds_write_b16 v240, v246
    v_add_u32 v240, 128, v240
    s_add_u32 s24, s24, s32
    s_addc_u32 s25, s25, 0
    s_xor_b32 s32, s32, 0x18ffe0
Ls_nf3:
    s_bitcmp0_b64 s[56:57], 8
    s_cbranch_scc1 Ls_na3
    s_add_u32 s35, s35, s31
    s_min_u32 s35, s35, 419404800
    s_xor_b32 s31, s31, 0x63ff800
Ls_na3:
    s_bitcmp0_b64 s[56:57], 5
    s_cbranch_scc1 Ls_evd3
Ls_e13:
    s_sub_u32 s61, s61, 1
    s_cbranch_scc1 Ls_last3
    v_mul_u32_u24 v216, v224, v241
    v_mul_u32_u24 v217, v224, v242
    v_mul_u32_u24 v218, v225, v241
    v_mul_u32_u24 v219, v225, v242
    v_mul_u32_u24 v220, v226, v241
    v_mul_u32_u24 v221, v226, v242
    v_mul_u32_u24 v222, v227, v241
    v_mul_u32_u24 v223, v227, v242
    v_add_u32 v238, 128, v238
    ds_read_b128 v[164:167], v239
    v_mfma_f32_4x4x4_16b_bf16 v[132:135], v[216:217], v[68:69], v[4:7]
    ds_read_b128 v[168:171], v239 offset:64
    ds_read_b128 v[172:175], v239 offset:128
    v_mfma_f32_4x4x4_16b_bf16 v[136:139], v[218:219], v[70:71], v[8:11]
    ds_read_b128 v[176:179], v239 offset:192
    ds_read_u16 v224, v238
    v_mfma_f32_4x4x4_16b_bf16 v[140:143], v[220:221], v[72:73], v[12:15]
    ds_read_u16 v225, v238 offset:8
    ds_read_u16 v226, v238 offset:64
    v_mfma_f32_4x4x4_16b_bf16 v[144:147], v[222:223], v[74:75], v[16:19]
    ds_read_u16 v227, v238 offset:72
    v_add_u32 v239, 272, v239
    v_mfma_f32_4x4x4_16b_bf16 v[246:249], v[216:217], v[76:77], v[20:23]
    v_cvt_pk_bf16_f32 v100, v132, v133
    v_cvt_pk_bf16_f32 v101, v134, v135
    v_mfma_f32_4x4x4_16b_bf16 v[250:253], v[218:219], v[78:79], v[24:27]
    v_cvt_pk_bf16_f32 v102, v136, v137
    v_cvt_pk_bf16_f32 v103, v138, v139
    v_mfma_f32_4x4x4_16b_bf16 v[132:135], v[220:221], v[80:81], v[28:31]
    v_cvt_pk_bf16_f32 v104, v140, v141
    v_cvt_pk_bf16_f32 v105, v142, v143
    v_mfma_f32_4x4x4_16b_bf16 v[136:139], v[222:223], v[82:83], v[32:35]
    v_cvt_pk_bf16_f32 v106, v144, v145
    v_cvt_pk_bf16_f32 v107, v146, v147
    v_mfma_f32_4x4x4_16b_bf16 v[140:143], v[216:217], v[84:85], v[36:39]
    v_cvt_pk_bf16_f32 v108, v246, v247
    v_cvt_pk_bf16_f32 v109, v248, v249
    v_mfma_f32_4x4x4_16b_bf16 v[144:147], v[218:219], v[86:87], v[40:43]
    v_cvt_pk_bf16_f32 v110, v250, v251
    v_cvt_pk_bf16_f32 v111, v252, v253
    v_mfma_f32_4x4x4_16b_bf16 v[246:249], v[220:221], v[88:89], v[44:47]
    v_cvt_pk_bf16_f32 v112, v132, v133
    v_cvt_pk_bf16_f32 v113, v134, v135
    v_mfma_f32_4x4x4_16b_bf16 v[250:253], v[222:223], v[90:91], v[48:51]
    v_cvt_pk_bf16_f32 v114, v136, v137
    v_cvt_pk_bf16_f32 v115, v138, v139
    v_mfma_f32_4x4x4_16b_bf16 v[132:135], v[216:217], v[92:93], v[52:55]
    v_cvt_pk_bf16_f32 v116, v140, v141
    v_cvt_pk_bf16_f32 v117, v142, v143
    v_mfma_f32_4x4x4_16b_bf16 v[136:139], v[218:219], v[94:95], v[56:59]
    v_cvt_pk_bf16_f32 v118, v144, v145
    v_cvt_pk_bf16_f32 v119, v146, v147
    v_mfma_f32_4x4x4_16b_bf16 v[140:143], v[220:221], v[96:97], v[60:63]
    v_cvt_pk_bf16_f32 v120, v246, v247
    v_cvt_pk_bf16_f32 v121, v248, v249
    v_mfma_f32_4x4x4_16b_bf16 v[144:147], v[222:223], v[98:99], v[64:67]
    v_cvt_pk_bf16_f32 v122, v250, v251
    v_cvt_pk_bf16_f32 v123, v252, v253
    v_cvt_pk_bf16_f32 v124, v132, v133
    v_cvt_pk_bf16_f32 v125, v134, v135
    v_cvt_pk_bf16_f32 v126, v136, v137
    v_cvt_pk_bf16_f32 v127, v138, v139
    v_cvt_pk_bf16_f32 v128, v140, v141
    v_cvt_pk_bf16_f32 v129, v142, v143
    v_cvt_pk_bf16_f32 v130, v144, v145
    v_cvt_pk_bf16_f32 v131, v146, v147
    s_waitcnt lgkmcnt(0)
    s_branch Ls_evd3
Ls_last0:
    s_branch Ls_tail
Ls_last1:
    v_add_u32 v236, 2080, v236
    s_lshr_b64 s[56:57], s[56:57], 1
    v_add_u32 v244, 16, v244
    s_branch Ls_tail
Ls_last2:
    v_add_u32 v236, 4160, v236
    s_lshr_b64 s[56:57], s[56:57], 2
    v_add_u32 v244, 32, v244
    s_branch Ls_tail
Ls_last3:
    v_add_u32 v236, 6240, v236
    s_lshr_b64 s[56:57], s[56:57], 3
    v_add_u32 v244, 48, v244
Ls_tail:
    ds_read_b32 v246, v244 offset:0
    s_waitcnt lgkmcnt(0)
    v_bfe_u32 v247, v246, 0, 8
    v_lshlrev_b32 v247, 1, v247
    v_bfe_u32 v248, v246, 8, 8
    v_lshlrev_b32 v248, 1, v248
    v_bfe_u32 v249, v246, 16, 8
    v_lshlrev_b32 v249, 1, v249
    v_bfe_u32 v250, v246, 24, 8
    v_lshlrev_b32 v250, 1, v250
    buffer_load_ushort v247, v247, s[24:27], 0 offen
    buffer_load_ushort v248, v248, s[24:27], 0 offen
    buffer_load_ushort v249, v249, s[24:27], 0 offen
    buffer_load_ushort v250, v250, s[24:27], 0 offen
    s_waitcnt vmcnt(0)
    v_lshlrev_b32 v247, 16, v247
    v_mul_f32 v208, v208, v247
    v_lshlrev_b32 v248, 16, v248
    v_mul_f32 v209, v209, v248
    v_lshlrev_b32 v249, 16, v249
    v_mul_f32 v210, v210, v249
    v_lshlrev_b32 v250, 16, v250
    v_mul_f32 v211, v211, v250
    v_exp_f32 v132, v148
    v_exp_f32 v133, v149
    v_exp_f32 v134, v150
    v_exp_f32 v135, v151
    v_exp_f32 v136, v152
    v_exp_f32 v137, v153
    v_mfma_f32_4x4x4_16b_bf16 v[132:135], v[228:229], v[228:229], v[132:135]
    v_cvt_pk_bf16_f32 v208, v208, v209
    v_cvt_pk_bf16_f32 v209, v210, v211
    v_exp_f32 v138, v154
    s_nop 0
    v_mfma_f32_4x4x4_16b_bf16 v[212:215], v[208:209], v[188:189], v[212:215] cbsz:4 abid:0
    ds_read_b64_tr_b16 v[188:189], v236 offset:0
    v_exp_f32 v139, v155
    v_exp_f32 v140, v156
    v_mfma_f32_4x4x4_16b_bf16 v[212:215], v[208:209], v[190:191], v[212:215] cbsz:4 abid:4
    ds_read_b64_tr_b16 v[190:191], v236 offset:512
    v_mfma_f32_4x4x4_16b_bf16 v[136:139], v[228:229], v[228:229], v[136:139]
    v_rcp_f32 v132, v132
    v_mfma_f32_4x4x4_16b_bf16 v[212:215], v[208:209], v[192:193], v[212:215] cbsz:4 abid:8
    ds_read_b64_tr_b16 v[192:193], v236 offset:1056
    v_exp_f32 v141, v157
    v_rcp_f32 v133, v133
    v_mfma_f32_4x4x4_16b_bf16 v[212:215], v[208:209], v[194:195], v[212:215] cbsz:4 abid:12
    ds_read_b64_tr_b16 v[194:195], v236 offset:1568
    v_exp_f32 v142, v158
    v_rcp_f32 v134, v134
    v_exp_f32 v143, v159
    v_rcp_f32 v135, v135
    v_cvt_pk_bf16_f32 v132, v132, v133
    v_mfma_f32_4x4x4_16b_bf16 v[140:143], v[228:229], v[228:229], v[140:143]
    v_exp_f32 v144, v160
    v_rcp_f32 v136, v136
    v_cvt_pk_bf16_f32 v133, v134, v135
    s_bitcmp0_b64 s[56:57], 1
    s_cbranch_scc1 Ls_tnf
    v_cvt_pk_bf16_f32 v246, v212, v212
    v_mov_b32 v212, 0
    ds_write_b16 v240, v246
    v_add_u32 v240, 128, v240
    s_add_u32 s24, s24, s32
    s_addc_u32 s25, s25, 0
    s_xor_b32 s32, s32, 0x18ffe0
Ls_tnf:
    s_waitcnt lgkmcnt(0)
    v_exp_f32 v145, v161
    v_rcp_f32 v137, v137
    v_exp_f32 v146, v162
    v_rcp_f32 v138, v138
    v_cvt_pk_bf16_f32 v134, v136, v137
    v_exp_f32 v147, v163
    v_rcp_f32 v139, v139
    s_nop 0
    v_mfma_f32_4x4x4_16b_bf16 v[144:147], v[228:229], v[228:229], v[144:147]
    v_rcp_f32 v140, v140
    v_rcp_f32 v141, v141
    v_cvt_pk_bf16_f32 v135, v138, v139
    v_rcp_f32 v142, v142
    v_cvt_pk_bf16_f32 v136, v140, v141
    v_mfma_f32_16x16x32_bf16 v[208:211], v[132:135], v[196:199], v[204:207]
    v_rcp_f32 v143, v143
    v_rcp_f32 v144, v144
    v_cvt_pk_bf16_f32 v137, v142, v143
    v_rcp_f32 v145, v145
    v_rcp_f32 v146, v146
    v_rcp_f32 v147, v147
    v_cvt_pk_bf16_f32 v138, v144, v145
    v_cvt_pk_bf16_f32 v139, v146, v147
    s_nop 1
    v_mfma_f32_16x16x32_bf16 v[208:211], v[136:139], v[200:203], v[208:211]
    ds_read_b32 v246, v244 offset:16
    s_waitcnt lgkmcnt(0)
    v_bfe_u32 v247, v246, 0, 8
    v_lshlrev_b32 v247, 1, v247
    v_bfe_u32 v248, v246, 8, 8
    v_lshlrev_b32 v248, 1, v248
    v_bfe_u32 v249, v246, 16, 8
    v_lshlrev_b32 v249, 1, v249
    v_bfe_u32 v250, v246, 24, 8
    v_lshlrev_b32 v250, 1, v250
    buffer_load_ushort v247, v247, s[24:27], 0 offen
    buffer_load_ushort v248, v248, s[24:27], 0 offen
    buffer_load_ushort v249, v249, s[24:27], 0 offen
    buffer_load_ushort v250, v250, s[24:27], 0 offen
    s_waitcnt vmcnt(0)
    v_lshlrev_b32 v247, 16, v247
    v_mul_f32 v208, v208, v247
    v_lshlrev_b32 v248, 16, v248
    v_mul_f32 v209, v209, v248
    v_lshlrev_b32 v249, 16, v249
    v_mul_f32 v210, v210, v249
    v_lshlrev_b32 v250, 16, v250
    v_mul_f32 v211, v211, v250
    v_cvt_pk_bf16_f32 v208, v208, v209
    v_cvt_pk_bf16_f32 v209, v210, v211
    s_nop 1
    v_mfma_f32_4x4x4_16b_bf16 v[212:215], v[208:209], v[188:189], v[212:215] cbsz:4 abid:0
    s_nop 1
    v_mfma_f32_4x4x4_16b_bf16 v[212:215], v[208:209], v[190:191], v[212:215] cbsz:4 abid:4
    s_nop 1
    v_mfma_f32_4x4x4_16b_bf16 v[212:215], v[208:209], v[192:193], v[212:215] cbsz:4 abid:8
    s_nop 1
    v_mfma_f32_4x4x4_16b_bf16 v[212:215], v[208:209], v[194:195], v[212:215] cbsz:4 abid:12
    s_nop 4
    v_cvt_pk_bf16_f32 v246, v212, v212
    ds_write_b16 v240, v246
    s_branch L_store
.section .rodata,"a"
.p2align 6
.amdhsa_kernel standalone__sequential_behavior_din__recsys_kernel
  .amdhsa_next_free_vgpr 256
  .amdhsa_next_free_sgpr 102
  .amdhsa_accum_offset 256
  .amdhsa_group_segment_fixed_size 0
  .amdhsa_kernarg_size 80
  .amdhsa_user_sgpr_count 2
  .amdhsa_user_sgpr_kernarg_segment_ptr 1
  .amdhsa_system_sgpr_workgroup_id_x 1
.end_amdhsa_kernel
```

```asm
; @launch grid=(256,1,1) block=(512,1,1) lds=163840
.amdgcn_target "amdgcn-amd-amdhsa--gfx950"
.text
.globl standalone__sequential_behavior_din__recsys_kernel
.p2align 8
.type standalone__sequential_behavior_din__recsys_kernel,@function
standalone__sequential_behavior_din__recsys_kernel:
    s_load_dwordx16 s[4:19], s[0:1], 0
    s_cmp_ge_u32 s2, 256
    s_cbranch_scc1 L_end
    v_lshrrev_b32 v1, 6, v0
    v_and_b32 v0, 63, v0
    v_readfirstlane_b32 s54, v1
    s_lshl_b32 s53, s2, 3
    v_lshlrev_b32 v2, 4, v0
    v_lshrrev_b32 v1, 4, v0
    v_and_b32 v3, 0xf0, v2
    v_lshlrev_b32 v3, 2, v3
    v_lshl_add_u32 v130, v1, 4, v3
    v_bfrev_b32 v3, 1
    s_add_u32 s53, s53, s54
    s_movk_i32 s66, 800
    v_cmp_gt_u32 vcc, s66, v130
    s_mul_i32 s93, s53, 800
    s_mul_i32 s52, s54, 20480
    s_mov_b64 s[28:29], vcc
    v_cndmask_b32 v3, v3, v130, vcc
    v_and_b32 v248, 16, v0
    v_lshlrev_b32 v246, 1, v248
    v_xor_b32 v246, v246, v2
    v_and_b32 v243, 0xf0, v2
    v_lshl_add_u32 v243, v1, 19, v243
    s_lshl_b32 s66, s53, 8
    v_add_u32 v243, s66, v243
    s_lshl_b32 s67, s54, 12
    s_add_u32 m0, s52, 8320
    s_mov_b32 s26, 6553600
    s_mov_b32 s27, 0x20000
    s_waitcnt lgkmcnt(0)
    s_mov_b32 s24, s8
    s_and_b32 s25, s9, 0xffff
    s_cmp_ge_u32 s54, 4
    s_cbranch_scc1 L_young0
    buffer_load_dwordx4 v[100:103], v3, s[24:27], s93 offen nt
L_young0:
    global_load_lds_dwordx4 v243, s[4:5] nt
    s_add_u32 m0, s52, 4160
    s_add_u32 s10, s10, s67
    s_addc_u32 s11, s11, 0
    v_xor_b32 v247, 64, v246
    global_load_lds_dwordx4 v246, s[10:11] offset:0
    global_load_lds_dwordx4 v247, s[10:11] offset:1024
    global_load_lds_dwordx4 v246, s[10:11] offset:2048
    global_load_lds_dwordx4 v247, s[10:11] offset:3072
    s_load_dword s30, s[16:17], 0
    s_and_b32 s67, s54, 3
    v_and_b32 v250, 3, v0
    s_mov_b32 s20, s6
    s_and_b32 s21, s7, 0xffff
    s_or_b32 s21, s21, 0x800000
    s_mov_b32 s22, 200
    s_mov_b32 s23, 0x20000
    s_sub_u32 s40, s20, 1056
    s_subb_u32 s41, s21, 0
    s_mov_b32 s42, 200
    s_mov_b32 s43, 0x20000
    s_mul_i32 s35, s53, 51200
    s_movk_i32 s31, 25600
    s_mov_b32 s51, 104832000
    s_mov_b32 s60, 7
    s_mov_b64 s[56:57], 0
    s_mov_b64 s[58:59], 0
    v_mov_b32 v148, -1
    v_mov_b32 v149, -1
    v_mov_b32 v150, -1
    v_mov_b32 v151, -1
    s_add_u32 s66, s52, 18432
    v_add_u32 v152, s66, v2
    ds_write_b128 v152, v[148:151]
    ds_write_b128 v152, v[148:151] offset:1024
    s_add_u32 s64, s52, 18448
    v_mov_b32 v153, -1
    v_mov_b32 v154, -1
    v_mov_b32 v155, -1
    v_lshrrev_b32 v237, 3, v0
    v_add_u32 v237, s64, v237
    v_lshl_add_u32 v244, v1, 2, s66
    v_and_b32 v231, 0x70, v2
    v_lshlrev_b32 v248, 2, v248
    v_xor_b32 v231, v231, v248
    v_mov_b32 v233, v231
    s_movk_i32 s66, 400
    v_cmp_le_u32 vcc, s66, v130
    v_lshrrev_b32 v126, 1, v130
    s_movk_i32 s66, -200
    v_cndmask_b32 v130, 0, 1, vcc
    v_mad_i32_i24 v126, v130, s66, v126
    v_mul_u32_u24 v127, 0x10001, v126
    v_add_u32 v126, 0x10000, v127
    v_add_u32 v128, 0x50004, v127
    v_add_u32 v129, 0x70006, v127
    v_add_u32 v127, 0x30002, v127
    v_mov_b32 v131, 0xbfe0bfe0
    s_mov_b32 s86, 0xfff0ffff
    s_mov_b32 s87, 0xf000ff00
    s_mov_b32 s88, 0xff00fff0
    s_mov_b32 s89, 0xf000
    s_mov_b32 s90, 0xf0000f
    s_mov_b32 s91, 0xf0000f00
    s_mov_b32 s84, 0x11111113
    s_mov_b32 s85, 0x11111111
    v_cndmask_b32 v116, 0, v131, s[86:87]
    v_cndmask_b32 v120, 0, v131, s[88:89]
    v_cndmask_b32 v117, 0, v131, s[86:87]
    v_cndmask_b32 v121, 0, v131, s[88:89]
    v_cndmask_b32 v122, 0, v131, s[84:85]
    v_cndmask_b32 v123, 0, v131, s[84:85]
    v_cndmask_b32 v124, 0, v131, s[84:85]
    v_cndmask_b32 v125, 0, v131, s[84:85]
    v_lshlrev_b32 v246, 4, v250
    v_sub_u32 v246, 48, v246
    s_mov_b32 s86, 0xbfe0bfe0
    s_mov_b32 s87, 0xf0bfe0
    v_lshrrev_b64 v[118:119], v246, s[86:87]
    v_mov_b32 v131, 0
    s_mov_b64 s[84:85], 0
    v_cndmask_b32 v118, v120, v118, s[90:91]
    v_cndmask_b32 v119, v121, v119, s[90:91]
    s_mov_b32 s61, 7
    s_mov_b32 s92, 0xbfb8aa3b
    v_and_b32 v251, 15, v0
    v_bfe_u32 v252, v0, 2, 2
    v_lshlrev_b32 v253, 3, v250
    v_lshl_add_u32 v253, v252, 7, v253
    v_and_b32 v246, 24, v0
    v_lshlrev_b32 v246, 2, v246
    v_xor_b32 v246, v253, v246
    v_lshl_add_u32 v246, v1, 10, v246
    s_lshl_b32 s66, s67, 5
    v_xor_b32 v66, s66, v246
    v_add_u32 v66, 45120, v66
    s_lshr_b32 s66, s54, 1
    s_lshl_b32 s66, s66, 5
    v_xor_b32 v64, s66, v246
    s_and_b32 s66, s54, 1
    s_mul_i32 s66, s66, 20480
    s_add_u32 s66, s66, 4160
    v_add_u32 v64, s66, v64
    v_add_u32 v65, 81920, v64
    s_and_b32 s66, s54, 4
    v_lshrrev_b32 v246, 3, v251
    v_add_u32 v246, s66, v246
    v_mul_u32_u24 v246, 20480, v246
    v_lshl_add_u32 v246, v1, 4, v246
    v_and_b32 v247, 7, v0
    v_lshl_add_u32 v67, v247, 7, v246
    v_and_b32 v247, 1, v0
    v_lshlrev_b32 v247, 4, v247
    v_lshlrev_b32 v247, v247, 1
    v_cmp_gt_u32 vcc, 2, v250
    v_mov_b32 v229, 0
    v_mov_b32 v228, 0x3f80
    v_cndmask_b32 v241, 0, v247, vcc
    v_cmp_eq_u32 vcc, 0, v251
    v_sub_u32 v242, v247, v241
    v_mul_u32_u24 v218, 0x3f80, v241
    v_cndmask_b32 v220, 0, -1, vcc
    v_mul_u32_u24 v219, 0x3f80, v242
    s_and_b32 s66, s54, 3
    s_lshl_b32 s66, s66, 6
    s_add_u32 s66, s66, 9344
    v_and_b32 v247, 7, v0
    v_mul_u32_u24 v247, 144, v247
    v_add3_u32 v98, v67, v247, s66
    s_add_u32 s66, s52, 14592
    v_lshl_add_u32 v221, v0, 2, s66
    ds_write_b32 v221, v229
    s_xor_b32 s66, s54, 4
    s_mul_i32 s66, s66, 20480
    s_add_u32 s66, s66, 14592
    v_writelane_b32 v221, s66, 1
    v_mov_b32 v222, s52
    ds_write_b32 v222, v229 offset:14848
    ds_write_b32 v222, v229 offset:14864
    s_mov_b32 s47, 0
    s_mov_b32 s50, 0
    s_mov_b32 s48, 5
    v_and_b32 v247, 8, v0
    v_lshlrev_b32 v247, 2, v247
    v_lshl_add_u32 v247, v251, 7, v247
    v_add_u32 v247, s52, v247
    v_and_b32 v248, 2, v0
    v_lshlrev_b32 v248, 1, v248
    v_xor_b32 v248, v248, v1
    v_lshl_add_u32 v234, v248, 4, v247
    v_xor_b32 v248, 4, v248
    v_lshl_add_u32 v235, v248, 4, v247
    v_and_b32 v247, 8, v0
    v_lshlrev_b32 v247, 3, v247
    v_lshl_add_u32 v248, v1, 5, v253
    v_xor_b32 v248, v248, v247
    v_add_u32 v236, s52, v248
    s_add_u32 s66, s52, 8320
    v_lshl_add_u32 v238, v250, 1, s66
    v_lshl_add_u32 v238, v1, 4, v238
    v_lshl_add_u32 v240, v0, 1, s66
    s_add_u32 s66, s52, 9344
    v_lshl_add_u32 v239, v1, 4, s66
    v_mov_b32 v188, 0
    v_mov_b32 v189, 0
    v_mov_b32 v190, 0
    v_mov_b32 v191, 0
    v_mov_b32 v192, 0
    v_mov_b32 v193, 0
    v_mov_b32 v194, 0
    v_mov_b32 v195, 0
    v_mov_b32 v208, 0
    v_mov_b32 v212, 0
    v_mov_b32 v209, 0
    v_mov_b32 v213, 0
    v_mov_b32 v210, 0
    v_mov_b32 v214, 0
    v_mov_b32 v211, 0
    v_mov_b32 v215, 0
    s_and_b32 s66, s54, 3
    s_lshl_b32 s66, s66, 5
    v_lshl_add_u32 v249, v1, 3, s66
    global_load_dwordx2 v[96:97], v249, s[12:13]
    s_cmp_ge_u32 s54, 4
    s_cbranch_scc0 L_old3z
    buffer_load_dwordx4 v[100:103], v3, s[24:27], s93 offen nt
L_old3z:
    s_cmp_ge_u32 s54, 4
    s_cbranch_scc1 L_young1
    s_waitcnt vmcnt(6) lgkmcnt(0)
    s_call_b64 s[62:63], L_fp
    s_waitcnt vmcnt(5)
    s_branch L_old1
L_young1:
    s_waitcnt vmcnt(2)
L_old1:
    s_waitcnt lgkmcnt(0)
    s_barrier
    ds_read_b64_tr_b16 v[16:17], v66 offset:0
    ds_read_b64_tr_b16 v[18:19], v66 offset:512
    ds_read_b64_tr_b16 v[20:21], v66 offset:20480
    ds_read_b64_tr_b16 v[22:23], v66 offset:20992
    ds_read_b64_tr_b16 v[24:25], v66 offset:40960
    ds_read_b64_tr_b16 v[26:27], v66 offset:41472
    ds_read_b64_tr_b16 v[28:29], v66 offset:61440
    ds_read_b64_tr_b16 v[30:31], v66 offset:61952
    ds_read_b128 v[32:35], v67 offset:8320
    ds_read_b128 v[36:39], v67 offset:8384
    ds_read_b128 v[40:43], v67 offset:49280
    ds_read_b128 v[44:47], v67 offset:49344
    ds_read_b64_tr_b16 v[4:5], v64 offset:0
    ds_read_b64_tr_b16 v[8:9], v65 offset:0
    ds_read_b64_tr_b16 v[12:13], v65 offset:40960
    ds_read_b64_tr_b16 v[6:7], v64 offset:512
    ds_read_b64_tr_b16 v[10:11], v65 offset:512
    ds_read_b64_tr_b16 v[14:15], v65 offset:41472
    s_cmp_ge_u32 s54, 4
    s_cbranch_scc1 L_young2
    s_waitcnt vmcnt(4)
    s_branch L_old2
L_young2:
    s_waitcnt vmcnt(1)
L_old2:
    s_add_u32 s93, s93, 1638400
    buffer_load_dwordx4 v[104:107], v3, s[24:27], s93 offen nt
    s_add_u32 s93, s93, 1638400
    buffer_load_dwordx4 v[108:111], v3, s[24:27], s93 offen nt
    s_add_u32 s93, s93, 1638400
    buffer_load_dwordx4 v[112:115], v3, s[24:27], s93 offen nt
    v_lshlrev_b32 v249, 3, v1
    v_lshl_add_u32 v249, v250, 5, v249
    global_load_dwordx2 v[216:217], v249, s[14:15]
    v_lshlrev_b32 v48, 16, v96
    v_and_b32 v49, 0xffff0000, v96
    v_lshlrev_b32 v50, 16, v97
    v_and_b32 v51, 0xffff0000, v97
    s_lshl_b32 s30, s30, 16
    v_and_b32 v204, s30, v220
    v_and_b32 v205, s30, v220
    v_and_b32 v206, s30, v220
    v_and_b32 v207, s30, v220
    s_waitcnt lgkmcnt(0)
    v_xor_b32 v24, 0x80008000, v24
    v_xor_b32 v25, 0x80008000, v25
    v_xor_b32 v26, 0x80008000, v26
    v_xor_b32 v27, 0x80008000, v27
    v_xor_b32 v28, 0x80008000, v28
    v_xor_b32 v29, 0x80008000, v29
    v_xor_b32 v30, 0x80008000, v30
    v_xor_b32 v31, 0x80008000, v31
    v_mfma_f32_4x4x4_16b_bf16 v[56:59], v[218:219], v[4:5], 0
    v_mfma_f32_4x4x4_16b_bf16 v[68:71], v[218:219], v[12:13], 0
    v_mfma_f32_4x4x4_16b_bf16 v[60:63], v[218:219], v[6:7], 0
    v_mfma_f32_4x4x4_16b_bf16 v[72:75], v[218:219], v[14:15], 0
    v_mfma_f32_4x4x4_16b_bf16 v[56:59], v[218:219], v[8:9], v[56:59]
    v_mfma_f32_4x4x4_16b_bf16 v[60:63], v[218:219], v[10:11], v[60:63]
    v_mfma_f32_16x16x32_bf16 v[52:55], v[16:19], v[40:43], v[48:51]
    v_mfma_f32_16x16x32_bf16 v[52:55], v[20:23], v[44:47], v[52:55]
    v_mfma_f32_16x16x32_bf16 v[52:55], v[24:27], v[40:43], v[52:55]
    v_mfma_f32_16x16x32_bf16 v[52:55], v[28:31], v[44:47], v[52:55]
    v_mfma_f32_16x16x32_bf16 v[48:51], v[16:19], v[32:35], v[48:51]
    v_mfma_f32_16x16x32_bf16 v[48:51], v[20:23], v[36:39], v[48:51]
    v_mfma_f32_16x16x32_bf16 v[48:51], v[24:27], v[32:35], v[48:51]
    v_mfma_f32_16x16x32_bf16 v[48:51], v[28:31], v[36:39], v[48:51]
    v_mul_f32 v56, s92, v56
    v_mul_f32 v57, s92, v57
    v_mul_f32 v58, s92, v58
    v_mul_f32 v59, s92, v59
    v_mul_f32 v60, s92, v60
    v_mul_f32 v61, s92, v61
    v_mul_f32 v62, s92, v62
    v_mul_f32 v63, s92, v63
    v_mul_f32 v68, s92, v68
    v_mul_f32 v69, s92, v69
    v_mul_f32 v70, s92, v70
    v_mul_f32 v71, s92, v71
    v_mul_f32 v72, s92, v72
    v_mul_f32 v73, s92, v73
    v_mul_f32 v74, s92, v74
    v_mul_f32 v75, s92, v75
    s_add_u32 s66, s52, 11520
    v_add_u32 v3, s66, v2
    v_cvt_pk_bf16_f32 v68, v68, v69
    v_cvt_pk_bf16_f32 v69, v70, v71
    v_cvt_pk_bf16_f32 v70, v72, v73
    v_cvt_pk_bf16_f32 v71, v74, v75
    v_mul_f32 v48, s92, v48
    v_mul_f32 v49, s92, v49
    v_mul_f32 v50, s92, v50
    v_mul_f32 v51, s92, v51
    v_mul_f32 v52, s92, v52
    v_mul_f32 v53, s92, v53
    v_mul_f32 v54, s92, v54
    v_mul_f32 v55, s92, v55
    ds_write_b128 v3, v[56:59]
    ds_write_b128 v3, v[60:63] offset:1024
    ds_write_b128 v3, v[68:71] offset:2048
    ds_write_b128 v98, v[48:51]
    ds_write_b128 v98, v[52:55] offset:40960
    v_add_u32 v3, 11520, v2
    v_add_u32 v246, 81920, v3
    s_waitcnt lgkmcnt(0)
    s_barrier
    s_cmp_ge_u32 s54, 4
    s_cbranch_scc0 L_old3
    s_waitcnt vmcnt(4)
    s_call_b64 s[62:63], L_fp
    s_branch L_yng3
L_old3:
    s_call_b64 s[62:63], L_t23
L_yng3:
    ds_read_b128 v[4:7], v3 offset:0
    ds_read_b128 v[8:11], v3 offset:1024
    ds_read_b128 v[68:71], v3 offset:2048
    ds_read_b128 v[12:15], v3 offset:20480
    ds_read_b128 v[16:19], v3 offset:21504
    ds_read_b128 v[72:75], v3 offset:22528
    ds_read_b128 v[20:23], v3 offset:40960
    ds_read_b128 v[24:27], v3 offset:41984
    ds_read_b128 v[76:79], v3 offset:43008
    s_waitcnt vmcnt(4)
    v_mfma_i32_16x16x64_i8 v[172:175], v[122:125], v[104:107], 0
    v_mfma_i32_16x16x64_i8 v[176:179], v[122:125], v[108:111], 0
    v_mfma_i32_16x16x64_i8 v[180:183], v[122:125], v[112:115], 0
    v_and_b32 v160, 0x800080, v104
    v_mul_u32_u24 v160, 0x7f, v160
    v_bitop3_b32 v131, v104, v160, v131 bitop3:0xbe
    v_and_b32 v161, 0x800080, v105
    v_mul_u32_u24 v161, 0x7f, v161
    v_bitop3_b32 v131, v105, v161, v131 bitop3:0xbe
    v_and_b32 v160, 0x800080, v106
    v_mul_u32_u24 v160, 0x7f, v160
    v_bitop3_b32 v131, v106, v160, v131 bitop3:0xbe
    v_mov_b32_dpp v184, v172 row_shr:1 row_mask:0xf bank_mask:0xf bound_ctrl:0
    v_mov_b32_dpp v185, v176 row_shr:1 row_mask:0xf bank_mask:0xf bound_ctrl:0
    v_mov_b32_dpp v186, v180 row_shr:1 row_mask:0xf bank_mask:0xf bound_ctrl:0
    v_add_u32_dpp v184, v184, v184 row_shr:1 row_mask:0xf bank_mask:0xf bound_ctrl:0
    v_add_u32_dpp v185, v185, v185 row_shr:1 row_mask:0xf bank_mask:0xf bound_ctrl:0
    v_add_u32_dpp v186, v186, v186 row_shr:1 row_mask:0xf bank_mask:0xf bound_ctrl:0
    v_add_u32_dpp v184, v184, v184 row_shr:2 row_mask:0xf bank_mask:0xf bound_ctrl:0
    v_add_u32_dpp v185, v185, v185 row_shr:2 row_mask:0xf bank_mask:0xf bound_ctrl:0
    v_add_u32_dpp v186, v186, v186 row_shr:2 row_mask:0xf bank_mask:0xf bound_ctrl:0
    v_add_u32_dpp v184, v184, v184 row_shr:4 row_mask:0xf bank_mask:0xf bound_ctrl:0
    v_add_u32_dpp v185, v185, v185 row_shr:4 row_mask:0xf bank_mask:0xf bound_ctrl:0
    v_add_u32_dpp v186, v186, v186 row_shr:4 row_mask:0xf bank_mask:0xf bound_ctrl:0
    v_add_u32_dpp v184, v184, v184 row_shr:8 row_mask:0xf bank_mask:0xf bound_ctrl:0
    v_add_u32_dpp v185, v185, v185 row_shr:8 row_mask:0xf bank_mask:0xf bound_ctrl:0
    v_add_u32_dpp v186, v186, v186 row_shr:8 row_mask:0xf bank_mask:0xf bound_ctrl:0
    ds_read_b128 v[28:31], v3 offset:61440
    ds_read_b128 v[32:35], v3 offset:62464
    ds_read_b128 v[80:83], v3 offset:63488
    ds_read_b128 v[36:39], v246 offset:0
    ds_read_b128 v[40:43], v246 offset:1024
    ds_read_b128 v[84:87], v246 offset:2048
    v_and_b32 v161, 0x800080, v107
    v_mul_u32_u24 v161, 0x7f, v161
    v_bitop3_b32 v131, v107, v161, v131 bitop3:0xbe
    v_and_b32 v160, 0x800080, v108
    v_mul_u32_u24 v160, 0x7f, v160
    v_bitop3_b32 v131, v108, v160, v131 bitop3:0xbe
    v_and_b32 v161, 0x800080, v109
    v_mul_u32_u24 v161, 0x7f, v161
    v_bitop3_b32 v131, v109, v161, v131 bitop3:0xbe
    v_and_b32 v160, 0x800080, v110
    v_mul_u32_u24 v160, 0x7f, v160
    v_bitop3_b32 v131, v110, v160, v131 bitop3:0xbe
    v_and_b32 v161, 0x800080, v111
    v_mul_u32_u24 v161, 0x7f, v161
    v_bitop3_b32 v131, v111, v161, v131 bitop3:0xbe
    v_and_b32 v160, 0x800080, v112
    v_mul_u32_u24 v160, 0x7f, v160
    v_bitop3_b32 v131, v112, v160, v131 bitop3:0xbe
    v_and_b32 v161, 0x800080, v113
    v_mul_u32_u24 v161, 0x7f, v161
    v_bitop3_b32 v131, v113, v161, v131 bitop3:0xbe
    v_and_b32 v160, 0x800080, v114
    v_mul_u32_u24 v160, 0x7f, v160
    v_bitop3_b32 v131, v114, v160, v131 bitop3:0xbe
    v_and_b32 v161, 0x800080, v115
    v_mul_u32_u24 v161, 0x7f, v161
    v_bitop3_b32 v131, v115, v161, v131 bitop3:0xbe
    v_cmp_ne_u32 vcc, 0, v131
    v_readlane_b32 s68, v184, 6
    v_readlane_b32 s69, v173, 6
    v_readlane_b32 s70, v184, 15
    v_readlane_b32 s72, v185, 6
    v_readlane_b32 s73, v177, 6
    v_readlane_b32 s74, v185, 15
    v_readlane_b32 s76, v186, 6
    v_readlane_b32 s77, v181, 6
    v_readlane_b32 s78, v186, 15
    s_cbranch_vccnz L_general
    s_add_u32 s66, s68, s69
    s_add_u32 s66, s66, s64
    s_add_u32 s67, s66, 15
    s_and_b32 s67, s67, -16
    s_add_u32 s55, s64, 16
    s_max_u32 s67, s67, s55
    s_sub_u32 s66, s67, s66
    v_mad_u32_u24 v184, v130, s66, v184
    s_sub_u32 s55, s64, 2048
    v_add_u32 v172, s55, v184
    v_add_u32 v173, s55, v184
    v_add_u32 v174, s55, v184
    v_add_u32 v175, s55, v184
    s_add_u32 s64, s64, s70
    s_add_u32 s64, s64, s66
    v_mfma_i32_16x16x64_i8 v[132:135], v[118:121], v[104:107], v[172:175]
    v_mfma_i32_16x16x64_i8 v[136:139], v[116:119], v[104:107], v[172:175]
    s_add_u32 s64, s64, 15
    s_and_b32 s64, s64, -16
    s_add_u32 s55, s67, 16
    s_max_u32 s64, s64, s55
    s_lshr_b32 s95, s67, 4
    s_bitset1_b64 s[56:57], s95
    s_lshr_b32 s95, s64, 4
    s_bitset1_b64 s[56:57], s95
    s_add_u32 s66, s72, s73
    s_add_u32 s66, s66, s64
    s_add_u32 s67, s66, 15
    s_and_b32 s67, s67, -16
    s_add_u32 s55, s64, 16
    s_max_u32 s67, s67, s55
    s_sub_u32 s66, s67, s66
    v_mad_u32_u24 v185, v130, s66, v185
    s_sub_u32 s55, s64, 2048
    v_add_u32 v176, s55, v185
    v_add_u32 v177, s55, v185
    v_add_u32 v178, s55, v185
    v_add_u32 v179, s55, v185
    s_add_u32 s64, s64, s74
    s_add_u32 s64, s64, s66
    v_mfma_i32_16x16x64_i8 v[140:143], v[118:121], v[108:111], v[176:179]
    v_mfma_i32_16x16x64_i8 v[144:147], v[116:119], v[108:111], v[176:179]
    s_add_u32 s64, s64, 15
    s_and_b32 s64, s64, -16
    s_add_u32 s55, s67, 16
    s_max_u32 s64, s64, s55
    s_lshr_b32 s95, s67, 4
    s_lshl_b64 s[86:87], 1, s95
    s_bitcmp1_b32 s67, 10
    s_cselect_b64 s[88:89], 0, s[86:87]
    s_cselect_b64 s[90:91], s[86:87], 0
    s_or_b64 s[56:57], s[56:57], s[88:89]
    s_or_b64 s[58:59], s[58:59], s[90:91]
    s_lshr_b32 s95, s64, 4
    s_lshl_b64 s[86:87], 1, s95
    s_bitcmp1_b32 s64, 10
    s_cselect_b64 s[88:89], 0, s[86:87]
    s_cselect_b64 s[90:91], s[86:87], 0
    s_or_b64 s[56:57], s[56:57], s[88:89]
    s_or_b64 s[58:59], s[58:59], s[90:91]
    s_mov_b32 s44, s64
    ds_write_b8 v132, v126
    ds_write_b8_d16_hi v133, v126
    ds_write_b8 v134, v127
    ds_write_b8_d16_hi v135, v127
    ds_write_b8 v136, v128
    ds_write_b8_d16_hi v137, v128
    ds_write_b8 v138, v129
    ds_write_b8_d16_hi v139, v129
    s_add_u32 s66, s76, s77
    s_add_u32 s66, s66, s64
    s_add_u32 s67, s66, 15
    s_and_b32 s67, s67, -16
    s_add_u32 s55, s64, 16
    s_max_u32 s67, s67, s55
    s_sub_u32 s66, s67, s66
    v_mad_u32_u24 v186, v130, s66, v186
    s_sub_u32 s55, s64, 2048
    v_add_u32 v180, s55, v186
    v_add_u32 v181, s55, v186
    v_add_u32 v182, s55, v186
    v_add_u32 v183, s55, v186
    s_add_u32 s64, s64, s78
    s_add_u32 s64, s64, s66
    v_mfma_i32_16x16x64_i8 v[164:167], v[118:121], v[112:115], v[180:183]
    v_mfma_i32_16x16x64_i8 v[168:171], v[116:119], v[112:115], v[180:183]
    s_add_u32 s64, s64, 15
    s_and_b32 s64, s64, -16
    s_add_u32 s55, s67, 16
    s_max_u32 s64, s64, s55
    s_mov_b32 s45, s67
    s_mov_b32 s46, s64
    ds_write_b8 v140, v126
    ds_write_b8_d16_hi v141, v126
    ds_write_b8 v142, v127
    ds_write_b8_d16_hi v143, v127
    ds_write_b8 v144, v128
    ds_write_b8_d16_hi v145, v128
    ds_write_b8 v146, v129
    ds_write_b8_d16_hi v147, v129
    ds_read_b128 v[44:47], v246 offset:20480
    ds_read_b128 v[48:51], v246 offset:21504
    ds_read_b128 v[88:91], v246 offset:22528
    ds_read_b128 v[52:55], v246 offset:40960
    ds_read_b128 v[56:59], v246 offset:41984
    ds_read_b128 v[92:95], v246 offset:43008
    ds_read_b128 v[60:63], v246 offset:61440
    ds_read_b128 v[64:67], v246 offset:62464
    ds_read_b128 v[96:99], v246 offset:63488
    ds_read_u16 v224, v238 offset:0
    ds_read_u16 v225, v238 offset:8
    ds_read_u16 v226, v238 offset:64
    ds_read_u16 v227, v238 offset:72
    ds_write_b8 v164, v126
    ds_write_b8_d16_hi v165, v126
    ds_write_b8 v166, v127
    ds_write_b8_d16_hi v167, v127
    ds_write_b8 v168, v128
    ds_write_b8_d16_hi v169, v128
    ds_write_b8 v170, v129
    ds_write_b8_d16_hi v171, v129
    s_cmp_ge_u32 s54, 4
    s_cbranch_scc0 L_old3b
    s_call_b64 s[62:63], L_t23
L_old3b:
L_listed:
    s_sub_u32 s66, s46, s44
    s_or_b32 s66, s66, s54
    s_and_b32 s67, s84, 0x40000000
    s_or_b32 s66, s66, s67
    s_bitset1_b32 s66, 31
    v_mov_b32 v132, s66
    v_mov_b32 v133, s44
    v_mov_b32 v134, s45
    v_mov_b32 v135, s46
    s_mov_b64 exec, 1
    ds_write_b128 v222, v[132:135] offset:14848
    s_mov_b64 exec, -1
    s_sub_u32 s66, s64, s52
    s_sub_u32 s66, s66, 18448
    s_lshr_b32 s66, s66, 3
    s_lshr_b32 s67, s54, 2
    s_mul_i32 s67, s67, 2
    s_add_u32 s66, s66, s67
    s_sub_u32 s67, 0, s66
    v_mov_b32 v2, v221
    v_mov_b32 v1, s66
    v_mov_b32 v3, -8
    v_writelane_b32 v1, s67, 1
    v_writelane_b32 v3, 8, 1
    ds_add_u32 v2, v1
    s_cmp_eq_u32 s94, 1
    s_cbranch_scc1 L_nolate
    ds_read_u8 v148, v237 offset:0
    ds_read_u8 v149, v237 offset:8
    ds_read_u8 v150, v237 offset:16
    ds_read_u8 v151, v237 offset:24
    ds_read_u8 v152, v237 offset:32
    ds_read_u8 v153, v237 offset:40
    ds_read_u8 v154, v237 offset:48
    ds_read_u8 v155, v237 offset:56
    s_waitcnt lgkmcnt(0)
    s_add_u32 m0, s52, 0
    v_mov_b32 v230, v148
    v_mov_b32 v232, v149
    buffer_load_dwordx4 v[230:231], s[20:23], s35 idxen offen nt lds
    buffer_load_dwordx4 v[232:233], s[40:43], s35 idxen offen offset:1056 nt lds
    s_bitcmp0_b64 s[56:57], 2
    s_cbranch_scc1 L_noadvl1
    s_add_u32 s35, s35, s31
    s_min_u32 s35, s35, 419404800
    s_sub_u32 s60, s60, 1
    s_bitcmp1_b32 s60, 0
    s_cselect_b32 s31, 25600, s51
L_noadvl1:
    s_add_u32 m0, s52, 2080
    v_mov_b32 v230, v150
    v_mov_b32 v232, v151
    buffer_load_dwordx4 v[230:231], s[20:23], s35 idxen offen nt lds
    buffer_load_dwordx4 v[232:233], s[40:43], s35 idxen offen offset:1056 nt lds
    s_bitcmp0_b64 s[56:57], 3
    s_cbranch_scc1 L_noadvl2
    s_add_u32 s35, s35, s31
    s_min_u32 s35, s35, 419404800
    s_sub_u32 s60, s60, 1
    s_bitcmp1_b32 s60, 0
    s_cselect_b32 s31, 25600, s51
L_noadvl2:
    s_add_u32 m0, s52, 4160
    v_mov_b32 v230, v152
    v_mov_b32 v232, v153
    buffer_load_dwordx4 v[230:231], s[20:23], s35 idxen offen nt lds
    buffer_load_dwordx4 v[232:233], s[40:43], s35 idxen offen offset:1056 nt lds
    s_bitcmp0_b64 s[56:57], 4
    s_cbranch_scc1 L_noadvl3
    s_add_u32 s35, s35, s31
    s_min_u32 s35, s35, 419404800
    s_sub_u32 s60, s60, 1
    s_bitcmp1_b32 s60, 0
    s_cselect_b32 s31, 25600, s51
L_noadvl3:
    s_add_u32 m0, s52, 6240
    v_mov_b32 v230, v154
    v_mov_b32 v232, v155
    buffer_load_dwordx4 v[230:231], s[20:23], s35 idxen offen nt lds
    buffer_load_dwordx4 v[232:233], s[40:43], s35 idxen offen offset:1056 nt lds
L_nolate:
    v_and_b32_dpp v196, v216, v220 quad_perm:[0,0,0,0] row_mask:0xf bank_mask:0xf
    v_and_b32_dpp v197, v217, v220 quad_perm:[0,0,0,0] row_mask:0xf bank_mask:0xf
    v_and_b32_dpp v198, v216, v220 quad_perm:[1,1,1,1] row_mask:0xf bank_mask:0xf
    v_and_b32_dpp v199, v217, v220 quad_perm:[1,1,1,1] row_mask:0xf bank_mask:0xf
    v_and_b32_dpp v200, v216, v220 quad_perm:[2,2,2,2] row_mask:0xf bank_mask:0xf
    v_and_b32_dpp v201, v217, v220 quad_perm:[2,2,2,2] row_mask:0xf bank_mask:0xf
    v_and_b32_dpp v202, v216, v220 quad_perm:[3,3,3,3] row_mask:0xf bank_mask:0xf
    v_and_b32_dpp v203, v217, v220 quad_perm:[3,3,3,3] row_mask:0xf bank_mask:0xf
    s_waitcnt vmcnt(6) lgkmcnt(0)
    ds_read_b128 v[180:183], v234 offset:0
    ds_read_b128 v[184:187], v235 offset:0
    v_mul_u32_u24 v216, v224, v241
    v_mul_u32_u24 v217, v224, v242
    v_mul_u32_u24 v218, v225, v241
    v_mul_u32_u24 v219, v225, v242
    v_mul_u32_u24 v220, v226, v241
    v_mul_u32_u24 v221, v226, v242
    v_mul_u32_u24 v222, v227, v241
    v_mul_u32_u24 v223, v227, v242
    v_add_u32 v238, 128, v238
    ds_read_b128 v[164:167], v239
    v_mfma_f32_4x4x4_16b_bf16 v[132:135], v[216:217], v[68:69], v[4:7]
    ds_read_b128 v[168:171], v239 offset:64
    ds_read_b128 v[172:175], v239 offset:128
    v_mfma_f32_4x4x4_16b_bf16 v[136:139], v[218:219], v[70:71], v[8:11]
    ds_read_b128 v[176:179], v239 offset:192
    ds_read_u16 v224, v238
    v_mfma_f32_4x4x4_16b_bf16 v[140:143], v[220:221], v[72:73], v[12:15]
    ds_read_u16 v225, v238 offset:8
    ds_read_u16 v226, v238 offset:64
    v_mfma_f32_4x4x4_16b_bf16 v[144:147], v[222:223], v[74:75], v[16:19]
    ds_read_u16 v227, v238 offset:72
    v_add_u32 v239, 272, v239
    v_mfma_f32_4x4x4_16b_bf16 v[246:249], v[216:217], v[76:77], v[20:23]
    v_cvt_pk_bf16_f32 v100, v132, v133
    v_cvt_pk_bf16_f32 v101, v134, v135
    v_mfma_f32_4x4x4_16b_bf16 v[250:253], v[218:219], v[78:79], v[24:27]
    v_cvt_pk_bf16_f32 v102, v136, v137
    v_cvt_pk_bf16_f32 v103, v138, v139
    v_mfma_f32_4x4x4_16b_bf16 v[132:135], v[220:221], v[80:81], v[28:31]
    v_cvt_pk_bf16_f32 v104, v140, v141
    v_cvt_pk_bf16_f32 v105, v142, v143
    v_mfma_f32_4x4x4_16b_bf16 v[136:139], v[222:223], v[82:83], v[32:35]
    v_cvt_pk_bf16_f32 v106, v144, v145
    v_cvt_pk_bf16_f32 v107, v146, v147
    v_mfma_f32_4x4x4_16b_bf16 v[140:143], v[216:217], v[84:85], v[36:39]
    v_cvt_pk_bf16_f32 v108, v246, v247
    v_cvt_pk_bf16_f32 v109, v248, v249
    v_mfma_f32_4x4x4_16b_bf16 v[144:147], v[218:219], v[86:87], v[40:43]
    v_cvt_pk_bf16_f32 v110, v250, v251
    v_cvt_pk_bf16_f32 v111, v252, v253
    v_mfma_f32_4x4x4_16b_bf16 v[246:249], v[220:221], v[88:89], v[44:47]
    v_cvt_pk_bf16_f32 v112, v132, v133
    v_cvt_pk_bf16_f32 v113, v134, v135
    v_mfma_f32_4x4x4_16b_bf16 v[250:253], v[222:223], v[90:91], v[48:51]
    v_cvt_pk_bf16_f32 v114, v136, v137
    v_cvt_pk_bf16_f32 v115, v138, v139
    v_mfma_f32_4x4x4_16b_bf16 v[132:135], v[216:217], v[92:93], v[52:55]
    v_cvt_pk_bf16_f32 v116, v140, v141
    v_cvt_pk_bf16_f32 v117, v142, v143
    v_mfma_f32_4x4x4_16b_bf16 v[136:139], v[218:219], v[94:95], v[56:59]
    v_cvt_pk_bf16_f32 v118, v144, v145
    v_cvt_pk_bf16_f32 v119, v146, v147
    v_mfma_f32_4x4x4_16b_bf16 v[140:143], v[220:221], v[96:97], v[60:63]
    v_cvt_pk_bf16_f32 v120, v246, v247
    v_cvt_pk_bf16_f32 v121, v248, v249
    v_mfma_f32_4x4x4_16b_bf16 v[144:147], v[222:223], v[98:99], v[64:67]
    v_cvt_pk_bf16_f32 v122, v250, v251
    v_cvt_pk_bf16_f32 v123, v252, v253
    v_cvt_pk_bf16_f32 v124, v132, v133
    v_cvt_pk_bf16_f32 v125, v134, v135
    v_cvt_pk_bf16_f32 v126, v136, v137
    v_cvt_pk_bf16_f32 v127, v138, v139
    v_cvt_pk_bf16_f32 v128, v140, v141
    v_cvt_pk_bf16_f32 v129, v142, v143
    v_cvt_pk_bf16_f32 v130, v144, v145
    v_cvt_pk_bf16_f32 v131, v146, v147
    s_waitcnt lgkmcnt(0)
    v_mfma_f32_16x16x32_bf16 v[148:151], v[100:103], v[180:183], v[164:167]
    v_mfma_f32_16x16x32_bf16 v[148:151], v[104:107], v[184:187], v[148:151]
    v_mfma_f32_16x16x32_bf16 v[152:155], v[108:111], v[180:183], v[168:171]
    v_mfma_f32_16x16x32_bf16 v[152:155], v[112:115], v[184:187], v[152:155]
    v_mfma_f32_16x16x32_bf16 v[156:159], v[116:119], v[180:183], v[172:175]
    v_mfma_f32_16x16x32_bf16 v[156:159], v[120:123], v[184:187], v[156:159]
    v_mfma_f32_16x16x32_bf16 v[160:163], v[124:127], v[180:183], v[176:179]
    v_mfma_f32_16x16x32_bf16 v[160:163], v[128:131], v[184:187], v[160:163]
    s_waitcnt vmcnt(4)
    ds_read_b128 v[180:183], v234 offset:2080
    ds_read_b128 v[184:187], v235 offset:2080
    ds_read_u8 v230, v237 offset:64
    ds_read_u8 v232, v237 offset:72
    s_lshr_b64 s[86:87], s[56:57], 2
    s_lshr_b64 s[36:37], s[56:57], 5
    s_or_b32 s36, s36, s86
    s_or_b32 s36, s36, s56
    s_cmp_lg_u64 s[84:85], 0
    s_cbranch_scc0 Lf_mid
    s_mul_i32 s66, s53, 800
    s_add_u32 s8, s8, s66
    s_addc_u32 s9, s9, 0
    s_mov_b32 s24, s8
    s_and_b32 s25, s9, 0xffff
    s_mov_b32 s26, 400
    s_mov_b32 s27, 0x20000
    s_movk_i32 s32, 400
    s_branch Ls_mid
L_fp:
    v_mfma_i32_16x16x64_i8 v[172:175], v[122:125], v[100:103], 0
    v_and_b32 v160, 0x800080, v100
    v_mul_u32_u24 v160, 0x7f, v160
    v_bitop3_b32 v131, v100, v160, v131 bitop3:0xbe
    v_and_b32 v161, 0x800080, v101
    v_mul_u32_u24 v161, 0x7f, v161
    v_bitop3_b32 v131, v101, v161, v131 bitop3:0xbe
    v_and_b32 v160, 0x800080, v102
    v_mul_u32_u24 v160, 0x7f, v160
    v_mov_b32_dpp v184, v172 row_shr:1 row_mask:0xf bank_mask:0xf bound_ctrl:0
    v_bitop3_b32 v131, v102, v160, v131 bitop3:0xbe
    s_nop 0
    v_add_u32_dpp v184, v184, v184 row_shr:1 row_mask:0xf bank_mask:0xf bound_ctrl:0
    v_and_b32 v161, 0x800080, v103
    s_nop 0
    v_add_u32_dpp v184, v184, v184 row_shr:2 row_mask:0xf bank_mask:0xf bound_ctrl:0
    v_mul_u32_u24 v161, 0x7f, v161
    s_nop 0
    v_add_u32_dpp v184, v184, v184 row_shr:4 row_mask:0xf bank_mask:0xf bound_ctrl:0
    v_bitop3_b32 v131, v103, v161, v131 bitop3:0xbe
    s_nop 0
    v_add_u32_dpp v184, v184, v184 row_shr:8 row_mask:0xf bank_mask:0xf bound_ctrl:0
    v_cmp_ne_u32 vcc, 0, v131
    v_readlane_b32 s68, v184, 6
    v_readlane_b32 s69, v173, 6
    v_readlane_b32 s70, v184, 15
    s_mov_b32 s94, 0
    s_cbranch_vccnz L_late
    s_add_u32 s66, s68, s69
    s_add_u32 s66, s66, s64
    s_add_u32 s67, s66, 15
    s_and_b32 s67, s67, -16
    s_add_u32 s55, s64, 16
    s_max_u32 s67, s67, s55
    s_sub_u32 s66, s67, s66
    v_mad_u32_u24 v184, v130, s66, v184
    s_sub_u32 s55, s64, 2048
    v_add_u32 v172, s55, v184
    v_add_u32 v173, s55, v184
    v_add_u32 v174, s55, v184
    v_add_u32 v175, s55, v184
    s_add_u32 s64, s64, s70
    s_add_u32 s64, s64, s66
    v_mfma_i32_16x16x64_i8 v[132:135], v[118:121], v[100:103], v[172:175]
    v_mfma_i32_16x16x64_i8 v[136:139], v[116:119], v[100:103], v[172:175]
    s_add_u32 s64, s64, 15
    s_and_b32 s64, s64, -16
    s_add_u32 s55, s67, 16
    s_max_u32 s64, s64, s55
    s_lshr_b32 s95, s67, 4
    s_bitset1_b64 s[56:57], s95
    s_lshr_b32 s95, s64, 4
    s_bitset1_b64 s[56:57], s95
    s_add_u32 s66, s52, 18512
    s_cmp_ge_u32 s64, s66
    ds_write_b8 v132, v126
    ds_write_b8_d16_hi v133, v126
    ds_write_b8 v134, v127
    ds_write_b8_d16_hi v135, v127
    ds_write_b8 v136, v128
    ds_write_b8_d16_hi v137, v128
    ds_write_b8 v138, v129
    ds_write_b8_d16_hi v139, v129
    s_cbranch_scc0 L_late
    s_mov_b32 s94, 1
    ds_read_u8 v148, v237 offset:0
    ds_read_u8 v149, v237 offset:8
    ds_read_u8 v150, v237 offset:16
    ds_read_u8 v151, v237 offset:24
    ds_read_u8 v152, v237 offset:32
    ds_read_u8 v153, v237 offset:40
    ds_read_u8 v154, v237 offset:48
    ds_read_u8 v155, v237 offset:56
    s_waitcnt lgkmcnt(0)
    s_add_u32 m0, s52, 0
    v_mov_b32 v230, v148
    v_mov_b32 v232, v149
    buffer_load_dwordx4 v[230:231], s[20:23], s35 idxen offen nt lds
    buffer_load_dwordx4 v[232:233], s[40:43], s35 idxen offen offset:1056 nt lds
    s_bitcmp0_b64 s[56:57], 2
    s_cbranch_scc1 L_noadve1
    s_add_u32 s35, s35, s31
    s_min_u32 s35, s35, 419404800
    s_sub_u32 s60, s60, 1
    s_bitcmp1_b32 s60, 0
    s_cselect_b32 s31, 25600, s51
L_noadve1:
    s_add_u32 m0, s52, 2080
    v_mov_b32 v230, v150
    v_mov_b32 v232, v151
    buffer_load_dwordx4 v[230:231], s[20:23], s35 idxen offen nt lds
    buffer_load_dwordx4 v[232:233], s[40:43], s35 idxen offen offset:1056 nt lds
    s_setpc_b64 s[62:63]
L_late:
    s_waitcnt vmcnt(0)
    s_setpc_b64 s[62:63]
L_swap:
    v_lshrrev_b32 v140, 3, v0
    v_and_b32 v141, 7, v0
    v_mul_u32_u24 v140, 20480, v140
    v_mul_u32_u24 v141, 20480, v141
    v_mov_b32 v143, 1
    s_mov_b64 exec, 1
    ds_add_rtn_u32 v143, v140, v143 offset:14864
    s_mov_b64 exec, -1
L_swap_poll:
    ds_read_b128 v[144:147], v140 offset:14848
    ds_read_b32 v142, v141 offset:14848
    v_and_b32 v248, 56, v0
    s_waitcnt lgkmcnt(0)
    v_cmp_le_i32 vcc, 0, v142
    v_cmp_gt_u32 s[86:87], v142, v144
    v_lshlrev_b32 v249, 1, v142
    v_readfirstlane_b32 s66, v143
    s_cbranch_vccnz L_swap_poll
    v_lshrrev_b64 v[246:247], v248, s[86:87]
    v_cmp_gt_i32 s[88:89], 0, v249
    v_and_b32 v246, 0xff, v246
    v_bcnt_u32_b32 v246, v246, 0
    v_cmp_eq_u32 vcc, s66, v246
    s_lshl_b32 s67, s54, 3
    s_ff1_i32_b64 s66, vcc
    s_cmp_lg_u64 s[88:89], 0
    s_cselect_b32 s66, s67, s66
    s_sub_u32 s95, s66, s67
    v_readlane_b32 s67, v146, s66
    v_readlane_b32 s55, v147, s66
    v_readlane_b32 s66, v145, s66
    s_mul_i32 s47, s95, 2560
    s_lshl_b32 s50, s95, 5
    s_mul_i32 s95, s95, 6400
    s_add_u32 s31, s31, s95
    s_sub_u32 s44, s66, s44
    v_add_u32 v237, s44, v237
    s_sub_u32 s46, s55, s46
    s_sub_u32 s46, s46, s44
    s_sub_u32 s67, s67, s66
    s_lshr_b32 s67, s67, 4
    s_add_u32 s67, s67, s49
    s_bitset1_b64 s[56:57], s67
    s_sub_u32 s55, s55, s66
    s_lshr_b32 s55, s55, 4
    s_add_u32 s55, s55, s49
    s_bitset1_b64 s[56:57], s55
    s_lshr_b64 s[86:87], s[56:57], 2
    s_lshr_b64 s[36:37], s[56:57], 5
    s_or_b32 s36, s36, s86
    s_or_b32 s36, s36, s56
    s_ashr_i32 s46, s46, 3
    v_mov_b32 v140, s46
    s_sub_u32 s46, 0, s46
    v_writelane_b32 v140, s46, 1
    ds_add_u32 v2, v140
    s_cmp_lg_u32 s61, 2
    s_cselect_b32 s45, 1, -1
    s_cbranch_scc1 L_swap_ret
    v_add_u32 v238, s47, v238
    v_add_u32 v239, s47, v239
    ds_read_u16 v224, v238 offset:0
    ds_read_u16 v225, v238 offset:8
    ds_read_u16 v226, v238 offset:64
    ds_read_u16 v227, v238 offset:72
L_swap_ret:
    s_setpc_b64 s[62:63]
L_t23:
    s_cmp_eq_u32 s94, 0
    s_cbranch_scc1 L_skip23
    s_bitcmp0_b64 s[56:57], 3
    s_cbranch_scc1 L_noadve2
    s_add_u32 s35, s35, s31
    s_min_u32 s35, s35, 419404800
    s_sub_u32 s60, s60, 1
    s_bitcmp1_b32 s60, 0
    s_cselect_b32 s31, 25600, s51
L_noadve2:
    s_add_u32 m0, s52, 4160
    v_mov_b32 v230, v152
    v_mov_b32 v232, v153
    buffer_load_dwordx4 v[230:231], s[20:23], s35 idxen offen nt lds
    buffer_load_dwordx4 v[232:233], s[40:43], s35 idxen offen offset:1056 nt lds
    s_bitcmp0_b64 s[56:57], 4
    s_cbranch_scc1 L_noadve3
    s_add_u32 s35, s35, s31
    s_min_u32 s35, s35, 419404800
    s_sub_u32 s60, s60, 1
    s_bitcmp1_b32 s60, 0
    s_cselect_b32 s31, 25600, s51
L_noadve3:
    s_add_u32 m0, s52, 6240
    v_mov_b32 v230, v154
    v_mov_b32 v232, v155
    buffer_load_dwordx4 v[230:231], s[20:23], s35 idxen offen nt lds
    buffer_load_dwordx4 v[232:233], s[40:43], s35 idxen offen offset:1056 nt lds
    s_setpc_b64 s[62:63]
L_skip23:
    s_waitcnt vmcnt(0)
    s_setpc_b64 s[62:63]
Lf_loop:
    ds_read_u8 v230, v237 offset:64
    ds_read_u8 v232, v237 offset:72
    v_mfma_f32_16x16x32_bf16 v[208:211], v[136:139], v[200:203], v[208:211]
Lf_mid:
    s_bitcmp1_b32 s36, 0
    s_cbranch_scc1 Lf_ev0
Lf_evd0:
    ds_add_rtn_u32 v1, v2, v3
    v_exp_f32 v132, v148
    v_exp_f32 v133, v149
    v_exp_f32 v134, v150
    v_exp_f32 v135, v151
    v_exp_f32 v136, v152
    v_exp_f32 v137, v153
    v_mfma_f32_4x4x4_16b_bf16 v[132:135], v[228:229], v[228:229], v[132:135]
    v_cvt_pk_bf16_f32 v208, v208, v209
    v_cvt_pk_bf16_f32 v209, v210, v211
    s_waitcnt lgkmcnt(2)
    v_mfma_f32_16x16x32_bf16 v[148:151], v[100:103], v[180:183], v[164:167]
    v_exp_f32 v138, v154
    v_mfma_f32_4x4x4_16b_bf16 v[212:215], v[208:209], v[188:189], v[212:215] cbsz:4 abid:0
    ds_read_b64_tr_b16 v[188:189], v236 offset:0
    v_exp_f32 v139, v155
    v_mfma_f32_16x16x32_bf16 v[152:155], v[108:111], v[180:183], v[168:171]
    v_exp_f32 v140, v156
    v_mfma_f32_4x4x4_16b_bf16 v[212:215], v[208:209], v[190:191], v[212:215] cbsz:4 abid:4
    ds_read_b64_tr_b16 v[190:191], v236 offset:512
    v_mfma_f32_4x4x4_16b_bf16 v[136:139], v[228:229], v[228:229], v[136:139]
    v_rcp_f32 v132, v132
    v_mfma_f32_4x4x4_16b_bf16 v[212:215], v[208:209], v[192:193], v[212:215] cbsz:4 abid:8
    ds_read_b64_tr_b16 v[192:193], v236 offset:1056
    v_exp_f32 v141, v157
    v_mfma_f32_16x16x32_bf16 v[148:151], v[104:107], v[184:187], v[148:151]
    v_rcp_f32 v133, v133
    v_mfma_f32_4x4x4_16b_bf16 v[212:215], v[208:209], v[194:195], v[212:215] cbsz:4 abid:12
    ds_read_b64_tr_b16 v[194:195], v236 offset:1568
    v_exp_f32 v142, v158
    v_mfma_f32_16x16x32_bf16 v[152:155], v[112:115], v[184:187], v[152:155]
    v_rcp_f32 v134, v134
    v_exp_f32 v143, v159
    v_rcp_f32 v135, v135
    v_cvt_pk_bf16_f32 v132, v132, v133
    v_mfma_f32_4x4x4_16b_bf16 v[140:143], v[228:229], v[228:229], v[140:143]
    v_exp_f32 v144, v160
    v_mfma_f32_16x16x32_bf16 v[156:159], v[116:119], v[180:183], v[172:175]
    v_rcp_f32 v136, v136
    v_cvt_pk_bf16_f32 v133, v134, v135
    s_add_u32 m0, s52, 0
    s_waitcnt lgkmcnt(0)
    buffer_load_dwordx4 v[230:231], s[20:23], s35 idxen offen nt lds
    v_exp_f32 v145, v161
    buffer_load_dwordx4 v[232:233], s[40:43], s35 idxen offen offset:1056 nt lds
    v_rcp_f32 v137, v137
    v_exp_f32 v146, v162
    v_rcp_f32 v138, v138
    v_cvt_pk_bf16_f32 v134, v136, v137
    v_exp_f32 v147, v163
    v_mfma_f32_16x16x32_bf16 v[160:163], v[124:127], v[180:183], v[176:179]
    v_readfirstlane_b32 s66, v1
    s_setprio 0
    s_cmp_gt_i32 s66, 0
    s_cbranch_scc0 Lf_lo0
    s_setprio 1
Lf_lo0:
    v_rcp_f32 v139, v139
    v_mfma_f32_4x4x4_16b_bf16 v[144:147], v[228:229], v[228:229], v[144:147]
    v_mfma_f32_16x16x32_bf16 v[156:159], v[120:123], v[184:187], v[156:159]
    v_rcp_f32 v140, v140
    v_mfma_f32_16x16x32_bf16 v[160:163], v[128:131], v[184:187], v[160:163]
    v_rcp_f32 v141, v141
    v_cvt_pk_bf16_f32 v135, v138, v139
    s_waitcnt vmcnt(4)
    ds_read_b128 v[180:183], v234 offset:4160
    ds_read_b128 v[184:187], v235 offset:4160
    v_rcp_f32 v142, v142
    v_cvt_pk_bf16_f32 v136, v140, v141
    v_mfma_f32_16x16x32_bf16 v[208:211], v[132:135], v[196:199], v[204:207]
    v_rcp_f32 v143, v143
    v_rcp_f32 v144, v144
    v_cvt_pk_bf16_f32 v137, v142, v143
    v_rcp_f32 v145, v145
    v_rcp_f32 v146, v146
    v_rcp_f32 v147, v147
    v_cvt_pk_bf16_f32 v138, v144, v145
    v_cvt_pk_bf16_f32 v139, v146, v147
    ds_read_u8 v230, v237 offset:80
    ds_read_u8 v232, v237 offset:88
    v_mfma_f32_16x16x32_bf16 v[208:211], v[136:139], v[200:203], v[208:211]
    s_bitcmp1_b32 s36, 1
    s_cbranch_scc1 Lf_ev1
Lf_evd1:
    v_exp_f32 v132, v148
    v_exp_f32 v133, v149
    v_exp_f32 v134, v150
    v_exp_f32 v135, v151
    v_exp_f32 v136, v152
    v_exp_f32 v137, v153
    v_mfma_f32_4x4x4_16b_bf16 v[132:135], v[228:229], v[228:229], v[132:135]
    v_cvt_pk_bf16_f32 v208, v208, v209
    v_cvt_pk_bf16_f32 v209, v210, v211
    s_waitcnt lgkmcnt(2)
    v_mfma_f32_16x16x32_bf16 v[148:151], v[100:103], v[180:183], v[164:167]
    v_exp_f32 v138, v154
    v_mfma_f32_4x4x4_16b_bf16 v[212:215], v[208:209], v[188:189], v[212:215] cbsz:4 abid:0
    ds_read_b64_tr_b16 v[188:189], v236 offset:2080
    v_exp_f32 v139, v155
    v_mfma_f32_16x16x32_bf16 v[152:155], v[108:111], v[180:183], v[168:171]
    v_exp_f32 v140, v156
    v_mfma_f32_4x4x4_16b_bf16 v[212:215], v[208:209], v[190:191], v[212:215] cbsz:4 abid:4
    ds_read_b64_tr_b16 v[190:191], v236 offset:2592
    v_mfma_f32_4x4x4_16b_bf16 v[136:139], v[228:229], v[228:229], v[136:139]
    v_rcp_f32 v132, v132
    v_mfma_f32_4x4x4_16b_bf16 v[212:215], v[208:209], v[192:193], v[212:215] cbsz:4 abid:8
    ds_read_b64_tr_b16 v[192:193], v236 offset:3136
    v_exp_f32 v141, v157
    v_mfma_f32_16x16x32_bf16 v[148:151], v[104:107], v[184:187], v[148:151]
    v_rcp_f32 v133, v133
    v_mfma_f32_4x4x4_16b_bf16 v[212:215], v[208:209], v[194:195], v[212:215] cbsz:4 abid:12
    ds_read_b64_tr_b16 v[194:195], v236 offset:3648
    v_exp_f32 v142, v158
    v_mfma_f32_16x16x32_bf16 v[152:155], v[112:115], v[184:187], v[152:155]
    v_rcp_f32 v134, v134
    v_exp_f32 v143, v159
    v_rcp_f32 v135, v135
    v_cvt_pk_bf16_f32 v132, v132, v133
    v_mfma_f32_4x4x4_16b_bf16 v[140:143], v[228:229], v[228:229], v[140:143]
    v_exp_f32 v144, v160
    v_mfma_f32_16x16x32_bf16 v[156:159], v[116:119], v[180:183], v[172:175]
    v_rcp_f32 v136, v136
    v_cvt_pk_bf16_f32 v133, v134, v135
    s_add_u32 m0, s52, 2080
    s_waitcnt lgkmcnt(0)
    buffer_load_dwordx4 v[230:231], s[20:23], s35 idxen offen nt lds
    v_exp_f32 v145, v161
    buffer_load_dwordx4 v[232:233], s[40:43], s35 idxen offen offset:1056 nt lds
    v_rcp_f32 v137, v137
    v_exp_f32 v146, v162
    v_rcp_f32 v138, v138
    v_cvt_pk_bf16_f32 v134, v136, v137
    v_exp_f32 v147, v163
    v_mfma_f32_16x16x32_bf16 v[160:163], v[124:127], v[180:183], v[176:179]
    v_rcp_f32 v139, v139
    v_mfma_f32_4x4x4_16b_bf16 v[144:147], v[228:229], v[228:229], v[144:147]
    v_mfma_f32_16x16x32_bf16 v[156:159], v[120:123], v[184:187], v[156:159]
    v_rcp_f32 v140, v140
    v_mfma_f32_16x16x32_bf16 v[160:163], v[128:131], v[184:187], v[160:163]
    v_rcp_f32 v141, v141
    v_cvt_pk_bf16_f32 v135, v138, v139
    s_waitcnt vmcnt(4)
    ds_read_b128 v[180:183], v234 offset:6240
    ds_read_b128 v[184:187], v235 offset:6240
    v_rcp_f32 v142, v142
    v_cvt_pk_bf16_f32 v136, v140, v141
    v_mfma_f32_16x16x32_bf16 v[208:211], v[132:135], v[196:199], v[204:207]
    v_rcp_f32 v143, v143
    v_rcp_f32 v144, v144
    v_cvt_pk_bf16_f32 v137, v142, v143
    v_rcp_f32 v145, v145
    v_rcp_f32 v146, v146
    v_rcp_f32 v147, v147
    v_cvt_pk_bf16_f32 v138, v144, v145
    v_cvt_pk_bf16_f32 v139, v146, v147
    ds_read_u8 v230, v237 offset:96
    ds_read_u8 v232, v237 offset:104
    v_mfma_f32_16x16x32_bf16 v[208:211], v[136:139], v[200:203], v[208:211]
    s_bitcmp1_b32 s36, 2
    s_cbranch_scc1 Lf_ev2
Lf_evd2:
    v_exp_f32 v132, v148
    v_exp_f32 v133, v149
    v_exp_f32 v134, v150
    v_exp_f32 v135, v151
    v_exp_f32 v136, v152
    v_exp_f32 v137, v153
    v_mfma_f32_4x4x4_16b_bf16 v[132:135], v[228:229], v[228:229], v[132:135]
    v_cvt_pk_bf16_f32 v208, v208, v209
    v_cvt_pk_bf16_f32 v209, v210, v211
    s_waitcnt lgkmcnt(2)
    v_mfma_f32_16x16x32_bf16 v[148:151], v[100:103], v[180:183], v[164:167]
    v_exp_f32 v138, v154
    v_mfma_f32_4x4x4_16b_bf16 v[212:215], v[208:209], v[188:189], v[212:215] cbsz:4 abid:0
    ds_read_b64_tr_b16 v[188:189], v236 offset:4160
    v_exp_f32 v139, v155
    v_mfma_f32_16x16x32_bf16 v[152:155], v[108:111], v[180:183], v[168:171]
    v_exp_f32 v140, v156
    v_mfma_f32_4x4x4_16b_bf16 v[212:215], v[208:209], v[190:191], v[212:215] cbsz:4 abid:4
    ds_read_b64_tr_b16 v[190:191], v236 offset:4672
    v_mfma_f32_4x4x4_16b_bf16 v[136:139], v[228:229], v[228:229], v[136:139]
    v_rcp_f32 v132, v132
    v_mfma_f32_4x4x4_16b_bf16 v[212:215], v[208:209], v[192:193], v[212:215] cbsz:4 abid:8
    ds_read_b64_tr_b16 v[192:193], v236 offset:5216
    v_exp_f32 v141, v157
    v_mfma_f32_16x16x32_bf16 v[148:151], v[104:107], v[184:187], v[148:151]
    v_rcp_f32 v133, v133
    v_mfma_f32_4x4x4_16b_bf16 v[212:215], v[208:209], v[194:195], v[212:215] cbsz:4 abid:12
    ds_read_b64_tr_b16 v[194:195], v236 offset:5728
    v_exp_f32 v142, v158
    v_mfma_f32_16x16x32_bf16 v[152:155], v[112:115], v[184:187], v[152:155]
    v_rcp_f32 v134, v134
    v_exp_f32 v143, v159
    v_rcp_f32 v135, v135
    v_cvt_pk_bf16_f32 v132, v132, v133
    v_mfma_f32_4x4x4_16b_bf16 v[140:143], v[228:229], v[228:229], v[140:143]
    v_exp_f32 v144, v160
    v_mfma_f32_16x16x32_bf16 v[156:159], v[116:119], v[180:183], v[172:175]
    v_rcp_f32 v136, v136
    v_cvt_pk_bf16_f32 v133, v134, v135
    s_add_u32 m0, s52, 4160
    s_waitcnt lgkmcnt(0)
    buffer_load_dwordx4 v[230:231], s[20:23], s35 idxen offen nt lds
    v_exp_f32 v145, v161
    buffer_load_dwordx4 v[232:233], s[40:43], s35 idxen offen offset:1056 nt lds
    v_rcp_f32 v137, v137
    v_exp_f32 v146, v162
    v_rcp_f32 v138, v138
    v_cvt_pk_bf16_f32 v134, v136, v137
    v_exp_f32 v147, v163
    v_mfma_f32_16x16x32_bf16 v[160:163], v[124:127], v[180:183], v[176:179]
    v_rcp_f32 v139, v139
    v_mfma_f32_4x4x4_16b_bf16 v[144:147], v[228:229], v[228:229], v[144:147]
    v_mfma_f32_16x16x32_bf16 v[156:159], v[120:123], v[184:187], v[156:159]
    v_rcp_f32 v140, v140
    v_mfma_f32_16x16x32_bf16 v[160:163], v[128:131], v[184:187], v[160:163]
    v_rcp_f32 v141, v141
    v_cvt_pk_bf16_f32 v135, v138, v139
    s_waitcnt vmcnt(4)
    ds_read_b128 v[180:183], v234 offset:0
    ds_read_b128 v[184:187], v235 offset:0
    v_rcp_f32 v142, v142
    v_cvt_pk_bf16_f32 v136, v140, v141
    v_mfma_f32_16x16x32_bf16 v[208:211], v[132:135], v[196:199], v[204:207]
    v_rcp_f32 v143, v143
    v_rcp_f32 v144, v144
    v_cvt_pk_bf16_f32 v137, v142, v143
    v_rcp_f32 v145, v145
    v_rcp_f32 v146, v146
    v_rcp_f32 v147, v147
    v_cvt_pk_bf16_f32 v138, v144, v145
    v_cvt_pk_bf16_f32 v139, v146, v147
    ds_read_u8 v230, v237 offset:112
    ds_read_u8 v232, v237 offset:120
    v_mfma_f32_16x16x32_bf16 v[208:211], v[136:139], v[200:203], v[208:211]
    s_bitcmp1_b32 s36, 3
    s_cbranch_scc1 Lf_ev3
Lf_evd3:
    v_exp_f32 v132, v148
    v_exp_f32 v133, v149
    v_exp_f32 v134, v150
    v_exp_f32 v135, v151
    v_exp_f32 v136, v152
    v_exp_f32 v137, v153
    v_mfma_f32_4x4x4_16b_bf16 v[132:135], v[228:229], v[228:229], v[132:135]
    v_cvt_pk_bf16_f32 v208, v208, v209
    v_cvt_pk_bf16_f32 v209, v210, v211
    s_waitcnt lgkmcnt(2)
    v_mfma_f32_16x16x32_bf16 v[148:151], v[100:103], v[180:183], v[164:167]
    v_exp_f32 v138, v154
    v_mfma_f32_4x4x4_16b_bf16 v[212:215], v[208:209], v[188:189], v[212:215] cbsz:4 abid:0
    ds_read_b64_tr_b16 v[188:189], v236 offset:6240
    v_exp_f32 v139, v155
    v_mfma_f32_16x16x32_bf16 v[152:155], v[108:111], v[180:183], v[168:171]
    v_exp_f32 v140, v156
    v_mfma_f32_4x4x4_16b_bf16 v[212:215], v[208:209], v[190:191], v[212:215] cbsz:4 abid:4
    ds_read_b64_tr_b16 v[190:191], v236 offset:6752
    v_mfma_f32_4x4x4_16b_bf16 v[136:139], v[228:229], v[228:229], v[136:139]
    v_rcp_f32 v132, v132
    v_mfma_f32_4x4x4_16b_bf16 v[212:215], v[208:209], v[192:193], v[212:215] cbsz:4 abid:8
    ds_read_b64_tr_b16 v[192:193], v236 offset:7296
    v_exp_f32 v141, v157
    v_mfma_f32_16x16x32_bf16 v[148:151], v[104:107], v[184:187], v[148:151]
    v_rcp_f32 v133, v133
    v_mfma_f32_4x4x4_16b_bf16 v[212:215], v[208:209], v[194:195], v[212:215] cbsz:4 abid:12
    ds_read_b64_tr_b16 v[194:195], v236 offset:7808
    v_exp_f32 v142, v158
    v_mfma_f32_16x16x32_bf16 v[152:155], v[112:115], v[184:187], v[152:155]
    v_rcp_f32 v134, v134
    v_exp_f32 v143, v159
    v_rcp_f32 v135, v135
    v_cvt_pk_bf16_f32 v132, v132, v133
    v_mfma_f32_4x4x4_16b_bf16 v[140:143], v[228:229], v[228:229], v[140:143]
    v_exp_f32 v144, v160
    v_mfma_f32_16x16x32_bf16 v[156:159], v[116:119], v[180:183], v[172:175]
    v_rcp_f32 v136, v136
    v_cvt_pk_bf16_f32 v133, v134, v135
    s_add_u32 m0, s52, 6240
    s_waitcnt lgkmcnt(0)
    buffer_load_dwordx4 v[230:231], s[20:23], s35 idxen offen nt lds
    v_exp_f32 v145, v161
    buffer_load_dwordx4 v[232:233], s[40:43], s35 idxen offen offset:1056 nt lds
    v_rcp_f32 v137, v137
    v_exp_f32 v146, v162
    v_rcp_f32 v138, v138
    v_cvt_pk_bf16_f32 v134, v136, v137
    v_exp_f32 v147, v163
    v_mfma_f32_16x16x32_bf16 v[160:163], v[124:127], v[180:183], v[176:179]
    v_rcp_f32 v139, v139
    v_mfma_f32_4x4x4_16b_bf16 v[144:147], v[228:229], v[228:229], v[144:147]
    v_mfma_f32_16x16x32_bf16 v[156:159], v[120:123], v[184:187], v[156:159]
    v_rcp_f32 v140, v140
    v_mfma_f32_16x16x32_bf16 v[160:163], v[128:131], v[184:187], v[160:163]
    v_rcp_f32 v141, v141
    v_cvt_pk_bf16_f32 v135, v138, v139
    s_waitcnt vmcnt(4)
    ds_read_b128 v[180:183], v234 offset:2080
    ds_read_b128 v[184:187], v235 offset:2080
    v_rcp_f32 v142, v142
    v_cvt_pk_bf16_f32 v136, v140, v141
    v_mfma_f32_16x16x32_bf16 v[208:211], v[132:135], v[196:199], v[204:207]
    v_rcp_f32 v143, v143
    s_lshr_b64 s[56:57], s[56:57], 4
    s_lshl_b64 s[86:87], s[58:59], 60
    s_or_b64 s[56:57], s[56:57], s[86:87]
    s_lshr_b64 s[58:59], s[58:59], 4
    s_lshr_b64 s[86:87], s[56:57], 2
    s_lshr_b64 s[36:37], s[56:57], 5
    s_or_b32 s36, s36, s86
    s_or_b32 s36, s36, s56
    v_add_u32 v237, 64, v237
    v_rcp_f32 v144, v144
    v_cvt_pk_bf16_f32 v137, v142, v143
    v_rcp_f32 v145, v145
    v_rcp_f32 v146, v146
    v_rcp_f32 v147, v147
    v_cvt_pk_bf16_f32 v138, v144, v145
    v_cvt_pk_bf16_f32 v139, v146, v147
    s_branch Lf_loop
Lf_ev0:
    s_bitcmp0_b64 s[56:57], 0
    s_cbranch_scc1 Lf_nf0
    v_cvt_pk_bf16_f32 v246, v212, v212
    v_mov_b32 v212, 0
    ds_write_b16 v240, v246
    s_sub_u32 s48, s48, 1
    s_cselect_b32 s66, s47, 0
    s_cselect_b32 s48, 64, s48
    s_add_u32 s66, s66, 128
    v_add_u32 v240, s66, v240
Lf_nf0:
    s_bitcmp0_b64 s[56:57], 5
    s_cbranch_scc1 Lf_na0
    s_cmp_lg_u32 s60, 2
    s_cbranch_scc1 Lf_ns0
    s_mov_b32 s49, 5
    s_call_b64 s[62:63], L_swap
    ds_read_u8 v230, v237 offset:64
    ds_read_u8 v232, v237 offset:72
    s_add_u32 s35, s35, s31
    s_min_u32 s35, s35, 419404800
    s_sub_u32 s60, s60, 1
    s_bitcmp1_b32 s60, 0
    s_cselect_b32 s31, 25600, s51
    s_bitcmp0_b64 s[56:57], 2
    s_cbranch_scc1 Lf_evd0
    s_waitcnt lgkmcnt(0)
    s_branch Lf_e10
Lf_ns0:
    s_add_u32 s35, s35, s31
    s_min_u32 s35, s35, 419404800
    s_sub_u32 s60, s60, 1
    s_bitcmp1_b32 s60, 0
    s_cselect_b32 s31, 25600, s51
Lf_na0:
    s_bitcmp0_b64 s[56:57], 2
    s_cbranch_scc1 Lf_evd0
Lf_e10:
    s_sub_u32 s61, s61, 1
    s_cbranch_scc1 Lf_last0
    s_cmp_lg_u32 s61, s45
    s_cbranch_scc1 Lf_nw0
    v_add_u32 v238, s47, v238
    v_add_u32 v239, s47, v239
    ds_read_u16 v224, v238 offset:0
    ds_read_u16 v225, v238 offset:8
    ds_read_u16 v226, v238 offset:64
    ds_read_u16 v227, v238 offset:72
    s_waitcnt lgkmcnt(0)
Lf_nw0:
    v_mul_u32_u24 v216, v224, v241
    v_mul_u32_u24 v217, v224, v242
    v_mul_u32_u24 v218, v225, v241
    v_mul_u32_u24 v219, v225, v242
    v_mul_u32_u24 v220, v226, v241
    v_mul_u32_u24 v221, v226, v242
    v_mul_u32_u24 v222, v227, v241
    v_mul_u32_u24 v223, v227, v242
    v_add_u32 v238, 128, v238
    ds_read_b128 v[164:167], v239
    v_mfma_f32_4x4x4_16b_bf16 v[132:135], v[216:217], v[68:69], v[4:7]
    ds_read_b128 v[168:171], v239 offset:64
    ds_read_b128 v[172:175], v239 offset:128
    v_mfma_f32_4x4x4_16b_bf16 v[136:139], v[218:219], v[70:71], v[8:11]
    ds_read_b128 v[176:179], v239 offset:192
    ds_read_u16 v224, v238
    v_mfma_f32_4x4x4_16b_bf16 v[140:143], v[220:221], v[72:73], v[12:15]
    ds_read_u16 v225, v238 offset:8
    ds_read_u16 v226, v238 offset:64
    v_mfma_f32_4x4x4_16b_bf16 v[144:147], v[222:223], v[74:75], v[16:19]
    ds_read_u16 v227, v238 offset:72
    v_add_u32 v239, 272, v239
    v_mfma_f32_4x4x4_16b_bf16 v[246:249], v[216:217], v[76:77], v[20:23]
    v_cvt_pk_bf16_f32 v100, v132, v133
    v_cvt_pk_bf16_f32 v101, v134, v135
    v_mfma_f32_4x4x4_16b_bf16 v[250:253], v[218:219], v[78:79], v[24:27]
    v_cvt_pk_bf16_f32 v102, v136, v137
    v_cvt_pk_bf16_f32 v103, v138, v139
    v_mfma_f32_4x4x4_16b_bf16 v[132:135], v[220:221], v[80:81], v[28:31]
    v_cvt_pk_bf16_f32 v104, v140, v141
    v_cvt_pk_bf16_f32 v105, v142, v143
    v_mfma_f32_4x4x4_16b_bf16 v[136:139], v[222:223], v[82:83], v[32:35]
    v_cvt_pk_bf16_f32 v106, v144, v145
    v_cvt_pk_bf16_f32 v107, v146, v147
    v_mfma_f32_4x4x4_16b_bf16 v[140:143], v[216:217], v[84:85], v[36:39]
    v_cvt_pk_bf16_f32 v108, v246, v247
    v_cvt_pk_bf16_f32 v109, v248, v249
    v_mfma_f32_4x4x4_16b_bf16 v[144:147], v[218:219], v[86:87], v[40:43]
    v_cvt_pk_bf16_f32 v110, v250, v251
    v_cvt_pk_bf16_f32 v111, v252, v253
    v_mfma_f32_4x4x4_16b_bf16 v[246:249], v[220:221], v[88:89], v[44:47]
    v_cvt_pk_bf16_f32 v112, v132, v133
    v_cvt_pk_bf16_f32 v113, v134, v135
    v_mfma_f32_4x4x4_16b_bf16 v[250:253], v[222:223], v[90:91], v[48:51]
    v_cvt_pk_bf16_f32 v114, v136, v137
    v_cvt_pk_bf16_f32 v115, v138, v139
    v_mfma_f32_4x4x4_16b_bf16 v[132:135], v[216:217], v[92:93], v[52:55]
    v_cvt_pk_bf16_f32 v116, v140, v141
    v_cvt_pk_bf16_f32 v117, v142, v143
    v_mfma_f32_4x4x4_16b_bf16 v[136:139], v[218:219], v[94:95], v[56:59]
    v_cvt_pk_bf16_f32 v118, v144, v145
    v_cvt_pk_bf16_f32 v119, v146, v147
    v_mfma_f32_4x4x4_16b_bf16 v[140:143], v[220:221], v[96:97], v[60:63]
    v_cvt_pk_bf16_f32 v120, v246, v247
    v_cvt_pk_bf16_f32 v121, v248, v249
    v_mfma_f32_4x4x4_16b_bf16 v[144:147], v[222:223], v[98:99], v[64:67]
    v_cvt_pk_bf16_f32 v122, v250, v251
    v_cvt_pk_bf16_f32 v123, v252, v253
    v_cvt_pk_bf16_f32 v124, v132, v133
    v_cvt_pk_bf16_f32 v125, v134, v135
    v_cvt_pk_bf16_f32 v126, v136, v137
    v_cvt_pk_bf16_f32 v127, v138, v139
    v_cvt_pk_bf16_f32 v128, v140, v141
    v_cvt_pk_bf16_f32 v129, v142, v143
    v_cvt_pk_bf16_f32 v130, v144, v145
    v_cvt_pk_bf16_f32 v131, v146, v147
    s_waitcnt lgkmcnt(0)
    s_branch Lf_evd0
Lf_ev1:
    s_bitcmp0_b64 s[56:57], 1
    s_cbranch_scc1 Lf_nf1
    v_cvt_pk_bf16_f32 v246, v212, v212
    v_mov_b32 v212, 0
    ds_write_b16 v240, v246
    s_sub_u32 s48, s48, 1
    s_cselect_b32 s66, s47, 0
    s_cselect_b32 s48, 64, s48
    s_add_u32 s66, s66, 128
    v_add_u32 v240, s66, v240
Lf_nf1:
    s_bitcmp0_b64 s[56:57], 6
    s_cbranch_scc1 Lf_na1
    s_cmp_lg_u32 s60, 2
    s_cbranch_scc1 Lf_ns1
    s_mov_b32 s49, 6
    s_call_b64 s[62:63], L_swap
    ds_read_u8 v230, v237 offset:80
    ds_read_u8 v232, v237 offset:88
    s_add_u32 s35, s35, s31
    s_min_u32 s35, s35, 419404800
    s_sub_u32 s60, s60, 1
    s_bitcmp1_b32 s60, 0
    s_cselect_b32 s31, 25600, s51
    s_bitcmp0_b64 s[56:57], 3
    s_cbranch_scc1 Lf_evd1
    s_waitcnt lgkmcnt(0)
    s_branch Lf_e11
Lf_ns1:
    s_add_u32 s35, s35, s31
    s_min_u32 s35, s35, 419404800
    s_sub_u32 s60, s60, 1
    s_bitcmp1_b32 s60, 0
    s_cselect_b32 s31, 25600, s51
Lf_na1:
    s_bitcmp0_b64 s[56:57], 3
    s_cbranch_scc1 Lf_evd1
Lf_e11:
    s_sub_u32 s61, s61, 1
    s_cbranch_scc1 Lf_last1
    s_cmp_lg_u32 s61, s45
    s_cbranch_scc1 Lf_nw1
    v_add_u32 v238, s47, v238
    v_add_u32 v239, s47, v239
    ds_read_u16 v224, v238 offset:0
    ds_read_u16 v225, v238 offset:8
    ds_read_u16 v226, v238 offset:64
    ds_read_u16 v227, v238 offset:72
    s_waitcnt lgkmcnt(0)
Lf_nw1:
    v_mul_u32_u24 v216, v224, v241
    v_mul_u32_u24 v217, v224, v242
    v_mul_u32_u24 v218, v225, v241
    v_mul_u32_u24 v219, v225, v242
    v_mul_u32_u24 v220, v226, v241
    v_mul_u32_u24 v221, v226, v242
    v_mul_u32_u24 v222, v227, v241
    v_mul_u32_u24 v223, v227, v242
    v_add_u32 v238, 128, v238
    ds_read_b128 v[164:167], v239
    v_mfma_f32_4x4x4_16b_bf16 v[132:135], v[216:217], v[68:69], v[4:7]
    ds_read_b128 v[168:171], v239 offset:64
    ds_read_b128 v[172:175], v239 offset:128
    v_mfma_f32_4x4x4_16b_bf16 v[136:139], v[218:219], v[70:71], v[8:11]
    ds_read_b128 v[176:179], v239 offset:192
    ds_read_u16 v224, v238
    v_mfma_f32_4x4x4_16b_bf16 v[140:143], v[220:221], v[72:73], v[12:15]
    ds_read_u16 v225, v238 offset:8
    ds_read_u16 v226, v238 offset:64
    v_mfma_f32_4x4x4_16b_bf16 v[144:147], v[222:223], v[74:75], v[16:19]
    ds_read_u16 v227, v238 offset:72
    v_add_u32 v239, 272, v239
    v_mfma_f32_4x4x4_16b_bf16 v[246:249], v[216:217], v[76:77], v[20:23]
    v_cvt_pk_bf16_f32 v100, v132, v133
    v_cvt_pk_bf16_f32 v101, v134, v135
    v_mfma_f32_4x4x4_16b_bf16 v[250:253], v[218:219], v[78:79], v[24:27]
    v_cvt_pk_bf16_f32 v102, v136, v137
    v_cvt_pk_bf16_f32 v103, v138, v139
    v_mfma_f32_4x4x4_16b_bf16 v[132:135], v[220:221], v[80:81], v[28:31]
    v_cvt_pk_bf16_f32 v104, v140, v141
    v_cvt_pk_bf16_f32 v105, v142, v143
    v_mfma_f32_4x4x4_16b_bf16 v[136:139], v[222:223], v[82:83], v[32:35]
    v_cvt_pk_bf16_f32 v106, v144, v145
    v_cvt_pk_bf16_f32 v107, v146, v147
    v_mfma_f32_4x4x4_16b_bf16 v[140:143], v[216:217], v[84:85], v[36:39]
    v_cvt_pk_bf16_f32 v108, v246, v247
    v_cvt_pk_bf16_f32 v109, v248, v249
    v_mfma_f32_4x4x4_16b_bf16 v[144:147], v[218:219], v[86:87], v[40:43]
    v_cvt_pk_bf16_f32 v110, v250, v251
    v_cvt_pk_bf16_f32 v111, v252, v253
    v_mfma_f32_4x4x4_16b_bf16 v[246:249], v[220:221], v[88:89], v[44:47]
    v_cvt_pk_bf16_f32 v112, v132, v133
    v_cvt_pk_bf16_f32 v113, v134, v135
    v_mfma_f32_4x4x4_16b_bf16 v[250:253], v[222:223], v[90:91], v[48:51]
    v_cvt_pk_bf16_f32 v114, v136, v137
    v_cvt_pk_bf16_f32 v115, v138, v139
    v_mfma_f32_4x4x4_16b_bf16 v[132:135], v[216:217], v[92:93], v[52:55]
    v_cvt_pk_bf16_f32 v116, v140, v141
    v_cvt_pk_bf16_f32 v117, v142, v143
    v_mfma_f32_4x4x4_16b_bf16 v[136:139], v[218:219], v[94:95], v[56:59]
    v_cvt_pk_bf16_f32 v118, v144, v145
    v_cvt_pk_bf16_f32 v119, v146, v147
    v_mfma_f32_4x4x4_16b_bf16 v[140:143], v[220:221], v[96:97], v[60:63]
    v_cvt_pk_bf16_f32 v120, v246, v247
    v_cvt_pk_bf16_f32 v121, v248, v249
    v_mfma_f32_4x4x4_16b_bf16 v[144:147], v[222:223], v[98:99], v[64:67]
    v_cvt_pk_bf16_f32 v122, v250, v251
    v_cvt_pk_bf16_f32 v123, v252, v253
    v_cvt_pk_bf16_f32 v124, v132, v133
    v_cvt_pk_bf16_f32 v125, v134, v135
    v_cvt_pk_bf16_f32 v126, v136, v137
    v_cvt_pk_bf16_f32 v127, v138, v139
    v_cvt_pk_bf16_f32 v128, v140, v141
    v_cvt_pk_bf16_f32 v129, v142, v143
    v_cvt_pk_bf16_f32 v130, v144, v145
    v_cvt_pk_bf16_f32 v131, v146, v147
    s_waitcnt lgkmcnt(0)
    s_branch Lf_evd1
Lf_ev2:
    s_bitcmp0_b64 s[56:57], 2
    s_cbranch_scc1 Lf_nf2
    v_cvt_pk_bf16_f32 v246, v212, v212
    v_mov_b32 v212, 0
    ds_write_b16 v240, v246
    s_sub_u32 s48, s48, 1
    s_cselect_b32 s66, s47, 0
    s_cselect_b32 s48, 64, s48
    s_add_u32 s66, s66, 128
    v_add_u32 v240, s66, v240
Lf_nf2:
    s_bitcmp0_b64 s[56:57], 7
    s_cbranch_scc1 Lf_na2
    s_cmp_lg_u32 s60, 2
    s_cbranch_scc1 Lf_ns2
    s_mov_b32 s49, 7
    s_call_b64 s[62:63], L_swap
    ds_read_u8 v230, v237 offset:96
    ds_read_u8 v232, v237 offset:104
    s_add_u32 s35, s35, s31
    s_min_u32 s35, s35, 419404800
    s_sub_u32 s60, s60, 1
    s_bitcmp1_b32 s60, 0
    s_cselect_b32 s31, 25600, s51
    s_bitcmp0_b64 s[56:57], 4
    s_cbranch_scc1 Lf_evd2
    s_waitcnt lgkmcnt(0)
    s_branch Lf_e12
Lf_ns2:
    s_add_u32 s35, s35, s31
    s_min_u32 s35, s35, 419404800
    s_sub_u32 s60, s60, 1
    s_bitcmp1_b32 s60, 0
    s_cselect_b32 s31, 25600, s51
Lf_na2:
    s_bitcmp0_b64 s[56:57], 4
    s_cbranch_scc1 Lf_evd2
Lf_e12:
    s_sub_u32 s61, s61, 1
    s_cbranch_scc1 Lf_last2
    s_cmp_lg_u32 s61, s45
    s_cbranch_scc1 Lf_nw2
    v_add_u32 v238, s47, v238
    v_add_u32 v239, s47, v239
    ds_read_u16 v224, v238 offset:0
    ds_read_u16 v225, v238 offset:8
    ds_read_u16 v226, v238 offset:64
    ds_read_u16 v227, v238 offset:72
    s_waitcnt lgkmcnt(0)
Lf_nw2:
    v_mul_u32_u24 v216, v224, v241
    v_mul_u32_u24 v217, v224, v242
    v_mul_u32_u24 v218, v225, v241
    v_mul_u32_u24 v219, v225, v242
    v_mul_u32_u24 v220, v226, v241
    v_mul_u32_u24 v221, v226, v242
    v_mul_u32_u24 v222, v227, v241
    v_mul_u32_u24 v223, v227, v242
    v_add_u32 v238, 128, v238
    ds_read_b128 v[164:167], v239
    v_mfma_f32_4x4x4_16b_bf16 v[132:135], v[216:217], v[68:69], v[4:7]
    ds_read_b128 v[168:171], v239 offset:64
    ds_read_b128 v[172:175], v239 offset:128
    v_mfma_f32_4x4x4_16b_bf16 v[136:139], v[218:219], v[70:71], v[8:11]
    ds_read_b128 v[176:179], v239 offset:192
    ds_read_u16 v224, v238
    v_mfma_f32_4x4x4_16b_bf16 v[140:143], v[220:221], v[72:73], v[12:15]
    ds_read_u16 v225, v238 offset:8
    ds_read_u16 v226, v238 offset:64
    v_mfma_f32_4x4x4_16b_bf16 v[144:147], v[222:223], v[74:75], v[16:19]
    ds_read_u16 v227, v238 offset:72
    v_add_u32 v239, 272, v239
    v_mfma_f32_4x4x4_16b_bf16 v[246:249], v[216:217], v[76:77], v[20:23]
    v_cvt_pk_bf16_f32 v100, v132, v133
    v_cvt_pk_bf16_f32 v101, v134, v135
    v_mfma_f32_4x4x4_16b_bf16 v[250:253], v[218:219], v[78:79], v[24:27]
    v_cvt_pk_bf16_f32 v102, v136, v137
    v_cvt_pk_bf16_f32 v103, v138, v139
    v_mfma_f32_4x4x4_16b_bf16 v[132:135], v[220:221], v[80:81], v[28:31]
    v_cvt_pk_bf16_f32 v104, v140, v141
    v_cvt_pk_bf16_f32 v105, v142, v143
    v_mfma_f32_4x4x4_16b_bf16 v[136:139], v[222:223], v[82:83], v[32:35]
    v_cvt_pk_bf16_f32 v106, v144, v145
    v_cvt_pk_bf16_f32 v107, v146, v147
    v_mfma_f32_4x4x4_16b_bf16 v[140:143], v[216:217], v[84:85], v[36:39]
    v_cvt_pk_bf16_f32 v108, v246, v247
    v_cvt_pk_bf16_f32 v109, v248, v249
    v_mfma_f32_4x4x4_16b_bf16 v[144:147], v[218:219], v[86:87], v[40:43]
    v_cvt_pk_bf16_f32 v110, v250, v251
    v_cvt_pk_bf16_f32 v111, v252, v253
    v_mfma_f32_4x4x4_16b_bf16 v[246:249], v[220:221], v[88:89], v[44:47]
    v_cvt_pk_bf16_f32 v112, v132, v133
    v_cvt_pk_bf16_f32 v113, v134, v135
    v_mfma_f32_4x4x4_16b_bf16 v[250:253], v[222:223], v[90:91], v[48:51]
    v_cvt_pk_bf16_f32 v114, v136, v137
    v_cvt_pk_bf16_f32 v115, v138, v139
    v_mfma_f32_4x4x4_16b_bf16 v[132:135], v[216:217], v[92:93], v[52:55]
    v_cvt_pk_bf16_f32 v116, v140, v141
    v_cvt_pk_bf16_f32 v117, v142, v143
    v_mfma_f32_4x4x4_16b_bf16 v[136:139], v[218:219], v[94:95], v[56:59]
    v_cvt_pk_bf16_f32 v118, v144, v145
    v_cvt_pk_bf16_f32 v119, v146, v147
    v_mfma_f32_4x4x4_16b_bf16 v[140:143], v[220:221], v[96:97], v[60:63]
    v_cvt_pk_bf16_f32 v120, v246, v247
    v_cvt_pk_bf16_f32 v121, v248, v249
    v_mfma_f32_4x4x4_16b_bf16 v[144:147], v[222:223], v[98:99], v[64:67]
    v_cvt_pk_bf16_f32 v122, v250, v251
    v_cvt_pk_bf16_f32 v123, v252, v253
    v_cvt_pk_bf16_f32 v124, v132, v133
    v_cvt_pk_bf16_f32 v125, v134, v135
    v_cvt_pk_bf16_f32 v126, v136, v137
    v_cvt_pk_bf16_f32 v127, v138, v139
    v_cvt_pk_bf16_f32 v128, v140, v141
    v_cvt_pk_bf16_f32 v129, v142, v143
    v_cvt_pk_bf16_f32 v130, v144, v145
    v_cvt_pk_bf16_f32 v131, v146, v147
    s_waitcnt lgkmcnt(0)
    s_branch Lf_evd2
Lf_ev3:
    s_bitcmp0_b64 s[56:57], 3
    s_cbranch_scc1 Lf_nf3
    v_cvt_pk_bf16_f32 v246, v212, v212
    v_mov_b32 v212, 0
    ds_write_b16 v240, v246
    s_sub_u32 s48, s48, 1
    s_cselect_b32 s66, s47, 0
    s_cselect_b32 s48, 64, s48
    s_add_u32 s66, s66, 128
    v_add_u32 v240, s66, v240
Lf_nf3:
    s_bitcmp0_b64 s[56:57], 8
    s_cbranch_scc1 Lf_na3
    s_cmp_lg_u32 s60, 2
    s_cbranch_scc1 Lf_ns3
    s_mov_b32 s49, 8
    s_call_b64 s[62:63], L_swap
    ds_read_u8 v230, v237 offset:112
    ds_read_u8 v232, v237 offset:120
    s_add_u32 s35, s35, s31
    s_min_u32 s35, s35, 419404800
    s_sub_u32 s60, s60, 1
    s_bitcmp1_b32 s60, 0
    s_cselect_b32 s31, 25600, s51
    s_bitcmp0_b64 s[56:57], 5
    s_cbranch_scc1 Lf_evd3
    s_waitcnt lgkmcnt(0)
    s_branch Lf_e13
Lf_ns3:
    s_add_u32 s35, s35, s31
    s_min_u32 s35, s35, 419404800
    s_sub_u32 s60, s60, 1
    s_bitcmp1_b32 s60, 0
    s_cselect_b32 s31, 25600, s51
Lf_na3:
    s_bitcmp0_b64 s[56:57], 5
    s_cbranch_scc1 Lf_evd3
Lf_e13:
    s_sub_u32 s61, s61, 1
    s_cbranch_scc1 Lf_last3
    s_cmp_lg_u32 s61, s45
    s_cbranch_scc1 Lf_nw3
    v_add_u32 v238, s47, v238
    v_add_u32 v239, s47, v239
    ds_read_u16 v224, v238 offset:0
    ds_read_u16 v225, v238 offset:8
    ds_read_u16 v226, v238 offset:64
    ds_read_u16 v227, v238 offset:72
    s_waitcnt lgkmcnt(0)
Lf_nw3:
    v_mul_u32_u24 v216, v224, v241
    v_mul_u32_u24 v217, v224, v242
    v_mul_u32_u24 v218, v225, v241
    v_mul_u32_u24 v219, v225, v242
    v_mul_u32_u24 v220, v226, v241
    v_mul_u32_u24 v221, v226, v242
    v_mul_u32_u24 v222, v227, v241
    v_mul_u32_u24 v223, v227, v242
    v_add_u32 v238, 128, v238
    ds_read_b128 v[164:167], v239
    v_mfma_f32_4x4x4_16b_bf16 v[132:135], v[216:217], v[68:69], v[4:7]
    ds_read_b128 v[168:171], v239 offset:64
    ds_read_b128 v[172:175], v239 offset:128
    v_mfma_f32_4x4x4_16b_bf16 v[136:139], v[218:219], v[70:71], v[8:11]
    ds_read_b128 v[176:179], v239 offset:192
    ds_read_u16 v224, v238
    v_mfma_f32_4x4x4_16b_bf16 v[140:143], v[220:221], v[72:73], v[12:15]
    ds_read_u16 v225, v238 offset:8
    ds_read_u16 v226, v238 offset:64
    v_mfma_f32_4x4x4_16b_bf16 v[144:147], v[222:223], v[74:75], v[16:19]
    ds_read_u16 v227, v238 offset:72
    v_add_u32 v239, 272, v239
    v_mfma_f32_4x4x4_16b_bf16 v[246:249], v[216:217], v[76:77], v[20:23]
    v_cvt_pk_bf16_f32 v100, v132, v133
    v_cvt_pk_bf16_f32 v101, v134, v135
    v_mfma_f32_4x4x4_16b_bf16 v[250:253], v[218:219], v[78:79], v[24:27]
    v_cvt_pk_bf16_f32 v102, v136, v137
    v_cvt_pk_bf16_f32 v103, v138, v139
    v_mfma_f32_4x4x4_16b_bf16 v[132:135], v[220:221], v[80:81], v[28:31]
    v_cvt_pk_bf16_f32 v104, v140, v141
    v_cvt_pk_bf16_f32 v105, v142, v143
    v_mfma_f32_4x4x4_16b_bf16 v[136:139], v[222:223], v[82:83], v[32:35]
    v_cvt_pk_bf16_f32 v106, v144, v145
    v_cvt_pk_bf16_f32 v107, v146, v147
    v_mfma_f32_4x4x4_16b_bf16 v[140:143], v[216:217], v[84:85], v[36:39]
    v_cvt_pk_bf16_f32 v108, v246, v247
    v_cvt_pk_bf16_f32 v109, v248, v249
    v_mfma_f32_4x4x4_16b_bf16 v[144:147], v[218:219], v[86:87], v[40:43]
    v_cvt_pk_bf16_f32 v110, v250, v251
    v_cvt_pk_bf16_f32 v111, v252, v253
    v_mfma_f32_4x4x4_16b_bf16 v[246:249], v[220:221], v[88:89], v[44:47]
    v_cvt_pk_bf16_f32 v112, v132, v133
    v_cvt_pk_bf16_f32 v113, v134, v135
    v_mfma_f32_4x4x4_16b_bf16 v[250:253], v[222:223], v[90:91], v[48:51]
    v_cvt_pk_bf16_f32 v114, v136, v137
    v_cvt_pk_bf16_f32 v115, v138, v139
    v_mfma_f32_4x4x4_16b_bf16 v[132:135], v[216:217], v[92:93], v[52:55]
    v_cvt_pk_bf16_f32 v116, v140, v141
    v_cvt_pk_bf16_f32 v117, v142, v143
    v_mfma_f32_4x4x4_16b_bf16 v[136:139], v[218:219], v[94:95], v[56:59]
    v_cvt_pk_bf16_f32 v118, v144, v145
    v_cvt_pk_bf16_f32 v119, v146, v147
    v_mfma_f32_4x4x4_16b_bf16 v[140:143], v[220:221], v[96:97], v[60:63]
    v_cvt_pk_bf16_f32 v120, v246, v247
    v_cvt_pk_bf16_f32 v121, v248, v249
    v_mfma_f32_4x4x4_16b_bf16 v[144:147], v[222:223], v[98:99], v[64:67]
    v_cvt_pk_bf16_f32 v122, v250, v251
    v_cvt_pk_bf16_f32 v123, v252, v253
    v_cvt_pk_bf16_f32 v124, v132, v133
    v_cvt_pk_bf16_f32 v125, v134, v135
    v_cvt_pk_bf16_f32 v126, v136, v137
    v_cvt_pk_bf16_f32 v127, v138, v139
    v_cvt_pk_bf16_f32 v128, v140, v141
    v_cvt_pk_bf16_f32 v129, v142, v143
    v_cvt_pk_bf16_f32 v130, v144, v145
    v_cvt_pk_bf16_f32 v131, v146, v147
    s_waitcnt lgkmcnt(0)
    s_branch Lf_evd3
Lf_last0:
    s_branch Lf_tail
Lf_last1:
    v_add_u32 v236, 2080, v236
    s_lshr_b64 s[56:57], s[56:57], 1
    s_branch Lf_tail
Lf_last2:
    v_add_u32 v236, 4160, v236
    s_lshr_b64 s[56:57], s[56:57], 2
    s_branch Lf_tail
Lf_last3:
    v_add_u32 v236, 6240, v236
    s_lshr_b64 s[56:57], s[56:57], 3
Lf_tail:
    v_exp_f32 v132, v148
    v_exp_f32 v133, v149
    v_exp_f32 v134, v150
    v_exp_f32 v135, v151
    v_exp_f32 v136, v152
    v_exp_f32 v137, v153
    v_mfma_f32_4x4x4_16b_bf16 v[132:135], v[228:229], v[228:229], v[132:135]
    v_cvt_pk_bf16_f32 v208, v208, v209
    v_cvt_pk_bf16_f32 v209, v210, v211
    v_exp_f32 v138, v154
    s_nop 0
    v_mfma_f32_4x4x4_16b_bf16 v[212:215], v[208:209], v[188:189], v[212:215] cbsz:4 abid:0
    ds_read_b64_tr_b16 v[188:189], v236 offset:0
    v_exp_f32 v139, v155
    v_exp_f32 v140, v156
    v_mfma_f32_4x4x4_16b_bf16 v[212:215], v[208:209], v[190:191], v[212:215] cbsz:4 abid:4
    ds_read_b64_tr_b16 v[190:191], v236 offset:512
    v_mfma_f32_4x4x4_16b_bf16 v[136:139], v[228:229], v[228:229], v[136:139]
    v_rcp_f32 v132, v132
    v_mfma_f32_4x4x4_16b_bf16 v[212:215], v[208:209], v[192:193], v[212:215] cbsz:4 abid:8
    ds_read_b64_tr_b16 v[192:193], v236 offset:1056
    v_exp_f32 v141, v157
    v_rcp_f32 v133, v133
    v_mfma_f32_4x4x4_16b_bf16 v[212:215], v[208:209], v[194:195], v[212:215] cbsz:4 abid:12
    ds_read_b64_tr_b16 v[194:195], v236 offset:1568
    v_exp_f32 v142, v158
    v_rcp_f32 v134, v134
    v_exp_f32 v143, v159
    v_rcp_f32 v135, v135
    v_cvt_pk_bf16_f32 v132, v132, v133
    v_mfma_f32_4x4x4_16b_bf16 v[140:143], v[228:229], v[228:229], v[140:143]
    v_exp_f32 v144, v160
    v_rcp_f32 v136, v136
    v_cvt_pk_bf16_f32 v133, v134, v135
    s_bitcmp0_b64 s[56:57], 1
    s_cbranch_scc1 Lf_tnf
    v_cvt_pk_bf16_f32 v246, v212, v212
    v_mov_b32 v212, 0
    ds_write_b16 v240, v246
    s_sub_u32 s48, s48, 1
    s_cselect_b32 s66, s47, 0
    s_cselect_b32 s48, 64, s48
    s_add_u32 s66, s66, 128
    v_add_u32 v240, s66, v240
Lf_tnf:
    s_waitcnt lgkmcnt(0)
    v_exp_f32 v145, v161
    v_rcp_f32 v137, v137
    v_exp_f32 v146, v162
    v_rcp_f32 v138, v138
    v_cvt_pk_bf16_f32 v134, v136, v137
    v_exp_f32 v147, v163
    v_rcp_f32 v139, v139
    s_nop 0
    v_mfma_f32_4x4x4_16b_bf16 v[144:147], v[228:229], v[228:229], v[144:147]
    v_rcp_f32 v140, v140
    v_rcp_f32 v141, v141
    v_cvt_pk_bf16_f32 v135, v138, v139
    v_rcp_f32 v142, v142
    v_cvt_pk_bf16_f32 v136, v140, v141
    v_mfma_f32_16x16x32_bf16 v[208:211], v[132:135], v[196:199], v[204:207]
    v_rcp_f32 v143, v143
    v_rcp_f32 v144, v144
    v_cvt_pk_bf16_f32 v137, v142, v143
    v_rcp_f32 v145, v145
    v_rcp_f32 v146, v146
    v_rcp_f32 v147, v147
    v_cvt_pk_bf16_f32 v138, v144, v145
    v_cvt_pk_bf16_f32 v139, v146, v147
    s_nop 1
    v_mfma_f32_16x16x32_bf16 v[208:211], v[136:139], v[200:203], v[208:211]
    s_nop 7
    v_cvt_pk_bf16_f32 v208, v208, v209
    v_cvt_pk_bf16_f32 v209, v210, v211
    s_nop 1
    v_mfma_f32_4x4x4_16b_bf16 v[212:215], v[208:209], v[188:189], v[212:215] cbsz:4 abid:0
    s_nop 1
    v_mfma_f32_4x4x4_16b_bf16 v[212:215], v[208:209], v[190:191], v[212:215] cbsz:4 abid:4
    s_nop 1
    v_mfma_f32_4x4x4_16b_bf16 v[212:215], v[208:209], v[192:193], v[212:215] cbsz:4 abid:8
    s_nop 1
    v_mfma_f32_4x4x4_16b_bf16 v[212:215], v[208:209], v[194:195], v[212:215] cbsz:4 abid:12
    s_nop 4
    v_cvt_pk_bf16_f32 v246, v212, v212
    ds_write_b16 v240, v246
L_store:
    s_add_u32 s66, s52, 8320
    v_lshl_add_u32 v247, v0, 4, s66
    s_bfm_b64 exec, 16, 48
    v_add_u32 v247, s47, v247
    v_add_u32 v243, s50, v243
    s_mov_b64 exec, -1
    ds_read_b128 v[148:151], v247
    s_waitcnt lgkmcnt(0)
    global_store_dwordx4 v243, v[148:151], s[18:19] sc0 sc1
L_end:
    s_endpgm
L_general:
    s_waitcnt vmcnt(0)
    ds_read_b128 v[44:47], v246 offset:20480
    ds_read_b128 v[48:51], v246 offset:21504
    ds_read_b128 v[88:91], v246 offset:22528
    ds_read_b128 v[52:55], v246 offset:40960
    ds_read_b128 v[56:59], v246 offset:41984
    ds_read_b128 v[92:95], v246 offset:43008
    ds_read_b128 v[60:63], v246 offset:61440
    ds_read_b128 v[64:67], v246 offset:62464
    ds_read_b128 v[96:99], v246 offset:63488
    ds_read_u16 v224, v238 offset:0
    ds_read_u16 v225, v238 offset:8
    ds_read_u16 v226, v238 offset:64
    ds_read_u16 v227, v238 offset:72
    s_mul_i32 s35, s53, 51200
    s_movk_i32 s31, 25600
    s_mov_b32 s51, 104832000
    s_mov_b32 s60, 7
    s_mov_b64 s[56:57], 0
    s_mov_b64 s[58:59], 0
    v_mov_b32 v148, -1
    v_mov_b32 v149, -1
    v_mov_b32 v150, -1
    v_mov_b32 v151, -1
    s_add_u32 s66, s52, 18432
    v_add_u32 v152, s66, v2
    ds_write_b128 v152, v[148:151]
    ds_write_b128 v152, v[148:151] offset:1024
    s_add_u32 s64, s52, 18448
    s_bfm_b64 s[28:29], 50, 0
    s_mul_i32 s66, s53, 800
    v_add_u32 v247, s66, v2
    s_mov_b64 exec, s[28:29]
    global_load_dwordx4 v[100:103], v247, s[8:9]
    v_add_u32 v247, 1638400, v247
    global_load_dwordx4 v[104:107], v247, s[8:9]
    v_add_u32 v247, 1638400, v247
    global_load_dwordx4 v[108:111], v247, s[8:9]
    v_add_u32 v247, 1638400, v247
    global_load_dwordx4 v[112:115], v247, s[8:9]
    v_add_u32 v247, 1638400, v247
    s_mov_b64 exec, -1
    v_cmp_lt_u32 vcc, 24, v0
    s_nop 1
    v_cndmask_b32 v145, 0, 1, vcc
    v_mul_u32_u24 v142, 25, v145
    v_sub_u32 v142, v0, v142
    v_mul_u32_u24 v142, 0x80008, v142
    v_add_u32 v141, 0x10000, v142
    v_add_u32 v143, 0x50004, v142
    v_add_u32 v144, 0x70006, v142
    v_add_u32 v142, 0x30002, v142
    s_waitcnt vmcnt(0)
    s_mov_b64 exec, s[28:29]
    v_cmp_neq_f16_sdwa s[68:69], v100, 0 src0_sel:WORD_0 src1_sel:WORD_0
    v_cmp_neq_f16_sdwa s[70:71], v100, 0 src0_sel:WORD_1 src1_sel:WORD_0
    v_cmp_neq_f16_sdwa s[72:73], v101, 0 src0_sel:WORD_0 src1_sel:WORD_0
    v_cmp_neq_f16_sdwa s[74:75], v101, 0 src0_sel:WORD_1 src1_sel:WORD_0
    v_cmp_neq_f16_sdwa s[76:77], v102, 0 src0_sel:WORD_0 src1_sel:WORD_0
    v_cmp_neq_f16_sdwa s[78:79], v102, 0 src0_sel:WORD_1 src1_sel:WORD_0
    v_cmp_neq_f16_sdwa s[80:81], v103, 0 src0_sel:WORD_0 src1_sel:WORD_0
    v_cmp_neq_f16_sdwa s[82:83], v103, 0 src0_sel:WORD_1 src1_sel:WORD_0
    s_mov_b64 exec, -1
    v_mov_b32 v132, s64
    v_mbcnt_lo_u32_b32 v132, s68, v132
    v_mbcnt_hi_u32_b32 v132, s69, v132
    v_mbcnt_lo_u32_b32 v132, s70, v132
    v_mbcnt_hi_u32_b32 v132, s71, v132
    v_mbcnt_lo_u32_b32 v132, s72, v132
    v_mbcnt_hi_u32_b32 v132, s73, v132
    v_mbcnt_lo_u32_b32 v132, s74, v132
    v_mbcnt_hi_u32_b32 v132, s75, v132
    v_mbcnt_lo_u32_b32 v132, s76, v132
    v_mbcnt_hi_u32_b32 v132, s77, v132
    v_mbcnt_lo_u32_b32 v132, s78, v132
    v_mbcnt_hi_u32_b32 v132, s79, v132
    v_mbcnt_lo_u32_b32 v132, s80, v132
    v_mbcnt_hi_u32_b32 v132, s81, v132
    v_mbcnt_lo_u32_b32 v132, s82, v132
    v_mbcnt_hi_u32_b32 v132, s83, v132
    s_add_u32 s55, s64, 16
    v_readlane_b32 s66, v132, 25
    v_readlane_b32 s67, v132, 63
    s_add_u32 s64, s66, 15
    s_and_b32 s64, s64, -16
    s_max_u32 s64, s64, s55
    s_sub_u32 s66, s64, s66
    v_mad_u32_u24 v132, v145, s66, v132
    s_mov_b32 s55, s64
    v_addc_co_u32 v133, vcc, 0, v132, s[68:69]
    v_addc_co_u32 v134, vcc, 0, v133, s[70:71]
    v_addc_co_u32 v135, vcc, 0, v134, s[72:73]
    v_addc_co_u32 v136, vcc, 0, v135, s[74:75]
    v_addc_co_u32 v137, vcc, 0, v136, s[76:77]
    v_addc_co_u32 v138, vcc, 0, v137, s[78:79]
    v_addc_co_u32 v139, vcc, 0, v138, s[80:81]
    s_add_u32 s67, s67, s66
    s_add_u32 s67, s67, 15
    s_and_b32 s67, s67, -16
    s_add_u32 s64, s64, 16
    s_max_u32 s64, s64, s67
    s_mov_b64 exec, s[68:69]
    ds_write_b8 v132, v141
    s_mov_b64 exec, s[70:71]
    ds_write_b8_d16_hi v133, v141
    s_mov_b64 exec, s[72:73]
    ds_write_b8 v134, v142
    s_mov_b64 exec, s[74:75]
    ds_write_b8_d16_hi v135, v142
    s_mov_b64 exec, s[76:77]
    ds_write_b8 v136, v143
    s_mov_b64 exec, s[78:79]
    ds_write_b8_d16_hi v137, v143
    s_mov_b64 exec, s[80:81]
    ds_write_b8 v138, v144
    s_mov_b64 exec, s[82:83]
    ds_write_b8_d16_hi v139, v144
    s_mov_b64 exec, -1
    s_lshr_b32 s95, s55, 4
    s_bitset1_b64 s[56:57], s95
    s_lshr_b32 s95, s64, 4
    s_bitset1_b64 s[56:57], s95
    s_mov_b64 exec, s[28:29]
    v_cmp_neq_f16_sdwa s[68:69], v104, 0 src0_sel:WORD_0 src1_sel:WORD_0
    v_cmp_neq_f16_sdwa s[70:71], v104, 0 src0_sel:WORD_1 src1_sel:WORD_0
    v_cmp_neq_f16_sdwa s[72:73], v105, 0 src0_sel:WORD_0 src1_sel:WORD_0
    v_cmp_neq_f16_sdwa s[74:75], v105, 0 src0_sel:WORD_1 src1_sel:WORD_0
    v_cmp_neq_f16_sdwa s[76:77], v106, 0 src0_sel:WORD_0 src1_sel:WORD_0
    v_cmp_neq_f16_sdwa s[78:79], v106, 0 src0_sel:WORD_1 src1_sel:WORD_0
    v_cmp_neq_f16_sdwa s[80:81], v107, 0 src0_sel:WORD_0 src1_sel:WORD_0
    v_cmp_neq_f16_sdwa s[82:83], v107, 0 src0_sel:WORD_1 src1_sel:WORD_0
    s_mov_b64 exec, -1
    v_mov_b32 v132, s64
    v_mbcnt_lo_u32_b32 v132, s68, v132
    v_mbcnt_hi_u32_b32 v132, s69, v132
    v_mbcnt_lo_u32_b32 v132, s70, v132
    v_mbcnt_hi_u32_b32 v132, s71, v132
    v_mbcnt_lo_u32_b32 v132, s72, v132
    v_mbcnt_hi_u32_b32 v132, s73, v132
    v_mbcnt_lo_u32_b32 v132, s74, v132
    v_mbcnt_hi_u32_b32 v132, s75, v132
    v_mbcnt_lo_u32_b32 v132, s76, v132
    v_mbcnt_hi_u32_b32 v132, s77, v132
    v_mbcnt_lo_u32_b32 v132, s78, v132
    v_mbcnt_hi_u32_b32 v132, s79, v132
    v_mbcnt_lo_u32_b32 v132, s80, v132
    v_mbcnt_hi_u32_b32 v132, s81, v132
    v_mbcnt_lo_u32_b32 v132, s82, v132
    v_mbcnt_hi_u32_b32 v132, s83, v132
    s_add_u32 s55, s64, 16
    v_readlane_b32 s66, v132, 25
    v_readlane_b32 s67, v132, 63
    s_add_u32 s64, s66, 15
    s_and_b32 s64, s64, -16
    s_max_u32 s64, s64, s55
    s_sub_u32 s66, s64, s66
    v_mad_u32_u24 v132, v145, s66, v132
    s_mov_b32 s55, s64
    v_addc_co_u32 v133, vcc, 0, v132, s[68:69]
    v_addc_co_u32 v134, vcc, 0, v133, s[70:71]
    v_addc_co_u32 v135, vcc, 0, v134, s[72:73]
    v_addc_co_u32 v136, vcc, 0, v135, s[74:75]
    v_addc_co_u32 v137, vcc, 0, v136, s[76:77]
    v_addc_co_u32 v138, vcc, 0, v137, s[78:79]
    v_addc_co_u32 v139, vcc, 0, v138, s[80:81]
    s_add_u32 s67, s67, s66
    s_add_u32 s67, s67, 15
    s_and_b32 s67, s67, -16
    s_add_u32 s64, s64, 16
    s_max_u32 s64, s64, s67
    s_mov_b64 exec, s[68:69]
    ds_write_b8 v132, v141
    s_mov_b64 exec, s[70:71]
    ds_write_b8_d16_hi v133, v141
    s_mov_b64 exec, s[72:73]
    ds_write_b8 v134, v142
    s_mov_b64 exec, s[74:75]
    ds_write_b8_d16_hi v135, v142
    s_mov_b64 exec, s[76:77]
    ds_write_b8 v136, v143
    s_mov_b64 exec, s[78:79]
    ds_write_b8_d16_hi v137, v143
    s_mov_b64 exec, s[80:81]
    ds_write_b8 v138, v144
    s_mov_b64 exec, s[82:83]
    ds_write_b8_d16_hi v139, v144
    s_mov_b64 exec, -1
    s_lshr_b32 s95, s55, 4
    s_bitset1_b64 s[56:57], s95
    s_lshr_b32 s95, s64, 4
    s_bitset1_b64 s[56:57], s95
    s_mov_b64 exec, s[28:29]
    v_cmp_neq_f16_sdwa s[68:69], v108, 0 src0_sel:WORD_0 src1_sel:WORD_0
    v_cmp_neq_f16_sdwa s[70:71], v108, 0 src0_sel:WORD_1 src1_sel:WORD_0
    v_cmp_neq_f16_sdwa s[72:73], v109, 0 src0_sel:WORD_0 src1_sel:WORD_0
    v_cmp_neq_f16_sdwa s[74:75], v109, 0 src0_sel:WORD_1 src1_sel:WORD_0
    v_cmp_neq_f16_sdwa s[76:77], v110, 0 src0_sel:WORD_0 src1_sel:WORD_0
    v_cmp_neq_f16_sdwa s[78:79], v110, 0 src0_sel:WORD_1 src1_sel:WORD_0
    v_cmp_neq_f16_sdwa s[80:81], v111, 0 src0_sel:WORD_0 src1_sel:WORD_0
    v_cmp_neq_f16_sdwa s[82:83], v111, 0 src0_sel:WORD_1 src1_sel:WORD_0
    s_mov_b64 exec, -1
    v_mov_b32 v132, s64
    v_mbcnt_lo_u32_b32 v132, s68, v132
    v_mbcnt_hi_u32_b32 v132, s69, v132
    v_mbcnt_lo_u32_b32 v132, s70, v132
    v_mbcnt_hi_u32_b32 v132, s71, v132
    v_mbcnt_lo_u32_b32 v132, s72, v132
    v_mbcnt_hi_u32_b32 v132, s73, v132
    v_mbcnt_lo_u32_b32 v132, s74, v132
    v_mbcnt_hi_u32_b32 v132, s75, v132
    v_mbcnt_lo_u32_b32 v132, s76, v132
    v_mbcnt_hi_u32_b32 v132, s77, v132
    v_mbcnt_lo_u32_b32 v132, s78, v132
    v_mbcnt_hi_u32_b32 v132, s79, v132
    v_mbcnt_lo_u32_b32 v132, s80, v132
    v_mbcnt_hi_u32_b32 v132, s81, v132
    v_mbcnt_lo_u32_b32 v132, s82, v132
    v_mbcnt_hi_u32_b32 v132, s83, v132
    s_add_u32 s55, s64, 16
    v_readlane_b32 s66, v132, 25
    v_readlane_b32 s67, v132, 63
    s_add_u32 s64, s66, 15
    s_and_b32 s64, s64, -16
    s_max_u32 s64, s64, s55
    s_sub_u32 s66, s64, s66
    v_mad_u32_u24 v132, v145, s66, v132
    s_mov_b32 s55, s64
    v_addc_co_u32 v133, vcc, 0, v132, s[68:69]
    v_addc_co_u32 v134, vcc, 0, v133, s[70:71]
    v_addc_co_u32 v135, vcc, 0, v134, s[72:73]
    v_addc_co_u32 v136, vcc, 0, v135, s[74:75]
    v_addc_co_u32 v137, vcc, 0, v136, s[76:77]
    v_addc_co_u32 v138, vcc, 0, v137, s[78:79]
    v_addc_co_u32 v139, vcc, 0, v138, s[80:81]
    s_add_u32 s67, s67, s66
    s_add_u32 s67, s67, 15
    s_and_b32 s67, s67, -16
    s_add_u32 s64, s64, 16
    s_max_u32 s64, s64, s67
    s_mov_b64 exec, s[68:69]
    ds_write_b8 v132, v141
    s_mov_b64 exec, s[70:71]
    ds_write_b8_d16_hi v133, v141
    s_mov_b64 exec, s[72:73]
    ds_write_b8 v134, v142
    s_mov_b64 exec, s[74:75]
    ds_write_b8_d16_hi v135, v142
    s_mov_b64 exec, s[76:77]
    ds_write_b8 v136, v143
    s_mov_b64 exec, s[78:79]
    ds_write_b8_d16_hi v137, v143
    s_mov_b64 exec, s[80:81]
    ds_write_b8 v138, v144
    s_mov_b64 exec, s[82:83]
    ds_write_b8_d16_hi v139, v144
    s_mov_b64 exec, -1
    s_lshr_b32 s95, s55, 4
    s_lshl_b64 s[86:87], 1, s95
    s_bitcmp1_b32 s55, 10
    s_cselect_b64 s[88:89], 0, s[86:87]
    s_cselect_b64 s[90:91], s[86:87], 0
    s_or_b64 s[56:57], s[56:57], s[88:89]
    s_or_b64 s[58:59], s[58:59], s[90:91]
    s_lshr_b32 s95, s64, 4
    s_lshl_b64 s[86:87], 1, s95
    s_bitcmp1_b32 s64, 10
    s_cselect_b64 s[88:89], 0, s[86:87]
    s_cselect_b64 s[90:91], s[86:87], 0
    s_or_b64 s[56:57], s[56:57], s[88:89]
    s_or_b64 s[58:59], s[58:59], s[90:91]
    s_mov_b32 s44, s64
    s_mov_b64 exec, s[28:29]
    v_cmp_neq_f16_sdwa s[68:69], v112, 0 src0_sel:WORD_0 src1_sel:WORD_0
    v_cmp_neq_f16_sdwa s[70:71], v112, 0 src0_sel:WORD_1 src1_sel:WORD_0
    v_cmp_neq_f16_sdwa s[72:73], v113, 0 src0_sel:WORD_0 src1_sel:WORD_0
    v_cmp_neq_f16_sdwa s[74:75], v113, 0 src0_sel:WORD_1 src1_sel:WORD_0
    v_cmp_neq_f16_sdwa s[76:77], v114, 0 src0_sel:WORD_0 src1_sel:WORD_0
    v_cmp_neq_f16_sdwa s[78:79], v114, 0 src0_sel:WORD_1 src1_sel:WORD_0
    v_cmp_neq_f16_sdwa s[80:81], v115, 0 src0_sel:WORD_0 src1_sel:WORD_0
    v_cmp_neq_f16_sdwa s[82:83], v115, 0 src0_sel:WORD_1 src1_sel:WORD_0
    s_mov_b64 exec, -1
    v_mov_b32 v132, s64
    v_mbcnt_lo_u32_b32 v132, s68, v132
    v_mbcnt_hi_u32_b32 v132, s69, v132
    v_mbcnt_lo_u32_b32 v132, s70, v132
    v_mbcnt_hi_u32_b32 v132, s71, v132
    v_mbcnt_lo_u32_b32 v132, s72, v132
    v_mbcnt_hi_u32_b32 v132, s73, v132
    v_mbcnt_lo_u32_b32 v132, s74, v132
    v_mbcnt_hi_u32_b32 v132, s75, v132
    v_mbcnt_lo_u32_b32 v132, s76, v132
    v_mbcnt_hi_u32_b32 v132, s77, v132
    v_mbcnt_lo_u32_b32 v132, s78, v132
    v_mbcnt_hi_u32_b32 v132, s79, v132
    v_mbcnt_lo_u32_b32 v132, s80, v132
    v_mbcnt_hi_u32_b32 v132, s81, v132
    v_mbcnt_lo_u32_b32 v132, s82, v132
    v_mbcnt_hi_u32_b32 v132, s83, v132
    s_add_u32 s55, s64, 16
    v_readlane_b32 s66, v132, 25
    v_readlane_b32 s67, v132, 63
    s_add_u32 s64, s66, 15
    s_and_b32 s64, s64, -16
    s_max_u32 s64, s64, s55
    s_sub_u32 s66, s64, s66
    v_mad_u32_u24 v132, v145, s66, v132
    s_mov_b32 s55, s64
    v_addc_co_u32 v133, vcc, 0, v132, s[68:69]
    v_addc_co_u32 v134, vcc, 0, v133, s[70:71]
    v_addc_co_u32 v135, vcc, 0, v134, s[72:73]
    v_addc_co_u32 v136, vcc, 0, v135, s[74:75]
    v_addc_co_u32 v137, vcc, 0, v136, s[76:77]
    v_addc_co_u32 v138, vcc, 0, v137, s[78:79]
    v_addc_co_u32 v139, vcc, 0, v138, s[80:81]
    s_add_u32 s67, s67, s66
    s_add_u32 s67, s67, 15
    s_and_b32 s67, s67, -16
    s_add_u32 s64, s64, 16
    s_max_u32 s64, s64, s67
    s_mov_b64 exec, s[68:69]
    ds_write_b8 v132, v141
    s_mov_b64 exec, s[70:71]
    ds_write_b8_d16_hi v133, v141
    s_mov_b64 exec, s[72:73]
    ds_write_b8 v134, v142
    s_mov_b64 exec, s[74:75]
    ds_write_b8_d16_hi v135, v142
    s_mov_b64 exec, s[76:77]
    ds_write_b8 v136, v143
    s_mov_b64 exec, s[78:79]
    ds_write_b8_d16_hi v137, v143
    s_mov_b64 exec, s[80:81]
    ds_write_b8 v138, v144
    s_mov_b64 exec, s[82:83]
    ds_write_b8_d16_hi v139, v144
    s_mov_b64 exec, -1
    s_mov_b32 s45, s55
    s_mov_b32 s46, s64
    s_mov_b32 s94, 0
    s_mov_b64 s[84:85], -1
    s_branch L_listed
Ls_loop:
    ds_read_u8 v230, v237 offset:64
    ds_read_u8 v232, v237 offset:72
    v_mfma_f32_16x16x32_bf16 v[208:211], v[136:139], v[200:203], v[208:211]
Ls_mid:
    s_bitcmp1_b32 s36, 0
    s_cbranch_scc1 Ls_ev0
Ls_evd0:
    ds_read_b32 v246, v244 offset:0
    s_waitcnt lgkmcnt(0)
    v_bfe_u32 v247, v246, 0, 8
    v_lshlrev_b32 v247, 1, v247
    v_bfe_u32 v248, v246, 8, 8
    v_lshlrev_b32 v248, 1, v248
    v_bfe_u32 v249, v246, 16, 8
    v_lshlrev_b32 v249, 1, v249
    v_bfe_u32 v250, v246, 24, 8
    v_lshlrev_b32 v250, 1, v250
    buffer_load_ushort v247, v247, s[24:27], 0 offen
    buffer_load_ushort v248, v248, s[24:27], 0 offen
    buffer_load_ushort v249, v249, s[24:27], 0 offen
    buffer_load_ushort v250, v250, s[24:27], 0 offen
    s_waitcnt vmcnt(0)
    v_lshlrev_b32 v247, 16, v247
    v_mul_f32 v208, v208, v247
    v_lshlrev_b32 v248, 16, v248
    v_mul_f32 v209, v209, v248
    v_lshlrev_b32 v249, 16, v249
    v_mul_f32 v210, v210, v249
    v_lshlrev_b32 v250, 16, v250
    v_mul_f32 v211, v211, v250
    ds_add_rtn_u32 v1, v2, v3
    v_exp_f32 v132, v148
    v_exp_f32 v133, v149
    v_exp_f32 v134, v150
    v_exp_f32 v135, v151
    v_exp_f32 v136, v152
    v_exp_f32 v137, v153
    v_mfma_f32_4x4x4_16b_bf16 v[132:135], v[228:229], v[228:229], v[132:135]
    v_cvt_pk_bf16_f32 v208, v208, v209
    v_cvt_pk_bf16_f32 v209, v210, v211
    s_waitcnt lgkmcnt(2)
    v_mfma_f32_16x16x32_bf16 v[148:151], v[100:103], v[180:183], v[164:167]
    v_exp_f32 v138, v154
    v_mfma_f32_4x4x4_16b_bf16 v[212:215], v[208:209], v[188:189], v[212:215] cbsz:4 abid:0
    ds_read_b64_tr_b16 v[188:189], v236 offset:0
    v_exp_f32 v139, v155
    v_mfma_f32_16x16x32_bf16 v[152:155], v[108:111], v[180:183], v[168:171]
    v_exp_f32 v140, v156
    v_mfma_f32_4x4x4_16b_bf16 v[212:215], v[208:209], v[190:191], v[212:215] cbsz:4 abid:4
    ds_read_b64_tr_b16 v[190:191], v236 offset:512
    v_mfma_f32_4x4x4_16b_bf16 v[136:139], v[228:229], v[228:229], v[136:139]
    v_rcp_f32 v132, v132
    v_mfma_f32_4x4x4_16b_bf16 v[212:215], v[208:209], v[192:193], v[212:215] cbsz:4 abid:8
    ds_read_b64_tr_b16 v[192:193], v236 offset:1056
    v_exp_f32 v141, v157
    v_mfma_f32_16x16x32_bf16 v[148:151], v[104:107], v[184:187], v[148:151]
    v_rcp_f32 v133, v133
    v_mfma_f32_4x4x4_16b_bf16 v[212:215], v[208:209], v[194:195], v[212:215] cbsz:4 abid:12
    ds_read_b64_tr_b16 v[194:195], v236 offset:1568
    v_exp_f32 v142, v158
    v_mfma_f32_16x16x32_bf16 v[152:155], v[112:115], v[184:187], v[152:155]
    v_rcp_f32 v134, v134
    v_exp_f32 v143, v159
    v_rcp_f32 v135, v135
    v_cvt_pk_bf16_f32 v132, v132, v133
    v_mfma_f32_4x4x4_16b_bf16 v[140:143], v[228:229], v[228:229], v[140:143]
    v_exp_f32 v144, v160
    v_mfma_f32_16x16x32_bf16 v[156:159], v[116:119], v[180:183], v[172:175]
    v_rcp_f32 v136, v136
    v_cvt_pk_bf16_f32 v133, v134, v135
    s_add_u32 m0, s52, 0
    s_waitcnt lgkmcnt(0)
    buffer_load_dwordx4 v[230:231], s[20:23], s35 idxen offen nt lds
    v_exp_f32 v145, v161
    buffer_load_dwordx4 v[232:233], s[40:43], s35 idxen offen offset:1056 nt lds
    v_rcp_f32 v137, v137
    v_exp_f32 v146, v162
    v_rcp_f32 v138, v138
    v_cvt_pk_bf16_f32 v134, v136, v137
    v_exp_f32 v147, v163
    v_mfma_f32_16x16x32_bf16 v[160:163], v[124:127], v[180:183], v[176:179]
    v_readfirstlane_b32 s66, v1
    s_setprio 0
    s_cmp_gt_i32 s66, 0
    s_cbranch_scc0 Ls_lo0
    s_setprio 1
Ls_lo0:
    v_rcp_f32 v139, v139
    v_mfma_f32_4x4x4_16b_bf16 v[144:147], v[228:229], v[228:229], v[144:147]
    v_mfma_f32_16x16x32_bf16 v[156:159], v[120:123], v[184:187], v[156:159]
    v_rcp_f32 v140, v140
    v_mfma_f32_16x16x32_bf16 v[160:163], v[128:131], v[184:187], v[160:163]
    v_rcp_f32 v141, v141
    v_cvt_pk_bf16_f32 v135, v138, v139
    s_waitcnt vmcnt(4)
    ds_read_b128 v[180:183], v234 offset:4160
    ds_read_b128 v[184:187], v235 offset:4160
    v_rcp_f32 v142, v142
    v_cvt_pk_bf16_f32 v136, v140, v141
    v_mfma_f32_16x16x32_bf16 v[208:211], v[132:135], v[196:199], v[204:207]
    v_rcp_f32 v143, v143
    v_rcp_f32 v144, v144
    v_cvt_pk_bf16_f32 v137, v142, v143
    v_rcp_f32 v145, v145
    v_rcp_f32 v146, v146
    v_rcp_f32 v147, v147
    v_cvt_pk_bf16_f32 v138, v144, v145
    v_cvt_pk_bf16_f32 v139, v146, v147
    ds_read_u8 v230, v237 offset:80
    ds_read_u8 v232, v237 offset:88
    v_mfma_f32_16x16x32_bf16 v[208:211], v[136:139], v[200:203], v[208:211]
    s_bitcmp1_b32 s36, 1
    s_cbranch_scc1 Ls_ev1
Ls_evd1:
    ds_read_b32 v246, v244 offset:16
    s_waitcnt lgkmcnt(0)
    v_bfe_u32 v247, v246, 0, 8
    v_lshlrev_b32 v247, 1, v247
    v_bfe_u32 v248, v246, 8, 8
    v_lshlrev_b32 v248, 1, v248
    v_bfe_u32 v249, v246, 16, 8
    v_lshlrev_b32 v249, 1, v249
    v_bfe_u32 v250, v246, 24, 8
    v_lshlrev_b32 v250, 1, v250
    buffer_load_ushort v247, v247, s[24:27], 0 offen
    buffer_load_ushort v248, v248, s[24:27], 0 offen
    buffer_load_ushort v249, v249, s[24:27], 0 offen
    buffer_load_ushort v250, v250, s[24:27], 0 offen
    s_waitcnt vmcnt(0)
    v_lshlrev_b32 v247, 16, v247
    v_mul_f32 v208, v208, v247
    v_lshlrev_b32 v248, 16, v248
    v_mul_f32 v209, v209, v248
    v_lshlrev_b32 v249, 16, v249
    v_mul_f32 v210, v210, v249
    v_lshlrev_b32 v250, 16, v250
    v_mul_f32 v211, v211, v250
    v_exp_f32 v132, v148
    v_exp_f32 v133, v149
    v_exp_f32 v134, v150
    v_exp_f32 v135, v151
    v_exp_f32 v136, v152
    v_exp_f32 v137, v153
    v_mfma_f32_4x4x4_16b_bf16 v[132:135], v[228:229], v[228:229], v[132:135]
    v_cvt_pk_bf16_f32 v208, v208, v209
    v_cvt_pk_bf16_f32 v209, v210, v211
    s_waitcnt lgkmcnt(2)
    v_mfma_f32_16x16x32_bf16 v[148:151], v[100:103], v[180:183], v[164:167]
    v_exp_f32 v138, v154
    v_mfma_f32_4x4x4_16b_bf16 v[212:215], v[208:209], v[188:189], v[212:215] cbsz:4 abid:0
    ds_read_b64_tr_b16 v[188:189], v236 offset:2080
    v_exp_f32 v139, v155
    v_mfma_f32_16x16x32_bf16 v[152:155], v[108:111], v[180:183], v[168:171]
    v_exp_f32 v140, v156
    v_mfma_f32_4x4x4_16b_bf16 v[212:215], v[208:209], v[190:191], v[212:215] cbsz:4 abid:4
    ds_read_b64_tr_b16 v[190:191], v236 offset:2592
    v_mfma_f32_4x4x4_16b_bf16 v[136:139], v[228:229], v[228:229], v[136:139]
    v_rcp_f32 v132, v132
    v_mfma_f32_4x4x4_16b_bf16 v[212:215], v[208:209], v[192:193], v[212:215] cbsz:4 abid:8
    ds_read_b64_tr_b16 v[192:193], v236 offset:3136
    v_exp_f32 v141, v157
    v_mfma_f32_16x16x32_bf16 v[148:151], v[104:107], v[184:187], v[148:151]
    v_rcp_f32 v133, v133
    v_mfma_f32_4x4x4_16b_bf16 v[212:215], v[208:209], v[194:195], v[212:215] cbsz:4 abid:12
    ds_read_b64_tr_b16 v[194:195], v236 offset:3648
    v_exp_f32 v142, v158
    v_mfma_f32_16x16x32_bf16 v[152:155], v[112:115], v[184:187], v[152:155]
    v_rcp_f32 v134, v134
    v_exp_f32 v143, v159
    v_rcp_f32 v135, v135
    v_cvt_pk_bf16_f32 v132, v132, v133
    v_mfma_f32_4x4x4_16b_bf16 v[140:143], v[228:229], v[228:229], v[140:143]
    v_exp_f32 v144, v160
    v_mfma_f32_16x16x32_bf16 v[156:159], v[116:119], v[180:183], v[172:175]
    v_rcp_f32 v136, v136
    v_cvt_pk_bf16_f32 v133, v134, v135
    s_add_u32 m0, s52, 2080
    s_waitcnt lgkmcnt(0)
    buffer_load_dwordx4 v[230:231], s[20:23], s35 idxen offen nt lds
    v_exp_f32 v145, v161
    buffer_load_dwordx4 v[232:233], s[40:43], s35 idxen offen offset:1056 nt lds
    v_rcp_f32 v137, v137
    v_exp_f32 v146, v162
    v_rcp_f32 v138, v138
    v_cvt_pk_bf16_f32 v134, v136, v137
    v_exp_f32 v147, v163
    v_mfma_f32_16x16x32_bf16 v[160:163], v[124:127], v[180:183], v[176:179]
    v_rcp_f32 v139, v139
    v_mfma_f32_4x4x4_16b_bf16 v[144:147], v[228:229], v[228:229], v[144:147]
    v_mfma_f32_16x16x32_bf16 v[156:159], v[120:123], v[184:187], v[156:159]
    v_rcp_f32 v140, v140
    v_mfma_f32_16x16x32_bf16 v[160:163], v[128:131], v[184:187], v[160:163]
    v_rcp_f32 v141, v141
    v_cvt_pk_bf16_f32 v135, v138, v139
    s_waitcnt vmcnt(4)
    ds_read_b128 v[180:183], v234 offset:6240
    ds_read_b128 v[184:187], v235 offset:6240
    v_rcp_f32 v142, v142
    v_cvt_pk_bf16_f32 v136, v140, v141
    v_mfma_f32_16x16x32_bf16 v[208:211], v[132:135], v[196:199], v[204:207]
    v_rcp_f32 v143, v143
    v_rcp_f32 v144, v144
    v_cvt_pk_bf16_f32 v137, v142, v143
    v_rcp_f32 v145, v145
    v_rcp_f32 v146, v146
    v_rcp_f32 v147, v147
    v_cvt_pk_bf16_f32 v138, v144, v145
    v_cvt_pk_bf16_f32 v139, v146, v147
    ds_read_u8 v230, v237 offset:96
    ds_read_u8 v232, v237 offset:104
    v_mfma_f32_16x16x32_bf16 v[208:211], v[136:139], v[200:203], v[208:211]
    s_bitcmp1_b32 s36, 2
    s_cbranch_scc1 Ls_ev2
Ls_evd2:
    ds_read_b32 v246, v244 offset:32
    s_waitcnt lgkmcnt(0)
    v_bfe_u32 v247, v246, 0, 8
    v_lshlrev_b32 v247, 1, v247
    v_bfe_u32 v248, v246, 8, 8
    v_lshlrev_b32 v248, 1, v248
    v_bfe_u32 v249, v246, 16, 8
    v_lshlrev_b32 v249, 1, v249
    v_bfe_u32 v250, v246, 24, 8
    v_lshlrev_b32 v250, 1, v250
    buffer_load_ushort v247, v247, s[24:27], 0 offen
    buffer_load_ushort v248, v248, s[24:27], 0 offen
    buffer_load_ushort v249, v249, s[24:27], 0 offen
    buffer_load_ushort v250, v250, s[24:27], 0 offen
    s_waitcnt vmcnt(0)
    v_lshlrev_b32 v247, 16, v247
    v_mul_f32 v208, v208, v247
    v_lshlrev_b32 v248, 16, v248
    v_mul_f32 v209, v209, v248
    v_lshlrev_b32 v249, 16, v249
    v_mul_f32 v210, v210, v249
    v_lshlrev_b32 v250, 16, v250
    v_mul_f32 v211, v211, v250
    v_exp_f32 v132, v148
    v_exp_f32 v133, v149
    v_exp_f32 v134, v150
    v_exp_f32 v135, v151
    v_exp_f32 v136, v152
    v_exp_f32 v137, v153
    v_mfma_f32_4x4x4_16b_bf16 v[132:135], v[228:229], v[228:229], v[132:135]
    v_cvt_pk_bf16_f32 v208, v208, v209
    v_cvt_pk_bf16_f32 v209, v210, v211
    s_waitcnt lgkmcnt(2)
    v_mfma_f32_16x16x32_bf16 v[148:151], v[100:103], v[180:183], v[164:167]
    v_exp_f32 v138, v154
    v_mfma_f32_4x4x4_16b_bf16 v[212:215], v[208:209], v[188:189], v[212:215] cbsz:4 abid:0
    ds_read_b64_tr_b16 v[188:189], v236 offset:4160
    v_exp_f32 v139, v155
    v_mfma_f32_16x16x32_bf16 v[152:155], v[108:111], v[180:183], v[168:171]
    v_exp_f32 v140, v156
    v_mfma_f32_4x4x4_16b_bf16 v[212:215], v[208:209], v[190:191], v[212:215] cbsz:4 abid:4
    ds_read_b64_tr_b16 v[190:191], v236 offset:4672
    v_mfma_f32_4x4x4_16b_bf16 v[136:139], v[228:229], v[228:229], v[136:139]
    v_rcp_f32 v132, v132
    v_mfma_f32_4x4x4_16b_bf16 v[212:215], v[208:209], v[192:193], v[212:215] cbsz:4 abid:8
    ds_read_b64_tr_b16 v[192:193], v236 offset:5216
    v_exp_f32 v141, v157
    v_mfma_f32_16x16x32_bf16 v[148:151], v[104:107], v[184:187], v[148:151]
    v_rcp_f32 v133, v133
    v_mfma_f32_4x4x4_16b_bf16 v[212:215], v[208:209], v[194:195], v[212:215] cbsz:4 abid:12
    ds_read_b64_tr_b16 v[194:195], v236 offset:5728
    v_exp_f32 v142, v158
    v_mfma_f32_16x16x32_bf16 v[152:155], v[112:115], v[184:187], v[152:155]
    v_rcp_f32 v134, v134
    v_exp_f32 v143, v159
    v_rcp_f32 v135, v135
    v_cvt_pk_bf16_f32 v132, v132, v133
    v_mfma_f32_4x4x4_16b_bf16 v[140:143], v[228:229], v[228:229], v[140:143]
    v_exp_f32 v144, v160
    v_mfma_f32_16x16x32_bf16 v[156:159], v[116:119], v[180:183], v[172:175]
    v_rcp_f32 v136, v136
    v_cvt_pk_bf16_f32 v133, v134, v135
    s_add_u32 m0, s52, 4160
    s_waitcnt lgkmcnt(0)
    buffer_load_dwordx4 v[230:231], s[20:23], s35 idxen offen nt lds
    v_exp_f32 v145, v161
    buffer_load_dwordx4 v[232:233], s[40:43], s35 idxen offen offset:1056 nt lds
    v_rcp_f32 v137, v137
    v_exp_f32 v146, v162
    v_rcp_f32 v138, v138
    v_cvt_pk_bf16_f32 v134, v136, v137
    v_exp_f32 v147, v163
    v_mfma_f32_16x16x32_bf16 v[160:163], v[124:127], v[180:183], v[176:179]
    v_rcp_f32 v139, v139
    v_mfma_f32_4x4x4_16b_bf16 v[144:147], v[228:229], v[228:229], v[144:147]
    v_mfma_f32_16x16x32_bf16 v[156:159], v[120:123], v[184:187], v[156:159]
    v_rcp_f32 v140, v140
    v_mfma_f32_16x16x32_bf16 v[160:163], v[128:131], v[184:187], v[160:163]
    v_rcp_f32 v141, v141
    v_cvt_pk_bf16_f32 v135, v138, v139
    s_waitcnt vmcnt(4)
    ds_read_b128 v[180:183], v234 offset:0
    ds_read_b128 v[184:187], v235 offset:0
    v_rcp_f32 v142, v142
    v_cvt_pk_bf16_f32 v136, v140, v141
    v_mfma_f32_16x16x32_bf16 v[208:211], v[132:135], v[196:199], v[204:207]
    v_rcp_f32 v143, v143
    v_rcp_f32 v144, v144
    v_cvt_pk_bf16_f32 v137, v142, v143
    v_rcp_f32 v145, v145
    v_rcp_f32 v146, v146
    v_rcp_f32 v147, v147
    v_cvt_pk_bf16_f32 v138, v144, v145
    v_cvt_pk_bf16_f32 v139, v146, v147
    ds_read_u8 v230, v237 offset:112
    ds_read_u8 v232, v237 offset:120
    v_mfma_f32_16x16x32_bf16 v[208:211], v[136:139], v[200:203], v[208:211]
    s_bitcmp1_b32 s36, 3
    s_cbranch_scc1 Ls_ev3
Ls_evd3:
    ds_read_b32 v246, v244 offset:48
    s_waitcnt lgkmcnt(0)
    v_bfe_u32 v247, v246, 0, 8
    v_lshlrev_b32 v247, 1, v247
    v_bfe_u32 v248, v246, 8, 8
    v_lshlrev_b32 v248, 1, v248
    v_bfe_u32 v249, v246, 16, 8
    v_lshlrev_b32 v249, 1, v249
    v_bfe_u32 v250, v246, 24, 8
    v_lshlrev_b32 v250, 1, v250
    buffer_load_ushort v247, v247, s[24:27], 0 offen
    buffer_load_ushort v248, v248, s[24:27], 0 offen
    buffer_load_ushort v249, v249, s[24:27], 0 offen
    buffer_load_ushort v250, v250, s[24:27], 0 offen
    s_waitcnt vmcnt(0)
    v_lshlrev_b32 v247, 16, v247
    v_mul_f32 v208, v208, v247
    v_lshlrev_b32 v248, 16, v248
    v_mul_f32 v209, v209, v248
    v_lshlrev_b32 v249, 16, v249
    v_mul_f32 v210, v210, v249
    v_lshlrev_b32 v250, 16, v250
    v_mul_f32 v211, v211, v250
    v_exp_f32 v132, v148
    v_exp_f32 v133, v149
    v_exp_f32 v134, v150
    v_exp_f32 v135, v151
    v_exp_f32 v136, v152
    v_exp_f32 v137, v153
    v_mfma_f32_4x4x4_16b_bf16 v[132:135], v[228:229], v[228:229], v[132:135]
    v_cvt_pk_bf16_f32 v208, v208, v209
    v_cvt_pk_bf16_f32 v209, v210, v211
    s_waitcnt lgkmcnt(2)
    v_mfma_f32_16x16x32_bf16 v[148:151], v[100:103], v[180:183], v[164:167]
    v_exp_f32 v138, v154
    v_mfma_f32_4x4x4_16b_bf16 v[212:215], v[208:209], v[188:189], v[212:215] cbsz:4 abid:0
    ds_read_b64_tr_b16 v[188:189], v236 offset:6240
    v_exp_f32 v139, v155
    v_mfma_f32_16x16x32_bf16 v[152:155], v[108:111], v[180:183], v[168:171]
    v_exp_f32 v140, v156
    v_mfma_f32_4x4x4_16b_bf16 v[212:215], v[208:209], v[190:191], v[212:215] cbsz:4 abid:4
    ds_read_b64_tr_b16 v[190:191], v236 offset:6752
    v_mfma_f32_4x4x4_16b_bf16 v[136:139], v[228:229], v[228:229], v[136:139]
    v_rcp_f32 v132, v132
    v_mfma_f32_4x4x4_16b_bf16 v[212:215], v[208:209], v[192:193], v[212:215] cbsz:4 abid:8
    ds_read_b64_tr_b16 v[192:193], v236 offset:7296
    v_exp_f32 v141, v157
    v_mfma_f32_16x16x32_bf16 v[148:151], v[104:107], v[184:187], v[148:151]
    v_rcp_f32 v133, v133
    v_mfma_f32_4x4x4_16b_bf16 v[212:215], v[208:209], v[194:195], v[212:215] cbsz:4 abid:12
    ds_read_b64_tr_b16 v[194:195], v236 offset:7808
    v_exp_f32 v142, v158
    v_mfma_f32_16x16x32_bf16 v[152:155], v[112:115], v[184:187], v[152:155]
    v_rcp_f32 v134, v134
    v_exp_f32 v143, v159
    v_rcp_f32 v135, v135
    v_cvt_pk_bf16_f32 v132, v132, v133
    v_mfma_f32_4x4x4_16b_bf16 v[140:143], v[228:229], v[228:229], v[140:143]
    v_exp_f32 v144, v160
    v_mfma_f32_16x16x32_bf16 v[156:159], v[116:119], v[180:183], v[172:175]
    v_rcp_f32 v136, v136
    v_cvt_pk_bf16_f32 v133, v134, v135
    s_add_u32 m0, s52, 6240
    s_waitcnt lgkmcnt(0)
    buffer_load_dwordx4 v[230:231], s[20:23], s35 idxen offen nt lds
    v_exp_f32 v145, v161
    buffer_load_dwordx4 v[232:233], s[40:43], s35 idxen offen offset:1056 nt lds
    v_rcp_f32 v137, v137
    v_exp_f32 v146, v162
    v_rcp_f32 v138, v138
    v_cvt_pk_bf16_f32 v134, v136, v137
    v_exp_f32 v147, v163
    v_mfma_f32_16x16x32_bf16 v[160:163], v[124:127], v[180:183], v[176:179]
    v_rcp_f32 v139, v139
    v_mfma_f32_4x4x4_16b_bf16 v[144:147], v[228:229], v[228:229], v[144:147]
    v_mfma_f32_16x16x32_bf16 v[156:159], v[120:123], v[184:187], v[156:159]
    v_rcp_f32 v140, v140
    v_mfma_f32_16x16x32_bf16 v[160:163], v[128:131], v[184:187], v[160:163]
    v_rcp_f32 v141, v141
    v_cvt_pk_bf16_f32 v135, v138, v139
    s_waitcnt vmcnt(4)
    ds_read_b128 v[180:183], v234 offset:2080
    ds_read_b128 v[184:187], v235 offset:2080
    v_rcp_f32 v142, v142
    v_cvt_pk_bf16_f32 v136, v140, v141
    v_mfma_f32_16x16x32_bf16 v[208:211], v[132:135], v[196:199], v[204:207]
    v_rcp_f32 v143, v143
    s_lshr_b64 s[56:57], s[56:57], 4
    s_lshl_b64 s[86:87], s[58:59], 60
    s_or_b64 s[56:57], s[56:57], s[86:87]
    s_lshr_b64 s[58:59], s[58:59], 4
    s_lshr_b64 s[86:87], s[56:57], 2
    s_lshr_b64 s[36:37], s[56:57], 5
    s_or_b32 s36, s36, s86
    s_or_b32 s36, s36, s56
    v_add_u32 v237, 64, v237
    v_add_u32 v244, 64, v244
    v_rcp_f32 v144, v144
    v_cvt_pk_bf16_f32 v137, v142, v143
    v_rcp_f32 v145, v145
    v_rcp_f32 v146, v146
    v_rcp_f32 v147, v147
    v_cvt_pk_bf16_f32 v138, v144, v145
    v_cvt_pk_bf16_f32 v139, v146, v147
    s_branch Ls_loop
Ls_ev0:
    s_bitcmp0_b64 s[56:57], 0
    s_cbranch_scc1 Ls_nf0
    v_cvt_pk_bf16_f32 v246, v212, v212
    v_mov_b32 v212, 0
    ds_write_b16 v240, v246
    s_sub_u32 s48, s48, 1
    s_cselect_b32 s66, s47, 0
    s_cselect_b32 s48, 64, s48
    s_add_u32 s66, s66, 128
    v_add_u32 v240, s66, v240
    s_add_u32 s24, s24, s32
    s_addc_u32 s25, s25, 0
    s_xor_b32 s32, s32, 0x18ffe0
Ls_nf0:
    s_bitcmp0_b64 s[56:57], 5
    s_cbranch_scc1 Ls_na0
    s_cmp_lg_u32 s60, 2
    s_cbranch_scc1 Ls_ns0
    s_mov_b32 s49, 5
    s_call_b64 s[62:63], L_swap
    ds_read_u8 v230, v237 offset:64
    ds_read_u8 v232, v237 offset:72
    s_add_u32 s35, s35, s31
    s_min_u32 s35, s35, 419404800
    s_sub_u32 s60, s60, 1
    s_bitcmp1_b32 s60, 0
    s_cselect_b32 s31, 25600, s51
    s_bitcmp0_b64 s[56:57], 2
    s_cbranch_scc1 Ls_evd0
    s_waitcnt lgkmcnt(0)
    s_branch Ls_e10
Ls_ns0:
    s_add_u32 s35, s35, s31
    s_min_u32 s35, s35, 419404800
    s_sub_u32 s60, s60, 1
    s_bitcmp1_b32 s60, 0
    s_cselect_b32 s31, 25600, s51
Ls_na0:
    s_bitcmp0_b64 s[56:57], 2
    s_cbranch_scc1 Ls_evd0
Ls_e10:
    s_sub_u32 s61, s61, 1
    s_cbranch_scc1 Ls_last0
    s_cmp_lg_u32 s61, s45
    s_cbranch_scc1 Ls_nw0
    v_add_u32 v238, s47, v238
    v_add_u32 v239, s47, v239
    ds_read_u16 v224, v238 offset:0
    ds_read_u16 v225, v238 offset:8
    ds_read_u16 v226, v238 offset:64
    ds_read_u16 v227, v238 offset:72
    s_waitcnt lgkmcnt(0)
Ls_nw0:
    v_mul_u32_u24 v216, v224, v241
    v_mul_u32_u24 v217, v224, v242
    v_mul_u32_u24 v218, v225, v241
    v_mul_u32_u24 v219, v225, v242
    v_mul_u32_u24 v220, v226, v241
    v_mul_u32_u24 v221, v226, v242
    v_mul_u32_u24 v222, v227, v241
    v_mul_u32_u24 v223, v227, v242
    v_add_u32 v238, 128, v238
    ds_read_b128 v[164:167], v239
    v_mfma_f32_4x4x4_16b_bf16 v[132:135], v[216:217], v[68:69], v[4:7]
    ds_read_b128 v[168:171], v239 offset:64
    ds_read_b128 v[172:175], v239 offset:128
    v_mfma_f32_4x4x4_16b_bf16 v[136:139], v[218:219], v[70:71], v[8:11]
    ds_read_b128 v[176:179], v239 offset:192
    ds_read_u16 v224, v238
    v_mfma_f32_4x4x4_16b_bf16 v[140:143], v[220:221], v[72:73], v[12:15]
    ds_read_u16 v225, v238 offset:8
    ds_read_u16 v226, v238 offset:64
    v_mfma_f32_4x4x4_16b_bf16 v[144:147], v[222:223], v[74:75], v[16:19]
    ds_read_u16 v227, v238 offset:72
    v_add_u32 v239, 272, v239
    v_mfma_f32_4x4x4_16b_bf16 v[246:249], v[216:217], v[76:77], v[20:23]
    v_cvt_pk_bf16_f32 v100, v132, v133
    v_cvt_pk_bf16_f32 v101, v134, v135
    v_mfma_f32_4x4x4_16b_bf16 v[250:253], v[218:219], v[78:79], v[24:27]
    v_cvt_pk_bf16_f32 v102, v136, v137
    v_cvt_pk_bf16_f32 v103, v138, v139
    v_mfma_f32_4x4x4_16b_bf16 v[132:135], v[220:221], v[80:81], v[28:31]
    v_cvt_pk_bf16_f32 v104, v140, v141
    v_cvt_pk_bf16_f32 v105, v142, v143
    v_mfma_f32_4x4x4_16b_bf16 v[136:139], v[222:223], v[82:83], v[32:35]
    v_cvt_pk_bf16_f32 v106, v144, v145
    v_cvt_pk_bf16_f32 v107, v146, v147
    v_mfma_f32_4x4x4_16b_bf16 v[140:143], v[216:217], v[84:85], v[36:39]
    v_cvt_pk_bf16_f32 v108, v246, v247
    v_cvt_pk_bf16_f32 v109, v248, v249
    v_mfma_f32_4x4x4_16b_bf16 v[144:147], v[218:219], v[86:87], v[40:43]
    v_cvt_pk_bf16_f32 v110, v250, v251
    v_cvt_pk_bf16_f32 v111, v252, v253
    v_mfma_f32_4x4x4_16b_bf16 v[246:249], v[220:221], v[88:89], v[44:47]
    v_cvt_pk_bf16_f32 v112, v132, v133
    v_cvt_pk_bf16_f32 v113, v134, v135
    v_mfma_f32_4x4x4_16b_bf16 v[250:253], v[222:223], v[90:91], v[48:51]
    v_cvt_pk_bf16_f32 v114, v136, v137
    v_cvt_pk_bf16_f32 v115, v138, v139
    v_mfma_f32_4x4x4_16b_bf16 v[132:135], v[216:217], v[92:93], v[52:55]
    v_cvt_pk_bf16_f32 v116, v140, v141
    v_cvt_pk_bf16_f32 v117, v142, v143
    v_mfma_f32_4x4x4_16b_bf16 v[136:139], v[218:219], v[94:95], v[56:59]
    v_cvt_pk_bf16_f32 v118, v144, v145
    v_cvt_pk_bf16_f32 v119, v146, v147
    v_mfma_f32_4x4x4_16b_bf16 v[140:143], v[220:221], v[96:97], v[60:63]
    v_cvt_pk_bf16_f32 v120, v246, v247
    v_cvt_pk_bf16_f32 v121, v248, v249
    v_mfma_f32_4x4x4_16b_bf16 v[144:147], v[222:223], v[98:99], v[64:67]
    v_cvt_pk_bf16_f32 v122, v250, v251
    v_cvt_pk_bf16_f32 v123, v252, v253
    v_cvt_pk_bf16_f32 v124, v132, v133
    v_cvt_pk_bf16_f32 v125, v134, v135
    v_cvt_pk_bf16_f32 v126, v136, v137
    v_cvt_pk_bf16_f32 v127, v138, v139
    v_cvt_pk_bf16_f32 v128, v140, v141
    v_cvt_pk_bf16_f32 v129, v142, v143
    v_cvt_pk_bf16_f32 v130, v144, v145
    v_cvt_pk_bf16_f32 v131, v146, v147
    s_waitcnt lgkmcnt(0)
    s_branch Ls_evd0
Ls_ev1:
    s_bitcmp0_b64 s[56:57], 1
    s_cbranch_scc1 Ls_nf1
    v_cvt_pk_bf16_f32 v246, v212, v212
    v_mov_b32 v212, 0
    ds_write_b16 v240, v246
    s_sub_u32 s48, s48, 1
    s_cselect_b32 s66, s47, 0
    s_cselect_b32 s48, 64, s48
    s_add_u32 s66, s66, 128
    v_add_u32 v240, s66, v240
    s_add_u32 s24, s24, s32
    s_addc_u32 s25, s25, 0
    s_xor_b32 s32, s32, 0x18ffe0
Ls_nf1:
    s_bitcmp0_b64 s[56:57], 6
    s_cbranch_scc1 Ls_na1
    s_cmp_lg_u32 s60, 2
    s_cbranch_scc1 Ls_ns1
    s_mov_b32 s49, 6
    s_call_b64 s[62:63], L_swap
    ds_read_u8 v230, v237 offset:80
    ds_read_u8 v232, v237 offset:88
    s_add_u32 s35, s35, s31
    s_min_u32 s35, s35, 419404800
    s_sub_u32 s60, s60, 1
    s_bitcmp1_b32 s60, 0
    s_cselect_b32 s31, 25600, s51
    s_bitcmp0_b64 s[56:57], 3
    s_cbranch_scc1 Ls_evd1
    s_waitcnt lgkmcnt(0)
    s_branch Ls_e11
Ls_ns1:
    s_add_u32 s35, s35, s31
    s_min_u32 s35, s35, 419404800
    s_sub_u32 s60, s60, 1
    s_bitcmp1_b32 s60, 0
    s_cselect_b32 s31, 25600, s51
Ls_na1:
    s_bitcmp0_b64 s[56:57], 3
    s_cbranch_scc1 Ls_evd1
Ls_e11:
    s_sub_u32 s61, s61, 1
    s_cbranch_scc1 Ls_last1
    s_cmp_lg_u32 s61, s45
    s_cbranch_scc1 Ls_nw1
    v_add_u32 v238, s47, v238
    v_add_u32 v239, s47, v239
    ds_read_u16 v224, v238 offset:0
    ds_read_u16 v225, v238 offset:8
    ds_read_u16 v226, v238 offset:64
    ds_read_u16 v227, v238 offset:72
    s_waitcnt lgkmcnt(0)
Ls_nw1:
    v_mul_u32_u24 v216, v224, v241
    v_mul_u32_u24 v217, v224, v242
    v_mul_u32_u24 v218, v225, v241
    v_mul_u32_u24 v219, v225, v242
    v_mul_u32_u24 v220, v226, v241
    v_mul_u32_u24 v221, v226, v242
    v_mul_u32_u24 v222, v227, v241
    v_mul_u32_u24 v223, v227, v242
    v_add_u32 v238, 128, v238
    ds_read_b128 v[164:167], v239
    v_mfma_f32_4x4x4_16b_bf16 v[132:135], v[216:217], v[68:69], v[4:7]
    ds_read_b128 v[168:171], v239 offset:64
    ds_read_b128 v[172:175], v239 offset:128
    v_mfma_f32_4x4x4_16b_bf16 v[136:139], v[218:219], v[70:71], v[8:11]
    ds_read_b128 v[176:179], v239 offset:192
    ds_read_u16 v224, v238
    v_mfma_f32_4x4x4_16b_bf16 v[140:143], v[220:221], v[72:73], v[12:15]
    ds_read_u16 v225, v238 offset:8
    ds_read_u16 v226, v238 offset:64
    v_mfma_f32_4x4x4_16b_bf16 v[144:147], v[222:223], v[74:75], v[16:19]
    ds_read_u16 v227, v238 offset:72
    v_add_u32 v239, 272, v239
    v_mfma_f32_4x4x4_16b_bf16 v[246:249], v[216:217], v[76:77], v[20:23]
    v_cvt_pk_bf16_f32 v100, v132, v133
    v_cvt_pk_bf16_f32 v101, v134, v135
    v_mfma_f32_4x4x4_16b_bf16 v[250:253], v[218:219], v[78:79], v[24:27]
    v_cvt_pk_bf16_f32 v102, v136, v137
    v_cvt_pk_bf16_f32 v103, v138, v139
    v_mfma_f32_4x4x4_16b_bf16 v[132:135], v[220:221], v[80:81], v[28:31]
    v_cvt_pk_bf16_f32 v104, v140, v141
    v_cvt_pk_bf16_f32 v105, v142, v143
    v_mfma_f32_4x4x4_16b_bf16 v[136:139], v[222:223], v[82:83], v[32:35]
    v_cvt_pk_bf16_f32 v106, v144, v145
    v_cvt_pk_bf16_f32 v107, v146, v147
    v_mfma_f32_4x4x4_16b_bf16 v[140:143], v[216:217], v[84:85], v[36:39]
    v_cvt_pk_bf16_f32 v108, v246, v247
    v_cvt_pk_bf16_f32 v109, v248, v249
    v_mfma_f32_4x4x4_16b_bf16 v[144:147], v[218:219], v[86:87], v[40:43]
    v_cvt_pk_bf16_f32 v110, v250, v251
    v_cvt_pk_bf16_f32 v111, v252, v253
    v_mfma_f32_4x4x4_16b_bf16 v[246:249], v[220:221], v[88:89], v[44:47]
    v_cvt_pk_bf16_f32 v112, v132, v133
    v_cvt_pk_bf16_f32 v113, v134, v135
    v_mfma_f32_4x4x4_16b_bf16 v[250:253], v[222:223], v[90:91], v[48:51]
    v_cvt_pk_bf16_f32 v114, v136, v137
    v_cvt_pk_bf16_f32 v115, v138, v139
    v_mfma_f32_4x4x4_16b_bf16 v[132:135], v[216:217], v[92:93], v[52:55]
    v_cvt_pk_bf16_f32 v116, v140, v141
    v_cvt_pk_bf16_f32 v117, v142, v143
    v_mfma_f32_4x4x4_16b_bf16 v[136:139], v[218:219], v[94:95], v[56:59]
    v_cvt_pk_bf16_f32 v118, v144, v145
    v_cvt_pk_bf16_f32 v119, v146, v147
    v_mfma_f32_4x4x4_16b_bf16 v[140:143], v[220:221], v[96:97], v[60:63]
    v_cvt_pk_bf16_f32 v120, v246, v247
    v_cvt_pk_bf16_f32 v121, v248, v249
    v_mfma_f32_4x4x4_16b_bf16 v[144:147], v[222:223], v[98:99], v[64:67]
    v_cvt_pk_bf16_f32 v122, v250, v251
    v_cvt_pk_bf16_f32 v123, v252, v253
    v_cvt_pk_bf16_f32 v124, v132, v133
    v_cvt_pk_bf16_f32 v125, v134, v135
    v_cvt_pk_bf16_f32 v126, v136, v137
    v_cvt_pk_bf16_f32 v127, v138, v139
    v_cvt_pk_bf16_f32 v128, v140, v141
    v_cvt_pk_bf16_f32 v129, v142, v143
    v_cvt_pk_bf16_f32 v130, v144, v145
    v_cvt_pk_bf16_f32 v131, v146, v147
    s_waitcnt lgkmcnt(0)
    s_branch Ls_evd1
Ls_ev2:
    s_bitcmp0_b64 s[56:57], 2
    s_cbranch_scc1 Ls_nf2
    v_cvt_pk_bf16_f32 v246, v212, v212
    v_mov_b32 v212, 0
    ds_write_b16 v240, v246
    s_sub_u32 s48, s48, 1
    s_cselect_b32 s66, s47, 0
    s_cselect_b32 s48, 64, s48
    s_add_u32 s66, s66, 128
    v_add_u32 v240, s66, v240
    s_add_u32 s24, s24, s32
    s_addc_u32 s25, s25, 0
    s_xor_b32 s32, s32, 0x18ffe0
Ls_nf2:
    s_bitcmp0_b64 s[56:57], 7
    s_cbranch_scc1 Ls_na2
    s_cmp_lg_u32 s60, 2
    s_cbranch_scc1 Ls_ns2
    s_mov_b32 s49, 7
    s_call_b64 s[62:63], L_swap
    ds_read_u8 v230, v237 offset:96
    ds_read_u8 v232, v237 offset:104
    s_add_u32 s35, s35, s31
    s_min_u32 s35, s35, 419404800
    s_sub_u32 s60, s60, 1
    s_bitcmp1_b32 s60, 0
    s_cselect_b32 s31, 25600, s51
    s_bitcmp0_b64 s[56:57], 4
    s_cbranch_scc1 Ls_evd2
    s_waitcnt lgkmcnt(0)
    s_branch Ls_e12
Ls_ns2:
    s_add_u32 s35, s35, s31
    s_min_u32 s35, s35, 419404800
    s_sub_u32 s60, s60, 1
    s_bitcmp1_b32 s60, 0
    s_cselect_b32 s31, 25600, s51
Ls_na2:
    s_bitcmp0_b64 s[56:57], 4
    s_cbranch_scc1 Ls_evd2
Ls_e12:
    s_sub_u32 s61, s61, 1
    s_cbranch_scc1 Ls_last2
    s_cmp_lg_u32 s61, s45
    s_cbranch_scc1 Ls_nw2
    v_add_u32 v238, s47, v238
    v_add_u32 v239, s47, v239
    ds_read_u16 v224, v238 offset:0
    ds_read_u16 v225, v238 offset:8
    ds_read_u16 v226, v238 offset:64
    ds_read_u16 v227, v238 offset:72
    s_waitcnt lgkmcnt(0)
Ls_nw2:
    v_mul_u32_u24 v216, v224, v241
    v_mul_u32_u24 v217, v224, v242
    v_mul_u32_u24 v218, v225, v241
    v_mul_u32_u24 v219, v225, v242
    v_mul_u32_u24 v220, v226, v241
    v_mul_u32_u24 v221, v226, v242
    v_mul_u32_u24 v222, v227, v241
    v_mul_u32_u24 v223, v227, v242
    v_add_u32 v238, 128, v238
    ds_read_b128 v[164:167], v239
    v_mfma_f32_4x4x4_16b_bf16 v[132:135], v[216:217], v[68:69], v[4:7]
    ds_read_b128 v[168:171], v239 offset:64
    ds_read_b128 v[172:175], v239 offset:128
    v_mfma_f32_4x4x4_16b_bf16 v[136:139], v[218:219], v[70:71], v[8:11]
    ds_read_b128 v[176:179], v239 offset:192
    ds_read_u16 v224, v238
    v_mfma_f32_4x4x4_16b_bf16 v[140:143], v[220:221], v[72:73], v[12:15]
    ds_read_u16 v225, v238 offset:8
    ds_read_u16 v226, v238 offset:64
    v_mfma_f32_4x4x4_16b_bf16 v[144:147], v[222:223], v[74:75], v[16:19]
    ds_read_u16 v227, v238 offset:72
    v_add_u32 v239, 272, v239
    v_mfma_f32_4x4x4_16b_bf16 v[246:249], v[216:217], v[76:77], v[20:23]
    v_cvt_pk_bf16_f32 v100, v132, v133
    v_cvt_pk_bf16_f32 v101, v134, v135
    v_mfma_f32_4x4x4_16b_bf16 v[250:253], v[218:219], v[78:79], v[24:27]
    v_cvt_pk_bf16_f32 v102, v136, v137
    v_cvt_pk_bf16_f32 v103, v138, v139
    v_mfma_f32_4x4x4_16b_bf16 v[132:135], v[220:221], v[80:81], v[28:31]
    v_cvt_pk_bf16_f32 v104, v140, v141
    v_cvt_pk_bf16_f32 v105, v142, v143
    v_mfma_f32_4x4x4_16b_bf16 v[136:139], v[222:223], v[82:83], v[32:35]
    v_cvt_pk_bf16_f32 v106, v144, v145
    v_cvt_pk_bf16_f32 v107, v146, v147
    v_mfma_f32_4x4x4_16b_bf16 v[140:143], v[216:217], v[84:85], v[36:39]
    v_cvt_pk_bf16_f32 v108, v246, v247
    v_cvt_pk_bf16_f32 v109, v248, v249
    v_mfma_f32_4x4x4_16b_bf16 v[144:147], v[218:219], v[86:87], v[40:43]
    v_cvt_pk_bf16_f32 v110, v250, v251
    v_cvt_pk_bf16_f32 v111, v252, v253
    v_mfma_f32_4x4x4_16b_bf16 v[246:249], v[220:221], v[88:89], v[44:47]
    v_cvt_pk_bf16_f32 v112, v132, v133
    v_cvt_pk_bf16_f32 v113, v134, v135
    v_mfma_f32_4x4x4_16b_bf16 v[250:253], v[222:223], v[90:91], v[48:51]
    v_cvt_pk_bf16_f32 v114, v136, v137
    v_cvt_pk_bf16_f32 v115, v138, v139
    v_mfma_f32_4x4x4_16b_bf16 v[132:135], v[216:217], v[92:93], v[52:55]
    v_cvt_pk_bf16_f32 v116, v140, v141
    v_cvt_pk_bf16_f32 v117, v142, v143
    v_mfma_f32_4x4x4_16b_bf16 v[136:139], v[218:219], v[94:95], v[56:59]
    v_cvt_pk_bf16_f32 v118, v144, v145
    v_cvt_pk_bf16_f32 v119, v146, v147
    v_mfma_f32_4x4x4_16b_bf16 v[140:143], v[220:221], v[96:97], v[60:63]
    v_cvt_pk_bf16_f32 v120, v246, v247
    v_cvt_pk_bf16_f32 v121, v248, v249
    v_mfma_f32_4x4x4_16b_bf16 v[144:147], v[222:223], v[98:99], v[64:67]
    v_cvt_pk_bf16_f32 v122, v250, v251
    v_cvt_pk_bf16_f32 v123, v252, v253
    v_cvt_pk_bf16_f32 v124, v132, v133
    v_cvt_pk_bf16_f32 v125, v134, v135
    v_cvt_pk_bf16_f32 v126, v136, v137
    v_cvt_pk_bf16_f32 v127, v138, v139
    v_cvt_pk_bf16_f32 v128, v140, v141
    v_cvt_pk_bf16_f32 v129, v142, v143
    v_cvt_pk_bf16_f32 v130, v144, v145
    v_cvt_pk_bf16_f32 v131, v146, v147
    s_waitcnt lgkmcnt(0)
    s_branch Ls_evd2
Ls_ev3:
    s_bitcmp0_b64 s[56:57], 3
    s_cbranch_scc1 Ls_nf3
    v_cvt_pk_bf16_f32 v246, v212, v212
    v_mov_b32 v212, 0
    ds_write_b16 v240, v246
    s_sub_u32 s48, s48, 1
    s_cselect_b32 s66, s47, 0
    s_cselect_b32 s48, 64, s48
    s_add_u32 s66, s66, 128
    v_add_u32 v240, s66, v240
    s_add_u32 s24, s24, s32
    s_addc_u32 s25, s25, 0
    s_xor_b32 s32, s32, 0x18ffe0
Ls_nf3:
    s_bitcmp0_b64 s[56:57], 8
    s_cbranch_scc1 Ls_na3
    s_cmp_lg_u32 s60, 2
    s_cbranch_scc1 Ls_ns3
    s_mov_b32 s49, 8
    s_call_b64 s[62:63], L_swap
    ds_read_u8 v230, v237 offset:112
    ds_read_u8 v232, v237 offset:120
    s_add_u32 s35, s35, s31
    s_min_u32 s35, s35, 419404800
    s_sub_u32 s60, s60, 1
    s_bitcmp1_b32 s60, 0
    s_cselect_b32 s31, 25600, s51
    s_bitcmp0_b64 s[56:57], 5
    s_cbranch_scc1 Ls_evd3
    s_waitcnt lgkmcnt(0)
    s_branch Ls_e13
Ls_ns3:
    s_add_u32 s35, s35, s31
    s_min_u32 s35, s35, 419404800
    s_sub_u32 s60, s60, 1
    s_bitcmp1_b32 s60, 0
    s_cselect_b32 s31, 25600, s51
Ls_na3:
    s_bitcmp0_b64 s[56:57], 5
    s_cbranch_scc1 Ls_evd3
Ls_e13:
    s_sub_u32 s61, s61, 1
    s_cbranch_scc1 Ls_last3
    s_cmp_lg_u32 s61, s45
    s_cbranch_scc1 Ls_nw3
    v_add_u32 v238, s47, v238
    v_add_u32 v239, s47, v239
    ds_read_u16 v224, v238 offset:0
    ds_read_u16 v225, v238 offset:8
    ds_read_u16 v226, v238 offset:64
    ds_read_u16 v227, v238 offset:72
    s_waitcnt lgkmcnt(0)
Ls_nw3:
    v_mul_u32_u24 v216, v224, v241
    v_mul_u32_u24 v217, v224, v242
    v_mul_u32_u24 v218, v225, v241
    v_mul_u32_u24 v219, v225, v242
    v_mul_u32_u24 v220, v226, v241
    v_mul_u32_u24 v221, v226, v242
    v_mul_u32_u24 v222, v227, v241
    v_mul_u32_u24 v223, v227, v242
    v_add_u32 v238, 128, v238
    ds_read_b128 v[164:167], v239
    v_mfma_f32_4x4x4_16b_bf16 v[132:135], v[216:217], v[68:69], v[4:7]
    ds_read_b128 v[168:171], v239 offset:64
    ds_read_b128 v[172:175], v239 offset:128
    v_mfma_f32_4x4x4_16b_bf16 v[136:139], v[218:219], v[70:71], v[8:11]
    ds_read_b128 v[176:179], v239 offset:192
    ds_read_u16 v224, v238
    v_mfma_f32_4x4x4_16b_bf16 v[140:143], v[220:221], v[72:73], v[12:15]
    ds_read_u16 v225, v238 offset:8
    ds_read_u16 v226, v238 offset:64
    v_mfma_f32_4x4x4_16b_bf16 v[144:147], v[222:223], v[74:75], v[16:19]
    ds_read_u16 v227, v238 offset:72
    v_add_u32 v239, 272, v239
    v_mfma_f32_4x4x4_16b_bf16 v[246:249], v[216:217], v[76:77], v[20:23]
    v_cvt_pk_bf16_f32 v100, v132, v133
    v_cvt_pk_bf16_f32 v101, v134, v135
    v_mfma_f32_4x4x4_16b_bf16 v[250:253], v[218:219], v[78:79], v[24:27]
    v_cvt_pk_bf16_f32 v102, v136, v137
    v_cvt_pk_bf16_f32 v103, v138, v139
    v_mfma_f32_4x4x4_16b_bf16 v[132:135], v[220:221], v[80:81], v[28:31]
    v_cvt_pk_bf16_f32 v104, v140, v141
    v_cvt_pk_bf16_f32 v105, v142, v143
    v_mfma_f32_4x4x4_16b_bf16 v[136:139], v[222:223], v[82:83], v[32:35]
    v_cvt_pk_bf16_f32 v106, v144, v145
    v_cvt_pk_bf16_f32 v107, v146, v147
    v_mfma_f32_4x4x4_16b_bf16 v[140:143], v[216:217], v[84:85], v[36:39]
    v_cvt_pk_bf16_f32 v108, v246, v247
    v_cvt_pk_bf16_f32 v109, v248, v249
    v_mfma_f32_4x4x4_16b_bf16 v[144:147], v[218:219], v[86:87], v[40:43]
    v_cvt_pk_bf16_f32 v110, v250, v251
    v_cvt_pk_bf16_f32 v111, v252, v253
    v_mfma_f32_4x4x4_16b_bf16 v[246:249], v[220:221], v[88:89], v[44:47]
    v_cvt_pk_bf16_f32 v112, v132, v133
    v_cvt_pk_bf16_f32 v113, v134, v135
    v_mfma_f32_4x4x4_16b_bf16 v[250:253], v[222:223], v[90:91], v[48:51]
    v_cvt_pk_bf16_f32 v114, v136, v137
    v_cvt_pk_bf16_f32 v115, v138, v139
    v_mfma_f32_4x4x4_16b_bf16 v[132:135], v[216:217], v[92:93], v[52:55]
    v_cvt_pk_bf16_f32 v116, v140, v141
    v_cvt_pk_bf16_f32 v117, v142, v143
    v_mfma_f32_4x4x4_16b_bf16 v[136:139], v[218:219], v[94:95], v[56:59]
    v_cvt_pk_bf16_f32 v118, v144, v145
    v_cvt_pk_bf16_f32 v119, v146, v147
    v_mfma_f32_4x4x4_16b_bf16 v[140:143], v[220:221], v[96:97], v[60:63]
    v_cvt_pk_bf16_f32 v120, v246, v247
    v_cvt_pk_bf16_f32 v121, v248, v249
    v_mfma_f32_4x4x4_16b_bf16 v[144:147], v[222:223], v[98:99], v[64:67]
    v_cvt_pk_bf16_f32 v122, v250, v251
    v_cvt_pk_bf16_f32 v123, v252, v253
    v_cvt_pk_bf16_f32 v124, v132, v133
    v_cvt_pk_bf16_f32 v125, v134, v135
    v_cvt_pk_bf16_f32 v126, v136, v137
    v_cvt_pk_bf16_f32 v127, v138, v139
    v_cvt_pk_bf16_f32 v128, v140, v141
    v_cvt_pk_bf16_f32 v129, v142, v143
    v_cvt_pk_bf16_f32 v130, v144, v145
    v_cvt_pk_bf16_f32 v131, v146, v147
    s_waitcnt lgkmcnt(0)
    s_branch Ls_evd3
Ls_last0:
    s_branch Ls_tail
Ls_last1:
    v_add_u32 v236, 2080, v236
    s_lshr_b64 s[56:57], s[56:57], 1
    v_add_u32 v244, 16, v244
    s_branch Ls_tail
Ls_last2:
    v_add_u32 v236, 4160, v236
    s_lshr_b64 s[56:57], s[56:57], 2
    v_add_u32 v244, 32, v244
    s_branch Ls_tail
Ls_last3:
    v_add_u32 v236, 6240, v236
    s_lshr_b64 s[56:57], s[56:57], 3
    v_add_u32 v244, 48, v244
Ls_tail:
    ds_read_b32 v246, v244 offset:0
    s_waitcnt lgkmcnt(0)
    v_bfe_u32 v247, v246, 0, 8
    v_lshlrev_b32 v247, 1, v247
    v_bfe_u32 v248, v246, 8, 8
    v_lshlrev_b32 v248, 1, v248
    v_bfe_u32 v249, v246, 16, 8
    v_lshlrev_b32 v249, 1, v249
    v_bfe_u32 v250, v246, 24, 8
    v_lshlrev_b32 v250, 1, v250
    buffer_load_ushort v247, v247, s[24:27], 0 offen
    buffer_load_ushort v248, v248, s[24:27], 0 offen
    buffer_load_ushort v249, v249, s[24:27], 0 offen
    buffer_load_ushort v250, v250, s[24:27], 0 offen
    s_waitcnt vmcnt(0)
    v_lshlrev_b32 v247, 16, v247
    v_mul_f32 v208, v208, v247
    v_lshlrev_b32 v248, 16, v248
    v_mul_f32 v209, v209, v248
    v_lshlrev_b32 v249, 16, v249
    v_mul_f32 v210, v210, v249
    v_lshlrev_b32 v250, 16, v250
    v_mul_f32 v211, v211, v250
    v_exp_f32 v132, v148
    v_exp_f32 v133, v149
    v_exp_f32 v134, v150
    v_exp_f32 v135, v151
    v_exp_f32 v136, v152
    v_exp_f32 v137, v153
    v_mfma_f32_4x4x4_16b_bf16 v[132:135], v[228:229], v[228:229], v[132:135]
    v_cvt_pk_bf16_f32 v208, v208, v209
    v_cvt_pk_bf16_f32 v209, v210, v211
    v_exp_f32 v138, v154
    s_nop 0
    v_mfma_f32_4x4x4_16b_bf16 v[212:215], v[208:209], v[188:189], v[212:215] cbsz:4 abid:0
    ds_read_b64_tr_b16 v[188:189], v236 offset:0
    v_exp_f32 v139, v155
    v_exp_f32 v140, v156
    v_mfma_f32_4x4x4_16b_bf16 v[212:215], v[208:209], v[190:191], v[212:215] cbsz:4 abid:4
    ds_read_b64_tr_b16 v[190:191], v236 offset:512
    v_mfma_f32_4x4x4_16b_bf16 v[136:139], v[228:229], v[228:229], v[136:139]
    v_rcp_f32 v132, v132
    v_mfma_f32_4x4x4_16b_bf16 v[212:215], v[208:209], v[192:193], v[212:215] cbsz:4 abid:8
    ds_read_b64_tr_b16 v[192:193], v236 offset:1056
    v_exp_f32 v141, v157
    v_rcp_f32 v133, v133
    v_mfma_f32_4x4x4_16b_bf16 v[212:215], v[208:209], v[194:195], v[212:215] cbsz:4 abid:12
    ds_read_b64_tr_b16 v[194:195], v236 offset:1568
    v_exp_f32 v142, v158
    v_rcp_f32 v134, v134
    v_exp_f32 v143, v159
    v_rcp_f32 v135, v135
    v_cvt_pk_bf16_f32 v132, v132, v133
    v_mfma_f32_4x4x4_16b_bf16 v[140:143], v[228:229], v[228:229], v[140:143]
    v_exp_f32 v144, v160
    v_rcp_f32 v136, v136
    v_cvt_pk_bf16_f32 v133, v134, v135
    s_bitcmp0_b64 s[56:57], 1
    s_cbranch_scc1 Ls_tnf
    v_cvt_pk_bf16_f32 v246, v212, v212
    v_mov_b32 v212, 0
    ds_write_b16 v240, v246
    s_sub_u32 s48, s48, 1
    s_cselect_b32 s66, s47, 0
    s_cselect_b32 s48, 64, s48
    s_add_u32 s66, s66, 128
    v_add_u32 v240, s66, v240
    s_add_u32 s24, s24, s32
    s_addc_u32 s25, s25, 0
    s_xor_b32 s32, s32, 0x18ffe0
Ls_tnf:
    s_waitcnt lgkmcnt(0)
    v_exp_f32 v145, v161
    v_rcp_f32 v137, v137
    v_exp_f32 v146, v162
    v_rcp_f32 v138, v138
    v_cvt_pk_bf16_f32 v134, v136, v137
    v_exp_f32 v147, v163
    v_rcp_f32 v139, v139
    s_nop 0
    v_mfma_f32_4x4x4_16b_bf16 v[144:147], v[228:229], v[228:229], v[144:147]
    v_rcp_f32 v140, v140
    v_rcp_f32 v141, v141
    v_cvt_pk_bf16_f32 v135, v138, v139
    v_rcp_f32 v142, v142
    v_cvt_pk_bf16_f32 v136, v140, v141
    v_mfma_f32_16x16x32_bf16 v[208:211], v[132:135], v[196:199], v[204:207]
    v_rcp_f32 v143, v143
    v_rcp_f32 v144, v144
    v_cvt_pk_bf16_f32 v137, v142, v143
    v_rcp_f32 v145, v145
    v_rcp_f32 v146, v146
    v_rcp_f32 v147, v147
    v_cvt_pk_bf16_f32 v138, v144, v145
    v_cvt_pk_bf16_f32 v139, v146, v147
    s_nop 1
    v_mfma_f32_16x16x32_bf16 v[208:211], v[136:139], v[200:203], v[208:211]
    ds_read_b32 v246, v244 offset:16
    s_waitcnt lgkmcnt(0)
    v_bfe_u32 v247, v246, 0, 8
    v_lshlrev_b32 v247, 1, v247
    v_bfe_u32 v248, v246, 8, 8
    v_lshlrev_b32 v248, 1, v248
    v_bfe_u32 v249, v246, 16, 8
    v_lshlrev_b32 v249, 1, v249
    v_bfe_u32 v250, v246, 24, 8
    v_lshlrev_b32 v250, 1, v250
    buffer_load_ushort v247, v247, s[24:27], 0 offen
    buffer_load_ushort v248, v248, s[24:27], 0 offen
    buffer_load_ushort v249, v249, s[24:27], 0 offen
    buffer_load_ushort v250, v250, s[24:27], 0 offen
    s_waitcnt vmcnt(0)
    v_lshlrev_b32 v247, 16, v247
    v_mul_f32 v208, v208, v247
    v_lshlrev_b32 v248, 16, v248
    v_mul_f32 v209, v209, v248
    v_lshlrev_b32 v249, 16, v249
    v_mul_f32 v210, v210, v249
    v_lshlrev_b32 v250, 16, v250
    v_mul_f32 v211, v211, v250
    v_cvt_pk_bf16_f32 v208, v208, v209
    v_cvt_pk_bf16_f32 v209, v210, v211
    s_nop 1
    v_mfma_f32_4x4x4_16b_bf16 v[212:215], v[208:209], v[188:189], v[212:215] cbsz:4 abid:0
    s_nop 1
    v_mfma_f32_4x4x4_16b_bf16 v[212:215], v[208:209], v[190:191], v[212:215] cbsz:4 abid:4
    s_nop 1
    v_mfma_f32_4x4x4_16b_bf16 v[212:215], v[208:209], v[192:193], v[212:215] cbsz:4 abid:8
    s_nop 1
    v_mfma_f32_4x4x4_16b_bf16 v[212:215], v[208:209], v[194:195], v[212:215] cbsz:4 abid:12
    s_nop 4
    v_cvt_pk_bf16_f32 v246, v212, v212
    ds_write_b16 v240, v246
    s_branch L_store
.section .rodata,"a"
.p2align 6
.amdhsa_kernel standalone__sequential_behavior_din__recsys_kernel
  .amdhsa_next_free_vgpr 256
  .amdhsa_next_free_sgpr 102
  .amdhsa_accum_offset 256
  .amdhsa_group_segment_fixed_size 0
  .amdhsa_kernarg_size 80
  .amdhsa_user_sgpr_count 2
  .amdhsa_user_sgpr_kernarg_segment_ptr 1
  .amdhsa_system_sgpr_workgroup_id_x 1
.end_amdhsa_kernel
```

```asm
; @launch grid=(256,1,1) block=(512,1,1) lds=163840
.amdgcn_target "amdgcn-amd-amdhsa--gfx950"
.text
.globl standalone__sequential_behavior_din__recsys_kernel
.p2align 8
.type standalone__sequential_behavior_din__recsys_kernel,@function
standalone__sequential_behavior_din__recsys_kernel:
    s_load_dwordx16 s[4:19], s[0:1], 0
    s_cmp_ge_u32 s2, 256
    s_cbranch_scc1 L_end
    v_lshrrev_b32 v1, 6, v0
    v_and_b32 v0, 63, v0
    v_readfirstlane_b32 s54, v1
    s_lshl_b32 s53, s2, 3
    v_lshlrev_b32 v2, 4, v0
    v_lshrrev_b32 v1, 4, v0
    v_and_b32 v3, 0xf0, v2
    v_lshlrev_b32 v3, 2, v3
    v_lshl_add_u32 v130, v1, 4, v3
    v_bfrev_b32 v3, 1
    s_add_u32 s53, s53, s54
    s_movk_i32 s66, 800
    v_cmp_gt_u32 vcc, s66, v130
    s_mul_i32 s93, s53, 800
    s_mul_i32 s52, s54, 20480
    s_mov_b64 s[28:29], vcc
    v_cndmask_b32 v3, v3, v130, vcc
    v_and_b32 v248, 16, v0
    v_lshlrev_b32 v246, 1, v248
    v_xor_b32 v246, v246, v2
    v_and_b32 v243, 0xf0, v2
    v_lshl_add_u32 v243, v1, 19, v243
    s_lshl_b32 s66, s53, 8
    v_add_u32 v243, s66, v243
    s_lshl_b32 s67, s54, 12
    s_add_u32 m0, s52, 8320
    s_mov_b32 s26, 6553600
    s_mov_b32 s27, 0x20000
    s_waitcnt lgkmcnt(0)
    s_mov_b32 s24, s8
    s_and_b32 s25, s9, 0xffff
    s_cmp_ge_u32 s54, 4
    s_cbranch_scc1 L_young0
    buffer_load_dwordx4 v[100:103], v3, s[24:27], s93 offen nt
L_young0:
    global_load_lds_dwordx4 v243, s[4:5] nt
    s_add_u32 m0, s52, 4160
    s_add_u32 s10, s10, s67
    s_addc_u32 s11, s11, 0
    v_xor_b32 v247, 64, v246
    global_load_lds_dwordx4 v246, s[10:11] offset:0
    global_load_lds_dwordx4 v247, s[10:11] offset:1024
    global_load_lds_dwordx4 v246, s[10:11] offset:2048
    global_load_lds_dwordx4 v247, s[10:11] offset:3072
    s_load_dword s30, s[16:17], 0
    s_and_b32 s67, s54, 3
    v_and_b32 v250, 3, v0
    s_mov_b32 s20, s6
    s_and_b32 s21, s7, 0xffff
    s_or_b32 s21, s21, 0x800000
    s_mov_b32 s22, 200
    s_mov_b32 s23, 0x20000
    s_sub_u32 s40, s20, 1056
    s_subb_u32 s41, s21, 0
    s_mov_b32 s42, 200
    s_mov_b32 s43, 0x20000
    s_mul_i32 s35, s53, 51200
    s_movk_i32 s31, 25600
    s_mov_b32 s60, 5
    s_mov_b64 s[56:57], 0
    s_mov_b64 s[58:59], 0
    v_mov_b32 v148, -1
    v_mov_b32 v149, -1
    v_mov_b32 v150, -1
    v_mov_b32 v151, -1
    s_add_u32 s66, s52, 18432
    v_add_u32 v152, s66, v2
    ds_write_b128 v152, v[148:151]
    ds_write_b128 v152, v[148:151] offset:1024
    s_add_u32 s64, s52, 18448
    v_mov_b32 v153, -1
    v_mov_b32 v154, -1
    v_mov_b32 v155, -1
    v_lshrrev_b32 v237, 3, v0
    v_add_u32 v237, s64, v237
    v_lshl_add_u32 v244, v1, 2, s66
    v_and_b32 v231, 0x70, v2
    v_lshlrev_b32 v248, 2, v248
    v_xor_b32 v231, v231, v248
    v_mov_b32 v233, v231
    s_movk_i32 s66, 400
    v_cmp_le_u32 vcc, s66, v130
    v_lshrrev_b32 v126, 1, v130
    s_movk_i32 s66, -200
    v_cndmask_b32 v130, 0, 1, vcc
    v_mad_i32_i24 v126, v130, s66, v126
    v_mul_u32_u24 v127, 0x10001, v126
    v_add_u32 v126, 0x10000, v127
    v_add_u32 v128, 0x50004, v127
    v_add_u32 v129, 0x70006, v127
    v_add_u32 v127, 0x30002, v127
    v_mov_b32 v131, 0xbfe0bfe0
    s_mov_b32 s86, 0xfff0ffff
    s_mov_b32 s87, 0xf000ff00
    s_mov_b32 s88, 0xff00fff0
    s_mov_b32 s89, 0xf000
    s_mov_b32 s90, 0xf0000f
    s_mov_b32 s91, 0xf0000f00
    s_mov_b32 s84, 0x11111113
    s_mov_b32 s85, 0x11111111
    v_cndmask_b32 v116, 0, v131, s[86:87]
    v_cndmask_b32 v120, 0, v131, s[88:89]
    v_cndmask_b32 v117, 0, v131, s[86:87]
    v_cndmask_b32 v121, 0, v131, s[88:89]
    v_cndmask_b32 v122, 0, v131, s[84:85]
    v_cndmask_b32 v123, 0, v131, s[84:85]
    v_cndmask_b32 v124, 0, v131, s[84:85]
    v_cndmask_b32 v125, 0, v131, s[84:85]
    v_lshlrev_b32 v246, 4, v250
    v_sub_u32 v246, 48, v246
    s_mov_b32 s86, 0xbfe0bfe0
    s_mov_b32 s87, 0xf0bfe0
    v_lshrrev_b64 v[118:119], v246, s[86:87]
    v_mov_b32 v131, 0
    s_mov_b64 s[84:85], 0
    v_cndmask_b32 v118, v120, v118, s[90:91]
    v_cndmask_b32 v119, v121, v119, s[90:91]
    s_mov_b32 s61, 7
    s_mov_b32 s92, 0xbfb8aa3b
    v_and_b32 v251, 15, v0
    v_bfe_u32 v252, v0, 2, 2
    v_lshlrev_b32 v253, 3, v250
    v_lshl_add_u32 v253, v252, 7, v253
    v_and_b32 v246, 24, v0
    v_lshlrev_b32 v246, 2, v246
    v_xor_b32 v246, v253, v246
    v_lshl_add_u32 v246, v1, 10, v246
    s_lshl_b32 s66, s67, 5
    v_xor_b32 v66, s66, v246
    v_add_u32 v66, 45120, v66
    s_lshr_b32 s66, s54, 1
    s_lshl_b32 s66, s66, 5
    v_xor_b32 v64, s66, v246
    s_and_b32 s66, s54, 1
    s_mul_i32 s66, s66, 20480
    s_add_u32 s66, s66, 4160
    v_add_u32 v64, s66, v64
    v_add_u32 v65, 81920, v64
    s_and_b32 s66, s54, 4
    v_lshrrev_b32 v246, 3, v251
    v_add_u32 v246, s66, v246
    v_mul_u32_u24 v246, 20480, v246
    v_lshl_add_u32 v246, v1, 4, v246
    v_and_b32 v247, 7, v0
    v_lshl_add_u32 v67, v247, 7, v246
    v_and_b32 v247, 1, v0
    v_lshlrev_b32 v247, 4, v247
    v_lshlrev_b32 v247, v247, 1
    v_cmp_gt_u32 vcc, 2, v250
    v_mov_b32 v229, 0
    v_mov_b32 v228, 0x3f80
    v_cndmask_b32 v241, 0, v247, vcc
    v_cmp_eq_u32 vcc, 0, v251
    v_sub_u32 v242, v247, v241
    v_mul_u32_u24 v218, 0x3f80, v241
    v_cndmask_b32 v220, 0, -1, vcc
    v_mul_u32_u24 v219, 0x3f80, v242
    s_and_b32 s66, s54, 3
    s_lshl_b32 s66, s66, 6
    s_add_u32 s66, s66, 9344
    v_and_b32 v247, 7, v0
    v_mul_u32_u24 v247, 144, v247
    v_add3_u32 v98, v67, v247, s66
    s_add_u32 s66, s52, 14592
    v_lshl_add_u32 v221, v0, 2, s66
    ds_write_b32 v221, v229
    s_xor_b32 s66, s54, 4
    s_mul_i32 s66, s66, 20480
    s_add_u32 s66, s66, 14592
    v_writelane_b32 v221, s66, 1
    v_mov_b32 v222, s52
    ds_write_b32 v222, v229 offset:14848
    ds_write_b32 v222, v229 offset:14864
    s_mov_b32 s47, 0
    s_mov_b32 s50, 0
    v_and_b32 v247, 8, v0
    v_lshlrev_b32 v247, 2, v247
    v_lshl_add_u32 v247, v251, 7, v247
    v_add_u32 v247, s52, v247
    v_and_b32 v248, 2, v0
    v_lshlrev_b32 v248, 1, v248
    v_xor_b32 v248, v248, v1
    v_lshl_add_u32 v234, v248, 4, v247
    v_xor_b32 v248, 4, v248
    v_lshl_add_u32 v235, v248, 4, v247
    v_and_b32 v247, 8, v0
    v_lshlrev_b32 v247, 3, v247
    v_lshl_add_u32 v248, v1, 5, v253
    v_xor_b32 v248, v248, v247
    v_add_u32 v236, s52, v248
    s_add_u32 s66, s52, 8320
    v_lshl_add_u32 v238, v250, 1, s66
    v_lshl_add_u32 v238, v1, 4, v238
    s_add_u32 s66, s52, 14880
    v_lshl_add_u32 v240, v0, 1, s66
    s_add_u32 s66, s52, 9344
    v_lshl_add_u32 v239, v1, 4, s66
    v_mov_b32 v188, 0
    v_mov_b32 v189, 0
    v_mov_b32 v190, 0
    v_mov_b32 v191, 0
    v_mov_b32 v192, 0
    v_mov_b32 v193, 0
    v_mov_b32 v194, 0
    v_mov_b32 v195, 0
    v_mov_b32 v208, 0
    v_mov_b32 v212, 0
    v_mov_b32 v209, 0
    v_mov_b32 v213, 0
    v_mov_b32 v210, 0
    v_mov_b32 v214, 0
    v_mov_b32 v211, 0
    v_mov_b32 v215, 0
    s_and_b32 s66, s54, 3
    s_lshl_b32 s66, s66, 5
    v_lshl_add_u32 v249, v1, 3, s66
    global_load_dwordx2 v[96:97], v249, s[12:13]
    s_cmp_ge_u32 s54, 4
    s_cbranch_scc0 L_old3z
    buffer_load_dwordx4 v[100:103], v3, s[24:27], s93 offen nt
L_old3z:
    s_cmp_ge_u32 s54, 4
    s_cbranch_scc1 L_young1
    s_waitcnt vmcnt(6) lgkmcnt(0)
    s_call_b64 s[62:63], L_fp
    s_waitcnt vmcnt(5)
    s_branch L_old1
L_young1:
    s_waitcnt vmcnt(2)
L_old1:
    s_waitcnt lgkmcnt(0)
    s_barrier
    ds_read_b64_tr_b16 v[16:17], v66 offset:0
    ds_read_b64_tr_b16 v[18:19], v66 offset:512
    ds_read_b64_tr_b16 v[20:21], v66 offset:20480
    ds_read_b64_tr_b16 v[22:23], v66 offset:20992
    ds_read_b64_tr_b16 v[24:25], v66 offset:40960
    ds_read_b64_tr_b16 v[26:27], v66 offset:41472
    ds_read_b64_tr_b16 v[28:29], v66 offset:61440
    ds_read_b64_tr_b16 v[30:31], v66 offset:61952
    ds_read_b128 v[32:35], v67 offset:8320
    ds_read_b128 v[36:39], v67 offset:8384
    ds_read_b128 v[40:43], v67 offset:49280
    ds_read_b128 v[44:47], v67 offset:49344
    ds_read_b64_tr_b16 v[4:5], v64 offset:0
    ds_read_b64_tr_b16 v[8:9], v65 offset:0
    ds_read_b64_tr_b16 v[12:13], v65 offset:40960
    ds_read_b64_tr_b16 v[6:7], v64 offset:512
    ds_read_b64_tr_b16 v[10:11], v65 offset:512
    ds_read_b64_tr_b16 v[14:15], v65 offset:41472
    s_cmp_ge_u32 s54, 4
    s_cbranch_scc1 L_young2
    s_waitcnt vmcnt(4)
    s_branch L_old2
L_young2:
    s_waitcnt vmcnt(1)
L_old2:
    s_add_u32 s93, s93, 1638400
    buffer_load_dwordx4 v[104:107], v3, s[24:27], s93 offen nt
    s_add_u32 s93, s93, 1638400
    buffer_load_dwordx4 v[108:111], v3, s[24:27], s93 offen nt
    s_add_u32 s93, s93, 1638400
    buffer_load_dwordx4 v[112:115], v3, s[24:27], s93 offen nt
    v_lshlrev_b32 v249, 3, v1
    v_lshl_add_u32 v249, v250, 5, v249
    global_load_dwordx2 v[216:217], v249, s[14:15]
    v_lshlrev_b32 v48, 16, v96
    v_and_b32 v49, 0xffff0000, v96
    v_lshlrev_b32 v50, 16, v97
    v_and_b32 v51, 0xffff0000, v97
    s_lshl_b32 s30, s30, 16
    v_and_b32 v204, s30, v220
    v_and_b32 v205, s30, v220
    v_and_b32 v206, s30, v220
    v_and_b32 v207, s30, v220
    s_waitcnt lgkmcnt(0)
    v_xor_b32 v24, 0x80008000, v24
    v_xor_b32 v25, 0x80008000, v25
    v_xor_b32 v26, 0x80008000, v26
    v_xor_b32 v27, 0x80008000, v27
    v_xor_b32 v28, 0x80008000, v28
    v_xor_b32 v29, 0x80008000, v29
    v_xor_b32 v30, 0x80008000, v30
    v_xor_b32 v31, 0x80008000, v31
    v_mfma_f32_4x4x4_16b_bf16 v[56:59], v[218:219], v[4:5], 0
    v_mfma_f32_4x4x4_16b_bf16 v[68:71], v[218:219], v[12:13], 0
    v_mfma_f32_4x4x4_16b_bf16 v[60:63], v[218:219], v[6:7], 0
    v_mfma_f32_4x4x4_16b_bf16 v[72:75], v[218:219], v[14:15], 0
    v_mfma_f32_4x4x4_16b_bf16 v[56:59], v[218:219], v[8:9], v[56:59]
    v_mfma_f32_4x4x4_16b_bf16 v[60:63], v[218:219], v[10:11], v[60:63]
    v_mfma_f32_16x16x32_bf16 v[52:55], v[16:19], v[40:43], v[48:51]
    v_mfma_f32_16x16x32_bf16 v[52:55], v[20:23], v[44:47], v[52:55]
    v_mfma_f32_16x16x32_bf16 v[52:55], v[24:27], v[40:43], v[52:55]
    v_mfma_f32_16x16x32_bf16 v[52:55], v[28:31], v[44:47], v[52:55]
    v_mfma_f32_16x16x32_bf16 v[48:51], v[16:19], v[32:35], v[48:51]
    v_mfma_f32_16x16x32_bf16 v[48:51], v[20:23], v[36:39], v[48:51]
    v_mfma_f32_16x16x32_bf16 v[48:51], v[24:27], v[32:35], v[48:51]
    v_mfma_f32_16x16x32_bf16 v[48:51], v[28:31], v[36:39], v[48:51]
    v_mul_f32 v56, s92, v56
    v_mul_f32 v57, s92, v57
    v_mul_f32 v58, s92, v58
    v_mul_f32 v59, s92, v59
    v_mul_f32 v60, s92, v60
    v_mul_f32 v61, s92, v61
    v_mul_f32 v62, s92, v62
    v_mul_f32 v63, s92, v63
    v_mul_f32 v68, s92, v68
    v_mul_f32 v69, s92, v69
    v_mul_f32 v70, s92, v70
    v_mul_f32 v71, s92, v71
    v_mul_f32 v72, s92, v72
    v_mul_f32 v73, s92, v73
    v_mul_f32 v74, s92, v74
    v_mul_f32 v75, s92, v75
    s_add_u32 s66, s52, 11520
    v_add_u32 v3, s66, v2
    v_cvt_pk_bf16_f32 v68, v68, v69
    v_cvt_pk_bf16_f32 v69, v70, v71
    v_cvt_pk_bf16_f32 v70, v72, v73
    v_cvt_pk_bf16_f32 v71, v74, v75
    v_mul_f32 v48, s92, v48
    v_mul_f32 v49, s92, v49
    v_mul_f32 v50, s92, v50
    v_mul_f32 v51, s92, v51
    v_mul_f32 v52, s92, v52
    v_mul_f32 v53, s92, v53
    v_mul_f32 v54, s92, v54
    v_mul_f32 v55, s92, v55
    ds_write_b128 v3, v[56:59]
    ds_write_b128 v3, v[60:63] offset:1024
    ds_write_b128 v3, v[68:71] offset:2048
    ds_write_b128 v98, v[48:51]
    ds_write_b128 v98, v[52:55] offset:40960
    v_add_u32 v3, 11520, v2
    v_add_u32 v246, 81920, v3
    s_waitcnt lgkmcnt(0)
    s_barrier
    s_cmp_ge_u32 s54, 4
    s_cbranch_scc0 L_old3
    s_waitcnt vmcnt(4)
    s_call_b64 s[62:63], L_fp
    s_branch L_yng3
L_old3:
    s_call_b64 s[62:63], L_t23
L_yng3:
    ds_read_b128 v[4:7], v3 offset:0
    ds_read_b128 v[8:11], v3 offset:1024
    ds_read_b128 v[68:71], v3 offset:2048
    ds_read_b128 v[12:15], v3 offset:20480
    ds_read_b128 v[16:19], v3 offset:21504
    ds_read_b128 v[72:75], v3 offset:22528
    ds_read_b128 v[20:23], v3 offset:40960
    ds_read_b128 v[24:27], v3 offset:41984
    ds_read_b128 v[76:79], v3 offset:43008
    s_waitcnt vmcnt(4)
    v_mfma_i32_16x16x64_i8 v[172:175], v[122:125], v[104:107], 0
    v_mfma_i32_16x16x64_i8 v[176:179], v[122:125], v[108:111], 0
    v_mfma_i32_16x16x64_i8 v[180:183], v[122:125], v[112:115], 0
    v_and_b32 v160, 0x800080, v104
    v_mul_u32_u24 v160, 0x7f, v160
    v_bitop3_b32 v131, v104, v160, v131 bitop3:0xbe
    v_and_b32 v161, 0x800080, v105
    v_mul_u32_u24 v161, 0x7f, v161
    v_bitop3_b32 v131, v105, v161, v131 bitop3:0xbe
    v_and_b32 v160, 0x800080, v106
    v_mul_u32_u24 v160, 0x7f, v160
    v_bitop3_b32 v131, v106, v160, v131 bitop3:0xbe
    v_mov_b32_dpp v184, v172 row_shr:1 row_mask:0xf bank_mask:0xf bound_ctrl:0
    v_mov_b32_dpp v185, v176 row_shr:1 row_mask:0xf bank_mask:0xf bound_ctrl:0
    v_mov_b32_dpp v186, v180 row_shr:1 row_mask:0xf bank_mask:0xf bound_ctrl:0
    v_add_u32_dpp v184, v184, v184 row_shr:1 row_mask:0xf bank_mask:0xf bound_ctrl:0
    v_add_u32_dpp v185, v185, v185 row_shr:1 row_mask:0xf bank_mask:0xf bound_ctrl:0
    v_add_u32_dpp v186, v186, v186 row_shr:1 row_mask:0xf bank_mask:0xf bound_ctrl:0
    v_add_u32_dpp v184, v184, v184 row_shr:2 row_mask:0xf bank_mask:0xf bound_ctrl:0
    v_add_u32_dpp v185, v185, v185 row_shr:2 row_mask:0xf bank_mask:0xf bound_ctrl:0
    v_add_u32_dpp v186, v186, v186 row_shr:2 row_mask:0xf bank_mask:0xf bound_ctrl:0
    v_add_u32_dpp v184, v184, v184 row_shr:4 row_mask:0xf bank_mask:0xf bound_ctrl:0
    v_add_u32_dpp v185, v185, v185 row_shr:4 row_mask:0xf bank_mask:0xf bound_ctrl:0
    v_add_u32_dpp v186, v186, v186 row_shr:4 row_mask:0xf bank_mask:0xf bound_ctrl:0
    v_add_u32_dpp v184, v184, v184 row_shr:8 row_mask:0xf bank_mask:0xf bound_ctrl:0
    v_add_u32_dpp v185, v185, v185 row_shr:8 row_mask:0xf bank_mask:0xf bound_ctrl:0
    v_add_u32_dpp v186, v186, v186 row_shr:8 row_mask:0xf bank_mask:0xf bound_ctrl:0
    ds_read_b128 v[28:31], v3 offset:61440
    ds_read_b128 v[32:35], v3 offset:62464
    ds_read_b128 v[80:83], v3 offset:63488
    ds_read_b128 v[36:39], v246 offset:0
    ds_read_b128 v[40:43], v246 offset:1024
    ds_read_b128 v[84:87], v246 offset:2048
    v_and_b32 v161, 0x800080, v107
    v_mul_u32_u24 v161, 0x7f, v161
    v_bitop3_b32 v131, v107, v161, v131 bitop3:0xbe
    v_and_b32 v160, 0x800080, v108
    v_mul_u32_u24 v160, 0x7f, v160
    v_bitop3_b32 v131, v108, v160, v131 bitop3:0xbe
    v_and_b32 v161, 0x800080, v109
    v_mul_u32_u24 v161, 0x7f, v161
    v_bitop3_b32 v131, v109, v161, v131 bitop3:0xbe
    v_and_b32 v160, 0x800080, v110
    v_mul_u32_u24 v160, 0x7f, v160
    v_bitop3_b32 v131, v110, v160, v131 bitop3:0xbe
    v_and_b32 v161, 0x800080, v111
    v_mul_u32_u24 v161, 0x7f, v161
    v_bitop3_b32 v131, v111, v161, v131 bitop3:0xbe
    v_and_b32 v160, 0x800080, v112
    v_mul_u32_u24 v160, 0x7f, v160
    v_bitop3_b32 v131, v112, v160, v131 bitop3:0xbe
    v_and_b32 v161, 0x800080, v113
    v_mul_u32_u24 v161, 0x7f, v161
    v_bitop3_b32 v131, v113, v161, v131 bitop3:0xbe
    v_and_b32 v160, 0x800080, v114
    v_mul_u32_u24 v160, 0x7f, v160
    v_bitop3_b32 v131, v114, v160, v131 bitop3:0xbe
    v_and_b32 v161, 0x800080, v115
    v_mul_u32_u24 v161, 0x7f, v161
    v_bitop3_b32 v131, v115, v161, v131 bitop3:0xbe
    v_cmp_ne_u32 vcc, 0, v131
    v_readlane_b32 s68, v184, 6
    v_readlane_b32 s69, v173, 6
    v_readlane_b32 s70, v184, 15
    v_readlane_b32 s72, v185, 6
    v_readlane_b32 s73, v177, 6
    v_readlane_b32 s74, v185, 15
    v_readlane_b32 s76, v186, 6
    v_readlane_b32 s77, v181, 6
    v_readlane_b32 s78, v186, 15
    s_cbranch_vccnz L_general
    s_add_u32 s66, s68, s69
    s_add_u32 s66, s66, s64
    s_add_u32 s67, s66, 15
    s_and_b32 s67, s67, -16
    s_add_u32 s55, s64, 16
    s_max_u32 s67, s67, s55
    s_sub_u32 s66, s67, s66
    v_mad_u32_u24 v184, v130, s66, v184
    s_sub_u32 s55, s64, 2048
    v_add_u32 v172, s55, v184
    v_add_u32 v173, s55, v184
    v_add_u32 v174, s55, v184
    v_add_u32 v175, s55, v184
    s_add_u32 s64, s64, s70
    s_add_u32 s64, s64, s66
    v_mfma_i32_16x16x64_i8 v[132:135], v[118:121], v[104:107], v[172:175]
    v_mfma_i32_16x16x64_i8 v[136:139], v[116:119], v[104:107], v[172:175]
    s_add_u32 s64, s64, 15
    s_and_b32 s64, s64, -16
    s_add_u32 s55, s67, 16
    s_max_u32 s64, s64, s55
    s_lshr_b32 s95, s67, 4
    s_bitset1_b64 s[56:57], s95
    s_lshr_b32 s95, s64, 4
    s_bitset1_b64 s[56:57], s95
    s_add_u32 s66, s72, s73
    s_add_u32 s66, s66, s64
    s_add_u32 s67, s66, 15
    s_and_b32 s67, s67, -16
    s_add_u32 s55, s64, 16
    s_max_u32 s67, s67, s55
    s_sub_u32 s66, s67, s66
    v_mad_u32_u24 v185, v130, s66, v185
    s_sub_u32 s55, s64, 2048
    v_add_u32 v176, s55, v185
    v_add_u32 v177, s55, v185
    v_add_u32 v178, s55, v185
    v_add_u32 v179, s55, v185
    s_add_u32 s64, s64, s74
    s_add_u32 s64, s64, s66
    v_mfma_i32_16x16x64_i8 v[140:143], v[118:121], v[108:111], v[176:179]
    v_mfma_i32_16x16x64_i8 v[144:147], v[116:119], v[108:111], v[176:179]
    s_add_u32 s64, s64, 15
    s_and_b32 s64, s64, -16
    s_add_u32 s55, s67, 16
    s_max_u32 s64, s64, s55
    s_lshr_b32 s95, s67, 4
    s_lshl_b64 s[86:87], 1, s95
    s_bitcmp1_b32 s67, 10
    s_cselect_b64 s[88:89], 0, s[86:87]
    s_cselect_b64 s[90:91], s[86:87], 0
    s_or_b64 s[56:57], s[56:57], s[88:89]
    s_or_b64 s[58:59], s[58:59], s[90:91]
    s_lshr_b32 s95, s64, 4
    s_lshl_b64 s[86:87], 1, s95
    s_bitcmp1_b32 s64, 10
    s_cselect_b64 s[88:89], 0, s[86:87]
    s_cselect_b64 s[90:91], s[86:87], 0
    s_or_b64 s[56:57], s[56:57], s[88:89]
    s_or_b64 s[58:59], s[58:59], s[90:91]
    s_mov_b32 s44, s64
    ds_write_b8 v132, v126
    ds_write_b8_d16_hi v133, v126
    ds_write_b8 v134, v127
    ds_write_b8_d16_hi v135, v127
    ds_write_b8 v136, v128
    ds_write_b8_d16_hi v137, v128
    ds_write_b8 v138, v129
    ds_write_b8_d16_hi v139, v129
    s_add_u32 s66, s76, s77
    s_add_u32 s66, s66, s64
    s_add_u32 s67, s66, 15
    s_and_b32 s67, s67, -16
    s_add_u32 s55, s64, 16
    s_max_u32 s67, s67, s55
    s_sub_u32 s66, s67, s66
    v_mad_u32_u24 v186, v130, s66, v186
    s_sub_u32 s55, s64, 2048
    v_add_u32 v180, s55, v186
    v_add_u32 v181, s55, v186
    v_add_u32 v182, s55, v186
    v_add_u32 v183, s55, v186
    s_add_u32 s64, s64, s78
    s_add_u32 s64, s64, s66
    v_mfma_i32_16x16x64_i8 v[164:167], v[118:121], v[112:115], v[180:183]
    v_mfma_i32_16x16x64_i8 v[168:171], v[116:119], v[112:115], v[180:183]
    s_add_u32 s64, s64, 15
    s_and_b32 s64, s64, -16
    s_add_u32 s55, s67, 16
    s_max_u32 s64, s64, s55
    s_mov_b32 s45, s67
    s_mov_b32 s46, s64
    ds_write_b8 v140, v126
    ds_write_b8_d16_hi v141, v126
    ds_write_b8 v142, v127
    ds_write_b8_d16_hi v143, v127
    ds_write_b8 v144, v128
    ds_write_b8_d16_hi v145, v128
    ds_write_b8 v146, v129
    ds_write_b8_d16_hi v147, v129
    ds_read_b128 v[44:47], v246 offset:20480
    ds_read_b128 v[48:51], v246 offset:21504
    ds_read_b128 v[88:91], v246 offset:22528
    ds_read_b128 v[52:55], v246 offset:40960
    ds_read_b128 v[56:59], v246 offset:41984
    ds_read_b128 v[92:95], v246 offset:43008
    ds_read_b128 v[60:63], v246 offset:61440
    ds_read_b128 v[64:67], v246 offset:62464
    ds_read_b128 v[96:99], v246 offset:63488
    ds_read_u16 v224, v238 offset:0
    ds_read_u16 v225, v238 offset:8
    ds_read_u16 v226, v238 offset:64
    ds_read_u16 v227, v238 offset:72
    ds_write_b8 v164, v126
    ds_write_b8_d16_hi v165, v126
    ds_write_b8 v166, v127
    ds_write_b8_d16_hi v167, v127
    ds_write_b8 v168, v128
    ds_write_b8_d16_hi v169, v128
    ds_write_b8 v170, v129
    ds_write_b8_d16_hi v171, v129
    s_cmp_ge_u32 s54, 4
    s_cbranch_scc0 L_old3b
    s_call_b64 s[62:63], L_t23
L_old3b:
L_listed:
    s_sub_u32 s66, s46, s44
    s_or_b32 s66, s66, s54
    s_and_b32 s67, s84, 0x40000000
    s_or_b32 s66, s66, s67
    s_bitset1_b32 s66, 31
    v_mov_b32 v132, s66
    v_mov_b32 v133, s44
    v_mov_b32 v134, s45
    v_mov_b32 v135, s46
    s_mov_b64 exec, 1
    ds_write_b128 v222, v[132:135] offset:14848
    s_mov_b64 exec, -1
    s_sub_u32 s66, s64, s52
    s_sub_u32 s66, s66, 18448
    s_lshr_b32 s66, s66, 3
    s_lshr_b32 s67, s54, 2
    s_mul_i32 s67, s67, 2
    s_add_u32 s66, s66, s67
    s_sub_u32 s67, 0, s66
    v_mov_b32 v2, v221
    v_mov_b32 v1, s66
    v_mov_b32 v3, -8
    v_writelane_b32 v1, s67, 1
    v_writelane_b32 v3, 8, 1
    ds_add_u32 v2, v1
    s_cmp_eq_u32 s94, 1
    s_cbranch_scc1 L_nolate
    ds_read_u8 v148, v237 offset:0
    ds_read_u8 v149, v237 offset:8
    ds_read_u8 v150, v237 offset:16
    ds_read_u8 v151, v237 offset:24
    ds_read_u8 v152, v237 offset:32
    ds_read_u8 v153, v237 offset:40
    ds_read_u8 v154, v237 offset:48
    ds_read_u8 v155, v237 offset:56
    s_waitcnt lgkmcnt(0)
    s_add_u32 m0, s52, 0
    v_mov_b32 v230, v148
    v_mov_b32 v232, v149
    buffer_load_dwordx4 v[230:231], s[20:23], s35 idxen offen nt lds
    buffer_load_dwordx4 v[232:233], s[40:43], s35 idxen offen offset:1056 nt lds
    s_bitcmp0_b64 s[56:57], 2
    s_cbranch_scc1 L_noadvl1
    s_add_u32 s35, s35, s31
    s_min_u32 s35, s35, 419404800
    s_xor_b32 s31, s31, 0x63ff800
    s_sub_u32 s60, s60, 1
L_noadvl1:
    s_add_u32 m0, s52, 2080
    v_mov_b32 v230, v150
    v_mov_b32 v232, v151
    buffer_load_dwordx4 v[230:231], s[20:23], s35 idxen offen nt lds
    buffer_load_dwordx4 v[232:233], s[40:43], s35 idxen offen offset:1056 nt lds
    s_bitcmp0_b64 s[56:57], 3
    s_cbranch_scc1 L_noadvl2
    s_add_u32 s35, s35, s31
    s_min_u32 s35, s35, 419404800
    s_xor_b32 s31, s31, 0x63ff800
    s_sub_u32 s60, s60, 1
L_noadvl2:
    s_add_u32 m0, s52, 4160
    v_mov_b32 v230, v152
    v_mov_b32 v232, v153
    buffer_load_dwordx4 v[230:231], s[20:23], s35 idxen offen nt lds
    buffer_load_dwordx4 v[232:233], s[40:43], s35 idxen offen offset:1056 nt lds
    s_bitcmp0_b64 s[56:57], 4
    s_cbranch_scc1 L_noadvl3
    s_add_u32 s35, s35, s31
    s_min_u32 s35, s35, 419404800
    s_xor_b32 s31, s31, 0x63ff800
    s_sub_u32 s60, s60, 1
L_noadvl3:
    s_add_u32 m0, s52, 6240
    v_mov_b32 v230, v154
    v_mov_b32 v232, v155
    buffer_load_dwordx4 v[230:231], s[20:23], s35 idxen offen nt lds
    buffer_load_dwordx4 v[232:233], s[40:43], s35 idxen offen offset:1056 nt lds
L_nolate:
    v_and_b32_dpp v196, v216, v220 quad_perm:[0,0,0,0] row_mask:0xf bank_mask:0xf
    v_and_b32_dpp v197, v217, v220 quad_perm:[0,0,0,0] row_mask:0xf bank_mask:0xf
    v_and_b32_dpp v198, v216, v220 quad_perm:[1,1,1,1] row_mask:0xf bank_mask:0xf
    v_and_b32_dpp v199, v217, v220 quad_perm:[1,1,1,1] row_mask:0xf bank_mask:0xf
    v_and_b32_dpp v200, v216, v220 quad_perm:[2,2,2,2] row_mask:0xf bank_mask:0xf
    v_and_b32_dpp v201, v217, v220 quad_perm:[2,2,2,2] row_mask:0xf bank_mask:0xf
    v_and_b32_dpp v202, v216, v220 quad_perm:[3,3,3,3] row_mask:0xf bank_mask:0xf
    v_and_b32_dpp v203, v217, v220 quad_perm:[3,3,3,3] row_mask:0xf bank_mask:0xf
    s_waitcnt vmcnt(6) lgkmcnt(0)
    ds_read_b128 v[180:183], v234 offset:0
    ds_read_b128 v[184:187], v235 offset:0
    v_mul_u32_u24 v216, v224, v241
    v_mul_u32_u24 v217, v224, v242
    v_mul_u32_u24 v218, v225, v241
    v_mul_u32_u24 v219, v225, v242
    v_mul_u32_u24 v220, v226, v241
    v_mul_u32_u24 v221, v226, v242
    v_mul_u32_u24 v222, v227, v241
    v_mul_u32_u24 v223, v227, v242
    v_add_u32 v238, 128, v238
    ds_read_b128 v[164:167], v239
    v_mfma_f32_4x4x4_16b_bf16 v[132:135], v[216:217], v[68:69], v[4:7]
    ds_read_b128 v[168:171], v239 offset:64
    ds_read_b128 v[172:175], v239 offset:128
    v_mfma_f32_4x4x4_16b_bf16 v[136:139], v[218:219], v[70:71], v[8:11]
    ds_read_b128 v[176:179], v239 offset:192
    ds_read_u16 v224, v238
    v_mfma_f32_4x4x4_16b_bf16 v[140:143], v[220:221], v[72:73], v[12:15]
    ds_read_u16 v225, v238 offset:8
    ds_read_u16 v226, v238 offset:64
    v_mfma_f32_4x4x4_16b_bf16 v[144:147], v[222:223], v[74:75], v[16:19]
    ds_read_u16 v227, v238 offset:72
    v_add_u32 v239, 272, v239
    v_mfma_f32_4x4x4_16b_bf16 v[246:249], v[216:217], v[76:77], v[20:23]
    v_cvt_pk_bf16_f32 v100, v132, v133
    v_cvt_pk_bf16_f32 v101, v134, v135
    v_mfma_f32_4x4x4_16b_bf16 v[250:253], v[218:219], v[78:79], v[24:27]
    v_cvt_pk_bf16_f32 v102, v136, v137
    v_cvt_pk_bf16_f32 v103, v138, v139
    v_mfma_f32_4x4x4_16b_bf16 v[132:135], v[220:221], v[80:81], v[28:31]
    v_cvt_pk_bf16_f32 v104, v140, v141
    v_cvt_pk_bf16_f32 v105, v142, v143
    v_mfma_f32_4x4x4_16b_bf16 v[136:139], v[222:223], v[82:83], v[32:35]
    v_cvt_pk_bf16_f32 v106, v144, v145
    v_cvt_pk_bf16_f32 v107, v146, v147
    v_mfma_f32_4x4x4_16b_bf16 v[140:143], v[216:217], v[84:85], v[36:39]
    v_cvt_pk_bf16_f32 v108, v246, v247
    v_cvt_pk_bf16_f32 v109, v248, v249
    v_mfma_f32_4x4x4_16b_bf16 v[144:147], v[218:219], v[86:87], v[40:43]
    v_cvt_pk_bf16_f32 v110, v250, v251
    v_cvt_pk_bf16_f32 v111, v252, v253
    v_mfma_f32_4x4x4_16b_bf16 v[246:249], v[220:221], v[88:89], v[44:47]
    v_cvt_pk_bf16_f32 v112, v132, v133
    v_cvt_pk_bf16_f32 v113, v134, v135
    v_mfma_f32_4x4x4_16b_bf16 v[250:253], v[222:223], v[90:91], v[48:51]
    v_cvt_pk_bf16_f32 v114, v136, v137
    v_cvt_pk_bf16_f32 v115, v138, v139
    v_mfma_f32_4x4x4_16b_bf16 v[132:135], v[216:217], v[92:93], v[52:55]
    v_cvt_pk_bf16_f32 v116, v140, v141
    v_cvt_pk_bf16_f32 v117, v142, v143
    v_mfma_f32_4x4x4_16b_bf16 v[136:139], v[218:219], v[94:95], v[56:59]
    v_cvt_pk_bf16_f32 v118, v144, v145
    v_cvt_pk_bf16_f32 v119, v146, v147
    v_mfma_f32_4x4x4_16b_bf16 v[140:143], v[220:221], v[96:97], v[60:63]
    v_cvt_pk_bf16_f32 v120, v246, v247
    v_cvt_pk_bf16_f32 v121, v248, v249
    v_mfma_f32_4x4x4_16b_bf16 v[144:147], v[222:223], v[98:99], v[64:67]
    v_cvt_pk_bf16_f32 v122, v250, v251
    v_cvt_pk_bf16_f32 v123, v252, v253
    v_cvt_pk_bf16_f32 v124, v132, v133
    v_cvt_pk_bf16_f32 v125, v134, v135
    v_cvt_pk_bf16_f32 v126, v136, v137
    v_cvt_pk_bf16_f32 v127, v138, v139
    v_cvt_pk_bf16_f32 v128, v140, v141
    v_cvt_pk_bf16_f32 v129, v142, v143
    v_cvt_pk_bf16_f32 v130, v144, v145
    v_cvt_pk_bf16_f32 v131, v146, v147
    s_waitcnt lgkmcnt(0)
    v_mfma_f32_16x16x32_bf16 v[148:151], v[100:103], v[180:183], v[164:167]
    v_mfma_f32_16x16x32_bf16 v[148:151], v[104:107], v[184:187], v[148:151]
    v_mfma_f32_16x16x32_bf16 v[152:155], v[108:111], v[180:183], v[168:171]
    v_mfma_f32_16x16x32_bf16 v[152:155], v[112:115], v[184:187], v[152:155]
    v_mfma_f32_16x16x32_bf16 v[156:159], v[116:119], v[180:183], v[172:175]
    v_mfma_f32_16x16x32_bf16 v[156:159], v[120:123], v[184:187], v[156:159]
    v_mfma_f32_16x16x32_bf16 v[160:163], v[124:127], v[180:183], v[176:179]
    v_mfma_f32_16x16x32_bf16 v[160:163], v[128:131], v[184:187], v[160:163]
    s_waitcnt vmcnt(4)
    ds_read_b128 v[180:183], v234 offset:2080
    ds_read_b128 v[184:187], v235 offset:2080
    ds_read_u8 v230, v237 offset:64
    ds_read_u8 v232, v237 offset:72
    s_lshr_b64 s[86:87], s[56:57], 2
    s_lshr_b64 s[36:37], s[56:57], 5
    s_or_b32 s36, s36, s86
    s_or_b32 s36, s36, s56
    s_cmp_lg_u64 s[84:85], 0
    s_cbranch_scc0 Lf_mid
    s_mul_i32 s66, s53, 800
    s_add_u32 s8, s8, s66
    s_addc_u32 s9, s9, 0
    s_mov_b32 s24, s8
    s_and_b32 s25, s9, 0xffff
    s_mov_b32 s26, 400
    s_mov_b32 s27, 0x20000
    s_movk_i32 s32, 400
    s_branch Ls_mid
L_fp:
    v_mfma_i32_16x16x64_i8 v[172:175], v[122:125], v[100:103], 0
    v_and_b32 v160, 0x800080, v100
    v_mul_u32_u24 v160, 0x7f, v160
    v_bitop3_b32 v131, v100, v160, v131 bitop3:0xbe
    v_and_b32 v161, 0x800080, v101
    v_mul_u32_u24 v161, 0x7f, v161
    v_bitop3_b32 v131, v101, v161, v131 bitop3:0xbe
    v_and_b32 v160, 0x800080, v102
    v_mul_u32_u24 v160, 0x7f, v160
    v_mov_b32_dpp v184, v172 row_shr:1 row_mask:0xf bank_mask:0xf bound_ctrl:0
    v_bitop3_b32 v131, v102, v160, v131 bitop3:0xbe
    s_nop 0
    v_add_u32_dpp v184, v184, v184 row_shr:1 row_mask:0xf bank_mask:0xf bound_ctrl:0
    v_and_b32 v161, 0x800080, v103
    s_nop 0
    v_add_u32_dpp v184, v184, v184 row_shr:2 row_mask:0xf bank_mask:0xf bound_ctrl:0
    v_mul_u32_u24 v161, 0x7f, v161
    s_nop 0
    v_add_u32_dpp v184, v184, v184 row_shr:4 row_mask:0xf bank_mask:0xf bound_ctrl:0
    v_bitop3_b32 v131, v103, v161, v131 bitop3:0xbe
    s_nop 0
    v_add_u32_dpp v184, v184, v184 row_shr:8 row_mask:0xf bank_mask:0xf bound_ctrl:0
    v_cmp_ne_u32 vcc, 0, v131
    v_readlane_b32 s68, v184, 6
    v_readlane_b32 s69, v173, 6
    v_readlane_b32 s70, v184, 15
    s_mov_b32 s94, 0
    s_cbranch_vccnz L_late
    s_add_u32 s66, s68, s69
    s_add_u32 s66, s66, s64
    s_add_u32 s67, s66, 15
    s_and_b32 s67, s67, -16
    s_add_u32 s55, s64, 16
    s_max_u32 s67, s67, s55
    s_sub_u32 s66, s67, s66
    v_mad_u32_u24 v184, v130, s66, v184
    s_sub_u32 s55, s64, 2048
    v_add_u32 v172, s55, v184
    v_add_u32 v173, s55, v184
    v_add_u32 v174, s55, v184
    v_add_u32 v175, s55, v184
    s_add_u32 s64, s64, s70
    s_add_u32 s64, s64, s66
    v_mfma_i32_16x16x64_i8 v[132:135], v[118:121], v[100:103], v[172:175]
    v_mfma_i32_16x16x64_i8 v[136:139], v[116:119], v[100:103], v[172:175]
    s_add_u32 s64, s64, 15
    s_and_b32 s64, s64, -16
    s_add_u32 s55, s67, 16
    s_max_u32 s64, s64, s55
    s_lshr_b32 s95, s67, 4
    s_bitset1_b64 s[56:57], s95
    s_lshr_b32 s95, s64, 4
    s_bitset1_b64 s[56:57], s95
    s_add_u32 s66, s52, 18512
    s_cmp_ge_u32 s64, s66
    ds_write_b8 v132, v126
    ds_write_b8_d16_hi v133, v126
    ds_write_b8 v134, v127
    ds_write_b8_d16_hi v135, v127
    ds_write_b8 v136, v128
    ds_write_b8_d16_hi v137, v128
    ds_write_b8 v138, v129
    ds_write_b8_d16_hi v139, v129
    s_cbranch_scc0 L_late
    s_mov_b32 s94, 1
    ds_read_u8 v148, v237 offset:0
    ds_read_u8 v149, v237 offset:8
    ds_read_u8 v150, v237 offset:16
    ds_read_u8 v151, v237 offset:24
    ds_read_u8 v152, v237 offset:32
    ds_read_u8 v153, v237 offset:40
    ds_read_u8 v154, v237 offset:48
    ds_read_u8 v155, v237 offset:56
    s_waitcnt lgkmcnt(0)
    s_add_u32 m0, s52, 0
    v_mov_b32 v230, v148
    v_mov_b32 v232, v149
    buffer_load_dwordx4 v[230:231], s[20:23], s35 idxen offen nt lds
    buffer_load_dwordx4 v[232:233], s[40:43], s35 idxen offen offset:1056 nt lds
    s_bitcmp0_b64 s[56:57], 2
    s_cbranch_scc1 L_noadve1
    s_add_u32 s35, s35, s31
    s_min_u32 s35, s35, 419404800
    s_xor_b32 s31, s31, 0x63ff800
    s_sub_u32 s60, s60, 1
L_noadve1:
    s_add_u32 m0, s52, 2080
    v_mov_b32 v230, v150
    v_mov_b32 v232, v151
    buffer_load_dwordx4 v[230:231], s[20:23], s35 idxen offen nt lds
    buffer_load_dwordx4 v[232:233], s[40:43], s35 idxen offen offset:1056 nt lds
    s_setpc_b64 s[62:63]
L_late:
    s_waitcnt vmcnt(0)
    s_setpc_b64 s[62:63]
L_swap:
    v_lshrrev_b32 v140, 3, v0
    v_and_b32 v141, 7, v0
    v_mul_u32_u24 v140, 20480, v140
    v_mul_u32_u24 v141, 20480, v141
    v_mov_b32 v143, 1
    s_mov_b64 exec, 1
    ds_add_rtn_u32 v143, v140, v143 offset:14864
    s_mov_b64 exec, -1
L_swap_poll:
    ds_read_b32 v142, v141 offset:14848
    ds_read_b128 v[144:147], v140 offset:14848
    v_and_b32 v248, 56, v0
    s_waitcnt lgkmcnt(0)
    v_cmp_le_i32 vcc, 0, v142
    v_cmp_gt_u32 s[86:87], v142, v144
    v_lshlrev_b32 v249, 1, v142
    v_readfirstlane_b32 s66, v143
    s_cbranch_vccnz L_swap_poll
    v_lshrrev_b64 v[246:247], v248, s[86:87]
    v_cmp_gt_i32 s[88:89], 0, v249
    v_and_b32 v246, 0xff, v246
    v_bcnt_u32_b32 v246, v246, 0
    v_cmp_eq_u32 vcc, s66, v246
    s_lshl_b32 s67, s54, 3
    s_ff1_i32_b64 s66, vcc
    s_cmp_lg_u64 s[88:89], 0
    s_cselect_b32 s66, s67, s66
    s_sub_u32 s95, s66, s67
    v_readlane_b32 s67, v146, s66
    v_readlane_b32 s55, v147, s66
    v_readlane_b32 s66, v145, s66
    s_mul_i32 s47, s95, 2560
    s_lshl_b32 s50, s95, 5
    s_mul_i32 s95, s95, 6400
    s_add_u32 s35, s35, s95
    s_mov_b32 s60, 8
    s_sub_u32 s44, s66, s44
    v_add_u32 v237, s44, v237
    s_sub_u32 s46, s55, s46
    s_sub_u32 s46, s46, s44
    s_sub_u32 s67, s67, s66
    s_lshr_b32 s67, s67, 4
    s_add_u32 s67, s67, s49
    s_bitset1_b64 s[56:57], s67
    s_sub_u32 s55, s55, s66
    s_lshr_b32 s55, s55, 4
    s_add_u32 s55, s55, s49
    s_bitset1_b64 s[56:57], s55
    s_lshr_b64 s[86:87], s[56:57], 2
    s_lshr_b64 s[36:37], s[56:57], 5
    s_or_b32 s36, s36, s86
    s_or_b32 s36, s36, s56
    s_ashr_i32 s46, s46, 3
    v_mov_b32 v140, s46
    s_sub_u32 s46, 0, s46
    v_writelane_b32 v140, s46, 1
    ds_add_u32 v2, v140
    s_cmp_lg_u32 s61, 2
    s_cselect_b32 s45, 1, -1
    s_cbranch_scc1 L_swap_ret
    v_add_u32 v238, s47, v238
    v_add_u32 v239, s47, v239
    ds_read_u16 v224, v238 offset:0
    ds_read_u16 v225, v238 offset:8
    ds_read_u16 v226, v238 offset:64
    ds_read_u16 v227, v238 offset:72
L_swap_ret:
    s_setpc_b64 s[62:63]
L_t23:
    s_cmp_eq_u32 s94, 0
    s_cbranch_scc1 L_skip23
    s_bitcmp0_b64 s[56:57], 3
    s_cbranch_scc1 L_noadve2
    s_add_u32 s35, s35, s31
    s_min_u32 s35, s35, 419404800
    s_xor_b32 s31, s31, 0x63ff800
    s_sub_u32 s60, s60, 1
L_noadve2:
    s_add_u32 m0, s52, 4160
    v_mov_b32 v230, v152
    v_mov_b32 v232, v153
    buffer_load_dwordx4 v[230:231], s[20:23], s35 idxen offen nt lds
    buffer_load_dwordx4 v[232:233], s[40:43], s35 idxen offen offset:1056 nt lds
    s_bitcmp0_b64 s[56:57], 4
    s_cbranch_scc1 L_noadve3
    s_add_u32 s35, s35, s31
    s_min_u32 s35, s35, 419404800
    s_xor_b32 s31, s31, 0x63ff800
    s_sub_u32 s60, s60, 1
L_noadve3:
    s_add_u32 m0, s52, 6240
    v_mov_b32 v230, v154
    v_mov_b32 v232, v155
    buffer_load_dwordx4 v[230:231], s[20:23], s35 idxen offen nt lds
    buffer_load_dwordx4 v[232:233], s[40:43], s35 idxen offen offset:1056 nt lds
    s_setpc_b64 s[62:63]
L_skip23:
    s_waitcnt vmcnt(0)
    s_setpc_b64 s[62:63]
Lf_loop:
    ds_read_u8 v230, v237 offset:64
    ds_read_u8 v232, v237 offset:72
    v_mfma_f32_16x16x32_bf16 v[208:211], v[136:139], v[200:203], v[208:211]
Lf_mid:
    s_bitcmp1_b32 s36, 0
    s_cbranch_scc1 Lf_ev0
Lf_evd0:
    ds_add_rtn_u32 v1, v2, v3
    v_exp_f32 v132, v148
    v_exp_f32 v133, v149
    v_exp_f32 v134, v150
    v_exp_f32 v135, v151
    v_exp_f32 v136, v152
    v_exp_f32 v137, v153
    v_mfma_f32_4x4x4_16b_bf16 v[132:135], v[228:229], v[228:229], v[132:135]
    v_cvt_pk_bf16_f32 v208, v208, v209
    v_cvt_pk_bf16_f32 v209, v210, v211
    s_waitcnt lgkmcnt(2)
    v_mfma_f32_16x16x32_bf16 v[148:151], v[100:103], v[180:183], v[164:167]
    v_exp_f32 v138, v154
    v_mfma_f32_4x4x4_16b_bf16 v[212:215], v[208:209], v[188:189], v[212:215] cbsz:4 abid:0
    ds_read_b64_tr_b16 v[188:189], v236 offset:0
    v_exp_f32 v139, v155
    v_mfma_f32_16x16x32_bf16 v[152:155], v[108:111], v[180:183], v[168:171]
    v_exp_f32 v140, v156
    v_mfma_f32_4x4x4_16b_bf16 v[212:215], v[208:209], v[190:191], v[212:215] cbsz:4 abid:4
    ds_read_b64_tr_b16 v[190:191], v236 offset:512
    v_mfma_f32_4x4x4_16b_bf16 v[136:139], v[228:229], v[228:229], v[136:139]
    v_rcp_f32 v132, v132
    v_mfma_f32_4x4x4_16b_bf16 v[212:215], v[208:209], v[192:193], v[212:215] cbsz:4 abid:8
    ds_read_b64_tr_b16 v[192:193], v236 offset:1056
    v_exp_f32 v141, v157
    v_mfma_f32_16x16x32_bf16 v[148:151], v[104:107], v[184:187], v[148:151]
    v_rcp_f32 v133, v133
    v_mfma_f32_4x4x4_16b_bf16 v[212:215], v[208:209], v[194:195], v[212:215] cbsz:4 abid:12
    ds_read_b64_tr_b16 v[194:195], v236 offset:1568
    v_exp_f32 v142, v158
    v_mfma_f32_16x16x32_bf16 v[152:155], v[112:115], v[184:187], v[152:155]
    v_rcp_f32 v134, v134
    v_exp_f32 v143, v159
    v_rcp_f32 v135, v135
    v_cvt_pk_bf16_f32 v132, v132, v133
    v_mfma_f32_4x4x4_16b_bf16 v[140:143], v[228:229], v[228:229], v[140:143]
    v_exp_f32 v144, v160
    v_mfma_f32_16x16x32_bf16 v[156:159], v[116:119], v[180:183], v[172:175]
    v_rcp_f32 v136, v136
    v_cvt_pk_bf16_f32 v133, v134, v135
    s_add_u32 m0, s52, 0
    s_waitcnt lgkmcnt(0)
    buffer_load_dwordx4 v[230:231], s[20:23], s35 idxen offen nt lds
    v_exp_f32 v145, v161
    buffer_load_dwordx4 v[232:233], s[40:43], s35 idxen offen offset:1056 nt lds
    v_rcp_f32 v137, v137
    v_exp_f32 v146, v162
    v_rcp_f32 v138, v138
    v_cvt_pk_bf16_f32 v134, v136, v137
    v_exp_f32 v147, v163
    v_mfma_f32_16x16x32_bf16 v[160:163], v[124:127], v[180:183], v[176:179]
    v_readfirstlane_b32 s66, v1
    s_setprio 0
    s_cmp_gt_i32 s66, 0
    s_cbranch_scc0 Lf_lo0
    s_setprio 1
Lf_lo0:
    v_rcp_f32 v139, v139
    v_mfma_f32_4x4x4_16b_bf16 v[144:147], v[228:229], v[228:229], v[144:147]
    v_mfma_f32_16x16x32_bf16 v[156:159], v[120:123], v[184:187], v[156:159]
    v_rcp_f32 v140, v140
    v_mfma_f32_16x16x32_bf16 v[160:163], v[128:131], v[184:187], v[160:163]
    v_rcp_f32 v141, v141
    v_cvt_pk_bf16_f32 v135, v138, v139
    s_waitcnt vmcnt(4)
    ds_read_b128 v[180:183], v234 offset:4160
    ds_read_b128 v[184:187], v235 offset:4160
    v_rcp_f32 v142, v142
    v_cvt_pk_bf16_f32 v136, v140, v141
    v_mfma_f32_16x16x32_bf16 v[208:211], v[132:135], v[196:199], v[204:207]
    v_rcp_f32 v143, v143
    v_rcp_f32 v144, v144
    v_cvt_pk_bf16_f32 v137, v142, v143
    v_rcp_f32 v145, v145
    v_rcp_f32 v146, v146
    v_rcp_f32 v147, v147
    v_cvt_pk_bf16_f32 v138, v144, v145
    v_cvt_pk_bf16_f32 v139, v146, v147
    ds_read_u8 v230, v237 offset:80
    ds_read_u8 v232, v237 offset:88
    v_mfma_f32_16x16x32_bf16 v[208:211], v[136:139], v[200:203], v[208:211]
    s_bitcmp1_b32 s36, 1
    s_cbranch_scc1 Lf_ev1
Lf_evd1:
    v_exp_f32 v132, v148
    v_exp_f32 v133, v149
    v_exp_f32 v134, v150
    v_exp_f32 v135, v151
    v_exp_f32 v136, v152
    v_exp_f32 v137, v153
    v_mfma_f32_4x4x4_16b_bf16 v[132:135], v[228:229], v[228:229], v[132:135]
    v_cvt_pk_bf16_f32 v208, v208, v209
    v_cvt_pk_bf16_f32 v209, v210, v211
    s_waitcnt lgkmcnt(2)
    v_mfma_f32_16x16x32_bf16 v[148:151], v[100:103], v[180:183], v[164:167]
    v_exp_f32 v138, v154
    v_mfma_f32_4x4x4_16b_bf16 v[212:215], v[208:209], v[188:189], v[212:215] cbsz:4 abid:0
    ds_read_b64_tr_b16 v[188:189], v236 offset:2080
    v_exp_f32 v139, v155
    v_mfma_f32_16x16x32_bf16 v[152:155], v[108:111], v[180:183], v[168:171]
    v_exp_f32 v140, v156
    v_mfma_f32_4x4x4_16b_bf16 v[212:215], v[208:209], v[190:191], v[212:215] cbsz:4 abid:4
    ds_read_b64_tr_b16 v[190:191], v236 offset:2592
    v_mfma_f32_4x4x4_16b_bf16 v[136:139], v[228:229], v[228:229], v[136:139]
    v_rcp_f32 v132, v132
    v_mfma_f32_4x4x4_16b_bf16 v[212:215], v[208:209], v[192:193], v[212:215] cbsz:4 abid:8
    ds_read_b64_tr_b16 v[192:193], v236 offset:3136
    v_exp_f32 v141, v157
    v_mfma_f32_16x16x32_bf16 v[148:151], v[104:107], v[184:187], v[148:151]
    v_rcp_f32 v133, v133
    v_mfma_f32_4x4x4_16b_bf16 v[212:215], v[208:209], v[194:195], v[212:215] cbsz:4 abid:12
    ds_read_b64_tr_b16 v[194:195], v236 offset:3648
    v_exp_f32 v142, v158
    v_mfma_f32_16x16x32_bf16 v[152:155], v[112:115], v[184:187], v[152:155]
    v_rcp_f32 v134, v134
    v_exp_f32 v143, v159
    v_rcp_f32 v135, v135
    v_cvt_pk_bf16_f32 v132, v132, v133
    v_mfma_f32_4x4x4_16b_bf16 v[140:143], v[228:229], v[228:229], v[140:143]
    v_exp_f32 v144, v160
    v_mfma_f32_16x16x32_bf16 v[156:159], v[116:119], v[180:183], v[172:175]
    v_rcp_f32 v136, v136
    v_cvt_pk_bf16_f32 v133, v134, v135
    s_add_u32 m0, s52, 2080
    s_waitcnt lgkmcnt(0)
    buffer_load_dwordx4 v[230:231], s[20:23], s35 idxen offen nt lds
    v_exp_f32 v145, v161
    buffer_load_dwordx4 v[232:233], s[40:43], s35 idxen offen offset:1056 nt lds
    v_rcp_f32 v137, v137
    v_exp_f32 v146, v162
    v_rcp_f32 v138, v138
    v_cvt_pk_bf16_f32 v134, v136, v137
    v_exp_f32 v147, v163
    v_mfma_f32_16x16x32_bf16 v[160:163], v[124:127], v[180:183], v[176:179]
    v_rcp_f32 v139, v139
    v_mfma_f32_4x4x4_16b_bf16 v[144:147], v[228:229], v[228:229], v[144:147]
    v_mfma_f32_16x16x32_bf16 v[156:159], v[120:123], v[184:187], v[156:159]
    v_rcp_f32 v140, v140
    v_mfma_f32_16x16x32_bf16 v[160:163], v[128:131], v[184:187], v[160:163]
    v_rcp_f32 v141, v141
    v_cvt_pk_bf16_f32 v135, v138, v139
    s_waitcnt vmcnt(4)
    ds_read_b128 v[180:183], v234 offset:6240
    ds_read_b128 v[184:187], v235 offset:6240
    v_rcp_f32 v142, v142
    v_cvt_pk_bf16_f32 v136, v140, v141
    v_mfma_f32_16x16x32_bf16 v[208:211], v[132:135], v[196:199], v[204:207]
    v_rcp_f32 v143, v143
    v_rcp_f32 v144, v144
    v_cvt_pk_bf16_f32 v137, v142, v143
    v_rcp_f32 v145, v145
    v_rcp_f32 v146, v146
    v_rcp_f32 v147, v147
    v_cvt_pk_bf16_f32 v138, v144, v145
    v_cvt_pk_bf16_f32 v139, v146, v147
    ds_read_u8 v230, v237 offset:96
    ds_read_u8 v232, v237 offset:104
    v_mfma_f32_16x16x32_bf16 v[208:211], v[136:139], v[200:203], v[208:211]
    s_bitcmp1_b32 s36, 2
    s_cbranch_scc1 Lf_ev2
Lf_evd2:
    v_exp_f32 v132, v148
    v_exp_f32 v133, v149
    v_exp_f32 v134, v150
    v_exp_f32 v135, v151
    v_exp_f32 v136, v152
    v_exp_f32 v137, v153
    v_mfma_f32_4x4x4_16b_bf16 v[132:135], v[228:229], v[228:229], v[132:135]
    v_cvt_pk_bf16_f32 v208, v208, v209
    v_cvt_pk_bf16_f32 v209, v210, v211
    s_waitcnt lgkmcnt(2)
    v_mfma_f32_16x16x32_bf16 v[148:151], v[100:103], v[180:183], v[164:167]
    v_exp_f32 v138, v154
    v_mfma_f32_4x4x4_16b_bf16 v[212:215], v[208:209], v[188:189], v[212:215] cbsz:4 abid:0
    ds_read_b64_tr_b16 v[188:189], v236 offset:4160
    v_exp_f32 v139, v155
    v_mfma_f32_16x16x32_bf16 v[152:155], v[108:111], v[180:183], v[168:171]
    v_exp_f32 v140, v156
    v_mfma_f32_4x4x4_16b_bf16 v[212:215], v[208:209], v[190:191], v[212:215] cbsz:4 abid:4
    ds_read_b64_tr_b16 v[190:191], v236 offset:4672
    v_mfma_f32_4x4x4_16b_bf16 v[136:139], v[228:229], v[228:229], v[136:139]
    v_rcp_f32 v132, v132
    v_mfma_f32_4x4x4_16b_bf16 v[212:215], v[208:209], v[192:193], v[212:215] cbsz:4 abid:8
    ds_read_b64_tr_b16 v[192:193], v236 offset:5216
    v_exp_f32 v141, v157
    v_mfma_f32_16x16x32_bf16 v[148:151], v[104:107], v[184:187], v[148:151]
    v_rcp_f32 v133, v133
    v_mfma_f32_4x4x4_16b_bf16 v[212:215], v[208:209], v[194:195], v[212:215] cbsz:4 abid:12
    ds_read_b64_tr_b16 v[194:195], v236 offset:5728
    v_exp_f32 v142, v158
    v_mfma_f32_16x16x32_bf16 v[152:155], v[112:115], v[184:187], v[152:155]
    v_rcp_f32 v134, v134
    v_exp_f32 v143, v159
    v_rcp_f32 v135, v135
    v_cvt_pk_bf16_f32 v132, v132, v133
    v_mfma_f32_4x4x4_16b_bf16 v[140:143], v[228:229], v[228:229], v[140:143]
    v_exp_f32 v144, v160
    v_mfma_f32_16x16x32_bf16 v[156:159], v[116:119], v[180:183], v[172:175]
    v_rcp_f32 v136, v136
    v_cvt_pk_bf16_f32 v133, v134, v135
    s_add_u32 m0, s52, 4160
    s_waitcnt lgkmcnt(0)
    buffer_load_dwordx4 v[230:231], s[20:23], s35 idxen offen nt lds
    v_exp_f32 v145, v161
    buffer_load_dwordx4 v[232:233], s[40:43], s35 idxen offen offset:1056 nt lds
    v_rcp_f32 v137, v137
    v_exp_f32 v146, v162
    v_rcp_f32 v138, v138
    v_cvt_pk_bf16_f32 v134, v136, v137
    v_exp_f32 v147, v163
    v_mfma_f32_16x16x32_bf16 v[160:163], v[124:127], v[180:183], v[176:179]
    v_rcp_f32 v139, v139
    v_mfma_f32_4x4x4_16b_bf16 v[144:147], v[228:229], v[228:229], v[144:147]
    v_mfma_f32_16x16x32_bf16 v[156:159], v[120:123], v[184:187], v[156:159]
    v_rcp_f32 v140, v140
    v_mfma_f32_16x16x32_bf16 v[160:163], v[128:131], v[184:187], v[160:163]
    v_rcp_f32 v141, v141
    v_cvt_pk_bf16_f32 v135, v138, v139
    s_waitcnt vmcnt(4)
    ds_read_b128 v[180:183], v234 offset:0
    ds_read_b128 v[184:187], v235 offset:0
    v_rcp_f32 v142, v142
    v_cvt_pk_bf16_f32 v136, v140, v141
    v_mfma_f32_16x16x32_bf16 v[208:211], v[132:135], v[196:199], v[204:207]
    v_rcp_f32 v143, v143
    v_rcp_f32 v144, v144
    v_cvt_pk_bf16_f32 v137, v142, v143
    v_rcp_f32 v145, v145
    v_rcp_f32 v146, v146
    v_rcp_f32 v147, v147
    v_cvt_pk_bf16_f32 v138, v144, v145
    v_cvt_pk_bf16_f32 v139, v146, v147
    ds_read_u8 v230, v237 offset:112
    ds_read_u8 v232, v237 offset:120
    v_mfma_f32_16x16x32_bf16 v[208:211], v[136:139], v[200:203], v[208:211]
    s_bitcmp1_b32 s36, 3
    s_cbranch_scc1 Lf_ev3
Lf_evd3:
    v_exp_f32 v132, v148
    v_exp_f32 v133, v149
    v_exp_f32 v134, v150
    v_exp_f32 v135, v151
    v_exp_f32 v136, v152
    v_exp_f32 v137, v153
    v_mfma_f32_4x4x4_16b_bf16 v[132:135], v[228:229], v[228:229], v[132:135]
    v_cvt_pk_bf16_f32 v208, v208, v209
    v_cvt_pk_bf16_f32 v209, v210, v211
    s_waitcnt lgkmcnt(2)
    v_mfma_f32_16x16x32_bf16 v[148:151], v[100:103], v[180:183], v[164:167]
    v_exp_f32 v138, v154
    v_mfma_f32_4x4x4_16b_bf16 v[212:215], v[208:209], v[188:189], v[212:215] cbsz:4 abid:0
    ds_read_b64_tr_b16 v[188:189], v236 offset:6240
    v_exp_f32 v139, v155
    v_mfma_f32_16x16x32_bf16 v[152:155], v[108:111], v[180:183], v[168:171]
    v_exp_f32 v140, v156
    v_mfma_f32_4x4x4_16b_bf16 v[212:215], v[208:209], v[190:191], v[212:215] cbsz:4 abid:4
    ds_read_b64_tr_b16 v[190:191], v236 offset:6752
    v_mfma_f32_4x4x4_16b_bf16 v[136:139], v[228:229], v[228:229], v[136:139]
    v_rcp_f32 v132, v132
    v_mfma_f32_4x4x4_16b_bf16 v[212:215], v[208:209], v[192:193], v[212:215] cbsz:4 abid:8
    ds_read_b64_tr_b16 v[192:193], v236 offset:7296
    v_exp_f32 v141, v157
    v_mfma_f32_16x16x32_bf16 v[148:151], v[104:107], v[184:187], v[148:151]
    v_rcp_f32 v133, v133
    v_mfma_f32_4x4x4_16b_bf16 v[212:215], v[208:209], v[194:195], v[212:215] cbsz:4 abid:12
    ds_read_b64_tr_b16 v[194:195], v236 offset:7808
    v_exp_f32 v142, v158
    v_mfma_f32_16x16x32_bf16 v[152:155], v[112:115], v[184:187], v[152:155]
    v_rcp_f32 v134, v134
    v_exp_f32 v143, v159
    v_rcp_f32 v135, v135
    v_cvt_pk_bf16_f32 v132, v132, v133
    v_mfma_f32_4x4x4_16b_bf16 v[140:143], v[228:229], v[228:229], v[140:143]
    v_exp_f32 v144, v160
    v_mfma_f32_16x16x32_bf16 v[156:159], v[116:119], v[180:183], v[172:175]
    v_rcp_f32 v136, v136
    v_cvt_pk_bf16_f32 v133, v134, v135
    s_add_u32 m0, s52, 6240
    s_waitcnt lgkmcnt(0)
    buffer_load_dwordx4 v[230:231], s[20:23], s35 idxen offen nt lds
    v_exp_f32 v145, v161
    buffer_load_dwordx4 v[232:233], s[40:43], s35 idxen offen offset:1056 nt lds
    v_rcp_f32 v137, v137
    v_exp_f32 v146, v162
    v_rcp_f32 v138, v138
    v_cvt_pk_bf16_f32 v134, v136, v137
    v_exp_f32 v147, v163
    v_mfma_f32_16x16x32_bf16 v[160:163], v[124:127], v[180:183], v[176:179]
    v_rcp_f32 v139, v139
    v_mfma_f32_4x4x4_16b_bf16 v[144:147], v[228:229], v[228:229], v[144:147]
    v_mfma_f32_16x16x32_bf16 v[156:159], v[120:123], v[184:187], v[156:159]
    v_rcp_f32 v140, v140
    v_mfma_f32_16x16x32_bf16 v[160:163], v[128:131], v[184:187], v[160:163]
    v_rcp_f32 v141, v141
    v_cvt_pk_bf16_f32 v135, v138, v139
    s_waitcnt vmcnt(4)
    ds_read_b128 v[180:183], v234 offset:2080
    ds_read_b128 v[184:187], v235 offset:2080
    v_rcp_f32 v142, v142
    v_cvt_pk_bf16_f32 v136, v140, v141
    v_mfma_f32_16x16x32_bf16 v[208:211], v[132:135], v[196:199], v[204:207]
    v_rcp_f32 v143, v143
    s_lshr_b64 s[56:57], s[56:57], 4
    s_lshl_b64 s[86:87], s[58:59], 60
    s_or_b64 s[56:57], s[56:57], s[86:87]
    s_lshr_b64 s[58:59], s[58:59], 4
    s_lshr_b64 s[86:87], s[56:57], 2
    s_lshr_b64 s[36:37], s[56:57], 5
    s_or_b32 s36, s36, s86
    s_or_b32 s36, s36, s56
    v_add_u32 v237, 64, v237
    v_rcp_f32 v144, v144
    v_cvt_pk_bf16_f32 v137, v142, v143
    v_rcp_f32 v145, v145
    v_rcp_f32 v146, v146
    v_rcp_f32 v147, v147
    v_cvt_pk_bf16_f32 v138, v144, v145
    v_cvt_pk_bf16_f32 v139, v146, v147
    s_branch Lf_loop
Lf_ev0:
    s_bitcmp0_b64 s[56:57], 0
    s_cbranch_scc1 Lf_nf0
    v_cvt_pk_bf16_f32 v246, v212, v212
    v_mov_b32 v212, 0
    ds_write_b16 v240, v246
    v_add_u32 v240, 128, v240
Lf_nf0:
    s_bitcmp0_b64 s[56:57], 5
    s_cbranch_scc1 Lf_na0
    s_sub_u32 s60, s60, 1
    s_cbranch_scc0 Lf_ns0
    s_mov_b32 s49, 5
    s_call_b64 s[62:63], L_swap
    ds_read_u8 v230, v237 offset:64
    ds_read_u8 v232, v237 offset:72
    s_add_u32 s35, s35, s31
    s_min_u32 s35, s35, 419404800
    s_xor_b32 s31, s31, 0x63ff800
    s_bitcmp0_b64 s[56:57], 2
    s_cbranch_scc1 Lf_evd0
    s_waitcnt lgkmcnt(0)
    s_branch Lf_e10
Lf_ns0:
    s_add_u32 s35, s35, s31
    s_min_u32 s35, s35, 419404800
    s_xor_b32 s31, s31, 0x63ff800
Lf_na0:
    s_bitcmp0_b64 s[56:57], 2
    s_cbranch_scc1 Lf_evd0
Lf_e10:
    s_sub_u32 s61, s61, 1
    s_cbranch_scc1 Lf_last0
    s_cmp_lg_u32 s61, s45
    s_cbranch_scc1 Lf_nw0
    v_add_u32 v238, s47, v238
    v_add_u32 v239, s47, v239
    ds_read_u16 v224, v238 offset:0
    ds_read_u16 v225, v238 offset:8
    ds_read_u16 v226, v238 offset:64
    ds_read_u16 v227, v238 offset:72
    s_waitcnt lgkmcnt(0)
Lf_nw0:
    v_mul_u32_u24 v216, v224, v241
    v_mul_u32_u24 v217, v224, v242
    v_mul_u32_u24 v218, v225, v241
    v_mul_u32_u24 v219, v225, v242
    v_mul_u32_u24 v220, v226, v241
    v_mul_u32_u24 v221, v226, v242
    v_mul_u32_u24 v222, v227, v241
    v_mul_u32_u24 v223, v227, v242
    v_add_u32 v238, 128, v238
    ds_read_b128 v[164:167], v239
    v_mfma_f32_4x4x4_16b_bf16 v[132:135], v[216:217], v[68:69], v[4:7]
    ds_read_b128 v[168:171], v239 offset:64
    ds_read_b128 v[172:175], v239 offset:128
    v_mfma_f32_4x4x4_16b_bf16 v[136:139], v[218:219], v[70:71], v[8:11]
    ds_read_b128 v[176:179], v239 offset:192
    ds_read_u16 v224, v238
    v_mfma_f32_4x4x4_16b_bf16 v[140:143], v[220:221], v[72:73], v[12:15]
    ds_read_u16 v225, v238 offset:8
    ds_read_u16 v226, v238 offset:64
    v_mfma_f32_4x4x4_16b_bf16 v[144:147], v[222:223], v[74:75], v[16:19]
    ds_read_u16 v227, v238 offset:72
    v_add_u32 v239, 272, v239
    v_mfma_f32_4x4x4_16b_bf16 v[246:249], v[216:217], v[76:77], v[20:23]
    v_cvt_pk_bf16_f32 v100, v132, v133
    v_cvt_pk_bf16_f32 v101, v134, v135
    v_mfma_f32_4x4x4_16b_bf16 v[250:253], v[218:219], v[78:79], v[24:27]
    v_cvt_pk_bf16_f32 v102, v136, v137
    v_cvt_pk_bf16_f32 v103, v138, v139
    v_mfma_f32_4x4x4_16b_bf16 v[132:135], v[220:221], v[80:81], v[28:31]
    v_cvt_pk_bf16_f32 v104, v140, v141
    v_cvt_pk_bf16_f32 v105, v142, v143
    v_mfma_f32_4x4x4_16b_bf16 v[136:139], v[222:223], v[82:83], v[32:35]
    v_cvt_pk_bf16_f32 v106, v144, v145
    v_cvt_pk_bf16_f32 v107, v146, v147
    v_mfma_f32_4x4x4_16b_bf16 v[140:143], v[216:217], v[84:85], v[36:39]
    v_cvt_pk_bf16_f32 v108, v246, v247
    v_cvt_pk_bf16_f32 v109, v248, v249
    v_mfma_f32_4x4x4_16b_bf16 v[144:147], v[218:219], v[86:87], v[40:43]
    v_cvt_pk_bf16_f32 v110, v250, v251
    v_cvt_pk_bf16_f32 v111, v252, v253
    v_mfma_f32_4x4x4_16b_bf16 v[246:249], v[220:221], v[88:89], v[44:47]
    v_cvt_pk_bf16_f32 v112, v132, v133
    v_cvt_pk_bf16_f32 v113, v134, v135
    v_mfma_f32_4x4x4_16b_bf16 v[250:253], v[222:223], v[90:91], v[48:51]
    v_cvt_pk_bf16_f32 v114, v136, v137
    v_cvt_pk_bf16_f32 v115, v138, v139
    v_mfma_f32_4x4x4_16b_bf16 v[132:135], v[216:217], v[92:93], v[52:55]
    v_cvt_pk_bf16_f32 v116, v140, v141
    v_cvt_pk_bf16_f32 v117, v142, v143
    v_mfma_f32_4x4x4_16b_bf16 v[136:139], v[218:219], v[94:95], v[56:59]
    v_cvt_pk_bf16_f32 v118, v144, v145
    v_cvt_pk_bf16_f32 v119, v146, v147
    v_mfma_f32_4x4x4_16b_bf16 v[140:143], v[220:221], v[96:97], v[60:63]
    v_cvt_pk_bf16_f32 v120, v246, v247
    v_cvt_pk_bf16_f32 v121, v248, v249
    v_mfma_f32_4x4x4_16b_bf16 v[144:147], v[222:223], v[98:99], v[64:67]
    v_cvt_pk_bf16_f32 v122, v250, v251
    v_cvt_pk_bf16_f32 v123, v252, v253
    v_cvt_pk_bf16_f32 v124, v132, v133
    v_cvt_pk_bf16_f32 v125, v134, v135
    v_cvt_pk_bf16_f32 v126, v136, v137
    v_cvt_pk_bf16_f32 v127, v138, v139
    v_cvt_pk_bf16_f32 v128, v140, v141
    v_cvt_pk_bf16_f32 v129, v142, v143
    v_cvt_pk_bf16_f32 v130, v144, v145
    v_cvt_pk_bf16_f32 v131, v146, v147
    s_waitcnt lgkmcnt(0)
    s_branch Lf_evd0
Lf_ev1:
    s_bitcmp0_b64 s[56:57], 1
    s_cbranch_scc1 Lf_nf1
    v_cvt_pk_bf16_f32 v246, v212, v212
    v_mov_b32 v212, 0
    ds_write_b16 v240, v246
    v_add_u32 v240, 128, v240
Lf_nf1:
    s_bitcmp0_b64 s[56:57], 6
    s_cbranch_scc1 Lf_na1
    s_sub_u32 s60, s60, 1
    s_cbranch_scc0 Lf_ns1
    s_mov_b32 s49, 6
    s_call_b64 s[62:63], L_swap
    ds_read_u8 v230, v237 offset:80
    ds_read_u8 v232, v237 offset:88
    s_add_u32 s35, s35, s31
    s_min_u32 s35, s35, 419404800
    s_xor_b32 s31, s31, 0x63ff800
    s_bitcmp0_b64 s[56:57], 3
    s_cbranch_scc1 Lf_evd1
    s_waitcnt lgkmcnt(0)
    s_branch Lf_e11
Lf_ns1:
    s_add_u32 s35, s35, s31
    s_min_u32 s35, s35, 419404800
    s_xor_b32 s31, s31, 0x63ff800
Lf_na1:
    s_bitcmp0_b64 s[56:57], 3
    s_cbranch_scc1 Lf_evd1
Lf_e11:
    s_sub_u32 s61, s61, 1
    s_cbranch_scc1 Lf_last1
    s_cmp_lg_u32 s61, s45
    s_cbranch_scc1 Lf_nw1
    v_add_u32 v238, s47, v238
    v_add_u32 v239, s47, v239
    ds_read_u16 v224, v238 offset:0
    ds_read_u16 v225, v238 offset:8
    ds_read_u16 v226, v238 offset:64
    ds_read_u16 v227, v238 offset:72
    s_waitcnt lgkmcnt(0)
Lf_nw1:
    v_mul_u32_u24 v216, v224, v241
    v_mul_u32_u24 v217, v224, v242
    v_mul_u32_u24 v218, v225, v241
    v_mul_u32_u24 v219, v225, v242
    v_mul_u32_u24 v220, v226, v241
    v_mul_u32_u24 v221, v226, v242
    v_mul_u32_u24 v222, v227, v241
    v_mul_u32_u24 v223, v227, v242
    v_add_u32 v238, 128, v238
    ds_read_b128 v[164:167], v239
    v_mfma_f32_4x4x4_16b_bf16 v[132:135], v[216:217], v[68:69], v[4:7]
    ds_read_b128 v[168:171], v239 offset:64
    ds_read_b128 v[172:175], v239 offset:128
    v_mfma_f32_4x4x4_16b_bf16 v[136:139], v[218:219], v[70:71], v[8:11]
    ds_read_b128 v[176:179], v239 offset:192
    ds_read_u16 v224, v238
    v_mfma_f32_4x4x4_16b_bf16 v[140:143], v[220:221], v[72:73], v[12:15]
    ds_read_u16 v225, v238 offset:8
    ds_read_u16 v226, v238 offset:64
    v_mfma_f32_4x4x4_16b_bf16 v[144:147], v[222:223], v[74:75], v[16:19]
    ds_read_u16 v227, v238 offset:72
    v_add_u32 v239, 272, v239
    v_mfma_f32_4x4x4_16b_bf16 v[246:249], v[216:217], v[76:77], v[20:23]
    v_cvt_pk_bf16_f32 v100, v132, v133
    v_cvt_pk_bf16_f32 v101, v134, v135
    v_mfma_f32_4x4x4_16b_bf16 v[250:253], v[218:219], v[78:79], v[24:27]
    v_cvt_pk_bf16_f32 v102, v136, v137
    v_cvt_pk_bf16_f32 v103, v138, v139
    v_mfma_f32_4x4x4_16b_bf16 v[132:135], v[220:221], v[80:81], v[28:31]
    v_cvt_pk_bf16_f32 v104, v140, v141
    v_cvt_pk_bf16_f32 v105, v142, v143
    v_mfma_f32_4x4x4_16b_bf16 v[136:139], v[222:223], v[82:83], v[32:35]
    v_cvt_pk_bf16_f32 v106, v144, v145
    v_cvt_pk_bf16_f32 v107, v146, v147
    v_mfma_f32_4x4x4_16b_bf16 v[140:143], v[216:217], v[84:85], v[36:39]
    v_cvt_pk_bf16_f32 v108, v246, v247
    v_cvt_pk_bf16_f32 v109, v248, v249
    v_mfma_f32_4x4x4_16b_bf16 v[144:147], v[218:219], v[86:87], v[40:43]
    v_cvt_pk_bf16_f32 v110, v250, v251
    v_cvt_pk_bf16_f32 v111, v252, v253
    v_mfma_f32_4x4x4_16b_bf16 v[246:249], v[220:221], v[88:89], v[44:47]
    v_cvt_pk_bf16_f32 v112, v132, v133
    v_cvt_pk_bf16_f32 v113, v134, v135
    v_mfma_f32_4x4x4_16b_bf16 v[250:253], v[222:223], v[90:91], v[48:51]
    v_cvt_pk_bf16_f32 v114, v136, v137
    v_cvt_pk_bf16_f32 v115, v138, v139
    v_mfma_f32_4x4x4_16b_bf16 v[132:135], v[216:217], v[92:93], v[52:55]
    v_cvt_pk_bf16_f32 v116, v140, v141
    v_cvt_pk_bf16_f32 v117, v142, v143
    v_mfma_f32_4x4x4_16b_bf16 v[136:139], v[218:219], v[94:95], v[56:59]
    v_cvt_pk_bf16_f32 v118, v144, v145
    v_cvt_pk_bf16_f32 v119, v146, v147
    v_mfma_f32_4x4x4_16b_bf16 v[140:143], v[220:221], v[96:97], v[60:63]
    v_cvt_pk_bf16_f32 v120, v246, v247
    v_cvt_pk_bf16_f32 v121, v248, v249
    v_mfma_f32_4x4x4_16b_bf16 v[144:147], v[222:223], v[98:99], v[64:67]
    v_cvt_pk_bf16_f32 v122, v250, v251
    v_cvt_pk_bf16_f32 v123, v252, v253
    v_cvt_pk_bf16_f32 v124, v132, v133
    v_cvt_pk_bf16_f32 v125, v134, v135
    v_cvt_pk_bf16_f32 v126, v136, v137
    v_cvt_pk_bf16_f32 v127, v138, v139
    v_cvt_pk_bf16_f32 v128, v140, v141
    v_cvt_pk_bf16_f32 v129, v142, v143
    v_cvt_pk_bf16_f32 v130, v144, v145
    v_cvt_pk_bf16_f32 v131, v146, v147
    s_waitcnt lgkmcnt(0)
    s_branch Lf_evd1
Lf_ev2:
    s_bitcmp0_b64 s[56:57], 2
    s_cbranch_scc1 Lf_nf2
    v_cvt_pk_bf16_f32 v246, v212, v212
    v_mov_b32 v212, 0
    ds_write_b16 v240, v246
    v_add_u32 v240, 128, v240
Lf_nf2:
    s_bitcmp0_b64 s[56:57], 7
    s_cbranch_scc1 Lf_na2
    s_sub_u32 s60, s60, 1
    s_cbranch_scc0 Lf_ns2
    s_mov_b32 s49, 7
    s_call_b64 s[62:63], L_swap
    ds_read_u8 v230, v237 offset:96
    ds_read_u8 v232, v237 offset:104
    s_add_u32 s35, s35, s31
    s_min_u32 s35, s35, 419404800
    s_xor_b32 s31, s31, 0x63ff800
    s_bitcmp0_b64 s[56:57], 4
    s_cbranch_scc1 Lf_evd2
    s_waitcnt lgkmcnt(0)
    s_branch Lf_e12
Lf_ns2:
    s_add_u32 s35, s35, s31
    s_min_u32 s35, s35, 419404800
    s_xor_b32 s31, s31, 0x63ff800
Lf_na2:
    s_bitcmp0_b64 s[56:57], 4
    s_cbranch_scc1 Lf_evd2
Lf_e12:
    s_sub_u32 s61, s61, 1
    s_cbranch_scc1 Lf_last2
    s_cmp_lg_u32 s61, s45
    s_cbranch_scc1 Lf_nw2
    v_add_u32 v238, s47, v238
    v_add_u32 v239, s47, v239
    ds_read_u16 v224, v238 offset:0
    ds_read_u16 v225, v238 offset:8
    ds_read_u16 v226, v238 offset:64
    ds_read_u16 v227, v238 offset:72
    s_waitcnt lgkmcnt(0)
Lf_nw2:
    v_mul_u32_u24 v216, v224, v241
    v_mul_u32_u24 v217, v224, v242
    v_mul_u32_u24 v218, v225, v241
    v_mul_u32_u24 v219, v225, v242
    v_mul_u32_u24 v220, v226, v241
    v_mul_u32_u24 v221, v226, v242
    v_mul_u32_u24 v222, v227, v241
    v_mul_u32_u24 v223, v227, v242
    v_add_u32 v238, 128, v238
    ds_read_b128 v[164:167], v239
    v_mfma_f32_4x4x4_16b_bf16 v[132:135], v[216:217], v[68:69], v[4:7]
    ds_read_b128 v[168:171], v239 offset:64
    ds_read_b128 v[172:175], v239 offset:128
    v_mfma_f32_4x4x4_16b_bf16 v[136:139], v[218:219], v[70:71], v[8:11]
    ds_read_b128 v[176:179], v239 offset:192
    ds_read_u16 v224, v238
    v_mfma_f32_4x4x4_16b_bf16 v[140:143], v[220:221], v[72:73], v[12:15]
    ds_read_u16 v225, v238 offset:8
    ds_read_u16 v226, v238 offset:64
    v_mfma_f32_4x4x4_16b_bf16 v[144:147], v[222:223], v[74:75], v[16:19]
    ds_read_u16 v227, v238 offset:72
    v_add_u32 v239, 272, v239
    v_mfma_f32_4x4x4_16b_bf16 v[246:249], v[216:217], v[76:77], v[20:23]
    v_cvt_pk_bf16_f32 v100, v132, v133
    v_cvt_pk_bf16_f32 v101, v134, v135
    v_mfma_f32_4x4x4_16b_bf16 v[250:253], v[218:219], v[78:79], v[24:27]
    v_cvt_pk_bf16_f32 v102, v136, v137
    v_cvt_pk_bf16_f32 v103, v138, v139
    v_mfma_f32_4x4x4_16b_bf16 v[132:135], v[220:221], v[80:81], v[28:31]
    v_cvt_pk_bf16_f32 v104, v140, v141
    v_cvt_pk_bf16_f32 v105, v142, v143
    v_mfma_f32_4x4x4_16b_bf16 v[136:139], v[222:223], v[82:83], v[32:35]
    v_cvt_pk_bf16_f32 v106, v144, v145
    v_cvt_pk_bf16_f32 v107, v146, v147
    v_mfma_f32_4x4x4_16b_bf16 v[140:143], v[216:217], v[84:85], v[36:39]
    v_cvt_pk_bf16_f32 v108, v246, v247
    v_cvt_pk_bf16_f32 v109, v248, v249
    v_mfma_f32_4x4x4_16b_bf16 v[144:147], v[218:219], v[86:87], v[40:43]
    v_cvt_pk_bf16_f32 v110, v250, v251
    v_cvt_pk_bf16_f32 v111, v252, v253
    v_mfma_f32_4x4x4_16b_bf16 v[246:249], v[220:221], v[88:89], v[44:47]
    v_cvt_pk_bf16_f32 v112, v132, v133
    v_cvt_pk_bf16_f32 v113, v134, v135
    v_mfma_f32_4x4x4_16b_bf16 v[250:253], v[222:223], v[90:91], v[48:51]
    v_cvt_pk_bf16_f32 v114, v136, v137
    v_cvt_pk_bf16_f32 v115, v138, v139
    v_mfma_f32_4x4x4_16b_bf16 v[132:135], v[216:217], v[92:93], v[52:55]
    v_cvt_pk_bf16_f32 v116, v140, v141
    v_cvt_pk_bf16_f32 v117, v142, v143
    v_mfma_f32_4x4x4_16b_bf16 v[136:139], v[218:219], v[94:95], v[56:59]
    v_cvt_pk_bf16_f32 v118, v144, v145
    v_cvt_pk_bf16_f32 v119, v146, v147
    v_mfma_f32_4x4x4_16b_bf16 v[140:143], v[220:221], v[96:97], v[60:63]
    v_cvt_pk_bf16_f32 v120, v246, v247
    v_cvt_pk_bf16_f32 v121, v248, v249
    v_mfma_f32_4x4x4_16b_bf16 v[144:147], v[222:223], v[98:99], v[64:67]
    v_cvt_pk_bf16_f32 v122, v250, v251
    v_cvt_pk_bf16_f32 v123, v252, v253
    v_cvt_pk_bf16_f32 v124, v132, v133
    v_cvt_pk_bf16_f32 v125, v134, v135
    v_cvt_pk_bf16_f32 v126, v136, v137
    v_cvt_pk_bf16_f32 v127, v138, v139
    v_cvt_pk_bf16_f32 v128, v140, v141
    v_cvt_pk_bf16_f32 v129, v142, v143
    v_cvt_pk_bf16_f32 v130, v144, v145
    v_cvt_pk_bf16_f32 v131, v146, v147
    s_waitcnt lgkmcnt(0)
    s_branch Lf_evd2
Lf_ev3:
    s_bitcmp0_b64 s[56:57], 3
    s_cbranch_scc1 Lf_nf3
    v_cvt_pk_bf16_f32 v246, v212, v212
    v_mov_b32 v212, 0
    ds_write_b16 v240, v246
    v_add_u32 v240, 128, v240
Lf_nf3:
    s_bitcmp0_b64 s[56:57], 8
    s_cbranch_scc1 Lf_na3
    s_sub_u32 s60, s60, 1
    s_cbranch_scc0 Lf_ns3
    s_mov_b32 s49, 8
    s_call_b64 s[62:63], L_swap
    ds_read_u8 v230, v237 offset:112
    ds_read_u8 v232, v237 offset:120
    s_add_u32 s35, s35, s31
    s_min_u32 s35, s35, 419404800
    s_xor_b32 s31, s31, 0x63ff800
    s_bitcmp0_b64 s[56:57], 5
    s_cbranch_scc1 Lf_evd3
    s_waitcnt lgkmcnt(0)
    s_branch Lf_e13
Lf_ns3:
    s_add_u32 s35, s35, s31
    s_min_u32 s35, s35, 419404800
    s_xor_b32 s31, s31, 0x63ff800
Lf_na3:
    s_bitcmp0_b64 s[56:57], 5
    s_cbranch_scc1 Lf_evd3
Lf_e13:
    s_sub_u32 s61, s61, 1
    s_cbranch_scc1 Lf_last3
    s_cmp_lg_u32 s61, s45
    s_cbranch_scc1 Lf_nw3
    v_add_u32 v238, s47, v238
    v_add_u32 v239, s47, v239
    ds_read_u16 v224, v238 offset:0
    ds_read_u16 v225, v238 offset:8
    ds_read_u16 v226, v238 offset:64
    ds_read_u16 v227, v238 offset:72
    s_waitcnt lgkmcnt(0)
Lf_nw3:
    v_mul_u32_u24 v216, v224, v241
    v_mul_u32_u24 v217, v224, v242
    v_mul_u32_u24 v218, v225, v241
    v_mul_u32_u24 v219, v225, v242
    v_mul_u32_u24 v220, v226, v241
    v_mul_u32_u24 v221, v226, v242
    v_mul_u32_u24 v222, v227, v241
    v_mul_u32_u24 v223, v227, v242
    v_add_u32 v238, 128, v238
    ds_read_b128 v[164:167], v239
    v_mfma_f32_4x4x4_16b_bf16 v[132:135], v[216:217], v[68:69], v[4:7]
    ds_read_b128 v[168:171], v239 offset:64
    ds_read_b128 v[172:175], v239 offset:128
    v_mfma_f32_4x4x4_16b_bf16 v[136:139], v[218:219], v[70:71], v[8:11]
    ds_read_b128 v[176:179], v239 offset:192
    ds_read_u16 v224, v238
    v_mfma_f32_4x4x4_16b_bf16 v[140:143], v[220:221], v[72:73], v[12:15]
    ds_read_u16 v225, v238 offset:8
    ds_read_u16 v226, v238 offset:64
    v_mfma_f32_4x4x4_16b_bf16 v[144:147], v[222:223], v[74:75], v[16:19]
    ds_read_u16 v227, v238 offset:72
    v_add_u32 v239, 272, v239
    v_mfma_f32_4x4x4_16b_bf16 v[246:249], v[216:217], v[76:77], v[20:23]
    v_cvt_pk_bf16_f32 v100, v132, v133
    v_cvt_pk_bf16_f32 v101, v134, v135
    v_mfma_f32_4x4x4_16b_bf16 v[250:253], v[218:219], v[78:79], v[24:27]
    v_cvt_pk_bf16_f32 v102, v136, v137
    v_cvt_pk_bf16_f32 v103, v138, v139
    v_mfma_f32_4x4x4_16b_bf16 v[132:135], v[220:221], v[80:81], v[28:31]
    v_cvt_pk_bf16_f32 v104, v140, v141
    v_cvt_pk_bf16_f32 v105, v142, v143
    v_mfma_f32_4x4x4_16b_bf16 v[136:139], v[222:223], v[82:83], v[32:35]
    v_cvt_pk_bf16_f32 v106, v144, v145
    v_cvt_pk_bf16_f32 v107, v146, v147
    v_mfma_f32_4x4x4_16b_bf16 v[140:143], v[216:217], v[84:85], v[36:39]
    v_cvt_pk_bf16_f32 v108, v246, v247
    v_cvt_pk_bf16_f32 v109, v248, v249
    v_mfma_f32_4x4x4_16b_bf16 v[144:147], v[218:219], v[86:87], v[40:43]
    v_cvt_pk_bf16_f32 v110, v250, v251
    v_cvt_pk_bf16_f32 v111, v252, v253
    v_mfma_f32_4x4x4_16b_bf16 v[246:249], v[220:221], v[88:89], v[44:47]
    v_cvt_pk_bf16_f32 v112, v132, v133
    v_cvt_pk_bf16_f32 v113, v134, v135
    v_mfma_f32_4x4x4_16b_bf16 v[250:253], v[222:223], v[90:91], v[48:51]
    v_cvt_pk_bf16_f32 v114, v136, v137
    v_cvt_pk_bf16_f32 v115, v138, v139
    v_mfma_f32_4x4x4_16b_bf16 v[132:135], v[216:217], v[92:93], v[52:55]
    v_cvt_pk_bf16_f32 v116, v140, v141
    v_cvt_pk_bf16_f32 v117, v142, v143
    v_mfma_f32_4x4x4_16b_bf16 v[136:139], v[218:219], v[94:95], v[56:59]
    v_cvt_pk_bf16_f32 v118, v144, v145
    v_cvt_pk_bf16_f32 v119, v146, v147
    v_mfma_f32_4x4x4_16b_bf16 v[140:143], v[220:221], v[96:97], v[60:63]
    v_cvt_pk_bf16_f32 v120, v246, v247
    v_cvt_pk_bf16_f32 v121, v248, v249
    v_mfma_f32_4x4x4_16b_bf16 v[144:147], v[222:223], v[98:99], v[64:67]
    v_cvt_pk_bf16_f32 v122, v250, v251
    v_cvt_pk_bf16_f32 v123, v252, v253
    v_cvt_pk_bf16_f32 v124, v132, v133
    v_cvt_pk_bf16_f32 v125, v134, v135
    v_cvt_pk_bf16_f32 v126, v136, v137
    v_cvt_pk_bf16_f32 v127, v138, v139
    v_cvt_pk_bf16_f32 v128, v140, v141
    v_cvt_pk_bf16_f32 v129, v142, v143
    v_cvt_pk_bf16_f32 v130, v144, v145
    v_cvt_pk_bf16_f32 v131, v146, v147
    s_waitcnt lgkmcnt(0)
    s_branch Lf_evd3
Lf_last0:
    s_branch Lf_tail
Lf_last1:
    v_add_u32 v236, 2080, v236
    s_lshr_b64 s[56:57], s[56:57], 1
    s_branch Lf_tail
Lf_last2:
    v_add_u32 v236, 4160, v236
    s_lshr_b64 s[56:57], s[56:57], 2
    s_branch Lf_tail
Lf_last3:
    v_add_u32 v236, 6240, v236
    s_lshr_b64 s[56:57], s[56:57], 3
Lf_tail:
    v_exp_f32 v132, v148
    v_exp_f32 v133, v149
    v_exp_f32 v134, v150
    v_exp_f32 v135, v151
    v_exp_f32 v136, v152
    v_exp_f32 v137, v153
    v_mfma_f32_4x4x4_16b_bf16 v[132:135], v[228:229], v[228:229], v[132:135]
    v_cvt_pk_bf16_f32 v208, v208, v209
    v_cvt_pk_bf16_f32 v209, v210, v211
    v_exp_f32 v138, v154
    s_nop 0
    v_mfma_f32_4x4x4_16b_bf16 v[212:215], v[208:209], v[188:189], v[212:215] cbsz:4 abid:0
    ds_read_b64_tr_b16 v[188:189], v236 offset:0
    v_exp_f32 v139, v155
    v_exp_f32 v140, v156
    v_mfma_f32_4x4x4_16b_bf16 v[212:215], v[208:209], v[190:191], v[212:215] cbsz:4 abid:4
    ds_read_b64_tr_b16 v[190:191], v236 offset:512
    v_mfma_f32_4x4x4_16b_bf16 v[136:139], v[228:229], v[228:229], v[136:139]
    v_rcp_f32 v132, v132
    v_mfma_f32_4x4x4_16b_bf16 v[212:215], v[208:209], v[192:193], v[212:215] cbsz:4 abid:8
    ds_read_b64_tr_b16 v[192:193], v236 offset:1056
    v_exp_f32 v141, v157
    v_rcp_f32 v133, v133
    v_mfma_f32_4x4x4_16b_bf16 v[212:215], v[208:209], v[194:195], v[212:215] cbsz:4 abid:12
    ds_read_b64_tr_b16 v[194:195], v236 offset:1568
    v_exp_f32 v142, v158
    v_rcp_f32 v134, v134
    v_exp_f32 v143, v159
    v_rcp_f32 v135, v135
    v_cvt_pk_bf16_f32 v132, v132, v133
    v_mfma_f32_4x4x4_16b_bf16 v[140:143], v[228:229], v[228:229], v[140:143]
    v_exp_f32 v144, v160
    v_rcp_f32 v136, v136
    v_cvt_pk_bf16_f32 v133, v134, v135
    s_bitcmp0_b64 s[56:57], 1
    s_cbranch_scc1 Lf_tnf
    v_cvt_pk_bf16_f32 v246, v212, v212
    v_mov_b32 v212, 0
    ds_write_b16 v240, v246
    v_add_u32 v240, 128, v240
Lf_tnf:
    s_waitcnt lgkmcnt(0)
    v_exp_f32 v145, v161
    v_rcp_f32 v137, v137
    v_exp_f32 v146, v162
    v_rcp_f32 v138, v138
    v_cvt_pk_bf16_f32 v134, v136, v137
    v_exp_f32 v147, v163
    v_rcp_f32 v139, v139
    s_nop 0
    v_mfma_f32_4x4x4_16b_bf16 v[144:147], v[228:229], v[228:229], v[144:147]
    v_rcp_f32 v140, v140
    v_rcp_f32 v141, v141
    v_cvt_pk_bf16_f32 v135, v138, v139
    v_rcp_f32 v142, v142
    v_cvt_pk_bf16_f32 v136, v140, v141
    v_mfma_f32_16x16x32_bf16 v[208:211], v[132:135], v[196:199], v[204:207]
    v_rcp_f32 v143, v143
    v_rcp_f32 v144, v144
    v_cvt_pk_bf16_f32 v137, v142, v143
    v_rcp_f32 v145, v145
    v_rcp_f32 v146, v146
    v_rcp_f32 v147, v147
    v_cvt_pk_bf16_f32 v138, v144, v145
    v_cvt_pk_bf16_f32 v139, v146, v147
    s_nop 1
    v_mfma_f32_16x16x32_bf16 v[208:211], v[136:139], v[200:203], v[208:211]
    s_nop 7
    v_cvt_pk_bf16_f32 v208, v208, v209
    v_cvt_pk_bf16_f32 v209, v210, v211
    s_nop 1
    v_mfma_f32_4x4x4_16b_bf16 v[212:215], v[208:209], v[188:189], v[212:215] cbsz:4 abid:0
    s_nop 1
    v_mfma_f32_4x4x4_16b_bf16 v[212:215], v[208:209], v[190:191], v[212:215] cbsz:4 abid:4
    s_nop 1
    v_mfma_f32_4x4x4_16b_bf16 v[212:215], v[208:209], v[192:193], v[212:215] cbsz:4 abid:8
    s_nop 1
    v_mfma_f32_4x4x4_16b_bf16 v[212:215], v[208:209], v[194:195], v[212:215] cbsz:4 abid:12
    s_nop 4
    v_cvt_pk_bf16_f32 v246, v212, v212
    ds_write_b16 v240, v246
L_store:
    s_add_u32 s66, s52, 14880
    v_lshl_add_u32 v247, v0, 4, s66
    s_bfm_b64 exec, 16, 48
    v_add_u32 v243, s50, v243
    s_mov_b64 exec, -1
    ds_read_b128 v[148:151], v247
    s_waitcnt lgkmcnt(0)
    global_store_dwordx4 v243, v[148:151], s[18:19] sc0 sc1
L_end:
    s_endpgm
L_general:
    s_waitcnt vmcnt(0)
    ds_read_b128 v[44:47], v246 offset:20480
    ds_read_b128 v[48:51], v246 offset:21504
    ds_read_b128 v[88:91], v246 offset:22528
    ds_read_b128 v[52:55], v246 offset:40960
    ds_read_b128 v[56:59], v246 offset:41984
    ds_read_b128 v[92:95], v246 offset:43008
    ds_read_b128 v[60:63], v246 offset:61440
    ds_read_b128 v[64:67], v246 offset:62464
    ds_read_b128 v[96:99], v246 offset:63488
    ds_read_u16 v224, v238 offset:0
    ds_read_u16 v225, v238 offset:8
    ds_read_u16 v226, v238 offset:64
    ds_read_u16 v227, v238 offset:72
    s_mul_i32 s35, s53, 51200
    s_movk_i32 s31, 25600
    s_mov_b32 s60, 5
    s_mov_b64 s[56:57], 0
    s_mov_b64 s[58:59], 0
    v_mov_b32 v148, -1
    v_mov_b32 v149, -1
    v_mov_b32 v150, -1
    v_mov_b32 v151, -1
    s_add_u32 s66, s52, 18432
    v_add_u32 v152, s66, v2
    ds_write_b128 v152, v[148:151]
    ds_write_b128 v152, v[148:151] offset:1024
    s_add_u32 s64, s52, 18448
    s_bfm_b64 s[28:29], 50, 0
    s_mul_i32 s66, s53, 800
    v_add_u32 v247, s66, v2
    s_mov_b64 exec, s[28:29]
    global_load_dwordx4 v[100:103], v247, s[8:9]
    v_add_u32 v247, 1638400, v247
    global_load_dwordx4 v[104:107], v247, s[8:9]
    v_add_u32 v247, 1638400, v247
    global_load_dwordx4 v[108:111], v247, s[8:9]
    v_add_u32 v247, 1638400, v247
    global_load_dwordx4 v[112:115], v247, s[8:9]
    v_add_u32 v247, 1638400, v247
    s_mov_b64 exec, -1
    v_cmp_lt_u32 vcc, 24, v0
    s_nop 1
    v_cndmask_b32 v145, 0, 1, vcc
    v_mul_u32_u24 v142, 25, v145
    v_sub_u32 v142, v0, v142
    v_mul_u32_u24 v142, 0x80008, v142
    v_add_u32 v141, 0x10000, v142
    v_add_u32 v143, 0x50004, v142
    v_add_u32 v144, 0x70006, v142
    v_add_u32 v142, 0x30002, v142
    s_waitcnt vmcnt(0)
    s_mov_b64 exec, s[28:29]
    v_cmp_neq_f16_sdwa s[68:69], v100, 0 src0_sel:WORD_0 src1_sel:WORD_0
    v_cmp_neq_f16_sdwa s[70:71], v100, 0 src0_sel:WORD_1 src1_sel:WORD_0
    v_cmp_neq_f16_sdwa s[72:73], v101, 0 src0_sel:WORD_0 src1_sel:WORD_0
    v_cmp_neq_f16_sdwa s[74:75], v101, 0 src0_sel:WORD_1 src1_sel:WORD_0
    v_cmp_neq_f16_sdwa s[76:77], v102, 0 src0_sel:WORD_0 src1_sel:WORD_0
    v_cmp_neq_f16_sdwa s[78:79], v102, 0 src0_sel:WORD_1 src1_sel:WORD_0
    v_cmp_neq_f16_sdwa s[80:81], v103, 0 src0_sel:WORD_0 src1_sel:WORD_0
    v_cmp_neq_f16_sdwa s[82:83], v103, 0 src0_sel:WORD_1 src1_sel:WORD_0
    s_mov_b64 exec, -1
    v_mov_b32 v132, s64
    v_mbcnt_lo_u32_b32 v132, s68, v132
    v_mbcnt_hi_u32_b32 v132, s69, v132
    v_mbcnt_lo_u32_b32 v132, s70, v132
    v_mbcnt_hi_u32_b32 v132, s71, v132
    v_mbcnt_lo_u32_b32 v132, s72, v132
    v_mbcnt_hi_u32_b32 v132, s73, v132
    v_mbcnt_lo_u32_b32 v132, s74, v132
    v_mbcnt_hi_u32_b32 v132, s75, v132
    v_mbcnt_lo_u32_b32 v132, s76, v132
    v_mbcnt_hi_u32_b32 v132, s77, v132
    v_mbcnt_lo_u32_b32 v132, s78, v132
    v_mbcnt_hi_u32_b32 v132, s79, v132
    v_mbcnt_lo_u32_b32 v132, s80, v132
    v_mbcnt_hi_u32_b32 v132, s81, v132
    v_mbcnt_lo_u32_b32 v132, s82, v132
    v_mbcnt_hi_u32_b32 v132, s83, v132
    s_add_u32 s55, s64, 16
    v_readlane_b32 s66, v132, 25
    v_readlane_b32 s67, v132, 63
    s_add_u32 s64, s66, 15
    s_and_b32 s64, s64, -16
    s_max_u32 s64, s64, s55
    s_sub_u32 s66, s64, s66
    v_mad_u32_u24 v132, v145, s66, v132
    s_mov_b32 s55, s64
    v_addc_co_u32 v133, vcc, 0, v132, s[68:69]
    v_addc_co_u32 v134, vcc, 0, v133, s[70:71]
    v_addc_co_u32 v135, vcc, 0, v134, s[72:73]
    v_addc_co_u32 v136, vcc, 0, v135, s[74:75]
    v_addc_co_u32 v137, vcc, 0, v136, s[76:77]
    v_addc_co_u32 v138, vcc, 0, v137, s[78:79]
    v_addc_co_u32 v139, vcc, 0, v138, s[80:81]
    s_add_u32 s67, s67, s66
    s_add_u32 s67, s67, 15
    s_and_b32 s67, s67, -16
    s_add_u32 s64, s64, 16
    s_max_u32 s64, s64, s67
    s_mov_b64 exec, s[68:69]
    ds_write_b8 v132, v141
    s_mov_b64 exec, s[70:71]
    ds_write_b8_d16_hi v133, v141
    s_mov_b64 exec, s[72:73]
    ds_write_b8 v134, v142
    s_mov_b64 exec, s[74:75]
    ds_write_b8_d16_hi v135, v142
    s_mov_b64 exec, s[76:77]
    ds_write_b8 v136, v143
    s_mov_b64 exec, s[78:79]
    ds_write_b8_d16_hi v137, v143
    s_mov_b64 exec, s[80:81]
    ds_write_b8 v138, v144
    s_mov_b64 exec, s[82:83]
    ds_write_b8_d16_hi v139, v144
    s_mov_b64 exec, -1
    s_lshr_b32 s95, s55, 4
    s_bitset1_b64 s[56:57], s95
    s_lshr_b32 s95, s64, 4
    s_bitset1_b64 s[56:57], s95
    s_mov_b64 exec, s[28:29]
    v_cmp_neq_f16_sdwa s[68:69], v104, 0 src0_sel:WORD_0 src1_sel:WORD_0
    v_cmp_neq_f16_sdwa s[70:71], v104, 0 src0_sel:WORD_1 src1_sel:WORD_0
    v_cmp_neq_f16_sdwa s[72:73], v105, 0 src0_sel:WORD_0 src1_sel:WORD_0
    v_cmp_neq_f16_sdwa s[74:75], v105, 0 src0_sel:WORD_1 src1_sel:WORD_0
    v_cmp_neq_f16_sdwa s[76:77], v106, 0 src0_sel:WORD_0 src1_sel:WORD_0
    v_cmp_neq_f16_sdwa s[78:79], v106, 0 src0_sel:WORD_1 src1_sel:WORD_0
    v_cmp_neq_f16_sdwa s[80:81], v107, 0 src0_sel:WORD_0 src1_sel:WORD_0
    v_cmp_neq_f16_sdwa s[82:83], v107, 0 src0_sel:WORD_1 src1_sel:WORD_0
    s_mov_b64 exec, -1
    v_mov_b32 v132, s64
    v_mbcnt_lo_u32_b32 v132, s68, v132
    v_mbcnt_hi_u32_b32 v132, s69, v132
    v_mbcnt_lo_u32_b32 v132, s70, v132
    v_mbcnt_hi_u32_b32 v132, s71, v132
    v_mbcnt_lo_u32_b32 v132, s72, v132
    v_mbcnt_hi_u32_b32 v132, s73, v132
    v_mbcnt_lo_u32_b32 v132, s74, v132
    v_mbcnt_hi_u32_b32 v132, s75, v132
    v_mbcnt_lo_u32_b32 v132, s76, v132
    v_mbcnt_hi_u32_b32 v132, s77, v132
    v_mbcnt_lo_u32_b32 v132, s78, v132
    v_mbcnt_hi_u32_b32 v132, s79, v132
    v_mbcnt_lo_u32_b32 v132, s80, v132
    v_mbcnt_hi_u32_b32 v132, s81, v132
    v_mbcnt_lo_u32_b32 v132, s82, v132
    v_mbcnt_hi_u32_b32 v132, s83, v132
    s_add_u32 s55, s64, 16
    v_readlane_b32 s66, v132, 25
    v_readlane_b32 s67, v132, 63
    s_add_u32 s64, s66, 15
    s_and_b32 s64, s64, -16
    s_max_u32 s64, s64, s55
    s_sub_u32 s66, s64, s66
    v_mad_u32_u24 v132, v145, s66, v132
    s_mov_b32 s55, s64
    v_addc_co_u32 v133, vcc, 0, v132, s[68:69]
    v_addc_co_u32 v134, vcc, 0, v133, s[70:71]
    v_addc_co_u32 v135, vcc, 0, v134, s[72:73]
    v_addc_co_u32 v136, vcc, 0, v135, s[74:75]
    v_addc_co_u32 v137, vcc, 0, v136, s[76:77]
    v_addc_co_u32 v138, vcc, 0, v137, s[78:79]
    v_addc_co_u32 v139, vcc, 0, v138, s[80:81]
    s_add_u32 s67, s67, s66
    s_add_u32 s67, s67, 15
    s_and_b32 s67, s67, -16
    s_add_u32 s64, s64, 16
    s_max_u32 s64, s64, s67
    s_mov_b64 exec, s[68:69]
    ds_write_b8 v132, v141
    s_mov_b64 exec, s[70:71]
    ds_write_b8_d16_hi v133, v141
    s_mov_b64 exec, s[72:73]
    ds_write_b8 v134, v142
    s_mov_b64 exec, s[74:75]
    ds_write_b8_d16_hi v135, v142
    s_mov_b64 exec, s[76:77]
    ds_write_b8 v136, v143
    s_mov_b64 exec, s[78:79]
    ds_write_b8_d16_hi v137, v143
    s_mov_b64 exec, s[80:81]
    ds_write_b8 v138, v144
    s_mov_b64 exec, s[82:83]
    ds_write_b8_d16_hi v139, v144
    s_mov_b64 exec, -1
    s_lshr_b32 s95, s55, 4
    s_bitset1_b64 s[56:57], s95
    s_lshr_b32 s95, s64, 4
    s_bitset1_b64 s[56:57], s95
    s_mov_b64 exec, s[28:29]
    v_cmp_neq_f16_sdwa s[68:69], v108, 0 src0_sel:WORD_0 src1_sel:WORD_0
    v_cmp_neq_f16_sdwa s[70:71], v108, 0 src0_sel:WORD_1 src1_sel:WORD_0
    v_cmp_neq_f16_sdwa s[72:73], v109, 0 src0_sel:WORD_0 src1_sel:WORD_0
    v_cmp_neq_f16_sdwa s[74:75], v109, 0 src0_sel:WORD_1 src1_sel:WORD_0
    v_cmp_neq_f16_sdwa s[76:77], v110, 0 src0_sel:WORD_0 src1_sel:WORD_0
    v_cmp_neq_f16_sdwa s[78:79], v110, 0 src0_sel:WORD_1 src1_sel:WORD_0
    v_cmp_neq_f16_sdwa s[80:81], v111, 0 src0_sel:WORD_0 src1_sel:WORD_0
    v_cmp_neq_f16_sdwa s[82:83], v111, 0 src0_sel:WORD_1 src1_sel:WORD_0
    s_mov_b64 exec, -1
    v_mov_b32 v132, s64
    v_mbcnt_lo_u32_b32 v132, s68, v132
    v_mbcnt_hi_u32_b32 v132, s69, v132
    v_mbcnt_lo_u32_b32 v132, s70, v132
    v_mbcnt_hi_u32_b32 v132, s71, v132
    v_mbcnt_lo_u32_b32 v132, s72, v132
    v_mbcnt_hi_u32_b32 v132, s73, v132
    v_mbcnt_lo_u32_b32 v132, s74, v132
    v_mbcnt_hi_u32_b32 v132, s75, v132
    v_mbcnt_lo_u32_b32 v132, s76, v132
    v_mbcnt_hi_u32_b32 v132, s77, v132
    v_mbcnt_lo_u32_b32 v132, s78, v132
    v_mbcnt_hi_u32_b32 v132, s79, v132
    v_mbcnt_lo_u32_b32 v132, s80, v132
    v_mbcnt_hi_u32_b32 v132, s81, v132
    v_mbcnt_lo_u32_b32 v132, s82, v132
    v_mbcnt_hi_u32_b32 v132, s83, v132
    s_add_u32 s55, s64, 16
    v_readlane_b32 s66, v132, 25
    v_readlane_b32 s67, v132, 63
    s_add_u32 s64, s66, 15
    s_and_b32 s64, s64, -16
    s_max_u32 s64, s64, s55
    s_sub_u32 s66, s64, s66
    v_mad_u32_u24 v132, v145, s66, v132
    s_mov_b32 s55, s64
    v_addc_co_u32 v133, vcc, 0, v132, s[68:69]
    v_addc_co_u32 v134, vcc, 0, v133, s[70:71]
    v_addc_co_u32 v135, vcc, 0, v134, s[72:73]
    v_addc_co_u32 v136, vcc, 0, v135, s[74:75]
    v_addc_co_u32 v137, vcc, 0, v136, s[76:77]
    v_addc_co_u32 v138, vcc, 0, v137, s[78:79]
    v_addc_co_u32 v139, vcc, 0, v138, s[80:81]
    s_add_u32 s67, s67, s66
    s_add_u32 s67, s67, 15
    s_and_b32 s67, s67, -16
    s_add_u32 s64, s64, 16
    s_max_u32 s64, s64, s67
    s_mov_b64 exec, s[68:69]
    ds_write_b8 v132, v141
    s_mov_b64 exec, s[70:71]
    ds_write_b8_d16_hi v133, v141
    s_mov_b64 exec, s[72:73]
    ds_write_b8 v134, v142
    s_mov_b64 exec, s[74:75]
    ds_write_b8_d16_hi v135, v142
    s_mov_b64 exec, s[76:77]
    ds_write_b8 v136, v143
    s_mov_b64 exec, s[78:79]
    ds_write_b8_d16_hi v137, v143
    s_mov_b64 exec, s[80:81]
    ds_write_b8 v138, v144
    s_mov_b64 exec, s[82:83]
    ds_write_b8_d16_hi v139, v144
    s_mov_b64 exec, -1
    s_lshr_b32 s95, s55, 4
    s_lshl_b64 s[86:87], 1, s95
    s_bitcmp1_b32 s55, 10
    s_cselect_b64 s[88:89], 0, s[86:87]
    s_cselect_b64 s[90:91], s[86:87], 0
    s_or_b64 s[56:57], s[56:57], s[88:89]
    s_or_b64 s[58:59], s[58:59], s[90:91]
    s_lshr_b32 s95, s64, 4
    s_lshl_b64 s[86:87], 1, s95
    s_bitcmp1_b32 s64, 10
    s_cselect_b64 s[88:89], 0, s[86:87]
    s_cselect_b64 s[90:91], s[86:87], 0
    s_or_b64 s[56:57], s[56:57], s[88:89]
    s_or_b64 s[58:59], s[58:59], s[90:91]
    s_mov_b32 s44, s64
    s_mov_b64 exec, s[28:29]
    v_cmp_neq_f16_sdwa s[68:69], v112, 0 src0_sel:WORD_0 src1_sel:WORD_0
    v_cmp_neq_f16_sdwa s[70:71], v112, 0 src0_sel:WORD_1 src1_sel:WORD_0
    v_cmp_neq_f16_sdwa s[72:73], v113, 0 src0_sel:WORD_0 src1_sel:WORD_0
    v_cmp_neq_f16_sdwa s[74:75], v113, 0 src0_sel:WORD_1 src1_sel:WORD_0
    v_cmp_neq_f16_sdwa s[76:77], v114, 0 src0_sel:WORD_0 src1_sel:WORD_0
    v_cmp_neq_f16_sdwa s[78:79], v114, 0 src0_sel:WORD_1 src1_sel:WORD_0
    v_cmp_neq_f16_sdwa s[80:81], v115, 0 src0_sel:WORD_0 src1_sel:WORD_0
    v_cmp_neq_f16_sdwa s[82:83], v115, 0 src0_sel:WORD_1 src1_sel:WORD_0
    s_mov_b64 exec, -1
    v_mov_b32 v132, s64
    v_mbcnt_lo_u32_b32 v132, s68, v132
    v_mbcnt_hi_u32_b32 v132, s69, v132
    v_mbcnt_lo_u32_b32 v132, s70, v132
    v_mbcnt_hi_u32_b32 v132, s71, v132
    v_mbcnt_lo_u32_b32 v132, s72, v132
    v_mbcnt_hi_u32_b32 v132, s73, v132
    v_mbcnt_lo_u32_b32 v132, s74, v132
    v_mbcnt_hi_u32_b32 v132, s75, v132
    v_mbcnt_lo_u32_b32 v132, s76, v132
    v_mbcnt_hi_u32_b32 v132, s77, v132
    v_mbcnt_lo_u32_b32 v132, s78, v132
    v_mbcnt_hi_u32_b32 v132, s79, v132
    v_mbcnt_lo_u32_b32 v132, s80, v132
    v_mbcnt_hi_u32_b32 v132, s81, v132
    v_mbcnt_lo_u32_b32 v132, s82, v132
    v_mbcnt_hi_u32_b32 v132, s83, v132
    s_add_u32 s55, s64, 16
    v_readlane_b32 s66, v132, 25
    v_readlane_b32 s67, v132, 63
    s_add_u32 s64, s66, 15
    s_and_b32 s64, s64, -16
    s_max_u32 s64, s64, s55
    s_sub_u32 s66, s64, s66
    v_mad_u32_u24 v132, v145, s66, v132
    s_mov_b32 s55, s64
    v_addc_co_u32 v133, vcc, 0, v132, s[68:69]
    v_addc_co_u32 v134, vcc, 0, v133, s[70:71]
    v_addc_co_u32 v135, vcc, 0, v134, s[72:73]
    v_addc_co_u32 v136, vcc, 0, v135, s[74:75]
    v_addc_co_u32 v137, vcc, 0, v136, s[76:77]
    v_addc_co_u32 v138, vcc, 0, v137, s[78:79]
    v_addc_co_u32 v139, vcc, 0, v138, s[80:81]
    s_add_u32 s67, s67, s66
    s_add_u32 s67, s67, 15
    s_and_b32 s67, s67, -16
    s_add_u32 s64, s64, 16
    s_max_u32 s64, s64, s67
    s_mov_b64 exec, s[68:69]
    ds_write_b8 v132, v141
    s_mov_b64 exec, s[70:71]
    ds_write_b8_d16_hi v133, v141
    s_mov_b64 exec, s[72:73]
    ds_write_b8 v134, v142
    s_mov_b64 exec, s[74:75]
    ds_write_b8_d16_hi v135, v142
    s_mov_b64 exec, s[76:77]
    ds_write_b8 v136, v143
    s_mov_b64 exec, s[78:79]
    ds_write_b8_d16_hi v137, v143
    s_mov_b64 exec, s[80:81]
    ds_write_b8 v138, v144
    s_mov_b64 exec, s[82:83]
    ds_write_b8_d16_hi v139, v144
    s_mov_b64 exec, -1
    s_mov_b32 s45, s55
    s_mov_b32 s46, s64
    s_mov_b32 s94, 0
    s_mov_b64 s[84:85], -1
    s_branch L_listed
Ls_loop:
    ds_read_u8 v230, v237 offset:64
    ds_read_u8 v232, v237 offset:72
    v_mfma_f32_16x16x32_bf16 v[208:211], v[136:139], v[200:203], v[208:211]
Ls_mid:
    s_bitcmp1_b32 s36, 0
    s_cbranch_scc1 Ls_ev0
Ls_evd0:
    ds_read_b32 v246, v244 offset:0
    s_waitcnt lgkmcnt(0)
    v_bfe_u32 v247, v246, 0, 8
    v_lshlrev_b32 v247, 1, v247
    v_bfe_u32 v248, v246, 8, 8
    v_lshlrev_b32 v248, 1, v248
    v_bfe_u32 v249, v246, 16, 8
    v_lshlrev_b32 v249, 1, v249
    v_bfe_u32 v250, v246, 24, 8
    v_lshlrev_b32 v250, 1, v250
    buffer_load_ushort v247, v247, s[24:27], 0 offen
    buffer_load_ushort v248, v248, s[24:27], 0 offen
    buffer_load_ushort v249, v249, s[24:27], 0 offen
    buffer_load_ushort v250, v250, s[24:27], 0 offen
    s_waitcnt vmcnt(0)
    v_lshlrev_b32 v247, 16, v247
    v_mul_f32 v208, v208, v247
    v_lshlrev_b32 v248, 16, v248
    v_mul_f32 v209, v209, v248
    v_lshlrev_b32 v249, 16, v249
    v_mul_f32 v210, v210, v249
    v_lshlrev_b32 v250, 16, v250
    v_mul_f32 v211, v211, v250
    ds_add_rtn_u32 v1, v2, v3
    v_exp_f32 v132, v148
    v_exp_f32 v133, v149
    v_exp_f32 v134, v150
    v_exp_f32 v135, v151
    v_exp_f32 v136, v152
    v_exp_f32 v137, v153
    v_mfma_f32_4x4x4_16b_bf16 v[132:135], v[228:229], v[228:229], v[132:135]
    v_cvt_pk_bf16_f32 v208, v208, v209
    v_cvt_pk_bf16_f32 v209, v210, v211
    s_waitcnt lgkmcnt(2)
    v_mfma_f32_16x16x32_bf16 v[148:151], v[100:103], v[180:183], v[164:167]
    v_exp_f32 v138, v154
    v_mfma_f32_4x4x4_16b_bf16 v[212:215], v[208:209], v[188:189], v[212:215] cbsz:4 abid:0
    ds_read_b64_tr_b16 v[188:189], v236 offset:0
    v_exp_f32 v139, v155
    v_mfma_f32_16x16x32_bf16 v[152:155], v[108:111], v[180:183], v[168:171]
    v_exp_f32 v140, v156
    v_mfma_f32_4x4x4_16b_bf16 v[212:215], v[208:209], v[190:191], v[212:215] cbsz:4 abid:4
    ds_read_b64_tr_b16 v[190:191], v236 offset:512
    v_mfma_f32_4x4x4_16b_bf16 v[136:139], v[228:229], v[228:229], v[136:139]
    v_rcp_f32 v132, v132
    v_mfma_f32_4x4x4_16b_bf16 v[212:215], v[208:209], v[192:193], v[212:215] cbsz:4 abid:8
    ds_read_b64_tr_b16 v[192:193], v236 offset:1056
    v_exp_f32 v141, v157
    v_mfma_f32_16x16x32_bf16 v[148:151], v[104:107], v[184:187], v[148:151]
    v_rcp_f32 v133, v133
    v_mfma_f32_4x4x4_16b_bf16 v[212:215], v[208:209], v[194:195], v[212:215] cbsz:4 abid:12
    ds_read_b64_tr_b16 v[194:195], v236 offset:1568
    v_exp_f32 v142, v158
    v_mfma_f32_16x16x32_bf16 v[152:155], v[112:115], v[184:187], v[152:155]
    v_rcp_f32 v134, v134
    v_exp_f32 v143, v159
    v_rcp_f32 v135, v135
    v_cvt_pk_bf16_f32 v132, v132, v133
    v_mfma_f32_4x4x4_16b_bf16 v[140:143], v[228:229], v[228:229], v[140:143]
    v_exp_f32 v144, v160
    v_mfma_f32_16x16x32_bf16 v[156:159], v[116:119], v[180:183], v[172:175]
    v_rcp_f32 v136, v136
    v_cvt_pk_bf16_f32 v133, v134, v135
    s_add_u32 m0, s52, 0
    s_waitcnt lgkmcnt(0)
    buffer_load_dwordx4 v[230:231], s[20:23], s35 idxen offen nt lds
    v_exp_f32 v145, v161
    buffer_load_dwordx4 v[232:233], s[40:43], s35 idxen offen offset:1056 nt lds
    v_rcp_f32 v137, v137
    v_exp_f32 v146, v162
    v_rcp_f32 v138, v138
    v_cvt_pk_bf16_f32 v134, v136, v137
    v_exp_f32 v147, v163
    v_mfma_f32_16x16x32_bf16 v[160:163], v[124:127], v[180:183], v[176:179]
    v_readfirstlane_b32 s66, v1
    s_setprio 0
    s_cmp_gt_i32 s66, 0
    s_cbranch_scc0 Ls_lo0
    s_setprio 1
Ls_lo0:
    v_rcp_f32 v139, v139
    v_mfma_f32_4x4x4_16b_bf16 v[144:147], v[228:229], v[228:229], v[144:147]
    v_mfma_f32_16x16x32_bf16 v[156:159], v[120:123], v[184:187], v[156:159]
    v_rcp_f32 v140, v140
    v_mfma_f32_16x16x32_bf16 v[160:163], v[128:131], v[184:187], v[160:163]
    v_rcp_f32 v141, v141
    v_cvt_pk_bf16_f32 v135, v138, v139
    s_waitcnt vmcnt(4)
    ds_read_b128 v[180:183], v234 offset:4160
    ds_read_b128 v[184:187], v235 offset:4160
    v_rcp_f32 v142, v142
    v_cvt_pk_bf16_f32 v136, v140, v141
    v_mfma_f32_16x16x32_bf16 v[208:211], v[132:135], v[196:199], v[204:207]
    v_rcp_f32 v143, v143
    v_rcp_f32 v144, v144
    v_cvt_pk_bf16_f32 v137, v142, v143
    v_rcp_f32 v145, v145
    v_rcp_f32 v146, v146
    v_rcp_f32 v147, v147
    v_cvt_pk_bf16_f32 v138, v144, v145
    v_cvt_pk_bf16_f32 v139, v146, v147
    ds_read_u8 v230, v237 offset:80
    ds_read_u8 v232, v237 offset:88
    v_mfma_f32_16x16x32_bf16 v[208:211], v[136:139], v[200:203], v[208:211]
    s_bitcmp1_b32 s36, 1
    s_cbranch_scc1 Ls_ev1
Ls_evd1:
    ds_read_b32 v246, v244 offset:16
    s_waitcnt lgkmcnt(0)
    v_bfe_u32 v247, v246, 0, 8
    v_lshlrev_b32 v247, 1, v247
    v_bfe_u32 v248, v246, 8, 8
    v_lshlrev_b32 v248, 1, v248
    v_bfe_u32 v249, v246, 16, 8
    v_lshlrev_b32 v249, 1, v249
    v_bfe_u32 v250, v246, 24, 8
    v_lshlrev_b32 v250, 1, v250
    buffer_load_ushort v247, v247, s[24:27], 0 offen
    buffer_load_ushort v248, v248, s[24:27], 0 offen
    buffer_load_ushort v249, v249, s[24:27], 0 offen
    buffer_load_ushort v250, v250, s[24:27], 0 offen
    s_waitcnt vmcnt(0)
    v_lshlrev_b32 v247, 16, v247
    v_mul_f32 v208, v208, v247
    v_lshlrev_b32 v248, 16, v248
    v_mul_f32 v209, v209, v248
    v_lshlrev_b32 v249, 16, v249
    v_mul_f32 v210, v210, v249
    v_lshlrev_b32 v250, 16, v250
    v_mul_f32 v211, v211, v250
    v_exp_f32 v132, v148
    v_exp_f32 v133, v149
    v_exp_f32 v134, v150
    v_exp_f32 v135, v151
    v_exp_f32 v136, v152
    v_exp_f32 v137, v153
    v_mfma_f32_4x4x4_16b_bf16 v[132:135], v[228:229], v[228:229], v[132:135]
    v_cvt_pk_bf16_f32 v208, v208, v209
    v_cvt_pk_bf16_f32 v209, v210, v211
    s_waitcnt lgkmcnt(2)
    v_mfma_f32_16x16x32_bf16 v[148:151], v[100:103], v[180:183], v[164:167]
    v_exp_f32 v138, v154
    v_mfma_f32_4x4x4_16b_bf16 v[212:215], v[208:209], v[188:189], v[212:215] cbsz:4 abid:0
    ds_read_b64_tr_b16 v[188:189], v236 offset:2080
    v_exp_f32 v139, v155
    v_mfma_f32_16x16x32_bf16 v[152:155], v[108:111], v[180:183], v[168:171]
    v_exp_f32 v140, v156
    v_mfma_f32_4x4x4_16b_bf16 v[212:215], v[208:209], v[190:191], v[212:215] cbsz:4 abid:4
    ds_read_b64_tr_b16 v[190:191], v236 offset:2592
    v_mfma_f32_4x4x4_16b_bf16 v[136:139], v[228:229], v[228:229], v[136:139]
    v_rcp_f32 v132, v132
    v_mfma_f32_4x4x4_16b_bf16 v[212:215], v[208:209], v[192:193], v[212:215] cbsz:4 abid:8
    ds_read_b64_tr_b16 v[192:193], v236 offset:3136
    v_exp_f32 v141, v157
    v_mfma_f32_16x16x32_bf16 v[148:151], v[104:107], v[184:187], v[148:151]
    v_rcp_f32 v133, v133
    v_mfma_f32_4x4x4_16b_bf16 v[212:215], v[208:209], v[194:195], v[212:215] cbsz:4 abid:12
    ds_read_b64_tr_b16 v[194:195], v236 offset:3648
    v_exp_f32 v142, v158
    v_mfma_f32_16x16x32_bf16 v[152:155], v[112:115], v[184:187], v[152:155]
    v_rcp_f32 v134, v134
    v_exp_f32 v143, v159
    v_rcp_f32 v135, v135
    v_cvt_pk_bf16_f32 v132, v132, v133
    v_mfma_f32_4x4x4_16b_bf16 v[140:143], v[228:229], v[228:229], v[140:143]
    v_exp_f32 v144, v160
    v_mfma_f32_16x16x32_bf16 v[156:159], v[116:119], v[180:183], v[172:175]
    v_rcp_f32 v136, v136
    v_cvt_pk_bf16_f32 v133, v134, v135
    s_add_u32 m0, s52, 2080
    s_waitcnt lgkmcnt(0)
    buffer_load_dwordx4 v[230:231], s[20:23], s35 idxen offen nt lds
    v_exp_f32 v145, v161
    buffer_load_dwordx4 v[232:233], s[40:43], s35 idxen offen offset:1056 nt lds
    v_rcp_f32 v137, v137
    v_exp_f32 v146, v162
    v_rcp_f32 v138, v138
    v_cvt_pk_bf16_f32 v134, v136, v137
    v_exp_f32 v147, v163
    v_mfma_f32_16x16x32_bf16 v[160:163], v[124:127], v[180:183], v[176:179]
    v_rcp_f32 v139, v139
    v_mfma_f32_4x4x4_16b_bf16 v[144:147], v[228:229], v[228:229], v[144:147]
    v_mfma_f32_16x16x32_bf16 v[156:159], v[120:123], v[184:187], v[156:159]
    v_rcp_f32 v140, v140
    v_mfma_f32_16x16x32_bf16 v[160:163], v[128:131], v[184:187], v[160:163]
    v_rcp_f32 v141, v141
    v_cvt_pk_bf16_f32 v135, v138, v139
    s_waitcnt vmcnt(4)
    ds_read_b128 v[180:183], v234 offset:6240
    ds_read_b128 v[184:187], v235 offset:6240
    v_rcp_f32 v142, v142
    v_cvt_pk_bf16_f32 v136, v140, v141
    v_mfma_f32_16x16x32_bf16 v[208:211], v[132:135], v[196:199], v[204:207]
    v_rcp_f32 v143, v143
    v_rcp_f32 v144, v144
    v_cvt_pk_bf16_f32 v137, v142, v143
    v_rcp_f32 v145, v145
    v_rcp_f32 v146, v146
    v_rcp_f32 v147, v147
    v_cvt_pk_bf16_f32 v138, v144, v145
    v_cvt_pk_bf16_f32 v139, v146, v147
    ds_read_u8 v230, v237 offset:96
    ds_read_u8 v232, v237 offset:104
    v_mfma_f32_16x16x32_bf16 v[208:211], v[136:139], v[200:203], v[208:211]
    s_bitcmp1_b32 s36, 2
    s_cbranch_scc1 Ls_ev2
Ls_evd2:
    ds_read_b32 v246, v244 offset:32
    s_waitcnt lgkmcnt(0)
    v_bfe_u32 v247, v246, 0, 8
    v_lshlrev_b32 v247, 1, v247
    v_bfe_u32 v248, v246, 8, 8
    v_lshlrev_b32 v248, 1, v248
    v_bfe_u32 v249, v246, 16, 8
    v_lshlrev_b32 v249, 1, v249
    v_bfe_u32 v250, v246, 24, 8
    v_lshlrev_b32 v250, 1, v250
    buffer_load_ushort v247, v247, s[24:27], 0 offen
    buffer_load_ushort v248, v248, s[24:27], 0 offen
    buffer_load_ushort v249, v249, s[24:27], 0 offen
    buffer_load_ushort v250, v250, s[24:27], 0 offen
    s_waitcnt vmcnt(0)
    v_lshlrev_b32 v247, 16, v247
    v_mul_f32 v208, v208, v247
    v_lshlrev_b32 v248, 16, v248
    v_mul_f32 v209, v209, v248
    v_lshlrev_b32 v249, 16, v249
    v_mul_f32 v210, v210, v249
    v_lshlrev_b32 v250, 16, v250
    v_mul_f32 v211, v211, v250
    v_exp_f32 v132, v148
    v_exp_f32 v133, v149
    v_exp_f32 v134, v150
    v_exp_f32 v135, v151
    v_exp_f32 v136, v152
    v_exp_f32 v137, v153
    v_mfma_f32_4x4x4_16b_bf16 v[132:135], v[228:229], v[228:229], v[132:135]
    v_cvt_pk_bf16_f32 v208, v208, v209
    v_cvt_pk_bf16_f32 v209, v210, v211
    s_waitcnt lgkmcnt(2)
    v_mfma_f32_16x16x32_bf16 v[148:151], v[100:103], v[180:183], v[164:167]
    v_exp_f32 v138, v154
    v_mfma_f32_4x4x4_16b_bf16 v[212:215], v[208:209], v[188:189], v[212:215] cbsz:4 abid:0
    ds_read_b64_tr_b16 v[188:189], v236 offset:4160
    v_exp_f32 v139, v155
    v_mfma_f32_16x16x32_bf16 v[152:155], v[108:111], v[180:183], v[168:171]
    v_exp_f32 v140, v156
    v_mfma_f32_4x4x4_16b_bf16 v[212:215], v[208:209], v[190:191], v[212:215] cbsz:4 abid:4
    ds_read_b64_tr_b16 v[190:191], v236 offset:4672
    v_mfma_f32_4x4x4_16b_bf16 v[136:139], v[228:229], v[228:229], v[136:139]
    v_rcp_f32 v132, v132
    v_mfma_f32_4x4x4_16b_bf16 v[212:215], v[208:209], v[192:193], v[212:215] cbsz:4 abid:8
    ds_read_b64_tr_b16 v[192:193], v236 offset:5216
    v_exp_f32 v141, v157
    v_mfma_f32_16x16x32_bf16 v[148:151], v[104:107], v[184:187], v[148:151]
    v_rcp_f32 v133, v133
    v_mfma_f32_4x4x4_16b_bf16 v[212:215], v[208:209], v[194:195], v[212:215] cbsz:4 abid:12
    ds_read_b64_tr_b16 v[194:195], v236 offset:5728
    v_exp_f32 v142, v158
    v_mfma_f32_16x16x32_bf16 v[152:155], v[112:115], v[184:187], v[152:155]
    v_rcp_f32 v134, v134
    v_exp_f32 v143, v159
    v_rcp_f32 v135, v135
    v_cvt_pk_bf16_f32 v132, v132, v133
    v_mfma_f32_4x4x4_16b_bf16 v[140:143], v[228:229], v[228:229], v[140:143]
    v_exp_f32 v144, v160
    v_mfma_f32_16x16x32_bf16 v[156:159], v[116:119], v[180:183], v[172:175]
    v_rcp_f32 v136, v136
    v_cvt_pk_bf16_f32 v133, v134, v135
    s_add_u32 m0, s52, 4160
    s_waitcnt lgkmcnt(0)
    buffer_load_dwordx4 v[230:231], s[20:23], s35 idxen offen nt lds
    v_exp_f32 v145, v161
    buffer_load_dwordx4 v[232:233], s[40:43], s35 idxen offen offset:1056 nt lds
    v_rcp_f32 v137, v137
    v_exp_f32 v146, v162
    v_rcp_f32 v138, v138
    v_cvt_pk_bf16_f32 v134, v136, v137
    v_exp_f32 v147, v163
    v_mfma_f32_16x16x32_bf16 v[160:163], v[124:127], v[180:183], v[176:179]
    v_rcp_f32 v139, v139
    v_mfma_f32_4x4x4_16b_bf16 v[144:147], v[228:229], v[228:229], v[144:147]
    v_mfma_f32_16x16x32_bf16 v[156:159], v[120:123], v[184:187], v[156:159]
    v_rcp_f32 v140, v140
    v_mfma_f32_16x16x32_bf16 v[160:163], v[128:131], v[184:187], v[160:163]
    v_rcp_f32 v141, v141
    v_cvt_pk_bf16_f32 v135, v138, v139
    s_waitcnt vmcnt(4)
    ds_read_b128 v[180:183], v234 offset:0
    ds_read_b128 v[184:187], v235 offset:0
    v_rcp_f32 v142, v142
    v_cvt_pk_bf16_f32 v136, v140, v141
    v_mfma_f32_16x16x32_bf16 v[208:211], v[132:135], v[196:199], v[204:207]
    v_rcp_f32 v143, v143
    v_rcp_f32 v144, v144
    v_cvt_pk_bf16_f32 v137, v142, v143
    v_rcp_f32 v145, v145
    v_rcp_f32 v146, v146
    v_rcp_f32 v147, v147
    v_cvt_pk_bf16_f32 v138, v144, v145
    v_cvt_pk_bf16_f32 v139, v146, v147
    ds_read_u8 v230, v237 offset:112
    ds_read_u8 v232, v237 offset:120
    v_mfma_f32_16x16x32_bf16 v[208:211], v[136:139], v[200:203], v[208:211]
    s_bitcmp1_b32 s36, 3
    s_cbranch_scc1 Ls_ev3
Ls_evd3:
    ds_read_b32 v246, v244 offset:48
    s_waitcnt lgkmcnt(0)
    v_bfe_u32 v247, v246, 0, 8
    v_lshlrev_b32 v247, 1, v247
    v_bfe_u32 v248, v246, 8, 8
    v_lshlrev_b32 v248, 1, v248
    v_bfe_u32 v249, v246, 16, 8
    v_lshlrev_b32 v249, 1, v249
    v_bfe_u32 v250, v246, 24, 8
    v_lshlrev_b32 v250, 1, v250
    buffer_load_ushort v247, v247, s[24:27], 0 offen
    buffer_load_ushort v248, v248, s[24:27], 0 offen
    buffer_load_ushort v249, v249, s[24:27], 0 offen
    buffer_load_ushort v250, v250, s[24:27], 0 offen
    s_waitcnt vmcnt(0)
    v_lshlrev_b32 v247, 16, v247
    v_mul_f32 v208, v208, v247
    v_lshlrev_b32 v248, 16, v248
    v_mul_f32 v209, v209, v248
    v_lshlrev_b32 v249, 16, v249
    v_mul_f32 v210, v210, v249
    v_lshlrev_b32 v250, 16, v250
    v_mul_f32 v211, v211, v250
    v_exp_f32 v132, v148
    v_exp_f32 v133, v149
    v_exp_f32 v134, v150
    v_exp_f32 v135, v151
    v_exp_f32 v136, v152
    v_exp_f32 v137, v153
    v_mfma_f32_4x4x4_16b_bf16 v[132:135], v[228:229], v[228:229], v[132:135]
    v_cvt_pk_bf16_f32 v208, v208, v209
    v_cvt_pk_bf16_f32 v209, v210, v211
    s_waitcnt lgkmcnt(2)
    v_mfma_f32_16x16x32_bf16 v[148:151], v[100:103], v[180:183], v[164:167]
    v_exp_f32 v138, v154
    v_mfma_f32_4x4x4_16b_bf16 v[212:215], v[208:209], v[188:189], v[212:215] cbsz:4 abid:0
    ds_read_b64_tr_b16 v[188:189], v236 offset:6240
    v_exp_f32 v139, v155
    v_mfma_f32_16x16x32_bf16 v[152:155], v[108:111], v[180:183], v[168:171]
    v_exp_f32 v140, v156
    v_mfma_f32_4x4x4_16b_bf16 v[212:215], v[208:209], v[190:191], v[212:215] cbsz:4 abid:4
    ds_read_b64_tr_b16 v[190:191], v236 offset:6752
    v_mfma_f32_4x4x4_16b_bf16 v[136:139], v[228:229], v[228:229], v[136:139]
    v_rcp_f32 v132, v132
    v_mfma_f32_4x4x4_16b_bf16 v[212:215], v[208:209], v[192:193], v[212:215] cbsz:4 abid:8
    ds_read_b64_tr_b16 v[192:193], v236 offset:7296
    v_exp_f32 v141, v157
    v_mfma_f32_16x16x32_bf16 v[148:151], v[104:107], v[184:187], v[148:151]
    v_rcp_f32 v133, v133
    v_mfma_f32_4x4x4_16b_bf16 v[212:215], v[208:209], v[194:195], v[212:215] cbsz:4 abid:12
    ds_read_b64_tr_b16 v[194:195], v236 offset:7808
    v_exp_f32 v142, v158
    v_mfma_f32_16x16x32_bf16 v[152:155], v[112:115], v[184:187], v[152:155]
    v_rcp_f32 v134, v134
    v_exp_f32 v143, v159
    v_rcp_f32 v135, v135
    v_cvt_pk_bf16_f32 v132, v132, v133
    v_mfma_f32_4x4x4_16b_bf16 v[140:143], v[228:229], v[228:229], v[140:143]
    v_exp_f32 v144, v160
    v_mfma_f32_16x16x32_bf16 v[156:159], v[116:119], v[180:183], v[172:175]
    v_rcp_f32 v136, v136
    v_cvt_pk_bf16_f32 v133, v134, v135
    s_add_u32 m0, s52, 6240
    s_waitcnt lgkmcnt(0)
    buffer_load_dwordx4 v[230:231], s[20:23], s35 idxen offen nt lds
    v_exp_f32 v145, v161
    buffer_load_dwordx4 v[232:233], s[40:43], s35 idxen offen offset:1056 nt lds
    v_rcp_f32 v137, v137
    v_exp_f32 v146, v162
    v_rcp_f32 v138, v138
    v_cvt_pk_bf16_f32 v134, v136, v137
    v_exp_f32 v147, v163
    v_mfma_f32_16x16x32_bf16 v[160:163], v[124:127], v[180:183], v[176:179]
    v_rcp_f32 v139, v139
    v_mfma_f32_4x4x4_16b_bf16 v[144:147], v[228:229], v[228:229], v[144:147]
    v_mfma_f32_16x16x32_bf16 v[156:159], v[120:123], v[184:187], v[156:159]
    v_rcp_f32 v140, v140
    v_mfma_f32_16x16x32_bf16 v[160:163], v[128:131], v[184:187], v[160:163]
    v_rcp_f32 v141, v141
    v_cvt_pk_bf16_f32 v135, v138, v139
    s_waitcnt vmcnt(4)
    ds_read_b128 v[180:183], v234 offset:2080
    ds_read_b128 v[184:187], v235 offset:2080
    v_rcp_f32 v142, v142
    v_cvt_pk_bf16_f32 v136, v140, v141
    v_mfma_f32_16x16x32_bf16 v[208:211], v[132:135], v[196:199], v[204:207]
    v_rcp_f32 v143, v143
    s_lshr_b64 s[56:57], s[56:57], 4
    s_lshl_b64 s[86:87], s[58:59], 60
    s_or_b64 s[56:57], s[56:57], s[86:87]
    s_lshr_b64 s[58:59], s[58:59], 4
    s_lshr_b64 s[86:87], s[56:57], 2
    s_lshr_b64 s[36:37], s[56:57], 5
    s_or_b32 s36, s36, s86
    s_or_b32 s36, s36, s56
    v_add_u32 v237, 64, v237
    v_add_u32 v244, 64, v244
    v_rcp_f32 v144, v144
    v_cvt_pk_bf16_f32 v137, v142, v143
    v_rcp_f32 v145, v145
    v_rcp_f32 v146, v146
    v_rcp_f32 v147, v147
    v_cvt_pk_bf16_f32 v138, v144, v145
    v_cvt_pk_bf16_f32 v139, v146, v147
    s_branch Ls_loop
Ls_ev0:
    s_bitcmp0_b64 s[56:57], 0
    s_cbranch_scc1 Ls_nf0
    v_cvt_pk_bf16_f32 v246, v212, v212
    v_mov_b32 v212, 0
    ds_write_b16 v240, v246
    v_add_u32 v240, 128, v240
    s_add_u32 s24, s24, s32
    s_addc_u32 s25, s25, 0
    s_xor_b32 s32, s32, 0x18ffe0
Ls_nf0:
    s_bitcmp0_b64 s[56:57], 5
    s_cbranch_scc1 Ls_na0
    s_sub_u32 s60, s60, 1
    s_cbranch_scc0 Ls_ns0
    s_mov_b32 s49, 5
    s_call_b64 s[62:63], L_swap
    ds_read_u8 v230, v237 offset:64
    ds_read_u8 v232, v237 offset:72
    s_add_u32 s35, s35, s31
    s_min_u32 s35, s35, 419404800
    s_xor_b32 s31, s31, 0x63ff800
    s_bitcmp0_b64 s[56:57], 2
    s_cbranch_scc1 Ls_evd0
    s_waitcnt lgkmcnt(0)
    s_branch Ls_e10
Ls_ns0:
    s_add_u32 s35, s35, s31
    s_min_u32 s35, s35, 419404800
    s_xor_b32 s31, s31, 0x63ff800
Ls_na0:
    s_bitcmp0_b64 s[56:57], 2
    s_cbranch_scc1 Ls_evd0
Ls_e10:
    s_sub_u32 s61, s61, 1
    s_cbranch_scc1 Ls_last0
    s_cmp_lg_u32 s61, s45
    s_cbranch_scc1 Ls_nw0
    v_add_u32 v238, s47, v238
    v_add_u32 v239, s47, v239
    ds_read_u16 v224, v238 offset:0
    ds_read_u16 v225, v238 offset:8
    ds_read_u16 v226, v238 offset:64
    ds_read_u16 v227, v238 offset:72
    s_waitcnt lgkmcnt(0)
Ls_nw0:
    v_mul_u32_u24 v216, v224, v241
    v_mul_u32_u24 v217, v224, v242
    v_mul_u32_u24 v218, v225, v241
    v_mul_u32_u24 v219, v225, v242
    v_mul_u32_u24 v220, v226, v241
    v_mul_u32_u24 v221, v226, v242
    v_mul_u32_u24 v222, v227, v241
    v_mul_u32_u24 v223, v227, v242
    v_add_u32 v238, 128, v238
    ds_read_b128 v[164:167], v239
    v_mfma_f32_4x4x4_16b_bf16 v[132:135], v[216:217], v[68:69], v[4:7]
    ds_read_b128 v[168:171], v239 offset:64
    ds_read_b128 v[172:175], v239 offset:128
    v_mfma_f32_4x4x4_16b_bf16 v[136:139], v[218:219], v[70:71], v[8:11]
    ds_read_b128 v[176:179], v239 offset:192
    ds_read_u16 v224, v238
    v_mfma_f32_4x4x4_16b_bf16 v[140:143], v[220:221], v[72:73], v[12:15]
    ds_read_u16 v225, v238 offset:8
    ds_read_u16 v226, v238 offset:64
    v_mfma_f32_4x4x4_16b_bf16 v[144:147], v[222:223], v[74:75], v[16:19]
    ds_read_u16 v227, v238 offset:72
    v_add_u32 v239, 272, v239
    v_mfma_f32_4x4x4_16b_bf16 v[246:249], v[216:217], v[76:77], v[20:23]
    v_cvt_pk_bf16_f32 v100, v132, v133
    v_cvt_pk_bf16_f32 v101, v134, v135
    v_mfma_f32_4x4x4_16b_bf16 v[250:253], v[218:219], v[78:79], v[24:27]
    v_cvt_pk_bf16_f32 v102, v136, v137
    v_cvt_pk_bf16_f32 v103, v138, v139
    v_mfma_f32_4x4x4_16b_bf16 v[132:135], v[220:221], v[80:81], v[28:31]
    v_cvt_pk_bf16_f32 v104, v140, v141
    v_cvt_pk_bf16_f32 v105, v142, v143
    v_mfma_f32_4x4x4_16b_bf16 v[136:139], v[222:223], v[82:83], v[32:35]
    v_cvt_pk_bf16_f32 v106, v144, v145
    v_cvt_pk_bf16_f32 v107, v146, v147
    v_mfma_f32_4x4x4_16b_bf16 v[140:143], v[216:217], v[84:85], v[36:39]
    v_cvt_pk_bf16_f32 v108, v246, v247
    v_cvt_pk_bf16_f32 v109, v248, v249
    v_mfma_f32_4x4x4_16b_bf16 v[144:147], v[218:219], v[86:87], v[40:43]
    v_cvt_pk_bf16_f32 v110, v250, v251
    v_cvt_pk_bf16_f32 v111, v252, v253
    v_mfma_f32_4x4x4_16b_bf16 v[246:249], v[220:221], v[88:89], v[44:47]
    v_cvt_pk_bf16_f32 v112, v132, v133
    v_cvt_pk_bf16_f32 v113, v134, v135
    v_mfma_f32_4x4x4_16b_bf16 v[250:253], v[222:223], v[90:91], v[48:51]
    v_cvt_pk_bf16_f32 v114, v136, v137
    v_cvt_pk_bf16_f32 v115, v138, v139
    v_mfma_f32_4x4x4_16b_bf16 v[132:135], v[216:217], v[92:93], v[52:55]
    v_cvt_pk_bf16_f32 v116, v140, v141
    v_cvt_pk_bf16_f32 v117, v142, v143
    v_mfma_f32_4x4x4_16b_bf16 v[136:139], v[218:219], v[94:95], v[56:59]
    v_cvt_pk_bf16_f32 v118, v144, v145
    v_cvt_pk_bf16_f32 v119, v146, v147
    v_mfma_f32_4x4x4_16b_bf16 v[140:143], v[220:221], v[96:97], v[60:63]
    v_cvt_pk_bf16_f32 v120, v246, v247
    v_cvt_pk_bf16_f32 v121, v248, v249
    v_mfma_f32_4x4x4_16b_bf16 v[144:147], v[222:223], v[98:99], v[64:67]
    v_cvt_pk_bf16_f32 v122, v250, v251
    v_cvt_pk_bf16_f32 v123, v252, v253
    v_cvt_pk_bf16_f32 v124, v132, v133
    v_cvt_pk_bf16_f32 v125, v134, v135
    v_cvt_pk_bf16_f32 v126, v136, v137
    v_cvt_pk_bf16_f32 v127, v138, v139
    v_cvt_pk_bf16_f32 v128, v140, v141
    v_cvt_pk_bf16_f32 v129, v142, v143
    v_cvt_pk_bf16_f32 v130, v144, v145
    v_cvt_pk_bf16_f32 v131, v146, v147
    s_waitcnt lgkmcnt(0)
    s_branch Ls_evd0
Ls_ev1:
    s_bitcmp0_b64 s[56:57], 1
    s_cbranch_scc1 Ls_nf1
    v_cvt_pk_bf16_f32 v246, v212, v212
    v_mov_b32 v212, 0
    ds_write_b16 v240, v246
    v_add_u32 v240, 128, v240
    s_add_u32 s24, s24, s32
    s_addc_u32 s25, s25, 0
    s_xor_b32 s32, s32, 0x18ffe0
Ls_nf1:
    s_bitcmp0_b64 s[56:57], 6
    s_cbranch_scc1 Ls_na1
    s_sub_u32 s60, s60, 1
    s_cbranch_scc0 Ls_ns1
    s_mov_b32 s49, 6
    s_call_b64 s[62:63], L_swap
    ds_read_u8 v230, v237 offset:80
    ds_read_u8 v232, v237 offset:88
    s_add_u32 s35, s35, s31
    s_min_u32 s35, s35, 419404800
    s_xor_b32 s31, s31, 0x63ff800
    s_bitcmp0_b64 s[56:57], 3
    s_cbranch_scc1 Ls_evd1
    s_waitcnt lgkmcnt(0)
    s_branch Ls_e11
Ls_ns1:
    s_add_u32 s35, s35, s31
    s_min_u32 s35, s35, 419404800
    s_xor_b32 s31, s31, 0x63ff800
Ls_na1:
    s_bitcmp0_b64 s[56:57], 3
    s_cbranch_scc1 Ls_evd1
Ls_e11:
    s_sub_u32 s61, s61, 1
    s_cbranch_scc1 Ls_last1
    s_cmp_lg_u32 s61, s45
    s_cbranch_scc1 Ls_nw1
    v_add_u32 v238, s47, v238
    v_add_u32 v239, s47, v239
    ds_read_u16 v224, v238 offset:0
    ds_read_u16 v225, v238 offset:8
    ds_read_u16 v226, v238 offset:64
    ds_read_u16 v227, v238 offset:72
    s_waitcnt lgkmcnt(0)
Ls_nw1:
    v_mul_u32_u24 v216, v224, v241
    v_mul_u32_u24 v217, v224, v242
    v_mul_u32_u24 v218, v225, v241
    v_mul_u32_u24 v219, v225, v242
    v_mul_u32_u24 v220, v226, v241
    v_mul_u32_u24 v221, v226, v242
    v_mul_u32_u24 v222, v227, v241
    v_mul_u32_u24 v223, v227, v242
    v_add_u32 v238, 128, v238
    ds_read_b128 v[164:167], v239
    v_mfma_f32_4x4x4_16b_bf16 v[132:135], v[216:217], v[68:69], v[4:7]
    ds_read_b128 v[168:171], v239 offset:64
    ds_read_b128 v[172:175], v239 offset:128
    v_mfma_f32_4x4x4_16b_bf16 v[136:139], v[218:219], v[70:71], v[8:11]
    ds_read_b128 v[176:179], v239 offset:192
    ds_read_u16 v224, v238
    v_mfma_f32_4x4x4_16b_bf16 v[140:143], v[220:221], v[72:73], v[12:15]
    ds_read_u16 v225, v238 offset:8
    ds_read_u16 v226, v238 offset:64
    v_mfma_f32_4x4x4_16b_bf16 v[144:147], v[222:223], v[74:75], v[16:19]
    ds_read_u16 v227, v238 offset:72
    v_add_u32 v239, 272, v239
    v_mfma_f32_4x4x4_16b_bf16 v[246:249], v[216:217], v[76:77], v[20:23]
    v_cvt_pk_bf16_f32 v100, v132, v133
    v_cvt_pk_bf16_f32 v101, v134, v135
    v_mfma_f32_4x4x4_16b_bf16 v[250:253], v[218:219], v[78:79], v[24:27]
    v_cvt_pk_bf16_f32 v102, v136, v137
    v_cvt_pk_bf16_f32 v103, v138, v139
    v_mfma_f32_4x4x4_16b_bf16 v[132:135], v[220:221], v[80:81], v[28:31]
    v_cvt_pk_bf16_f32 v104, v140, v141
    v_cvt_pk_bf16_f32 v105, v142, v143
    v_mfma_f32_4x4x4_16b_bf16 v[136:139], v[222:223], v[82:83], v[32:35]
    v_cvt_pk_bf16_f32 v106, v144, v145
    v_cvt_pk_bf16_f32 v107, v146, v147
    v_mfma_f32_4x4x4_16b_bf16 v[140:143], v[216:217], v[84:85], v[36:39]
    v_cvt_pk_bf16_f32 v108, v246, v247
    v_cvt_pk_bf16_f32 v109, v248, v249
    v_mfma_f32_4x4x4_16b_bf16 v[144:147], v[218:219], v[86:87], v[40:43]
    v_cvt_pk_bf16_f32 v110, v250, v251
    v_cvt_pk_bf16_f32 v111, v252, v253
    v_mfma_f32_4x4x4_16b_bf16 v[246:249], v[220:221], v[88:89], v[44:47]
    v_cvt_pk_bf16_f32 v112, v132, v133
    v_cvt_pk_bf16_f32 v113, v134, v135
    v_mfma_f32_4x4x4_16b_bf16 v[250:253], v[222:223], v[90:91], v[48:51]
    v_cvt_pk_bf16_f32 v114, v136, v137
    v_cvt_pk_bf16_f32 v115, v138, v139
    v_mfma_f32_4x4x4_16b_bf16 v[132:135], v[216:217], v[92:93], v[52:55]
    v_cvt_pk_bf16_f32 v116, v140, v141
    v_cvt_pk_bf16_f32 v117, v142, v143
    v_mfma_f32_4x4x4_16b_bf16 v[136:139], v[218:219], v[94:95], v[56:59]
    v_cvt_pk_bf16_f32 v118, v144, v145
    v_cvt_pk_bf16_f32 v119, v146, v147
    v_mfma_f32_4x4x4_16b_bf16 v[140:143], v[220:221], v[96:97], v[60:63]
    v_cvt_pk_bf16_f32 v120, v246, v247
    v_cvt_pk_bf16_f32 v121, v248, v249
    v_mfma_f32_4x4x4_16b_bf16 v[144:147], v[222:223], v[98:99], v[64:67]
    v_cvt_pk_bf16_f32 v122, v250, v251
    v_cvt_pk_bf16_f32 v123, v252, v253
    v_cvt_pk_bf16_f32 v124, v132, v133
    v_cvt_pk_bf16_f32 v125, v134, v135
    v_cvt_pk_bf16_f32 v126, v136, v137
    v_cvt_pk_bf16_f32 v127, v138, v139
    v_cvt_pk_bf16_f32 v128, v140, v141
    v_cvt_pk_bf16_f32 v129, v142, v143
    v_cvt_pk_bf16_f32 v130, v144, v145
    v_cvt_pk_bf16_f32 v131, v146, v147
    s_waitcnt lgkmcnt(0)
    s_branch Ls_evd1
Ls_ev2:
    s_bitcmp0_b64 s[56:57], 2
    s_cbranch_scc1 Ls_nf2
    v_cvt_pk_bf16_f32 v246, v212, v212
    v_mov_b32 v212, 0
    ds_write_b16 v240, v246
    v_add_u32 v240, 128, v240
    s_add_u32 s24, s24, s32
    s_addc_u32 s25, s25, 0
    s_xor_b32 s32, s32, 0x18ffe0
Ls_nf2:
    s_bitcmp0_b64 s[56:57], 7
    s_cbranch_scc1 Ls_na2
    s_sub_u32 s60, s60, 1
    s_cbranch_scc0 Ls_ns2
    s_mov_b32 s49, 7
    s_call_b64 s[62:63], L_swap
    ds_read_u8 v230, v237 offset:96
    ds_read_u8 v232, v237 offset:104
    s_add_u32 s35, s35, s31
    s_min_u32 s35, s35, 419404800
    s_xor_b32 s31, s31, 0x63ff800
    s_bitcmp0_b64 s[56:57], 4
    s_cbranch_scc1 Ls_evd2
    s_waitcnt lgkmcnt(0)
    s_branch Ls_e12
Ls_ns2:
    s_add_u32 s35, s35, s31
    s_min_u32 s35, s35, 419404800
    s_xor_b32 s31, s31, 0x63ff800
Ls_na2:
    s_bitcmp0_b64 s[56:57], 4
    s_cbranch_scc1 Ls_evd2
Ls_e12:
    s_sub_u32 s61, s61, 1
    s_cbranch_scc1 Ls_last2
    s_cmp_lg_u32 s61, s45
    s_cbranch_scc1 Ls_nw2
    v_add_u32 v238, s47, v238
    v_add_u32 v239, s47, v239
    ds_read_u16 v224, v238 offset:0
    ds_read_u16 v225, v238 offset:8
    ds_read_u16 v226, v238 offset:64
    ds_read_u16 v227, v238 offset:72
    s_waitcnt lgkmcnt(0)
Ls_nw2:
    v_mul_u32_u24 v216, v224, v241
    v_mul_u32_u24 v217, v224, v242
    v_mul_u32_u24 v218, v225, v241
    v_mul_u32_u24 v219, v225, v242
    v_mul_u32_u24 v220, v226, v241
    v_mul_u32_u24 v221, v226, v242
    v_mul_u32_u24 v222, v227, v241
    v_mul_u32_u24 v223, v227, v242
    v_add_u32 v238, 128, v238
    ds_read_b128 v[164:167], v239
    v_mfma_f32_4x4x4_16b_bf16 v[132:135], v[216:217], v[68:69], v[4:7]
    ds_read_b128 v[168:171], v239 offset:64
    ds_read_b128 v[172:175], v239 offset:128
    v_mfma_f32_4x4x4_16b_bf16 v[136:139], v[218:219], v[70:71], v[8:11]
    ds_read_b128 v[176:179], v239 offset:192
    ds_read_u16 v224, v238
    v_mfma_f32_4x4x4_16b_bf16 v[140:143], v[220:221], v[72:73], v[12:15]
    ds_read_u16 v225, v238 offset:8
    ds_read_u16 v226, v238 offset:64
    v_mfma_f32_4x4x4_16b_bf16 v[144:147], v[222:223], v[74:75], v[16:19]
    ds_read_u16 v227, v238 offset:72
    v_add_u32 v239, 272, v239
    v_mfma_f32_4x4x4_16b_bf16 v[246:249], v[216:217], v[76:77], v[20:23]
    v_cvt_pk_bf16_f32 v100, v132, v133
    v_cvt_pk_bf16_f32 v101, v134, v135
    v_mfma_f32_4x4x4_16b_bf16 v[250:253], v[218:219], v[78:79], v[24:27]
    v_cvt_pk_bf16_f32 v102, v136, v137
    v_cvt_pk_bf16_f32 v103, v138, v139
    v_mfma_f32_4x4x4_16b_bf16 v[132:135], v[220:221], v[80:81], v[28:31]
    v_cvt_pk_bf16_f32 v104, v140, v141
    v_cvt_pk_bf16_f32 v105, v142, v143
    v_mfma_f32_4x4x4_16b_bf16 v[136:139], v[222:223], v[82:83], v[32:35]
    v_cvt_pk_bf16_f32 v106, v144, v145
    v_cvt_pk_bf16_f32 v107, v146, v147
    v_mfma_f32_4x4x4_16b_bf16 v[140:143], v[216:217], v[84:85], v[36:39]
    v_cvt_pk_bf16_f32 v108, v246, v247
    v_cvt_pk_bf16_f32 v109, v248, v249
    v_mfma_f32_4x4x4_16b_bf16 v[144:147], v[218:219], v[86:87], v[40:43]
    v_cvt_pk_bf16_f32 v110, v250, v251
    v_cvt_pk_bf16_f32 v111, v252, v253
    v_mfma_f32_4x4x4_16b_bf16 v[246:249], v[220:221], v[88:89], v[44:47]
    v_cvt_pk_bf16_f32 v112, v132, v133
    v_cvt_pk_bf16_f32 v113, v134, v135
    v_mfma_f32_4x4x4_16b_bf16 v[250:253], v[222:223], v[90:91], v[48:51]
    v_cvt_pk_bf16_f32 v114, v136, v137
    v_cvt_pk_bf16_f32 v115, v138, v139
    v_mfma_f32_4x4x4_16b_bf16 v[132:135], v[216:217], v[92:93], v[52:55]
    v_cvt_pk_bf16_f32 v116, v140, v141
    v_cvt_pk_bf16_f32 v117, v142, v143
    v_mfma_f32_4x4x4_16b_bf16 v[136:139], v[218:219], v[94:95], v[56:59]
    v_cvt_pk_bf16_f32 v118, v144, v145
    v_cvt_pk_bf16_f32 v119, v146, v147
    v_mfma_f32_4x4x4_16b_bf16 v[140:143], v[220:221], v[96:97], v[60:63]
    v_cvt_pk_bf16_f32 v120, v246, v247
    v_cvt_pk_bf16_f32 v121, v248, v249
    v_mfma_f32_4x4x4_16b_bf16 v[144:147], v[222:223], v[98:99], v[64:67]
    v_cvt_pk_bf16_f32 v122, v250, v251
    v_cvt_pk_bf16_f32 v123, v252, v253
    v_cvt_pk_bf16_f32 v124, v132, v133
    v_cvt_pk_bf16_f32 v125, v134, v135
    v_cvt_pk_bf16_f32 v126, v136, v137
    v_cvt_pk_bf16_f32 v127, v138, v139
    v_cvt_pk_bf16_f32 v128, v140, v141
    v_cvt_pk_bf16_f32 v129, v142, v143
    v_cvt_pk_bf16_f32 v130, v144, v145
    v_cvt_pk_bf16_f32 v131, v146, v147
    s_waitcnt lgkmcnt(0)
    s_branch Ls_evd2
Ls_ev3:
    s_bitcmp0_b64 s[56:57], 3
    s_cbranch_scc1 Ls_nf3
    v_cvt_pk_bf16_f32 v246, v212, v212
    v_mov_b32 v212, 0
    ds_write_b16 v240, v246
    v_add_u32 v240, 128, v240
    s_add_u32 s24, s24, s32
    s_addc_u32 s25, s25, 0
    s_xor_b32 s32, s32, 0x18ffe0
Ls_nf3:
    s_bitcmp0_b64 s[56:57], 8
    s_cbranch_scc1 Ls_na3
    s_sub_u32 s60, s60, 1
    s_cbranch_scc0 Ls_ns3
    s_mov_b32 s49, 8
    s_call_b64 s[62:63], L_swap
    ds_read_u8 v230, v237 offset:112
    ds_read_u8 v232, v237 offset:120
    s_add_u32 s35, s35, s31
    s_min_u32 s35, s35, 419404800
    s_xor_b32 s31, s31, 0x63ff800
    s_bitcmp0_b64 s[56:57], 5
    s_cbranch_scc1 Ls_evd3
    s_waitcnt lgkmcnt(0)
    s_branch Ls_e13
Ls_ns3:
    s_add_u32 s35, s35, s31
    s_min_u32 s35, s35, 419404800
    s_xor_b32 s31, s31, 0x63ff800
Ls_na3:
    s_bitcmp0_b64 s[56:57], 5
    s_cbranch_scc1 Ls_evd3
Ls_e13:
    s_sub_u32 s61, s61, 1
    s_cbranch_scc1 Ls_last3
    s_cmp_lg_u32 s61, s45
    s_cbranch_scc1 Ls_nw3
    v_add_u32 v238, s47, v238
    v_add_u32 v239, s47, v239
    ds_read_u16 v224, v238 offset:0
    ds_read_u16 v225, v238 offset:8
    ds_read_u16 v226, v238 offset:64
    ds_read_u16 v227, v238 offset:72
    s_waitcnt lgkmcnt(0)
Ls_nw3:
    v_mul_u32_u24 v216, v224, v241
    v_mul_u32_u24 v217, v224, v242
    v_mul_u32_u24 v218, v225, v241
    v_mul_u32_u24 v219, v225, v242
    v_mul_u32_u24 v220, v226, v241
    v_mul_u32_u24 v221, v226, v242
    v_mul_u32_u24 v222, v227, v241
    v_mul_u32_u24 v223, v227, v242
    v_add_u32 v238, 128, v238
    ds_read_b128 v[164:167], v239
    v_mfma_f32_4x4x4_16b_bf16 v[132:135], v[216:217], v[68:69], v[4:7]
    ds_read_b128 v[168:171], v239 offset:64
    ds_read_b128 v[172:175], v239 offset:128
    v_mfma_f32_4x4x4_16b_bf16 v[136:139], v[218:219], v[70:71], v[8:11]
    ds_read_b128 v[176:179], v239 offset:192
    ds_read_u16 v224, v238
    v_mfma_f32_4x4x4_16b_bf16 v[140:143], v[220:221], v[72:73], v[12:15]
    ds_read_u16 v225, v238 offset:8
    ds_read_u16 v226, v238 offset:64
    v_mfma_f32_4x4x4_16b_bf16 v[144:147], v[222:223], v[74:75], v[16:19]
    ds_read_u16 v227, v238 offset:72
    v_add_u32 v239, 272, v239
    v_mfma_f32_4x4x4_16b_bf16 v[246:249], v[216:217], v[76:77], v[20:23]
    v_cvt_pk_bf16_f32 v100, v132, v133
    v_cvt_pk_bf16_f32 v101, v134, v135
    v_mfma_f32_4x4x4_16b_bf16 v[250:253], v[218:219], v[78:79], v[24:27]
    v_cvt_pk_bf16_f32 v102, v136, v137
    v_cvt_pk_bf16_f32 v103, v138, v139
    v_mfma_f32_4x4x4_16b_bf16 v[132:135], v[220:221], v[80:81], v[28:31]
    v_cvt_pk_bf16_f32 v104, v140, v141
    v_cvt_pk_bf16_f32 v105, v142, v143
    v_mfma_f32_4x4x4_16b_bf16 v[136:139], v[222:223], v[82:83], v[32:35]
    v_cvt_pk_bf16_f32 v106, v144, v145
    v_cvt_pk_bf16_f32 v107, v146, v147
    v_mfma_f32_4x4x4_16b_bf16 v[140:143], v[216:217], v[84:85], v[36:39]
    v_cvt_pk_bf16_f32 v108, v246, v247
    v_cvt_pk_bf16_f32 v109, v248, v249
    v_mfma_f32_4x4x4_16b_bf16 v[144:147], v[218:219], v[86:87], v[40:43]
    v_cvt_pk_bf16_f32 v110, v250, v251
    v_cvt_pk_bf16_f32 v111, v252, v253
    v_mfma_f32_4x4x4_16b_bf16 v[246:249], v[220:221], v[88:89], v[44:47]
    v_cvt_pk_bf16_f32 v112, v132, v133
    v_cvt_pk_bf16_f32 v113, v134, v135
    v_mfma_f32_4x4x4_16b_bf16 v[250:253], v[222:223], v[90:91], v[48:51]
    v_cvt_pk_bf16_f32 v114, v136, v137
    v_cvt_pk_bf16_f32 v115, v138, v139
    v_mfma_f32_4x4x4_16b_bf16 v[132:135], v[216:217], v[92:93], v[52:55]
    v_cvt_pk_bf16_f32 v116, v140, v141
    v_cvt_pk_bf16_f32 v117, v142, v143
    v_mfma_f32_4x4x4_16b_bf16 v[136:139], v[218:219], v[94:95], v[56:59]
    v_cvt_pk_bf16_f32 v118, v144, v145
    v_cvt_pk_bf16_f32 v119, v146, v147
    v_mfma_f32_4x4x4_16b_bf16 v[140:143], v[220:221], v[96:97], v[60:63]
    v_cvt_pk_bf16_f32 v120, v246, v247
    v_cvt_pk_bf16_f32 v121, v248, v249
    v_mfma_f32_4x4x4_16b_bf16 v[144:147], v[222:223], v[98:99], v[64:67]
    v_cvt_pk_bf16_f32 v122, v250, v251
    v_cvt_pk_bf16_f32 v123, v252, v253
    v_cvt_pk_bf16_f32 v124, v132, v133
    v_cvt_pk_bf16_f32 v125, v134, v135
    v_cvt_pk_bf16_f32 v126, v136, v137
    v_cvt_pk_bf16_f32 v127, v138, v139
    v_cvt_pk_bf16_f32 v128, v140, v141
    v_cvt_pk_bf16_f32 v129, v142, v143
    v_cvt_pk_bf16_f32 v130, v144, v145
    v_cvt_pk_bf16_f32 v131, v146, v147
    s_waitcnt lgkmcnt(0)
    s_branch Ls_evd3
Ls_last0:
    s_branch Ls_tail
Ls_last1:
    v_add_u32 v236, 2080, v236
    s_lshr_b64 s[56:57], s[56:57], 1
    v_add_u32 v244, 16, v244
    s_branch Ls_tail
Ls_last2:
    v_add_u32 v236, 4160, v236
    s_lshr_b64 s[56:57], s[56:57], 2
    v_add_u32 v244, 32, v244
    s_branch Ls_tail
Ls_last3:
    v_add_u32 v236, 6240, v236
    s_lshr_b64 s[56:57], s[56:57], 3
    v_add_u32 v244, 48, v244
Ls_tail:
    ds_read_b32 v246, v244 offset:0
    s_waitcnt lgkmcnt(0)
    v_bfe_u32 v247, v246, 0, 8
    v_lshlrev_b32 v247, 1, v247
    v_bfe_u32 v248, v246, 8, 8
    v_lshlrev_b32 v248, 1, v248
    v_bfe_u32 v249, v246, 16, 8
    v_lshlrev_b32 v249, 1, v249
    v_bfe_u32 v250, v246, 24, 8
    v_lshlrev_b32 v250, 1, v250
    buffer_load_ushort v247, v247, s[24:27], 0 offen
    buffer_load_ushort v248, v248, s[24:27], 0 offen
    buffer_load_ushort v249, v249, s[24:27], 0 offen
    buffer_load_ushort v250, v250, s[24:27], 0 offen
    s_waitcnt vmcnt(0)
    v_lshlrev_b32 v247, 16, v247
    v_mul_f32 v208, v208, v247
    v_lshlrev_b32 v248, 16, v248
    v_mul_f32 v209, v209, v248
    v_lshlrev_b32 v249, 16, v249
    v_mul_f32 v210, v210, v249
    v_lshlrev_b32 v250, 16, v250
    v_mul_f32 v211, v211, v250
    v_exp_f32 v132, v148
    v_exp_f32 v133, v149
    v_exp_f32 v134, v150
    v_exp_f32 v135, v151
    v_exp_f32 v136, v152
    v_exp_f32 v137, v153
    v_mfma_f32_4x4x4_16b_bf16 v[132:135], v[228:229], v[228:229], v[132:135]
    v_cvt_pk_bf16_f32 v208, v208, v209
    v_cvt_pk_bf16_f32 v209, v210, v211
    v_exp_f32 v138, v154
    s_nop 0
    v_mfma_f32_4x4x4_16b_bf16 v[212:215], v[208:209], v[188:189], v[212:215] cbsz:4 abid:0
    ds_read_b64_tr_b16 v[188:189], v236 offset:0
    v_exp_f32 v139, v155
    v_exp_f32 v140, v156
    v_mfma_f32_4x4x4_16b_bf16 v[212:215], v[208:209], v[190:191], v[212:215] cbsz:4 abid:4
    ds_read_b64_tr_b16 v[190:191], v236 offset:512
    v_mfma_f32_4x4x4_16b_bf16 v[136:139], v[228:229], v[228:229], v[136:139]
    v_rcp_f32 v132, v132
    v_mfma_f32_4x4x4_16b_bf16 v[212:215], v[208:209], v[192:193], v[212:215] cbsz:4 abid:8
    ds_read_b64_tr_b16 v[192:193], v236 offset:1056
    v_exp_f32 v141, v157
    v_rcp_f32 v133, v133
    v_mfma_f32_4x4x4_16b_bf16 v[212:215], v[208:209], v[194:195], v[212:215] cbsz:4 abid:12
    ds_read_b64_tr_b16 v[194:195], v236 offset:1568
    v_exp_f32 v142, v158
    v_rcp_f32 v134, v134
    v_exp_f32 v143, v159
    v_rcp_f32 v135, v135
    v_cvt_pk_bf16_f32 v132, v132, v133
    v_mfma_f32_4x4x4_16b_bf16 v[140:143], v[228:229], v[228:229], v[140:143]
    v_exp_f32 v144, v160
    v_rcp_f32 v136, v136
    v_cvt_pk_bf16_f32 v133, v134, v135
    s_bitcmp0_b64 s[56:57], 1
    s_cbranch_scc1 Ls_tnf
    v_cvt_pk_bf16_f32 v246, v212, v212
    v_mov_b32 v212, 0
    ds_write_b16 v240, v246
    v_add_u32 v240, 128, v240
    s_add_u32 s24, s24, s32
    s_addc_u32 s25, s25, 0
    s_xor_b32 s32, s32, 0x18ffe0
Ls_tnf:
    s_waitcnt lgkmcnt(0)
    v_exp_f32 v145, v161
    v_rcp_f32 v137, v137
    v_exp_f32 v146, v162
    v_rcp_f32 v138, v138
    v_cvt_pk_bf16_f32 v134, v136, v137
    v_exp_f32 v147, v163
    v_rcp_f32 v139, v139
    s_nop 0
    v_mfma_f32_4x4x4_16b_bf16 v[144:147], v[228:229], v[228:229], v[144:147]
    v_rcp_f32 v140, v140
    v_rcp_f32 v141, v141
    v_cvt_pk_bf16_f32 v135, v138, v139
    v_rcp_f32 v142, v142
    v_cvt_pk_bf16_f32 v136, v140, v141
    v_mfma_f32_16x16x32_bf16 v[208:211], v[132:135], v[196:199], v[204:207]
    v_rcp_f32 v143, v143
    v_rcp_f32 v144, v144
    v_cvt_pk_bf16_f32 v137, v142, v143
    v_rcp_f32 v145, v145
    v_rcp_f32 v146, v146
    v_rcp_f32 v147, v147
    v_cvt_pk_bf16_f32 v138, v144, v145
    v_cvt_pk_bf16_f32 v139, v146, v147
    s_nop 1
    v_mfma_f32_16x16x32_bf16 v[208:211], v[136:139], v[200:203], v[208:211]
    ds_read_b32 v246, v244 offset:16
    s_waitcnt lgkmcnt(0)
    v_bfe_u32 v247, v246, 0, 8
    v_lshlrev_b32 v247, 1, v247
    v_bfe_u32 v248, v246, 8, 8
    v_lshlrev_b32 v248, 1, v248
    v_bfe_u32 v249, v246, 16, 8
    v_lshlrev_b32 v249, 1, v249
    v_bfe_u32 v250, v246, 24, 8
    v_lshlrev_b32 v250, 1, v250
    buffer_load_ushort v247, v247, s[24:27], 0 offen
    buffer_load_ushort v248, v248, s[24:27], 0 offen
    buffer_load_ushort v249, v249, s[24:27], 0 offen
    buffer_load_ushort v250, v250, s[24:27], 0 offen
    s_waitcnt vmcnt(0)
    v_lshlrev_b32 v247, 16, v247
    v_mul_f32 v208, v208, v247
    v_lshlrev_b32 v248, 16, v248
    v_mul_f32 v209, v209, v248
    v_lshlrev_b32 v249, 16, v249
    v_mul_f32 v210, v210, v249
    v_lshlrev_b32 v250, 16, v250
    v_mul_f32 v211, v211, v250
    v_cvt_pk_bf16_f32 v208, v208, v209
    v_cvt_pk_bf16_f32 v209, v210, v211
    s_nop 1
    v_mfma_f32_4x4x4_16b_bf16 v[212:215], v[208:209], v[188:189], v[212:215] cbsz:4 abid:0
    s_nop 1
    v_mfma_f32_4x4x4_16b_bf16 v[212:215], v[208:209], v[190:191], v[212:215] cbsz:4 abid:4
    s_nop 1
    v_mfma_f32_4x4x4_16b_bf16 v[212:215], v[208:209], v[192:193], v[212:215] cbsz:4 abid:8
    s_nop 1
    v_mfma_f32_4x4x4_16b_bf16 v[212:215], v[208:209], v[194:195], v[212:215] cbsz:4 abid:12
    s_nop 4
    v_cvt_pk_bf16_f32 v246, v212, v212
    ds_write_b16 v240, v246
    s_branch L_store
.section .rodata,"a"
.p2align 6
.amdhsa_kernel standalone__sequential_behavior_din__recsys_kernel
  .amdhsa_next_free_vgpr 256
  .amdhsa_next_free_sgpr 102
  .amdhsa_accum_offset 256
  .amdhsa_group_segment_fixed_size 0
  .amdhsa_kernarg_size 80
  .amdhsa_user_sgpr_count 2
  .amdhsa_user_sgpr_kernarg_segment_ptr 1
  .amdhsa_system_sgpr_workgroup_id_x 1
.end_amdhsa_kernel
```

```asm
; @launch grid=(256,1,1) block=(512,1,1) lds=163840
.amdgcn_target "amdgcn-amd-amdhsa--gfx950"
.text
.globl standalone__sequential_behavior_din__recsys_kernel
.p2align 8
.type standalone__sequential_behavior_din__recsys_kernel,@function
standalone__sequential_behavior_din__recsys_kernel:
    s_load_dwordx16 s[4:19], s[0:1], 0
    s_cmp_ge_u32 s2, 256
    s_cbranch_scc1 L_end
    v_lshrrev_b32 v1, 6, v0
    v_and_b32 v0, 63, v0
    v_readfirstlane_b32 s54, v1
    s_lshl_b32 s53, s2, 3
    v_lshlrev_b32 v2, 4, v0
    v_lshrrev_b32 v1, 4, v0
    v_and_b32 v3, 0xf0, v2
    v_lshlrev_b32 v3, 2, v3
    v_lshl_add_u32 v130, v1, 4, v3
    v_bfrev_b32 v3, 1
    s_add_u32 s53, s53, s54
    s_movk_i32 s66, 800
    v_cmp_gt_u32 vcc, s66, v130
    s_mul_i32 s93, s53, 800
    s_mul_i32 s52, s54, 20480
    s_mov_b64 s[28:29], vcc
    v_cndmask_b32 v3, v3, v130, vcc
    v_and_b32 v248, 16, v0
    v_lshlrev_b32 v246, 1, v248
    v_xor_b32 v246, v246, v2
    v_and_b32 v243, 0xf0, v2
    v_lshl_add_u32 v243, v1, 19, v243
    s_lshl_b32 s66, s53, 8
    v_add_u32 v243, s66, v243
    s_lshl_b32 s67, s54, 12
    s_add_u32 m0, s52, 8320
    s_mov_b32 s26, 6553600
    s_mov_b32 s27, 0x20000
    s_waitcnt lgkmcnt(0)
    s_mov_b32 s24, s8
    s_and_b32 s25, s9, 0xffff
    s_cmp_ge_u32 s54, 4
    s_cbranch_scc1 L_young0
    buffer_load_dwordx4 v[100:103], v3, s[24:27], s93 offen nt
L_young0:
    global_load_lds_dwordx4 v243, s[4:5] nt
    s_add_u32 m0, s52, 4160
    s_add_u32 s10, s10, s67
    s_addc_u32 s11, s11, 0
    v_xor_b32 v247, 64, v246
    global_load_lds_dwordx4 v246, s[10:11] offset:0
    global_load_lds_dwordx4 v247, s[10:11] offset:1024
    global_load_lds_dwordx4 v246, s[10:11] offset:2048
    global_load_lds_dwordx4 v247, s[10:11] offset:3072
    s_load_dword s30, s[16:17], 0
    s_and_b32 s67, s54, 3
    v_and_b32 v250, 3, v0
    s_mov_b32 s20, s6
    s_and_b32 s21, s7, 0xffff
    s_or_b32 s21, s21, 0x800000
    s_mov_b32 s22, 200
    s_mov_b32 s23, 0x20000
    s_sub_u32 s40, s20, 1056
    s_subb_u32 s41, s21, 0
    s_mov_b32 s42, 200
    s_mov_b32 s43, 0x20000
    s_mul_i32 s35, s53, 51200
    s_movk_i32 s31, 25600
    s_mov_b32 s60, 5
    s_mov_b64 s[56:57], 0
    s_mov_b64 s[58:59], 0
    v_mov_b32 v148, -1
    v_mov_b32 v149, -1
    v_mov_b32 v150, -1
    v_mov_b32 v151, -1
    s_add_u32 s66, s52, 18432
    v_add_u32 v152, s66, v2
    ds_write_b128 v152, v[148:151]
    ds_write_b128 v152, v[148:151] offset:1024
    s_add_u32 s64, s52, 18448
    v_mov_b32 v153, -1
    v_mov_b32 v154, -1
    v_mov_b32 v155, -1
    v_lshrrev_b32 v237, 3, v0
    v_add_u32 v237, s64, v237
    v_lshl_add_u32 v244, v1, 2, s66
    v_and_b32 v231, 0x70, v2
    v_lshlrev_b32 v248, 2, v248
    v_xor_b32 v231, v231, v248
    v_mov_b32 v233, v231
    s_movk_i32 s66, 400
    v_cmp_le_u32 vcc, s66, v130
    v_lshrrev_b32 v126, 1, v130
    s_movk_i32 s66, -200
    v_cndmask_b32 v130, 0, 1, vcc
    v_mad_i32_i24 v126, v130, s66, v126
    v_mul_u32_u24 v127, 0x10001, v126
    v_add_u32 v126, 0x10000, v127
    v_add_u32 v128, 0x50004, v127
    v_add_u32 v129, 0x70006, v127
    v_add_u32 v127, 0x30002, v127
    v_mov_b32 v131, 0xbfe0bfe0
    s_mov_b32 s86, 0xfff0ffff
    s_mov_b32 s87, 0xf000ff00
    s_mov_b32 s88, 0xff00fff0
    s_mov_b32 s89, 0xf000
    s_mov_b32 s90, 0xf0000f
    s_mov_b32 s91, 0xf0000f00
    s_mov_b32 s84, 0x11111113
    s_mov_b32 s85, 0x11111111
    v_cndmask_b32 v116, 0, v131, s[86:87]
    v_cndmask_b32 v120, 0, v131, s[88:89]
    v_cndmask_b32 v117, 0, v131, s[86:87]
    v_cndmask_b32 v121, 0, v131, s[88:89]
    v_cndmask_b32 v122, 0, v131, s[84:85]
    v_cndmask_b32 v123, 0, v131, s[84:85]
    v_cndmask_b32 v124, 0, v131, s[84:85]
    v_cndmask_b32 v125, 0, v131, s[84:85]
    v_lshlrev_b32 v246, 4, v250
    v_sub_u32 v246, 48, v246
    s_mov_b32 s86, 0xbfe0bfe0
    s_mov_b32 s87, 0xf0bfe0
    v_lshrrev_b64 v[118:119], v246, s[86:87]
    v_mov_b32 v131, 0
    s_mov_b64 s[84:85], 0
    v_cndmask_b32 v118, v120, v118, s[90:91]
    v_cndmask_b32 v119, v121, v119, s[90:91]
    s_mov_b32 s61, 7
    s_mov_b32 s92, 0xbfb8aa3b
    v_and_b32 v251, 15, v0
    v_bfe_u32 v252, v0, 2, 2
    v_lshlrev_b32 v253, 3, v250
    v_lshl_add_u32 v253, v252, 7, v253
    v_and_b32 v246, 24, v0
    v_lshlrev_b32 v246, 2, v246
    v_xor_b32 v246, v253, v246
    v_lshl_add_u32 v246, v1, 10, v246
    s_lshl_b32 s66, s67, 5
    v_xor_b32 v66, s66, v246
    v_add_u32 v66, 45120, v66
    s_lshr_b32 s66, s54, 1
    s_lshl_b32 s66, s66, 5
    v_xor_b32 v64, s66, v246
    s_and_b32 s66, s54, 1
    s_mul_i32 s66, s66, 20480
    s_add_u32 s66, s66, 4160
    v_add_u32 v64, s66, v64
    v_add_u32 v65, 81920, v64
    s_and_b32 s66, s54, 4
    v_lshrrev_b32 v246, 3, v251
    v_add_u32 v246, s66, v246
    v_mul_u32_u24 v246, 20480, v246
    v_lshl_add_u32 v246, v1, 4, v246
    v_and_b32 v247, 7, v0
    v_lshl_add_u32 v67, v247, 7, v246
    v_and_b32 v247, 1, v0
    v_lshlrev_b32 v247, 4, v247
    v_lshlrev_b32 v247, v247, 1
    v_cmp_gt_u32 vcc, 2, v250
    v_mov_b32 v229, 0
    v_mov_b32 v228, 0x3f80
    v_cndmask_b32 v241, 0, v247, vcc
    v_cmp_eq_u32 vcc, 0, v251
    v_sub_u32 v242, v247, v241
    v_mul_u32_u24 v218, 0x3f80, v241
    v_cndmask_b32 v220, 0, -1, vcc
    v_mul_u32_u24 v219, 0x3f80, v242
    s_and_b32 s66, s54, 3
    s_lshl_b32 s66, s66, 6
    s_add_u32 s66, s66, 9344
    v_and_b32 v247, 7, v0
    v_mul_u32_u24 v247, 144, v247
    v_add3_u32 v98, v67, v247, s66
    s_add_u32 s66, s52, 14592
    v_lshl_add_u32 v221, v0, 2, s66
    ds_write_b32 v221, v229
    s_xor_b32 s66, s54, 4
    s_mul_i32 s66, s66, 20480
    s_add_u32 s66, s66, 14592
    v_writelane_b32 v221, s66, 1
    v_mov_b32 v222, s52
    ds_write_b32 v222, v229 offset:14848
    ds_write_b32 v222, v229 offset:14864
    s_mov_b32 s47, 0
    s_mov_b32 s50, 0
    v_and_b32 v247, 8, v0
    v_lshlrev_b32 v247, 2, v247
    v_lshl_add_u32 v247, v251, 7, v247
    v_add_u32 v247, s52, v247
    v_and_b32 v248, 2, v0
    v_lshlrev_b32 v248, 1, v248
    v_xor_b32 v248, v248, v1
    v_lshl_add_u32 v234, v248, 4, v247
    v_xor_b32 v248, 4, v248
    v_lshl_add_u32 v235, v248, 4, v247
    v_and_b32 v247, 8, v0
    v_lshlrev_b32 v247, 3, v247
    v_lshl_add_u32 v248, v1, 5, v253
    v_xor_b32 v248, v248, v247
    v_add_u32 v236, s52, v248
    s_add_u32 s66, s52, 8320
    v_lshl_add_u32 v238, v250, 1, s66
    v_lshl_add_u32 v238, v1, 4, v238
    s_add_u32 s66, s52, 14880
    v_lshl_add_u32 v240, v0, 1, s66
    s_add_u32 s66, s52, 9344
    v_lshl_add_u32 v239, v1, 4, s66
    v_mov_b32 v188, 0
    v_mov_b32 v189, 0
    v_mov_b32 v190, 0
    v_mov_b32 v191, 0
    v_mov_b32 v192, 0
    v_mov_b32 v193, 0
    v_mov_b32 v194, 0
    v_mov_b32 v195, 0
    v_mov_b32 v208, 0
    v_mov_b32 v212, 0
    v_mov_b32 v209, 0
    v_mov_b32 v213, 0
    v_mov_b32 v210, 0
    v_mov_b32 v214, 0
    v_mov_b32 v211, 0
    v_mov_b32 v215, 0
    s_and_b32 s66, s54, 3
    s_lshl_b32 s66, s66, 5
    v_lshl_add_u32 v249, v1, 3, s66
    global_load_dwordx2 v[96:97], v249, s[12:13]
    s_cmp_ge_u32 s54, 4
    s_cbranch_scc0 L_old3z
    buffer_load_dwordx4 v[100:103], v3, s[24:27], s93 offen nt
L_old3z:
    s_cmp_ge_u32 s54, 4
    s_cbranch_scc1 L_young1
    s_waitcnt vmcnt(6) lgkmcnt(0)
    s_call_b64 s[62:63], L_fp
    s_waitcnt vmcnt(5)
    s_branch L_old1
L_young1:
    s_waitcnt vmcnt(2)
L_old1:
    s_waitcnt lgkmcnt(0)
    s_barrier
    ds_read_b64_tr_b16 v[16:17], v66 offset:0
    ds_read_b64_tr_b16 v[18:19], v66 offset:512
    ds_read_b64_tr_b16 v[20:21], v66 offset:20480
    ds_read_b64_tr_b16 v[22:23], v66 offset:20992
    ds_read_b64_tr_b16 v[24:25], v66 offset:40960
    ds_read_b64_tr_b16 v[26:27], v66 offset:41472
    ds_read_b64_tr_b16 v[28:29], v66 offset:61440
    ds_read_b64_tr_b16 v[30:31], v66 offset:61952
    ds_read_b128 v[32:35], v67 offset:8320
    ds_read_b128 v[36:39], v67 offset:8384
    ds_read_b128 v[40:43], v67 offset:49280
    ds_read_b128 v[44:47], v67 offset:49344
    ds_read_b64_tr_b16 v[4:5], v64 offset:0
    ds_read_b64_tr_b16 v[8:9], v65 offset:0
    ds_read_b64_tr_b16 v[12:13], v65 offset:40960
    ds_read_b64_tr_b16 v[6:7], v64 offset:512
    ds_read_b64_tr_b16 v[10:11], v65 offset:512
    ds_read_b64_tr_b16 v[14:15], v65 offset:41472
    s_cmp_ge_u32 s54, 4
    s_cbranch_scc1 L_young2
    s_waitcnt vmcnt(4)
    s_branch L_old2
L_young2:
    s_waitcnt vmcnt(1)
L_old2:
    s_add_u32 s93, s93, 1638400
    buffer_load_dwordx4 v[104:107], v3, s[24:27], s93 offen nt
    s_add_u32 s93, s93, 1638400
    buffer_load_dwordx4 v[108:111], v3, s[24:27], s93 offen nt
    s_add_u32 s93, s93, 1638400
    buffer_load_dwordx4 v[112:115], v3, s[24:27], s93 offen nt
    v_lshlrev_b32 v249, 3, v1
    v_lshl_add_u32 v249, v250, 5, v249
    global_load_dwordx2 v[216:217], v249, s[14:15]
    v_lshlrev_b32 v48, 16, v96
    v_and_b32 v49, 0xffff0000, v96
    v_lshlrev_b32 v50, 16, v97
    v_and_b32 v51, 0xffff0000, v97
    s_lshl_b32 s30, s30, 16
    v_and_b32 v204, s30, v220
    v_and_b32 v205, s30, v220
    v_and_b32 v206, s30, v220
    v_and_b32 v207, s30, v220
    s_waitcnt lgkmcnt(0)
    v_xor_b32 v24, 0x80008000, v24
    v_xor_b32 v25, 0x80008000, v25
    v_xor_b32 v26, 0x80008000, v26
    v_xor_b32 v27, 0x80008000, v27
    v_xor_b32 v28, 0x80008000, v28
    v_xor_b32 v29, 0x80008000, v29
    v_xor_b32 v30, 0x80008000, v30
    v_xor_b32 v31, 0x80008000, v31
    v_mfma_f32_4x4x4_16b_bf16 v[56:59], v[218:219], v[4:5], 0
    v_mfma_f32_4x4x4_16b_bf16 v[68:71], v[218:219], v[12:13], 0
    v_mfma_f32_4x4x4_16b_bf16 v[60:63], v[218:219], v[6:7], 0
    v_mfma_f32_4x4x4_16b_bf16 v[72:75], v[218:219], v[14:15], 0
    v_mfma_f32_4x4x4_16b_bf16 v[56:59], v[218:219], v[8:9], v[56:59]
    v_mfma_f32_4x4x4_16b_bf16 v[60:63], v[218:219], v[10:11], v[60:63]
    v_mfma_f32_16x16x32_bf16 v[52:55], v[16:19], v[40:43], v[48:51]
    v_mfma_f32_16x16x32_bf16 v[52:55], v[20:23], v[44:47], v[52:55]
    v_mfma_f32_16x16x32_bf16 v[52:55], v[24:27], v[40:43], v[52:55]
    v_mfma_f32_16x16x32_bf16 v[52:55], v[28:31], v[44:47], v[52:55]
    v_mfma_f32_16x16x32_bf16 v[48:51], v[16:19], v[32:35], v[48:51]
    v_mfma_f32_16x16x32_bf16 v[48:51], v[20:23], v[36:39], v[48:51]
    v_mfma_f32_16x16x32_bf16 v[48:51], v[24:27], v[32:35], v[48:51]
    v_mfma_f32_16x16x32_bf16 v[48:51], v[28:31], v[36:39], v[48:51]
    v_mul_f32 v56, s92, v56
    v_mul_f32 v57, s92, v57
    v_mul_f32 v58, s92, v58
    v_mul_f32 v59, s92, v59
    v_mul_f32 v60, s92, v60
    v_mul_f32 v61, s92, v61
    v_mul_f32 v62, s92, v62
    v_mul_f32 v63, s92, v63
    v_mul_f32 v68, s92, v68
    v_mul_f32 v69, s92, v69
    v_mul_f32 v70, s92, v70
    v_mul_f32 v71, s92, v71
    v_mul_f32 v72, s92, v72
    v_mul_f32 v73, s92, v73
    v_mul_f32 v74, s92, v74
    v_mul_f32 v75, s92, v75
    s_add_u32 s66, s52, 11520
    v_add_u32 v3, s66, v2
    v_cvt_pk_bf16_f32 v68, v68, v69
    v_cvt_pk_bf16_f32 v69, v70, v71
    v_cvt_pk_bf16_f32 v70, v72, v73
    v_cvt_pk_bf16_f32 v71, v74, v75
    v_mul_f32 v48, s92, v48
    v_mul_f32 v49, s92, v49
    v_mul_f32 v50, s92, v50
    v_mul_f32 v51, s92, v51
    v_mul_f32 v52, s92, v52
    v_mul_f32 v53, s92, v53
    v_mul_f32 v54, s92, v54
    v_mul_f32 v55, s92, v55
    ds_write_b128 v3, v[56:59]
    ds_write_b128 v3, v[60:63] offset:1024
    ds_write_b128 v3, v[68:71] offset:2048
    ds_write_b128 v98, v[48:51]
    ds_write_b128 v98, v[52:55] offset:40960
    v_add_u32 v3, 11520, v2
    v_add_u32 v246, 81920, v3
    s_waitcnt lgkmcnt(0)
    s_barrier
    s_cmp_ge_u32 s54, 4
    s_cbranch_scc0 L_old3
    s_waitcnt vmcnt(4)
    s_call_b64 s[62:63], L_fp
    s_branch L_yng3
L_old3:
    s_call_b64 s[62:63], L_t23
L_yng3:
    ds_read_b128 v[4:7], v3 offset:0
    ds_read_b128 v[8:11], v3 offset:1024
    ds_read_b128 v[68:71], v3 offset:2048
    ds_read_b128 v[12:15], v3 offset:20480
    ds_read_b128 v[16:19], v3 offset:21504
    ds_read_b128 v[72:75], v3 offset:22528
    ds_read_b128 v[20:23], v3 offset:40960
    ds_read_b128 v[24:27], v3 offset:41984
    ds_read_b128 v[76:79], v3 offset:43008
    s_waitcnt vmcnt(4)
    v_mfma_i32_16x16x64_i8 v[172:175], v[122:125], v[104:107], 0
    v_mfma_i32_16x16x64_i8 v[176:179], v[122:125], v[108:111], 0
    v_mfma_i32_16x16x64_i8 v[180:183], v[122:125], v[112:115], 0
    v_and_b32 v160, 0x800080, v104
    v_mul_u32_u24 v160, 0x7f, v160
    v_bitop3_b32 v131, v104, v160, v131 bitop3:0xbe
    v_and_b32 v161, 0x800080, v105
    v_mul_u32_u24 v161, 0x7f, v161
    v_bitop3_b32 v131, v105, v161, v131 bitop3:0xbe
    v_and_b32 v160, 0x800080, v106
    v_mul_u32_u24 v160, 0x7f, v160
    v_bitop3_b32 v131, v106, v160, v131 bitop3:0xbe
    v_mov_b32_dpp v184, v172 row_shr:1 row_mask:0xf bank_mask:0xf bound_ctrl:0
    v_mov_b32_dpp v185, v176 row_shr:1 row_mask:0xf bank_mask:0xf bound_ctrl:0
    v_mov_b32_dpp v186, v180 row_shr:1 row_mask:0xf bank_mask:0xf bound_ctrl:0
    v_add_u32_dpp v184, v184, v184 row_shr:1 row_mask:0xf bank_mask:0xf bound_ctrl:0
    v_add_u32_dpp v185, v185, v185 row_shr:1 row_mask:0xf bank_mask:0xf bound_ctrl:0
    v_add_u32_dpp v186, v186, v186 row_shr:1 row_mask:0xf bank_mask:0xf bound_ctrl:0
    v_add_u32_dpp v184, v184, v184 row_shr:2 row_mask:0xf bank_mask:0xf bound_ctrl:0
    v_add_u32_dpp v185, v185, v185 row_shr:2 row_mask:0xf bank_mask:0xf bound_ctrl:0
    v_add_u32_dpp v186, v186, v186 row_shr:2 row_mask:0xf bank_mask:0xf bound_ctrl:0
    v_add_u32_dpp v184, v184, v184 row_shr:4 row_mask:0xf bank_mask:0xf bound_ctrl:0
    v_add_u32_dpp v185, v185, v185 row_shr:4 row_mask:0xf bank_mask:0xf bound_ctrl:0
    v_add_u32_dpp v186, v186, v186 row_shr:4 row_mask:0xf bank_mask:0xf bound_ctrl:0
    v_add_u32_dpp v184, v184, v184 row_shr:8 row_mask:0xf bank_mask:0xf bound_ctrl:0
    v_add_u32_dpp v185, v185, v185 row_shr:8 row_mask:0xf bank_mask:0xf bound_ctrl:0
    v_add_u32_dpp v186, v186, v186 row_shr:8 row_mask:0xf bank_mask:0xf bound_ctrl:0
    ds_read_b128 v[28:31], v3 offset:61440
    ds_read_b128 v[32:35], v3 offset:62464
    ds_read_b128 v[80:83], v3 offset:63488
    ds_read_b128 v[36:39], v246 offset:0
    ds_read_b128 v[40:43], v246 offset:1024
    ds_read_b128 v[84:87], v246 offset:2048
    v_and_b32 v161, 0x800080, v107
    v_mul_u32_u24 v161, 0x7f, v161
    v_bitop3_b32 v131, v107, v161, v131 bitop3:0xbe
    v_and_b32 v160, 0x800080, v108
    v_mul_u32_u24 v160, 0x7f, v160
    v_bitop3_b32 v131, v108, v160, v131 bitop3:0xbe
    v_and_b32 v161, 0x800080, v109
    v_mul_u32_u24 v161, 0x7f, v161
    v_bitop3_b32 v131, v109, v161, v131 bitop3:0xbe
    v_and_b32 v160, 0x800080, v110
    v_mul_u32_u24 v160, 0x7f, v160
    v_bitop3_b32 v131, v110, v160, v131 bitop3:0xbe
    v_and_b32 v161, 0x800080, v111
    v_mul_u32_u24 v161, 0x7f, v161
    v_bitop3_b32 v131, v111, v161, v131 bitop3:0xbe
    v_and_b32 v160, 0x800080, v112
    v_mul_u32_u24 v160, 0x7f, v160
    v_bitop3_b32 v131, v112, v160, v131 bitop3:0xbe
    v_and_b32 v161, 0x800080, v113
    v_mul_u32_u24 v161, 0x7f, v161
    v_bitop3_b32 v131, v113, v161, v131 bitop3:0xbe
    v_and_b32 v160, 0x800080, v114
    v_mul_u32_u24 v160, 0x7f, v160
    v_bitop3_b32 v131, v114, v160, v131 bitop3:0xbe
    v_and_b32 v161, 0x800080, v115
    v_mul_u32_u24 v161, 0x7f, v161
    v_bitop3_b32 v131, v115, v161, v131 bitop3:0xbe
    v_cmp_ne_u32 vcc, 0, v131
    v_readlane_b32 s68, v184, 6
    v_readlane_b32 s69, v173, 6
    v_readlane_b32 s70, v184, 15
    v_readlane_b32 s72, v185, 6
    v_readlane_b32 s73, v177, 6
    v_readlane_b32 s74, v185, 15
    v_readlane_b32 s76, v186, 6
    v_readlane_b32 s77, v181, 6
    v_readlane_b32 s78, v186, 15
    s_cbranch_vccnz L_general
    s_add_u32 s66, s68, s69
    s_add_u32 s66, s66, s64
    s_add_u32 s67, s66, 15
    s_and_b32 s67, s67, -16
    s_add_u32 s55, s64, 16
    s_max_u32 s67, s67, s55
    s_sub_u32 s66, s67, s66
    v_mad_u32_u24 v184, v130, s66, v184
    s_sub_u32 s55, s64, 2048
    v_add_u32 v172, s55, v184
    v_add_u32 v173, s55, v184
    v_add_u32 v174, s55, v184
    v_add_u32 v175, s55, v184
    s_add_u32 s64, s64, s70
    s_add_u32 s64, s64, s66
    v_mfma_i32_16x16x64_i8 v[132:135], v[118:121], v[104:107], v[172:175]
    v_mfma_i32_16x16x64_i8 v[136:139], v[116:119], v[104:107], v[172:175]
    s_add_u32 s64, s64, 15
    s_and_b32 s64, s64, -16
    s_add_u32 s55, s67, 16
    s_max_u32 s64, s64, s55
    s_lshr_b32 s95, s67, 4
    s_bitset1_b64 s[56:57], s95
    s_lshr_b32 s95, s64, 4
    s_bitset1_b64 s[56:57], s95
    s_add_u32 s66, s72, s73
    s_add_u32 s66, s66, s64
    s_add_u32 s67, s66, 15
    s_and_b32 s67, s67, -16
    s_add_u32 s55, s64, 16
    s_max_u32 s67, s67, s55
    s_sub_u32 s66, s67, s66
    v_mad_u32_u24 v185, v130, s66, v185
    s_sub_u32 s55, s64, 2048
    v_add_u32 v176, s55, v185
    v_add_u32 v177, s55, v185
    v_add_u32 v178, s55, v185
    v_add_u32 v179, s55, v185
    s_add_u32 s64, s64, s74
    s_add_u32 s64, s64, s66
    v_mfma_i32_16x16x64_i8 v[140:143], v[118:121], v[108:111], v[176:179]
    v_mfma_i32_16x16x64_i8 v[144:147], v[116:119], v[108:111], v[176:179]
    s_add_u32 s64, s64, 15
    s_and_b32 s64, s64, -16
    s_add_u32 s55, s67, 16
    s_max_u32 s64, s64, s55
    s_lshr_b32 s95, s67, 4
    s_lshl_b64 s[86:87], 1, s95
    s_bitcmp1_b32 s67, 10
    s_cselect_b64 s[88:89], 0, s[86:87]
    s_cselect_b64 s[90:91], s[86:87], 0
    s_or_b64 s[56:57], s[56:57], s[88:89]
    s_or_b64 s[58:59], s[58:59], s[90:91]
    s_lshr_b32 s95, s64, 4
    s_lshl_b64 s[86:87], 1, s95
    s_bitcmp1_b32 s64, 10
    s_cselect_b64 s[88:89], 0, s[86:87]
    s_cselect_b64 s[90:91], s[86:87], 0
    s_or_b64 s[56:57], s[56:57], s[88:89]
    s_or_b64 s[58:59], s[58:59], s[90:91]
    s_mov_b32 s44, s64
    ds_write_b8 v132, v126
    ds_write_b8_d16_hi v133, v126
    ds_write_b8 v134, v127
    ds_write_b8_d16_hi v135, v127
    ds_write_b8 v136, v128
    ds_write_b8_d16_hi v137, v128
    ds_write_b8 v138, v129
    ds_write_b8_d16_hi v139, v129
    s_add_u32 s66, s76, s77
    s_add_u32 s66, s66, s64
    s_add_u32 s67, s66, 15
    s_and_b32 s67, s67, -16
    s_add_u32 s55, s64, 16
    s_max_u32 s67, s67, s55
    s_sub_u32 s66, s67, s66
    v_mad_u32_u24 v186, v130, s66, v186
    s_sub_u32 s55, s64, 2048
    v_add_u32 v180, s55, v186
    v_add_u32 v181, s55, v186
    v_add_u32 v182, s55, v186
    v_add_u32 v183, s55, v186
    s_add_u32 s64, s64, s78
    s_add_u32 s64, s64, s66
    v_mfma_i32_16x16x64_i8 v[164:167], v[118:121], v[112:115], v[180:183]
    v_mfma_i32_16x16x64_i8 v[168:171], v[116:119], v[112:115], v[180:183]
    s_add_u32 s64, s64, 15
    s_and_b32 s64, s64, -16
    s_add_u32 s55, s67, 16
    s_max_u32 s64, s64, s55
    s_mov_b32 s45, s67
    s_mov_b32 s46, s64
    ds_write_b8 v140, v126
    ds_write_b8_d16_hi v141, v126
    ds_write_b8 v142, v127
    ds_write_b8_d16_hi v143, v127
    ds_write_b8 v144, v128
    ds_write_b8_d16_hi v145, v128
    ds_write_b8 v146, v129
    ds_write_b8_d16_hi v147, v129
    ds_read_b128 v[44:47], v246 offset:20480
    ds_read_b128 v[48:51], v246 offset:21504
    ds_read_b128 v[88:91], v246 offset:22528
    ds_read_b128 v[52:55], v246 offset:40960
    ds_read_b128 v[56:59], v246 offset:41984
    ds_read_b128 v[92:95], v246 offset:43008
    ds_read_b128 v[60:63], v246 offset:61440
    ds_read_b128 v[64:67], v246 offset:62464
    ds_read_b128 v[96:99], v246 offset:63488
    ds_read_u16 v224, v238 offset:0
    ds_read_u16 v225, v238 offset:8
    ds_read_u16 v226, v238 offset:64
    ds_read_u16 v227, v238 offset:72
    ds_write_b8 v164, v126
    ds_write_b8_d16_hi v165, v126
    ds_write_b8 v166, v127
    ds_write_b8_d16_hi v167, v127
    ds_write_b8 v168, v128
    ds_write_b8_d16_hi v169, v128
    ds_write_b8 v170, v129
    ds_write_b8_d16_hi v171, v129
    s_cmp_ge_u32 s54, 4
    s_cbranch_scc0 L_old3b
    s_call_b64 s[62:63], L_t23
L_old3b:
L_listed:
    s_sub_u32 s66, s46, s44
    s_or_b32 s66, s66, s54
    s_and_b32 s67, s84, 0x40000000
    s_or_b32 s66, s66, s67
    s_bitset1_b32 s66, 31
    v_mov_b32 v132, s66
    v_mov_b32 v133, s44
    v_mov_b32 v134, s45
    v_mov_b32 v135, s46
    s_mov_b64 exec, 1
    ds_write_b128 v222, v[132:135] offset:14848
    s_mov_b64 exec, -1
    s_sub_u32 s66, s64, s52
    s_sub_u32 s66, s66, 18448
    s_lshr_b32 s66, s66, 3
    s_lshr_b32 s67, s54, 2
    s_mul_i32 s67, s67, 2
    s_add_u32 s66, s66, s67
    s_sub_u32 s67, 0, s66
    v_mov_b32 v2, v221
    v_mov_b32 v1, s66
    v_mov_b32 v3, -8
    v_writelane_b32 v1, s67, 1
    v_writelane_b32 v3, 8, 1
    ds_add_u32 v2, v1
    s_cmp_eq_u32 s94, 1
    s_cbranch_scc1 L_nolate
    ds_read_u8 v148, v237 offset:0
    ds_read_u8 v149, v237 offset:8
    ds_read_u8 v150, v237 offset:16
    ds_read_u8 v151, v237 offset:24
    ds_read_u8 v152, v237 offset:32
    ds_read_u8 v153, v237 offset:40
    ds_read_u8 v154, v237 offset:48
    ds_read_u8 v155, v237 offset:56
    s_waitcnt lgkmcnt(0)
    s_add_u32 m0, s52, 0
    v_mov_b32 v230, v148
    v_mov_b32 v232, v149
    buffer_load_dwordx4 v[230:231], s[20:23], s35 idxen offen nt lds
    buffer_load_dwordx4 v[232:233], s[40:43], s35 idxen offen offset:1056 nt lds
    s_bitcmp0_b64 s[56:57], 2
    s_cbranch_scc1 L_noadvl1
    s_add_u32 s35, s35, s31
    s_min_u32 s35, s35, 419404800
    s_xor_b32 s31, s31, 0x63ff800
    s_sub_u32 s60, s60, 1
L_noadvl1:
    s_add_u32 m0, s52, 2080
    v_mov_b32 v230, v150
    v_mov_b32 v232, v151
    buffer_load_dwordx4 v[230:231], s[20:23], s35 idxen offen nt lds
    buffer_load_dwordx4 v[232:233], s[40:43], s35 idxen offen offset:1056 nt lds
    s_bitcmp0_b64 s[56:57], 3
    s_cbranch_scc1 L_noadvl2
    s_add_u32 s35, s35, s31
    s_min_u32 s35, s35, 419404800
    s_xor_b32 s31, s31, 0x63ff800
    s_sub_u32 s60, s60, 1
L_noadvl2:
    s_add_u32 m0, s52, 4160
    v_mov_b32 v230, v152
    v_mov_b32 v232, v153
    buffer_load_dwordx4 v[230:231], s[20:23], s35 idxen offen nt lds
    buffer_load_dwordx4 v[232:233], s[40:43], s35 idxen offen offset:1056 nt lds
    s_bitcmp0_b64 s[56:57], 4
    s_cbranch_scc1 L_noadvl3
    s_add_u32 s35, s35, s31
    s_min_u32 s35, s35, 419404800
    s_xor_b32 s31, s31, 0x63ff800
    s_sub_u32 s60, s60, 1
L_noadvl3:
    s_add_u32 m0, s52, 6240
    v_mov_b32 v230, v154
    v_mov_b32 v232, v155
    buffer_load_dwordx4 v[230:231], s[20:23], s35 idxen offen nt lds
    buffer_load_dwordx4 v[232:233], s[40:43], s35 idxen offen offset:1056 nt lds
L_nolate:
    v_and_b32_dpp v196, v216, v220 quad_perm:[0,0,0,0] row_mask:0xf bank_mask:0xf
    v_and_b32_dpp v197, v217, v220 quad_perm:[0,0,0,0] row_mask:0xf bank_mask:0xf
    v_and_b32_dpp v198, v216, v220 quad_perm:[1,1,1,1] row_mask:0xf bank_mask:0xf
    v_and_b32_dpp v199, v217, v220 quad_perm:[1,1,1,1] row_mask:0xf bank_mask:0xf
    v_and_b32_dpp v200, v216, v220 quad_perm:[2,2,2,2] row_mask:0xf bank_mask:0xf
    v_and_b32_dpp v201, v217, v220 quad_perm:[2,2,2,2] row_mask:0xf bank_mask:0xf
    v_and_b32_dpp v202, v216, v220 quad_perm:[3,3,3,3] row_mask:0xf bank_mask:0xf
    v_and_b32_dpp v203, v217, v220 quad_perm:[3,3,3,3] row_mask:0xf bank_mask:0xf
    s_waitcnt vmcnt(6) lgkmcnt(0)
    ds_read_b128 v[180:183], v234 offset:0
    ds_read_b128 v[184:187], v235 offset:0
    v_mul_u32_u24 v216, v224, v241
    v_mul_u32_u24 v217, v224, v242
    v_mul_u32_u24 v218, v225, v241
    v_mul_u32_u24 v219, v225, v242
    v_mul_u32_u24 v220, v226, v241
    v_mul_u32_u24 v221, v226, v242
    v_mul_u32_u24 v222, v227, v241
    v_mul_u32_u24 v223, v227, v242
    v_mfma_f32_4x4x4_16b_bf16 v[140:143], v[216:217], v[68:69], v[4:7]
    v_add_u32 v238, 128, v238
    ds_read_b128 v[164:167], v239 offset:0
    ds_read_b128 v[168:171], v239 offset:64
    v_mfma_f32_4x4x4_16b_bf16 v[144:147], v[218:219], v[70:71], v[8:11]
    ds_read_b128 v[172:175], v239 offset:128
    ds_read_b128 v[176:179], v239 offset:192
    ds_read_u16 v224, v238 offset:0
    ds_read_u16 v225, v238 offset:8
    ds_read_u16 v226, v238 offset:64
    ds_read_u16 v227, v238 offset:72
    v_mfma_f32_4x4x4_16b_bf16 v[246:249], v[220:221], v[72:73], v[12:15]
    v_cvt_pk_bf16_f32 v100, v140, v141
    v_cvt_pk_bf16_f32 v101, v142, v143
    v_mfma_f32_4x4x4_16b_bf16 v[250:253], v[222:223], v[74:75], v[16:19]
    v_cvt_pk_bf16_f32 v102, v144, v145
    v_cvt_pk_bf16_f32 v103, v146, v147
    v_mfma_f32_4x4x4_16b_bf16 v[140:143], v[216:217], v[76:77], v[20:23]
    v_cvt_pk_bf16_f32 v104, v246, v247
    v_cvt_pk_bf16_f32 v105, v248, v249
    v_mfma_f32_4x4x4_16b_bf16 v[144:147], v[218:219], v[78:79], v[24:27]
    v_cvt_pk_bf16_f32 v106, v250, v251
    v_cvt_pk_bf16_f32 v107, v252, v253
    v_mfma_f32_4x4x4_16b_bf16 v[246:249], v[220:221], v[80:81], v[28:31]
    v_cvt_pk_bf16_f32 v108, v140, v141
    v_cvt_pk_bf16_f32 v109, v142, v143
    v_mfma_f32_4x4x4_16b_bf16 v[250:253], v[222:223], v[82:83], v[32:35]
    v_cvt_pk_bf16_f32 v110, v144, v145
    v_cvt_pk_bf16_f32 v111, v146, v147
    v_mfma_f32_4x4x4_16b_bf16 v[140:143], v[216:217], v[84:85], v[36:39]
    v_cvt_pk_bf16_f32 v112, v246, v247
    v_cvt_pk_bf16_f32 v113, v248, v249
    v_mfma_f32_4x4x4_16b_bf16 v[144:147], v[218:219], v[86:87], v[40:43]
    v_cvt_pk_bf16_f32 v114, v250, v251
    v_cvt_pk_bf16_f32 v115, v252, v253
    v_mfma_f32_4x4x4_16b_bf16 v[246:249], v[220:221], v[88:89], v[44:47]
    v_cvt_pk_bf16_f32 v116, v140, v141
    v_cvt_pk_bf16_f32 v117, v142, v143
    v_mfma_f32_4x4x4_16b_bf16 v[250:253], v[222:223], v[90:91], v[48:51]
    v_cvt_pk_bf16_f32 v118, v144, v145
    v_cvt_pk_bf16_f32 v119, v146, v147
    v_mfma_f32_4x4x4_16b_bf16 v[140:143], v[216:217], v[92:93], v[52:55]
    v_cvt_pk_bf16_f32 v120, v246, v247
    v_cvt_pk_bf16_f32 v121, v248, v249
    v_mfma_f32_4x4x4_16b_bf16 v[144:147], v[218:219], v[94:95], v[56:59]
    v_cvt_pk_bf16_f32 v122, v250, v251
    v_cvt_pk_bf16_f32 v123, v252, v253
    v_mfma_f32_4x4x4_16b_bf16 v[246:249], v[220:221], v[96:97], v[60:63]
    v_cvt_pk_bf16_f32 v124, v140, v141
    v_cvt_pk_bf16_f32 v125, v142, v143
    v_mfma_f32_4x4x4_16b_bf16 v[250:253], v[222:223], v[98:99], v[64:67]
    v_cvt_pk_bf16_f32 v126, v144, v145
    v_cvt_pk_bf16_f32 v127, v146, v147
    v_cvt_pk_bf16_f32 v128, v246, v247
    v_cvt_pk_bf16_f32 v129, v248, v249
    v_add_u32 v239, 272, v239
    v_cvt_pk_bf16_f32 v130, v250, v251
    v_cvt_pk_bf16_f32 v131, v252, v253
    s_waitcnt lgkmcnt(0)
    v_mfma_f32_16x16x32_bf16 v[148:151], v[100:103], v[180:183], v[164:167]
    v_mfma_f32_16x16x32_bf16 v[148:151], v[104:107], v[184:187], v[148:151]
    v_mfma_f32_16x16x32_bf16 v[152:155], v[108:111], v[180:183], v[168:171]
    v_mfma_f32_16x16x32_bf16 v[152:155], v[112:115], v[184:187], v[152:155]
    v_mfma_f32_16x16x32_bf16 v[156:159], v[116:119], v[180:183], v[172:175]
    v_mfma_f32_16x16x32_bf16 v[156:159], v[120:123], v[184:187], v[156:159]
    v_mfma_f32_16x16x32_bf16 v[160:163], v[124:127], v[180:183], v[176:179]
    v_mfma_f32_16x16x32_bf16 v[160:163], v[128:131], v[184:187], v[160:163]
    v_mov_b32 v136, 0
    v_mov_b32 v137, 0
    v_mov_b32 v138, 0
    v_mov_b32 v139, 0
    s_lshr_b64 s[86:87], s[56:57], 2
    s_lshr_b64 s[36:37], s[56:57], 5
    s_or_b32 s36, s36, s86
    s_or_b32 s36, s36, s56
    s_cmp_lg_u64 s[84:85], 0
    s_cbranch_scc0 Lf_mid
    s_mul_i32 s66, s53, 800
    s_add_u32 s8, s8, s66
    s_addc_u32 s9, s9, 0
    s_mov_b32 s24, s8
    s_and_b32 s25, s9, 0xffff
    s_mov_b32 s26, 400
    s_mov_b32 s27, 0x20000
    s_movk_i32 s32, 400
    s_branch Ls_mid
L_fp:
    v_mfma_i32_16x16x64_i8 v[172:175], v[122:125], v[100:103], 0
    v_and_b32 v160, 0x800080, v100
    v_mul_u32_u24 v160, 0x7f, v160
    v_bitop3_b32 v131, v100, v160, v131 bitop3:0xbe
    v_and_b32 v161, 0x800080, v101
    v_mul_u32_u24 v161, 0x7f, v161
    v_bitop3_b32 v131, v101, v161, v131 bitop3:0xbe
    v_and_b32 v160, 0x800080, v102
    v_mul_u32_u24 v160, 0x7f, v160
    v_mov_b32_dpp v184, v172 row_shr:1 row_mask:0xf bank_mask:0xf bound_ctrl:0
    v_bitop3_b32 v131, v102, v160, v131 bitop3:0xbe
    s_nop 0
    v_add_u32_dpp v184, v184, v184 row_shr:1 row_mask:0xf bank_mask:0xf bound_ctrl:0
    v_and_b32 v161, 0x800080, v103
    s_nop 0
    v_add_u32_dpp v184, v184, v184 row_shr:2 row_mask:0xf bank_mask:0xf bound_ctrl:0
    v_mul_u32_u24 v161, 0x7f, v161
    s_nop 0
    v_add_u32_dpp v184, v184, v184 row_shr:4 row_mask:0xf bank_mask:0xf bound_ctrl:0
    v_bitop3_b32 v131, v103, v161, v131 bitop3:0xbe
    s_nop 0
    v_add_u32_dpp v184, v184, v184 row_shr:8 row_mask:0xf bank_mask:0xf bound_ctrl:0
    v_cmp_ne_u32 vcc, 0, v131
    v_readlane_b32 s68, v184, 6
    v_readlane_b32 s69, v173, 6
    v_readlane_b32 s70, v184, 15
    s_mov_b32 s94, 0
    s_cbranch_vccnz L_late
    s_add_u32 s66, s68, s69
    s_add_u32 s66, s66, s64
    s_add_u32 s67, s66, 15
    s_and_b32 s67, s67, -16
    s_add_u32 s55, s64, 16
    s_max_u32 s67, s67, s55
    s_sub_u32 s66, s67, s66
    v_mad_u32_u24 v184, v130, s66, v184
    s_sub_u32 s55, s64, 2048
    v_add_u32 v172, s55, v184
    v_add_u32 v173, s55, v184
    v_add_u32 v174, s55, v184
    v_add_u32 v175, s55, v184
    s_add_u32 s64, s64, s70
    s_add_u32 s64, s64, s66
    v_mfma_i32_16x16x64_i8 v[132:135], v[118:121], v[100:103], v[172:175]
    v_mfma_i32_16x16x64_i8 v[136:139], v[116:119], v[100:103], v[172:175]
    s_add_u32 s64, s64, 15
    s_and_b32 s64, s64, -16
    s_add_u32 s55, s67, 16
    s_max_u32 s64, s64, s55
    s_lshr_b32 s95, s67, 4
    s_bitset1_b64 s[56:57], s95
    s_lshr_b32 s95, s64, 4
    s_bitset1_b64 s[56:57], s95
    s_add_u32 s66, s52, 18512
    s_cmp_ge_u32 s64, s66
    ds_write_b8 v132, v126
    ds_write_b8_d16_hi v133, v126
    ds_write_b8 v134, v127
    ds_write_b8_d16_hi v135, v127
    ds_write_b8 v136, v128
    ds_write_b8_d16_hi v137, v128
    ds_write_b8 v138, v129
    ds_write_b8_d16_hi v139, v129
    s_cbranch_scc0 L_late
    s_mov_b32 s94, 1
    ds_read_u8 v148, v237 offset:0
    ds_read_u8 v149, v237 offset:8
    ds_read_u8 v150, v237 offset:16
    ds_read_u8 v151, v237 offset:24
    ds_read_u8 v152, v237 offset:32
    ds_read_u8 v153, v237 offset:40
    ds_read_u8 v154, v237 offset:48
    ds_read_u8 v155, v237 offset:56
    s_waitcnt lgkmcnt(0)
    s_add_u32 m0, s52, 0
    v_mov_b32 v230, v148
    v_mov_b32 v232, v149
    buffer_load_dwordx4 v[230:231], s[20:23], s35 idxen offen nt lds
    buffer_load_dwordx4 v[232:233], s[40:43], s35 idxen offen offset:1056 nt lds
    s_bitcmp0_b64 s[56:57], 2
    s_cbranch_scc1 L_noadve1
    s_add_u32 s35, s35, s31
    s_min_u32 s35, s35, 419404800
    s_xor_b32 s31, s31, 0x63ff800
    s_sub_u32 s60, s60, 1
L_noadve1:
    s_add_u32 m0, s52, 2080
    v_mov_b32 v230, v150
    v_mov_b32 v232, v151
    buffer_load_dwordx4 v[230:231], s[20:23], s35 idxen offen nt lds
    buffer_load_dwordx4 v[232:233], s[40:43], s35 idxen offen offset:1056 nt lds
    s_setpc_b64 s[62:63]
L_late:
    s_waitcnt vmcnt(0)
    s_setpc_b64 s[62:63]
L_swap:
    v_lshrrev_b32 v140, 3, v0
    v_and_b32 v141, 7, v0
    v_mul_u32_u24 v140, 20480, v140
    v_mul_u32_u24 v141, 20480, v141
    v_mov_b32 v143, 1
    s_mov_b64 exec, 1
    ds_add_rtn_u32 v143, v140, v143 offset:14864
    s_mov_b64 exec, -1
L_swap_poll:
    ds_read_b32 v142, v141 offset:14848
    ds_read_b128 v[144:147], v140 offset:14848
    v_and_b32 v248, 56, v0
    s_waitcnt lgkmcnt(0)
    v_cmp_le_i32 vcc, 0, v142
    v_cmp_gt_u32 s[86:87], v142, v144
    v_lshlrev_b32 v249, 1, v142
    v_readfirstlane_b32 s66, v143
    s_cbranch_vccnz L_swap_poll
    v_lshrrev_b64 v[246:247], v248, s[86:87]
    v_cmp_gt_i32 s[88:89], 0, v249
    v_and_b32 v246, 0xff, v246
    v_bcnt_u32_b32 v246, v246, 0
    v_cmp_eq_u32 vcc, s66, v246
    s_lshl_b32 s67, s54, 3
    s_ff1_i32_b64 s66, vcc
    s_cmp_lg_u64 s[88:89], 0
    s_cselect_b32 s66, s67, s66
    s_sub_u32 s95, s66, s67
    v_readlane_b32 s67, v146, s66
    v_readlane_b32 s55, v147, s66
    v_readlane_b32 s66, v145, s66
    s_mul_i32 s47, s95, 2560
    s_lshl_b32 s50, s95, 5
    s_mul_i32 s95, s95, 6400
    s_add_u32 s35, s35, s95
    s_mov_b32 s60, 8
    s_sub_u32 s44, s66, s44
    v_add_u32 v237, s44, v237
    s_sub_u32 s46, s55, s46
    s_sub_u32 s46, s46, s44
    s_sub_u32 s67, s67, s66
    s_lshr_b32 s67, s67, 4
    s_add_u32 s67, s67, s49
    s_bitset1_b64 s[56:57], s67
    s_sub_u32 s55, s55, s66
    s_lshr_b32 s55, s55, 4
    s_add_u32 s55, s55, s49
    s_bitset1_b64 s[56:57], s55
    s_lshr_b64 s[86:87], s[56:57], 2
    s_lshr_b64 s[36:37], s[56:57], 5
    s_or_b32 s36, s36, s86
    s_or_b32 s36, s36, s56
    s_ashr_i32 s46, s46, 3
    v_mov_b32 v140, s46
    s_sub_u32 s46, 0, s46
    v_writelane_b32 v140, s46, 1
    ds_add_u32 v2, v140
    s_cmp_lg_u32 s61, 2
    s_cselect_b32 s45, 1, -1
    s_cbranch_scc1 L_swap_ret
    v_add_u32 v238, s47, v238
    v_add_u32 v239, s47, v239
    ds_read_u16 v224, v238 offset:0
    ds_read_u16 v225, v238 offset:8
    ds_read_u16 v226, v238 offset:64
    ds_read_u16 v227, v238 offset:72
L_swap_ret:
    s_setpc_b64 s[62:63]
L_t23:
    s_cmp_eq_u32 s94, 0
    s_cbranch_scc1 L_skip23
    s_bitcmp0_b64 s[56:57], 3
    s_cbranch_scc1 L_noadve2
    s_add_u32 s35, s35, s31
    s_min_u32 s35, s35, 419404800
    s_xor_b32 s31, s31, 0x63ff800
    s_sub_u32 s60, s60, 1
L_noadve2:
    s_add_u32 m0, s52, 4160
    v_mov_b32 v230, v152
    v_mov_b32 v232, v153
    buffer_load_dwordx4 v[230:231], s[20:23], s35 idxen offen nt lds
    buffer_load_dwordx4 v[232:233], s[40:43], s35 idxen offen offset:1056 nt lds
    s_bitcmp0_b64 s[56:57], 4
    s_cbranch_scc1 L_noadve3
    s_add_u32 s35, s35, s31
    s_min_u32 s35, s35, 419404800
    s_xor_b32 s31, s31, 0x63ff800
    s_sub_u32 s60, s60, 1
L_noadve3:
    s_add_u32 m0, s52, 6240
    v_mov_b32 v230, v154
    v_mov_b32 v232, v155
    buffer_load_dwordx4 v[230:231], s[20:23], s35 idxen offen nt lds
    buffer_load_dwordx4 v[232:233], s[40:43], s35 idxen offen offset:1056 nt lds
    s_setpc_b64 s[62:63]
L_skip23:
    s_waitcnt vmcnt(0)
    s_setpc_b64 s[62:63]
.p2align 6
Lf_loop:
Lf_mid:
    s_bitcmp1_b32 s36, 0
    s_cbranch_scc1 Lf_ev0
Lf_evd0:
    v_mfma_f32_16x16x32_bf16 v[208:211], v[136:139], v[200:203], v[208:211]
    v_exp_f32 v132, v148
    v_exp_f32 v133, v149
    v_exp_f32 v134, v150
    v_exp_f32 v135, v151
    v_exp_f32 v136, v152
    v_exp_f32 v137, v153
    v_mfma_f32_4x4x4_16b_bf16 v[132:135], v[228:229], v[228:229], v[132:135]
    v_exp_f32 v138, v154
    v_exp_f32 v139, v155
    v_cvt_pk_bf16_f32 v208, v208, v209
    v_cvt_pk_bf16_f32 v209, v210, v211
    v_exp_f32 v140, v156
    v_exp_f32 v141, v157
    v_mfma_f32_4x4x4_16b_bf16 v[212:215], v[208:209], v[188:189], v[212:215] cbsz:4 abid:0
    v_mfma_f32_4x4x4_16b_bf16 v[136:139], v[228:229], v[228:229], v[136:139]
    v_exp_f32 v142, v158
    v_mfma_f32_4x4x4_16b_bf16 v[212:215], v[208:209], v[190:191], v[212:215] cbsz:4 abid:4
    v_exp_f32 v143, v159
    v_exp_f32 v144, v160
    v_mfma_f32_4x4x4_16b_bf16 v[212:215], v[208:209], v[192:193], v[212:215] cbsz:4 abid:8
    v_exp_f32 v145, v161
    v_mfma_f32_4x4x4_16b_bf16 v[140:143], v[228:229], v[228:229], v[140:143]
    v_mfma_f32_4x4x4_16b_bf16 v[212:215], v[208:209], v[194:195], v[212:215] cbsz:4 abid:12
    ds_add_rtn_u32 v1, v2, v3
    ds_read_u8 v230, v237 offset:64
    ds_read_u8 v232, v237 offset:72
    ds_read_b64_tr_b16 v[188:189], v236 offset:0
    ds_read_b64_tr_b16 v[190:191], v236 offset:512
    ds_read_b64_tr_b16 v[192:193], v236 offset:1056
    ds_read_b64_tr_b16 v[194:195], v236 offset:1568
    s_waitcnt vmcnt(4)
    ds_read_b128 v[180:183], v234 offset:2080
    ds_read_b128 v[184:187], v235 offset:2080
    s_add_u32 m0, s52, 0
    v_exp_f32 v146, v162
    v_exp_f32 v147, v163
    v_rcp_f32 v132, v132
    v_rcp_f32 v133, v133
    v_mfma_f32_4x4x4_16b_bf16 v[144:147], v[228:229], v[228:229], v[144:147]
    v_rcp_f32 v134, v134
    v_cvt_pk_bf16_f32 v132, v132, v133
    s_waitcnt lgkmcnt(2)
    buffer_load_dwordx4 v[230:231], s[20:23], s35 idxen offen nt lds
    buffer_load_dwordx4 v[232:233], s[40:43], s35 idxen offen offset:1056 nt lds
    s_waitcnt lgkmcnt(0)
    v_mfma_f32_16x16x32_bf16 v[148:151], v[100:103], v[180:183], v[164:167]
    v_rcp_f32 v135, v135
    v_mfma_f32_16x16x32_bf16 v[152:155], v[108:111], v[180:183], v[168:171]
    v_rcp_f32 v136, v136
    v_cvt_pk_bf16_f32 v133, v134, v135
    v_mfma_f32_16x16x32_bf16 v[148:151], v[104:107], v[184:187], v[148:151]
    v_rcp_f32 v137, v137
    v_readfirstlane_b32 s66, v1
    s_setprio 0
    s_cmp_gt_i32 s66, 0
    s_cbranch_scc0 Lf_lo0
    s_setprio 1
Lf_lo0:
    v_mfma_f32_16x16x32_bf16 v[152:155], v[112:115], v[184:187], v[152:155]
    v_rcp_f32 v138, v138
    v_cvt_pk_bf16_f32 v134, v136, v137
    v_mfma_f32_16x16x32_bf16 v[156:159], v[116:119], v[180:183], v[172:175]
    v_rcp_f32 v139, v139
    v_mfma_f32_16x16x32_bf16 v[160:163], v[124:127], v[180:183], v[176:179]
    v_rcp_f32 v140, v140
    v_cvt_pk_bf16_f32 v135, v138, v139
    v_mfma_f32_16x16x32_bf16 v[156:159], v[120:123], v[184:187], v[156:159]
    v_rcp_f32 v141, v141
    v_mfma_f32_16x16x32_bf16 v[160:163], v[128:131], v[184:187], v[160:163]
    v_rcp_f32 v142, v142
    v_cvt_pk_bf16_f32 v136, v140, v141
    v_mfma_f32_16x16x32_bf16 v[208:211], v[132:135], v[196:199], v[204:207]
    v_rcp_f32 v143, v143
    v_rcp_f32 v144, v144
    v_cvt_pk_bf16_f32 v137, v142, v143
    v_rcp_f32 v145, v145
    v_rcp_f32 v146, v146
    v_rcp_f32 v147, v147
    v_cvt_pk_bf16_f32 v138, v144, v145
    v_cvt_pk_bf16_f32 v139, v146, v147
    s_bitcmp1_b32 s36, 1
    s_cbranch_scc1 Lf_ev1
Lf_evd1:
    v_mfma_f32_16x16x32_bf16 v[208:211], v[136:139], v[200:203], v[208:211]
    v_exp_f32 v132, v148
    v_exp_f32 v133, v149
    v_exp_f32 v134, v150
    v_exp_f32 v135, v151
    v_exp_f32 v136, v152
    v_exp_f32 v137, v153
    v_mfma_f32_4x4x4_16b_bf16 v[132:135], v[228:229], v[228:229], v[132:135]
    v_exp_f32 v138, v154
    v_exp_f32 v139, v155
    v_cvt_pk_bf16_f32 v208, v208, v209
    v_cvt_pk_bf16_f32 v209, v210, v211
    v_exp_f32 v140, v156
    v_exp_f32 v141, v157
    v_mfma_f32_4x4x4_16b_bf16 v[212:215], v[208:209], v[188:189], v[212:215] cbsz:4 abid:0
    v_mfma_f32_4x4x4_16b_bf16 v[136:139], v[228:229], v[228:229], v[136:139]
    v_exp_f32 v142, v158
    v_mfma_f32_4x4x4_16b_bf16 v[212:215], v[208:209], v[190:191], v[212:215] cbsz:4 abid:4
    v_exp_f32 v143, v159
    v_exp_f32 v144, v160
    v_mfma_f32_4x4x4_16b_bf16 v[212:215], v[208:209], v[192:193], v[212:215] cbsz:4 abid:8
    v_exp_f32 v145, v161
    v_mfma_f32_4x4x4_16b_bf16 v[140:143], v[228:229], v[228:229], v[140:143]
    v_mfma_f32_4x4x4_16b_bf16 v[212:215], v[208:209], v[194:195], v[212:215] cbsz:4 abid:12
    ds_read_u8 v230, v237 offset:80
    ds_read_u8 v232, v237 offset:88
    ds_read_b64_tr_b16 v[188:189], v236 offset:2080
    ds_read_b64_tr_b16 v[190:191], v236 offset:2592
    ds_read_b64_tr_b16 v[192:193], v236 offset:3136
    ds_read_b64_tr_b16 v[194:195], v236 offset:3648
    s_waitcnt vmcnt(4)
    ds_read_b128 v[180:183], v234 offset:4160
    ds_read_b128 v[184:187], v235 offset:4160
    s_add_u32 m0, s52, 2080
    v_exp_f32 v146, v162
    v_exp_f32 v147, v163
    v_rcp_f32 v132, v132
    v_rcp_f32 v133, v133
    v_mfma_f32_4x4x4_16b_bf16 v[144:147], v[228:229], v[228:229], v[144:147]
    v_rcp_f32 v134, v134
    v_cvt_pk_bf16_f32 v132, v132, v133
    s_waitcnt lgkmcnt(2)
    buffer_load_dwordx4 v[230:231], s[20:23], s35 idxen offen nt lds
    buffer_load_dwordx4 v[232:233], s[40:43], s35 idxen offen offset:1056 nt lds
    s_waitcnt lgkmcnt(0)
    v_mfma_f32_16x16x32_bf16 v[148:151], v[100:103], v[180:183], v[164:167]
    v_rcp_f32 v135, v135
    v_mfma_f32_16x16x32_bf16 v[152:155], v[108:111], v[180:183], v[168:171]
    v_rcp_f32 v136, v136
    v_cvt_pk_bf16_f32 v133, v134, v135
    v_mfma_f32_16x16x32_bf16 v[148:151], v[104:107], v[184:187], v[148:151]
    v_rcp_f32 v137, v137
    v_mfma_f32_16x16x32_bf16 v[152:155], v[112:115], v[184:187], v[152:155]
    v_rcp_f32 v138, v138
    v_cvt_pk_bf16_f32 v134, v136, v137
    v_mfma_f32_16x16x32_bf16 v[156:159], v[116:119], v[180:183], v[172:175]
    v_rcp_f32 v139, v139
    v_mfma_f32_16x16x32_bf16 v[160:163], v[124:127], v[180:183], v[176:179]
    v_rcp_f32 v140, v140
    v_cvt_pk_bf16_f32 v135, v138, v139
    v_mfma_f32_16x16x32_bf16 v[156:159], v[120:123], v[184:187], v[156:159]
    v_rcp_f32 v141, v141
    v_mfma_f32_16x16x32_bf16 v[160:163], v[128:131], v[184:187], v[160:163]
    v_rcp_f32 v142, v142
    v_cvt_pk_bf16_f32 v136, v140, v141
    v_mfma_f32_16x16x32_bf16 v[208:211], v[132:135], v[196:199], v[204:207]
    v_rcp_f32 v143, v143
    v_rcp_f32 v144, v144
    v_cvt_pk_bf16_f32 v137, v142, v143
    v_rcp_f32 v145, v145
    v_rcp_f32 v146, v146
    v_rcp_f32 v147, v147
    v_cvt_pk_bf16_f32 v138, v144, v145
    v_cvt_pk_bf16_f32 v139, v146, v147
    s_bitcmp1_b32 s36, 2
    s_cbranch_scc1 Lf_ev2
Lf_evd2:
    v_mfma_f32_16x16x32_bf16 v[208:211], v[136:139], v[200:203], v[208:211]
    v_exp_f32 v132, v148
    v_exp_f32 v133, v149
    v_exp_f32 v134, v150
    v_exp_f32 v135, v151
    v_exp_f32 v136, v152
    v_exp_f32 v137, v153
    v_mfma_f32_4x4x4_16b_bf16 v[132:135], v[228:229], v[228:229], v[132:135]
    v_exp_f32 v138, v154
    v_exp_f32 v139, v155
    v_cvt_pk_bf16_f32 v208, v208, v209
    v_cvt_pk_bf16_f32 v209, v210, v211
    v_exp_f32 v140, v156
    v_exp_f32 v141, v157
    v_mfma_f32_4x4x4_16b_bf16 v[212:215], v[208:209], v[188:189], v[212:215] cbsz:4 abid:0
    v_mfma_f32_4x4x4_16b_bf16 v[136:139], v[228:229], v[228:229], v[136:139]
    v_exp_f32 v142, v158
    v_mfma_f32_4x4x4_16b_bf16 v[212:215], v[208:209], v[190:191], v[212:215] cbsz:4 abid:4
    v_exp_f32 v143, v159
    v_exp_f32 v144, v160
    v_mfma_f32_4x4x4_16b_bf16 v[212:215], v[208:209], v[192:193], v[212:215] cbsz:4 abid:8
    v_exp_f32 v145, v161
    v_mfma_f32_4x4x4_16b_bf16 v[140:143], v[228:229], v[228:229], v[140:143]
    v_mfma_f32_4x4x4_16b_bf16 v[212:215], v[208:209], v[194:195], v[212:215] cbsz:4 abid:12
    ds_read_u8 v230, v237 offset:96
    ds_read_u8 v232, v237 offset:104
    ds_read_b64_tr_b16 v[188:189], v236 offset:4160
    ds_read_b64_tr_b16 v[190:191], v236 offset:4672
    ds_read_b64_tr_b16 v[192:193], v236 offset:5216
    ds_read_b64_tr_b16 v[194:195], v236 offset:5728
    s_waitcnt vmcnt(4)
    ds_read_b128 v[180:183], v234 offset:6240
    ds_read_b128 v[184:187], v235 offset:6240
    s_add_u32 m0, s52, 4160
    v_exp_f32 v146, v162
    v_exp_f32 v147, v163
    v_rcp_f32 v132, v132
    v_rcp_f32 v133, v133
    v_mfma_f32_4x4x4_16b_bf16 v[144:147], v[228:229], v[228:229], v[144:147]
    v_rcp_f32 v134, v134
    v_cvt_pk_bf16_f32 v132, v132, v133
    s_waitcnt lgkmcnt(2)
    buffer_load_dwordx4 v[230:231], s[20:23], s35 idxen offen nt lds
    buffer_load_dwordx4 v[232:233], s[40:43], s35 idxen offen offset:1056 nt lds
    s_waitcnt lgkmcnt(0)
    v_mfma_f32_16x16x32_bf16 v[148:151], v[100:103], v[180:183], v[164:167]
    v_rcp_f32 v135, v135
    v_mfma_f32_16x16x32_bf16 v[152:155], v[108:111], v[180:183], v[168:171]
    v_rcp_f32 v136, v136
    v_cvt_pk_bf16_f32 v133, v134, v135
    v_mfma_f32_16x16x32_bf16 v[148:151], v[104:107], v[184:187], v[148:151]
    v_rcp_f32 v137, v137
    v_mfma_f32_16x16x32_bf16 v[152:155], v[112:115], v[184:187], v[152:155]
    v_rcp_f32 v138, v138
    v_cvt_pk_bf16_f32 v134, v136, v137
    v_mfma_f32_16x16x32_bf16 v[156:159], v[116:119], v[180:183], v[172:175]
    v_rcp_f32 v139, v139
    v_mfma_f32_16x16x32_bf16 v[160:163], v[124:127], v[180:183], v[176:179]
    v_rcp_f32 v140, v140
    v_cvt_pk_bf16_f32 v135, v138, v139
    v_mfma_f32_16x16x32_bf16 v[156:159], v[120:123], v[184:187], v[156:159]
    v_rcp_f32 v141, v141
    v_mfma_f32_16x16x32_bf16 v[160:163], v[128:131], v[184:187], v[160:163]
    v_rcp_f32 v142, v142
    v_cvt_pk_bf16_f32 v136, v140, v141
    v_mfma_f32_16x16x32_bf16 v[208:211], v[132:135], v[196:199], v[204:207]
    v_rcp_f32 v143, v143
    v_rcp_f32 v144, v144
    v_cvt_pk_bf16_f32 v137, v142, v143
    v_rcp_f32 v145, v145
    v_rcp_f32 v146, v146
    v_rcp_f32 v147, v147
    v_cvt_pk_bf16_f32 v138, v144, v145
    v_cvt_pk_bf16_f32 v139, v146, v147
    s_bitcmp1_b32 s36, 3
    s_cbranch_scc1 Lf_ev3
Lf_evd3:
    v_mfma_f32_16x16x32_bf16 v[208:211], v[136:139], v[200:203], v[208:211]
    v_exp_f32 v132, v148
    v_exp_f32 v133, v149
    v_exp_f32 v134, v150
    v_exp_f32 v135, v151
    v_exp_f32 v136, v152
    v_exp_f32 v137, v153
    v_mfma_f32_4x4x4_16b_bf16 v[132:135], v[228:229], v[228:229], v[132:135]
    v_exp_f32 v138, v154
    v_exp_f32 v139, v155
    v_cvt_pk_bf16_f32 v208, v208, v209
    v_cvt_pk_bf16_f32 v209, v210, v211
    v_exp_f32 v140, v156
    v_exp_f32 v141, v157
    v_mfma_f32_4x4x4_16b_bf16 v[212:215], v[208:209], v[188:189], v[212:215] cbsz:4 abid:0
    v_mfma_f32_4x4x4_16b_bf16 v[136:139], v[228:229], v[228:229], v[136:139]
    v_exp_f32 v142, v158
    v_mfma_f32_4x4x4_16b_bf16 v[212:215], v[208:209], v[190:191], v[212:215] cbsz:4 abid:4
    v_exp_f32 v143, v159
    v_exp_f32 v144, v160
    v_mfma_f32_4x4x4_16b_bf16 v[212:215], v[208:209], v[192:193], v[212:215] cbsz:4 abid:8
    v_exp_f32 v145, v161
    v_mfma_f32_4x4x4_16b_bf16 v[140:143], v[228:229], v[228:229], v[140:143]
    v_mfma_f32_4x4x4_16b_bf16 v[212:215], v[208:209], v[194:195], v[212:215] cbsz:4 abid:12
    ds_read_u8 v230, v237 offset:112
    ds_read_u8 v232, v237 offset:120
    ds_read_b64_tr_b16 v[188:189], v236 offset:6240
    ds_read_b64_tr_b16 v[190:191], v236 offset:6752
    ds_read_b64_tr_b16 v[192:193], v236 offset:7296
    ds_read_b64_tr_b16 v[194:195], v236 offset:7808
    s_waitcnt vmcnt(4)
    ds_read_b128 v[180:183], v234 offset:0
    ds_read_b128 v[184:187], v235 offset:0
    s_add_u32 m0, s52, 6240
    v_exp_f32 v146, v162
    v_exp_f32 v147, v163
    v_rcp_f32 v132, v132
    v_rcp_f32 v133, v133
    v_mfma_f32_4x4x4_16b_bf16 v[144:147], v[228:229], v[228:229], v[144:147]
    v_rcp_f32 v134, v134
    v_cvt_pk_bf16_f32 v132, v132, v133
    s_waitcnt lgkmcnt(2)
    buffer_load_dwordx4 v[230:231], s[20:23], s35 idxen offen nt lds
    buffer_load_dwordx4 v[232:233], s[40:43], s35 idxen offen offset:1056 nt lds
    s_waitcnt lgkmcnt(0)
    v_mfma_f32_16x16x32_bf16 v[148:151], v[100:103], v[180:183], v[164:167]
    v_rcp_f32 v135, v135
    v_mfma_f32_16x16x32_bf16 v[152:155], v[108:111], v[180:183], v[168:171]
    v_rcp_f32 v136, v136
    v_cvt_pk_bf16_f32 v133, v134, v135
    v_mfma_f32_16x16x32_bf16 v[148:151], v[104:107], v[184:187], v[148:151]
    v_rcp_f32 v137, v137
    v_mfma_f32_16x16x32_bf16 v[152:155], v[112:115], v[184:187], v[152:155]
    v_rcp_f32 v138, v138
    v_cvt_pk_bf16_f32 v134, v136, v137
    v_mfma_f32_16x16x32_bf16 v[156:159], v[116:119], v[180:183], v[172:175]
    v_rcp_f32 v139, v139
    v_mfma_f32_16x16x32_bf16 v[160:163], v[124:127], v[180:183], v[176:179]
    v_rcp_f32 v140, v140
    v_cvt_pk_bf16_f32 v135, v138, v139
    v_mfma_f32_16x16x32_bf16 v[156:159], v[120:123], v[184:187], v[156:159]
    v_rcp_f32 v141, v141
    v_mfma_f32_16x16x32_bf16 v[160:163], v[128:131], v[184:187], v[160:163]
    v_rcp_f32 v142, v142
    v_cvt_pk_bf16_f32 v136, v140, v141
    v_mfma_f32_16x16x32_bf16 v[208:211], v[132:135], v[196:199], v[204:207]
    v_rcp_f32 v143, v143
    v_rcp_f32 v144, v144
    v_cvt_pk_bf16_f32 v137, v142, v143
    s_lshr_b64 s[56:57], s[56:57], 4
    s_lshl_b64 s[86:87], s[58:59], 60
    s_or_b64 s[56:57], s[56:57], s[86:87]
    s_lshr_b64 s[58:59], s[58:59], 4
    s_lshr_b64 s[86:87], s[56:57], 2
    s_lshr_b64 s[36:37], s[56:57], 5
    s_or_b32 s36, s36, s86
    s_or_b32 s36, s36, s56
    v_add_u32 v237, 64, v237
    v_rcp_f32 v145, v145
    v_rcp_f32 v146, v146
    v_rcp_f32 v147, v147
    v_cvt_pk_bf16_f32 v138, v144, v145
    v_cvt_pk_bf16_f32 v139, v146, v147
    s_branch Lf_loop
Lf_ev0:
    s_bitcmp0_b64 s[56:57], 0
    s_cbranch_scc1 Lf_nf0
    v_cvt_pk_bf16_f32 v246, v212, v212
    v_mov_b32 v212, 0
    ds_write_b16 v240, v246
    v_add_u32 v240, 128, v240
Lf_nf0:
    s_bitcmp0_b64 s[56:57], 5
    s_cbranch_scc1 Lf_na0
    s_sub_u32 s60, s60, 1
    s_cbranch_scc0 Lf_ns0
    s_mov_b32 s49, 5
    s_call_b64 s[62:63], L_swap
    s_add_u32 s35, s35, s31
    s_min_u32 s35, s35, 419404800
    s_xor_b32 s31, s31, 0x63ff800
    s_bitcmp0_b64 s[56:57], 2
    s_cbranch_scc1 Lf_evd0
    s_waitcnt lgkmcnt(0)
    s_branch Lf_e10
Lf_ns0:
    s_add_u32 s35, s35, s31
    s_min_u32 s35, s35, 419404800
    s_xor_b32 s31, s31, 0x63ff800
Lf_na0:
    s_bitcmp0_b64 s[56:57], 2
    s_cbranch_scc1 Lf_evd0
Lf_e10:
    s_sub_u32 s61, s61, 1
    s_cbranch_scc1 Lf_last0
    s_cmp_lg_u32 s61, s45
    s_cbranch_scc1 Lf_nw0
    v_add_u32 v238, s47, v238
    v_add_u32 v239, s47, v239
    ds_read_u16 v224, v238 offset:0
    ds_read_u16 v225, v238 offset:8
    ds_read_u16 v226, v238 offset:64
    ds_read_u16 v227, v238 offset:72
    s_waitcnt lgkmcnt(0)
Lf_nw0:
    v_mul_u32_u24 v216, v224, v241
    v_mul_u32_u24 v217, v224, v242
    v_mul_u32_u24 v218, v225, v241
    v_mul_u32_u24 v219, v225, v242
    v_mul_u32_u24 v220, v226, v241
    v_mul_u32_u24 v221, v226, v242
    v_mul_u32_u24 v222, v227, v241
    v_mul_u32_u24 v223, v227, v242
    v_mfma_f32_4x4x4_16b_bf16 v[140:143], v[216:217], v[68:69], v[4:7]
    v_add_u32 v238, 128, v238
    ds_read_b128 v[164:167], v239 offset:0
    ds_read_b128 v[168:171], v239 offset:64
    v_mfma_f32_4x4x4_16b_bf16 v[144:147], v[218:219], v[70:71], v[8:11]
    ds_read_b128 v[172:175], v239 offset:128
    ds_read_b128 v[176:179], v239 offset:192
    ds_read_u16 v224, v238 offset:0
    ds_read_u16 v225, v238 offset:8
    ds_read_u16 v226, v238 offset:64
    ds_read_u16 v227, v238 offset:72
    v_mfma_f32_4x4x4_16b_bf16 v[246:249], v[220:221], v[72:73], v[12:15]
    v_cvt_pk_bf16_f32 v100, v140, v141
    v_cvt_pk_bf16_f32 v101, v142, v143
    v_mfma_f32_4x4x4_16b_bf16 v[250:253], v[222:223], v[74:75], v[16:19]
    v_cvt_pk_bf16_f32 v102, v144, v145
    v_cvt_pk_bf16_f32 v103, v146, v147
    v_mfma_f32_4x4x4_16b_bf16 v[140:143], v[216:217], v[76:77], v[20:23]
    v_cvt_pk_bf16_f32 v104, v246, v247
    v_cvt_pk_bf16_f32 v105, v248, v249
    v_mfma_f32_4x4x4_16b_bf16 v[144:147], v[218:219], v[78:79], v[24:27]
    v_cvt_pk_bf16_f32 v106, v250, v251
    v_cvt_pk_bf16_f32 v107, v252, v253
    v_mfma_f32_4x4x4_16b_bf16 v[246:249], v[220:221], v[80:81], v[28:31]
    v_cvt_pk_bf16_f32 v108, v140, v141
    v_cvt_pk_bf16_f32 v109, v142, v143
    v_mfma_f32_4x4x4_16b_bf16 v[250:253], v[222:223], v[82:83], v[32:35]
    v_cvt_pk_bf16_f32 v110, v144, v145
    v_cvt_pk_bf16_f32 v111, v146, v147
    v_mfma_f32_4x4x4_16b_bf16 v[140:143], v[216:217], v[84:85], v[36:39]
    v_cvt_pk_bf16_f32 v112, v246, v247
    v_cvt_pk_bf16_f32 v113, v248, v249
    v_mfma_f32_4x4x4_16b_bf16 v[144:147], v[218:219], v[86:87], v[40:43]
    v_cvt_pk_bf16_f32 v114, v250, v251
    v_cvt_pk_bf16_f32 v115, v252, v253
    v_mfma_f32_4x4x4_16b_bf16 v[246:249], v[220:221], v[88:89], v[44:47]
    v_cvt_pk_bf16_f32 v116, v140, v141
    v_cvt_pk_bf16_f32 v117, v142, v143
    v_mfma_f32_4x4x4_16b_bf16 v[250:253], v[222:223], v[90:91], v[48:51]
    v_cvt_pk_bf16_f32 v118, v144, v145
    v_cvt_pk_bf16_f32 v119, v146, v147
    v_mfma_f32_4x4x4_16b_bf16 v[140:143], v[216:217], v[92:93], v[52:55]
    v_cvt_pk_bf16_f32 v120, v246, v247
    v_cvt_pk_bf16_f32 v121, v248, v249
    v_mfma_f32_4x4x4_16b_bf16 v[144:147], v[218:219], v[94:95], v[56:59]
    v_cvt_pk_bf16_f32 v122, v250, v251
    v_cvt_pk_bf16_f32 v123, v252, v253
    v_mfma_f32_4x4x4_16b_bf16 v[246:249], v[220:221], v[96:97], v[60:63]
    v_cvt_pk_bf16_f32 v124, v140, v141
    v_cvt_pk_bf16_f32 v125, v142, v143
    v_mfma_f32_4x4x4_16b_bf16 v[250:253], v[222:223], v[98:99], v[64:67]
    v_cvt_pk_bf16_f32 v126, v144, v145
    v_cvt_pk_bf16_f32 v127, v146, v147
    v_cvt_pk_bf16_f32 v128, v246, v247
    v_cvt_pk_bf16_f32 v129, v248, v249
    v_add_u32 v239, 272, v239
    v_cvt_pk_bf16_f32 v130, v250, v251
    v_cvt_pk_bf16_f32 v131, v252, v253
    s_waitcnt lgkmcnt(0)
    s_branch Lf_evd0
Lf_ev1:
    s_bitcmp0_b64 s[56:57], 1
    s_cbranch_scc1 Lf_nf1
    v_cvt_pk_bf16_f32 v246, v212, v212
    v_mov_b32 v212, 0
    ds_write_b16 v240, v246
    v_add_u32 v240, 128, v240
Lf_nf1:
    s_bitcmp0_b64 s[56:57], 6
    s_cbranch_scc1 Lf_na1
    s_sub_u32 s60, s60, 1
    s_cbranch_scc0 Lf_ns1
    s_mov_b32 s49, 6
    s_call_b64 s[62:63], L_swap
    s_add_u32 s35, s35, s31
    s_min_u32 s35, s35, 419404800
    s_xor_b32 s31, s31, 0x63ff800
    s_bitcmp0_b64 s[56:57], 3
    s_cbranch_scc1 Lf_evd1
    s_waitcnt lgkmcnt(0)
    s_branch Lf_e11
Lf_ns1:
    s_add_u32 s35, s35, s31
    s_min_u32 s35, s35, 419404800
    s_xor_b32 s31, s31, 0x63ff800
Lf_na1:
    s_bitcmp0_b64 s[56:57], 3
    s_cbranch_scc1 Lf_evd1
Lf_e11:
    s_sub_u32 s61, s61, 1
    s_cbranch_scc1 Lf_last1
    s_cmp_lg_u32 s61, s45
    s_cbranch_scc1 Lf_nw1
    v_add_u32 v238, s47, v238
    v_add_u32 v239, s47, v239
    ds_read_u16 v224, v238 offset:0
    ds_read_u16 v225, v238 offset:8
    ds_read_u16 v226, v238 offset:64
    ds_read_u16 v227, v238 offset:72
    s_waitcnt lgkmcnt(0)
Lf_nw1:
    v_mul_u32_u24 v216, v224, v241
    v_mul_u32_u24 v217, v224, v242
    v_mul_u32_u24 v218, v225, v241
    v_mul_u32_u24 v219, v225, v242
    v_mul_u32_u24 v220, v226, v241
    v_mul_u32_u24 v221, v226, v242
    v_mul_u32_u24 v222, v227, v241
    v_mul_u32_u24 v223, v227, v242
    v_mfma_f32_4x4x4_16b_bf16 v[140:143], v[216:217], v[68:69], v[4:7]
    v_add_u32 v238, 128, v238
    ds_read_b128 v[164:167], v239 offset:0
    ds_read_b128 v[168:171], v239 offset:64
    v_mfma_f32_4x4x4_16b_bf16 v[144:147], v[218:219], v[70:71], v[8:11]
    ds_read_b128 v[172:175], v239 offset:128
    ds_read_b128 v[176:179], v239 offset:192
    ds_read_u16 v224, v238 offset:0
    ds_read_u16 v225, v238 offset:8
    ds_read_u16 v226, v238 offset:64
    ds_read_u16 v227, v238 offset:72
    v_mfma_f32_4x4x4_16b_bf16 v[246:249], v[220:221], v[72:73], v[12:15]
    v_cvt_pk_bf16_f32 v100, v140, v141
    v_cvt_pk_bf16_f32 v101, v142, v143
    v_mfma_f32_4x4x4_16b_bf16 v[250:253], v[222:223], v[74:75], v[16:19]
    v_cvt_pk_bf16_f32 v102, v144, v145
    v_cvt_pk_bf16_f32 v103, v146, v147
    v_mfma_f32_4x4x4_16b_bf16 v[140:143], v[216:217], v[76:77], v[20:23]
    v_cvt_pk_bf16_f32 v104, v246, v247
    v_cvt_pk_bf16_f32 v105, v248, v249
    v_mfma_f32_4x4x4_16b_bf16 v[144:147], v[218:219], v[78:79], v[24:27]
    v_cvt_pk_bf16_f32 v106, v250, v251
    v_cvt_pk_bf16_f32 v107, v252, v253
    v_mfma_f32_4x4x4_16b_bf16 v[246:249], v[220:221], v[80:81], v[28:31]
    v_cvt_pk_bf16_f32 v108, v140, v141
    v_cvt_pk_bf16_f32 v109, v142, v143
    v_mfma_f32_4x4x4_16b_bf16 v[250:253], v[222:223], v[82:83], v[32:35]
    v_cvt_pk_bf16_f32 v110, v144, v145
    v_cvt_pk_bf16_f32 v111, v146, v147
    v_mfma_f32_4x4x4_16b_bf16 v[140:143], v[216:217], v[84:85], v[36:39]
    v_cvt_pk_bf16_f32 v112, v246, v247
    v_cvt_pk_bf16_f32 v113, v248, v249
    v_mfma_f32_4x4x4_16b_bf16 v[144:147], v[218:219], v[86:87], v[40:43]
    v_cvt_pk_bf16_f32 v114, v250, v251
    v_cvt_pk_bf16_f32 v115, v252, v253
    v_mfma_f32_4x4x4_16b_bf16 v[246:249], v[220:221], v[88:89], v[44:47]
    v_cvt_pk_bf16_f32 v116, v140, v141
    v_cvt_pk_bf16_f32 v117, v142, v143
    v_mfma_f32_4x4x4_16b_bf16 v[250:253], v[222:223], v[90:91], v[48:51]
    v_cvt_pk_bf16_f32 v118, v144, v145
    v_cvt_pk_bf16_f32 v119, v146, v147
    v_mfma_f32_4x4x4_16b_bf16 v[140:143], v[216:217], v[92:93], v[52:55]
    v_cvt_pk_bf16_f32 v120, v246, v247
    v_cvt_pk_bf16_f32 v121, v248, v249
    v_mfma_f32_4x4x4_16b_bf16 v[144:147], v[218:219], v[94:95], v[56:59]
    v_cvt_pk_bf16_f32 v122, v250, v251
    v_cvt_pk_bf16_f32 v123, v252, v253
    v_mfma_f32_4x4x4_16b_bf16 v[246:249], v[220:221], v[96:97], v[60:63]
    v_cvt_pk_bf16_f32 v124, v140, v141
    v_cvt_pk_bf16_f32 v125, v142, v143
    v_mfma_f32_4x4x4_16b_bf16 v[250:253], v[222:223], v[98:99], v[64:67]
    v_cvt_pk_bf16_f32 v126, v144, v145
    v_cvt_pk_bf16_f32 v127, v146, v147
    v_cvt_pk_bf16_f32 v128, v246, v247
    v_cvt_pk_bf16_f32 v129, v248, v249
    v_add_u32 v239, 272, v239
    v_cvt_pk_bf16_f32 v130, v250, v251
    v_cvt_pk_bf16_f32 v131, v252, v253
    s_waitcnt lgkmcnt(0)
    s_branch Lf_evd1
Lf_ev2:
    s_bitcmp0_b64 s[56:57], 2
    s_cbranch_scc1 Lf_nf2
    v_cvt_pk_bf16_f32 v246, v212, v212
    v_mov_b32 v212, 0
    ds_write_b16 v240, v246
    v_add_u32 v240, 128, v240
Lf_nf2:
    s_bitcmp0_b64 s[56:57], 7
    s_cbranch_scc1 Lf_na2
    s_sub_u32 s60, s60, 1
    s_cbranch_scc0 Lf_ns2
    s_mov_b32 s49, 7
    s_call_b64 s[62:63], L_swap
    s_add_u32 s35, s35, s31
    s_min_u32 s35, s35, 419404800
    s_xor_b32 s31, s31, 0x63ff800
    s_bitcmp0_b64 s[56:57], 4
    s_cbranch_scc1 Lf_evd2
    s_waitcnt lgkmcnt(0)
    s_branch Lf_e12
Lf_ns2:
    s_add_u32 s35, s35, s31
    s_min_u32 s35, s35, 419404800
    s_xor_b32 s31, s31, 0x63ff800
Lf_na2:
    s_bitcmp0_b64 s[56:57], 4
    s_cbranch_scc1 Lf_evd2
Lf_e12:
    s_sub_u32 s61, s61, 1
    s_cbranch_scc1 Lf_last2
    s_cmp_lg_u32 s61, s45
    s_cbranch_scc1 Lf_nw2
    v_add_u32 v238, s47, v238
    v_add_u32 v239, s47, v239
    ds_read_u16 v224, v238 offset:0
    ds_read_u16 v225, v238 offset:8
    ds_read_u16 v226, v238 offset:64
    ds_read_u16 v227, v238 offset:72
    s_waitcnt lgkmcnt(0)
Lf_nw2:
    v_mul_u32_u24 v216, v224, v241
    v_mul_u32_u24 v217, v224, v242
    v_mul_u32_u24 v218, v225, v241
    v_mul_u32_u24 v219, v225, v242
    v_mul_u32_u24 v220, v226, v241
    v_mul_u32_u24 v221, v226, v242
    v_mul_u32_u24 v222, v227, v241
    v_mul_u32_u24 v223, v227, v242
    v_mfma_f32_4x4x4_16b_bf16 v[140:143], v[216:217], v[68:69], v[4:7]
    v_add_u32 v238, 128, v238
    ds_read_b128 v[164:167], v239 offset:0
    ds_read_b128 v[168:171], v239 offset:64
    v_mfma_f32_4x4x4_16b_bf16 v[144:147], v[218:219], v[70:71], v[8:11]
    ds_read_b128 v[172:175], v239 offset:128
    ds_read_b128 v[176:179], v239 offset:192
    ds_read_u16 v224, v238 offset:0
    ds_read_u16 v225, v238 offset:8
    ds_read_u16 v226, v238 offset:64
    ds_read_u16 v227, v238 offset:72
    v_mfma_f32_4x4x4_16b_bf16 v[246:249], v[220:221], v[72:73], v[12:15]
    v_cvt_pk_bf16_f32 v100, v140, v141
    v_cvt_pk_bf16_f32 v101, v142, v143
    v_mfma_f32_4x4x4_16b_bf16 v[250:253], v[222:223], v[74:75], v[16:19]
    v_cvt_pk_bf16_f32 v102, v144, v145
    v_cvt_pk_bf16_f32 v103, v146, v147
    v_mfma_f32_4x4x4_16b_bf16 v[140:143], v[216:217], v[76:77], v[20:23]
    v_cvt_pk_bf16_f32 v104, v246, v247
    v_cvt_pk_bf16_f32 v105, v248, v249
    v_mfma_f32_4x4x4_16b_bf16 v[144:147], v[218:219], v[78:79], v[24:27]
    v_cvt_pk_bf16_f32 v106, v250, v251
    v_cvt_pk_bf16_f32 v107, v252, v253
    v_mfma_f32_4x4x4_16b_bf16 v[246:249], v[220:221], v[80:81], v[28:31]
    v_cvt_pk_bf16_f32 v108, v140, v141
    v_cvt_pk_bf16_f32 v109, v142, v143
    v_mfma_f32_4x4x4_16b_bf16 v[250:253], v[222:223], v[82:83], v[32:35]
    v_cvt_pk_bf16_f32 v110, v144, v145
    v_cvt_pk_bf16_f32 v111, v146, v147
    v_mfma_f32_4x4x4_16b_bf16 v[140:143], v[216:217], v[84:85], v[36:39]
    v_cvt_pk_bf16_f32 v112, v246, v247
    v_cvt_pk_bf16_f32 v113, v248, v249
    v_mfma_f32_4x4x4_16b_bf16 v[144:147], v[218:219], v[86:87], v[40:43]
    v_cvt_pk_bf16_f32 v114, v250, v251
    v_cvt_pk_bf16_f32 v115, v252, v253
    v_mfma_f32_4x4x4_16b_bf16 v[246:249], v[220:221], v[88:89], v[44:47]
    v_cvt_pk_bf16_f32 v116, v140, v141
    v_cvt_pk_bf16_f32 v117, v142, v143
    v_mfma_f32_4x4x4_16b_bf16 v[250:253], v[222:223], v[90:91], v[48:51]
    v_cvt_pk_bf16_f32 v118, v144, v145
    v_cvt_pk_bf16_f32 v119, v146, v147
    v_mfma_f32_4x4x4_16b_bf16 v[140:143], v[216:217], v[92:93], v[52:55]
    v_cvt_pk_bf16_f32 v120, v246, v247
    v_cvt_pk_bf16_f32 v121, v248, v249
    v_mfma_f32_4x4x4_16b_bf16 v[144:147], v[218:219], v[94:95], v[56:59]
    v_cvt_pk_bf16_f32 v122, v250, v251
    v_cvt_pk_bf16_f32 v123, v252, v253
    v_mfma_f32_4x4x4_16b_bf16 v[246:249], v[220:221], v[96:97], v[60:63]
    v_cvt_pk_bf16_f32 v124, v140, v141
    v_cvt_pk_bf16_f32 v125, v142, v143
    v_mfma_f32_4x4x4_16b_bf16 v[250:253], v[222:223], v[98:99], v[64:67]
    v_cvt_pk_bf16_f32 v126, v144, v145
    v_cvt_pk_bf16_f32 v127, v146, v147
    v_cvt_pk_bf16_f32 v128, v246, v247
    v_cvt_pk_bf16_f32 v129, v248, v249
    v_add_u32 v239, 272, v239
    v_cvt_pk_bf16_f32 v130, v250, v251
    v_cvt_pk_bf16_f32 v131, v252, v253
    s_waitcnt lgkmcnt(0)
    s_branch Lf_evd2
Lf_ev3:
    s_bitcmp0_b64 s[56:57], 3
    s_cbranch_scc1 Lf_nf3
    v_cvt_pk_bf16_f32 v246, v212, v212
    v_mov_b32 v212, 0
    ds_write_b16 v240, v246
    v_add_u32 v240, 128, v240
Lf_nf3:
    s_bitcmp0_b64 s[56:57], 8
    s_cbranch_scc1 Lf_na3
    s_sub_u32 s60, s60, 1
    s_cbranch_scc0 Lf_ns3
    s_mov_b32 s49, 8
    s_call_b64 s[62:63], L_swap
    s_add_u32 s35, s35, s31
    s_min_u32 s35, s35, 419404800
    s_xor_b32 s31, s31, 0x63ff800
    s_bitcmp0_b64 s[56:57], 5
    s_cbranch_scc1 Lf_evd3
    s_waitcnt lgkmcnt(0)
    s_branch Lf_e13
Lf_ns3:
    s_add_u32 s35, s35, s31
    s_min_u32 s35, s35, 419404800
    s_xor_b32 s31, s31, 0x63ff800
Lf_na3:
    s_bitcmp0_b64 s[56:57], 5
    s_cbranch_scc1 Lf_evd3
Lf_e13:
    s_sub_u32 s61, s61, 1
    s_cbranch_scc1 Lf_last3
    s_cmp_lg_u32 s61, s45
    s_cbranch_scc1 Lf_nw3
    v_add_u32 v238, s47, v238
    v_add_u32 v239, s47, v239
    ds_read_u16 v224, v238 offset:0
    ds_read_u16 v225, v238 offset:8
    ds_read_u16 v226, v238 offset:64
    ds_read_u16 v227, v238 offset:72
    s_waitcnt lgkmcnt(0)
Lf_nw3:
    v_mul_u32_u24 v216, v224, v241
    v_mul_u32_u24 v217, v224, v242
    v_mul_u32_u24 v218, v225, v241
    v_mul_u32_u24 v219, v225, v242
    v_mul_u32_u24 v220, v226, v241
    v_mul_u32_u24 v221, v226, v242
    v_mul_u32_u24 v222, v227, v241
    v_mul_u32_u24 v223, v227, v242
    v_mfma_f32_4x4x4_16b_bf16 v[140:143], v[216:217], v[68:69], v[4:7]
    v_add_u32 v238, 128, v238
    ds_read_b128 v[164:167], v239 offset:0
    ds_read_b128 v[168:171], v239 offset:64
    v_mfma_f32_4x4x4_16b_bf16 v[144:147], v[218:219], v[70:71], v[8:11]
    ds_read_b128 v[172:175], v239 offset:128
    ds_read_b128 v[176:179], v239 offset:192
    ds_read_u16 v224, v238 offset:0
    ds_read_u16 v225, v238 offset:8
    ds_read_u16 v226, v238 offset:64
    ds_read_u16 v227, v238 offset:72
    v_mfma_f32_4x4x4_16b_bf16 v[246:249], v[220:221], v[72:73], v[12:15]
    v_cvt_pk_bf16_f32 v100, v140, v141
    v_cvt_pk_bf16_f32 v101, v142, v143
    v_mfma_f32_4x4x4_16b_bf16 v[250:253], v[222:223], v[74:75], v[16:19]
    v_cvt_pk_bf16_f32 v102, v144, v145
    v_cvt_pk_bf16_f32 v103, v146, v147
    v_mfma_f32_4x4x4_16b_bf16 v[140:143], v[216:217], v[76:77], v[20:23]
    v_cvt_pk_bf16_f32 v104, v246, v247
    v_cvt_pk_bf16_f32 v105, v248, v249
    v_mfma_f32_4x4x4_16b_bf16 v[144:147], v[218:219], v[78:79], v[24:27]
    v_cvt_pk_bf16_f32 v106, v250, v251
    v_cvt_pk_bf16_f32 v107, v252, v253
    v_mfma_f32_4x4x4_16b_bf16 v[246:249], v[220:221], v[80:81], v[28:31]
    v_cvt_pk_bf16_f32 v108, v140, v141
    v_cvt_pk_bf16_f32 v109, v142, v143
    v_mfma_f32_4x4x4_16b_bf16 v[250:253], v[222:223], v[82:83], v[32:35]
    v_cvt_pk_bf16_f32 v110, v144, v145
    v_cvt_pk_bf16_f32 v111, v146, v147
    v_mfma_f32_4x4x4_16b_bf16 v[140:143], v[216:217], v[84:85], v[36:39]
    v_cvt_pk_bf16_f32 v112, v246, v247
    v_cvt_pk_bf16_f32 v113, v248, v249
    v_mfma_f32_4x4x4_16b_bf16 v[144:147], v[218:219], v[86:87], v[40:43]
    v_cvt_pk_bf16_f32 v114, v250, v251
    v_cvt_pk_bf16_f32 v115, v252, v253
    v_mfma_f32_4x4x4_16b_bf16 v[246:249], v[220:221], v[88:89], v[44:47]
    v_cvt_pk_bf16_f32 v116, v140, v141
    v_cvt_pk_bf16_f32 v117, v142, v143
    v_mfma_f32_4x4x4_16b_bf16 v[250:253], v[222:223], v[90:91], v[48:51]
    v_cvt_pk_bf16_f32 v118, v144, v145
    v_cvt_pk_bf16_f32 v119, v146, v147
    v_mfma_f32_4x4x4_16b_bf16 v[140:143], v[216:217], v[92:93], v[52:55]
    v_cvt_pk_bf16_f32 v120, v246, v247
    v_cvt_pk_bf16_f32 v121, v248, v249
    v_mfma_f32_4x4x4_16b_bf16 v[144:147], v[218:219], v[94:95], v[56:59]
    v_cvt_pk_bf16_f32 v122, v250, v251
    v_cvt_pk_bf16_f32 v123, v252, v253
    v_mfma_f32_4x4x4_16b_bf16 v[246:249], v[220:221], v[96:97], v[60:63]
    v_cvt_pk_bf16_f32 v124, v140, v141
    v_cvt_pk_bf16_f32 v125, v142, v143
    v_mfma_f32_4x4x4_16b_bf16 v[250:253], v[222:223], v[98:99], v[64:67]
    v_cvt_pk_bf16_f32 v126, v144, v145
    v_cvt_pk_bf16_f32 v127, v146, v147
    v_cvt_pk_bf16_f32 v128, v246, v247
    v_cvt_pk_bf16_f32 v129, v248, v249
    v_add_u32 v239, 272, v239
    v_cvt_pk_bf16_f32 v130, v250, v251
    v_cvt_pk_bf16_f32 v131, v252, v253
    s_waitcnt lgkmcnt(0)
    s_branch Lf_evd3
Lf_last0:
    s_branch Lf_tail
Lf_last1:
    v_add_u32 v236, 2080, v236
    s_lshr_b64 s[56:57], s[56:57], 1
    s_branch Lf_tail
Lf_last2:
    v_add_u32 v236, 4160, v236
    s_lshr_b64 s[56:57], s[56:57], 2
    s_branch Lf_tail
Lf_last3:
    v_add_u32 v236, 6240, v236
    s_lshr_b64 s[56:57], s[56:57], 3
Lf_tail:
    v_mfma_f32_16x16x32_bf16 v[208:211], v[136:139], v[200:203], v[208:211]
    v_exp_f32 v132, v148
    v_exp_f32 v133, v149
    v_exp_f32 v134, v150
    v_exp_f32 v135, v151
    v_exp_f32 v136, v152
    v_exp_f32 v137, v153
    v_mfma_f32_4x4x4_16b_bf16 v[132:135], v[228:229], v[228:229], v[132:135]
    v_exp_f32 v138, v154
    v_exp_f32 v139, v155
    v_cvt_pk_bf16_f32 v208, v208, v209
    v_cvt_pk_bf16_f32 v209, v210, v211
    v_exp_f32 v140, v156
    v_exp_f32 v141, v157
    v_mfma_f32_4x4x4_16b_bf16 v[212:215], v[208:209], v[188:189], v[212:215] cbsz:4 abid:0
    v_mfma_f32_4x4x4_16b_bf16 v[136:139], v[228:229], v[228:229], v[136:139]
    v_exp_f32 v142, v158
    v_mfma_f32_4x4x4_16b_bf16 v[212:215], v[208:209], v[190:191], v[212:215] cbsz:4 abid:4
    v_exp_f32 v143, v159
    v_exp_f32 v144, v160
    v_mfma_f32_4x4x4_16b_bf16 v[212:215], v[208:209], v[192:193], v[212:215] cbsz:4 abid:8
    v_exp_f32 v145, v161
    v_mfma_f32_4x4x4_16b_bf16 v[140:143], v[228:229], v[228:229], v[140:143]
    v_mfma_f32_4x4x4_16b_bf16 v[212:215], v[208:209], v[194:195], v[212:215] cbsz:4 abid:12
    ds_read_b64_tr_b16 v[188:189], v236 offset:0
    ds_read_b64_tr_b16 v[190:191], v236 offset:512
    ds_read_b64_tr_b16 v[192:193], v236 offset:1056
    ds_read_b64_tr_b16 v[194:195], v236 offset:1568
    v_exp_f32 v146, v162
    v_exp_f32 v147, v163
    v_rcp_f32 v132, v132
    v_rcp_f32 v133, v133
    v_mfma_f32_4x4x4_16b_bf16 v[144:147], v[228:229], v[228:229], v[144:147]
    v_rcp_f32 v134, v134
    s_bitcmp0_b64 s[56:57], 1
    s_cbranch_scc1 Lf_tnf
    v_cvt_pk_bf16_f32 v246, v212, v212
    v_mov_b32 v212, 0
    ds_write_b16 v240, v246
    v_add_u32 v240, 128, v240
Lf_tnf:
    v_cvt_pk_bf16_f32 v132, v132, v133
    s_waitcnt lgkmcnt(0)
    v_rcp_f32 v135, v135
    v_rcp_f32 v136, v136
    v_cvt_pk_bf16_f32 v133, v134, v135
    v_rcp_f32 v137, v137
    v_rcp_f32 v138, v138
    v_cvt_pk_bf16_f32 v134, v136, v137
    v_rcp_f32 v139, v139
    v_rcp_f32 v140, v140
    v_cvt_pk_bf16_f32 v135, v138, v139
    v_rcp_f32 v141, v141
    v_rcp_f32 v142, v142
    v_cvt_pk_bf16_f32 v136, v140, v141
    v_mfma_f32_16x16x32_bf16 v[208:211], v[132:135], v[196:199], v[204:207]
    v_rcp_f32 v143, v143
    v_rcp_f32 v144, v144
    v_cvt_pk_bf16_f32 v137, v142, v143
    v_rcp_f32 v145, v145
    v_rcp_f32 v146, v146
    v_rcp_f32 v147, v147
    v_cvt_pk_bf16_f32 v138, v144, v145
    v_cvt_pk_bf16_f32 v139, v146, v147
    s_nop 1
    v_mfma_f32_16x16x32_bf16 v[208:211], v[136:139], v[200:203], v[208:211]
    s_nop 7
    v_cvt_pk_bf16_f32 v208, v208, v209
    v_cvt_pk_bf16_f32 v209, v210, v211
    s_nop 1
    v_mfma_f32_4x4x4_16b_bf16 v[212:215], v[208:209], v[188:189], v[212:215] cbsz:4 abid:0
    s_nop 1
    v_mfma_f32_4x4x4_16b_bf16 v[212:215], v[208:209], v[190:191], v[212:215] cbsz:4 abid:4
    s_nop 1
    v_mfma_f32_4x4x4_16b_bf16 v[212:215], v[208:209], v[192:193], v[212:215] cbsz:4 abid:8
    s_nop 1
    v_mfma_f32_4x4x4_16b_bf16 v[212:215], v[208:209], v[194:195], v[212:215] cbsz:4 abid:12
    s_nop 4
    v_cvt_pk_bf16_f32 v246, v212, v212
    ds_write_b16 v240, v246
L_store:
    s_add_u32 s66, s52, 14880
    v_lshl_add_u32 v247, v0, 4, s66
    s_bfm_b64 exec, 16, 48
    v_add_u32 v243, s50, v243
    s_mov_b64 exec, -1
    ds_read_b128 v[148:151], v247
    s_waitcnt lgkmcnt(0)
    global_store_dwordx4 v243, v[148:151], s[18:19] sc0 sc1
L_end:
    s_endpgm
L_general:
    s_waitcnt vmcnt(0)
    ds_read_b128 v[44:47], v246 offset:20480
    ds_read_b128 v[48:51], v246 offset:21504
    ds_read_b128 v[88:91], v246 offset:22528
    ds_read_b128 v[52:55], v246 offset:40960
    ds_read_b128 v[56:59], v246 offset:41984
    ds_read_b128 v[92:95], v246 offset:43008
    ds_read_b128 v[60:63], v246 offset:61440
    ds_read_b128 v[64:67], v246 offset:62464
    ds_read_b128 v[96:99], v246 offset:63488
    ds_read_u16 v224, v238 offset:0
    ds_read_u16 v225, v238 offset:8
    ds_read_u16 v226, v238 offset:64
    ds_read_u16 v227, v238 offset:72
    s_mul_i32 s35, s53, 51200
    s_movk_i32 s31, 25600
    s_mov_b32 s60, 5
    s_mov_b64 s[56:57], 0
    s_mov_b64 s[58:59], 0
    v_mov_b32 v148, -1
    v_mov_b32 v149, -1
    v_mov_b32 v150, -1
    v_mov_b32 v151, -1
    s_add_u32 s66, s52, 18432
    v_add_u32 v152, s66, v2
    ds_write_b128 v152, v[148:151]
    ds_write_b128 v152, v[148:151] offset:1024
    s_add_u32 s64, s52, 18448
    s_bfm_b64 s[28:29], 50, 0
    s_mul_i32 s66, s53, 800
    v_add_u32 v247, s66, v2
    s_mov_b64 exec, s[28:29]
    global_load_dwordx4 v[100:103], v247, s[8:9]
    v_add_u32 v247, 1638400, v247
    global_load_dwordx4 v[104:107], v247, s[8:9]
    v_add_u32 v247, 1638400, v247
    global_load_dwordx4 v[108:111], v247, s[8:9]
    v_add_u32 v247, 1638400, v247
    global_load_dwordx4 v[112:115], v247, s[8:9]
    v_add_u32 v247, 1638400, v247
    s_mov_b64 exec, -1
    v_cmp_lt_u32 vcc, 24, v0
    s_nop 1
    v_cndmask_b32 v145, 0, 1, vcc
    v_mul_u32_u24 v142, 25, v145
    v_sub_u32 v142, v0, v142
    v_mul_u32_u24 v142, 0x80008, v142
    v_add_u32 v141, 0x10000, v142
    v_add_u32 v143, 0x50004, v142
    v_add_u32 v144, 0x70006, v142
    v_add_u32 v142, 0x30002, v142
    s_waitcnt vmcnt(0)
    s_mov_b64 exec, s[28:29]
    v_cmp_neq_f16_sdwa s[68:69], v100, 0 src0_sel:WORD_0 src1_sel:WORD_0
    v_cmp_neq_f16_sdwa s[70:71], v100, 0 src0_sel:WORD_1 src1_sel:WORD_0
    v_cmp_neq_f16_sdwa s[72:73], v101, 0 src0_sel:WORD_0 src1_sel:WORD_0
    v_cmp_neq_f16_sdwa s[74:75], v101, 0 src0_sel:WORD_1 src1_sel:WORD_0
    v_cmp_neq_f16_sdwa s[76:77], v102, 0 src0_sel:WORD_0 src1_sel:WORD_0
    v_cmp_neq_f16_sdwa s[78:79], v102, 0 src0_sel:WORD_1 src1_sel:WORD_0
    v_cmp_neq_f16_sdwa s[80:81], v103, 0 src0_sel:WORD_0 src1_sel:WORD_0
    v_cmp_neq_f16_sdwa s[82:83], v103, 0 src0_sel:WORD_1 src1_sel:WORD_0
    s_mov_b64 exec, -1
    v_mov_b32 v132, s64
    v_mbcnt_lo_u32_b32 v132, s68, v132
    v_mbcnt_hi_u32_b32 v132, s69, v132
    v_mbcnt_lo_u32_b32 v132, s70, v132
    v_mbcnt_hi_u32_b32 v132, s71, v132
    v_mbcnt_lo_u32_b32 v132, s72, v132
    v_mbcnt_hi_u32_b32 v132, s73, v132
    v_mbcnt_lo_u32_b32 v132, s74, v132
    v_mbcnt_hi_u32_b32 v132, s75, v132
    v_mbcnt_lo_u32_b32 v132, s76, v132
    v_mbcnt_hi_u32_b32 v132, s77, v132
    v_mbcnt_lo_u32_b32 v132, s78, v132
    v_mbcnt_hi_u32_b32 v132, s79, v132
    v_mbcnt_lo_u32_b32 v132, s80, v132
    v_mbcnt_hi_u32_b32 v132, s81, v132
    v_mbcnt_lo_u32_b32 v132, s82, v132
    v_mbcnt_hi_u32_b32 v132, s83, v132
    s_add_u32 s55, s64, 16
    v_readlane_b32 s66, v132, 25
    v_readlane_b32 s67, v132, 63
    s_add_u32 s64, s66, 15
    s_and_b32 s64, s64, -16
    s_max_u32 s64, s64, s55
    s_sub_u32 s66, s64, s66
    v_mad_u32_u24 v132, v145, s66, v132
    s_mov_b32 s55, s64
    v_addc_co_u32 v133, vcc, 0, v132, s[68:69]
    v_addc_co_u32 v134, vcc, 0, v133, s[70:71]
    v_addc_co_u32 v135, vcc, 0, v134, s[72:73]
    v_addc_co_u32 v136, vcc, 0, v135, s[74:75]
    v_addc_co_u32 v137, vcc, 0, v136, s[76:77]
    v_addc_co_u32 v138, vcc, 0, v137, s[78:79]
    v_addc_co_u32 v139, vcc, 0, v138, s[80:81]
    s_add_u32 s67, s67, s66
    s_add_u32 s67, s67, 15
    s_and_b32 s67, s67, -16
    s_add_u32 s64, s64, 16
    s_max_u32 s64, s64, s67
    s_mov_b64 exec, s[68:69]
    ds_write_b8 v132, v141
    s_mov_b64 exec, s[70:71]
    ds_write_b8_d16_hi v133, v141
    s_mov_b64 exec, s[72:73]
    ds_write_b8 v134, v142
    s_mov_b64 exec, s[74:75]
    ds_write_b8_d16_hi v135, v142
    s_mov_b64 exec, s[76:77]
    ds_write_b8 v136, v143
    s_mov_b64 exec, s[78:79]
    ds_write_b8_d16_hi v137, v143
    s_mov_b64 exec, s[80:81]
    ds_write_b8 v138, v144
    s_mov_b64 exec, s[82:83]
    ds_write_b8_d16_hi v139, v144
    s_mov_b64 exec, -1
    s_lshr_b32 s95, s55, 4
    s_bitset1_b64 s[56:57], s95
    s_lshr_b32 s95, s64, 4
    s_bitset1_b64 s[56:57], s95
    s_mov_b64 exec, s[28:29]
    v_cmp_neq_f16_sdwa s[68:69], v104, 0 src0_sel:WORD_0 src1_sel:WORD_0
    v_cmp_neq_f16_sdwa s[70:71], v104, 0 src0_sel:WORD_1 src1_sel:WORD_0
    v_cmp_neq_f16_sdwa s[72:73], v105, 0 src0_sel:WORD_0 src1_sel:WORD_0
    v_cmp_neq_f16_sdwa s[74:75], v105, 0 src0_sel:WORD_1 src1_sel:WORD_0
    v_cmp_neq_f16_sdwa s[76:77], v106, 0 src0_sel:WORD_0 src1_sel:WORD_0
    v_cmp_neq_f16_sdwa s[78:79], v106, 0 src0_sel:WORD_1 src1_sel:WORD_0
    v_cmp_neq_f16_sdwa s[80:81], v107, 0 src0_sel:WORD_0 src1_sel:WORD_0
    v_cmp_neq_f16_sdwa s[82:83], v107, 0 src0_sel:WORD_1 src1_sel:WORD_0
    s_mov_b64 exec, -1
    v_mov_b32 v132, s64
    v_mbcnt_lo_u32_b32 v132, s68, v132
    v_mbcnt_hi_u32_b32 v132, s69, v132
    v_mbcnt_lo_u32_b32 v132, s70, v132
    v_mbcnt_hi_u32_b32 v132, s71, v132
    v_mbcnt_lo_u32_b32 v132, s72, v132
    v_mbcnt_hi_u32_b32 v132, s73, v132
    v_mbcnt_lo_u32_b32 v132, s74, v132
    v_mbcnt_hi_u32_b32 v132, s75, v132
    v_mbcnt_lo_u32_b32 v132, s76, v132
    v_mbcnt_hi_u32_b32 v132, s77, v132
    v_mbcnt_lo_u32_b32 v132, s78, v132
    v_mbcnt_hi_u32_b32 v132, s79, v132
    v_mbcnt_lo_u32_b32 v132, s80, v132
    v_mbcnt_hi_u32_b32 v132, s81, v132
    v_mbcnt_lo_u32_b32 v132, s82, v132
    v_mbcnt_hi_u32_b32 v132, s83, v132
    s_add_u32 s55, s64, 16
    v_readlane_b32 s66, v132, 25
    v_readlane_b32 s67, v132, 63
    s_add_u32 s64, s66, 15
    s_and_b32 s64, s64, -16
    s_max_u32 s64, s64, s55
    s_sub_u32 s66, s64, s66
    v_mad_u32_u24 v132, v145, s66, v132
    s_mov_b32 s55, s64
    v_addc_co_u32 v133, vcc, 0, v132, s[68:69]
    v_addc_co_u32 v134, vcc, 0, v133, s[70:71]
    v_addc_co_u32 v135, vcc, 0, v134, s[72:73]
    v_addc_co_u32 v136, vcc, 0, v135, s[74:75]
    v_addc_co_u32 v137, vcc, 0, v136, s[76:77]
    v_addc_co_u32 v138, vcc, 0, v137, s[78:79]
    v_addc_co_u32 v139, vcc, 0, v138, s[80:81]
    s_add_u32 s67, s67, s66
    s_add_u32 s67, s67, 15
    s_and_b32 s67, s67, -16
    s_add_u32 s64, s64, 16
    s_max_u32 s64, s64, s67
    s_mov_b64 exec, s[68:69]
    ds_write_b8 v132, v141
    s_mov_b64 exec, s[70:71]
    ds_write_b8_d16_hi v133, v141
    s_mov_b64 exec, s[72:73]
    ds_write_b8 v134, v142
    s_mov_b64 exec, s[74:75]
    ds_write_b8_d16_hi v135, v142
    s_mov_b64 exec, s[76:77]
    ds_write_b8 v136, v143
    s_mov_b64 exec, s[78:79]
    ds_write_b8_d16_hi v137, v143
    s_mov_b64 exec, s[80:81]
    ds_write_b8 v138, v144
    s_mov_b64 exec, s[82:83]
    ds_write_b8_d16_hi v139, v144
    s_mov_b64 exec, -1
    s_lshr_b32 s95, s55, 4
    s_bitset1_b64 s[56:57], s95
    s_lshr_b32 s95, s64, 4
    s_bitset1_b64 s[56:57], s95
    s_mov_b64 exec, s[28:29]
    v_cmp_neq_f16_sdwa s[68:69], v108, 0 src0_sel:WORD_0 src1_sel:WORD_0
    v_cmp_neq_f16_sdwa s[70:71], v108, 0 src0_sel:WORD_1 src1_sel:WORD_0
    v_cmp_neq_f16_sdwa s[72:73], v109, 0 src0_sel:WORD_0 src1_sel:WORD_0
    v_cmp_neq_f16_sdwa s[74:75], v109, 0 src0_sel:WORD_1 src1_sel:WORD_0
    v_cmp_neq_f16_sdwa s[76:77], v110, 0 src0_sel:WORD_0 src1_sel:WORD_0
    v_cmp_neq_f16_sdwa s[78:79], v110, 0 src0_sel:WORD_1 src1_sel:WORD_0
    v_cmp_neq_f16_sdwa s[80:81], v111, 0 src0_sel:WORD_0 src1_sel:WORD_0
    v_cmp_neq_f16_sdwa s[82:83], v111, 0 src0_sel:WORD_1 src1_sel:WORD_0
    s_mov_b64 exec, -1
    v_mov_b32 v132, s64
    v_mbcnt_lo_u32_b32 v132, s68, v132
    v_mbcnt_hi_u32_b32 v132, s69, v132
    v_mbcnt_lo_u32_b32 v132, s70, v132
    v_mbcnt_hi_u32_b32 v132, s71, v132
    v_mbcnt_lo_u32_b32 v132, s72, v132
    v_mbcnt_hi_u32_b32 v132, s73, v132
    v_mbcnt_lo_u32_b32 v132, s74, v132
    v_mbcnt_hi_u32_b32 v132, s75, v132
    v_mbcnt_lo_u32_b32 v132, s76, v132
    v_mbcnt_hi_u32_b32 v132, s77, v132
    v_mbcnt_lo_u32_b32 v132, s78, v132
    v_mbcnt_hi_u32_b32 v132, s79, v132
    v_mbcnt_lo_u32_b32 v132, s80, v132
    v_mbcnt_hi_u32_b32 v132, s81, v132
    v_mbcnt_lo_u32_b32 v132, s82, v132
    v_mbcnt_hi_u32_b32 v132, s83, v132
    s_add_u32 s55, s64, 16
    v_readlane_b32 s66, v132, 25
    v_readlane_b32 s67, v132, 63
    s_add_u32 s64, s66, 15
    s_and_b32 s64, s64, -16
    s_max_u32 s64, s64, s55
    s_sub_u32 s66, s64, s66
    v_mad_u32_u24 v132, v145, s66, v132
    s_mov_b32 s55, s64
    v_addc_co_u32 v133, vcc, 0, v132, s[68:69]
    v_addc_co_u32 v134, vcc, 0, v133, s[70:71]
    v_addc_co_u32 v135, vcc, 0, v134, s[72:73]
    v_addc_co_u32 v136, vcc, 0, v135, s[74:75]
    v_addc_co_u32 v137, vcc, 0, v136, s[76:77]
    v_addc_co_u32 v138, vcc, 0, v137, s[78:79]
    v_addc_co_u32 v139, vcc, 0, v138, s[80:81]
    s_add_u32 s67, s67, s66
    s_add_u32 s67, s67, 15
    s_and_b32 s67, s67, -16
    s_add_u32 s64, s64, 16
    s_max_u32 s64, s64, s67
    s_mov_b64 exec, s[68:69]
    ds_write_b8 v132, v141
    s_mov_b64 exec, s[70:71]
    ds_write_b8_d16_hi v133, v141
    s_mov_b64 exec, s[72:73]
    ds_write_b8 v134, v142
    s_mov_b64 exec, s[74:75]
    ds_write_b8_d16_hi v135, v142
    s_mov_b64 exec, s[76:77]
    ds_write_b8 v136, v143
    s_mov_b64 exec, s[78:79]
    ds_write_b8_d16_hi v137, v143
    s_mov_b64 exec, s[80:81]
    ds_write_b8 v138, v144
    s_mov_b64 exec, s[82:83]
    ds_write_b8_d16_hi v139, v144
    s_mov_b64 exec, -1
    s_lshr_b32 s95, s55, 4
    s_lshl_b64 s[86:87], 1, s95
    s_bitcmp1_b32 s55, 10
    s_cselect_b64 s[88:89], 0, s[86:87]
    s_cselect_b64 s[90:91], s[86:87], 0
    s_or_b64 s[56:57], s[56:57], s[88:89]
    s_or_b64 s[58:59], s[58:59], s[90:91]
    s_lshr_b32 s95, s64, 4
    s_lshl_b64 s[86:87], 1, s95
    s_bitcmp1_b32 s64, 10
    s_cselect_b64 s[88:89], 0, s[86:87]
    s_cselect_b64 s[90:91], s[86:87], 0
    s_or_b64 s[56:57], s[56:57], s[88:89]
    s_or_b64 s[58:59], s[58:59], s[90:91]
    s_mov_b32 s44, s64
    s_mov_b64 exec, s[28:29]
    v_cmp_neq_f16_sdwa s[68:69], v112, 0 src0_sel:WORD_0 src1_sel:WORD_0
    v_cmp_neq_f16_sdwa s[70:71], v112, 0 src0_sel:WORD_1 src1_sel:WORD_0
    v_cmp_neq_f16_sdwa s[72:73], v113, 0 src0_sel:WORD_0 src1_sel:WORD_0
    v_cmp_neq_f16_sdwa s[74:75], v113, 0 src0_sel:WORD_1 src1_sel:WORD_0
    v_cmp_neq_f16_sdwa s[76:77], v114, 0 src0_sel:WORD_0 src1_sel:WORD_0
    v_cmp_neq_f16_sdwa s[78:79], v114, 0 src0_sel:WORD_1 src1_sel:WORD_0
    v_cmp_neq_f16_sdwa s[80:81], v115, 0 src0_sel:WORD_0 src1_sel:WORD_0
    v_cmp_neq_f16_sdwa s[82:83], v115, 0 src0_sel:WORD_1 src1_sel:WORD_0
    s_mov_b64 exec, -1
    v_mov_b32 v132, s64
    v_mbcnt_lo_u32_b32 v132, s68, v132
    v_mbcnt_hi_u32_b32 v132, s69, v132
    v_mbcnt_lo_u32_b32 v132, s70, v132
    v_mbcnt_hi_u32_b32 v132, s71, v132
    v_mbcnt_lo_u32_b32 v132, s72, v132
    v_mbcnt_hi_u32_b32 v132, s73, v132
    v_mbcnt_lo_u32_b32 v132, s74, v132
    v_mbcnt_hi_u32_b32 v132, s75, v132
    v_mbcnt_lo_u32_b32 v132, s76, v132
    v_mbcnt_hi_u32_b32 v132, s77, v132
    v_mbcnt_lo_u32_b32 v132, s78, v132
    v_mbcnt_hi_u32_b32 v132, s79, v132
    v_mbcnt_lo_u32_b32 v132, s80, v132
    v_mbcnt_hi_u32_b32 v132, s81, v132
    v_mbcnt_lo_u32_b32 v132, s82, v132
    v_mbcnt_hi_u32_b32 v132, s83, v132
    s_add_u32 s55, s64, 16
    v_readlane_b32 s66, v132, 25
    v_readlane_b32 s67, v132, 63
    s_add_u32 s64, s66, 15
    s_and_b32 s64, s64, -16
    s_max_u32 s64, s64, s55
    s_sub_u32 s66, s64, s66
    v_mad_u32_u24 v132, v145, s66, v132
    s_mov_b32 s55, s64
    v_addc_co_u32 v133, vcc, 0, v132, s[68:69]
    v_addc_co_u32 v134, vcc, 0, v133, s[70:71]
    v_addc_co_u32 v135, vcc, 0, v134, s[72:73]
    v_addc_co_u32 v136, vcc, 0, v135, s[74:75]
    v_addc_co_u32 v137, vcc, 0, v136, s[76:77]
    v_addc_co_u32 v138, vcc, 0, v137, s[78:79]
    v_addc_co_u32 v139, vcc, 0, v138, s[80:81]
    s_add_u32 s67, s67, s66
    s_add_u32 s67, s67, 15
    s_and_b32 s67, s67, -16
    s_add_u32 s64, s64, 16
    s_max_u32 s64, s64, s67
    s_mov_b64 exec, s[68:69]
    ds_write_b8 v132, v141
    s_mov_b64 exec, s[70:71]
    ds_write_b8_d16_hi v133, v141
    s_mov_b64 exec, s[72:73]
    ds_write_b8 v134, v142
    s_mov_b64 exec, s[74:75]
    ds_write_b8_d16_hi v135, v142
    s_mov_b64 exec, s[76:77]
    ds_write_b8 v136, v143
    s_mov_b64 exec, s[78:79]
    ds_write_b8_d16_hi v137, v143
    s_mov_b64 exec, s[80:81]
    ds_write_b8 v138, v144
    s_mov_b64 exec, s[82:83]
    ds_write_b8_d16_hi v139, v144
    s_mov_b64 exec, -1
    s_mov_b32 s45, s55
    s_mov_b32 s46, s64
    s_mov_b32 s94, 0
    s_mov_b64 s[84:85], -1
    s_branch L_listed
Ls_loop:
Ls_mid:
    s_bitcmp1_b32 s36, 0
    s_cbranch_scc1 Ls_ev0
Ls_evd0:
    v_mfma_f32_16x16x32_bf16 v[208:211], v[136:139], v[200:203], v[208:211]
    ds_read_b32 v246, v244 offset:0
    s_waitcnt lgkmcnt(0)
    v_bfe_u32 v247, v246, 0, 8
    v_lshlrev_b32 v247, 1, v247
    v_bfe_u32 v248, v246, 8, 8
    v_lshlrev_b32 v248, 1, v248
    v_bfe_u32 v249, v246, 16, 8
    v_lshlrev_b32 v249, 1, v249
    v_bfe_u32 v250, v246, 24, 8
    v_lshlrev_b32 v250, 1, v250
    buffer_load_ushort v247, v247, s[24:27], 0 offen
    buffer_load_ushort v248, v248, s[24:27], 0 offen
    buffer_load_ushort v249, v249, s[24:27], 0 offen
    buffer_load_ushort v250, v250, s[24:27], 0 offen
    s_waitcnt vmcnt(0)
    v_lshlrev_b32 v247, 16, v247
    v_mul_f32 v208, v208, v247
    v_lshlrev_b32 v248, 16, v248
    v_mul_f32 v209, v209, v248
    v_lshlrev_b32 v249, 16, v249
    v_mul_f32 v210, v210, v249
    v_lshlrev_b32 v250, 16, v250
    v_mul_f32 v211, v211, v250
    v_exp_f32 v132, v148
    v_exp_f32 v133, v149
    v_exp_f32 v134, v150
    v_exp_f32 v135, v151
    v_exp_f32 v136, v152
    v_exp_f32 v137, v153
    v_mfma_f32_4x4x4_16b_bf16 v[132:135], v[228:229], v[228:229], v[132:135]
    v_exp_f32 v138, v154
    v_exp_f32 v139, v155
    v_cvt_pk_bf16_f32 v208, v208, v209
    v_cvt_pk_bf16_f32 v209, v210, v211
    v_exp_f32 v140, v156
    v_exp_f32 v141, v157
    v_mfma_f32_4x4x4_16b_bf16 v[212:215], v[208:209], v[188:189], v[212:215] cbsz:4 abid:0
    v_mfma_f32_4x4x4_16b_bf16 v[136:139], v[228:229], v[228:229], v[136:139]
    v_exp_f32 v142, v158
    v_mfma_f32_4x4x4_16b_bf16 v[212:215], v[208:209], v[190:191], v[212:215] cbsz:4 abid:4
    v_exp_f32 v143, v159
    v_exp_f32 v144, v160
    v_mfma_f32_4x4x4_16b_bf16 v[212:215], v[208:209], v[192:193], v[212:215] cbsz:4 abid:8
    v_exp_f32 v145, v161
    v_mfma_f32_4x4x4_16b_bf16 v[140:143], v[228:229], v[228:229], v[140:143]
    v_mfma_f32_4x4x4_16b_bf16 v[212:215], v[208:209], v[194:195], v[212:215] cbsz:4 abid:12
    ds_add_rtn_u32 v1, v2, v3
    ds_read_u8 v230, v237 offset:64
    ds_read_u8 v232, v237 offset:72
    ds_read_b64_tr_b16 v[188:189], v236 offset:0
    ds_read_b64_tr_b16 v[190:191], v236 offset:512
    ds_read_b64_tr_b16 v[192:193], v236 offset:1056
    ds_read_b64_tr_b16 v[194:195], v236 offset:1568
    s_waitcnt vmcnt(4)
    ds_read_b128 v[180:183], v234 offset:2080
    ds_read_b128 v[184:187], v235 offset:2080
    s_add_u32 m0, s52, 0
    v_exp_f32 v146, v162
    v_exp_f32 v147, v163
    v_rcp_f32 v132, v132
    v_rcp_f32 v133, v133
    v_mfma_f32_4x4x4_16b_bf16 v[144:147], v[228:229], v[228:229], v[144:147]
    v_rcp_f32 v134, v134
    v_cvt_pk_bf16_f32 v132, v132, v133
    s_waitcnt lgkmcnt(2)
    buffer_load_dwordx4 v[230:231], s[20:23], s35 idxen offen nt lds
    buffer_load_dwordx4 v[232:233], s[40:43], s35 idxen offen offset:1056 nt lds
    s_waitcnt lgkmcnt(0)
    v_mfma_f32_16x16x32_bf16 v[148:151], v[100:103], v[180:183], v[164:167]
    v_rcp_f32 v135, v135
    v_mfma_f32_16x16x32_bf16 v[152:155], v[108:111], v[180:183], v[168:171]
    v_rcp_f32 v136, v136
    v_cvt_pk_bf16_f32 v133, v134, v135
    v_mfma_f32_16x16x32_bf16 v[148:151], v[104:107], v[184:187], v[148:151]
    v_rcp_f32 v137, v137
    v_readfirstlane_b32 s66, v1
    s_setprio 0
    s_cmp_gt_i32 s66, 0
    s_cbranch_scc0 Ls_lo0
    s_setprio 1
Ls_lo0:
    v_mfma_f32_16x16x32_bf16 v[152:155], v[112:115], v[184:187], v[152:155]
    v_rcp_f32 v138, v138
    v_cvt_pk_bf16_f32 v134, v136, v137
    v_mfma_f32_16x16x32_bf16 v[156:159], v[116:119], v[180:183], v[172:175]
    v_rcp_f32 v139, v139
    v_mfma_f32_16x16x32_bf16 v[160:163], v[124:127], v[180:183], v[176:179]
    v_rcp_f32 v140, v140
    v_cvt_pk_bf16_f32 v135, v138, v139
    v_mfma_f32_16x16x32_bf16 v[156:159], v[120:123], v[184:187], v[156:159]
    v_rcp_f32 v141, v141
    v_mfma_f32_16x16x32_bf16 v[160:163], v[128:131], v[184:187], v[160:163]
    v_rcp_f32 v142, v142
    v_cvt_pk_bf16_f32 v136, v140, v141
    v_mfma_f32_16x16x32_bf16 v[208:211], v[132:135], v[196:199], v[204:207]
    v_rcp_f32 v143, v143
    v_rcp_f32 v144, v144
    v_cvt_pk_bf16_f32 v137, v142, v143
    v_rcp_f32 v145, v145
    v_rcp_f32 v146, v146
    v_rcp_f32 v147, v147
    v_cvt_pk_bf16_f32 v138, v144, v145
    v_cvt_pk_bf16_f32 v139, v146, v147
    s_bitcmp1_b32 s36, 1
    s_cbranch_scc1 Ls_ev1
Ls_evd1:
    v_mfma_f32_16x16x32_bf16 v[208:211], v[136:139], v[200:203], v[208:211]
    ds_read_b32 v246, v244 offset:16
    s_waitcnt lgkmcnt(0)
    v_bfe_u32 v247, v246, 0, 8
    v_lshlrev_b32 v247, 1, v247
    v_bfe_u32 v248, v246, 8, 8
    v_lshlrev_b32 v248, 1, v248
    v_bfe_u32 v249, v246, 16, 8
    v_lshlrev_b32 v249, 1, v249
    v_bfe_u32 v250, v246, 24, 8
    v_lshlrev_b32 v250, 1, v250
    buffer_load_ushort v247, v247, s[24:27], 0 offen
    buffer_load_ushort v248, v248, s[24:27], 0 offen
    buffer_load_ushort v249, v249, s[24:27], 0 offen
    buffer_load_ushort v250, v250, s[24:27], 0 offen
    s_waitcnt vmcnt(0)
    v_lshlrev_b32 v247, 16, v247
    v_mul_f32 v208, v208, v247
    v_lshlrev_b32 v248, 16, v248
    v_mul_f32 v209, v209, v248
    v_lshlrev_b32 v249, 16, v249
    v_mul_f32 v210, v210, v249
    v_lshlrev_b32 v250, 16, v250
    v_mul_f32 v211, v211, v250
    v_exp_f32 v132, v148
    v_exp_f32 v133, v149
    v_exp_f32 v134, v150
    v_exp_f32 v135, v151
    v_exp_f32 v136, v152
    v_exp_f32 v137, v153
    v_mfma_f32_4x4x4_16b_bf16 v[132:135], v[228:229], v[228:229], v[132:135]
    v_exp_f32 v138, v154
    v_exp_f32 v139, v155
    v_cvt_pk_bf16_f32 v208, v208, v209
    v_cvt_pk_bf16_f32 v209, v210, v211
    v_exp_f32 v140, v156
    v_exp_f32 v141, v157
    v_mfma_f32_4x4x4_16b_bf16 v[212:215], v[208:209], v[188:189], v[212:215] cbsz:4 abid:0
    v_mfma_f32_4x4x4_16b_bf16 v[136:139], v[228:229], v[228:229], v[136:139]
    v_exp_f32 v142, v158
    v_mfma_f32_4x4x4_16b_bf16 v[212:215], v[208:209], v[190:191], v[212:215] cbsz:4 abid:4
    v_exp_f32 v143, v159
    v_exp_f32 v144, v160
    v_mfma_f32_4x4x4_16b_bf16 v[212:215], v[208:209], v[192:193], v[212:215] cbsz:4 abid:8
    v_exp_f32 v145, v161
    v_mfma_f32_4x4x4_16b_bf16 v[140:143], v[228:229], v[228:229], v[140:143]
    v_mfma_f32_4x4x4_16b_bf16 v[212:215], v[208:209], v[194:195], v[212:215] cbsz:4 abid:12
    ds_read_u8 v230, v237 offset:80
    ds_read_u8 v232, v237 offset:88
    ds_read_b64_tr_b16 v[188:189], v236 offset:2080
    ds_read_b64_tr_b16 v[190:191], v236 offset:2592
    ds_read_b64_tr_b16 v[192:193], v236 offset:3136
    ds_read_b64_tr_b16 v[194:195], v236 offset:3648
    s_waitcnt vmcnt(4)
    ds_read_b128 v[180:183], v234 offset:4160
    ds_read_b128 v[184:187], v235 offset:4160
    s_add_u32 m0, s52, 2080
    v_exp_f32 v146, v162
    v_exp_f32 v147, v163
    v_rcp_f32 v132, v132
    v_rcp_f32 v133, v133
    v_mfma_f32_4x4x4_16b_bf16 v[144:147], v[228:229], v[228:229], v[144:147]
    v_rcp_f32 v134, v134
    v_cvt_pk_bf16_f32 v132, v132, v133
    s_waitcnt lgkmcnt(2)
    buffer_load_dwordx4 v[230:231], s[20:23], s35 idxen offen nt lds
    buffer_load_dwordx4 v[232:233], s[40:43], s35 idxen offen offset:1056 nt lds
    s_waitcnt lgkmcnt(0)
    v_mfma_f32_16x16x32_bf16 v[148:151], v[100:103], v[180:183], v[164:167]
    v_rcp_f32 v135, v135
    v_mfma_f32_16x16x32_bf16 v[152:155], v[108:111], v[180:183], v[168:171]
    v_rcp_f32 v136, v136
    v_cvt_pk_bf16_f32 v133, v134, v135
    v_mfma_f32_16x16x32_bf16 v[148:151], v[104:107], v[184:187], v[148:151]
    v_rcp_f32 v137, v137
    v_mfma_f32_16x16x32_bf16 v[152:155], v[112:115], v[184:187], v[152:155]
    v_rcp_f32 v138, v138
    v_cvt_pk_bf16_f32 v134, v136, v137
    v_mfma_f32_16x16x32_bf16 v[156:159], v[116:119], v[180:183], v[172:175]
    v_rcp_f32 v139, v139
    v_mfma_f32_16x16x32_bf16 v[160:163], v[124:127], v[180:183], v[176:179]
    v_rcp_f32 v140, v140
    v_cvt_pk_bf16_f32 v135, v138, v139
    v_mfma_f32_16x16x32_bf16 v[156:159], v[120:123], v[184:187], v[156:159]
    v_rcp_f32 v141, v141
    v_mfma_f32_16x16x32_bf16 v[160:163], v[128:131], v[184:187], v[160:163]
    v_rcp_f32 v142, v142
    v_cvt_pk_bf16_f32 v136, v140, v141
    v_mfma_f32_16x16x32_bf16 v[208:211], v[132:135], v[196:199], v[204:207]
    v_rcp_f32 v143, v143
    v_rcp_f32 v144, v144
    v_cvt_pk_bf16_f32 v137, v142, v143
    v_rcp_f32 v145, v145
    v_rcp_f32 v146, v146
    v_rcp_f32 v147, v147
    v_cvt_pk_bf16_f32 v138, v144, v145
    v_cvt_pk_bf16_f32 v139, v146, v147
    s_bitcmp1_b32 s36, 2
    s_cbranch_scc1 Ls_ev2
Ls_evd2:
    v_mfma_f32_16x16x32_bf16 v[208:211], v[136:139], v[200:203], v[208:211]
    ds_read_b32 v246, v244 offset:32
    s_waitcnt lgkmcnt(0)
    v_bfe_u32 v247, v246, 0, 8
    v_lshlrev_b32 v247, 1, v247
    v_bfe_u32 v248, v246, 8, 8
    v_lshlrev_b32 v248, 1, v248
    v_bfe_u32 v249, v246, 16, 8
    v_lshlrev_b32 v249, 1, v249
    v_bfe_u32 v250, v246, 24, 8
    v_lshlrev_b32 v250, 1, v250
    buffer_load_ushort v247, v247, s[24:27], 0 offen
    buffer_load_ushort v248, v248, s[24:27], 0 offen
    buffer_load_ushort v249, v249, s[24:27], 0 offen
    buffer_load_ushort v250, v250, s[24:27], 0 offen
    s_waitcnt vmcnt(0)
    v_lshlrev_b32 v247, 16, v247
    v_mul_f32 v208, v208, v247
    v_lshlrev_b32 v248, 16, v248
    v_mul_f32 v209, v209, v248
    v_lshlrev_b32 v249, 16, v249
    v_mul_f32 v210, v210, v249
    v_lshlrev_b32 v250, 16, v250
    v_mul_f32 v211, v211, v250
    v_exp_f32 v132, v148
    v_exp_f32 v133, v149
    v_exp_f32 v134, v150
    v_exp_f32 v135, v151
    v_exp_f32 v136, v152
    v_exp_f32 v137, v153
    v_mfma_f32_4x4x4_16b_bf16 v[132:135], v[228:229], v[228:229], v[132:135]
    v_exp_f32 v138, v154
    v_exp_f32 v139, v155
    v_cvt_pk_bf16_f32 v208, v208, v209
    v_cvt_pk_bf16_f32 v209, v210, v211
    v_exp_f32 v140, v156
    v_exp_f32 v141, v157
    v_mfma_f32_4x4x4_16b_bf16 v[212:215], v[208:209], v[188:189], v[212:215] cbsz:4 abid:0
    v_mfma_f32_4x4x4_16b_bf16 v[136:139], v[228:229], v[228:229], v[136:139]
    v_exp_f32 v142, v158
    v_mfma_f32_4x4x4_16b_bf16 v[212:215], v[208:209], v[190:191], v[212:215] cbsz:4 abid:4
    v_exp_f32 v143, v159
    v_exp_f32 v144, v160
    v_mfma_f32_4x4x4_16b_bf16 v[212:215], v[208:209], v[192:193], v[212:215] cbsz:4 abid:8
    v_exp_f32 v145, v161
    v_mfma_f32_4x4x4_16b_bf16 v[140:143], v[228:229], v[228:229], v[140:143]
    v_mfma_f32_4x4x4_16b_bf16 v[212:215], v[208:209], v[194:195], v[212:215] cbsz:4 abid:12
    ds_read_u8 v230, v237 offset:96
    ds_read_u8 v232, v237 offset:104
    ds_read_b64_tr_b16 v[188:189], v236 offset:4160
    ds_read_b64_tr_b16 v[190:191], v236 offset:4672
    ds_read_b64_tr_b16 v[192:193], v236 offset:5216
    ds_read_b64_tr_b16 v[194:195], v236 offset:5728
    s_waitcnt vmcnt(4)
    ds_read_b128 v[180:183], v234 offset:6240
    ds_read_b128 v[184:187], v235 offset:6240
    s_add_u32 m0, s52, 4160
    v_exp_f32 v146, v162
    v_exp_f32 v147, v163
    v_rcp_f32 v132, v132
    v_rcp_f32 v133, v133
    v_mfma_f32_4x4x4_16b_bf16 v[144:147], v[228:229], v[228:229], v[144:147]
    v_rcp_f32 v134, v134
    v_cvt_pk_bf16_f32 v132, v132, v133
    s_waitcnt lgkmcnt(2)
    buffer_load_dwordx4 v[230:231], s[20:23], s35 idxen offen nt lds
    buffer_load_dwordx4 v[232:233], s[40:43], s35 idxen offen offset:1056 nt lds
    s_waitcnt lgkmcnt(0)
    v_mfma_f32_16x16x32_bf16 v[148:151], v[100:103], v[180:183], v[164:167]
    v_rcp_f32 v135, v135
    v_mfma_f32_16x16x32_bf16 v[152:155], v[108:111], v[180:183], v[168:171]
    v_rcp_f32 v136, v136
    v_cvt_pk_bf16_f32 v133, v134, v135
    v_mfma_f32_16x16x32_bf16 v[148:151], v[104:107], v[184:187], v[148:151]
    v_rcp_f32 v137, v137
    v_mfma_f32_16x16x32_bf16 v[152:155], v[112:115], v[184:187], v[152:155]
    v_rcp_f32 v138, v138
    v_cvt_pk_bf16_f32 v134, v136, v137
    v_mfma_f32_16x16x32_bf16 v[156:159], v[116:119], v[180:183], v[172:175]
    v_rcp_f32 v139, v139
    v_mfma_f32_16x16x32_bf16 v[160:163], v[124:127], v[180:183], v[176:179]
    v_rcp_f32 v140, v140
    v_cvt_pk_bf16_f32 v135, v138, v139
    v_mfma_f32_16x16x32_bf16 v[156:159], v[120:123], v[184:187], v[156:159]
    v_rcp_f32 v141, v141
    v_mfma_f32_16x16x32_bf16 v[160:163], v[128:131], v[184:187], v[160:163]
    v_rcp_f32 v142, v142
    v_cvt_pk_bf16_f32 v136, v140, v141
    v_mfma_f32_16x16x32_bf16 v[208:211], v[132:135], v[196:199], v[204:207]
    v_rcp_f32 v143, v143
    v_rcp_f32 v144, v144
    v_cvt_pk_bf16_f32 v137, v142, v143
    v_rcp_f32 v145, v145
    v_rcp_f32 v146, v146
    v_rcp_f32 v147, v147
    v_cvt_pk_bf16_f32 v138, v144, v145
    v_cvt_pk_bf16_f32 v139, v146, v147
    s_bitcmp1_b32 s36, 3
    s_cbranch_scc1 Ls_ev3
Ls_evd3:
    v_mfma_f32_16x16x32_bf16 v[208:211], v[136:139], v[200:203], v[208:211]
    ds_read_b32 v246, v244 offset:48
    s_waitcnt lgkmcnt(0)
    v_bfe_u32 v247, v246, 0, 8
    v_lshlrev_b32 v247, 1, v247
    v_bfe_u32 v248, v246, 8, 8
    v_lshlrev_b32 v248, 1, v248
    v_bfe_u32 v249, v246, 16, 8
    v_lshlrev_b32 v249, 1, v249
    v_bfe_u32 v250, v246, 24, 8
    v_lshlrev_b32 v250, 1, v250
    buffer_load_ushort v247, v247, s[24:27], 0 offen
    buffer_load_ushort v248, v248, s[24:27], 0 offen
    buffer_load_ushort v249, v249, s[24:27], 0 offen
    buffer_load_ushort v250, v250, s[24:27], 0 offen
    s_waitcnt vmcnt(0)
    v_lshlrev_b32 v247, 16, v247
    v_mul_f32 v208, v208, v247
    v_lshlrev_b32 v248, 16, v248
    v_mul_f32 v209, v209, v248
    v_lshlrev_b32 v249, 16, v249
    v_mul_f32 v210, v210, v249
    v_lshlrev_b32 v250, 16, v250
    v_mul_f32 v211, v211, v250
    v_exp_f32 v132, v148
    v_exp_f32 v133, v149
    v_exp_f32 v134, v150
    v_exp_f32 v135, v151
    v_exp_f32 v136, v152
    v_exp_f32 v137, v153
    v_mfma_f32_4x4x4_16b_bf16 v[132:135], v[228:229], v[228:229], v[132:135]
    v_exp_f32 v138, v154
    v_exp_f32 v139, v155
    v_cvt_pk_bf16_f32 v208, v208, v209
    v_cvt_pk_bf16_f32 v209, v210, v211
    v_exp_f32 v140, v156
    v_exp_f32 v141, v157
    v_mfma_f32_4x4x4_16b_bf16 v[212:215], v[208:209], v[188:189], v[212:215] cbsz:4 abid:0
    v_mfma_f32_4x4x4_16b_bf16 v[136:139], v[228:229], v[228:229], v[136:139]
    v_exp_f32 v142, v158
    v_mfma_f32_4x4x4_16b_bf16 v[212:215], v[208:209], v[190:191], v[212:215] cbsz:4 abid:4
    v_exp_f32 v143, v159
    v_exp_f32 v144, v160
    v_mfma_f32_4x4x4_16b_bf16 v[212:215], v[208:209], v[192:193], v[212:215] cbsz:4 abid:8
    v_exp_f32 v145, v161
    v_mfma_f32_4x4x4_16b_bf16 v[140:143], v[228:229], v[228:229], v[140:143]
    v_mfma_f32_4x4x4_16b_bf16 v[212:215], v[208:209], v[194:195], v[212:215] cbsz:4 abid:12
    ds_read_u8 v230, v237 offset:112
    ds_read_u8 v232, v237 offset:120
    ds_read_b64_tr_b16 v[188:189], v236 offset:6240
    ds_read_b64_tr_b16 v[190:191], v236 offset:6752
    ds_read_b64_tr_b16 v[192:193], v236 offset:7296
    ds_read_b64_tr_b16 v[194:195], v236 offset:7808
    s_waitcnt vmcnt(4)
    ds_read_b128 v[180:183], v234 offset:0
    ds_read_b128 v[184:187], v235 offset:0
    s_add_u32 m0, s52, 6240
    v_exp_f32 v146, v162
    v_exp_f32 v147, v163
    v_rcp_f32 v132, v132
    v_rcp_f32 v133, v133
    v_mfma_f32_4x4x4_16b_bf16 v[144:147], v[228:229], v[228:229], v[144:147]
    v_rcp_f32 v134, v134
    v_cvt_pk_bf16_f32 v132, v132, v133
    s_waitcnt lgkmcnt(2)
    buffer_load_dwordx4 v[230:231], s[20:23], s35 idxen offen nt lds
    buffer_load_dwordx4 v[232:233], s[40:43], s35 idxen offen offset:1056 nt lds
    s_waitcnt lgkmcnt(0)
    v_mfma_f32_16x16x32_bf16 v[148:151], v[100:103], v[180:183], v[164:167]
    v_rcp_f32 v135, v135
    v_mfma_f32_16x16x32_bf16 v[152:155], v[108:111], v[180:183], v[168:171]
    v_rcp_f32 v136, v136
    v_cvt_pk_bf16_f32 v133, v134, v135
    v_mfma_f32_16x16x32_bf16 v[148:151], v[104:107], v[184:187], v[148:151]
    v_rcp_f32 v137, v137
    v_mfma_f32_16x16x32_bf16 v[152:155], v[112:115], v[184:187], v[152:155]
    v_rcp_f32 v138, v138
    v_cvt_pk_bf16_f32 v134, v136, v137
    v_mfma_f32_16x16x32_bf16 v[156:159], v[116:119], v[180:183], v[172:175]
    v_rcp_f32 v139, v139
    v_mfma_f32_16x16x32_bf16 v[160:163], v[124:127], v[180:183], v[176:179]
    v_rcp_f32 v140, v140
    v_cvt_pk_bf16_f32 v135, v138, v139
    v_mfma_f32_16x16x32_bf16 v[156:159], v[120:123], v[184:187], v[156:159]
    v_rcp_f32 v141, v141
    v_mfma_f32_16x16x32_bf16 v[160:163], v[128:131], v[184:187], v[160:163]
    v_rcp_f32 v142, v142
    v_cvt_pk_bf16_f32 v136, v140, v141
    v_mfma_f32_16x16x32_bf16 v[208:211], v[132:135], v[196:199], v[204:207]
    v_rcp_f32 v143, v143
    v_rcp_f32 v144, v144
    v_cvt_pk_bf16_f32 v137, v142, v143
    s_lshr_b64 s[56:57], s[56:57], 4
    s_lshl_b64 s[86:87], s[58:59], 60
    s_or_b64 s[56:57], s[56:57], s[86:87]
    s_lshr_b64 s[58:59], s[58:59], 4
    s_lshr_b64 s[86:87], s[56:57], 2
    s_lshr_b64 s[36:37], s[56:57], 5
    s_or_b32 s36, s36, s86
    s_or_b32 s36, s36, s56
    v_add_u32 v237, 64, v237
    v_add_u32 v244, 64, v244
    v_rcp_f32 v145, v145
    v_rcp_f32 v146, v146
    v_rcp_f32 v147, v147
    v_cvt_pk_bf16_f32 v138, v144, v145
    v_cvt_pk_bf16_f32 v139, v146, v147
    s_branch Ls_loop
Ls_ev0:
    s_bitcmp0_b64 s[56:57], 0
    s_cbranch_scc1 Ls_nf0
    v_cvt_pk_bf16_f32 v246, v212, v212
    v_mov_b32 v212, 0
    ds_write_b16 v240, v246
    v_add_u32 v240, 128, v240
    s_add_u32 s24, s24, s32
    s_addc_u32 s25, s25, 0
    s_xor_b32 s32, s32, 0x18ffe0
Ls_nf0:
    s_bitcmp0_b64 s[56:57], 5
    s_cbranch_scc1 Ls_na0
    s_sub_u32 s60, s60, 1
    s_cbranch_scc0 Ls_ns0
    s_mov_b32 s49, 5
    s_call_b64 s[62:63], L_swap
    s_add_u32 s35, s35, s31
    s_min_u32 s35, s35, 419404800
    s_xor_b32 s31, s31, 0x63ff800
    s_bitcmp0_b64 s[56:57], 2
    s_cbranch_scc1 Ls_evd0
    s_waitcnt lgkmcnt(0)
    s_branch Ls_e10
Ls_ns0:
    s_add_u32 s35, s35, s31
    s_min_u32 s35, s35, 419404800
    s_xor_b32 s31, s31, 0x63ff800
Ls_na0:
    s_bitcmp0_b64 s[56:57], 2
    s_cbranch_scc1 Ls_evd0
Ls_e10:
    s_sub_u32 s61, s61, 1
    s_cbranch_scc1 Ls_last0
    s_cmp_lg_u32 s61, s45
    s_cbranch_scc1 Ls_nw0
    v_add_u32 v238, s47, v238
    v_add_u32 v239, s47, v239
    ds_read_u16 v224, v238 offset:0
    ds_read_u16 v225, v238 offset:8
    ds_read_u16 v226, v238 offset:64
    ds_read_u16 v227, v238 offset:72
    s_waitcnt lgkmcnt(0)
Ls_nw0:
    v_mul_u32_u24 v216, v224, v241
    v_mul_u32_u24 v217, v224, v242
    v_mul_u32_u24 v218, v225, v241
    v_mul_u32_u24 v219, v225, v242
    v_mul_u32_u24 v220, v226, v241
    v_mul_u32_u24 v221, v226, v242
    v_mul_u32_u24 v222, v227, v241
    v_mul_u32_u24 v223, v227, v242
    v_mfma_f32_4x4x4_16b_bf16 v[140:143], v[216:217], v[68:69], v[4:7]
    v_add_u32 v238, 128, v238
    ds_read_b128 v[164:167], v239 offset:0
    ds_read_b128 v[168:171], v239 offset:64
    v_mfma_f32_4x4x4_16b_bf16 v[144:147], v[218:219], v[70:71], v[8:11]
    ds_read_b128 v[172:175], v239 offset:128
    ds_read_b128 v[176:179], v239 offset:192
    ds_read_u16 v224, v238 offset:0
    ds_read_u16 v225, v238 offset:8
    ds_read_u16 v226, v238 offset:64
    ds_read_u16 v227, v238 offset:72
    v_mfma_f32_4x4x4_16b_bf16 v[246:249], v[220:221], v[72:73], v[12:15]
    v_cvt_pk_bf16_f32 v100, v140, v141
    v_cvt_pk_bf16_f32 v101, v142, v143
    v_mfma_f32_4x4x4_16b_bf16 v[250:253], v[222:223], v[74:75], v[16:19]
    v_cvt_pk_bf16_f32 v102, v144, v145
    v_cvt_pk_bf16_f32 v103, v146, v147
    v_mfma_f32_4x4x4_16b_bf16 v[140:143], v[216:217], v[76:77], v[20:23]
    v_cvt_pk_bf16_f32 v104, v246, v247
    v_cvt_pk_bf16_f32 v105, v248, v249
    v_mfma_f32_4x4x4_16b_bf16 v[144:147], v[218:219], v[78:79], v[24:27]
    v_cvt_pk_bf16_f32 v106, v250, v251
    v_cvt_pk_bf16_f32 v107, v252, v253
    v_mfma_f32_4x4x4_16b_bf16 v[246:249], v[220:221], v[80:81], v[28:31]
    v_cvt_pk_bf16_f32 v108, v140, v141
    v_cvt_pk_bf16_f32 v109, v142, v143
    v_mfma_f32_4x4x4_16b_bf16 v[250:253], v[222:223], v[82:83], v[32:35]
    v_cvt_pk_bf16_f32 v110, v144, v145
    v_cvt_pk_bf16_f32 v111, v146, v147
    v_mfma_f32_4x4x4_16b_bf16 v[140:143], v[216:217], v[84:85], v[36:39]
    v_cvt_pk_bf16_f32 v112, v246, v247
    v_cvt_pk_bf16_f32 v113, v248, v249
    v_mfma_f32_4x4x4_16b_bf16 v[144:147], v[218:219], v[86:87], v[40:43]
    v_cvt_pk_bf16_f32 v114, v250, v251
    v_cvt_pk_bf16_f32 v115, v252, v253
    v_mfma_f32_4x4x4_16b_bf16 v[246:249], v[220:221], v[88:89], v[44:47]
    v_cvt_pk_bf16_f32 v116, v140, v141
    v_cvt_pk_bf16_f32 v117, v142, v143
    v_mfma_f32_4x4x4_16b_bf16 v[250:253], v[222:223], v[90:91], v[48:51]
    v_cvt_pk_bf16_f32 v118, v144, v145
    v_cvt_pk_bf16_f32 v119, v146, v147
    v_mfma_f32_4x4x4_16b_bf16 v[140:143], v[216:217], v[92:93], v[52:55]
    v_cvt_pk_bf16_f32 v120, v246, v247
    v_cvt_pk_bf16_f32 v121, v248, v249
    v_mfma_f32_4x4x4_16b_bf16 v[144:147], v[218:219], v[94:95], v[56:59]
    v_cvt_pk_bf16_f32 v122, v250, v251
    v_cvt_pk_bf16_f32 v123, v252, v253
    v_mfma_f32_4x4x4_16b_bf16 v[246:249], v[220:221], v[96:97], v[60:63]
    v_cvt_pk_bf16_f32 v124, v140, v141
    v_cvt_pk_bf16_f32 v125, v142, v143
    v_mfma_f32_4x4x4_16b_bf16 v[250:253], v[222:223], v[98:99], v[64:67]
    v_cvt_pk_bf16_f32 v126, v144, v145
    v_cvt_pk_bf16_f32 v127, v146, v147
    v_cvt_pk_bf16_f32 v128, v246, v247
    v_cvt_pk_bf16_f32 v129, v248, v249
    v_add_u32 v239, 272, v239
    v_cvt_pk_bf16_f32 v130, v250, v251
    v_cvt_pk_bf16_f32 v131, v252, v253
    s_waitcnt lgkmcnt(0)
    s_branch Ls_evd0
Ls_ev1:
    s_bitcmp0_b64 s[56:57], 1
    s_cbranch_scc1 Ls_nf1
    v_cvt_pk_bf16_f32 v246, v212, v212
    v_mov_b32 v212, 0
    ds_write_b16 v240, v246
    v_add_u32 v240, 128, v240
    s_add_u32 s24, s24, s32
    s_addc_u32 s25, s25, 0
    s_xor_b32 s32, s32, 0x18ffe0
Ls_nf1:
    s_bitcmp0_b64 s[56:57], 6
    s_cbranch_scc1 Ls_na1
    s_sub_u32 s60, s60, 1
    s_cbranch_scc0 Ls_ns1
    s_mov_b32 s49, 6
    s_call_b64 s[62:63], L_swap
    s_add_u32 s35, s35, s31
    s_min_u32 s35, s35, 419404800
    s_xor_b32 s31, s31, 0x63ff800
    s_bitcmp0_b64 s[56:57], 3
    s_cbranch_scc1 Ls_evd1
    s_waitcnt lgkmcnt(0)
    s_branch Ls_e11
Ls_ns1:
    s_add_u32 s35, s35, s31
    s_min_u32 s35, s35, 419404800
    s_xor_b32 s31, s31, 0x63ff800
Ls_na1:
    s_bitcmp0_b64 s[56:57], 3
    s_cbranch_scc1 Ls_evd1
Ls_e11:
    s_sub_u32 s61, s61, 1
    s_cbranch_scc1 Ls_last1
    s_cmp_lg_u32 s61, s45
    s_cbranch_scc1 Ls_nw1
    v_add_u32 v238, s47, v238
    v_add_u32 v239, s47, v239
    ds_read_u16 v224, v238 offset:0
    ds_read_u16 v225, v238 offset:8
    ds_read_u16 v226, v238 offset:64
    ds_read_u16 v227, v238 offset:72
    s_waitcnt lgkmcnt(0)
Ls_nw1:
    v_mul_u32_u24 v216, v224, v241
    v_mul_u32_u24 v217, v224, v242
    v_mul_u32_u24 v218, v225, v241
    v_mul_u32_u24 v219, v225, v242
    v_mul_u32_u24 v220, v226, v241
    v_mul_u32_u24 v221, v226, v242
    v_mul_u32_u24 v222, v227, v241
    v_mul_u32_u24 v223, v227, v242
    v_mfma_f32_4x4x4_16b_bf16 v[140:143], v[216:217], v[68:69], v[4:7]
    v_add_u32 v238, 128, v238
    ds_read_b128 v[164:167], v239 offset:0
    ds_read_b128 v[168:171], v239 offset:64
    v_mfma_f32_4x4x4_16b_bf16 v[144:147], v[218:219], v[70:71], v[8:11]
    ds_read_b128 v[172:175], v239 offset:128
    ds_read_b128 v[176:179], v239 offset:192
    ds_read_u16 v224, v238 offset:0
    ds_read_u16 v225, v238 offset:8
    ds_read_u16 v226, v238 offset:64
    ds_read_u16 v227, v238 offset:72
    v_mfma_f32_4x4x4_16b_bf16 v[246:249], v[220:221], v[72:73], v[12:15]
    v_cvt_pk_bf16_f32 v100, v140, v141
    v_cvt_pk_bf16_f32 v101, v142, v143
    v_mfma_f32_4x4x4_16b_bf16 v[250:253], v[222:223], v[74:75], v[16:19]
    v_cvt_pk_bf16_f32 v102, v144, v145
    v_cvt_pk_bf16_f32 v103, v146, v147
    v_mfma_f32_4x4x4_16b_bf16 v[140:143], v[216:217], v[76:77], v[20:23]
    v_cvt_pk_bf16_f32 v104, v246, v247
    v_cvt_pk_bf16_f32 v105, v248, v249
    v_mfma_f32_4x4x4_16b_bf16 v[144:147], v[218:219], v[78:79], v[24:27]
    v_cvt_pk_bf16_f32 v106, v250, v251
    v_cvt_pk_bf16_f32 v107, v252, v253
    v_mfma_f32_4x4x4_16b_bf16 v[246:249], v[220:221], v[80:81], v[28:31]
    v_cvt_pk_bf16_f32 v108, v140, v141
    v_cvt_pk_bf16_f32 v109, v142, v143
    v_mfma_f32_4x4x4_16b_bf16 v[250:253], v[222:223], v[82:83], v[32:35]
    v_cvt_pk_bf16_f32 v110, v144, v145
    v_cvt_pk_bf16_f32 v111, v146, v147
    v_mfma_f32_4x4x4_16b_bf16 v[140:143], v[216:217], v[84:85], v[36:39]
    v_cvt_pk_bf16_f32 v112, v246, v247
    v_cvt_pk_bf16_f32 v113, v248, v249
    v_mfma_f32_4x4x4_16b_bf16 v[144:147], v[218:219], v[86:87], v[40:43]
    v_cvt_pk_bf16_f32 v114, v250, v251
    v_cvt_pk_bf16_f32 v115, v252, v253
    v_mfma_f32_4x4x4_16b_bf16 v[246:249], v[220:221], v[88:89], v[44:47]
    v_cvt_pk_bf16_f32 v116, v140, v141
    v_cvt_pk_bf16_f32 v117, v142, v143
    v_mfma_f32_4x4x4_16b_bf16 v[250:253], v[222:223], v[90:91], v[48:51]
    v_cvt_pk_bf16_f32 v118, v144, v145
    v_cvt_pk_bf16_f32 v119, v146, v147
    v_mfma_f32_4x4x4_16b_bf16 v[140:143], v[216:217], v[92:93], v[52:55]
    v_cvt_pk_bf16_f32 v120, v246, v247
    v_cvt_pk_bf16_f32 v121, v248, v249
    v_mfma_f32_4x4x4_16b_bf16 v[144:147], v[218:219], v[94:95], v[56:59]
    v_cvt_pk_bf16_f32 v122, v250, v251
    v_cvt_pk_bf16_f32 v123, v252, v253
    v_mfma_f32_4x4x4_16b_bf16 v[246:249], v[220:221], v[96:97], v[60:63]
    v_cvt_pk_bf16_f32 v124, v140, v141
    v_cvt_pk_bf16_f32 v125, v142, v143
    v_mfma_f32_4x4x4_16b_bf16 v[250:253], v[222:223], v[98:99], v[64:67]
    v_cvt_pk_bf16_f32 v126, v144, v145
    v_cvt_pk_bf16_f32 v127, v146, v147
    v_cvt_pk_bf16_f32 v128, v246, v247
    v_cvt_pk_bf16_f32 v129, v248, v249
    v_add_u32 v239, 272, v239
    v_cvt_pk_bf16_f32 v130, v250, v251
    v_cvt_pk_bf16_f32 v131, v252, v253
    s_waitcnt lgkmcnt(0)
    s_branch Ls_evd1
Ls_ev2:
    s_bitcmp0_b64 s[56:57], 2
    s_cbranch_scc1 Ls_nf2
    v_cvt_pk_bf16_f32 v246, v212, v212
    v_mov_b32 v212, 0
    ds_write_b16 v240, v246
    v_add_u32 v240, 128, v240
    s_add_u32 s24, s24, s32
    s_addc_u32 s25, s25, 0
    s_xor_b32 s32, s32, 0x18ffe0
Ls_nf2:
    s_bitcmp0_b64 s[56:57], 7
    s_cbranch_scc1 Ls_na2
    s_sub_u32 s60, s60, 1
    s_cbranch_scc0 Ls_ns2
    s_mov_b32 s49, 7
    s_call_b64 s[62:63], L_swap
    s_add_u32 s35, s35, s31
    s_min_u32 s35, s35, 419404800
    s_xor_b32 s31, s31, 0x63ff800
    s_bitcmp0_b64 s[56:57], 4
    s_cbranch_scc1 Ls_evd2
    s_waitcnt lgkmcnt(0)
    s_branch Ls_e12
Ls_ns2:
    s_add_u32 s35, s35, s31
    s_min_u32 s35, s35, 419404800
    s_xor_b32 s31, s31, 0x63ff800
Ls_na2:
    s_bitcmp0_b64 s[56:57], 4
    s_cbranch_scc1 Ls_evd2
Ls_e12:
    s_sub_u32 s61, s61, 1
    s_cbranch_scc1 Ls_last2
    s_cmp_lg_u32 s61, s45
    s_cbranch_scc1 Ls_nw2
    v_add_u32 v238, s47, v238
    v_add_u32 v239, s47, v239
    ds_read_u16 v224, v238 offset:0
    ds_read_u16 v225, v238 offset:8
    ds_read_u16 v226, v238 offset:64
    ds_read_u16 v227, v238 offset:72
    s_waitcnt lgkmcnt(0)
Ls_nw2:
    v_mul_u32_u24 v216, v224, v241
    v_mul_u32_u24 v217, v224, v242
    v_mul_u32_u24 v218, v225, v241
    v_mul_u32_u24 v219, v225, v242
    v_mul_u32_u24 v220, v226, v241
    v_mul_u32_u24 v221, v226, v242
    v_mul_u32_u24 v222, v227, v241
    v_mul_u32_u24 v223, v227, v242
    v_mfma_f32_4x4x4_16b_bf16 v[140:143], v[216:217], v[68:69], v[4:7]
    v_add_u32 v238, 128, v238
    ds_read_b128 v[164:167], v239 offset:0
    ds_read_b128 v[168:171], v239 offset:64
    v_mfma_f32_4x4x4_16b_bf16 v[144:147], v[218:219], v[70:71], v[8:11]
    ds_read_b128 v[172:175], v239 offset:128
    ds_read_b128 v[176:179], v239 offset:192
    ds_read_u16 v224, v238 offset:0
    ds_read_u16 v225, v238 offset:8
    ds_read_u16 v226, v238 offset:64
    ds_read_u16 v227, v238 offset:72
    v_mfma_f32_4x4x4_16b_bf16 v[246:249], v[220:221], v[72:73], v[12:15]
    v_cvt_pk_bf16_f32 v100, v140, v141
    v_cvt_pk_bf16_f32 v101, v142, v143
    v_mfma_f32_4x4x4_16b_bf16 v[250:253], v[222:223], v[74:75], v[16:19]
    v_cvt_pk_bf16_f32 v102, v144, v145
    v_cvt_pk_bf16_f32 v103, v146, v147
    v_mfma_f32_4x4x4_16b_bf16 v[140:143], v[216:217], v[76:77], v[20:23]
    v_cvt_pk_bf16_f32 v104, v246, v247
    v_cvt_pk_bf16_f32 v105, v248, v249
    v_mfma_f32_4x4x4_16b_bf16 v[144:147], v[218:219], v[78:79], v[24:27]
    v_cvt_pk_bf16_f32 v106, v250, v251
    v_cvt_pk_bf16_f32 v107, v252, v253
    v_mfma_f32_4x4x4_16b_bf16 v[246:249], v[220:221], v[80:81], v[28:31]
    v_cvt_pk_bf16_f32 v108, v140, v141
    v_cvt_pk_bf16_f32 v109, v142, v143
    v_mfma_f32_4x4x4_16b_bf16 v[250:253], v[222:223], v[82:83], v[32:35]
    v_cvt_pk_bf16_f32 v110, v144, v145
    v_cvt_pk_bf16_f32 v111, v146, v147
    v_mfma_f32_4x4x4_16b_bf16 v[140:143], v[216:217], v[84:85], v[36:39]
    v_cvt_pk_bf16_f32 v112, v246, v247
    v_cvt_pk_bf16_f32 v113, v248, v249
    v_mfma_f32_4x4x4_16b_bf16 v[144:147], v[218:219], v[86:87], v[40:43]
    v_cvt_pk_bf16_f32 v114, v250, v251
    v_cvt_pk_bf16_f32 v115, v252, v253
    v_mfma_f32_4x4x4_16b_bf16 v[246:249], v[220:221], v[88:89], v[44:47]
    v_cvt_pk_bf16_f32 v116, v140, v141
    v_cvt_pk_bf16_f32 v117, v142, v143
    v_mfma_f32_4x4x4_16b_bf16 v[250:253], v[222:223], v[90:91], v[48:51]
    v_cvt_pk_bf16_f32 v118, v144, v145
    v_cvt_pk_bf16_f32 v119, v146, v147
    v_mfma_f32_4x4x4_16b_bf16 v[140:143], v[216:217], v[92:93], v[52:55]
    v_cvt_pk_bf16_f32 v120, v246, v247
    v_cvt_pk_bf16_f32 v121, v248, v249
    v_mfma_f32_4x4x4_16b_bf16 v[144:147], v[218:219], v[94:95], v[56:59]
    v_cvt_pk_bf16_f32 v122, v250, v251
    v_cvt_pk_bf16_f32 v123, v252, v253
    v_mfma_f32_4x4x4_16b_bf16 v[246:249], v[220:221], v[96:97], v[60:63]
    v_cvt_pk_bf16_f32 v124, v140, v141
    v_cvt_pk_bf16_f32 v125, v142, v143
    v_mfma_f32_4x4x4_16b_bf16 v[250:253], v[222:223], v[98:99], v[64:67]
    v_cvt_pk_bf16_f32 v126, v144, v145
    v_cvt_pk_bf16_f32 v127, v146, v147
    v_cvt_pk_bf16_f32 v128, v246, v247
    v_cvt_pk_bf16_f32 v129, v248, v249
    v_add_u32 v239, 272, v239
    v_cvt_pk_bf16_f32 v130, v250, v251
    v_cvt_pk_bf16_f32 v131, v252, v253
    s_waitcnt lgkmcnt(0)
    s_branch Ls_evd2
Ls_ev3:
    s_bitcmp0_b64 s[56:57], 3
    s_cbranch_scc1 Ls_nf3
    v_cvt_pk_bf16_f32 v246, v212, v212
    v_mov_b32 v212, 0
    ds_write_b16 v240, v246
    v_add_u32 v240, 128, v240
    s_add_u32 s24, s24, s32
    s_addc_u32 s25, s25, 0
    s_xor_b32 s32, s32, 0x18ffe0
Ls_nf3:
    s_bitcmp0_b64 s[56:57], 8
    s_cbranch_scc1 Ls_na3
    s_sub_u32 s60, s60, 1
    s_cbranch_scc0 Ls_ns3
    s_mov_b32 s49, 8
    s_call_b64 s[62:63], L_swap
    s_add_u32 s35, s35, s31
    s_min_u32 s35, s35, 419404800
    s_xor_b32 s31, s31, 0x63ff800
    s_bitcmp0_b64 s[56:57], 5
    s_cbranch_scc1 Ls_evd3
    s_waitcnt lgkmcnt(0)
    s_branch Ls_e13
Ls_ns3:
    s_add_u32 s35, s35, s31
    s_min_u32 s35, s35, 419404800
    s_xor_b32 s31, s31, 0x63ff800
Ls_na3:
    s_bitcmp0_b64 s[56:57], 5
    s_cbranch_scc1 Ls_evd3
Ls_e13:
    s_sub_u32 s61, s61, 1
    s_cbranch_scc1 Ls_last3
    s_cmp_lg_u32 s61, s45
    s_cbranch_scc1 Ls_nw3
    v_add_u32 v238, s47, v238
    v_add_u32 v239, s47, v239
    ds_read_u16 v224, v238 offset:0
    ds_read_u16 v225, v238 offset:8
    ds_read_u16 v226, v238 offset:64
    ds_read_u16 v227, v238 offset:72
    s_waitcnt lgkmcnt(0)
Ls_nw3:
    v_mul_u32_u24 v216, v224, v241
    v_mul_u32_u24 v217, v224, v242
    v_mul_u32_u24 v218, v225, v241
    v_mul_u32_u24 v219, v225, v242
    v_mul_u32_u24 v220, v226, v241
    v_mul_u32_u24 v221, v226, v242
    v_mul_u32_u24 v222, v227, v241
    v_mul_u32_u24 v223, v227, v242
    v_mfma_f32_4x4x4_16b_bf16 v[140:143], v[216:217], v[68:69], v[4:7]
    v_add_u32 v238, 128, v238
    ds_read_b128 v[164:167], v239 offset:0
    ds_read_b128 v[168:171], v239 offset:64
    v_mfma_f32_4x4x4_16b_bf16 v[144:147], v[218:219], v[70:71], v[8:11]
    ds_read_b128 v[172:175], v239 offset:128
    ds_read_b128 v[176:179], v239 offset:192
    ds_read_u16 v224, v238 offset:0
    ds_read_u16 v225, v238 offset:8
    ds_read_u16 v226, v238 offset:64
    ds_read_u16 v227, v238 offset:72
    v_mfma_f32_4x4x4_16b_bf16 v[246:249], v[220:221], v[72:73], v[12:15]
    v_cvt_pk_bf16_f32 v100, v140, v141
    v_cvt_pk_bf16_f32 v101, v142, v143
    v_mfma_f32_4x4x4_16b_bf16 v[250:253], v[222:223], v[74:75], v[16:19]
    v_cvt_pk_bf16_f32 v102, v144, v145
    v_cvt_pk_bf16_f32 v103, v146, v147
    v_mfma_f32_4x4x4_16b_bf16 v[140:143], v[216:217], v[76:77], v[20:23]
    v_cvt_pk_bf16_f32 v104, v246, v247
    v_cvt_pk_bf16_f32 v105, v248, v249
    v_mfma_f32_4x4x4_16b_bf16 v[144:147], v[218:219], v[78:79], v[24:27]
    v_cvt_pk_bf16_f32 v106, v250, v251
    v_cvt_pk_bf16_f32 v107, v252, v253
    v_mfma_f32_4x4x4_16b_bf16 v[246:249], v[220:221], v[80:81], v[28:31]
    v_cvt_pk_bf16_f32 v108, v140, v141
    v_cvt_pk_bf16_f32 v109, v142, v143
    v_mfma_f32_4x4x4_16b_bf16 v[250:253], v[222:223], v[82:83], v[32:35]
    v_cvt_pk_bf16_f32 v110, v144, v145
    v_cvt_pk_bf16_f32 v111, v146, v147
    v_mfma_f32_4x4x4_16b_bf16 v[140:143], v[216:217], v[84:85], v[36:39]
    v_cvt_pk_bf16_f32 v112, v246, v247
    v_cvt_pk_bf16_f32 v113, v248, v249
    v_mfma_f32_4x4x4_16b_bf16 v[144:147], v[218:219], v[86:87], v[40:43]
    v_cvt_pk_bf16_f32 v114, v250, v251
    v_cvt_pk_bf16_f32 v115, v252, v253
    v_mfma_f32_4x4x4_16b_bf16 v[246:249], v[220:221], v[88:89], v[44:47]
    v_cvt_pk_bf16_f32 v116, v140, v141
    v_cvt_pk_bf16_f32 v117, v142, v143
    v_mfma_f32_4x4x4_16b_bf16 v[250:253], v[222:223], v[90:91], v[48:51]
    v_cvt_pk_bf16_f32 v118, v144, v145
    v_cvt_pk_bf16_f32 v119, v146, v147
    v_mfma_f32_4x4x4_16b_bf16 v[140:143], v[216:217], v[92:93], v[52:55]
    v_cvt_pk_bf16_f32 v120, v246, v247
    v_cvt_pk_bf16_f32 v121, v248, v249
    v_mfma_f32_4x4x4_16b_bf16 v[144:147], v[218:219], v[94:95], v[56:59]
    v_cvt_pk_bf16_f32 v122, v250, v251
    v_cvt_pk_bf16_f32 v123, v252, v253
    v_mfma_f32_4x4x4_16b_bf16 v[246:249], v[220:221], v[96:97], v[60:63]
    v_cvt_pk_bf16_f32 v124, v140, v141
    v_cvt_pk_bf16_f32 v125, v142, v143
    v_mfma_f32_4x4x4_16b_bf16 v[250:253], v[222:223], v[98:99], v[64:67]
    v_cvt_pk_bf16_f32 v126, v144, v145
    v_cvt_pk_bf16_f32 v127, v146, v147
    v_cvt_pk_bf16_f32 v128, v246, v247
    v_cvt_pk_bf16_f32 v129, v248, v249
    v_add_u32 v239, 272, v239
    v_cvt_pk_bf16_f32 v130, v250, v251
    v_cvt_pk_bf16_f32 v131, v252, v253
    s_waitcnt lgkmcnt(0)
    s_branch Ls_evd3
Ls_last0:
    s_branch Ls_tail
Ls_last1:
    v_add_u32 v236, 2080, v236
    s_lshr_b64 s[56:57], s[56:57], 1
    v_add_u32 v244, 16, v244
    s_branch Ls_tail
Ls_last2:
    v_add_u32 v236, 4160, v236
    s_lshr_b64 s[56:57], s[56:57], 2
    v_add_u32 v244, 32, v244
    s_branch Ls_tail
Ls_last3:
    v_add_u32 v236, 6240, v236
    s_lshr_b64 s[56:57], s[56:57], 3
    v_add_u32 v244, 48, v244
Ls_tail:
    v_mfma_f32_16x16x32_bf16 v[208:211], v[136:139], v[200:203], v[208:211]
    ds_read_b32 v246, v244 offset:0
    s_waitcnt lgkmcnt(0)
    v_bfe_u32 v247, v246, 0, 8
    v_lshlrev_b32 v247, 1, v247
    v_bfe_u32 v248, v246, 8, 8
    v_lshlrev_b32 v248, 1, v248
    v_bfe_u32 v249, v246, 16, 8
    v_lshlrev_b32 v249, 1, v249
    v_bfe_u32 v250, v246, 24, 8
    v_lshlrev_b32 v250, 1, v250
    buffer_load_ushort v247, v247, s[24:27], 0 offen
    buffer_load_ushort v248, v248, s[24:27], 0 offen
    buffer_load_ushort v249, v249, s[24:27], 0 offen
    buffer_load_ushort v250, v250, s[24:27], 0 offen
    s_waitcnt vmcnt(0)
    v_lshlrev_b32 v247, 16, v247
    v_mul_f32 v208, v208, v247
    v_lshlrev_b32 v248, 16, v248
    v_mul_f32 v209, v209, v248
    v_lshlrev_b32 v249, 16, v249
    v_mul_f32 v210, v210, v249
    v_lshlrev_b32 v250, 16, v250
    v_mul_f32 v211, v211, v250
    v_exp_f32 v132, v148
    v_exp_f32 v133, v149
    v_exp_f32 v134, v150
    v_exp_f32 v135, v151
    v_exp_f32 v136, v152
    v_exp_f32 v137, v153
    v_mfma_f32_4x4x4_16b_bf16 v[132:135], v[228:229], v[228:229], v[132:135]
    v_exp_f32 v138, v154
    v_exp_f32 v139, v155
    v_cvt_pk_bf16_f32 v208, v208, v209
    v_cvt_pk_bf16_f32 v209, v210, v211
    v_exp_f32 v140, v156
    v_exp_f32 v141, v157
    v_mfma_f32_4x4x4_16b_bf16 v[212:215], v[208:209], v[188:189], v[212:215] cbsz:4 abid:0
    v_mfma_f32_4x4x4_16b_bf16 v[136:139], v[228:229], v[228:229], v[136:139]
    v_exp_f32 v142, v158
    v_mfma_f32_4x4x4_16b_bf16 v[212:215], v[208:209], v[190:191], v[212:215] cbsz:4 abid:4
    v_exp_f32 v143, v159
    v_exp_f32 v144, v160
    v_mfma_f32_4x4x4_16b_bf16 v[212:215], v[208:209], v[192:193], v[212:215] cbsz:4 abid:8
    v_exp_f32 v145, v161
    v_mfma_f32_4x4x4_16b_bf16 v[140:143], v[228:229], v[228:229], v[140:143]
    v_mfma_f32_4x4x4_16b_bf16 v[212:215], v[208:209], v[194:195], v[212:215] cbsz:4 abid:12
    ds_read_b64_tr_b16 v[188:189], v236 offset:0
    ds_read_b64_tr_b16 v[190:191], v236 offset:512
    ds_read_b64_tr_b16 v[192:193], v236 offset:1056
    ds_read_b64_tr_b16 v[194:195], v236 offset:1568
    v_exp_f32 v146, v162
    v_exp_f32 v147, v163
    v_rcp_f32 v132, v132
    v_rcp_f32 v133, v133
    v_mfma_f32_4x4x4_16b_bf16 v[144:147], v[228:229], v[228:229], v[144:147]
    v_rcp_f32 v134, v134
    s_bitcmp0_b64 s[56:57], 1
    s_cbranch_scc1 Ls_tnf
    v_cvt_pk_bf16_f32 v246, v212, v212
    v_mov_b32 v212, 0
    ds_write_b16 v240, v246
    v_add_u32 v240, 128, v240
    s_add_u32 s24, s24, s32
    s_addc_u32 s25, s25, 0
    s_xor_b32 s32, s32, 0x18ffe0
Ls_tnf:
    v_cvt_pk_bf16_f32 v132, v132, v133
    s_waitcnt lgkmcnt(0)
    v_rcp_f32 v135, v135
    v_rcp_f32 v136, v136
    v_cvt_pk_bf16_f32 v133, v134, v135
    v_rcp_f32 v137, v137
    v_rcp_f32 v138, v138
    v_cvt_pk_bf16_f32 v134, v136, v137
    v_rcp_f32 v139, v139
    v_rcp_f32 v140, v140
    v_cvt_pk_bf16_f32 v135, v138, v139
    v_rcp_f32 v141, v141
    v_rcp_f32 v142, v142
    v_cvt_pk_bf16_f32 v136, v140, v141
    v_mfma_f32_16x16x32_bf16 v[208:211], v[132:135], v[196:199], v[204:207]
    v_rcp_f32 v143, v143
    v_rcp_f32 v144, v144
    v_cvt_pk_bf16_f32 v137, v142, v143
    v_rcp_f32 v145, v145
    v_rcp_f32 v146, v146
    v_rcp_f32 v147, v147
    v_cvt_pk_bf16_f32 v138, v144, v145
    v_cvt_pk_bf16_f32 v139, v146, v147
    s_nop 1
    v_mfma_f32_16x16x32_bf16 v[208:211], v[136:139], v[200:203], v[208:211]
    ds_read_b32 v246, v244 offset:16
    s_waitcnt lgkmcnt(0)
    v_bfe_u32 v247, v246, 0, 8
    v_lshlrev_b32 v247, 1, v247
    v_bfe_u32 v248, v246, 8, 8
    v_lshlrev_b32 v248, 1, v248
    v_bfe_u32 v249, v246, 16, 8
    v_lshlrev_b32 v249, 1, v249
    v_bfe_u32 v250, v246, 24, 8
    v_lshlrev_b32 v250, 1, v250
    buffer_load_ushort v247, v247, s[24:27], 0 offen
    buffer_load_ushort v248, v248, s[24:27], 0 offen
    buffer_load_ushort v249, v249, s[24:27], 0 offen
    buffer_load_ushort v250, v250, s[24:27], 0 offen
    s_waitcnt vmcnt(0)
    v_lshlrev_b32 v247, 16, v247
    v_mul_f32 v208, v208, v247
    v_lshlrev_b32 v248, 16, v248
    v_mul_f32 v209, v209, v248
    v_lshlrev_b32 v249, 16, v249
    v_mul_f32 v210, v210, v249
    v_lshlrev_b32 v250, 16, v250
    v_mul_f32 v211, v211, v250
    v_cvt_pk_bf16_f32 v208, v208, v209
    v_cvt_pk_bf16_f32 v209, v210, v211
    s_nop 1
    v_mfma_f32_4x4x4_16b_bf16 v[212:215], v[208:209], v[188:189], v[212:215] cbsz:4 abid:0
    s_nop 1
    v_mfma_f32_4x4x4_16b_bf16 v[212:215], v[208:209], v[190:191], v[212:215] cbsz:4 abid:4
    s_nop 1
    v_mfma_f32_4x4x4_16b_bf16 v[212:215], v[208:209], v[192:193], v[212:215] cbsz:4 abid:8
    s_nop 1
    v_mfma_f32_4x4x4_16b_bf16 v[212:215], v[208:209], v[194:195], v[212:215] cbsz:4 abid:12
    s_nop 4
    v_cvt_pk_bf16_f32 v246, v212, v212
    ds_write_b16 v240, v246
    s_branch L_store
.section .rodata,"a"
.p2align 6
.amdhsa_kernel standalone__sequential_behavior_din__recsys_kernel
  .amdhsa_next_free_vgpr 256
  .amdhsa_next_free_sgpr 102
  .amdhsa_accum_offset 256
  .amdhsa_group_segment_fixed_size 0
  .amdhsa_kernarg_size 80
  .amdhsa_user_sgpr_count 2
  .amdhsa_user_sgpr_kernarg_segment_ptr 1
  .amdhsa_system_sgpr_workgroup_id_x 1
.end_amdhsa_kernel
```

```asm
; @launch grid=(256,1,1) block=(512,1,1) lds=163840
.amdgcn_target "amdgcn-amd-amdhsa--gfx950"
.text
.globl standalone__sequential_behavior_din__recsys_kernel
.p2align 8
.type standalone__sequential_behavior_din__recsys_kernel,@function
standalone__sequential_behavior_din__recsys_kernel:
    s_load_dwordx16 s[4:19], s[0:1], 0
    s_cmp_ge_u32 s2, 256
    s_cbranch_scc1 L_end
    v_lshrrev_b32 v1, 6, v0
    v_and_b32 v0, 63, v0
    v_readfirstlane_b32 s54, v1
    s_lshl_b32 s53, s2, 3
    v_lshlrev_b32 v2, 4, v0
    v_lshrrev_b32 v1, 4, v0
    v_and_b32 v3, 0xf0, v2
    v_lshlrev_b32 v3, 2, v3
    v_lshl_add_u32 v130, v1, 4, v3
    v_bfrev_b32 v3, 1
    s_add_u32 s53, s53, s54
    s_movk_i32 s66, 800
    v_cmp_gt_u32 vcc, s66, v130
    s_mul_i32 s93, s53, 800
    s_mul_i32 s52, s54, 20480
    s_mov_b64 s[28:29], vcc
    v_cndmask_b32 v3, v3, v130, vcc
    v_and_b32 v248, 16, v0
    v_lshlrev_b32 v246, 1, v248
    v_xor_b32 v246, v246, v2
    v_and_b32 v243, 0xf0, v2
    v_lshl_add_u32 v243, v1, 19, v243
    s_lshl_b32 s66, s53, 8
    v_add_u32 v243, s66, v243
    s_lshl_b32 s67, s54, 12
    s_add_u32 m0, s52, 8320
    s_mov_b32 s26, 6553600
    s_mov_b32 s27, 0x20000
    s_waitcnt lgkmcnt(0)
    s_mov_b32 s24, s8
    s_and_b32 s25, s9, 0xffff
    s_cmp_ge_u32 s54, 4
    s_cbranch_scc1 L_young0
    buffer_load_dwordx4 v[100:103], v3, s[24:27], s93 offen nt
L_young0:
    global_load_lds_dwordx4 v243, s[4:5] nt
    s_add_u32 m0, s52, 4160
    s_add_u32 s10, s10, s67
    s_addc_u32 s11, s11, 0
    v_xor_b32 v247, 64, v246
    global_load_lds_dwordx4 v246, s[10:11] offset:0
    global_load_lds_dwordx4 v247, s[10:11] offset:1024
    global_load_lds_dwordx4 v246, s[10:11] offset:2048
    global_load_lds_dwordx4 v247, s[10:11] offset:3072
    s_load_dword s30, s[16:17], 0
    s_and_b32 s67, s54, 3
    v_and_b32 v250, 3, v0
    s_mov_b32 s20, s6
    s_and_b32 s21, s7, 0xffff
    s_or_b32 s21, s21, 0x800000
    s_mov_b32 s22, 200
    s_mov_b32 s23, 0x20000
    s_sub_u32 s40, s20, 1056
    s_subb_u32 s41, s21, 0
    s_mov_b32 s42, 200
    s_mov_b32 s43, 0x20000
    s_mul_i32 s35, s53, 51200
    s_movk_i32 s31, 25600
    s_mov_b32 s60, 3
    s_mov_b64 s[56:57], 0
    s_mov_b64 s[58:59], 0
    v_mov_b32 v148, -1
    v_mov_b32 v149, -1
    v_mov_b32 v150, -1
    v_mov_b32 v151, -1
    s_add_u32 s66, s52, 18432
    v_add_u32 v152, s66, v2
    ds_write_b128 v152, v[148:151]
    ds_write_b128 v152, v[148:151] offset:1024
    s_add_u32 s64, s52, 18448
    v_mov_b32 v153, -1
    v_mov_b32 v154, -1
    v_mov_b32 v155, -1
    v_lshrrev_b32 v237, 3, v0
    v_add_u32 v237, s64, v237
    v_lshl_add_u32 v244, v1, 2, s66
    v_and_b32 v231, 0x70, v2
    v_lshlrev_b32 v248, 2, v248
    v_xor_b32 v231, v231, v248
    v_mov_b32 v233, v231
    s_movk_i32 s66, 400
    v_cmp_le_u32 vcc, s66, v130
    v_lshrrev_b32 v126, 1, v130
    s_movk_i32 s66, -200
    v_cndmask_b32 v130, 0, 1, vcc
    v_mad_i32_i24 v126, v130, s66, v126
    v_mul_u32_u24 v127, 0x10001, v126
    v_add_u32 v126, 0x10000, v127
    v_add_u32 v128, 0x50004, v127
    v_add_u32 v129, 0x70006, v127
    v_add_u32 v127, 0x30002, v127
    v_mov_b32 v131, 0xbfe0bfe0
    s_mov_b32 s86, 0xfff0ffff
    s_mov_b32 s87, 0xf000ff00
    s_mov_b32 s88, 0xff00fff0
    s_mov_b32 s89, 0xf000
    s_mov_b32 s90, 0xf0000f
    s_mov_b32 s91, 0xf0000f00
    s_mov_b32 s84, 0x11111113
    s_mov_b32 s85, 0x11111111
    v_cndmask_b32 v116, 0, v131, s[86:87]
    v_cndmask_b32 v120, 0, v131, s[88:89]
    v_cndmask_b32 v117, 0, v131, s[86:87]
    v_cndmask_b32 v121, 0, v131, s[88:89]
    v_cndmask_b32 v122, 0, v131, s[84:85]
    v_cndmask_b32 v123, 0, v131, s[84:85]
    v_cndmask_b32 v124, 0, v131, s[84:85]
    v_cndmask_b32 v125, 0, v131, s[84:85]
    v_lshlrev_b32 v246, 4, v250
    v_sub_u32 v246, 48, v246
    s_mov_b32 s86, 0xbfe0bfe0
    s_mov_b32 s87, 0xf0bfe0
    v_lshrrev_b64 v[118:119], v246, s[86:87]
    v_mov_b32 v131, 0
    s_mov_b64 s[84:85], 0
    v_cndmask_b32 v118, v120, v118, s[90:91]
    v_cndmask_b32 v119, v121, v119, s[90:91]
    s_mov_b32 s61, 7
    s_mov_b32 s92, 0xbfb8aa3b
    v_and_b32 v251, 15, v0
    v_bfe_u32 v252, v0, 2, 2
    v_lshlrev_b32 v253, 3, v250
    v_lshl_add_u32 v253, v252, 7, v253
    v_and_b32 v246, 24, v0
    v_lshlrev_b32 v246, 2, v246
    v_xor_b32 v246, v253, v246
    v_lshl_add_u32 v246, v1, 10, v246
    s_lshl_b32 s66, s67, 5
    v_xor_b32 v66, s66, v246
    v_add_u32 v66, 45120, v66
    s_lshr_b32 s66, s54, 1
    s_lshl_b32 s66, s66, 5
    v_xor_b32 v64, s66, v246
    s_and_b32 s66, s54, 1
    s_mul_i32 s66, s66, 20480
    s_add_u32 s66, s66, 4160
    v_add_u32 v64, s66, v64
    v_add_u32 v65, 81920, v64
    s_and_b32 s66, s54, 4
    v_lshrrev_b32 v246, 3, v251
    v_add_u32 v246, s66, v246
    v_mul_u32_u24 v246, 20480, v246
    v_lshl_add_u32 v246, v1, 4, v246
    v_and_b32 v247, 7, v0
    v_lshl_add_u32 v67, v247, 7, v246
    v_and_b32 v247, 1, v0
    v_lshlrev_b32 v247, 4, v247
    v_lshlrev_b32 v247, v247, 1
    v_cmp_gt_u32 vcc, 2, v250
    v_mov_b32 v229, 0
    v_mov_b32 v228, 0x3f80
    v_cndmask_b32 v241, 0, v247, vcc
    v_cmp_eq_u32 vcc, 0, v251
    v_sub_u32 v242, v247, v241
    v_mul_u32_u24 v218, 0x3f80, v241
    v_cndmask_b32 v220, 0, -1, vcc
    v_mul_u32_u24 v219, 0x3f80, v242
    s_and_b32 s66, s54, 3
    s_lshl_b32 s66, s66, 6
    s_add_u32 s66, s66, 9344
    v_and_b32 v247, 7, v0
    v_mul_u32_u24 v247, 144, v247
    v_add3_u32 v98, v67, v247, s66
    s_add_u32 s66, s52, 14592
    v_lshl_add_u32 v221, v0, 2, s66
    ds_write_b32 v221, v229
    s_xor_b32 s66, s54, 4
    s_mul_i32 s66, s66, 20480
    s_add_u32 s66, s66, 14592
    v_writelane_b32 v221, s66, 1
    v_add_u32 v222, s52, v2
    s_mov_b64 exec, 15
    ds_write_b32 v222, v229 offset:14848
    s_mov_b64 exec, -1
    v_and_b32 v247, 8, v0
    v_lshlrev_b32 v247, 2, v247
    v_lshl_add_u32 v247, v251, 7, v247
    v_add_u32 v247, s52, v247
    v_and_b32 v248, 2, v0
    v_lshlrev_b32 v248, 1, v248
    v_xor_b32 v248, v248, v1
    v_lshl_add_u32 v234, v248, 4, v247
    v_xor_b32 v248, 4, v248
    v_lshl_add_u32 v235, v248, 4, v247
    v_and_b32 v247, 8, v0
    v_lshlrev_b32 v247, 3, v247
    v_lshl_add_u32 v248, v1, 5, v253
    v_xor_b32 v248, v248, v247
    v_add_u32 v236, s52, v248
    s_add_u32 s66, s52, 8320
    v_lshl_add_u32 v238, v250, 1, s66
    v_lshl_add_u32 v238, v1, 4, v238
    s_add_u32 s66, s52, 14912
    v_lshl_add_u32 v240, v0, 1, s66
    s_add_u32 s66, s52, 9344
    v_lshl_add_u32 v239, v1, 4, s66
    v_mov_b32 v188, 0
    v_mov_b32 v189, 0
    v_mov_b32 v190, 0
    v_mov_b32 v191, 0
    v_mov_b32 v192, 0
    v_mov_b32 v193, 0
    v_mov_b32 v194, 0
    v_mov_b32 v195, 0
    v_mov_b32 v208, 0
    v_mov_b32 v212, 0
    v_mov_b32 v209, 0
    v_mov_b32 v213, 0
    v_mov_b32 v210, 0
    v_mov_b32 v214, 0
    v_mov_b32 v211, 0
    v_mov_b32 v215, 0
    s_and_b32 s66, s54, 3
    s_lshl_b32 s66, s66, 5
    v_lshl_add_u32 v249, v1, 3, s66
    global_load_dwordx2 v[96:97], v249, s[12:13]
    s_cmp_ge_u32 s54, 4
    s_cbranch_scc0 L_old3z
    buffer_load_dwordx4 v[100:103], v3, s[24:27], s93 offen nt
L_old3z:
    s_cmp_ge_u32 s54, 4
    s_cbranch_scc1 L_young1
    s_waitcnt vmcnt(6) lgkmcnt(0)
    s_call_b64 s[62:63], L_fp
    s_waitcnt vmcnt(5)
    s_branch L_old1
L_young1:
    s_waitcnt vmcnt(2)
L_old1:
    s_waitcnt lgkmcnt(0)
    s_barrier
    ds_read_b64_tr_b16 v[16:17], v66 offset:0
    ds_read_b64_tr_b16 v[18:19], v66 offset:512
    ds_read_b64_tr_b16 v[20:21], v66 offset:20480
    ds_read_b64_tr_b16 v[22:23], v66 offset:20992
    ds_read_b64_tr_b16 v[24:25], v66 offset:40960
    ds_read_b64_tr_b16 v[26:27], v66 offset:41472
    ds_read_b64_tr_b16 v[28:29], v66 offset:61440
    ds_read_b64_tr_b16 v[30:31], v66 offset:61952
    ds_read_b128 v[32:35], v67 offset:8320
    ds_read_b128 v[36:39], v67 offset:8384
    ds_read_b128 v[40:43], v67 offset:49280
    ds_read_b128 v[44:47], v67 offset:49344
    ds_read_b64_tr_b16 v[4:5], v64 offset:0
    ds_read_b64_tr_b16 v[8:9], v65 offset:0
    ds_read_b64_tr_b16 v[12:13], v65 offset:40960
    ds_read_b64_tr_b16 v[6:7], v64 offset:512
    ds_read_b64_tr_b16 v[10:11], v65 offset:512
    ds_read_b64_tr_b16 v[14:15], v65 offset:41472
    s_cmp_ge_u32 s54, 4
    s_cbranch_scc1 L_young2
    s_waitcnt vmcnt(4)
    s_branch L_old2
L_young2:
    s_waitcnt vmcnt(1)
L_old2:
    s_add_u32 s93, s93, 1638400
    buffer_load_dwordx4 v[104:107], v3, s[24:27], s93 offen nt
    s_add_u32 s93, s93, 1638400
    buffer_load_dwordx4 v[108:111], v3, s[24:27], s93 offen nt
    s_add_u32 s93, s93, 1638400
    buffer_load_dwordx4 v[112:115], v3, s[24:27], s93 offen nt
    v_lshlrev_b32 v249, 3, v1
    v_lshl_add_u32 v249, v250, 5, v249
    global_load_dwordx2 v[216:217], v249, s[14:15]
    v_lshlrev_b32 v48, 16, v96
    v_and_b32 v49, 0xffff0000, v96
    v_lshlrev_b32 v50, 16, v97
    v_and_b32 v51, 0xffff0000, v97
    s_lshl_b32 s30, s30, 16
    v_and_b32 v204, s30, v220
    v_and_b32 v205, s30, v220
    v_and_b32 v206, s30, v220
    v_and_b32 v207, s30, v220
    s_waitcnt lgkmcnt(0)
    v_xor_b32 v24, 0x80008000, v24
    v_xor_b32 v25, 0x80008000, v25
    v_xor_b32 v26, 0x80008000, v26
    v_xor_b32 v27, 0x80008000, v27
    v_xor_b32 v28, 0x80008000, v28
    v_xor_b32 v29, 0x80008000, v29
    v_xor_b32 v30, 0x80008000, v30
    v_xor_b32 v31, 0x80008000, v31
    v_mfma_f32_4x4x4_16b_bf16 v[56:59], v[218:219], v[4:5], 0
    v_mfma_f32_4x4x4_16b_bf16 v[68:71], v[218:219], v[12:13], 0
    v_mfma_f32_4x4x4_16b_bf16 v[60:63], v[218:219], v[6:7], 0
    v_mfma_f32_4x4x4_16b_bf16 v[72:75], v[218:219], v[14:15], 0
    v_mfma_f32_4x4x4_16b_bf16 v[56:59], v[218:219], v[8:9], v[56:59]
    v_mfma_f32_4x4x4_16b_bf16 v[60:63], v[218:219], v[10:11], v[60:63]
    v_mfma_f32_16x16x32_bf16 v[52:55], v[16:19], v[40:43], v[48:51]
    v_mfma_f32_16x16x32_bf16 v[52:55], v[20:23], v[44:47], v[52:55]
    v_mfma_f32_16x16x32_bf16 v[52:55], v[24:27], v[40:43], v[52:55]
    v_mfma_f32_16x16x32_bf16 v[52:55], v[28:31], v[44:47], v[52:55]
    v_mfma_f32_16x16x32_bf16 v[48:51], v[16:19], v[32:35], v[48:51]
    v_mfma_f32_16x16x32_bf16 v[48:51], v[20:23], v[36:39], v[48:51]
    v_mfma_f32_16x16x32_bf16 v[48:51], v[24:27], v[32:35], v[48:51]
    v_mfma_f32_16x16x32_bf16 v[48:51], v[28:31], v[36:39], v[48:51]
    v_mul_f32 v56, s92, v56
    v_mul_f32 v57, s92, v57
    v_mul_f32 v58, s92, v58
    v_mul_f32 v59, s92, v59
    v_mul_f32 v60, s92, v60
    v_mul_f32 v61, s92, v61
    v_mul_f32 v62, s92, v62
    v_mul_f32 v63, s92, v63
    v_mul_f32 v68, s92, v68
    v_mul_f32 v69, s92, v69
    v_mul_f32 v70, s92, v70
    v_mul_f32 v71, s92, v71
    v_mul_f32 v72, s92, v72
    v_mul_f32 v73, s92, v73
    v_mul_f32 v74, s92, v74
    v_mul_f32 v75, s92, v75
    s_add_u32 s66, s52, 11520
    v_add_u32 v3, s66, v2
    v_cvt_pk_bf16_f32 v68, v68, v69
    v_cvt_pk_bf16_f32 v69, v70, v71
    v_cvt_pk_bf16_f32 v70, v72, v73
    v_cvt_pk_bf16_f32 v71, v74, v75
    v_mul_f32 v48, s92, v48
    v_mul_f32 v49, s92, v49
    v_mul_f32 v50, s92, v50
    v_mul_f32 v51, s92, v51
    v_mul_f32 v52, s92, v52
    v_mul_f32 v53, s92, v53
    v_mul_f32 v54, s92, v54
    v_mul_f32 v55, s92, v55
    ds_write_b128 v3, v[56:59]
    ds_write_b128 v3, v[60:63] offset:1024
    ds_write_b128 v3, v[68:71] offset:2048
    ds_write_b128 v98, v[48:51]
    ds_write_b128 v98, v[52:55] offset:40960
    v_add_u32 v3, 11520, v2
    v_add_u32 v246, 81920, v3
    s_waitcnt lgkmcnt(0)
    s_barrier
    s_cmp_ge_u32 s54, 4
    s_cbranch_scc0 L_old3
    s_waitcnt vmcnt(4)
    s_call_b64 s[62:63], L_fp
    s_branch L_yng3
L_old3:
    s_call_b64 s[62:63], L_t23
L_yng3:
    ds_read_b128 v[4:7], v3 offset:0
    ds_read_b128 v[8:11], v3 offset:1024
    ds_read_b128 v[68:71], v3 offset:2048
    ds_read_b128 v[12:15], v3 offset:20480
    ds_read_b128 v[16:19], v3 offset:21504
    ds_read_b128 v[72:75], v3 offset:22528
    ds_read_b128 v[20:23], v3 offset:40960
    ds_read_b128 v[24:27], v3 offset:41984
    ds_read_b128 v[76:79], v3 offset:43008
    s_waitcnt vmcnt(4)
    v_mfma_i32_16x16x64_i8 v[172:175], v[122:125], v[104:107], 0
    v_mfma_i32_16x16x64_i8 v[176:179], v[122:125], v[108:111], 0
    v_mfma_i32_16x16x64_i8 v[180:183], v[122:125], v[112:115], 0
    v_and_b32 v160, 0x800080, v104
    v_mul_u32_u24 v160, 0x7f, v160
    v_bitop3_b32 v131, v104, v160, v131 bitop3:0xbe
    v_and_b32 v161, 0x800080, v105
    v_mul_u32_u24 v161, 0x7f, v161
    v_bitop3_b32 v131, v105, v161, v131 bitop3:0xbe
    v_and_b32 v160, 0x800080, v106
    v_mul_u32_u24 v160, 0x7f, v160
    v_bitop3_b32 v131, v106, v160, v131 bitop3:0xbe
    v_mov_b32_dpp v184, v172 row_shr:1 row_mask:0xf bank_mask:0xf bound_ctrl:0
    v_mov_b32_dpp v185, v176 row_shr:1 row_mask:0xf bank_mask:0xf bound_ctrl:0
    v_mov_b32_dpp v186, v180 row_shr:1 row_mask:0xf bank_mask:0xf bound_ctrl:0
    v_add_u32_dpp v184, v184, v184 row_shr:1 row_mask:0xf bank_mask:0xf bound_ctrl:0
    v_add_u32_dpp v185, v185, v185 row_shr:1 row_mask:0xf bank_mask:0xf bound_ctrl:0
    v_add_u32_dpp v186, v186, v186 row_shr:1 row_mask:0xf bank_mask:0xf bound_ctrl:0
    v_add_u32_dpp v184, v184, v184 row_shr:2 row_mask:0xf bank_mask:0xf bound_ctrl:0
    v_add_u32_dpp v185, v185, v185 row_shr:2 row_mask:0xf bank_mask:0xf bound_ctrl:0
    v_add_u32_dpp v186, v186, v186 row_shr:2 row_mask:0xf bank_mask:0xf bound_ctrl:0
    v_add_u32_dpp v184, v184, v184 row_shr:4 row_mask:0xf bank_mask:0xf bound_ctrl:0
    v_add_u32_dpp v185, v185, v185 row_shr:4 row_mask:0xf bank_mask:0xf bound_ctrl:0
    v_add_u32_dpp v186, v186, v186 row_shr:4 row_mask:0xf bank_mask:0xf bound_ctrl:0
    v_add_u32_dpp v184, v184, v184 row_shr:8 row_mask:0xf bank_mask:0xf bound_ctrl:0
    v_add_u32_dpp v185, v185, v185 row_shr:8 row_mask:0xf bank_mask:0xf bound_ctrl:0
    v_add_u32_dpp v186, v186, v186 row_shr:8 row_mask:0xf bank_mask:0xf bound_ctrl:0
    ds_read_b128 v[28:31], v3 offset:61440
    ds_read_b128 v[32:35], v3 offset:62464
    ds_read_b128 v[80:83], v3 offset:63488
    ds_read_b128 v[36:39], v246 offset:0
    ds_read_b128 v[40:43], v246 offset:1024
    ds_read_b128 v[84:87], v246 offset:2048
    v_and_b32 v161, 0x800080, v107
    v_mul_u32_u24 v161, 0x7f, v161
    v_bitop3_b32 v131, v107, v161, v131 bitop3:0xbe
    v_and_b32 v160, 0x800080, v108
    v_mul_u32_u24 v160, 0x7f, v160
    v_bitop3_b32 v131, v108, v160, v131 bitop3:0xbe
    v_and_b32 v161, 0x800080, v109
    v_mul_u32_u24 v161, 0x7f, v161
    v_bitop3_b32 v131, v109, v161, v131 bitop3:0xbe
    v_and_b32 v160, 0x800080, v110
    v_mul_u32_u24 v160, 0x7f, v160
    v_bitop3_b32 v131, v110, v160, v131 bitop3:0xbe
    v_and_b32 v161, 0x800080, v111
    v_mul_u32_u24 v161, 0x7f, v161
    v_bitop3_b32 v131, v111, v161, v131 bitop3:0xbe
    v_and_b32 v160, 0x800080, v112
    v_mul_u32_u24 v160, 0x7f, v160
    v_bitop3_b32 v131, v112, v160, v131 bitop3:0xbe
    v_and_b32 v161, 0x800080, v113
    v_mul_u32_u24 v161, 0x7f, v161
    v_bitop3_b32 v131, v113, v161, v131 bitop3:0xbe
    v_and_b32 v160, 0x800080, v114
    v_mul_u32_u24 v160, 0x7f, v160
    v_bitop3_b32 v131, v114, v160, v131 bitop3:0xbe
    v_and_b32 v161, 0x800080, v115
    v_mul_u32_u24 v161, 0x7f, v161
    v_bitop3_b32 v131, v115, v161, v131 bitop3:0xbe
    v_cmp_ne_u32 vcc, 0, v131
    v_readlane_b32 s68, v184, 6
    v_readlane_b32 s69, v173, 6
    v_readlane_b32 s70, v184, 15
    v_readlane_b32 s72, v185, 6
    v_readlane_b32 s73, v177, 6
    v_readlane_b32 s74, v185, 15
    v_readlane_b32 s76, v186, 6
    v_readlane_b32 s77, v181, 6
    v_readlane_b32 s78, v186, 15
    s_cbranch_vccnz L_general
    s_add_u32 s66, s68, s69
    s_add_u32 s66, s66, s64
    s_add_u32 s67, s66, 15
    s_and_b32 s67, s67, -16
    s_add_u32 s55, s64, 16
    s_max_u32 s67, s67, s55
    s_sub_u32 s66, s67, s66
    v_mad_u32_u24 v184, v130, s66, v184
    s_sub_u32 s55, s64, 2048
    v_add_u32 v172, s55, v184
    v_add_u32 v173, s55, v184
    v_add_u32 v174, s55, v184
    v_add_u32 v175, s55, v184
    s_add_u32 s64, s64, s70
    s_add_u32 s64, s64, s66
    v_mfma_i32_16x16x64_i8 v[132:135], v[118:121], v[104:107], v[172:175]
    v_mfma_i32_16x16x64_i8 v[136:139], v[116:119], v[104:107], v[172:175]
    s_add_u32 s64, s64, 15
    s_and_b32 s64, s64, -16
    s_add_u32 s55, s67, 16
    s_max_u32 s64, s64, s55
    s_lshr_b32 s95, s67, 4
    s_bitset1_b64 s[56:57], s95
    s_lshr_b32 s95, s64, 4
    s_bitset1_b64 s[56:57], s95
    s_mov_b32 s44, s64
    s_add_u32 s66, s72, s73
    s_add_u32 s66, s66, s64
    s_add_u32 s67, s66, 15
    s_and_b32 s67, s67, -16
    s_add_u32 s55, s64, 16
    s_max_u32 s67, s67, s55
    s_sub_u32 s66, s67, s66
    v_mad_u32_u24 v185, v130, s66, v185
    s_sub_u32 s55, s64, 2048
    v_add_u32 v176, s55, v185
    v_add_u32 v177, s55, v185
    v_add_u32 v178, s55, v185
    v_add_u32 v179, s55, v185
    s_add_u32 s64, s64, s74
    s_add_u32 s64, s64, s66
    v_mfma_i32_16x16x64_i8 v[140:143], v[118:121], v[108:111], v[176:179]
    v_mfma_i32_16x16x64_i8 v[144:147], v[116:119], v[108:111], v[176:179]
    s_add_u32 s64, s64, 15
    s_and_b32 s64, s64, -16
    s_add_u32 s55, s67, 16
    s_max_u32 s64, s64, s55
    s_mov_b32 s45, s67
    s_mov_b32 s46, s64
    ds_write_b8 v132, v126
    ds_write_b8_d16_hi v133, v126
    ds_write_b8 v134, v127
    ds_write_b8_d16_hi v135, v127
    ds_write_b8 v136, v128
    ds_write_b8_d16_hi v137, v128
    ds_write_b8 v138, v129
    ds_write_b8_d16_hi v139, v129
    s_add_u32 s66, s76, s77
    s_add_u32 s66, s66, s64
    s_add_u32 s67, s66, 15
    s_and_b32 s67, s67, -16
    s_add_u32 s55, s64, 16
    s_max_u32 s67, s67, s55
    s_sub_u32 s66, s67, s66
    v_mad_u32_u24 v186, v130, s66, v186
    s_sub_u32 s55, s64, 2048
    v_add_u32 v180, s55, v186
    v_add_u32 v181, s55, v186
    v_add_u32 v182, s55, v186
    v_add_u32 v183, s55, v186
    s_add_u32 s64, s64, s78
    s_add_u32 s64, s64, s66
    v_mfma_i32_16x16x64_i8 v[164:167], v[118:121], v[112:115], v[180:183]
    v_mfma_i32_16x16x64_i8 v[168:171], v[116:119], v[112:115], v[180:183]
    s_add_u32 s64, s64, 15
    s_and_b32 s64, s64, -16
    s_add_u32 s55, s67, 16
    s_max_u32 s64, s64, s55
    s_mov_b32 s47, s67
    s_mov_b32 s48, s64
    ds_write_b8 v140, v126
    ds_write_b8_d16_hi v141, v126
    ds_write_b8 v142, v127
    ds_write_b8_d16_hi v143, v127
    ds_write_b8 v144, v128
    ds_write_b8_d16_hi v145, v128
    ds_write_b8 v146, v129
    ds_write_b8_d16_hi v147, v129
    ds_read_b128 v[44:47], v246 offset:20480
    ds_read_b128 v[48:51], v246 offset:21504
    ds_read_b128 v[88:91], v246 offset:22528
    ds_read_b128 v[52:55], v246 offset:40960
    ds_read_b128 v[56:59], v246 offset:41984
    ds_read_b128 v[92:95], v246 offset:43008
    ds_read_b128 v[60:63], v246 offset:61440
    ds_read_b128 v[64:67], v246 offset:62464
    ds_read_b128 v[96:99], v246 offset:63488
    ds_read_u16 v224, v238 offset:0
    ds_read_u16 v225, v238 offset:8
    ds_read_u16 v226, v238 offset:64
    ds_read_u16 v227, v238 offset:72
    ds_write_b8 v164, v126
    ds_write_b8_d16_hi v165, v126
    ds_write_b8 v166, v127
    ds_write_b8_d16_hi v167, v127
    ds_write_b8 v168, v128
    ds_write_b8_d16_hi v169, v128
    ds_write_b8 v170, v129
    ds_write_b8_d16_hi v171, v129
    s_cmp_ge_u32 s54, 4
    s_cbranch_scc0 L_old3b
    s_call_b64 s[62:63], L_t23
L_old3b:
L_listed:
    s_and_b32 s55, s84, 0x40000000
    s_or_b32 s55, s55, s54
    s_bitset1_b32 s55, 31
    s_and_b32 s66, s74, 0x1ff
    s_lshl_b32 s66, s66, 3
    s_or_b32 s66, s66, s55
    s_and_b32 s67, s78, 0x1ff
    s_lshl_b32 s67, s67, 3
    s_or_b32 s67, s67, s55
    v_mov_b32 v132, s66
    v_mov_b32 v133, s44
    v_mov_b32 v134, s45
    v_mov_b32 v135, s46
    v_writelane_b32 v132, s67, 1
    v_writelane_b32 v133, s46, 1
    v_writelane_b32 v134, s47, 1
    v_writelane_b32 v135, s48, 1
    s_mov_b64 exec, 3
    ds_write_b128 v222, v[132:135] offset:14848
    s_mov_b64 exec, -1
    s_sub_u32 s68, s46, s44
    s_sub_u32 s69, s48, s46
    s_lshl_b32 s50, s54, 3
    s_mov_b32 s51, 0
    s_mov_b32 s33, 0
    s_sub_u32 s66, s64, s52
    s_sub_u32 s66, s66, 18448
    s_lshr_b32 s66, s66, 3
    s_lshr_b32 s67, s54, 2
    s_mul_i32 s67, s67, 2
    s_add_u32 s66, s66, s67
    s_sub_u32 s67, 0, s66
    v_mov_b32 v2, v221
    v_mov_b32 v1, s66
    v_mov_b32 v3, -8
    v_writelane_b32 v1, s67, 1
    v_writelane_b32 v3, 8, 1
    ds_add_u32 v2, v1
    s_cmp_eq_u32 s94, 1
    s_cbranch_scc1 L_nolate
    ds_read_u8 v148, v237 offset:0
    ds_read_u8 v149, v237 offset:8
    ds_read_u8 v150, v237 offset:16
    ds_read_u8 v151, v237 offset:24
    ds_read_u8 v152, v237 offset:32
    ds_read_u8 v153, v237 offset:40
    ds_read_u8 v154, v237 offset:48
    ds_read_u8 v155, v237 offset:56
    s_waitcnt lgkmcnt(0)
    s_add_u32 m0, s52, 0
    v_mov_b32 v230, v148
    v_mov_b32 v232, v149
    buffer_load_dwordx4 v[230:231], s[20:23], s35 idxen offen nt lds
    buffer_load_dwordx4 v[232:233], s[40:43], s35 idxen offen offset:1056 nt lds
    s_bitcmp0_b64 s[56:57], 2
    s_cbranch_scc1 L_noadvl1
    s_add_u32 s35, s35, s31
    s_min_u32 s35, s35, 419404800
    s_xor_b32 s31, s31, 0x63ff800
    s_sub_u32 s60, s60, 1
L_noadvl1:
    s_add_u32 m0, s52, 2080
    v_mov_b32 v230, v150
    v_mov_b32 v232, v151
    buffer_load_dwordx4 v[230:231], s[20:23], s35 idxen offen nt lds
    buffer_load_dwordx4 v[232:233], s[40:43], s35 idxen offen offset:1056 nt lds
    s_bitcmp0_b64 s[56:57], 3
    s_cbranch_scc1 L_noadvl2
    s_add_u32 s35, s35, s31
    s_min_u32 s35, s35, 419404800
    s_xor_b32 s31, s31, 0x63ff800
    s_sub_u32 s60, s60, 1
L_noadvl2:
    s_add_u32 m0, s52, 4160
    v_mov_b32 v230, v152
    v_mov_b32 v232, v153
    buffer_load_dwordx4 v[230:231], s[20:23], s35 idxen offen nt lds
    buffer_load_dwordx4 v[232:233], s[40:43], s35 idxen offen offset:1056 nt lds
    s_bitcmp0_b64 s[56:57], 4
    s_cbranch_scc1 L_noadvl3
    s_add_u32 s35, s35, s31
    s_min_u32 s35, s35, 419404800
    s_xor_b32 s31, s31, 0x63ff800
    s_sub_u32 s60, s60, 1
L_noadvl3:
    s_add_u32 m0, s52, 6240
    v_mov_b32 v230, v154
    v_mov_b32 v232, v155
    buffer_load_dwordx4 v[230:231], s[20:23], s35 idxen offen nt lds
    buffer_load_dwordx4 v[232:233], s[40:43], s35 idxen offen offset:1056 nt lds
L_nolate:
    v_and_b32_dpp v196, v216, v220 quad_perm:[0,0,0,0] row_mask:0xf bank_mask:0xf
    v_and_b32_dpp v197, v217, v220 quad_perm:[0,0,0,0] row_mask:0xf bank_mask:0xf
    v_and_b32_dpp v198, v216, v220 quad_perm:[1,1,1,1] row_mask:0xf bank_mask:0xf
    v_and_b32_dpp v199, v217, v220 quad_perm:[1,1,1,1] row_mask:0xf bank_mask:0xf
    v_and_b32_dpp v200, v216, v220 quad_perm:[2,2,2,2] row_mask:0xf bank_mask:0xf
    v_and_b32_dpp v201, v217, v220 quad_perm:[2,2,2,2] row_mask:0xf bank_mask:0xf
    v_and_b32_dpp v202, v216, v220 quad_perm:[3,3,3,3] row_mask:0xf bank_mask:0xf
    v_and_b32_dpp v203, v217, v220 quad_perm:[3,3,3,3] row_mask:0xf bank_mask:0xf
    s_waitcnt vmcnt(6) lgkmcnt(0)
    ds_read_b128 v[180:183], v234 offset:0
    ds_read_b128 v[184:187], v235 offset:0
    v_mul_u32_u24 v216, v224, v241
    v_mul_u32_u24 v217, v224, v242
    v_mul_u32_u24 v218, v225, v241
    v_mul_u32_u24 v219, v225, v242
    v_mul_u32_u24 v220, v226, v241
    v_mul_u32_u24 v221, v226, v242
    v_mul_u32_u24 v222, v227, v241
    v_mul_u32_u24 v223, v227, v242
    v_mfma_f32_4x4x4_16b_bf16 v[140:143], v[216:217], v[68:69], v[4:7]
    v_add_u32 v238, 128, v238
    ds_read_b128 v[164:167], v239 offset:0
    ds_read_b128 v[168:171], v239 offset:64
    v_mfma_f32_4x4x4_16b_bf16 v[144:147], v[218:219], v[70:71], v[8:11]
    ds_read_b128 v[172:175], v239 offset:128
    ds_read_b128 v[176:179], v239 offset:192
    ds_read_u16 v224, v238 offset:0
    ds_read_u16 v225, v238 offset:8
    ds_read_u16 v226, v238 offset:64
    ds_read_u16 v227, v238 offset:72
    v_mfma_f32_4x4x4_16b_bf16 v[246:249], v[220:221], v[72:73], v[12:15]
    v_cvt_pk_bf16_f32 v100, v140, v141
    v_cvt_pk_bf16_f32 v101, v142, v143
    v_mfma_f32_4x4x4_16b_bf16 v[250:253], v[222:223], v[74:75], v[16:19]
    v_cvt_pk_bf16_f32 v102, v144, v145
    v_cvt_pk_bf16_f32 v103, v146, v147
    v_mfma_f32_4x4x4_16b_bf16 v[140:143], v[216:217], v[76:77], v[20:23]
    v_cvt_pk_bf16_f32 v104, v246, v247
    v_cvt_pk_bf16_f32 v105, v248, v249
    v_mfma_f32_4x4x4_16b_bf16 v[144:147], v[218:219], v[78:79], v[24:27]
    v_cvt_pk_bf16_f32 v106, v250, v251
    v_cvt_pk_bf16_f32 v107, v252, v253
    v_mfma_f32_4x4x4_16b_bf16 v[246:249], v[220:221], v[80:81], v[28:31]
    v_cvt_pk_bf16_f32 v108, v140, v141
    v_cvt_pk_bf16_f32 v109, v142, v143
    v_mfma_f32_4x4x4_16b_bf16 v[250:253], v[222:223], v[82:83], v[32:35]
    v_cvt_pk_bf16_f32 v110, v144, v145
    v_cvt_pk_bf16_f32 v111, v146, v147
    v_mfma_f32_4x4x4_16b_bf16 v[140:143], v[216:217], v[84:85], v[36:39]
    v_cvt_pk_bf16_f32 v112, v246, v247
    v_cvt_pk_bf16_f32 v113, v248, v249
    v_mfma_f32_4x4x4_16b_bf16 v[144:147], v[218:219], v[86:87], v[40:43]
    v_cvt_pk_bf16_f32 v114, v250, v251
    v_cvt_pk_bf16_f32 v115, v252, v253
    v_mfma_f32_4x4x4_16b_bf16 v[246:249], v[220:221], v[88:89], v[44:47]
    v_cvt_pk_bf16_f32 v116, v140, v141
    v_cvt_pk_bf16_f32 v117, v142, v143
    v_mfma_f32_4x4x4_16b_bf16 v[250:253], v[222:223], v[90:91], v[48:51]
    v_cvt_pk_bf16_f32 v118, v144, v145
    v_cvt_pk_bf16_f32 v119, v146, v147
    v_mfma_f32_4x4x4_16b_bf16 v[140:143], v[216:217], v[92:93], v[52:55]
    v_cvt_pk_bf16_f32 v120, v246, v247
    v_cvt_pk_bf16_f32 v121, v248, v249
    v_mfma_f32_4x4x4_16b_bf16 v[144:147], v[218:219], v[94:95], v[56:59]
    v_cvt_pk_bf16_f32 v122, v250, v251
    v_cvt_pk_bf16_f32 v123, v252, v253
    v_mfma_f32_4x4x4_16b_bf16 v[246:249], v[220:221], v[96:97], v[60:63]
    v_cvt_pk_bf16_f32 v124, v140, v141
    v_cvt_pk_bf16_f32 v125, v142, v143
    v_mfma_f32_4x4x4_16b_bf16 v[250:253], v[222:223], v[98:99], v[64:67]
    v_cvt_pk_bf16_f32 v126, v144, v145
    v_cvt_pk_bf16_f32 v127, v146, v147
    v_cvt_pk_bf16_f32 v128, v246, v247
    v_cvt_pk_bf16_f32 v129, v248, v249
    v_add_u32 v239, 272, v239
    v_cvt_pk_bf16_f32 v130, v250, v251
    v_cvt_pk_bf16_f32 v131, v252, v253
    s_waitcnt lgkmcnt(0)
    v_mfma_f32_16x16x32_bf16 v[148:151], v[100:103], v[180:183], v[164:167]
    v_mfma_f32_16x16x32_bf16 v[148:151], v[104:107], v[184:187], v[148:151]
    v_mfma_f32_16x16x32_bf16 v[152:155], v[108:111], v[180:183], v[168:171]
    v_mfma_f32_16x16x32_bf16 v[152:155], v[112:115], v[184:187], v[152:155]
    v_mfma_f32_16x16x32_bf16 v[156:159], v[116:119], v[180:183], v[172:175]
    v_mfma_f32_16x16x32_bf16 v[156:159], v[120:123], v[184:187], v[156:159]
    v_mfma_f32_16x16x32_bf16 v[160:163], v[124:127], v[180:183], v[176:179]
    v_mfma_f32_16x16x32_bf16 v[160:163], v[128:131], v[184:187], v[160:163]
    v_mov_b32 v136, 0
    v_mov_b32 v137, 0
    v_mov_b32 v138, 0
    v_mov_b32 v139, 0
    s_lshr_b64 s[86:87], s[56:57], 2
    s_lshr_b64 s[36:37], s[56:57], 5
    s_or_b32 s36, s36, s86
    s_or_b32 s36, s36, s56
    s_cmp_lg_u64 s[84:85], 0
    s_cbranch_scc0 Lf_mid
    s_mul_i32 s66, s53, 800
    s_add_u32 s8, s8, s66
    s_addc_u32 s9, s9, 0
    s_mov_b32 s24, s8
    s_and_b32 s25, s9, 0xffff
    s_mov_b32 s26, 400
    s_mov_b32 s27, 0x20000
    s_movk_i32 s32, 400
    s_branch Ls_mid
L_fp:
    v_mfma_i32_16x16x64_i8 v[172:175], v[122:125], v[100:103], 0
    v_and_b32 v160, 0x800080, v100
    v_mul_u32_u24 v160, 0x7f, v160
    v_bitop3_b32 v131, v100, v160, v131 bitop3:0xbe
    v_and_b32 v161, 0x800080, v101
    v_mul_u32_u24 v161, 0x7f, v161
    v_bitop3_b32 v131, v101, v161, v131 bitop3:0xbe
    v_and_b32 v160, 0x800080, v102
    v_mul_u32_u24 v160, 0x7f, v160
    v_mov_b32_dpp v184, v172 row_shr:1 row_mask:0xf bank_mask:0xf bound_ctrl:0
    v_bitop3_b32 v131, v102, v160, v131 bitop3:0xbe
    s_nop 0
    v_add_u32_dpp v184, v184, v184 row_shr:1 row_mask:0xf bank_mask:0xf bound_ctrl:0
    v_and_b32 v161, 0x800080, v103
    s_nop 0
    v_add_u32_dpp v184, v184, v184 row_shr:2 row_mask:0xf bank_mask:0xf bound_ctrl:0
    v_mul_u32_u24 v161, 0x7f, v161
    s_nop 0
    v_add_u32_dpp v184, v184, v184 row_shr:4 row_mask:0xf bank_mask:0xf bound_ctrl:0
    v_bitop3_b32 v131, v103, v161, v131 bitop3:0xbe
    s_nop 0
    v_add_u32_dpp v184, v184, v184 row_shr:8 row_mask:0xf bank_mask:0xf bound_ctrl:0
    v_cmp_ne_u32 vcc, 0, v131
    v_readlane_b32 s68, v184, 6
    v_readlane_b32 s69, v173, 6
    v_readlane_b32 s70, v184, 15
    s_mov_b32 s94, 0
    s_cbranch_vccnz L_late
    s_add_u32 s66, s68, s69
    s_add_u32 s66, s66, s64
    s_add_u32 s67, s66, 15
    s_and_b32 s67, s67, -16
    s_add_u32 s55, s64, 16
    s_max_u32 s67, s67, s55
    s_sub_u32 s66, s67, s66
    v_mad_u32_u24 v184, v130, s66, v184
    s_sub_u32 s55, s64, 2048
    v_add_u32 v172, s55, v184
    v_add_u32 v173, s55, v184
    v_add_u32 v174, s55, v184
    v_add_u32 v175, s55, v184
    s_add_u32 s64, s64, s70
    s_add_u32 s64, s64, s66
    v_mfma_i32_16x16x64_i8 v[132:135], v[118:121], v[100:103], v[172:175]
    v_mfma_i32_16x16x64_i8 v[136:139], v[116:119], v[100:103], v[172:175]
    s_add_u32 s64, s64, 15
    s_and_b32 s64, s64, -16
    s_add_u32 s55, s67, 16
    s_max_u32 s64, s64, s55
    s_lshr_b32 s95, s67, 4
    s_bitset1_b64 s[56:57], s95
    s_lshr_b32 s95, s64, 4
    s_bitset1_b64 s[56:57], s95
    s_add_u32 s66, s52, 18512
    s_cmp_ge_u32 s64, s66
    ds_write_b8 v132, v126
    ds_write_b8_d16_hi v133, v126
    ds_write_b8 v134, v127
    ds_write_b8_d16_hi v135, v127
    ds_write_b8 v136, v128
    ds_write_b8_d16_hi v137, v128
    ds_write_b8 v138, v129
    ds_write_b8_d16_hi v139, v129
    s_cbranch_scc0 L_late
    s_mov_b32 s94, 1
    ds_read_u8 v148, v237 offset:0
    ds_read_u8 v149, v237 offset:8
    ds_read_u8 v150, v237 offset:16
    ds_read_u8 v151, v237 offset:24
    ds_read_u8 v152, v237 offset:32
    ds_read_u8 v153, v237 offset:40
    ds_read_u8 v154, v237 offset:48
    ds_read_u8 v155, v237 offset:56
    s_waitcnt lgkmcnt(0)
    s_add_u32 m0, s52, 0
    v_mov_b32 v230, v148
    v_mov_b32 v232, v149
    buffer_load_dwordx4 v[230:231], s[20:23], s35 idxen offen nt lds
    buffer_load_dwordx4 v[232:233], s[40:43], s35 idxen offen offset:1056 nt lds
    s_bitcmp0_b64 s[56:57], 2
    s_cbranch_scc1 L_noadve1
    s_add_u32 s35, s35, s31
    s_min_u32 s35, s35, 419404800
    s_xor_b32 s31, s31, 0x63ff800
    s_sub_u32 s60, s60, 1
L_noadve1:
    s_add_u32 m0, s52, 2080
    v_mov_b32 v230, v150
    v_mov_b32 v232, v151
    buffer_load_dwordx4 v[230:231], s[20:23], s35 idxen offen nt lds
    buffer_load_dwordx4 v[232:233], s[40:43], s35 idxen offen offset:1056 nt lds
    s_setpc_b64 s[62:63]
L_late:
    s_waitcnt vmcnt(0)
    s_setpc_b64 s[62:63]
L_swap:
    v_lshrrev_b32 v140, 3, v0
    v_and_b32 v141, 7, v0
    v_mul_u32_u24 v140, 20480, v140
    v_mul_u32_u24 v141, 20480, v141
    v_add_u32 v140, s51, v140
    v_add_u32 v141, s51, v141
    v_mov_b32 v143, 1
    s_mov_b64 exec, 1
    ds_add_rtn_u32 v143, v140, v143 offset:14880
    s_mov_b64 exec, -1
L_swap_poll:
    ds_read_b32 v142, v141 offset:14848
    ds_read_b128 v[144:147], v140 offset:14848
    v_and_b32 v248, 56, v0
    s_waitcnt lgkmcnt(0)
    v_cmp_le_i32 vcc, 0, v142
    v_cmp_gt_u32 s[86:87], v142, v144
    v_lshlrev_b32 v249, 1, v142
    v_readfirstlane_b32 s66, v143
    s_cbranch_vccnz L_swap_poll
    v_lshrrev_b64 v[246:247], v248, s[86:87]
    v_cmp_gt_i32 s[88:89], 0, v249
    v_and_b32 v246, 0xff, v246
    v_bcnt_u32_b32 v246, v246, 0
    v_cmp_eq_u32 vcc, s66, v246
    s_lshl_b32 s67, s54, 3
    s_ff1_i32_b64 s66, vcc
    s_cmp_lg_u64 s[88:89], 0
    s_cselect_b32 s66, s67, s66
    s_sub_u32 s95, s66, s50
    s_mov_b32 s50, s66
    s_sub_u32 s83, s66, s67
    v_readlane_b32 s67, v146, s66
    v_readlane_b32 s55, v147, s66
    v_readlane_b32 s66, v145, s66
    s_mul_i32 s81, s95, 2560
    s_mul_i32 s95, s95, 6400
    s_add_u32 s35, s35, s95
    s_sub_u32 s95, s66, s44
    v_add_u32 v237, s95, v237
    s_mov_b32 s44, s55
    s_sub_u32 s67, s67, s66
    s_sub_u32 s55, s55, s66
    s_sub_u32 s95, s55, s68
    s_lshr_b32 s67, s67, 4
    s_add_u32 s67, s67, s49
    s_bitset1_b64 s[56:57], s67
    s_lshr_b32 s55, s55, 4
    s_add_u32 s55, s55, s49
    s_bitset1_b64 s[56:57], s55
    s_lshr_b64 s[86:87], s[56:57], 2
    s_lshr_b64 s[36:37], s[56:57], 5
    s_or_b32 s36, s36, s86
    s_or_b32 s36, s36, s56
    s_ashr_i32 s95, s95, 3
    v_mov_b32 v140, s95
    s_sub_u32 s95, 0, s95
    v_writelane_b32 v140, s95, 1
    ds_add_u32 v2, v140
    s_cmp_eq_u32 s51, 0
    s_cselect_b32 s80, s81, s80
    s_cselect_b32 s82, s83, s82
    s_cselect_b32 s60, 1, 8
    s_cselect_b32 s66, 4, 2
    s_mov_b32 s68, s69
    s_mov_b32 s51, 16
    s_cmp_eq_u32 s61, s66
    s_cbranch_scc1 L_swap_now
    s_sub_u32 s66, s66, 1
    s_bitset1_b32 s33, s66
    s_setpc_b64 s[62:63]
L_swap_now:
    v_add_u32 v238, s81, v238
    v_add_u32 v239, s81, v239
    ds_read_u16 v224, v238 offset:0
    ds_read_u16 v225, v238 offset:8
    ds_read_u16 v226, v238 offset:64
    ds_read_u16 v227, v238 offset:72
    s_setpc_b64 s[62:63]
L_t23:
    s_cmp_eq_u32 s94, 0
    s_cbranch_scc1 L_skip23
    s_bitcmp0_b64 s[56:57], 3
    s_cbranch_scc1 L_noadve2
    s_add_u32 s35, s35, s31
    s_min_u32 s35, s35, 419404800
    s_xor_b32 s31, s31, 0x63ff800
    s_sub_u32 s60, s60, 1
L_noadve2:
    s_add_u32 m0, s52, 4160
    v_mov_b32 v230, v152
    v_mov_b32 v232, v153
    buffer_load_dwordx4 v[230:231], s[20:23], s35 idxen offen nt lds
    buffer_load_dwordx4 v[232:233], s[40:43], s35 idxen offen offset:1056 nt lds
    s_bitcmp0_b64 s[56:57], 4
    s_cbranch_scc1 L_noadve3
    s_add_u32 s35, s35, s31
    s_min_u32 s35, s35, 419404800
    s_xor_b32 s31, s31, 0x63ff800
    s_sub_u32 s60, s60, 1
L_noadve3:
    s_add_u32 m0, s52, 6240
    v_mov_b32 v230, v154
    v_mov_b32 v232, v155
    buffer_load_dwordx4 v[230:231], s[20:23], s35 idxen offen nt lds
    buffer_load_dwordx4 v[232:233], s[40:43], s35 idxen offen offset:1056 nt lds
    s_setpc_b64 s[62:63]
L_skip23:
    s_waitcnt vmcnt(0)
    s_setpc_b64 s[62:63]
.p2align 6
Lf_loop:
Lf_mid:
    s_bitcmp1_b32 s36, 0
    s_cbranch_scc1 Lf_ev0
Lf_evd0:
    v_mfma_f32_16x16x32_bf16 v[208:211], v[136:139], v[200:203], v[208:211]
    v_exp_f32 v132, v148
    v_exp_f32 v133, v149
    v_exp_f32 v134, v150
    v_exp_f32 v135, v151
    v_exp_f32 v136, v152
    v_exp_f32 v137, v153
    v_mfma_f32_4x4x4_16b_bf16 v[132:135], v[228:229], v[228:229], v[132:135]
    v_exp_f32 v138, v154
    v_exp_f32 v139, v155
    v_cvt_pk_bf16_f32 v208, v208, v209
    v_cvt_pk_bf16_f32 v209, v210, v211
    v_exp_f32 v140, v156
    v_exp_f32 v141, v157
    v_mfma_f32_4x4x4_16b_bf16 v[212:215], v[208:209], v[188:189], v[212:215] cbsz:4 abid:0
    v_mfma_f32_4x4x4_16b_bf16 v[136:139], v[228:229], v[228:229], v[136:139]
    v_exp_f32 v142, v158
    v_mfma_f32_4x4x4_16b_bf16 v[212:215], v[208:209], v[190:191], v[212:215] cbsz:4 abid:4
    v_exp_f32 v143, v159
    v_exp_f32 v144, v160
    v_mfma_f32_4x4x4_16b_bf16 v[212:215], v[208:209], v[192:193], v[212:215] cbsz:4 abid:8
    v_exp_f32 v145, v161
    v_mfma_f32_4x4x4_16b_bf16 v[140:143], v[228:229], v[228:229], v[140:143]
    v_mfma_f32_4x4x4_16b_bf16 v[212:215], v[208:209], v[194:195], v[212:215] cbsz:4 abid:12
    ds_add_rtn_u32 v1, v2, v3
    ds_read_u8 v230, v237 offset:64
    ds_read_u8 v232, v237 offset:72
    ds_read_b64_tr_b16 v[188:189], v236 offset:0
    ds_read_b64_tr_b16 v[190:191], v236 offset:512
    ds_read_b64_tr_b16 v[192:193], v236 offset:1056
    ds_read_b64_tr_b16 v[194:195], v236 offset:1568
    s_waitcnt vmcnt(4)
    ds_read_b128 v[180:183], v234 offset:2080
    ds_read_b128 v[184:187], v235 offset:2080
    s_add_u32 m0, s52, 0
    v_exp_f32 v146, v162
    v_exp_f32 v147, v163
    v_rcp_f32 v132, v132
    v_rcp_f32 v133, v133
    v_mfma_f32_4x4x4_16b_bf16 v[144:147], v[228:229], v[228:229], v[144:147]
    v_rcp_f32 v134, v134
    v_cvt_pk_bf16_f32 v132, v132, v133
    s_waitcnt lgkmcnt(2)
    buffer_load_dwordx4 v[230:231], s[20:23], s35 idxen offen nt lds
    buffer_load_dwordx4 v[232:233], s[40:43], s35 idxen offen offset:1056 nt lds
    s_waitcnt lgkmcnt(0)
    v_mfma_f32_16x16x32_bf16 v[148:151], v[100:103], v[180:183], v[164:167]
    v_rcp_f32 v135, v135
    v_mfma_f32_16x16x32_bf16 v[152:155], v[108:111], v[180:183], v[168:171]
    v_rcp_f32 v136, v136
    v_cvt_pk_bf16_f32 v133, v134, v135
    v_mfma_f32_16x16x32_bf16 v[148:151], v[104:107], v[184:187], v[148:151]
    v_rcp_f32 v137, v137
    v_readfirstlane_b32 s66, v1
    s_setprio 0
    s_cmp_gt_i32 s66, 0
    s_cbranch_scc0 Lf_lo0
    s_setprio 1
Lf_lo0:
    v_mfma_f32_16x16x32_bf16 v[152:155], v[112:115], v[184:187], v[152:155]
    v_rcp_f32 v138, v138
    v_cvt_pk_bf16_f32 v134, v136, v137
    v_mfma_f32_16x16x32_bf16 v[156:159], v[116:119], v[180:183], v[172:175]
    v_rcp_f32 v139, v139
    v_mfma_f32_16x16x32_bf16 v[160:163], v[124:127], v[180:183], v[176:179]
    v_rcp_f32 v140, v140
    v_cvt_pk_bf16_f32 v135, v138, v139
    v_mfma_f32_16x16x32_bf16 v[156:159], v[120:123], v[184:187], v[156:159]
    v_rcp_f32 v141, v141
    v_mfma_f32_16x16x32_bf16 v[160:163], v[128:131], v[184:187], v[160:163]
    v_rcp_f32 v142, v142
    v_cvt_pk_bf16_f32 v136, v140, v141
    v_mfma_f32_16x16x32_bf16 v[208:211], v[132:135], v[196:199], v[204:207]
    v_rcp_f32 v143, v143
    v_rcp_f32 v144, v144
    v_cvt_pk_bf16_f32 v137, v142, v143
    v_rcp_f32 v145, v145
    v_rcp_f32 v146, v146
    v_rcp_f32 v147, v147
    v_cvt_pk_bf16_f32 v138, v144, v145
    v_cvt_pk_bf16_f32 v139, v146, v147
    s_bitcmp1_b32 s36, 1
    s_cbranch_scc1 Lf_ev1
Lf_evd1:
    v_mfma_f32_16x16x32_bf16 v[208:211], v[136:139], v[200:203], v[208:211]
    v_exp_f32 v132, v148
    v_exp_f32 v133, v149
    v_exp_f32 v134, v150
    v_exp_f32 v135, v151
    v_exp_f32 v136, v152
    v_exp_f32 v137, v153
    v_mfma_f32_4x4x4_16b_bf16 v[132:135], v[228:229], v[228:229], v[132:135]
    v_exp_f32 v138, v154
    v_exp_f32 v139, v155
    v_cvt_pk_bf16_f32 v208, v208, v209
    v_cvt_pk_bf16_f32 v209, v210, v211
    v_exp_f32 v140, v156
    v_exp_f32 v141, v157
    v_mfma_f32_4x4x4_16b_bf16 v[212:215], v[208:209], v[188:189], v[212:215] cbsz:4 abid:0
    v_mfma_f32_4x4x4_16b_bf16 v[136:139], v[228:229], v[228:229], v[136:139]
    v_exp_f32 v142, v158
    v_mfma_f32_4x4x4_16b_bf16 v[212:215], v[208:209], v[190:191], v[212:215] cbsz:4 abid:4
    v_exp_f32 v143, v159
    v_exp_f32 v144, v160
    v_mfma_f32_4x4x4_16b_bf16 v[212:215], v[208:209], v[192:193], v[212:215] cbsz:4 abid:8
    v_exp_f32 v145, v161
    v_mfma_f32_4x4x4_16b_bf16 v[140:143], v[228:229], v[228:229], v[140:143]
    v_mfma_f32_4x4x4_16b_bf16 v[212:215], v[208:209], v[194:195], v[212:215] cbsz:4 abid:12
    ds_read_u8 v230, v237 offset:80
    ds_read_u8 v232, v237 offset:88
    ds_read_b64_tr_b16 v[188:189], v236 offset:2080
    ds_read_b64_tr_b16 v[190:191], v236 offset:2592
    ds_read_b64_tr_b16 v[192:193], v236 offset:3136
    ds_read_b64_tr_b16 v[194:195], v236 offset:3648
    s_waitcnt vmcnt(4)
    ds_read_b128 v[180:183], v234 offset:4160
    ds_read_b128 v[184:187], v235 offset:4160
    s_add_u32 m0, s52, 2080
    v_exp_f32 v146, v162
    v_exp_f32 v147, v163
    v_rcp_f32 v132, v132
    v_rcp_f32 v133, v133
    v_mfma_f32_4x4x4_16b_bf16 v[144:147], v[228:229], v[228:229], v[144:147]
    v_rcp_f32 v134, v134
    v_cvt_pk_bf16_f32 v132, v132, v133
    s_waitcnt lgkmcnt(2)
    buffer_load_dwordx4 v[230:231], s[20:23], s35 idxen offen nt lds
    buffer_load_dwordx4 v[232:233], s[40:43], s35 idxen offen offset:1056 nt lds
    s_waitcnt lgkmcnt(0)
    v_mfma_f32_16x16x32_bf16 v[148:151], v[100:103], v[180:183], v[164:167]
    v_rcp_f32 v135, v135
    v_mfma_f32_16x16x32_bf16 v[152:155], v[108:111], v[180:183], v[168:171]
    v_rcp_f32 v136, v136
    v_cvt_pk_bf16_f32 v133, v134, v135
    v_mfma_f32_16x16x32_bf16 v[148:151], v[104:107], v[184:187], v[148:151]
    v_rcp_f32 v137, v137
    v_mfma_f32_16x16x32_bf16 v[152:155], v[112:115], v[184:187], v[152:155]
    v_rcp_f32 v138, v138
    v_cvt_pk_bf16_f32 v134, v136, v137
    v_mfma_f32_16x16x32_bf16 v[156:159], v[116:119], v[180:183], v[172:175]
    v_rcp_f32 v139, v139
    v_mfma_f32_16x16x32_bf16 v[160:163], v[124:127], v[180:183], v[176:179]
    v_rcp_f32 v140, v140
    v_cvt_pk_bf16_f32 v135, v138, v139
    v_mfma_f32_16x16x32_bf16 v[156:159], v[120:123], v[184:187], v[156:159]
    v_rcp_f32 v141, v141
    v_mfma_f32_16x16x32_bf16 v[160:163], v[128:131], v[184:187], v[160:163]
    v_rcp_f32 v142, v142
    v_cvt_pk_bf16_f32 v136, v140, v141
    v_mfma_f32_16x16x32_bf16 v[208:211], v[132:135], v[196:199], v[204:207]
    v_rcp_f32 v143, v143
    v_rcp_f32 v144, v144
    v_cvt_pk_bf16_f32 v137, v142, v143
    v_rcp_f32 v145, v145
    v_rcp_f32 v146, v146
    v_rcp_f32 v147, v147
    v_cvt_pk_bf16_f32 v138, v144, v145
    v_cvt_pk_bf16_f32 v139, v146, v147
    s_bitcmp1_b32 s36, 2
    s_cbranch_scc1 Lf_ev2
Lf_evd2:
    v_mfma_f32_16x16x32_bf16 v[208:211], v[136:139], v[200:203], v[208:211]
    v_exp_f32 v132, v148
    v_exp_f32 v133, v149
    v_exp_f32 v134, v150
    v_exp_f32 v135, v151
    v_exp_f32 v136, v152
    v_exp_f32 v137, v153
    v_mfma_f32_4x4x4_16b_bf16 v[132:135], v[228:229], v[228:229], v[132:135]
    v_exp_f32 v138, v154
    v_exp_f32 v139, v155
    v_cvt_pk_bf16_f32 v208, v208, v209
    v_cvt_pk_bf16_f32 v209, v210, v211
    v_exp_f32 v140, v156
    v_exp_f32 v141, v157
    v_mfma_f32_4x4x4_16b_bf16 v[212:215], v[208:209], v[188:189], v[212:215] cbsz:4 abid:0
    v_mfma_f32_4x4x4_16b_bf16 v[136:139], v[228:229], v[228:229], v[136:139]
    v_exp_f32 v142, v158
    v_mfma_f32_4x4x4_16b_bf16 v[212:215], v[208:209], v[190:191], v[212:215] cbsz:4 abid:4
    v_exp_f32 v143, v159
    v_exp_f32 v144, v160
    v_mfma_f32_4x4x4_16b_bf16 v[212:215], v[208:209], v[192:193], v[212:215] cbsz:4 abid:8
    v_exp_f32 v145, v161
    v_mfma_f32_4x4x4_16b_bf16 v[140:143], v[228:229], v[228:229], v[140:143]
    v_mfma_f32_4x4x4_16b_bf16 v[212:215], v[208:209], v[194:195], v[212:215] cbsz:4 abid:12
    ds_read_u8 v230, v237 offset:96
    ds_read_u8 v232, v237 offset:104
    ds_read_b64_tr_b16 v[188:189], v236 offset:4160
    ds_read_b64_tr_b16 v[190:191], v236 offset:4672
    ds_read_b64_tr_b16 v[192:193], v236 offset:5216
    ds_read_b64_tr_b16 v[194:195], v236 offset:5728
    s_waitcnt vmcnt(4)
    ds_read_b128 v[180:183], v234 offset:6240
    ds_read_b128 v[184:187], v235 offset:6240
    s_add_u32 m0, s52, 4160
    v_exp_f32 v146, v162
    v_exp_f32 v147, v163
    v_rcp_f32 v132, v132
    v_rcp_f32 v133, v133
    v_mfma_f32_4x4x4_16b_bf16 v[144:147], v[228:229], v[228:229], v[144:147]
    v_rcp_f32 v134, v134
    v_cvt_pk_bf16_f32 v132, v132, v133
    s_waitcnt lgkmcnt(2)
    buffer_load_dwordx4 v[230:231], s[20:23], s35 idxen offen nt lds
    buffer_load_dwordx4 v[232:233], s[40:43], s35 idxen offen offset:1056 nt lds
    s_waitcnt lgkmcnt(0)
    v_mfma_f32_16x16x32_bf16 v[148:151], v[100:103], v[180:183], v[164:167]
    v_rcp_f32 v135, v135
    v_mfma_f32_16x16x32_bf16 v[152:155], v[108:111], v[180:183], v[168:171]
    v_rcp_f32 v136, v136
    v_cvt_pk_bf16_f32 v133, v134, v135
    v_mfma_f32_16x16x32_bf16 v[148:151], v[104:107], v[184:187], v[148:151]
    v_rcp_f32 v137, v137
    v_mfma_f32_16x16x32_bf16 v[152:155], v[112:115], v[184:187], v[152:155]
    v_rcp_f32 v138, v138
    v_cvt_pk_bf16_f32 v134, v136, v137
    v_mfma_f32_16x16x32_bf16 v[156:159], v[116:119], v[180:183], v[172:175]
    v_rcp_f32 v139, v139
    v_mfma_f32_16x16x32_bf16 v[160:163], v[124:127], v[180:183], v[176:179]
    v_rcp_f32 v140, v140
    v_cvt_pk_bf16_f32 v135, v138, v139
    v_mfma_f32_16x16x32_bf16 v[156:159], v[120:123], v[184:187], v[156:159]
    v_rcp_f32 v141, v141
    v_mfma_f32_16x16x32_bf16 v[160:163], v[128:131], v[184:187], v[160:163]
    v_rcp_f32 v142, v142
    v_cvt_pk_bf16_f32 v136, v140, v141
    v_mfma_f32_16x16x32_bf16 v[208:211], v[132:135], v[196:199], v[204:207]
    v_rcp_f32 v143, v143
    v_rcp_f32 v144, v144
    v_cvt_pk_bf16_f32 v137, v142, v143
    v_rcp_f32 v145, v145
    v_rcp_f32 v146, v146
    v_rcp_f32 v147, v147
    v_cvt_pk_bf16_f32 v138, v144, v145
    v_cvt_pk_bf16_f32 v139, v146, v147
    s_bitcmp1_b32 s36, 3
    s_cbranch_scc1 Lf_ev3
Lf_evd3:
    v_mfma_f32_16x16x32_bf16 v[208:211], v[136:139], v[200:203], v[208:211]
    v_exp_f32 v132, v148
    v_exp_f32 v133, v149
    v_exp_f32 v134, v150
    v_exp_f32 v135, v151
    v_exp_f32 v136, v152
    v_exp_f32 v137, v153
    v_mfma_f32_4x4x4_16b_bf16 v[132:135], v[228:229], v[228:229], v[132:135]
    v_exp_f32 v138, v154
    v_exp_f32 v139, v155
    v_cvt_pk_bf16_f32 v208, v208, v209
    v_cvt_pk_bf16_f32 v209, v210, v211
    v_exp_f32 v140, v156
    v_exp_f32 v141, v157
    v_mfma_f32_4x4x4_16b_bf16 v[212:215], v[208:209], v[188:189], v[212:215] cbsz:4 abid:0
    v_mfma_f32_4x4x4_16b_bf16 v[136:139], v[228:229], v[228:229], v[136:139]
    v_exp_f32 v142, v158
    v_mfma_f32_4x4x4_16b_bf16 v[212:215], v[208:209], v[190:191], v[212:215] cbsz:4 abid:4
    v_exp_f32 v143, v159
    v_exp_f32 v144, v160
    v_mfma_f32_4x4x4_16b_bf16 v[212:215], v[208:209], v[192:193], v[212:215] cbsz:4 abid:8
    v_exp_f32 v145, v161
    v_mfma_f32_4x4x4_16b_bf16 v[140:143], v[228:229], v[228:229], v[140:143]
    v_mfma_f32_4x4x4_16b_bf16 v[212:215], v[208:209], v[194:195], v[212:215] cbsz:4 abid:12
    ds_read_u8 v230, v237 offset:112
    ds_read_u8 v232, v237 offset:120
    ds_read_b64_tr_b16 v[188:189], v236 offset:6240
    ds_read_b64_tr_b16 v[190:191], v236 offset:6752
    ds_read_b64_tr_b16 v[192:193], v236 offset:7296
    ds_read_b64_tr_b16 v[194:195], v236 offset:7808
    s_waitcnt vmcnt(4)
    ds_read_b128 v[180:183], v234 offset:0
    ds_read_b128 v[184:187], v235 offset:0
    s_add_u32 m0, s52, 6240
    v_exp_f32 v146, v162
    v_exp_f32 v147, v163
    v_rcp_f32 v132, v132
    v_rcp_f32 v133, v133
    v_mfma_f32_4x4x4_16b_bf16 v[144:147], v[228:229], v[228:229], v[144:147]
    v_rcp_f32 v134, v134
    v_cvt_pk_bf16_f32 v132, v132, v133
    s_waitcnt lgkmcnt(2)
    buffer_load_dwordx4 v[230:231], s[20:23], s35 idxen offen nt lds
    buffer_load_dwordx4 v[232:233], s[40:43], s35 idxen offen offset:1056 nt lds
    s_waitcnt lgkmcnt(0)
    v_mfma_f32_16x16x32_bf16 v[148:151], v[100:103], v[180:183], v[164:167]
    v_rcp_f32 v135, v135
    v_mfma_f32_16x16x32_bf16 v[152:155], v[108:111], v[180:183], v[168:171]
    v_rcp_f32 v136, v136
    v_cvt_pk_bf16_f32 v133, v134, v135
    v_mfma_f32_16x16x32_bf16 v[148:151], v[104:107], v[184:187], v[148:151]
    v_rcp_f32 v137, v137
    v_mfma_f32_16x16x32_bf16 v[152:155], v[112:115], v[184:187], v[152:155]
    v_rcp_f32 v138, v138
    v_cvt_pk_bf16_f32 v134, v136, v137
    v_mfma_f32_16x16x32_bf16 v[156:159], v[116:119], v[180:183], v[172:175]
    v_rcp_f32 v139, v139
    v_mfma_f32_16x16x32_bf16 v[160:163], v[124:127], v[180:183], v[176:179]
    v_rcp_f32 v140, v140
    v_cvt_pk_bf16_f32 v135, v138, v139
    v_mfma_f32_16x16x32_bf16 v[156:159], v[120:123], v[184:187], v[156:159]
    v_rcp_f32 v141, v141
    v_mfma_f32_16x16x32_bf16 v[160:163], v[128:131], v[184:187], v[160:163]
    v_rcp_f32 v142, v142
    v_cvt_pk_bf16_f32 v136, v140, v141
    v_mfma_f32_16x16x32_bf16 v[208:211], v[132:135], v[196:199], v[204:207]
    v_rcp_f32 v143, v143
    v_rcp_f32 v144, v144
    v_cvt_pk_bf16_f32 v137, v142, v143
    s_lshr_b64 s[56:57], s[56:57], 4
    s_lshl_b64 s[86:87], s[58:59], 60
    s_or_b64 s[56:57], s[56:57], s[86:87]
    s_lshr_b64 s[58:59], s[58:59], 4
    s_lshr_b64 s[86:87], s[56:57], 2
    s_lshr_b64 s[36:37], s[56:57], 5
    s_or_b32 s36, s36, s86
    s_or_b32 s36, s36, s56
    v_add_u32 v237, 64, v237
    v_rcp_f32 v145, v145
    v_rcp_f32 v146, v146
    v_rcp_f32 v147, v147
    v_cvt_pk_bf16_f32 v138, v144, v145
    v_cvt_pk_bf16_f32 v139, v146, v147
    s_branch Lf_loop
Lf_ev0:
    s_bitcmp0_b64 s[56:57], 0
    s_cbranch_scc1 Lf_nf0
    v_cvt_pk_bf16_f32 v246, v212, v212
    v_mov_b32 v212, 0
    ds_write_b16 v240, v246
    v_add_u32 v240, 128, v240
Lf_nf0:
    s_bitcmp0_b64 s[56:57], 5
    s_cbranch_scc1 Lf_na0
    s_sub_u32 s60, s60, 1
    s_cbranch_scc0 Lf_ns0
    s_mov_b32 s49, 5
    s_call_b64 s[62:63], L_swap
    s_add_u32 s35, s35, s31
    s_min_u32 s35, s35, 419404800
    s_xor_b32 s31, s31, 0x63ff800
    s_bitcmp0_b64 s[56:57], 2
    s_cbranch_scc1 Lf_evd0
    s_waitcnt lgkmcnt(0)
    s_branch Lf_e10
Lf_ns0:
    s_add_u32 s35, s35, s31
    s_min_u32 s35, s35, 419404800
    s_xor_b32 s31, s31, 0x63ff800
Lf_na0:
    s_bitcmp0_b64 s[56:57], 2
    s_cbranch_scc1 Lf_evd0
Lf_e10:
    s_sub_u32 s61, s61, 1
    s_cbranch_scc1 Lf_last0
    s_bitcmp0_b32 s33, s61
    s_cbranch_scc1 Lf_nw0
    s_cmp_eq_u32 s61, 3
    s_cselect_b32 s66, s80, s81
    v_add_u32 v238, s66, v238
    v_add_u32 v239, s66, v239
    ds_read_u16 v224, v238 offset:0
    ds_read_u16 v225, v238 offset:8
    ds_read_u16 v226, v238 offset:64
    ds_read_u16 v227, v238 offset:72
    s_waitcnt lgkmcnt(0)
Lf_nw0:
    v_mul_u32_u24 v216, v224, v241
    v_mul_u32_u24 v217, v224, v242
    v_mul_u32_u24 v218, v225, v241
    v_mul_u32_u24 v219, v225, v242
    v_mul_u32_u24 v220, v226, v241
    v_mul_u32_u24 v221, v226, v242
    v_mul_u32_u24 v222, v227, v241
    v_mul_u32_u24 v223, v227, v242
    v_mfma_f32_4x4x4_16b_bf16 v[140:143], v[216:217], v[68:69], v[4:7]
    v_add_u32 v238, 128, v238
    ds_read_b128 v[164:167], v239 offset:0
    ds_read_b128 v[168:171], v239 offset:64
    v_mfma_f32_4x4x4_16b_bf16 v[144:147], v[218:219], v[70:71], v[8:11]
    ds_read_b128 v[172:175], v239 offset:128
    ds_read_b128 v[176:179], v239 offset:192
    ds_read_u16 v224, v238 offset:0
    ds_read_u16 v225, v238 offset:8
    ds_read_u16 v226, v238 offset:64
    ds_read_u16 v227, v238 offset:72
    v_mfma_f32_4x4x4_16b_bf16 v[246:249], v[220:221], v[72:73], v[12:15]
    v_cvt_pk_bf16_f32 v100, v140, v141
    v_cvt_pk_bf16_f32 v101, v142, v143
    v_mfma_f32_4x4x4_16b_bf16 v[250:253], v[222:223], v[74:75], v[16:19]
    v_cvt_pk_bf16_f32 v102, v144, v145
    v_cvt_pk_bf16_f32 v103, v146, v147
    v_mfma_f32_4x4x4_16b_bf16 v[140:143], v[216:217], v[76:77], v[20:23]
    v_cvt_pk_bf16_f32 v104, v246, v247
    v_cvt_pk_bf16_f32 v105, v248, v249
    v_mfma_f32_4x4x4_16b_bf16 v[144:147], v[218:219], v[78:79], v[24:27]
    v_cvt_pk_bf16_f32 v106, v250, v251
    v_cvt_pk_bf16_f32 v107, v252, v253
    v_mfma_f32_4x4x4_16b_bf16 v[246:249], v[220:221], v[80:81], v[28:31]
    v_cvt_pk_bf16_f32 v108, v140, v141
    v_cvt_pk_bf16_f32 v109, v142, v143
    v_mfma_f32_4x4x4_16b_bf16 v[250:253], v[222:223], v[82:83], v[32:35]
    v_cvt_pk_bf16_f32 v110, v144, v145
    v_cvt_pk_bf16_f32 v111, v146, v147
    v_mfma_f32_4x4x4_16b_bf16 v[140:143], v[216:217], v[84:85], v[36:39]
    v_cvt_pk_bf16_f32 v112, v246, v247
    v_cvt_pk_bf16_f32 v113, v248, v249
    v_mfma_f32_4x4x4_16b_bf16 v[144:147], v[218:219], v[86:87], v[40:43]
    v_cvt_pk_bf16_f32 v114, v250, v251
    v_cvt_pk_bf16_f32 v115, v252, v253
    v_mfma_f32_4x4x4_16b_bf16 v[246:249], v[220:221], v[88:89], v[44:47]
    v_cvt_pk_bf16_f32 v116, v140, v141
    v_cvt_pk_bf16_f32 v117, v142, v143
    v_mfma_f32_4x4x4_16b_bf16 v[250:253], v[222:223], v[90:91], v[48:51]
    v_cvt_pk_bf16_f32 v118, v144, v145
    v_cvt_pk_bf16_f32 v119, v146, v147
    v_mfma_f32_4x4x4_16b_bf16 v[140:143], v[216:217], v[92:93], v[52:55]
    v_cvt_pk_bf16_f32 v120, v246, v247
    v_cvt_pk_bf16_f32 v121, v248, v249
    v_mfma_f32_4x4x4_16b_bf16 v[144:147], v[218:219], v[94:95], v[56:59]
    v_cvt_pk_bf16_f32 v122, v250, v251
    v_cvt_pk_bf16_f32 v123, v252, v253
    v_mfma_f32_4x4x4_16b_bf16 v[246:249], v[220:221], v[96:97], v[60:63]
    v_cvt_pk_bf16_f32 v124, v140, v141
    v_cvt_pk_bf16_f32 v125, v142, v143
    v_mfma_f32_4x4x4_16b_bf16 v[250:253], v[222:223], v[98:99], v[64:67]
    v_cvt_pk_bf16_f32 v126, v144, v145
    v_cvt_pk_bf16_f32 v127, v146, v147
    v_cvt_pk_bf16_f32 v128, v246, v247
    v_cvt_pk_bf16_f32 v129, v248, v249
    v_add_u32 v239, 272, v239
    v_cvt_pk_bf16_f32 v130, v250, v251
    v_cvt_pk_bf16_f32 v131, v252, v253
    s_waitcnt lgkmcnt(0)
    s_branch Lf_evd0
Lf_ev1:
    s_bitcmp0_b64 s[56:57], 1
    s_cbranch_scc1 Lf_nf1
    v_cvt_pk_bf16_f32 v246, v212, v212
    v_mov_b32 v212, 0
    ds_write_b16 v240, v246
    v_add_u32 v240, 128, v240
Lf_nf1:
    s_bitcmp0_b64 s[56:57], 6
    s_cbranch_scc1 Lf_na1
    s_sub_u32 s60, s60, 1
    s_cbranch_scc0 Lf_ns1
    s_mov_b32 s49, 6
    s_call_b64 s[62:63], L_swap
    s_add_u32 s35, s35, s31
    s_min_u32 s35, s35, 419404800
    s_xor_b32 s31, s31, 0x63ff800
    s_bitcmp0_b64 s[56:57], 3
    s_cbranch_scc1 Lf_evd1
    s_waitcnt lgkmcnt(0)
    s_branch Lf_e11
Lf_ns1:
    s_add_u32 s35, s35, s31
    s_min_u32 s35, s35, 419404800
    s_xor_b32 s31, s31, 0x63ff800
Lf_na1:
    s_bitcmp0_b64 s[56:57], 3
    s_cbranch_scc1 Lf_evd1
Lf_e11:
    s_sub_u32 s61, s61, 1
    s_cbranch_scc1 Lf_last1
    s_bitcmp0_b32 s33, s61
    s_cbranch_scc1 Lf_nw1
    s_cmp_eq_u32 s61, 3
    s_cselect_b32 s66, s80, s81
    v_add_u32 v238, s66, v238
    v_add_u32 v239, s66, v239
    ds_read_u16 v224, v238 offset:0
    ds_read_u16 v225, v238 offset:8
    ds_read_u16 v226, v238 offset:64
    ds_read_u16 v227, v238 offset:72
    s_waitcnt lgkmcnt(0)
Lf_nw1:
    v_mul_u32_u24 v216, v224, v241
    v_mul_u32_u24 v217, v224, v242
    v_mul_u32_u24 v218, v225, v241
    v_mul_u32_u24 v219, v225, v242
    v_mul_u32_u24 v220, v226, v241
    v_mul_u32_u24 v221, v226, v242
    v_mul_u32_u24 v222, v227, v241
    v_mul_u32_u24 v223, v227, v242
    v_mfma_f32_4x4x4_16b_bf16 v[140:143], v[216:217], v[68:69], v[4:7]
    v_add_u32 v238, 128, v238
    ds_read_b128 v[164:167], v239 offset:0
    ds_read_b128 v[168:171], v239 offset:64
    v_mfma_f32_4x4x4_16b_bf16 v[144:147], v[218:219], v[70:71], v[8:11]
    ds_read_b128 v[172:175], v239 offset:128
    ds_read_b128 v[176:179], v239 offset:192
    ds_read_u16 v224, v238 offset:0
    ds_read_u16 v225, v238 offset:8
    ds_read_u16 v226, v238 offset:64
    ds_read_u16 v227, v238 offset:72
    v_mfma_f32_4x4x4_16b_bf16 v[246:249], v[220:221], v[72:73], v[12:15]
    v_cvt_pk_bf16_f32 v100, v140, v141
    v_cvt_pk_bf16_f32 v101, v142, v143
    v_mfma_f32_4x4x4_16b_bf16 v[250:253], v[222:223], v[74:75], v[16:19]
    v_cvt_pk_bf16_f32 v102, v144, v145
    v_cvt_pk_bf16_f32 v103, v146, v147
    v_mfma_f32_4x4x4_16b_bf16 v[140:143], v[216:217], v[76:77], v[20:23]
    v_cvt_pk_bf16_f32 v104, v246, v247
    v_cvt_pk_bf16_f32 v105, v248, v249
    v_mfma_f32_4x4x4_16b_bf16 v[144:147], v[218:219], v[78:79], v[24:27]
    v_cvt_pk_bf16_f32 v106, v250, v251
    v_cvt_pk_bf16_f32 v107, v252, v253
    v_mfma_f32_4x4x4_16b_bf16 v[246:249], v[220:221], v[80:81], v[28:31]
    v_cvt_pk_bf16_f32 v108, v140, v141
    v_cvt_pk_bf16_f32 v109, v142, v143
    v_mfma_f32_4x4x4_16b_bf16 v[250:253], v[222:223], v[82:83], v[32:35]
    v_cvt_pk_bf16_f32 v110, v144, v145
    v_cvt_pk_bf16_f32 v111, v146, v147
    v_mfma_f32_4x4x4_16b_bf16 v[140:143], v[216:217], v[84:85], v[36:39]
    v_cvt_pk_bf16_f32 v112, v246, v247
    v_cvt_pk_bf16_f32 v113, v248, v249
    v_mfma_f32_4x4x4_16b_bf16 v[144:147], v[218:219], v[86:87], v[40:43]
    v_cvt_pk_bf16_f32 v114, v250, v251
    v_cvt_pk_bf16_f32 v115, v252, v253
    v_mfma_f32_4x4x4_16b_bf16 v[246:249], v[220:221], v[88:89], v[44:47]
    v_cvt_pk_bf16_f32 v116, v140, v141
    v_cvt_pk_bf16_f32 v117, v142, v143
    v_mfma_f32_4x4x4_16b_bf16 v[250:253], v[222:223], v[90:91], v[48:51]
    v_cvt_pk_bf16_f32 v118, v144, v145
    v_cvt_pk_bf16_f32 v119, v146, v147
    v_mfma_f32_4x4x4_16b_bf16 v[140:143], v[216:217], v[92:93], v[52:55]
    v_cvt_pk_bf16_f32 v120, v246, v247
    v_cvt_pk_bf16_f32 v121, v248, v249
    v_mfma_f32_4x4x4_16b_bf16 v[144:147], v[218:219], v[94:95], v[56:59]
    v_cvt_pk_bf16_f32 v122, v250, v251
    v_cvt_pk_bf16_f32 v123, v252, v253
    v_mfma_f32_4x4x4_16b_bf16 v[246:249], v[220:221], v[96:97], v[60:63]
    v_cvt_pk_bf16_f32 v124, v140, v141
    v_cvt_pk_bf16_f32 v125, v142, v143
    v_mfma_f32_4x4x4_16b_bf16 v[250:253], v[222:223], v[98:99], v[64:67]
    v_cvt_pk_bf16_f32 v126, v144, v145
    v_cvt_pk_bf16_f32 v127, v146, v147
    v_cvt_pk_bf16_f32 v128, v246, v247
    v_cvt_pk_bf16_f32 v129, v248, v249
    v_add_u32 v239, 272, v239
    v_cvt_pk_bf16_f32 v130, v250, v251
    v_cvt_pk_bf16_f32 v131, v252, v253
    s_waitcnt lgkmcnt(0)
    s_branch Lf_evd1
Lf_ev2:
    s_bitcmp0_b64 s[56:57], 2
    s_cbranch_scc1 Lf_nf2
    v_cvt_pk_bf16_f32 v246, v212, v212
    v_mov_b32 v212, 0
    ds_write_b16 v240, v246
    v_add_u32 v240, 128, v240
Lf_nf2:
    s_bitcmp0_b64 s[56:57], 7
    s_cbranch_scc1 Lf_na2
    s_sub_u32 s60, s60, 1
    s_cbranch_scc0 Lf_ns2
    s_mov_b32 s49, 7
    s_call_b64 s[62:63], L_swap
    s_add_u32 s35, s35, s31
    s_min_u32 s35, s35, 419404800
    s_xor_b32 s31, s31, 0x63ff800
    s_bitcmp0_b64 s[56:57], 4
    s_cbranch_scc1 Lf_evd2
    s_waitcnt lgkmcnt(0)
    s_branch Lf_e12
Lf_ns2:
    s_add_u32 s35, s35, s31
    s_min_u32 s35, s35, 419404800
    s_xor_b32 s31, s31, 0x63ff800
Lf_na2:
    s_bitcmp0_b64 s[56:57], 4
    s_cbranch_scc1 Lf_evd2
Lf_e12:
    s_sub_u32 s61, s61, 1
    s_cbranch_scc1 Lf_last2
    s_bitcmp0_b32 s33, s61
    s_cbranch_scc1 Lf_nw2
    s_cmp_eq_u32 s61, 3
    s_cselect_b32 s66, s80, s81
    v_add_u32 v238, s66, v238
    v_add_u32 v239, s66, v239
    ds_read_u16 v224, v238 offset:0
    ds_read_u16 v225, v238 offset:8
    ds_read_u16 v226, v238 offset:64
    ds_read_u16 v227, v238 offset:72
    s_waitcnt lgkmcnt(0)
Lf_nw2:
    v_mul_u32_u24 v216, v224, v241
    v_mul_u32_u24 v217, v224, v242
    v_mul_u32_u24 v218, v225, v241
    v_mul_u32_u24 v219, v225, v242
    v_mul_u32_u24 v220, v226, v241
    v_mul_u32_u24 v221, v226, v242
    v_mul_u32_u24 v222, v227, v241
    v_mul_u32_u24 v223, v227, v242
    v_mfma_f32_4x4x4_16b_bf16 v[140:143], v[216:217], v[68:69], v[4:7]
    v_add_u32 v238, 128, v238
    ds_read_b128 v[164:167], v239 offset:0
    ds_read_b128 v[168:171], v239 offset:64
    v_mfma_f32_4x4x4_16b_bf16 v[144:147], v[218:219], v[70:71], v[8:11]
    ds_read_b128 v[172:175], v239 offset:128
    ds_read_b128 v[176:179], v239 offset:192
    ds_read_u16 v224, v238 offset:0
    ds_read_u16 v225, v238 offset:8
    ds_read_u16 v226, v238 offset:64
    ds_read_u16 v227, v238 offset:72
    v_mfma_f32_4x4x4_16b_bf16 v[246:249], v[220:221], v[72:73], v[12:15]
    v_cvt_pk_bf16_f32 v100, v140, v141
    v_cvt_pk_bf16_f32 v101, v142, v143
    v_mfma_f32_4x4x4_16b_bf16 v[250:253], v[222:223], v[74:75], v[16:19]
    v_cvt_pk_bf16_f32 v102, v144, v145
    v_cvt_pk_bf16_f32 v103, v146, v147
    v_mfma_f32_4x4x4_16b_bf16 v[140:143], v[216:217], v[76:77], v[20:23]
    v_cvt_pk_bf16_f32 v104, v246, v247
    v_cvt_pk_bf16_f32 v105, v248, v249
    v_mfma_f32_4x4x4_16b_bf16 v[144:147], v[218:219], v[78:79], v[24:27]
    v_cvt_pk_bf16_f32 v106, v250, v251
    v_cvt_pk_bf16_f32 v107, v252, v253
    v_mfma_f32_4x4x4_16b_bf16 v[246:249], v[220:221], v[80:81], v[28:31]
    v_cvt_pk_bf16_f32 v108, v140, v141
    v_cvt_pk_bf16_f32 v109, v142, v143
    v_mfma_f32_4x4x4_16b_bf16 v[250:253], v[222:223], v[82:83], v[32:35]
    v_cvt_pk_bf16_f32 v110, v144, v145
    v_cvt_pk_bf16_f32 v111, v146, v147
    v_mfma_f32_4x4x4_16b_bf16 v[140:143], v[216:217], v[84:85], v[36:39]
    v_cvt_pk_bf16_f32 v112, v246, v247
    v_cvt_pk_bf16_f32 v113, v248, v249
    v_mfma_f32_4x4x4_16b_bf16 v[144:147], v[218:219], v[86:87], v[40:43]
    v_cvt_pk_bf16_f32 v114, v250, v251
    v_cvt_pk_bf16_f32 v115, v252, v253
    v_mfma_f32_4x4x4_16b_bf16 v[246:249], v[220:221], v[88:89], v[44:47]
    v_cvt_pk_bf16_f32 v116, v140, v141
    v_cvt_pk_bf16_f32 v117, v142, v143
    v_mfma_f32_4x4x4_16b_bf16 v[250:253], v[222:223], v[90:91], v[48:51]
    v_cvt_pk_bf16_f32 v118, v144, v145
    v_cvt_pk_bf16_f32 v119, v146, v147
    v_mfma_f32_4x4x4_16b_bf16 v[140:143], v[216:217], v[92:93], v[52:55]
    v_cvt_pk_bf16_f32 v120, v246, v247
    v_cvt_pk_bf16_f32 v121, v248, v249
    v_mfma_f32_4x4x4_16b_bf16 v[144:147], v[218:219], v[94:95], v[56:59]
    v_cvt_pk_bf16_f32 v122, v250, v251
    v_cvt_pk_bf16_f32 v123, v252, v253
    v_mfma_f32_4x4x4_16b_bf16 v[246:249], v[220:221], v[96:97], v[60:63]
    v_cvt_pk_bf16_f32 v124, v140, v141
    v_cvt_pk_bf16_f32 v125, v142, v143
    v_mfma_f32_4x4x4_16b_bf16 v[250:253], v[222:223], v[98:99], v[64:67]
    v_cvt_pk_bf16_f32 v126, v144, v145
    v_cvt_pk_bf16_f32 v127, v146, v147
    v_cvt_pk_bf16_f32 v128, v246, v247
    v_cvt_pk_bf16_f32 v129, v248, v249
    v_add_u32 v239, 272, v239
    v_cvt_pk_bf16_f32 v130, v250, v251
    v_cvt_pk_bf16_f32 v131, v252, v253
    s_waitcnt lgkmcnt(0)
    s_branch Lf_evd2
Lf_ev3:
    s_bitcmp0_b64 s[56:57], 3
    s_cbranch_scc1 Lf_nf3
    v_cvt_pk_bf16_f32 v246, v212, v212
    v_mov_b32 v212, 0
    ds_write_b16 v240, v246
    v_add_u32 v240, 128, v240
Lf_nf3:
    s_bitcmp0_b64 s[56:57], 8
    s_cbranch_scc1 Lf_na3
    s_sub_u32 s60, s60, 1
    s_cbranch_scc0 Lf_ns3
    s_mov_b32 s49, 8
    s_call_b64 s[62:63], L_swap
    s_add_u32 s35, s35, s31
    s_min_u32 s35, s35, 419404800
    s_xor_b32 s31, s31, 0x63ff800
    s_bitcmp0_b64 s[56:57], 5
    s_cbranch_scc1 Lf_evd3
    s_waitcnt lgkmcnt(0)
    s_branch Lf_e13
Lf_ns3:
    s_add_u32 s35, s35, s31
    s_min_u32 s35, s35, 419404800
    s_xor_b32 s31, s31, 0x63ff800
Lf_na3:
    s_bitcmp0_b64 s[56:57], 5
    s_cbranch_scc1 Lf_evd3
Lf_e13:
    s_sub_u32 s61, s61, 1
    s_cbranch_scc1 Lf_last3
    s_bitcmp0_b32 s33, s61
    s_cbranch_scc1 Lf_nw3
    s_cmp_eq_u32 s61, 3
    s_cselect_b32 s66, s80, s81
    v_add_u32 v238, s66, v238
    v_add_u32 v239, s66, v239
    ds_read_u16 v224, v238 offset:0
    ds_read_u16 v225, v238 offset:8
    ds_read_u16 v226, v238 offset:64
    ds_read_u16 v227, v238 offset:72
    s_waitcnt lgkmcnt(0)
Lf_nw3:
    v_mul_u32_u24 v216, v224, v241
    v_mul_u32_u24 v217, v224, v242
    v_mul_u32_u24 v218, v225, v241
    v_mul_u32_u24 v219, v225, v242
    v_mul_u32_u24 v220, v226, v241
    v_mul_u32_u24 v221, v226, v242
    v_mul_u32_u24 v222, v227, v241
    v_mul_u32_u24 v223, v227, v242
    v_mfma_f32_4x4x4_16b_bf16 v[140:143], v[216:217], v[68:69], v[4:7]
    v_add_u32 v238, 128, v238
    ds_read_b128 v[164:167], v239 offset:0
    ds_read_b128 v[168:171], v239 offset:64
    v_mfma_f32_4x4x4_16b_bf16 v[144:147], v[218:219], v[70:71], v[8:11]
    ds_read_b128 v[172:175], v239 offset:128
    ds_read_b128 v[176:179], v239 offset:192
    ds_read_u16 v224, v238 offset:0
    ds_read_u16 v225, v238 offset:8
    ds_read_u16 v226, v238 offset:64
    ds_read_u16 v227, v238 offset:72
    v_mfma_f32_4x4x4_16b_bf16 v[246:249], v[220:221], v[72:73], v[12:15]
    v_cvt_pk_bf16_f32 v100, v140, v141
    v_cvt_pk_bf16_f32 v101, v142, v143
    v_mfma_f32_4x4x4_16b_bf16 v[250:253], v[222:223], v[74:75], v[16:19]
    v_cvt_pk_bf16_f32 v102, v144, v145
    v_cvt_pk_bf16_f32 v103, v146, v147
    v_mfma_f32_4x4x4_16b_bf16 v[140:143], v[216:217], v[76:77], v[20:23]
    v_cvt_pk_bf16_f32 v104, v246, v247
    v_cvt_pk_bf16_f32 v105, v248, v249
    v_mfma_f32_4x4x4_16b_bf16 v[144:147], v[218:219], v[78:79], v[24:27]
    v_cvt_pk_bf16_f32 v106, v250, v251
    v_cvt_pk_bf16_f32 v107, v252, v253
    v_mfma_f32_4x4x4_16b_bf16 v[246:249], v[220:221], v[80:81], v[28:31]
    v_cvt_pk_bf16_f32 v108, v140, v141
    v_cvt_pk_bf16_f32 v109, v142, v143
    v_mfma_f32_4x4x4_16b_bf16 v[250:253], v[222:223], v[82:83], v[32:35]
    v_cvt_pk_bf16_f32 v110, v144, v145
    v_cvt_pk_bf16_f32 v111, v146, v147
    v_mfma_f32_4x4x4_16b_bf16 v[140:143], v[216:217], v[84:85], v[36:39]
    v_cvt_pk_bf16_f32 v112, v246, v247
    v_cvt_pk_bf16_f32 v113, v248, v249
    v_mfma_f32_4x4x4_16b_bf16 v[144:147], v[218:219], v[86:87], v[40:43]
    v_cvt_pk_bf16_f32 v114, v250, v251
    v_cvt_pk_bf16_f32 v115, v252, v253
    v_mfma_f32_4x4x4_16b_bf16 v[246:249], v[220:221], v[88:89], v[44:47]
    v_cvt_pk_bf16_f32 v116, v140, v141
    v_cvt_pk_bf16_f32 v117, v142, v143
    v_mfma_f32_4x4x4_16b_bf16 v[250:253], v[222:223], v[90:91], v[48:51]
    v_cvt_pk_bf16_f32 v118, v144, v145
    v_cvt_pk_bf16_f32 v119, v146, v147
    v_mfma_f32_4x4x4_16b_bf16 v[140:143], v[216:217], v[92:93], v[52:55]
    v_cvt_pk_bf16_f32 v120, v246, v247
    v_cvt_pk_bf16_f32 v121, v248, v249
    v_mfma_f32_4x4x4_16b_bf16 v[144:147], v[218:219], v[94:95], v[56:59]
    v_cvt_pk_bf16_f32 v122, v250, v251
    v_cvt_pk_bf16_f32 v123, v252, v253
    v_mfma_f32_4x4x4_16b_bf16 v[246:249], v[220:221], v[96:97], v[60:63]
    v_cvt_pk_bf16_f32 v124, v140, v141
    v_cvt_pk_bf16_f32 v125, v142, v143
    v_mfma_f32_4x4x4_16b_bf16 v[250:253], v[222:223], v[98:99], v[64:67]
    v_cvt_pk_bf16_f32 v126, v144, v145
    v_cvt_pk_bf16_f32 v127, v146, v147
    v_cvt_pk_bf16_f32 v128, v246, v247
    v_cvt_pk_bf16_f32 v129, v248, v249
    v_add_u32 v239, 272, v239
    v_cvt_pk_bf16_f32 v130, v250, v251
    v_cvt_pk_bf16_f32 v131, v252, v253
    s_waitcnt lgkmcnt(0)
    s_branch Lf_evd3
Lf_last0:
    s_branch Lf_tail
Lf_last1:
    v_add_u32 v236, 2080, v236
    s_lshr_b64 s[56:57], s[56:57], 1
    s_branch Lf_tail
Lf_last2:
    v_add_u32 v236, 4160, v236
    s_lshr_b64 s[56:57], s[56:57], 2
    s_branch Lf_tail
Lf_last3:
    v_add_u32 v236, 6240, v236
    s_lshr_b64 s[56:57], s[56:57], 3
Lf_tail:
    v_mfma_f32_16x16x32_bf16 v[208:211], v[136:139], v[200:203], v[208:211]
    v_exp_f32 v132, v148
    v_exp_f32 v133, v149
    v_exp_f32 v134, v150
    v_exp_f32 v135, v151
    v_exp_f32 v136, v152
    v_exp_f32 v137, v153
    v_mfma_f32_4x4x4_16b_bf16 v[132:135], v[228:229], v[228:229], v[132:135]
    v_exp_f32 v138, v154
    v_exp_f32 v139, v155
    v_cvt_pk_bf16_f32 v208, v208, v209
    v_cvt_pk_bf16_f32 v209, v210, v211
    v_exp_f32 v140, v156
    v_exp_f32 v141, v157
    v_mfma_f32_4x4x4_16b_bf16 v[212:215], v[208:209], v[188:189], v[212:215] cbsz:4 abid:0
    v_mfma_f32_4x4x4_16b_bf16 v[136:139], v[228:229], v[228:229], v[136:139]
    v_exp_f32 v142, v158
    v_mfma_f32_4x4x4_16b_bf16 v[212:215], v[208:209], v[190:191], v[212:215] cbsz:4 abid:4
    v_exp_f32 v143, v159
    v_exp_f32 v144, v160
    v_mfma_f32_4x4x4_16b_bf16 v[212:215], v[208:209], v[192:193], v[212:215] cbsz:4 abid:8
    v_exp_f32 v145, v161
    v_mfma_f32_4x4x4_16b_bf16 v[140:143], v[228:229], v[228:229], v[140:143]
    v_mfma_f32_4x4x4_16b_bf16 v[212:215], v[208:209], v[194:195], v[212:215] cbsz:4 abid:12
    ds_read_b64_tr_b16 v[188:189], v236 offset:0
    ds_read_b64_tr_b16 v[190:191], v236 offset:512
    ds_read_b64_tr_b16 v[192:193], v236 offset:1056
    ds_read_b64_tr_b16 v[194:195], v236 offset:1568
    v_exp_f32 v146, v162
    v_exp_f32 v147, v163
    v_rcp_f32 v132, v132
    v_rcp_f32 v133, v133
    v_mfma_f32_4x4x4_16b_bf16 v[144:147], v[228:229], v[228:229], v[144:147]
    v_rcp_f32 v134, v134
    s_bitcmp0_b64 s[56:57], 1
    s_cbranch_scc1 Lf_tnf
    v_cvt_pk_bf16_f32 v246, v212, v212
    v_mov_b32 v212, 0
    ds_write_b16 v240, v246
    v_add_u32 v240, 128, v240
Lf_tnf:
    v_cvt_pk_bf16_f32 v132, v132, v133
    s_waitcnt lgkmcnt(0)
    v_rcp_f32 v135, v135
    v_rcp_f32 v136, v136
    v_cvt_pk_bf16_f32 v133, v134, v135
    v_rcp_f32 v137, v137
    v_rcp_f32 v138, v138
    v_cvt_pk_bf16_f32 v134, v136, v137
    v_rcp_f32 v139, v139
    v_rcp_f32 v140, v140
    v_cvt_pk_bf16_f32 v135, v138, v139
    v_rcp_f32 v141, v141
    v_rcp_f32 v142, v142
    v_cvt_pk_bf16_f32 v136, v140, v141
    v_mfma_f32_16x16x32_bf16 v[208:211], v[132:135], v[196:199], v[204:207]
    v_rcp_f32 v143, v143
    v_rcp_f32 v144, v144
    v_cvt_pk_bf16_f32 v137, v142, v143
    v_rcp_f32 v145, v145
    v_rcp_f32 v146, v146
    v_rcp_f32 v147, v147
    v_cvt_pk_bf16_f32 v138, v144, v145
    v_cvt_pk_bf16_f32 v139, v146, v147
    s_nop 1
    v_mfma_f32_16x16x32_bf16 v[208:211], v[136:139], v[200:203], v[208:211]
    s_nop 7
    v_cvt_pk_bf16_f32 v208, v208, v209
    v_cvt_pk_bf16_f32 v209, v210, v211
    s_nop 1
    v_mfma_f32_4x4x4_16b_bf16 v[212:215], v[208:209], v[188:189], v[212:215] cbsz:4 abid:0
    s_nop 1
    v_mfma_f32_4x4x4_16b_bf16 v[212:215], v[208:209], v[190:191], v[212:215] cbsz:4 abid:4
    s_nop 1
    v_mfma_f32_4x4x4_16b_bf16 v[212:215], v[208:209], v[192:193], v[212:215] cbsz:4 abid:8
    s_nop 1
    v_mfma_f32_4x4x4_16b_bf16 v[212:215], v[208:209], v[194:195], v[212:215] cbsz:4 abid:12
    s_nop 4
    v_cvt_pk_bf16_f32 v246, v212, v212
    ds_write_b16 v240, v246
L_store:
    s_add_u32 s66, s52, 14912
    v_lshl_add_u32 v247, v0, 4, s66
    s_lshl_b32 s66, s82, 5
    s_bfm_b64 exec, 16, 32
    v_add_u32 v243, s66, v243
    s_lshl_b32 s66, s83, 5
    s_bfm_b64 exec, 16, 48
    v_add_u32 v243, s66, v243
    s_mov_b64 exec, -1
    ds_read_b128 v[148:151], v247
    s_waitcnt lgkmcnt(0)
    global_store_dwordx4 v243, v[148:151], s[18:19] sc0 sc1
L_end:
    s_endpgm
L_general:
    s_waitcnt vmcnt(0)
    ds_read_b128 v[44:47], v246 offset:20480
    ds_read_b128 v[48:51], v246 offset:21504
    ds_read_b128 v[88:91], v246 offset:22528
    ds_read_b128 v[52:55], v246 offset:40960
    ds_read_b128 v[56:59], v246 offset:41984
    ds_read_b128 v[92:95], v246 offset:43008
    ds_read_b128 v[60:63], v246 offset:61440
    ds_read_b128 v[64:67], v246 offset:62464
    ds_read_b128 v[96:99], v246 offset:63488
    ds_read_u16 v224, v238 offset:0
    ds_read_u16 v225, v238 offset:8
    ds_read_u16 v226, v238 offset:64
    ds_read_u16 v227, v238 offset:72
    s_mul_i32 s35, s53, 51200
    s_movk_i32 s31, 25600
    s_mov_b32 s60, 3
    s_mov_b64 s[56:57], 0
    s_mov_b64 s[58:59], 0
    v_mov_b32 v148, -1
    v_mov_b32 v149, -1
    v_mov_b32 v150, -1
    v_mov_b32 v151, -1
    s_add_u32 s66, s52, 18432
    v_add_u32 v152, s66, v2
    ds_write_b128 v152, v[148:151]
    ds_write_b128 v152, v[148:151] offset:1024
    s_add_u32 s64, s52, 18448
    s_bfm_b64 s[28:29], 50, 0
    s_mul_i32 s66, s53, 800
    v_add_u32 v247, s66, v2
    s_mov_b64 exec, s[28:29]
    global_load_dwordx4 v[100:103], v247, s[8:9]
    v_add_u32 v247, 1638400, v247
    global_load_dwordx4 v[104:107], v247, s[8:9]
    v_add_u32 v247, 1638400, v247
    global_load_dwordx4 v[108:111], v247, s[8:9]
    v_add_u32 v247, 1638400, v247
    global_load_dwordx4 v[112:115], v247, s[8:9]
    v_add_u32 v247, 1638400, v247
    s_mov_b64 exec, -1
    v_cmp_lt_u32 vcc, 24, v0
    s_nop 1
    v_cndmask_b32 v145, 0, 1, vcc
    v_mul_u32_u24 v142, 25, v145
    v_sub_u32 v142, v0, v142
    v_mul_u32_u24 v142, 0x80008, v142
    v_add_u32 v141, 0x10000, v142
    v_add_u32 v143, 0x50004, v142
    v_add_u32 v144, 0x70006, v142
    v_add_u32 v142, 0x30002, v142
    s_waitcnt vmcnt(0)
    s_mov_b64 exec, s[28:29]
    v_cmp_neq_f16_sdwa s[68:69], v100, 0 src0_sel:WORD_0 src1_sel:WORD_0
    v_cmp_neq_f16_sdwa s[70:71], v100, 0 src0_sel:WORD_1 src1_sel:WORD_0
    v_cmp_neq_f16_sdwa s[72:73], v101, 0 src0_sel:WORD_0 src1_sel:WORD_0
    v_cmp_neq_f16_sdwa s[74:75], v101, 0 src0_sel:WORD_1 src1_sel:WORD_0
    v_cmp_neq_f16_sdwa s[76:77], v102, 0 src0_sel:WORD_0 src1_sel:WORD_0
    v_cmp_neq_f16_sdwa s[78:79], v102, 0 src0_sel:WORD_1 src1_sel:WORD_0
    v_cmp_neq_f16_sdwa s[80:81], v103, 0 src0_sel:WORD_0 src1_sel:WORD_0
    v_cmp_neq_f16_sdwa s[82:83], v103, 0 src0_sel:WORD_1 src1_sel:WORD_0
    s_mov_b64 exec, -1
    v_mov_b32 v132, s64
    v_mbcnt_lo_u32_b32 v132, s68, v132
    v_mbcnt_hi_u32_b32 v132, s69, v132
    v_mbcnt_lo_u32_b32 v132, s70, v132
    v_mbcnt_hi_u32_b32 v132, s71, v132
    v_mbcnt_lo_u32_b32 v132, s72, v132
    v_mbcnt_hi_u32_b32 v132, s73, v132
    v_mbcnt_lo_u32_b32 v132, s74, v132
    v_mbcnt_hi_u32_b32 v132, s75, v132
    v_mbcnt_lo_u32_b32 v132, s76, v132
    v_mbcnt_hi_u32_b32 v132, s77, v132
    v_mbcnt_lo_u32_b32 v132, s78, v132
    v_mbcnt_hi_u32_b32 v132, s79, v132
    v_mbcnt_lo_u32_b32 v132, s80, v132
    v_mbcnt_hi_u32_b32 v132, s81, v132
    v_mbcnt_lo_u32_b32 v132, s82, v132
    v_mbcnt_hi_u32_b32 v132, s83, v132
    s_add_u32 s55, s64, 16
    v_readlane_b32 s66, v132, 25
    v_readlane_b32 s67, v132, 63
    s_add_u32 s64, s66, 15
    s_and_b32 s64, s64, -16
    s_max_u32 s64, s64, s55
    s_sub_u32 s66, s64, s66
    v_mad_u32_u24 v132, v145, s66, v132
    s_mov_b32 s55, s64
    v_addc_co_u32 v133, vcc, 0, v132, s[68:69]
    v_addc_co_u32 v134, vcc, 0, v133, s[70:71]
    v_addc_co_u32 v135, vcc, 0, v134, s[72:73]
    v_addc_co_u32 v136, vcc, 0, v135, s[74:75]
    v_addc_co_u32 v137, vcc, 0, v136, s[76:77]
    v_addc_co_u32 v138, vcc, 0, v137, s[78:79]
    v_addc_co_u32 v139, vcc, 0, v138, s[80:81]
    s_add_u32 s67, s67, s66
    s_add_u32 s67, s67, 15
    s_and_b32 s67, s67, -16
    s_add_u32 s64, s64, 16
    s_max_u32 s64, s64, s67
    s_mov_b64 exec, s[68:69]
    ds_write_b8 v132, v141
    s_mov_b64 exec, s[70:71]
    ds_write_b8_d16_hi v133, v141
    s_mov_b64 exec, s[72:73]
    ds_write_b8 v134, v142
    s_mov_b64 exec, s[74:75]
    ds_write_b8_d16_hi v135, v142
    s_mov_b64 exec, s[76:77]
    ds_write_b8 v136, v143
    s_mov_b64 exec, s[78:79]
    ds_write_b8_d16_hi v137, v143
    s_mov_b64 exec, s[80:81]
    ds_write_b8 v138, v144
    s_mov_b64 exec, s[82:83]
    ds_write_b8_d16_hi v139, v144
    s_mov_b64 exec, -1
    s_lshr_b32 s95, s55, 4
    s_bitset1_b64 s[56:57], s95
    s_lshr_b32 s95, s64, 4
    s_bitset1_b64 s[56:57], s95
    s_mov_b64 exec, s[28:29]
    v_cmp_neq_f16_sdwa s[68:69], v104, 0 src0_sel:WORD_0 src1_sel:WORD_0
    v_cmp_neq_f16_sdwa s[70:71], v104, 0 src0_sel:WORD_1 src1_sel:WORD_0
    v_cmp_neq_f16_sdwa s[72:73], v105, 0 src0_sel:WORD_0 src1_sel:WORD_0
    v_cmp_neq_f16_sdwa s[74:75], v105, 0 src0_sel:WORD_1 src1_sel:WORD_0
    v_cmp_neq_f16_sdwa s[76:77], v106, 0 src0_sel:WORD_0 src1_sel:WORD_0
    v_cmp_neq_f16_sdwa s[78:79], v106, 0 src0_sel:WORD_1 src1_sel:WORD_0
    v_cmp_neq_f16_sdwa s[80:81], v107, 0 src0_sel:WORD_0 src1_sel:WORD_0
    v_cmp_neq_f16_sdwa s[82:83], v107, 0 src0_sel:WORD_1 src1_sel:WORD_0
    s_mov_b64 exec, -1
    v_mov_b32 v132, s64
    v_mbcnt_lo_u32_b32 v132, s68, v132
    v_mbcnt_hi_u32_b32 v132, s69, v132
    v_mbcnt_lo_u32_b32 v132, s70, v132
    v_mbcnt_hi_u32_b32 v132, s71, v132
    v_mbcnt_lo_u32_b32 v132, s72, v132
    v_mbcnt_hi_u32_b32 v132, s73, v132
    v_mbcnt_lo_u32_b32 v132, s74, v132
    v_mbcnt_hi_u32_b32 v132, s75, v132
    v_mbcnt_lo_u32_b32 v132, s76, v132
    v_mbcnt_hi_u32_b32 v132, s77, v132
    v_mbcnt_lo_u32_b32 v132, s78, v132
    v_mbcnt_hi_u32_b32 v132, s79, v132
    v_mbcnt_lo_u32_b32 v132, s80, v132
    v_mbcnt_hi_u32_b32 v132, s81, v132
    v_mbcnt_lo_u32_b32 v132, s82, v132
    v_mbcnt_hi_u32_b32 v132, s83, v132
    s_add_u32 s55, s64, 16
    v_readlane_b32 s66, v132, 25
    v_readlane_b32 s67, v132, 63
    s_add_u32 s64, s66, 15
    s_and_b32 s64, s64, -16
    s_max_u32 s64, s64, s55
    s_sub_u32 s66, s64, s66
    v_mad_u32_u24 v132, v145, s66, v132
    s_mov_b32 s55, s64
    v_addc_co_u32 v133, vcc, 0, v132, s[68:69]
    v_addc_co_u32 v134, vcc, 0, v133, s[70:71]
    v_addc_co_u32 v135, vcc, 0, v134, s[72:73]
    v_addc_co_u32 v136, vcc, 0, v135, s[74:75]
    v_addc_co_u32 v137, vcc, 0, v136, s[76:77]
    v_addc_co_u32 v138, vcc, 0, v137, s[78:79]
    v_addc_co_u32 v139, vcc, 0, v138, s[80:81]
    s_add_u32 s67, s67, s66
    s_add_u32 s67, s67, 15
    s_and_b32 s67, s67, -16
    s_add_u32 s64, s64, 16
    s_max_u32 s64, s64, s67
    s_mov_b64 exec, s[68:69]
    ds_write_b8 v132, v141
    s_mov_b64 exec, s[70:71]
    ds_write_b8_d16_hi v133, v141
    s_mov_b64 exec, s[72:73]
    ds_write_b8 v134, v142
    s_mov_b64 exec, s[74:75]
    ds_write_b8_d16_hi v135, v142
    s_mov_b64 exec, s[76:77]
    ds_write_b8 v136, v143
    s_mov_b64 exec, s[78:79]
    ds_write_b8_d16_hi v137, v143
    s_mov_b64 exec, s[80:81]
    ds_write_b8 v138, v144
    s_mov_b64 exec, s[82:83]
    ds_write_b8_d16_hi v139, v144
    s_mov_b64 exec, -1
    s_lshr_b32 s95, s55, 4
    s_bitset1_b64 s[56:57], s95
    s_lshr_b32 s95, s64, 4
    s_bitset1_b64 s[56:57], s95
    s_mov_b32 s44, s64
    s_mov_b64 exec, s[28:29]
    v_cmp_neq_f16_sdwa s[68:69], v108, 0 src0_sel:WORD_0 src1_sel:WORD_0
    v_cmp_neq_f16_sdwa s[70:71], v108, 0 src0_sel:WORD_1 src1_sel:WORD_0
    v_cmp_neq_f16_sdwa s[72:73], v109, 0 src0_sel:WORD_0 src1_sel:WORD_0
    v_cmp_neq_f16_sdwa s[74:75], v109, 0 src0_sel:WORD_1 src1_sel:WORD_0
    v_cmp_neq_f16_sdwa s[76:77], v110, 0 src0_sel:WORD_0 src1_sel:WORD_0
    v_cmp_neq_f16_sdwa s[78:79], v110, 0 src0_sel:WORD_1 src1_sel:WORD_0
    v_cmp_neq_f16_sdwa s[80:81], v111, 0 src0_sel:WORD_0 src1_sel:WORD_0
    v_cmp_neq_f16_sdwa s[82:83], v111, 0 src0_sel:WORD_1 src1_sel:WORD_0
    s_mov_b64 exec, -1
    v_mov_b32 v132, s64
    v_mbcnt_lo_u32_b32 v132, s68, v132
    v_mbcnt_hi_u32_b32 v132, s69, v132
    v_mbcnt_lo_u32_b32 v132, s70, v132
    v_mbcnt_hi_u32_b32 v132, s71, v132
    v_mbcnt_lo_u32_b32 v132, s72, v132
    v_mbcnt_hi_u32_b32 v132, s73, v132
    v_mbcnt_lo_u32_b32 v132, s74, v132
    v_mbcnt_hi_u32_b32 v132, s75, v132
    v_mbcnt_lo_u32_b32 v132, s76, v132
    v_mbcnt_hi_u32_b32 v132, s77, v132
    v_mbcnt_lo_u32_b32 v132, s78, v132
    v_mbcnt_hi_u32_b32 v132, s79, v132
    v_mbcnt_lo_u32_b32 v132, s80, v132
    v_mbcnt_hi_u32_b32 v132, s81, v132
    v_mbcnt_lo_u32_b32 v132, s82, v132
    v_mbcnt_hi_u32_b32 v132, s83, v132
    s_add_u32 s55, s64, 16
    v_readlane_b32 s66, v132, 25
    v_readlane_b32 s67, v132, 63
    s_add_u32 s64, s66, 15
    s_and_b32 s64, s64, -16
    s_max_u32 s64, s64, s55
    s_sub_u32 s66, s64, s66
    v_mad_u32_u24 v132, v145, s66, v132
    s_mov_b32 s55, s64
    v_addc_co_u32 v133, vcc, 0, v132, s[68:69]
    v_addc_co_u32 v134, vcc, 0, v133, s[70:71]
    v_addc_co_u32 v135, vcc, 0, v134, s[72:73]
    v_addc_co_u32 v136, vcc, 0, v135, s[74:75]
    v_addc_co_u32 v137, vcc, 0, v136, s[76:77]
    v_addc_co_u32 v138, vcc, 0, v137, s[78:79]
    v_addc_co_u32 v139, vcc, 0, v138, s[80:81]
    s_add_u32 s67, s67, s66
    s_add_u32 s67, s67, 15
    s_and_b32 s67, s67, -16
    s_add_u32 s64, s64, 16
    s_max_u32 s64, s64, s67
    s_mov_b64 exec, s[68:69]
    ds_write_b8 v132, v141
    s_mov_b64 exec, s[70:71]
    ds_write_b8_d16_hi v133, v141
    s_mov_b64 exec, s[72:73]
    ds_write_b8 v134, v142
    s_mov_b64 exec, s[74:75]
    ds_write_b8_d16_hi v135, v142
    s_mov_b64 exec, s[76:77]
    ds_write_b8 v136, v143
    s_mov_b64 exec, s[78:79]
    ds_write_b8_d16_hi v137, v143
    s_mov_b64 exec, s[80:81]
    ds_write_b8 v138, v144
    s_mov_b64 exec, s[82:83]
    ds_write_b8_d16_hi v139, v144
    s_mov_b64 exec, -1
    s_mov_b32 s45, s55
    s_mov_b32 s46, s64
    s_mov_b64 exec, s[28:29]
    v_cmp_neq_f16_sdwa s[68:69], v112, 0 src0_sel:WORD_0 src1_sel:WORD_0
    v_cmp_neq_f16_sdwa s[70:71], v112, 0 src0_sel:WORD_1 src1_sel:WORD_0
    v_cmp_neq_f16_sdwa s[72:73], v113, 0 src0_sel:WORD_0 src1_sel:WORD_0
    v_cmp_neq_f16_sdwa s[74:75], v113, 0 src0_sel:WORD_1 src1_sel:WORD_0
    v_cmp_neq_f16_sdwa s[76:77], v114, 0 src0_sel:WORD_0 src1_sel:WORD_0
    v_cmp_neq_f16_sdwa s[78:79], v114, 0 src0_sel:WORD_1 src1_sel:WORD_0
    v_cmp_neq_f16_sdwa s[80:81], v115, 0 src0_sel:WORD_0 src1_sel:WORD_0
    v_cmp_neq_f16_sdwa s[82:83], v115, 0 src0_sel:WORD_1 src1_sel:WORD_0
    s_mov_b64 exec, -1
    v_mov_b32 v132, s64
    v_mbcnt_lo_u32_b32 v132, s68, v132
    v_mbcnt_hi_u32_b32 v132, s69, v132
    v_mbcnt_lo_u32_b32 v132, s70, v132
    v_mbcnt_hi_u32_b32 v132, s71, v132
    v_mbcnt_lo_u32_b32 v132, s72, v132
    v_mbcnt_hi_u32_b32 v132, s73, v132
    v_mbcnt_lo_u32_b32 v132, s74, v132
    v_mbcnt_hi_u32_b32 v132, s75, v132
    v_mbcnt_lo_u32_b32 v132, s76, v132
    v_mbcnt_hi_u32_b32 v132, s77, v132
    v_mbcnt_lo_u32_b32 v132, s78, v132
    v_mbcnt_hi_u32_b32 v132, s79, v132
    v_mbcnt_lo_u32_b32 v132, s80, v132
    v_mbcnt_hi_u32_b32 v132, s81, v132
    v_mbcnt_lo_u32_b32 v132, s82, v132
    v_mbcnt_hi_u32_b32 v132, s83, v132
    s_add_u32 s55, s64, 16
    v_readlane_b32 s66, v132, 25
    v_readlane_b32 s67, v132, 63
    s_add_u32 s64, s66, 15
    s_and_b32 s64, s64, -16
    s_max_u32 s64, s64, s55
    s_sub_u32 s66, s64, s66
    v_mad_u32_u24 v132, v145, s66, v132
    s_mov_b32 s55, s64
    v_addc_co_u32 v133, vcc, 0, v132, s[68:69]
    v_addc_co_u32 v134, vcc, 0, v133, s[70:71]
    v_addc_co_u32 v135, vcc, 0, v134, s[72:73]
    v_addc_co_u32 v136, vcc, 0, v135, s[74:75]
    v_addc_co_u32 v137, vcc, 0, v136, s[76:77]
    v_addc_co_u32 v138, vcc, 0, v137, s[78:79]
    v_addc_co_u32 v139, vcc, 0, v138, s[80:81]
    s_add_u32 s67, s67, s66
    s_add_u32 s67, s67, 15
    s_and_b32 s67, s67, -16
    s_add_u32 s64, s64, 16
    s_max_u32 s64, s64, s67
    s_mov_b64 exec, s[68:69]
    ds_write_b8 v132, v141
    s_mov_b64 exec, s[70:71]
    ds_write_b8_d16_hi v133, v141
    s_mov_b64 exec, s[72:73]
    ds_write_b8 v134, v142
    s_mov_b64 exec, s[74:75]
    ds_write_b8_d16_hi v135, v142
    s_mov_b64 exec, s[76:77]
    ds_write_b8 v136, v143
    s_mov_b64 exec, s[78:79]
    ds_write_b8_d16_hi v137, v143
    s_mov_b64 exec, s[80:81]
    ds_write_b8 v138, v144
    s_mov_b64 exec, s[82:83]
    ds_write_b8_d16_hi v139, v144
    s_mov_b64 exec, -1
    s_mov_b32 s47, s55
    s_mov_b32 s48, s64
    s_mov_b32 s94, 0
    s_mov_b64 s[84:85], -1
    s_branch L_listed
Ls_loop:
Ls_mid:
    s_bitcmp1_b32 s36, 0
    s_cbranch_scc1 Ls_ev0
Ls_evd0:
    v_mfma_f32_16x16x32_bf16 v[208:211], v[136:139], v[200:203], v[208:211]
    ds_read_b32 v246, v244 offset:0
    s_waitcnt lgkmcnt(0)
    v_bfe_u32 v247, v246, 0, 8
    v_lshlrev_b32 v247, 1, v247
    v_bfe_u32 v248, v246, 8, 8
    v_lshlrev_b32 v248, 1, v248
    v_bfe_u32 v249, v246, 16, 8
    v_lshlrev_b32 v249, 1, v249
    v_bfe_u32 v250, v246, 24, 8
    v_lshlrev_b32 v250, 1, v250
    buffer_load_ushort v247, v247, s[24:27], 0 offen
    buffer_load_ushort v248, v248, s[24:27], 0 offen
    buffer_load_ushort v249, v249, s[24:27], 0 offen
    buffer_load_ushort v250, v250, s[24:27], 0 offen
    s_waitcnt vmcnt(0)
    v_lshlrev_b32 v247, 16, v247
    v_mul_f32 v208, v208, v247
    v_lshlrev_b32 v248, 16, v248
    v_mul_f32 v209, v209, v248
    v_lshlrev_b32 v249, 16, v249
    v_mul_f32 v210, v210, v249
    v_lshlrev_b32 v250, 16, v250
    v_mul_f32 v211, v211, v250
    v_exp_f32 v132, v148
    v_exp_f32 v133, v149
    v_exp_f32 v134, v150
    v_exp_f32 v135, v151
    v_exp_f32 v136, v152
    v_exp_f32 v137, v153
    v_mfma_f32_4x4x4_16b_bf16 v[132:135], v[228:229], v[228:229], v[132:135]
    v_exp_f32 v138, v154
    v_exp_f32 v139, v155
    v_cvt_pk_bf16_f32 v208, v208, v209
    v_cvt_pk_bf16_f32 v209, v210, v211
    v_exp_f32 v140, v156
    v_exp_f32 v141, v157
    v_mfma_f32_4x4x4_16b_bf16 v[212:215], v[208:209], v[188:189], v[212:215] cbsz:4 abid:0
    v_mfma_f32_4x4x4_16b_bf16 v[136:139], v[228:229], v[228:229], v[136:139]
    v_exp_f32 v142, v158
    v_mfma_f32_4x4x4_16b_bf16 v[212:215], v[208:209], v[190:191], v[212:215] cbsz:4 abid:4
    v_exp_f32 v143, v159
    v_exp_f32 v144, v160
    v_mfma_f32_4x4x4_16b_bf16 v[212:215], v[208:209], v[192:193], v[212:215] cbsz:4 abid:8
    v_exp_f32 v145, v161
    v_mfma_f32_4x4x4_16b_bf16 v[140:143], v[228:229], v[228:229], v[140:143]
    v_mfma_f32_4x4x4_16b_bf16 v[212:215], v[208:209], v[194:195], v[212:215] cbsz:4 abid:12
    ds_add_rtn_u32 v1, v2, v3
    ds_read_u8 v230, v237 offset:64
    ds_read_u8 v232, v237 offset:72
    ds_read_b64_tr_b16 v[188:189], v236 offset:0
    ds_read_b64_tr_b16 v[190:191], v236 offset:512
    ds_read_b64_tr_b16 v[192:193], v236 offset:1056
    ds_read_b64_tr_b16 v[194:195], v236 offset:1568
    s_waitcnt vmcnt(4)
    ds_read_b128 v[180:183], v234 offset:2080
    ds_read_b128 v[184:187], v235 offset:2080
    s_add_u32 m0, s52, 0
    v_exp_f32 v146, v162
    v_exp_f32 v147, v163
    v_rcp_f32 v132, v132
    v_rcp_f32 v133, v133
    v_mfma_f32_4x4x4_16b_bf16 v[144:147], v[228:229], v[228:229], v[144:147]
    v_rcp_f32 v134, v134
    v_cvt_pk_bf16_f32 v132, v132, v133
    s_waitcnt lgkmcnt(2)
    buffer_load_dwordx4 v[230:231], s[20:23], s35 idxen offen nt lds
    buffer_load_dwordx4 v[232:233], s[40:43], s35 idxen offen offset:1056 nt lds
    s_waitcnt lgkmcnt(0)
    v_mfma_f32_16x16x32_bf16 v[148:151], v[100:103], v[180:183], v[164:167]
    v_rcp_f32 v135, v135
    v_mfma_f32_16x16x32_bf16 v[152:155], v[108:111], v[180:183], v[168:171]
    v_rcp_f32 v136, v136
    v_cvt_pk_bf16_f32 v133, v134, v135
    v_mfma_f32_16x16x32_bf16 v[148:151], v[104:107], v[184:187], v[148:151]
    v_rcp_f32 v137, v137
    v_readfirstlane_b32 s66, v1
    s_setprio 0
    s_cmp_gt_i32 s66, 0
    s_cbranch_scc0 Ls_lo0
    s_setprio 1
Ls_lo0:
    v_mfma_f32_16x16x32_bf16 v[152:155], v[112:115], v[184:187], v[152:155]
    v_rcp_f32 v138, v138
    v_cvt_pk_bf16_f32 v134, v136, v137
    v_mfma_f32_16x16x32_bf16 v[156:159], v[116:119], v[180:183], v[172:175]
    v_rcp_f32 v139, v139
    v_mfma_f32_16x16x32_bf16 v[160:163], v[124:127], v[180:183], v[176:179]
    v_rcp_f32 v140, v140
    v_cvt_pk_bf16_f32 v135, v138, v139
    v_mfma_f32_16x16x32_bf16 v[156:159], v[120:123], v[184:187], v[156:159]
    v_rcp_f32 v141, v141
    v_mfma_f32_16x16x32_bf16 v[160:163], v[128:131], v[184:187], v[160:163]
    v_rcp_f32 v142, v142
    v_cvt_pk_bf16_f32 v136, v140, v141
    v_mfma_f32_16x16x32_bf16 v[208:211], v[132:135], v[196:199], v[204:207]
    v_rcp_f32 v143, v143
    v_rcp_f32 v144, v144
    v_cvt_pk_bf16_f32 v137, v142, v143
    v_rcp_f32 v145, v145
    v_rcp_f32 v146, v146
    v_rcp_f32 v147, v147
    v_cvt_pk_bf16_f32 v138, v144, v145
    v_cvt_pk_bf16_f32 v139, v146, v147
    s_bitcmp1_b32 s36, 1
    s_cbranch_scc1 Ls_ev1
Ls_evd1:
    v_mfma_f32_16x16x32_bf16 v[208:211], v[136:139], v[200:203], v[208:211]
    ds_read_b32 v246, v244 offset:16
    s_waitcnt lgkmcnt(0)
    v_bfe_u32 v247, v246, 0, 8
    v_lshlrev_b32 v247, 1, v247
    v_bfe_u32 v248, v246, 8, 8
    v_lshlrev_b32 v248, 1, v248
    v_bfe_u32 v249, v246, 16, 8
    v_lshlrev_b32 v249, 1, v249
    v_bfe_u32 v250, v246, 24, 8
    v_lshlrev_b32 v250, 1, v250
    buffer_load_ushort v247, v247, s[24:27], 0 offen
    buffer_load_ushort v248, v248, s[24:27], 0 offen
    buffer_load_ushort v249, v249, s[24:27], 0 offen
    buffer_load_ushort v250, v250, s[24:27], 0 offen
    s_waitcnt vmcnt(0)
    v_lshlrev_b32 v247, 16, v247
    v_mul_f32 v208, v208, v247
    v_lshlrev_b32 v248, 16, v248
    v_mul_f32 v209, v209, v248
    v_lshlrev_b32 v249, 16, v249
    v_mul_f32 v210, v210, v249
    v_lshlrev_b32 v250, 16, v250
    v_mul_f32 v211, v211, v250
    v_exp_f32 v132, v148
    v_exp_f32 v133, v149
    v_exp_f32 v134, v150
    v_exp_f32 v135, v151
    v_exp_f32 v136, v152
    v_exp_f32 v137, v153
    v_mfma_f32_4x4x4_16b_bf16 v[132:135], v[228:229], v[228:229], v[132:135]
    v_exp_f32 v138, v154
    v_exp_f32 v139, v155
    v_cvt_pk_bf16_f32 v208, v208, v209
    v_cvt_pk_bf16_f32 v209, v210, v211
    v_exp_f32 v140, v156
    v_exp_f32 v141, v157
    v_mfma_f32_4x4x4_16b_bf16 v[212:215], v[208:209], v[188:189], v[212:215] cbsz:4 abid:0
    v_mfma_f32_4x4x4_16b_bf16 v[136:139], v[228:229], v[228:229], v[136:139]
    v_exp_f32 v142, v158
    v_mfma_f32_4x4x4_16b_bf16 v[212:215], v[208:209], v[190:191], v[212:215] cbsz:4 abid:4
    v_exp_f32 v143, v159
    v_exp_f32 v144, v160
    v_mfma_f32_4x4x4_16b_bf16 v[212:215], v[208:209], v[192:193], v[212:215] cbsz:4 abid:8
    v_exp_f32 v145, v161
    v_mfma_f32_4x4x4_16b_bf16 v[140:143], v[228:229], v[228:229], v[140:143]
    v_mfma_f32_4x4x4_16b_bf16 v[212:215], v[208:209], v[194:195], v[212:215] cbsz:4 abid:12
    ds_read_u8 v230, v237 offset:80
    ds_read_u8 v232, v237 offset:88
    ds_read_b64_tr_b16 v[188:189], v236 offset:2080
    ds_read_b64_tr_b16 v[190:191], v236 offset:2592
    ds_read_b64_tr_b16 v[192:193], v236 offset:3136
    ds_read_b64_tr_b16 v[194:195], v236 offset:3648
    s_waitcnt vmcnt(4)
    ds_read_b128 v[180:183], v234 offset:4160
    ds_read_b128 v[184:187], v235 offset:4160
    s_add_u32 m0, s52, 2080
    v_exp_f32 v146, v162
    v_exp_f32 v147, v163
    v_rcp_f32 v132, v132
    v_rcp_f32 v133, v133
    v_mfma_f32_4x4x4_16b_bf16 v[144:147], v[228:229], v[228:229], v[144:147]
    v_rcp_f32 v134, v134
    v_cvt_pk_bf16_f32 v132, v132, v133
    s_waitcnt lgkmcnt(2)
    buffer_load_dwordx4 v[230:231], s[20:23], s35 idxen offen nt lds
    buffer_load_dwordx4 v[232:233], s[40:43], s35 idxen offen offset:1056 nt lds
    s_waitcnt lgkmcnt(0)
    v_mfma_f32_16x16x32_bf16 v[148:151], v[100:103], v[180:183], v[164:167]
    v_rcp_f32 v135, v135
    v_mfma_f32_16x16x32_bf16 v[152:155], v[108:111], v[180:183], v[168:171]
    v_rcp_f32 v136, v136
    v_cvt_pk_bf16_f32 v133, v134, v135
    v_mfma_f32_16x16x32_bf16 v[148:151], v[104:107], v[184:187], v[148:151]
    v_rcp_f32 v137, v137
    v_mfma_f32_16x16x32_bf16 v[152:155], v[112:115], v[184:187], v[152:155]
    v_rcp_f32 v138, v138
    v_cvt_pk_bf16_f32 v134, v136, v137
    v_mfma_f32_16x16x32_bf16 v[156:159], v[116:119], v[180:183], v[172:175]
    v_rcp_f32 v139, v139
    v_mfma_f32_16x16x32_bf16 v[160:163], v[124:127], v[180:183], v[176:179]
    v_rcp_f32 v140, v140
    v_cvt_pk_bf16_f32 v135, v138, v139
    v_mfma_f32_16x16x32_bf16 v[156:159], v[120:123], v[184:187], v[156:159]
    v_rcp_f32 v141, v141
    v_mfma_f32_16x16x32_bf16 v[160:163], v[128:131], v[184:187], v[160:163]
    v_rcp_f32 v142, v142
    v_cvt_pk_bf16_f32 v136, v140, v141
    v_mfma_f32_16x16x32_bf16 v[208:211], v[132:135], v[196:199], v[204:207]
    v_rcp_f32 v143, v143
    v_rcp_f32 v144, v144
    v_cvt_pk_bf16_f32 v137, v142, v143
    v_rcp_f32 v145, v145
    v_rcp_f32 v146, v146
    v_rcp_f32 v147, v147
    v_cvt_pk_bf16_f32 v138, v144, v145
    v_cvt_pk_bf16_f32 v139, v146, v147
    s_bitcmp1_b32 s36, 2
    s_cbranch_scc1 Ls_ev2
Ls_evd2:
    v_mfma_f32_16x16x32_bf16 v[208:211], v[136:139], v[200:203], v[208:211]
    ds_read_b32 v246, v244 offset:32
    s_waitcnt lgkmcnt(0)
    v_bfe_u32 v247, v246, 0, 8
    v_lshlrev_b32 v247, 1, v247
    v_bfe_u32 v248, v246, 8, 8
    v_lshlrev_b32 v248, 1, v248
    v_bfe_u32 v249, v246, 16, 8
    v_lshlrev_b32 v249, 1, v249
    v_bfe_u32 v250, v246, 24, 8
    v_lshlrev_b32 v250, 1, v250
    buffer_load_ushort v247, v247, s[24:27], 0 offen
    buffer_load_ushort v248, v248, s[24:27], 0 offen
    buffer_load_ushort v249, v249, s[24:27], 0 offen
    buffer_load_ushort v250, v250, s[24:27], 0 offen
    s_waitcnt vmcnt(0)
    v_lshlrev_b32 v247, 16, v247
    v_mul_f32 v208, v208, v247
    v_lshlrev_b32 v248, 16, v248
    v_mul_f32 v209, v209, v248
    v_lshlrev_b32 v249, 16, v249
    v_mul_f32 v210, v210, v249
    v_lshlrev_b32 v250, 16, v250
    v_mul_f32 v211, v211, v250
    v_exp_f32 v132, v148
    v_exp_f32 v133, v149
    v_exp_f32 v134, v150
    v_exp_f32 v135, v151
    v_exp_f32 v136, v152
    v_exp_f32 v137, v153
    v_mfma_f32_4x4x4_16b_bf16 v[132:135], v[228:229], v[228:229], v[132:135]
    v_exp_f32 v138, v154
    v_exp_f32 v139, v155
    v_cvt_pk_bf16_f32 v208, v208, v209
    v_cvt_pk_bf16_f32 v209, v210, v211
    v_exp_f32 v140, v156
    v_exp_f32 v141, v157
    v_mfma_f32_4x4x4_16b_bf16 v[212:215], v[208:209], v[188:189], v[212:215] cbsz:4 abid:0
    v_mfma_f32_4x4x4_16b_bf16 v[136:139], v[228:229], v[228:229], v[136:139]
    v_exp_f32 v142, v158
    v_mfma_f32_4x4x4_16b_bf16 v[212:215], v[208:209], v[190:191], v[212:215] cbsz:4 abid:4
    v_exp_f32 v143, v159
    v_exp_f32 v144, v160
    v_mfma_f32_4x4x4_16b_bf16 v[212:215], v[208:209], v[192:193], v[212:215] cbsz:4 abid:8
    v_exp_f32 v145, v161
    v_mfma_f32_4x4x4_16b_bf16 v[140:143], v[228:229], v[228:229], v[140:143]
    v_mfma_f32_4x4x4_16b_bf16 v[212:215], v[208:209], v[194:195], v[212:215] cbsz:4 abid:12
    ds_read_u8 v230, v237 offset:96
    ds_read_u8 v232, v237 offset:104
    ds_read_b64_tr_b16 v[188:189], v236 offset:4160
    ds_read_b64_tr_b16 v[190:191], v236 offset:4672
    ds_read_b64_tr_b16 v[192:193], v236 offset:5216
    ds_read_b64_tr_b16 v[194:195], v236 offset:5728
    s_waitcnt vmcnt(4)
    ds_read_b128 v[180:183], v234 offset:6240
    ds_read_b128 v[184:187], v235 offset:6240
    s_add_u32 m0, s52, 4160
    v_exp_f32 v146, v162
    v_exp_f32 v147, v163
    v_rcp_f32 v132, v132
    v_rcp_f32 v133, v133
    v_mfma_f32_4x4x4_16b_bf16 v[144:147], v[228:229], v[228:229], v[144:147]
    v_rcp_f32 v134, v134
    v_cvt_pk_bf16_f32 v132, v132, v133
    s_waitcnt lgkmcnt(2)
    buffer_load_dwordx4 v[230:231], s[20:23], s35 idxen offen nt lds
    buffer_load_dwordx4 v[232:233], s[40:43], s35 idxen offen offset:1056 nt lds
    s_waitcnt lgkmcnt(0)
    v_mfma_f32_16x16x32_bf16 v[148:151], v[100:103], v[180:183], v[164:167]
    v_rcp_f32 v135, v135
    v_mfma_f32_16x16x32_bf16 v[152:155], v[108:111], v[180:183], v[168:171]
    v_rcp_f32 v136, v136
    v_cvt_pk_bf16_f32 v133, v134, v135
    v_mfma_f32_16x16x32_bf16 v[148:151], v[104:107], v[184:187], v[148:151]
    v_rcp_f32 v137, v137
    v_mfma_f32_16x16x32_bf16 v[152:155], v[112:115], v[184:187], v[152:155]
    v_rcp_f32 v138, v138
    v_cvt_pk_bf16_f32 v134, v136, v137
    v_mfma_f32_16x16x32_bf16 v[156:159], v[116:119], v[180:183], v[172:175]
    v_rcp_f32 v139, v139
    v_mfma_f32_16x16x32_bf16 v[160:163], v[124:127], v[180:183], v[176:179]
    v_rcp_f32 v140, v140
    v_cvt_pk_bf16_f32 v135, v138, v139
    v_mfma_f32_16x16x32_bf16 v[156:159], v[120:123], v[184:187], v[156:159]
    v_rcp_f32 v141, v141
    v_mfma_f32_16x16x32_bf16 v[160:163], v[128:131], v[184:187], v[160:163]
    v_rcp_f32 v142, v142
    v_cvt_pk_bf16_f32 v136, v140, v141
    v_mfma_f32_16x16x32_bf16 v[208:211], v[132:135], v[196:199], v[204:207]
    v_rcp_f32 v143, v143
    v_rcp_f32 v144, v144
    v_cvt_pk_bf16_f32 v137, v142, v143
    v_rcp_f32 v145, v145
    v_rcp_f32 v146, v146
    v_rcp_f32 v147, v147
    v_cvt_pk_bf16_f32 v138, v144, v145
    v_cvt_pk_bf16_f32 v139, v146, v147
    s_bitcmp1_b32 s36, 3
    s_cbranch_scc1 Ls_ev3
Ls_evd3:
    v_mfma_f32_16x16x32_bf16 v[208:211], v[136:139], v[200:203], v[208:211]
    ds_read_b32 v246, v244 offset:48
    s_waitcnt lgkmcnt(0)
    v_bfe_u32 v247, v246, 0, 8
    v_lshlrev_b32 v247, 1, v247
    v_bfe_u32 v248, v246, 8, 8
    v_lshlrev_b32 v248, 1, v248
    v_bfe_u32 v249, v246, 16, 8
    v_lshlrev_b32 v249, 1, v249
    v_bfe_u32 v250, v246, 24, 8
    v_lshlrev_b32 v250, 1, v250
    buffer_load_ushort v247, v247, s[24:27], 0 offen
    buffer_load_ushort v248, v248, s[24:27], 0 offen
    buffer_load_ushort v249, v249, s[24:27], 0 offen
    buffer_load_ushort v250, v250, s[24:27], 0 offen
    s_waitcnt vmcnt(0)
    v_lshlrev_b32 v247, 16, v247
    v_mul_f32 v208, v208, v247
    v_lshlrev_b32 v248, 16, v248
    v_mul_f32 v209, v209, v248
    v_lshlrev_b32 v249, 16, v249
    v_mul_f32 v210, v210, v249
    v_lshlrev_b32 v250, 16, v250
    v_mul_f32 v211, v211, v250
    v_exp_f32 v132, v148
    v_exp_f32 v133, v149
    v_exp_f32 v134, v150
    v_exp_f32 v135, v151
    v_exp_f32 v136, v152
    v_exp_f32 v137, v153
    v_mfma_f32_4x4x4_16b_bf16 v[132:135], v[228:229], v[228:229], v[132:135]
    v_exp_f32 v138, v154
    v_exp_f32 v139, v155
    v_cvt_pk_bf16_f32 v208, v208, v209
    v_cvt_pk_bf16_f32 v209, v210, v211
    v_exp_f32 v140, v156
    v_exp_f32 v141, v157
    v_mfma_f32_4x4x4_16b_bf16 v[212:215], v[208:209], v[188:189], v[212:215] cbsz:4 abid:0
    v_mfma_f32_4x4x4_16b_bf16 v[136:139], v[228:229], v[228:229], v[136:139]
    v_exp_f32 v142, v158
    v_mfma_f32_4x4x4_16b_bf16 v[212:215], v[208:209], v[190:191], v[212:215] cbsz:4 abid:4
    v_exp_f32 v143, v159
    v_exp_f32 v144, v160
    v_mfma_f32_4x4x4_16b_bf16 v[212:215], v[208:209], v[192:193], v[212:215] cbsz:4 abid:8
    v_exp_f32 v145, v161
    v_mfma_f32_4x4x4_16b_bf16 v[140:143], v[228:229], v[228:229], v[140:143]
    v_mfma_f32_4x4x4_16b_bf16 v[212:215], v[208:209], v[194:195], v[212:215] cbsz:4 abid:12
    ds_read_u8 v230, v237 offset:112
    ds_read_u8 v232, v237 offset:120
    ds_read_b64_tr_b16 v[188:189], v236 offset:6240
    ds_read_b64_tr_b16 v[190:191], v236 offset:6752
    ds_read_b64_tr_b16 v[192:193], v236 offset:7296
    ds_read_b64_tr_b16 v[194:195], v236 offset:7808
    s_waitcnt vmcnt(4)
    ds_read_b128 v[180:183], v234 offset:0
    ds_read_b128 v[184:187], v235 offset:0
    s_add_u32 m0, s52, 6240
    v_exp_f32 v146, v162
    v_exp_f32 v147, v163
    v_rcp_f32 v132, v132
    v_rcp_f32 v133, v133
    v_mfma_f32_4x4x4_16b_bf16 v[144:147], v[228:229], v[228:229], v[144:147]
    v_rcp_f32 v134, v134
    v_cvt_pk_bf16_f32 v132, v132, v133
    s_waitcnt lgkmcnt(2)
    buffer_load_dwordx4 v[230:231], s[20:23], s35 idxen offen nt lds
    buffer_load_dwordx4 v[232:233], s[40:43], s35 idxen offen offset:1056 nt lds
    s_waitcnt lgkmcnt(0)
    v_mfma_f32_16x16x32_bf16 v[148:151], v[100:103], v[180:183], v[164:167]
    v_rcp_f32 v135, v135
    v_mfma_f32_16x16x32_bf16 v[152:155], v[108:111], v[180:183], v[168:171]
    v_rcp_f32 v136, v136
    v_cvt_pk_bf16_f32 v133, v134, v135
    v_mfma_f32_16x16x32_bf16 v[148:151], v[104:107], v[184:187], v[148:151]
    v_rcp_f32 v137, v137
    v_mfma_f32_16x16x32_bf16 v[152:155], v[112:115], v[184:187], v[152:155]
    v_rcp_f32 v138, v138
    v_cvt_pk_bf16_f32 v134, v136, v137
    v_mfma_f32_16x16x32_bf16 v[156:159], v[116:119], v[180:183], v[172:175]
    v_rcp_f32 v139, v139
    v_mfma_f32_16x16x32_bf16 v[160:163], v[124:127], v[180:183], v[176:179]
    v_rcp_f32 v140, v140
    v_cvt_pk_bf16_f32 v135, v138, v139
    v_mfma_f32_16x16x32_bf16 v[156:159], v[120:123], v[184:187], v[156:159]
    v_rcp_f32 v141, v141
    v_mfma_f32_16x16x32_bf16 v[160:163], v[128:131], v[184:187], v[160:163]
    v_rcp_f32 v142, v142
    v_cvt_pk_bf16_f32 v136, v140, v141
    v_mfma_f32_16x16x32_bf16 v[208:211], v[132:135], v[196:199], v[204:207]
    v_rcp_f32 v143, v143
    v_rcp_f32 v144, v144
    v_cvt_pk_bf16_f32 v137, v142, v143
    s_lshr_b64 s[56:57], s[56:57], 4
    s_lshl_b64 s[86:87], s[58:59], 60
    s_or_b64 s[56:57], s[56:57], s[86:87]
    s_lshr_b64 s[58:59], s[58:59], 4
    s_lshr_b64 s[86:87], s[56:57], 2
    s_lshr_b64 s[36:37], s[56:57], 5
    s_or_b32 s36, s36, s86
    s_or_b32 s36, s36, s56
    v_add_u32 v237, 64, v237
    v_add_u32 v244, 64, v244
    v_rcp_f32 v145, v145
    v_rcp_f32 v146, v146
    v_rcp_f32 v147, v147
    v_cvt_pk_bf16_f32 v138, v144, v145
    v_cvt_pk_bf16_f32 v139, v146, v147
    s_branch Ls_loop
Ls_ev0:
    s_bitcmp0_b64 s[56:57], 0
    s_cbranch_scc1 Ls_nf0
    v_cvt_pk_bf16_f32 v246, v212, v212
    v_mov_b32 v212, 0
    ds_write_b16 v240, v246
    v_add_u32 v240, 128, v240
    s_add_u32 s24, s24, s32
    s_addc_u32 s25, s25, 0
    s_xor_b32 s32, s32, 0x18ffe0
Ls_nf0:
    s_bitcmp0_b64 s[56:57], 5
    s_cbranch_scc1 Ls_na0
    s_sub_u32 s60, s60, 1
    s_cbranch_scc0 Ls_ns0
    s_mov_b32 s49, 5
    s_call_b64 s[62:63], L_swap
    s_add_u32 s35, s35, s31
    s_min_u32 s35, s35, 419404800
    s_xor_b32 s31, s31, 0x63ff800
    s_bitcmp0_b64 s[56:57], 2
    s_cbranch_scc1 Ls_evd0
    s_waitcnt lgkmcnt(0)
    s_branch Ls_e10
Ls_ns0:
    s_add_u32 s35, s35, s31
    s_min_u32 s35, s35, 419404800
    s_xor_b32 s31, s31, 0x63ff800
Ls_na0:
    s_bitcmp0_b64 s[56:57], 2
    s_cbranch_scc1 Ls_evd0
Ls_e10:
    s_sub_u32 s61, s61, 1
    s_cbranch_scc1 Ls_last0
    s_bitcmp0_b32 s33, s61
    s_cbranch_scc1 Ls_nw0
    s_cmp_eq_u32 s61, 3
    s_cselect_b32 s66, s80, s81
    v_add_u32 v238, s66, v238
    v_add_u32 v239, s66, v239
    ds_read_u16 v224, v238 offset:0
    ds_read_u16 v225, v238 offset:8
    ds_read_u16 v226, v238 offset:64
    ds_read_u16 v227, v238 offset:72
    s_waitcnt lgkmcnt(0)
Ls_nw0:
    v_mul_u32_u24 v216, v224, v241
    v_mul_u32_u24 v217, v224, v242
    v_mul_u32_u24 v218, v225, v241
    v_mul_u32_u24 v219, v225, v242
    v_mul_u32_u24 v220, v226, v241
    v_mul_u32_u24 v221, v226, v242
    v_mul_u32_u24 v222, v227, v241
    v_mul_u32_u24 v223, v227, v242
    v_mfma_f32_4x4x4_16b_bf16 v[140:143], v[216:217], v[68:69], v[4:7]
    v_add_u32 v238, 128, v238
    ds_read_b128 v[164:167], v239 offset:0
    ds_read_b128 v[168:171], v239 offset:64
    v_mfma_f32_4x4x4_16b_bf16 v[144:147], v[218:219], v[70:71], v[8:11]
    ds_read_b128 v[172:175], v239 offset:128
    ds_read_b128 v[176:179], v239 offset:192
    ds_read_u16 v224, v238 offset:0
    ds_read_u16 v225, v238 offset:8
    ds_read_u16 v226, v238 offset:64
    ds_read_u16 v227, v238 offset:72
    v_mfma_f32_4x4x4_16b_bf16 v[246:249], v[220:221], v[72:73], v[12:15]
    v_cvt_pk_bf16_f32 v100, v140, v141
    v_cvt_pk_bf16_f32 v101, v142, v143
    v_mfma_f32_4x4x4_16b_bf16 v[250:253], v[222:223], v[74:75], v[16:19]
    v_cvt_pk_bf16_f32 v102, v144, v145
    v_cvt_pk_bf16_f32 v103, v146, v147
    v_mfma_f32_4x4x4_16b_bf16 v[140:143], v[216:217], v[76:77], v[20:23]
    v_cvt_pk_bf16_f32 v104, v246, v247
    v_cvt_pk_bf16_f32 v105, v248, v249
    v_mfma_f32_4x4x4_16b_bf16 v[144:147], v[218:219], v[78:79], v[24:27]
    v_cvt_pk_bf16_f32 v106, v250, v251
    v_cvt_pk_bf16_f32 v107, v252, v253
    v_mfma_f32_4x4x4_16b_bf16 v[246:249], v[220:221], v[80:81], v[28:31]
    v_cvt_pk_bf16_f32 v108, v140, v141
    v_cvt_pk_bf16_f32 v109, v142, v143
    v_mfma_f32_4x4x4_16b_bf16 v[250:253], v[222:223], v[82:83], v[32:35]
    v_cvt_pk_bf16_f32 v110, v144, v145
    v_cvt_pk_bf16_f32 v111, v146, v147
    v_mfma_f32_4x4x4_16b_bf16 v[140:143], v[216:217], v[84:85], v[36:39]
    v_cvt_pk_bf16_f32 v112, v246, v247
    v_cvt_pk_bf16_f32 v113, v248, v249
    v_mfma_f32_4x4x4_16b_bf16 v[144:147], v[218:219], v[86:87], v[40:43]
    v_cvt_pk_bf16_f32 v114, v250, v251
    v_cvt_pk_bf16_f32 v115, v252, v253
    v_mfma_f32_4x4x4_16b_bf16 v[246:249], v[220:221], v[88:89], v[44:47]
    v_cvt_pk_bf16_f32 v116, v140, v141
    v_cvt_pk_bf16_f32 v117, v142, v143
    v_mfma_f32_4x4x4_16b_bf16 v[250:253], v[222:223], v[90:91], v[48:51]
    v_cvt_pk_bf16_f32 v118, v144, v145
    v_cvt_pk_bf16_f32 v119, v146, v147
    v_mfma_f32_4x4x4_16b_bf16 v[140:143], v[216:217], v[92:93], v[52:55]
    v_cvt_pk_bf16_f32 v120, v246, v247
    v_cvt_pk_bf16_f32 v121, v248, v249
    v_mfma_f32_4x4x4_16b_bf16 v[144:147], v[218:219], v[94:95], v[56:59]
    v_cvt_pk_bf16_f32 v122, v250, v251
    v_cvt_pk_bf16_f32 v123, v252, v253
    v_mfma_f32_4x4x4_16b_bf16 v[246:249], v[220:221], v[96:97], v[60:63]
    v_cvt_pk_bf16_f32 v124, v140, v141
    v_cvt_pk_bf16_f32 v125, v142, v143
    v_mfma_f32_4x4x4_16b_bf16 v[250:253], v[222:223], v[98:99], v[64:67]
    v_cvt_pk_bf16_f32 v126, v144, v145
    v_cvt_pk_bf16_f32 v127, v146, v147
    v_cvt_pk_bf16_f32 v128, v246, v247
    v_cvt_pk_bf16_f32 v129, v248, v249
    v_add_u32 v239, 272, v239
    v_cvt_pk_bf16_f32 v130, v250, v251
    v_cvt_pk_bf16_f32 v131, v252, v253
    s_waitcnt lgkmcnt(0)
    s_branch Ls_evd0
Ls_ev1:
    s_bitcmp0_b64 s[56:57], 1
    s_cbranch_scc1 Ls_nf1
    v_cvt_pk_bf16_f32 v246, v212, v212
    v_mov_b32 v212, 0
    ds_write_b16 v240, v246
    v_add_u32 v240, 128, v240
    s_add_u32 s24, s24, s32
    s_addc_u32 s25, s25, 0
    s_xor_b32 s32, s32, 0x18ffe0
Ls_nf1:
    s_bitcmp0_b64 s[56:57], 6
    s_cbranch_scc1 Ls_na1
    s_sub_u32 s60, s60, 1
    s_cbranch_scc0 Ls_ns1
    s_mov_b32 s49, 6
    s_call_b64 s[62:63], L_swap
    s_add_u32 s35, s35, s31
    s_min_u32 s35, s35, 419404800
    s_xor_b32 s31, s31, 0x63ff800
    s_bitcmp0_b64 s[56:57], 3
    s_cbranch_scc1 Ls_evd1
    s_waitcnt lgkmcnt(0)
    s_branch Ls_e11
Ls_ns1:
    s_add_u32 s35, s35, s31
    s_min_u32 s35, s35, 419404800
    s_xor_b32 s31, s31, 0x63ff800
Ls_na1:
    s_bitcmp0_b64 s[56:57], 3
    s_cbranch_scc1 Ls_evd1
Ls_e11:
    s_sub_u32 s61, s61, 1
    s_cbranch_scc1 Ls_last1
    s_bitcmp0_b32 s33, s61
    s_cbranch_scc1 Ls_nw1
    s_cmp_eq_u32 s61, 3
    s_cselect_b32 s66, s80, s81
    v_add_u32 v238, s66, v238
    v_add_u32 v239, s66, v239
    ds_read_u16 v224, v238 offset:0
    ds_read_u16 v225, v238 offset:8
    ds_read_u16 v226, v238 offset:64
    ds_read_u16 v227, v238 offset:72
    s_waitcnt lgkmcnt(0)
Ls_nw1:
    v_mul_u32_u24 v216, v224, v241
    v_mul_u32_u24 v217, v224, v242
    v_mul_u32_u24 v218, v225, v241
    v_mul_u32_u24 v219, v225, v242
    v_mul_u32_u24 v220, v226, v241
    v_mul_u32_u24 v221, v226, v242
    v_mul_u32_u24 v222, v227, v241
    v_mul_u32_u24 v223, v227, v242
    v_mfma_f32_4x4x4_16b_bf16 v[140:143], v[216:217], v[68:69], v[4:7]
    v_add_u32 v238, 128, v238
    ds_read_b128 v[164:167], v239 offset:0
    ds_read_b128 v[168:171], v239 offset:64
    v_mfma_f32_4x4x4_16b_bf16 v[144:147], v[218:219], v[70:71], v[8:11]
    ds_read_b128 v[172:175], v239 offset:128
    ds_read_b128 v[176:179], v239 offset:192
    ds_read_u16 v224, v238 offset:0
    ds_read_u16 v225, v238 offset:8
    ds_read_u16 v226, v238 offset:64
    ds_read_u16 v227, v238 offset:72
    v_mfma_f32_4x4x4_16b_bf16 v[246:249], v[220:221], v[72:73], v[12:15]
    v_cvt_pk_bf16_f32 v100, v140, v141
    v_cvt_pk_bf16_f32 v101, v142, v143
    v_mfma_f32_4x4x4_16b_bf16 v[250:253], v[222:223], v[74:75], v[16:19]
    v_cvt_pk_bf16_f32 v102, v144, v145
    v_cvt_pk_bf16_f32 v103, v146, v147
    v_mfma_f32_4x4x4_16b_bf16 v[140:143], v[216:217], v[76:77], v[20:23]
    v_cvt_pk_bf16_f32 v104, v246, v247
    v_cvt_pk_bf16_f32 v105, v248, v249
    v_mfma_f32_4x4x4_16b_bf16 v[144:147], v[218:219], v[78:79], v[24:27]
    v_cvt_pk_bf16_f32 v106, v250, v251
    v_cvt_pk_bf16_f32 v107, v252, v253
    v_mfma_f32_4x4x4_16b_bf16 v[246:249], v[220:221], v[80:81], v[28:31]
    v_cvt_pk_bf16_f32 v108, v140, v141
    v_cvt_pk_bf16_f32 v109, v142, v143
    v_mfma_f32_4x4x4_16b_bf16 v[250:253], v[222:223], v[82:83], v[32:35]
    v_cvt_pk_bf16_f32 v110, v144, v145
    v_cvt_pk_bf16_f32 v111, v146, v147
    v_mfma_f32_4x4x4_16b_bf16 v[140:143], v[216:217], v[84:85], v[36:39]
    v_cvt_pk_bf16_f32 v112, v246, v247
    v_cvt_pk_bf16_f32 v113, v248, v249
    v_mfma_f32_4x4x4_16b_bf16 v[144:147], v[218:219], v[86:87], v[40:43]
    v_cvt_pk_bf16_f32 v114, v250, v251
    v_cvt_pk_bf16_f32 v115, v252, v253
    v_mfma_f32_4x4x4_16b_bf16 v[246:249], v[220:221], v[88:89], v[44:47]
    v_cvt_pk_bf16_f32 v116, v140, v141
    v_cvt_pk_bf16_f32 v117, v142, v143
    v_mfma_f32_4x4x4_16b_bf16 v[250:253], v[222:223], v[90:91], v[48:51]
    v_cvt_pk_bf16_f32 v118, v144, v145
    v_cvt_pk_bf16_f32 v119, v146, v147
    v_mfma_f32_4x4x4_16b_bf16 v[140:143], v[216:217], v[92:93], v[52:55]
    v_cvt_pk_bf16_f32 v120, v246, v247
    v_cvt_pk_bf16_f32 v121, v248, v249
    v_mfma_f32_4x4x4_16b_bf16 v[144:147], v[218:219], v[94:95], v[56:59]
    v_cvt_pk_bf16_f32 v122, v250, v251
    v_cvt_pk_bf16_f32 v123, v252, v253
    v_mfma_f32_4x4x4_16b_bf16 v[246:249], v[220:221], v[96:97], v[60:63]
    v_cvt_pk_bf16_f32 v124, v140, v141
    v_cvt_pk_bf16_f32 v125, v142, v143
    v_mfma_f32_4x4x4_16b_bf16 v[250:253], v[222:223], v[98:99], v[64:67]
    v_cvt_pk_bf16_f32 v126, v144, v145
    v_cvt_pk_bf16_f32 v127, v146, v147
    v_cvt_pk_bf16_f32 v128, v246, v247
    v_cvt_pk_bf16_f32 v129, v248, v249
    v_add_u32 v239, 272, v239
    v_cvt_pk_bf16_f32 v130, v250, v251
    v_cvt_pk_bf16_f32 v131, v252, v253
    s_waitcnt lgkmcnt(0)
    s_branch Ls_evd1
Ls_ev2:
    s_bitcmp0_b64 s[56:57], 2
    s_cbranch_scc1 Ls_nf2
    v_cvt_pk_bf16_f32 v246, v212, v212
    v_mov_b32 v212, 0
    ds_write_b16 v240, v246
    v_add_u32 v240, 128, v240
    s_add_u32 s24, s24, s32
    s_addc_u32 s25, s25, 0
    s_xor_b32 s32, s32, 0x18ffe0
Ls_nf2:
    s_bitcmp0_b64 s[56:57], 7
    s_cbranch_scc1 Ls_na2
    s_sub_u32 s60, s60, 1
    s_cbranch_scc0 Ls_ns2
    s_mov_b32 s49, 7
    s_call_b64 s[62:63], L_swap
    s_add_u32 s35, s35, s31
    s_min_u32 s35, s35, 419404800
    s_xor_b32 s31, s31, 0x63ff800
    s_bitcmp0_b64 s[56:57], 4
    s_cbranch_scc1 Ls_evd2
    s_waitcnt lgkmcnt(0)
    s_branch Ls_e12
Ls_ns2:
    s_add_u32 s35, s35, s31
    s_min_u32 s35, s35, 419404800
    s_xor_b32 s31, s31, 0x63ff800
Ls_na2:
    s_bitcmp0_b64 s[56:57], 4
    s_cbranch_scc1 Ls_evd2
Ls_e12:
    s_sub_u32 s61, s61, 1
    s_cbranch_scc1 Ls_last2
    s_bitcmp0_b32 s33, s61
    s_cbranch_scc1 Ls_nw2
    s_cmp_eq_u32 s61, 3
    s_cselect_b32 s66, s80, s81
    v_add_u32 v238, s66, v238
    v_add_u32 v239, s66, v239
    ds_read_u16 v224, v238 offset:0
    ds_read_u16 v225, v238 offset:8
    ds_read_u16 v226, v238 offset:64
    ds_read_u16 v227, v238 offset:72
    s_waitcnt lgkmcnt(0)
Ls_nw2:
    v_mul_u32_u24 v216, v224, v241
    v_mul_u32_u24 v217, v224, v242
    v_mul_u32_u24 v218, v225, v241
    v_mul_u32_u24 v219, v225, v242
    v_mul_u32_u24 v220, v226, v241
    v_mul_u32_u24 v221, v226, v242
    v_mul_u32_u24 v222, v227, v241
    v_mul_u32_u24 v223, v227, v242
    v_mfma_f32_4x4x4_16b_bf16 v[140:143], v[216:217], v[68:69], v[4:7]
    v_add_u32 v238, 128, v238
    ds_read_b128 v[164:167], v239 offset:0
    ds_read_b128 v[168:171], v239 offset:64
    v_mfma_f32_4x4x4_16b_bf16 v[144:147], v[218:219], v[70:71], v[8:11]
    ds_read_b128 v[172:175], v239 offset:128
    ds_read_b128 v[176:179], v239 offset:192
    ds_read_u16 v224, v238 offset:0
    ds_read_u16 v225, v238 offset:8
    ds_read_u16 v226, v238 offset:64
    ds_read_u16 v227, v238 offset:72
    v_mfma_f32_4x4x4_16b_bf16 v[246:249], v[220:221], v[72:73], v[12:15]
    v_cvt_pk_bf16_f32 v100, v140, v141
    v_cvt_pk_bf16_f32 v101, v142, v143
    v_mfma_f32_4x4x4_16b_bf16 v[250:253], v[222:223], v[74:75], v[16:19]
    v_cvt_pk_bf16_f32 v102, v144, v145
    v_cvt_pk_bf16_f32 v103, v146, v147
    v_mfma_f32_4x4x4_16b_bf16 v[140:143], v[216:217], v[76:77], v[20:23]
    v_cvt_pk_bf16_f32 v104, v246, v247
    v_cvt_pk_bf16_f32 v105, v248, v249
    v_mfma_f32_4x4x4_16b_bf16 v[144:147], v[218:219], v[78:79], v[24:27]
    v_cvt_pk_bf16_f32 v106, v250, v251
    v_cvt_pk_bf16_f32 v107, v252, v253
    v_mfma_f32_4x4x4_16b_bf16 v[246:249], v[220:221], v[80:81], v[28:31]
    v_cvt_pk_bf16_f32 v108, v140, v141
    v_cvt_pk_bf16_f32 v109, v142, v143
    v_mfma_f32_4x4x4_16b_bf16 v[250:253], v[222:223], v[82:83], v[32:35]
    v_cvt_pk_bf16_f32 v110, v144, v145
    v_cvt_pk_bf16_f32 v111, v146, v147
    v_mfma_f32_4x4x4_16b_bf16 v[140:143], v[216:217], v[84:85], v[36:39]
    v_cvt_pk_bf16_f32 v112, v246, v247
    v_cvt_pk_bf16_f32 v113, v248, v249
    v_mfma_f32_4x4x4_16b_bf16 v[144:147], v[218:219], v[86:87], v[40:43]
    v_cvt_pk_bf16_f32 v114, v250, v251
    v_cvt_pk_bf16_f32 v115, v252, v253
    v_mfma_f32_4x4x4_16b_bf16 v[246:249], v[220:221], v[88:89], v[44:47]
    v_cvt_pk_bf16_f32 v116, v140, v141
    v_cvt_pk_bf16_f32 v117, v142, v143
    v_mfma_f32_4x4x4_16b_bf16 v[250:253], v[222:223], v[90:91], v[48:51]
    v_cvt_pk_bf16_f32 v118, v144, v145
    v_cvt_pk_bf16_f32 v119, v146, v147
    v_mfma_f32_4x4x4_16b_bf16 v[140:143], v[216:217], v[92:93], v[52:55]
    v_cvt_pk_bf16_f32 v120, v246, v247
    v_cvt_pk_bf16_f32 v121, v248, v249
    v_mfma_f32_4x4x4_16b_bf16 v[144:147], v[218:219], v[94:95], v[56:59]
    v_cvt_pk_bf16_f32 v122, v250, v251
    v_cvt_pk_bf16_f32 v123, v252, v253
    v_mfma_f32_4x4x4_16b_bf16 v[246:249], v[220:221], v[96:97], v[60:63]
    v_cvt_pk_bf16_f32 v124, v140, v141
    v_cvt_pk_bf16_f32 v125, v142, v143
    v_mfma_f32_4x4x4_16b_bf16 v[250:253], v[222:223], v[98:99], v[64:67]
    v_cvt_pk_bf16_f32 v126, v144, v145
    v_cvt_pk_bf16_f32 v127, v146, v147
    v_cvt_pk_bf16_f32 v128, v246, v247
    v_cvt_pk_bf16_f32 v129, v248, v249
    v_add_u32 v239, 272, v239
    v_cvt_pk_bf16_f32 v130, v250, v251
    v_cvt_pk_bf16_f32 v131, v252, v253
    s_waitcnt lgkmcnt(0)
    s_branch Ls_evd2
Ls_ev3:
    s_bitcmp0_b64 s[56:57], 3
    s_cbranch_scc1 Ls_nf3
    v_cvt_pk_bf16_f32 v246, v212, v212
    v_mov_b32 v212, 0
    ds_write_b16 v240, v246
    v_add_u32 v240, 128, v240
    s_add_u32 s24, s24, s32
    s_addc_u32 s25, s25, 0
    s_xor_b32 s32, s32, 0x18ffe0
Ls_nf3:
    s_bitcmp0_b64 s[56:57], 8
    s_cbranch_scc1 Ls_na3
    s_sub_u32 s60, s60, 1
    s_cbranch_scc0 Ls_ns3
    s_mov_b32 s49, 8
    s_call_b64 s[62:63], L_swap
    s_add_u32 s35, s35, s31
    s_min_u32 s35, s35, 419404800
    s_xor_b32 s31, s31, 0x63ff800
    s_bitcmp0_b64 s[56:57], 5
    s_cbranch_scc1 Ls_evd3
    s_waitcnt lgkmcnt(0)
    s_branch Ls_e13
Ls_ns3:
    s_add_u32 s35, s35, s31
    s_min_u32 s35, s35, 419404800
    s_xor_b32 s31, s31, 0x63ff800
Ls_na3:
    s_bitcmp0_b64 s[56:57], 5
    s_cbranch_scc1 Ls_evd3
Ls_e13:
    s_sub_u32 s61, s61, 1
    s_cbranch_scc1 Ls_last3
    s_bitcmp0_b32 s33, s61
    s_cbranch_scc1 Ls_nw3
    s_cmp_eq_u32 s61, 3
    s_cselect_b32 s66, s80, s81
    v_add_u32 v238, s66, v238
    v_add_u32 v239, s66, v239
    ds_read_u16 v224, v238 offset:0
    ds_read_u16 v225, v238 offset:8
    ds_read_u16 v226, v238 offset:64
    ds_read_u16 v227, v238 offset:72
    s_waitcnt lgkmcnt(0)
Ls_nw3:
    v_mul_u32_u24 v216, v224, v241
    v_mul_u32_u24 v217, v224, v242
    v_mul_u32_u24 v218, v225, v241
    v_mul_u32_u24 v219, v225, v242
    v_mul_u32_u24 v220, v226, v241
    v_mul_u32_u24 v221, v226, v242
    v_mul_u32_u24 v222, v227, v241
    v_mul_u32_u24 v223, v227, v242
    v_mfma_f32_4x4x4_16b_bf16 v[140:143], v[216:217], v[68:69], v[4:7]
    v_add_u32 v238, 128, v238
    ds_read_b128 v[164:167], v239 offset:0
    ds_read_b128 v[168:171], v239 offset:64
    v_mfma_f32_4x4x4_16b_bf16 v[144:147], v[218:219], v[70:71], v[8:11]
    ds_read_b128 v[172:175], v239 offset:128
    ds_read_b128 v[176:179], v239 offset:192
    ds_read_u16 v224, v238 offset:0
    ds_read_u16 v225, v238 offset:8
    ds_read_u16 v226, v238 offset:64
    ds_read_u16 v227, v238 offset:72
    v_mfma_f32_4x4x4_16b_bf16 v[246:249], v[220:221], v[72:73], v[12:15]
    v_cvt_pk_bf16_f32 v100, v140, v141
    v_cvt_pk_bf16_f32 v101, v142, v143
    v_mfma_f32_4x4x4_16b_bf16 v[250:253], v[222:223], v[74:75], v[16:19]
    v_cvt_pk_bf16_f32 v102, v144, v145
    v_cvt_pk_bf16_f32 v103, v146, v147
    v_mfma_f32_4x4x4_16b_bf16 v[140:143], v[216:217], v[76:77], v[20:23]
    v_cvt_pk_bf16_f32 v104, v246, v247
    v_cvt_pk_bf16_f32 v105, v248, v249
    v_mfma_f32_4x4x4_16b_bf16 v[144:147], v[218:219], v[78:79], v[24:27]
    v_cvt_pk_bf16_f32 v106, v250, v251
    v_cvt_pk_bf16_f32 v107, v252, v253
    v_mfma_f32_4x4x4_16b_bf16 v[246:249], v[220:221], v[80:81], v[28:31]
    v_cvt_pk_bf16_f32 v108, v140, v141
    v_cvt_pk_bf16_f32 v109, v142, v143
    v_mfma_f32_4x4x4_16b_bf16 v[250:253], v[222:223], v[82:83], v[32:35]
    v_cvt_pk_bf16_f32 v110, v144, v145
    v_cvt_pk_bf16_f32 v111, v146, v147
    v_mfma_f32_4x4x4_16b_bf16 v[140:143], v[216:217], v[84:85], v[36:39]
    v_cvt_pk_bf16_f32 v112, v246, v247
    v_cvt_pk_bf16_f32 v113, v248, v249
    v_mfma_f32_4x4x4_16b_bf16 v[144:147], v[218:219], v[86:87], v[40:43]
    v_cvt_pk_bf16_f32 v114, v250, v251
    v_cvt_pk_bf16_f32 v115, v252, v253
    v_mfma_f32_4x4x4_16b_bf16 v[246:249], v[220:221], v[88:89], v[44:47]
    v_cvt_pk_bf16_f32 v116, v140, v141
    v_cvt_pk_bf16_f32 v117, v142, v143
    v_mfma_f32_4x4x4_16b_bf16 v[250:253], v[222:223], v[90:91], v[48:51]
    v_cvt_pk_bf16_f32 v118, v144, v145
    v_cvt_pk_bf16_f32 v119, v146, v147
    v_mfma_f32_4x4x4_16b_bf16 v[140:143], v[216:217], v[92:93], v[52:55]
    v_cvt_pk_bf16_f32 v120, v246, v247
    v_cvt_pk_bf16_f32 v121, v248, v249
    v_mfma_f32_4x4x4_16b_bf16 v[144:147], v[218:219], v[94:95], v[56:59]
    v_cvt_pk_bf16_f32 v122, v250, v251
    v_cvt_pk_bf16_f32 v123, v252, v253
    v_mfma_f32_4x4x4_16b_bf16 v[246:249], v[220:221], v[96:97], v[60:63]
    v_cvt_pk_bf16_f32 v124, v140, v141
    v_cvt_pk_bf16_f32 v125, v142, v143
    v_mfma_f32_4x4x4_16b_bf16 v[250:253], v[222:223], v[98:99], v[64:67]
    v_cvt_pk_bf16_f32 v126, v144, v145
    v_cvt_pk_bf16_f32 v127, v146, v147
    v_cvt_pk_bf16_f32 v128, v246, v247
    v_cvt_pk_bf16_f32 v129, v248, v249
    v_add_u32 v239, 272, v239
    v_cvt_pk_bf16_f32 v130, v250, v251
    v_cvt_pk_bf16_f32 v131, v252, v253
    s_waitcnt lgkmcnt(0)
    s_branch Ls_evd3
Ls_last0:
    s_branch Ls_tail
Ls_last1:
    v_add_u32 v236, 2080, v236
    s_lshr_b64 s[56:57], s[56:57], 1
    v_add_u32 v244, 16, v244
    s_branch Ls_tail
Ls_last2:
    v_add_u32 v236, 4160, v236
    s_lshr_b64 s[56:57], s[56:57], 2
    v_add_u32 v244, 32, v244
    s_branch Ls_tail
Ls_last3:
    v_add_u32 v236, 6240, v236
    s_lshr_b64 s[56:57], s[56:57], 3
    v_add_u32 v244, 48, v244
Ls_tail:
    v_mfma_f32_16x16x32_bf16 v[208:211], v[136:139], v[200:203], v[208:211]
    ds_read_b32 v246, v244 offset:0
    s_waitcnt lgkmcnt(0)
    v_bfe_u32 v247, v246, 0, 8
    v_lshlrev_b32 v247, 1, v247
    v_bfe_u32 v248, v246, 8, 8
    v_lshlrev_b32 v248, 1, v248
    v_bfe_u32 v249, v246, 16, 8
    v_lshlrev_b32 v249, 1, v249
    v_bfe_u32 v250, v246, 24, 8
    v_lshlrev_b32 v250, 1, v250
    buffer_load_ushort v247, v247, s[24:27], 0 offen
    buffer_load_ushort v248, v248, s[24:27], 0 offen
    buffer_load_ushort v249, v249, s[24:27], 0 offen
    buffer_load_ushort v250, v250, s[24:27], 0 offen
    s_waitcnt vmcnt(0)
    v_lshlrev_b32 v247, 16, v247
    v_mul_f32 v208, v208, v247
    v_lshlrev_b32 v248, 16, v248
    v_mul_f32 v209, v209, v248
    v_lshlrev_b32 v249, 16, v249
    v_mul_f32 v210, v210, v249
    v_lshlrev_b32 v250, 16, v250
    v_mul_f32 v211, v211, v250
    v_exp_f32 v132, v148
    v_exp_f32 v133, v149
    v_exp_f32 v134, v150
    v_exp_f32 v135, v151
    v_exp_f32 v136, v152
    v_exp_f32 v137, v153
    v_mfma_f32_4x4x4_16b_bf16 v[132:135], v[228:229], v[228:229], v[132:135]
    v_exp_f32 v138, v154
    v_exp_f32 v139, v155
    v_cvt_pk_bf16_f32 v208, v208, v209
    v_cvt_pk_bf16_f32 v209, v210, v211
    v_exp_f32 v140, v156
    v_exp_f32 v141, v157
    v_mfma_f32_4x4x4_16b_bf16 v[212:215], v[208:209], v[188:189], v[212:215] cbsz:4 abid:0
    v_mfma_f32_4x4x4_16b_bf16 v[136:139], v[228:229], v[228:229], v[136:139]
    v_exp_f32 v142, v158
    v_mfma_f32_4x4x4_16b_bf16 v[212:215], v[208:209], v[190:191], v[212:215] cbsz:4 abid:4
    v_exp_f32 v143, v159
    v_exp_f32 v144, v160
    v_mfma_f32_4x4x4_16b_bf16 v[212:215], v[208:209], v[192:193], v[212:215] cbsz:4 abid:8
    v_exp_f32 v145, v161
    v_mfma_f32_4x4x4_16b_bf16 v[140:143], v[228:229], v[228:229], v[140:143]
    v_mfma_f32_4x4x4_16b_bf16 v[212:215], v[208:209], v[194:195], v[212:215] cbsz:4 abid:12
    ds_read_b64_tr_b16 v[188:189], v236 offset:0
    ds_read_b64_tr_b16 v[190:191], v236 offset:512
    ds_read_b64_tr_b16 v[192:193], v236 offset:1056
    ds_read_b64_tr_b16 v[194:195], v236 offset:1568
    v_exp_f32 v146, v162
    v_exp_f32 v147, v163
    v_rcp_f32 v132, v132
    v_rcp_f32 v133, v133
    v_mfma_f32_4x4x4_16b_bf16 v[144:147], v[228:229], v[228:229], v[144:147]
    v_rcp_f32 v134, v134
    s_bitcmp0_b64 s[56:57], 1
    s_cbranch_scc1 Ls_tnf
    v_cvt_pk_bf16_f32 v246, v212, v212
    v_mov_b32 v212, 0
    ds_write_b16 v240, v246
    v_add_u32 v240, 128, v240
    s_add_u32 s24, s24, s32
    s_addc_u32 s25, s25, 0
    s_xor_b32 s32, s32, 0x18ffe0
Ls_tnf:
    v_cvt_pk_bf16_f32 v132, v132, v133
    s_waitcnt lgkmcnt(0)
    v_rcp_f32 v135, v135
    v_rcp_f32 v136, v136
    v_cvt_pk_bf16_f32 v133, v134, v135
    v_rcp_f32 v137, v137
    v_rcp_f32 v138, v138
    v_cvt_pk_bf16_f32 v134, v136, v137
    v_rcp_f32 v139, v139
    v_rcp_f32 v140, v140
    v_cvt_pk_bf16_f32 v135, v138, v139
    v_rcp_f32 v141, v141
    v_rcp_f32 v142, v142
    v_cvt_pk_bf16_f32 v136, v140, v141
    v_mfma_f32_16x16x32_bf16 v[208:211], v[132:135], v[196:199], v[204:207]
    v_rcp_f32 v143, v143
    v_rcp_f32 v144, v144
    v_cvt_pk_bf16_f32 v137, v142, v143
    v_rcp_f32 v145, v145
    v_rcp_f32 v146, v146
    v_rcp_f32 v147, v147
    v_cvt_pk_bf16_f32 v138, v144, v145
    v_cvt_pk_bf16_f32 v139, v146, v147
    s_nop 1
    v_mfma_f32_16x16x32_bf16 v[208:211], v[136:139], v[200:203], v[208:211]
    ds_read_b32 v246, v244 offset:16
    s_waitcnt lgkmcnt(0)
    v_bfe_u32 v247, v246, 0, 8
    v_lshlrev_b32 v247, 1, v247
    v_bfe_u32 v248, v246, 8, 8
    v_lshlrev_b32 v248, 1, v248
    v_bfe_u32 v249, v246, 16, 8
    v_lshlrev_b32 v249, 1, v249
    v_bfe_u32 v250, v246, 24, 8
    v_lshlrev_b32 v250, 1, v250
    buffer_load_ushort v247, v247, s[24:27], 0 offen
    buffer_load_ushort v248, v248, s[24:27], 0 offen
    buffer_load_ushort v249, v249, s[24:27], 0 offen
    buffer_load_ushort v250, v250, s[24:27], 0 offen
    s_waitcnt vmcnt(0)
    v_lshlrev_b32 v247, 16, v247
    v_mul_f32 v208, v208, v247
    v_lshlrev_b32 v248, 16, v248
    v_mul_f32 v209, v209, v248
    v_lshlrev_b32 v249, 16, v249
    v_mul_f32 v210, v210, v249
    v_lshlrev_b32 v250, 16, v250
    v_mul_f32 v211, v211, v250
    v_cvt_pk_bf16_f32 v208, v208, v209
    v_cvt_pk_bf16_f32 v209, v210, v211
    s_nop 1
    v_mfma_f32_4x4x4_16b_bf16 v[212:215], v[208:209], v[188:189], v[212:215] cbsz:4 abid:0
    s_nop 1
    v_mfma_f32_4x4x4_16b_bf16 v[212:215], v[208:209], v[190:191], v[212:215] cbsz:4 abid:4
    s_nop 1
    v_mfma_f32_4x4x4_16b_bf16 v[212:215], v[208:209], v[192:193], v[212:215] cbsz:4 abid:8
    s_nop 1
    v_mfma_f32_4x4x4_16b_bf16 v[212:215], v[208:209], v[194:195], v[212:215] cbsz:4 abid:12
    s_nop 4
    v_cvt_pk_bf16_f32 v246, v212, v212
    ds_write_b16 v240, v246
    s_branch L_store
.section .rodata,"a"
.p2align 6
.amdhsa_kernel standalone__sequential_behavior_din__recsys_kernel
  .amdhsa_next_free_vgpr 256
  .amdhsa_next_free_sgpr 102
  .amdhsa_accum_offset 256
  .amdhsa_group_segment_fixed_size 0
  .amdhsa_kernarg_size 80
  .amdhsa_user_sgpr_count 2
  .amdhsa_user_sgpr_kernarg_segment_ptr 1
  .amdhsa_system_sgpr_workgroup_id_x 1
.end_amdhsa_kernel
```

```asm
; @launch grid=(256,1,1) block=(512,1,1) lds=163840
.amdgcn_target "amdgcn-amd-amdhsa--gfx950"
.text
.globl standalone__sequential_behavior_din__recsys_kernel
.p2align 8
.type standalone__sequential_behavior_din__recsys_kernel,@function
standalone__sequential_behavior_din__recsys_kernel:
    s_load_dwordx16 s[4:19], s[0:1], 0
    s_cmp_ge_u32 s2, 256
    s_cbranch_scc1 L_end
    v_lshrrev_b32 v1, 6, v0
    v_and_b32 v0, 63, v0
    v_readfirstlane_b32 s54, v1
    s_lshl_b32 s53, s2, 3
    v_lshlrev_b32 v2, 4, v0
    v_lshrrev_b32 v1, 4, v0
    v_and_b32 v3, 0xf0, v2
    v_lshlrev_b32 v3, 2, v3
    v_lshl_add_u32 v130, v1, 4, v3
    v_bfrev_b32 v3, 1
    s_add_u32 s53, s53, s54
    s_movk_i32 s66, 800
    v_cmp_gt_u32 vcc, s66, v130
    s_mul_i32 s93, s53, 800
    s_mul_i32 s52, s54, 20480
    s_mov_b64 s[28:29], vcc
    v_cndmask_b32 v3, v3, v130, vcc
    v_and_b32 v248, 16, v0
    v_lshlrev_b32 v246, 1, v248
    v_xor_b32 v246, v246, v2
    v_and_b32 v243, 0xf0, v2
    v_lshl_add_u32 v243, v1, 19, v243
    s_lshl_b32 s66, s53, 8
    v_add_u32 v243, s66, v243
    s_lshl_b32 s67, s54, 12
    s_add_u32 m0, s52, 8320
    s_mov_b32 s26, 6553600
    s_mov_b32 s27, 0x20000
    s_waitcnt lgkmcnt(0)
    s_mov_b32 s24, s8
    s_and_b32 s25, s9, 0xffff
    s_cmp_ge_u32 s54, 4
    s_cbranch_scc1 L_young0
    buffer_load_dwordx4 v[100:103], v3, s[24:27], s93 offen nt
L_young0:
    global_load_lds_dwordx4 v243, s[4:5] nt
    s_add_u32 m0, s52, 4160
    s_add_u32 s10, s10, s67
    s_addc_u32 s11, s11, 0
    v_xor_b32 v247, 64, v246
    global_load_lds_dwordx4 v246, s[10:11] offset:0
    global_load_lds_dwordx4 v247, s[10:11] offset:1024
    global_load_lds_dwordx4 v246, s[10:11] offset:2048
    global_load_lds_dwordx4 v247, s[10:11] offset:3072
    s_load_dword s30, s[16:17], 0
    s_and_b32 s67, s54, 3
    v_and_b32 v250, 3, v0
    s_mov_b32 s20, s6
    s_and_b32 s21, s7, 0xffff
    s_or_b32 s21, s21, 0x800000
    s_mov_b32 s22, 200
    s_mov_b32 s23, 0x20000
    s_sub_u32 s40, s20, 1056
    s_subb_u32 s41, s21, 0
    s_mov_b32 s42, 200
    s_mov_b32 s43, 0x20000
    s_mul_i32 s35, s53, 51200
    s_movk_i32 s31, 25600
    s_mov_b32 s60, 3
    s_mov_b64 s[56:57], 0
    v_mov_b32 v148, -1
    v_mov_b32 v149, -1
    v_mov_b32 v150, -1
    v_mov_b32 v151, -1
    s_add_u32 s66, s52, 18432
    v_add_u32 v152, s66, v2
    ds_write_b128 v152, v[148:151]
    ds_write_b128 v152, v[148:151] offset:1024
    s_add_u32 s64, s52, 18448
    v_mov_b32 v153, -1
    v_mov_b32 v154, -1
    v_mov_b32 v155, -1
    v_lshrrev_b32 v237, 3, v0
    v_add_u32 v237, s64, v237
    v_lshl_add_u32 v244, v1, 2, s66
    v_and_b32 v231, 0x70, v2
    v_lshlrev_b32 v248, 2, v248
    v_xor_b32 v231, v231, v248
    v_mov_b32 v233, v231
    s_movk_i32 s66, 400
    v_cmp_le_u32 vcc, s66, v130
    v_lshrrev_b32 v126, 1, v130
    s_movk_i32 s66, -200
    v_cndmask_b32 v130, 0, 1, vcc
    v_mad_i32_i24 v126, v130, s66, v126
    v_mul_u32_u24 v127, 0x10001, v126
    v_add_u32 v126, 0x10000, v127
    v_add_u32 v128, 0x50004, v127
    v_add_u32 v129, 0x70006, v127
    v_add_u32 v127, 0x30002, v127
    v_mov_b32 v131, 0xbfe0bfe0
    s_mov_b32 s86, 0xfff0ffff
    s_mov_b32 s87, 0xf000ff00
    s_mov_b32 s88, 0xff00fff0
    s_mov_b32 s89, 0xf000
    s_mov_b32 s90, 0xf0000f
    s_mov_b32 s91, 0xf0000f00
    s_mov_b32 s84, 0x11111113
    s_mov_b32 s85, 0x11111111
    v_cndmask_b32 v116, 0, v131, s[86:87]
    v_cndmask_b32 v120, 0, v131, s[88:89]
    v_cndmask_b32 v117, 0, v131, s[86:87]
    v_cndmask_b32 v121, 0, v131, s[88:89]
    v_cndmask_b32 v122, 0, v131, s[84:85]
    v_cndmask_b32 v123, 0, v131, s[84:85]
    v_cndmask_b32 v124, 0, v131, s[84:85]
    v_cndmask_b32 v125, 0, v131, s[84:85]
    v_lshlrev_b32 v246, 4, v250
    v_sub_u32 v246, 48, v246
    s_mov_b32 s86, 0xbfe0bfe0
    s_mov_b32 s87, 0xf0bfe0
    v_lshrrev_b64 v[118:119], v246, s[86:87]
    v_mov_b32 v131, 0
    s_mov_b64 s[84:85], 0
    v_cndmask_b32 v118, v120, v118, s[90:91]
    v_cndmask_b32 v119, v121, v119, s[90:91]
    s_mov_b32 s61, 7
    s_mov_b32 s92, 0xbfb8aa3b
    v_and_b32 v251, 15, v0
    v_bfe_u32 v252, v0, 2, 2
    v_lshlrev_b32 v253, 3, v250
    v_lshl_add_u32 v253, v252, 7, v253
    v_and_b32 v246, 24, v0
    v_lshlrev_b32 v246, 2, v246
    v_xor_b32 v246, v253, v246
    v_lshl_add_u32 v246, v1, 10, v246
    s_lshl_b32 s66, s67, 5
    v_xor_b32 v66, s66, v246
    v_add_u32 v66, 45120, v66
    s_lshr_b32 s66, s54, 1
    s_lshl_b32 s66, s66, 5
    v_xor_b32 v64, s66, v246
    s_and_b32 s66, s54, 1
    s_mul_i32 s66, s66, 20480
    s_add_u32 s66, s66, 4160
    v_add_u32 v64, s66, v64
    v_add_u32 v65, 81920, v64
    s_and_b32 s66, s54, 4
    v_lshrrev_b32 v246, 3, v251
    v_add_u32 v246, s66, v246
    v_mul_u32_u24 v246, 20480, v246
    v_lshl_add_u32 v246, v1, 4, v246
    v_and_b32 v247, 7, v0
    v_lshl_add_u32 v67, v247, 7, v246
    v_and_b32 v247, 1, v0
    v_lshlrev_b32 v247, 4, v247
    v_lshlrev_b32 v247, v247, 1
    v_cmp_gt_u32 vcc, 2, v250
    v_mov_b32 v229, 0
    v_mov_b32 v228, 0x3f80
    v_cndmask_b32 v241, 0, v247, vcc
    v_cmp_eq_u32 vcc, 0, v251
    v_sub_u32 v242, v247, v241
    v_mul_u32_u24 v218, 0x3f80, v241
    v_cndmask_b32 v220, 0, -1, vcc
    v_mul_u32_u24 v219, 0x3f80, v242
    s_and_b32 s66, s54, 3
    s_lshl_b32 s66, s66, 6
    s_add_u32 s66, s66, 9344
    v_and_b32 v247, 7, v0
    v_mul_u32_u24 v247, 144, v247
    v_add3_u32 v98, v67, v247, s66
    s_add_u32 s66, s52, 14592
    v_lshl_add_u32 v221, v0, 2, s66
    ds_write_b32 v221, v229
    s_xor_b32 s66, s54, 4
    s_mul_i32 s66, s66, 20480
    s_add_u32 s66, s66, 14592
    v_writelane_b32 v221, s66, 1
    v_add_u32 v222, s52, v2
    s_mov_b64 exec, 15
    ds_write_b32 v222, v229 offset:14848
    s_mov_b64 exec, -1
    v_and_b32 v247, 8, v0
    v_lshlrev_b32 v247, 2, v247
    v_lshl_add_u32 v247, v251, 7, v247
    v_add_u32 v247, s52, v247
    v_and_b32 v248, 2, v0
    v_lshlrev_b32 v248, 1, v248
    v_xor_b32 v248, v248, v1
    v_lshl_add_u32 v234, v248, 4, v247
    v_xor_b32 v248, 4, v248
    v_lshl_add_u32 v235, v248, 4, v247
    v_and_b32 v247, 8, v0
    v_lshlrev_b32 v247, 3, v247
    v_lshl_add_u32 v248, v1, 5, v253
    v_xor_b32 v248, v248, v247
    v_add_u32 v236, s52, v248
    s_add_u32 s66, s52, 8320
    v_lshl_add_u32 v238, v250, 1, s66
    v_lshl_add_u32 v238, v1, 4, v238
    s_add_u32 s66, s52, 14912
    v_lshl_add_u32 v240, v0, 1, s66
    s_add_u32 s66, s52, 9344
    v_lshl_add_u32 v239, v1, 4, s66
    v_mov_b32 v188, 0
    v_mov_b32 v189, 0
    v_mov_b32 v190, 0
    v_mov_b32 v191, 0
    v_mov_b32 v192, 0
    v_mov_b32 v193, 0
    v_mov_b32 v194, 0
    v_mov_b32 v195, 0
    v_mov_b32 v208, 0
    v_mov_b32 v212, 0
    v_mov_b32 v209, 0
    v_mov_b32 v213, 0
    v_mov_b32 v210, 0
    v_mov_b32 v214, 0
    v_mov_b32 v211, 0
    v_mov_b32 v215, 0
    s_and_b32 s66, s54, 3
    s_lshl_b32 s66, s66, 5
    v_lshl_add_u32 v249, v1, 3, s66
    global_load_dwordx2 v[96:97], v249, s[12:13]
    s_cmp_ge_u32 s54, 4
    s_cbranch_scc0 L_old3z
    buffer_load_dwordx4 v[100:103], v3, s[24:27], s93 offen nt
L_old3z:
    s_cmp_ge_u32 s54, 4
    s_cbranch_scc1 L_young1
    s_waitcnt vmcnt(6) lgkmcnt(0)
    s_call_b64 s[62:63], L_fp
    s_waitcnt vmcnt(5)
    s_branch L_old1
L_young1:
    s_waitcnt vmcnt(2)
L_old1:
    s_waitcnt lgkmcnt(0)
    s_barrier
    ds_read_b64_tr_b16 v[16:17], v66 offset:0
    ds_read_b64_tr_b16 v[18:19], v66 offset:512
    ds_read_b64_tr_b16 v[20:21], v66 offset:20480
    ds_read_b64_tr_b16 v[22:23], v66 offset:20992
    ds_read_b64_tr_b16 v[24:25], v66 offset:40960
    ds_read_b64_tr_b16 v[26:27], v66 offset:41472
    ds_read_b64_tr_b16 v[28:29], v66 offset:61440
    ds_read_b64_tr_b16 v[30:31], v66 offset:61952
    ds_read_b128 v[32:35], v67 offset:8320
    ds_read_b128 v[36:39], v67 offset:8384
    ds_read_b128 v[40:43], v67 offset:49280
    ds_read_b128 v[44:47], v67 offset:49344
    ds_read_b64_tr_b16 v[4:5], v64 offset:0
    ds_read_b64_tr_b16 v[8:9], v65 offset:0
    ds_read_b64_tr_b16 v[12:13], v65 offset:40960
    ds_read_b64_tr_b16 v[6:7], v64 offset:512
    ds_read_b64_tr_b16 v[10:11], v65 offset:512
    ds_read_b64_tr_b16 v[14:15], v65 offset:41472
    s_cmp_ge_u32 s54, 4
    s_cbranch_scc1 L_young2
    s_waitcnt vmcnt(4)
    s_branch L_old2
L_young2:
    s_waitcnt vmcnt(1)
L_old2:
    s_add_u32 s93, s93, 1638400
    buffer_load_dwordx4 v[104:107], v3, s[24:27], s93 offen nt
    s_add_u32 s93, s93, 1638400
    buffer_load_dwordx4 v[108:111], v3, s[24:27], s93 offen nt
    s_add_u32 s93, s93, 1638400
    buffer_load_dwordx4 v[112:115], v3, s[24:27], s93 offen nt
    v_lshlrev_b32 v249, 3, v1
    v_lshl_add_u32 v249, v250, 5, v249
    global_load_dwordx2 v[216:217], v249, s[14:15]
    v_lshlrev_b32 v48, 16, v96
    v_and_b32 v49, 0xffff0000, v96
    v_lshlrev_b32 v50, 16, v97
    v_and_b32 v51, 0xffff0000, v97
    s_lshl_b32 s30, s30, 16
    v_and_b32 v204, s30, v220
    v_and_b32 v205, s30, v220
    v_and_b32 v206, s30, v220
    v_and_b32 v207, s30, v220
    s_waitcnt lgkmcnt(0)
    v_xor_b32 v24, 0x80008000, v24
    v_xor_b32 v25, 0x80008000, v25
    v_xor_b32 v26, 0x80008000, v26
    v_xor_b32 v27, 0x80008000, v27
    v_xor_b32 v28, 0x80008000, v28
    v_xor_b32 v29, 0x80008000, v29
    v_xor_b32 v30, 0x80008000, v30
    v_xor_b32 v31, 0x80008000, v31
    v_mfma_f32_4x4x4_16b_bf16 v[56:59], v[218:219], v[4:5], 0
    v_mfma_f32_4x4x4_16b_bf16 v[68:71], v[218:219], v[12:13], 0
    v_mfma_f32_4x4x4_16b_bf16 v[60:63], v[218:219], v[6:7], 0
    v_mfma_f32_4x4x4_16b_bf16 v[72:75], v[218:219], v[14:15], 0
    v_mfma_f32_4x4x4_16b_bf16 v[56:59], v[218:219], v[8:9], v[56:59]
    v_mfma_f32_4x4x4_16b_bf16 v[60:63], v[218:219], v[10:11], v[60:63]
    v_mfma_f32_16x16x32_bf16 v[52:55], v[16:19], v[40:43], v[48:51]
    v_mfma_f32_16x16x32_bf16 v[52:55], v[20:23], v[44:47], v[52:55]
    v_mfma_f32_16x16x32_bf16 v[52:55], v[24:27], v[40:43], v[52:55]
    v_mfma_f32_16x16x32_bf16 v[52:55], v[28:31], v[44:47], v[52:55]
    v_mfma_f32_16x16x32_bf16 v[48:51], v[16:19], v[32:35], v[48:51]
    v_mfma_f32_16x16x32_bf16 v[48:51], v[20:23], v[36:39], v[48:51]
    v_mfma_f32_16x16x32_bf16 v[48:51], v[24:27], v[32:35], v[48:51]
    v_mfma_f32_16x16x32_bf16 v[48:51], v[28:31], v[36:39], v[48:51]
    v_mul_f32 v56, s92, v56
    v_mul_f32 v57, s92, v57
    v_mul_f32 v58, s92, v58
    v_mul_f32 v59, s92, v59
    v_mul_f32 v60, s92, v60
    v_mul_f32 v61, s92, v61
    v_mul_f32 v62, s92, v62
    v_mul_f32 v63, s92, v63
    v_mul_f32 v68, s92, v68
    v_mul_f32 v69, s92, v69
    v_mul_f32 v70, s92, v70
    v_mul_f32 v71, s92, v71
    v_mul_f32 v72, s92, v72
    v_mul_f32 v73, s92, v73
    v_mul_f32 v74, s92, v74
    v_mul_f32 v75, s92, v75
    s_add_u32 s66, s52, 11520
    v_add_u32 v3, s66, v2
    v_cvt_pk_bf16_f32 v68, v68, v69
    v_cvt_pk_bf16_f32 v69, v70, v71
    v_cvt_pk_bf16_f32 v70, v72, v73
    v_cvt_pk_bf16_f32 v71, v74, v75
    v_mul_f32 v48, s92, v48
    v_mul_f32 v49, s92, v49
    v_mul_f32 v50, s92, v50
    v_mul_f32 v51, s92, v51
    v_mul_f32 v52, s92, v52
    v_mul_f32 v53, s92, v53
    v_mul_f32 v54, s92, v54
    v_mul_f32 v55, s92, v55
    ds_write_b128 v3, v[56:59]
    ds_write_b128 v3, v[60:63] offset:1024
    ds_write_b128 v3, v[68:71] offset:2048
    ds_write_b128 v98, v[48:51]
    ds_write_b128 v98, v[52:55] offset:40960
    v_add_u32 v3, 11520, v2
    v_add_u32 v246, 81920, v3
    s_waitcnt lgkmcnt(0)
    s_barrier
    s_cmp_ge_u32 s54, 4
    s_cbranch_scc0 L_old3
    s_waitcnt vmcnt(4)
    s_call_b64 s[62:63], L_fp
    s_branch L_yng3
L_old3:
    s_call_b64 s[62:63], L_t23
L_yng3:
    ds_read_b128 v[4:7], v3 offset:0
    ds_read_b128 v[8:11], v3 offset:1024
    ds_read_b128 v[68:71], v3 offset:2048
    ds_read_b128 v[12:15], v3 offset:20480
    ds_read_b128 v[16:19], v3 offset:21504
    ds_read_b128 v[72:75], v3 offset:22528
    ds_read_b128 v[20:23], v3 offset:40960
    ds_read_b128 v[24:27], v3 offset:41984
    ds_read_b128 v[76:79], v3 offset:43008
    s_waitcnt vmcnt(4)
    v_mfma_i32_16x16x64_i8 v[172:175], v[122:125], v[104:107], 0
    v_mfma_i32_16x16x64_i8 v[176:179], v[122:125], v[108:111], 0
    v_mfma_i32_16x16x64_i8 v[180:183], v[122:125], v[112:115], 0
    v_and_b32 v160, 0x800080, v104
    v_mul_u32_u24 v160, 0x7f, v160
    v_bitop3_b32 v131, v104, v160, v131 bitop3:0xbe
    v_and_b32 v161, 0x800080, v105
    v_mul_u32_u24 v161, 0x7f, v161
    v_bitop3_b32 v131, v105, v161, v131 bitop3:0xbe
    v_and_b32 v160, 0x800080, v106
    v_mul_u32_u24 v160, 0x7f, v160
    v_bitop3_b32 v131, v106, v160, v131 bitop3:0xbe
    v_mov_b32_dpp v184, v172 row_shr:1 row_mask:0xf bank_mask:0xf bound_ctrl:0
    v_mov_b32_dpp v185, v176 row_shr:1 row_mask:0xf bank_mask:0xf bound_ctrl:0
    v_mov_b32_dpp v186, v180 row_shr:1 row_mask:0xf bank_mask:0xf bound_ctrl:0
    v_add_u32_dpp v184, v184, v184 row_shr:1 row_mask:0xf bank_mask:0xf bound_ctrl:0
    v_add_u32_dpp v185, v185, v185 row_shr:1 row_mask:0xf bank_mask:0xf bound_ctrl:0
    v_add_u32_dpp v186, v186, v186 row_shr:1 row_mask:0xf bank_mask:0xf bound_ctrl:0
    v_add_u32_dpp v184, v184, v184 row_shr:2 row_mask:0xf bank_mask:0xf bound_ctrl:0
    v_add_u32_dpp v185, v185, v185 row_shr:2 row_mask:0xf bank_mask:0xf bound_ctrl:0
    v_add_u32_dpp v186, v186, v186 row_shr:2 row_mask:0xf bank_mask:0xf bound_ctrl:0
    v_add_u32_dpp v184, v184, v184 row_shr:4 row_mask:0xf bank_mask:0xf bound_ctrl:0
    v_add_u32_dpp v185, v185, v185 row_shr:4 row_mask:0xf bank_mask:0xf bound_ctrl:0
    v_add_u32_dpp v186, v186, v186 row_shr:4 row_mask:0xf bank_mask:0xf bound_ctrl:0
    v_add_u32_dpp v184, v184, v184 row_shr:8 row_mask:0xf bank_mask:0xf bound_ctrl:0
    v_add_u32_dpp v185, v185, v185 row_shr:8 row_mask:0xf bank_mask:0xf bound_ctrl:0
    v_add_u32_dpp v186, v186, v186 row_shr:8 row_mask:0xf bank_mask:0xf bound_ctrl:0
    ds_read_b128 v[28:31], v3 offset:61440
    ds_read_b128 v[32:35], v3 offset:62464
    ds_read_b128 v[80:83], v3 offset:63488
    ds_read_b128 v[36:39], v246 offset:0
    ds_read_b128 v[40:43], v246 offset:1024
    ds_read_b128 v[84:87], v246 offset:2048
    v_and_b32 v161, 0x800080, v107
    v_mul_u32_u24 v161, 0x7f, v161
    v_bitop3_b32 v131, v107, v161, v131 bitop3:0xbe
    v_and_b32 v160, 0x800080, v108
    v_mul_u32_u24 v160, 0x7f, v160
    v_bitop3_b32 v131, v108, v160, v131 bitop3:0xbe
    v_and_b32 v161, 0x800080, v109
    v_mul_u32_u24 v161, 0x7f, v161
    v_bitop3_b32 v131, v109, v161, v131 bitop3:0xbe
    v_and_b32 v160, 0x800080, v110
    v_mul_u32_u24 v160, 0x7f, v160
    v_bitop3_b32 v131, v110, v160, v131 bitop3:0xbe
    v_and_b32 v161, 0x800080, v111
    v_mul_u32_u24 v161, 0x7f, v161
    v_bitop3_b32 v131, v111, v161, v131 bitop3:0xbe
    v_and_b32 v160, 0x800080, v112
    v_mul_u32_u24 v160, 0x7f, v160
    v_bitop3_b32 v131, v112, v160, v131 bitop3:0xbe
    v_and_b32 v161, 0x800080, v113
    v_mul_u32_u24 v161, 0x7f, v161
    v_bitop3_b32 v131, v113, v161, v131 bitop3:0xbe
    v_and_b32 v160, 0x800080, v114
    v_mul_u32_u24 v160, 0x7f, v160
    v_bitop3_b32 v131, v114, v160, v131 bitop3:0xbe
    v_and_b32 v161, 0x800080, v115
    v_mul_u32_u24 v161, 0x7f, v161
    v_bitop3_b32 v131, v115, v161, v131 bitop3:0xbe
    v_cmp_ne_u32 vcc, 0, v131
    v_readlane_b32 s68, v184, 6
    v_readlane_b32 s69, v173, 6
    v_readlane_b32 s70, v184, 15
    v_readlane_b32 s72, v185, 6
    v_readlane_b32 s73, v177, 6
    v_readlane_b32 s74, v185, 15
    v_readlane_b32 s76, v186, 6
    v_readlane_b32 s77, v181, 6
    v_readlane_b32 s78, v186, 15
    s_cbranch_vccnz L_general
    s_add_u32 s66, s68, s69
    s_add_u32 s66, s66, s64
    s_add_u32 s67, s66, 15
    s_and_b32 s67, s67, -16
    s_add_u32 s55, s64, 16
    s_max_u32 s67, s67, s55
    s_sub_u32 s66, s67, s66
    v_mad_u32_u24 v184, v130, s66, v184
    s_sub_u32 s55, s64, 2048
    v_add_u32 v172, s55, v184
    v_add_u32 v173, s55, v184
    v_add_u32 v174, s55, v184
    v_add_u32 v175, s55, v184
    s_add_u32 s64, s64, s70
    s_add_u32 s64, s64, s66
    v_mfma_i32_16x16x64_i8 v[132:135], v[118:121], v[104:107], v[172:175]
    v_mfma_i32_16x16x64_i8 v[136:139], v[116:119], v[104:107], v[172:175]
    s_add_u32 s64, s64, 15
    s_and_b32 s64, s64, -16
    s_add_u32 s55, s67, 16
    s_max_u32 s64, s64, s55
    s_lshr_b32 s95, s67, 4
    s_bitset1_b64 s[56:57], s95
    s_lshr_b32 s95, s64, 4
    s_bitset1_b64 s[56:57], s95
    s_mov_b32 s44, s64
    s_add_u32 s66, s72, s73
    s_add_u32 s66, s66, s64
    s_add_u32 s67, s66, 15
    s_and_b32 s67, s67, -16
    s_add_u32 s55, s64, 16
    s_max_u32 s67, s67, s55
    s_sub_u32 s66, s67, s66
    v_mad_u32_u24 v185, v130, s66, v185
    s_sub_u32 s55, s64, 2048
    v_add_u32 v176, s55, v185
    v_add_u32 v177, s55, v185
    v_add_u32 v178, s55, v185
    v_add_u32 v179, s55, v185
    s_add_u32 s64, s64, s74
    s_add_u32 s64, s64, s66
    v_mfma_i32_16x16x64_i8 v[140:143], v[118:121], v[108:111], v[176:179]
    v_mfma_i32_16x16x64_i8 v[144:147], v[116:119], v[108:111], v[176:179]
    s_add_u32 s64, s64, 15
    s_and_b32 s64, s64, -16
    s_add_u32 s55, s67, 16
    s_max_u32 s64, s64, s55
    s_mov_b32 s45, s67
    s_mov_b32 s46, s64
    ds_write_b8 v132, v126
    ds_write_b8_d16_hi v133, v126
    ds_write_b8 v134, v127
    ds_write_b8_d16_hi v135, v127
    ds_write_b8 v136, v128
    ds_write_b8_d16_hi v137, v128
    ds_write_b8 v138, v129
    ds_write_b8_d16_hi v139, v129
    s_add_u32 s66, s76, s77
    s_add_u32 s66, s66, s64
    s_add_u32 s67, s66, 15
    s_and_b32 s67, s67, -16
    s_add_u32 s55, s64, 16
    s_max_u32 s67, s67, s55
    s_sub_u32 s66, s67, s66
    v_mad_u32_u24 v186, v130, s66, v186
    s_sub_u32 s55, s64, 2048
    v_add_u32 v180, s55, v186
    v_add_u32 v181, s55, v186
    v_add_u32 v182, s55, v186
    v_add_u32 v183, s55, v186
    s_add_u32 s64, s64, s78
    s_add_u32 s64, s64, s66
    v_mfma_i32_16x16x64_i8 v[164:167], v[118:121], v[112:115], v[180:183]
    v_mfma_i32_16x16x64_i8 v[168:171], v[116:119], v[112:115], v[180:183]
    s_add_u32 s64, s64, 15
    s_and_b32 s64, s64, -16
    s_add_u32 s55, s67, 16
    s_max_u32 s64, s64, s55
    s_mov_b32 s47, s67
    s_mov_b32 s48, s64
    ds_write_b8 v140, v126
    ds_write_b8_d16_hi v141, v126
    ds_write_b8 v142, v127
    ds_write_b8_d16_hi v143, v127
    ds_write_b8 v144, v128
    ds_write_b8_d16_hi v145, v128
    ds_write_b8 v146, v129
    ds_write_b8_d16_hi v147, v129
    ds_read_b128 v[44:47], v246 offset:20480
    ds_read_b128 v[48:51], v246 offset:21504
    ds_read_b128 v[88:91], v246 offset:22528
    ds_read_b128 v[52:55], v246 offset:40960
    ds_read_b128 v[56:59], v246 offset:41984
    ds_read_b128 v[92:95], v246 offset:43008
    ds_read_b128 v[60:63], v246 offset:61440
    ds_read_b128 v[64:67], v246 offset:62464
    ds_read_b128 v[96:99], v246 offset:63488
    ds_read_u16 v224, v238 offset:0
    ds_read_u16 v225, v238 offset:8
    ds_read_u16 v226, v238 offset:64
    ds_read_u16 v227, v238 offset:72
    ds_write_b8 v164, v126
    ds_write_b8_d16_hi v165, v126
    ds_write_b8 v166, v127
    ds_write_b8_d16_hi v167, v127
    ds_write_b8 v168, v128
    ds_write_b8_d16_hi v169, v128
    ds_write_b8 v170, v129
    ds_write_b8_d16_hi v171, v129
    s_cmp_ge_u32 s54, 4
    s_cbranch_scc0 L_old3b
    s_call_b64 s[62:63], L_t23
L_old3b:
L_listed:
    s_and_b32 s55, s84, 0x40000000
    s_or_b32 s55, s55, s54
    s_bitset1_b32 s55, 31
    s_and_b32 s66, s74, 0x1ff
    s_lshl_b32 s66, s66, 3
    s_or_b32 s66, s66, s55
    s_and_b32 s67, s78, 0x1ff
    s_lshl_b32 s67, s67, 3
    s_or_b32 s67, s67, s55
    v_mov_b32 v132, s66
    v_mov_b32 v133, s44
    v_mov_b32 v134, s45
    v_mov_b32 v135, s46
    v_writelane_b32 v132, s67, 1
    v_writelane_b32 v133, s46, 1
    v_writelane_b32 v134, s47, 1
    v_writelane_b32 v135, s48, 1
    s_mov_b64 exec, 3
    ds_write_b128 v222, v[132:135] offset:14848
    s_mov_b64 exec, -1
    s_sub_u32 s68, s46, s44
    s_sub_u32 s69, s48, s46
    s_lshl_b32 s50, s54, 3
    s_mov_b32 s51, 0
    s_mov_b32 s33, 0
    s_sub_u32 s66, s64, s52
    s_sub_u32 s66, s66, 18448
    s_lshr_b32 s66, s66, 3
    s_lshr_b32 s67, s54, 2
    s_mul_i32 s67, s67, 2
    s_add_u32 s66, s66, s67
    s_sub_u32 s67, 0, s66
    v_mov_b32 v2, v221
    v_mov_b32 v1, s66
    v_mov_b32 v3, -8
    v_writelane_b32 v1, s67, 1
    v_writelane_b32 v3, 8, 1
    ds_add_u32 v2, v1
    s_cmp_eq_u32 s94, 1
    s_cbranch_scc1 L_nolate
    ds_read_u8 v148, v237 offset:0
    ds_read_u8 v149, v237 offset:8
    ds_read_u8 v150, v237 offset:16
    ds_read_u8 v151, v237 offset:24
    ds_read_u8 v152, v237 offset:32
    ds_read_u8 v153, v237 offset:40
    ds_read_u8 v154, v237 offset:48
    ds_read_u8 v155, v237 offset:56
    s_waitcnt lgkmcnt(0)
    s_add_u32 m0, s52, 0
    v_mov_b32 v230, v148
    v_mov_b32 v232, v149
    buffer_load_dwordx4 v[230:231], s[20:23], s35 idxen offen nt lds
    buffer_load_dwordx4 v[232:233], s[40:43], s35 idxen offen offset:1056 nt lds
    s_bitcmp0_b64 s[56:57], 2
    s_cbranch_scc1 L_noadvl1
    s_add_u32 s35, s35, s31
    s_min_u32 s35, s35, 419404800
    s_xor_b32 s31, s31, 0x63ff800
    s_sub_u32 s60, s60, 1
L_noadvl1:
    s_add_u32 m0, s52, 2080
    v_mov_b32 v230, v150
    v_mov_b32 v232, v151
    buffer_load_dwordx4 v[230:231], s[20:23], s35 idxen offen nt lds
    buffer_load_dwordx4 v[232:233], s[40:43], s35 idxen offen offset:1056 nt lds
    s_bitcmp0_b64 s[56:57], 3
    s_cbranch_scc1 L_noadvl2
    s_add_u32 s35, s35, s31
    s_min_u32 s35, s35, 419404800
    s_xor_b32 s31, s31, 0x63ff800
    s_sub_u32 s60, s60, 1
L_noadvl2:
    s_add_u32 m0, s52, 4160
    v_mov_b32 v230, v152
    v_mov_b32 v232, v153
    buffer_load_dwordx4 v[230:231], s[20:23], s35 idxen offen nt lds
    buffer_load_dwordx4 v[232:233], s[40:43], s35 idxen offen offset:1056 nt lds
    s_bitcmp0_b64 s[56:57], 4
    s_cbranch_scc1 L_noadvl3
    s_add_u32 s35, s35, s31
    s_min_u32 s35, s35, 419404800
    s_xor_b32 s31, s31, 0x63ff800
    s_sub_u32 s60, s60, 1
L_noadvl3:
    s_add_u32 m0, s52, 6240
    v_mov_b32 v230, v154
    v_mov_b32 v232, v155
    buffer_load_dwordx4 v[230:231], s[20:23], s35 idxen offen nt lds
    buffer_load_dwordx4 v[232:233], s[40:43], s35 idxen offen offset:1056 nt lds
L_nolate:
    v_and_b32_dpp v196, v216, v220 quad_perm:[0,0,0,0] row_mask:0xf bank_mask:0xf
    v_and_b32_dpp v197, v217, v220 quad_perm:[0,0,0,0] row_mask:0xf bank_mask:0xf
    v_and_b32_dpp v198, v216, v220 quad_perm:[1,1,1,1] row_mask:0xf bank_mask:0xf
    v_and_b32_dpp v199, v217, v220 quad_perm:[1,1,1,1] row_mask:0xf bank_mask:0xf
    v_and_b32_dpp v200, v216, v220 quad_perm:[2,2,2,2] row_mask:0xf bank_mask:0xf
    v_and_b32_dpp v201, v217, v220 quad_perm:[2,2,2,2] row_mask:0xf bank_mask:0xf
    v_and_b32_dpp v202, v216, v220 quad_perm:[3,3,3,3] row_mask:0xf bank_mask:0xf
    v_and_b32_dpp v203, v217, v220 quad_perm:[3,3,3,3] row_mask:0xf bank_mask:0xf
    s_waitcnt vmcnt(6) lgkmcnt(0)
    ds_read_b128 v[180:183], v234 offset:0
    ds_read_b128 v[184:187], v235 offset:0
    v_mul_u32_u24 v216, v224, v241
    v_mul_u32_u24 v217, v224, v242
    v_mul_u32_u24 v218, v225, v241
    v_mul_u32_u24 v219, v225, v242
    v_mul_u32_u24 v220, v226, v241
    v_mul_u32_u24 v221, v226, v242
    v_mul_u32_u24 v222, v227, v241
    v_mul_u32_u24 v223, v227, v242
    v_mfma_f32_4x4x4_16b_bf16 v[140:143], v[216:217], v[68:69], v[4:7]
    v_add_u32 v238, 128, v238
    ds_read_b128 v[164:167], v239 offset:0
    ds_read_b128 v[168:171], v239 offset:64
    v_mfma_f32_4x4x4_16b_bf16 v[144:147], v[218:219], v[70:71], v[8:11]
    ds_read_b128 v[172:175], v239 offset:128
    ds_read_b128 v[176:179], v239 offset:192
    ds_read_u16 v224, v238 offset:0
    ds_read_u16 v225, v238 offset:8
    ds_read_u16 v226, v238 offset:64
    ds_read_u16 v227, v238 offset:72
    v_mfma_f32_4x4x4_16b_bf16 v[246:249], v[220:221], v[72:73], v[12:15]
    v_cvt_pk_bf16_f32 v100, v140, v141
    v_cvt_pk_bf16_f32 v101, v142, v143
    v_mfma_f32_4x4x4_16b_bf16 v[250:253], v[222:223], v[74:75], v[16:19]
    v_cvt_pk_bf16_f32 v102, v144, v145
    v_cvt_pk_bf16_f32 v103, v146, v147
    v_mfma_f32_4x4x4_16b_bf16 v[140:143], v[216:217], v[76:77], v[20:23]
    v_cvt_pk_bf16_f32 v104, v246, v247
    v_cvt_pk_bf16_f32 v105, v248, v249
    v_mfma_f32_4x4x4_16b_bf16 v[144:147], v[218:219], v[78:79], v[24:27]
    v_cvt_pk_bf16_f32 v106, v250, v251
    v_cvt_pk_bf16_f32 v107, v252, v253
    v_mfma_f32_4x4x4_16b_bf16 v[246:249], v[220:221], v[80:81], v[28:31]
    v_cvt_pk_bf16_f32 v108, v140, v141
    v_cvt_pk_bf16_f32 v109, v142, v143
    v_mfma_f32_4x4x4_16b_bf16 v[250:253], v[222:223], v[82:83], v[32:35]
    v_cvt_pk_bf16_f32 v110, v144, v145
    v_cvt_pk_bf16_f32 v111, v146, v147
    v_mfma_f32_4x4x4_16b_bf16 v[140:143], v[216:217], v[84:85], v[36:39]
    v_cvt_pk_bf16_f32 v112, v246, v247
    v_cvt_pk_bf16_f32 v113, v248, v249
    v_mfma_f32_4x4x4_16b_bf16 v[144:147], v[218:219], v[86:87], v[40:43]
    v_cvt_pk_bf16_f32 v114, v250, v251
    v_cvt_pk_bf16_f32 v115, v252, v253
    v_mfma_f32_4x4x4_16b_bf16 v[246:249], v[220:221], v[88:89], v[44:47]
    v_cvt_pk_bf16_f32 v116, v140, v141
    v_cvt_pk_bf16_f32 v117, v142, v143
    v_mfma_f32_4x4x4_16b_bf16 v[250:253], v[222:223], v[90:91], v[48:51]
    v_cvt_pk_bf16_f32 v118, v144, v145
    v_cvt_pk_bf16_f32 v119, v146, v147
    v_mfma_f32_4x4x4_16b_bf16 v[140:143], v[216:217], v[92:93], v[52:55]
    v_cvt_pk_bf16_f32 v120, v246, v247
    v_cvt_pk_bf16_f32 v121, v248, v249
    v_mfma_f32_4x4x4_16b_bf16 v[144:147], v[218:219], v[94:95], v[56:59]
    v_cvt_pk_bf16_f32 v122, v250, v251
    v_cvt_pk_bf16_f32 v123, v252, v253
    v_mfma_f32_4x4x4_16b_bf16 v[246:249], v[220:221], v[96:97], v[60:63]
    v_cvt_pk_bf16_f32 v124, v140, v141
    v_cvt_pk_bf16_f32 v125, v142, v143
    v_mfma_f32_4x4x4_16b_bf16 v[250:253], v[222:223], v[98:99], v[64:67]
    v_cvt_pk_bf16_f32 v126, v144, v145
    v_cvt_pk_bf16_f32 v127, v146, v147
    v_cvt_pk_bf16_f32 v128, v246, v247
    v_cvt_pk_bf16_f32 v129, v248, v249
    v_add_u32 v239, 272, v239
    v_cvt_pk_bf16_f32 v130, v250, v251
    v_cvt_pk_bf16_f32 v131, v252, v253
    s_waitcnt lgkmcnt(0)
    v_mfma_f32_16x16x32_bf16 v[148:151], v[100:103], v[180:183], v[164:167]
    v_mfma_f32_16x16x32_bf16 v[148:151], v[104:107], v[184:187], v[148:151]
    v_mfma_f32_16x16x32_bf16 v[152:155], v[108:111], v[180:183], v[168:171]
    v_mfma_f32_16x16x32_bf16 v[152:155], v[112:115], v[184:187], v[152:155]
    v_mfma_f32_16x16x32_bf16 v[156:159], v[116:119], v[180:183], v[172:175]
    v_mfma_f32_16x16x32_bf16 v[156:159], v[120:123], v[184:187], v[156:159]
    v_mfma_f32_16x16x32_bf16 v[160:163], v[124:127], v[180:183], v[176:179]
    v_mfma_f32_16x16x32_bf16 v[160:163], v[128:131], v[184:187], v[160:163]
    v_mov_b32 v136, 0
    v_mov_b32 v137, 0
    v_mov_b32 v138, 0
    v_mov_b32 v139, 0
    s_lshr_b64 s[86:87], s[56:57], 2
    s_lshr_b64 s[36:37], s[56:57], 5
    s_or_b32 s36, s36, s86
    s_or_b32 s36, s36, s56
    s_cmp_lg_u64 s[84:85], 0
    s_cbranch_scc0 Lf_mid
    s_mul_i32 s66, s53, 800
    s_add_u32 s8, s8, s66
    s_addc_u32 s9, s9, 0
    s_mov_b32 s24, s8
    s_and_b32 s25, s9, 0xffff
    s_mov_b32 s26, 400
    s_mov_b32 s27, 0x20000
    s_movk_i32 s32, 400
    s_branch Ls_mid
L_fp:
    v_mfma_i32_16x16x64_i8 v[172:175], v[122:125], v[100:103], 0
    v_and_b32 v160, 0x800080, v100
    v_mul_u32_u24 v160, 0x7f, v160
    v_bitop3_b32 v131, v100, v160, v131 bitop3:0xbe
    v_and_b32 v161, 0x800080, v101
    v_mul_u32_u24 v161, 0x7f, v161
    v_bitop3_b32 v131, v101, v161, v131 bitop3:0xbe
    v_and_b32 v160, 0x800080, v102
    v_mul_u32_u24 v160, 0x7f, v160
    v_mov_b32_dpp v184, v172 row_shr:1 row_mask:0xf bank_mask:0xf bound_ctrl:0
    v_bitop3_b32 v131, v102, v160, v131 bitop3:0xbe
    s_nop 0
    v_add_u32_dpp v184, v184, v184 row_shr:1 row_mask:0xf bank_mask:0xf bound_ctrl:0
    v_and_b32 v161, 0x800080, v103
    s_nop 0
    v_add_u32_dpp v184, v184, v184 row_shr:2 row_mask:0xf bank_mask:0xf bound_ctrl:0
    v_mul_u32_u24 v161, 0x7f, v161
    s_nop 0
    v_add_u32_dpp v184, v184, v184 row_shr:4 row_mask:0xf bank_mask:0xf bound_ctrl:0
    v_bitop3_b32 v131, v103, v161, v131 bitop3:0xbe
    s_nop 0
    v_add_u32_dpp v184, v184, v184 row_shr:8 row_mask:0xf bank_mask:0xf bound_ctrl:0
    v_cmp_ne_u32 vcc, 0, v131
    v_readlane_b32 s68, v184, 6
    v_readlane_b32 s69, v173, 6
    v_readlane_b32 s70, v184, 15
    s_mov_b32 s94, 0
    s_cbranch_vccnz L_late
    s_add_u32 s66, s68, s69
    s_add_u32 s66, s66, s64
    s_add_u32 s67, s66, 15
    s_and_b32 s67, s67, -16
    s_add_u32 s55, s64, 16
    s_max_u32 s67, s67, s55
    s_sub_u32 s66, s67, s66
    v_mad_u32_u24 v184, v130, s66, v184
    s_sub_u32 s55, s64, 2048
    v_add_u32 v172, s55, v184
    v_add_u32 v173, s55, v184
    v_add_u32 v174, s55, v184
    v_add_u32 v175, s55, v184
    s_add_u32 s64, s64, s70
    s_add_u32 s64, s64, s66
    v_mfma_i32_16x16x64_i8 v[132:135], v[118:121], v[100:103], v[172:175]
    v_mfma_i32_16x16x64_i8 v[136:139], v[116:119], v[100:103], v[172:175]
    s_add_u32 s64, s64, 15
    s_and_b32 s64, s64, -16
    s_add_u32 s55, s67, 16
    s_max_u32 s64, s64, s55
    s_lshr_b32 s95, s67, 4
    s_bitset1_b64 s[56:57], s95
    s_lshr_b32 s95, s64, 4
    s_bitset1_b64 s[56:57], s95
    s_add_u32 s66, s52, 18512
    s_cmp_ge_u32 s64, s66
    ds_write_b8 v132, v126
    ds_write_b8_d16_hi v133, v126
    ds_write_b8 v134, v127
    ds_write_b8_d16_hi v135, v127
    ds_write_b8 v136, v128
    ds_write_b8_d16_hi v137, v128
    ds_write_b8 v138, v129
    ds_write_b8_d16_hi v139, v129
    s_cbranch_scc0 L_late
    s_mov_b32 s94, 1
    ds_read_u8 v148, v237 offset:0
    ds_read_u8 v149, v237 offset:8
    ds_read_u8 v150, v237 offset:16
    ds_read_u8 v151, v237 offset:24
    ds_read_u8 v152, v237 offset:32
    ds_read_u8 v153, v237 offset:40
    ds_read_u8 v154, v237 offset:48
    ds_read_u8 v155, v237 offset:56
    s_waitcnt lgkmcnt(0)
    s_add_u32 m0, s52, 0
    v_mov_b32 v230, v148
    v_mov_b32 v232, v149
    buffer_load_dwordx4 v[230:231], s[20:23], s35 idxen offen nt lds
    buffer_load_dwordx4 v[232:233], s[40:43], s35 idxen offen offset:1056 nt lds
    s_bitcmp0_b64 s[56:57], 2
    s_cbranch_scc1 L_noadve1
    s_add_u32 s35, s35, s31
    s_min_u32 s35, s35, 419404800
    s_xor_b32 s31, s31, 0x63ff800
    s_sub_u32 s60, s60, 1
L_noadve1:
    s_add_u32 m0, s52, 2080
    v_mov_b32 v230, v150
    v_mov_b32 v232, v151
    buffer_load_dwordx4 v[230:231], s[20:23], s35 idxen offen nt lds
    buffer_load_dwordx4 v[232:233], s[40:43], s35 idxen offen offset:1056 nt lds
    s_setpc_b64 s[62:63]
L_late:
    s_waitcnt vmcnt(0)
    s_setpc_b64 s[62:63]
L_swap:
    v_lshrrev_b32 v140, 3, v0
    v_and_b32 v141, 7, v0
    v_mul_u32_u24 v140, 20480, v140
    v_mul_u32_u24 v141, 20480, v141
    v_add_u32 v140, s51, v140
    v_add_u32 v141, s51, v141
    v_mov_b32 v143, 1
    s_mov_b64 exec, 1
    ds_add_rtn_u32 v143, v140, v143 offset:14880
    s_mov_b64 exec, -1
L_swap_poll:
    ds_read_b32 v142, v141 offset:14848
    ds_read_b128 v[144:147], v140 offset:14848
    v_and_b32 v248, 56, v0
    s_waitcnt lgkmcnt(0)
    v_cmp_le_i32 vcc, 0, v142
    v_cmp_gt_u32 s[86:87], v142, v144
    v_lshlrev_b32 v249, 1, v142
    v_readfirstlane_b32 s66, v143
    s_cbranch_vccnz L_swap_poll
    v_lshrrev_b64 v[246:247], v248, s[86:87]
    v_cmp_gt_i32 s[88:89], 0, v249
    v_and_b32 v246, 0xff, v246
    v_bcnt_u32_b32 v246, v246, 0
    v_cmp_eq_u32 vcc, s66, v246
    s_lshl_b32 s67, s54, 3
    s_ff1_i32_b64 s66, vcc
    s_cmp_lg_u64 s[88:89], 0
    s_cselect_b32 s66, s67, s66
    s_sub_u32 s95, s66, s50
    s_mov_b32 s50, s66
    s_sub_u32 s83, s66, s67
    v_readlane_b32 s67, v146, s66
    v_readlane_b32 s55, v147, s66
    v_readlane_b32 s66, v145, s66
    s_mul_i32 s81, s95, 2560
    s_mul_i32 s95, s95, 6400
    s_add_u32 s35, s35, s95
    s_sub_u32 s95, s66, s44
    v_add_u32 v237, s95, v237
    s_mov_b32 s44, s55
    s_sub_u32 s67, s67, s66
    s_sub_u32 s55, s55, s66
    s_sub_u32 s95, s55, s68
    s_lshr_b32 s67, s67, 4
    s_add_u32 s67, s67, s49
    s_bitset1_b64 s[56:57], s67
    s_lshr_b32 s55, s55, 4
    s_add_u32 s55, s55, s49
    s_bitset1_b64 s[56:57], s55
    s_lshr_b64 s[86:87], s[56:57], 2
    s_lshr_b64 s[36:37], s[56:57], 5
    s_or_b32 s36, s36, s86
    s_or_b32 s36, s36, s56
    s_ashr_i32 s95, s95, 3
    v_mov_b32 v140, s95
    s_sub_u32 s95, 0, s95
    v_writelane_b32 v140, s95, 1
    ds_add_u32 v2, v140
    s_cmp_eq_u32 s51, 0
    s_cselect_b32 s80, s81, s80
    s_cselect_b32 s82, s83, s82
    s_cselect_b32 s60, 1, 8
    s_cselect_b32 s66, 4, 2
    s_mov_b32 s68, s69
    s_mov_b32 s51, 16
    s_cmp_eq_u32 s61, s66
    s_cbranch_scc1 L_swap_now
    s_sub_u32 s66, s66, 1
    s_bitset1_b32 s33, s66
    s_setpc_b64 s[62:63]
L_swap_now:
    v_add_u32 v238, s81, v238
    v_add_u32 v239, s81, v239
    ds_read_u16 v224, v238 offset:0
    ds_read_u16 v225, v238 offset:8
    ds_read_u16 v226, v238 offset:64
    ds_read_u16 v227, v238 offset:72
    s_setpc_b64 s[62:63]
L_t23:
    s_cmp_eq_u32 s94, 0
    s_cbranch_scc1 L_skip23
    s_bitcmp0_b64 s[56:57], 3
    s_cbranch_scc1 L_noadve2
    s_add_u32 s35, s35, s31
    s_min_u32 s35, s35, 419404800
    s_xor_b32 s31, s31, 0x63ff800
    s_sub_u32 s60, s60, 1
L_noadve2:
    s_add_u32 m0, s52, 4160
    v_mov_b32 v230, v152
    v_mov_b32 v232, v153
    buffer_load_dwordx4 v[230:231], s[20:23], s35 idxen offen nt lds
    buffer_load_dwordx4 v[232:233], s[40:43], s35 idxen offen offset:1056 nt lds
    s_bitcmp0_b64 s[56:57], 4
    s_cbranch_scc1 L_noadve3
    s_add_u32 s35, s35, s31
    s_min_u32 s35, s35, 419404800
    s_xor_b32 s31, s31, 0x63ff800
    s_sub_u32 s60, s60, 1
L_noadve3:
    s_add_u32 m0, s52, 6240
    v_mov_b32 v230, v154
    v_mov_b32 v232, v155
    buffer_load_dwordx4 v[230:231], s[20:23], s35 idxen offen nt lds
    buffer_load_dwordx4 v[232:233], s[40:43], s35 idxen offen offset:1056 nt lds
    s_setpc_b64 s[62:63]
L_skip23:
    s_waitcnt vmcnt(0)
    s_setpc_b64 s[62:63]
.p2align 6
Lf_loop:
Lf_mid:
    s_bitcmp1_b32 s36, 0
    s_cbranch_scc1 Lf_ev0
Lf_evd0:
    v_mfma_f32_16x16x32_bf16 v[208:211], v[136:139], v[200:203], v[208:211]
    v_exp_f32 v132, v148
    v_exp_f32 v133, v149
    v_exp_f32 v134, v150
    v_exp_f32 v135, v151
    v_exp_f32 v136, v152
    v_exp_f32 v137, v153
    v_mfma_f32_4x4x4_16b_bf16 v[132:135], v[228:229], v[228:229], v[132:135]
    v_exp_f32 v138, v154
    v_exp_f32 v139, v155
    v_cvt_pk_bf16_f32 v208, v208, v209
    v_cvt_pk_bf16_f32 v209, v210, v211
    v_exp_f32 v140, v156
    v_exp_f32 v141, v157
    v_mfma_f32_4x4x4_16b_bf16 v[212:215], v[208:209], v[188:189], v[212:215] cbsz:4 abid:0
    v_mfma_f32_4x4x4_16b_bf16 v[136:139], v[228:229], v[228:229], v[136:139]
    v_exp_f32 v142, v158
    v_mfma_f32_4x4x4_16b_bf16 v[212:215], v[208:209], v[190:191], v[212:215] cbsz:4 abid:4
    v_exp_f32 v143, v159
    v_exp_f32 v144, v160
    v_mfma_f32_4x4x4_16b_bf16 v[212:215], v[208:209], v[192:193], v[212:215] cbsz:4 abid:8
    v_exp_f32 v145, v161
    v_mfma_f32_4x4x4_16b_bf16 v[140:143], v[228:229], v[228:229], v[140:143]
    v_mfma_f32_4x4x4_16b_bf16 v[212:215], v[208:209], v[194:195], v[212:215] cbsz:4 abid:12
    ds_add_rtn_u32 v1, v2, v3
    ds_read_u8 v230, v237 offset:64
    ds_read_u8 v232, v237 offset:72
    ds_read_b64_tr_b16 v[188:189], v236 offset:0
    ds_read_b64_tr_b16 v[190:191], v236 offset:512
    ds_read_b64_tr_b16 v[192:193], v236 offset:1056
    ds_read_b64_tr_b16 v[194:195], v236 offset:1568
    s_waitcnt vmcnt(4)
    ds_read_b128 v[180:183], v234 offset:2080
    ds_read_b128 v[184:187], v235 offset:2080
    s_add_u32 m0, s52, 0
    v_exp_f32 v146, v162
    v_exp_f32 v147, v163
    v_rcp_f32 v132, v132
    v_rcp_f32 v133, v133
    v_mfma_f32_4x4x4_16b_bf16 v[144:147], v[228:229], v[228:229], v[144:147]
    v_rcp_f32 v134, v134
    v_cvt_pk_bf16_f32 v132, v132, v133
    s_waitcnt lgkmcnt(2)
    buffer_load_dwordx4 v[230:231], s[20:23], s35 idxen offen nt lds
    buffer_load_dwordx4 v[232:233], s[40:43], s35 idxen offen offset:1056 nt lds
    s_waitcnt lgkmcnt(0)
    v_mfma_f32_16x16x32_bf16 v[148:151], v[100:103], v[180:183], v[164:167]
    v_rcp_f32 v135, v135
    v_mfma_f32_16x16x32_bf16 v[152:155], v[108:111], v[180:183], v[168:171]
    v_rcp_f32 v136, v136
    v_cvt_pk_bf16_f32 v133, v134, v135
    v_mfma_f32_16x16x32_bf16 v[148:151], v[104:107], v[184:187], v[148:151]
    v_rcp_f32 v137, v137
    v_readfirstlane_b32 s66, v1
    s_setprio 0
    s_cmp_gt_i32 s66, 0
    s_cbranch_scc0 Lf_lo0
    s_setprio 1
Lf_lo0:
    v_mfma_f32_16x16x32_bf16 v[152:155], v[112:115], v[184:187], v[152:155]
    v_rcp_f32 v138, v138
    v_cvt_pk_bf16_f32 v134, v136, v137
    v_mfma_f32_16x16x32_bf16 v[156:159], v[116:119], v[180:183], v[172:175]
    v_rcp_f32 v139, v139
    v_mfma_f32_16x16x32_bf16 v[160:163], v[124:127], v[180:183], v[176:179]
    v_rcp_f32 v140, v140
    v_cvt_pk_bf16_f32 v135, v138, v139
    v_mfma_f32_16x16x32_bf16 v[156:159], v[120:123], v[184:187], v[156:159]
    v_rcp_f32 v141, v141
    v_mfma_f32_16x16x32_bf16 v[160:163], v[128:131], v[184:187], v[160:163]
    v_rcp_f32 v142, v142
    v_cvt_pk_bf16_f32 v136, v140, v141
    v_mfma_f32_16x16x32_bf16 v[208:211], v[132:135], v[196:199], v[204:207]
    v_rcp_f32 v143, v143
    v_rcp_f32 v144, v144
    v_cvt_pk_bf16_f32 v137, v142, v143
    v_rcp_f32 v145, v145
    v_rcp_f32 v146, v146
    v_rcp_f32 v147, v147
    v_cvt_pk_bf16_f32 v138, v144, v145
    v_cvt_pk_bf16_f32 v139, v146, v147
    s_bitcmp1_b32 s36, 1
    s_cbranch_scc1 Lf_ev1
Lf_evd1:
    v_mfma_f32_16x16x32_bf16 v[208:211], v[136:139], v[200:203], v[208:211]
    v_exp_f32 v132, v148
    v_exp_f32 v133, v149
    v_exp_f32 v134, v150
    v_exp_f32 v135, v151
    v_exp_f32 v136, v152
    v_exp_f32 v137, v153
    v_mfma_f32_4x4x4_16b_bf16 v[132:135], v[228:229], v[228:229], v[132:135]
    v_exp_f32 v138, v154
    v_exp_f32 v139, v155
    v_cvt_pk_bf16_f32 v208, v208, v209
    v_cvt_pk_bf16_f32 v209, v210, v211
    v_exp_f32 v140, v156
    v_exp_f32 v141, v157
    v_mfma_f32_4x4x4_16b_bf16 v[212:215], v[208:209], v[188:189], v[212:215] cbsz:4 abid:0
    v_mfma_f32_4x4x4_16b_bf16 v[136:139], v[228:229], v[228:229], v[136:139]
    v_exp_f32 v142, v158
    v_mfma_f32_4x4x4_16b_bf16 v[212:215], v[208:209], v[190:191], v[212:215] cbsz:4 abid:4
    v_exp_f32 v143, v159
    v_exp_f32 v144, v160
    v_mfma_f32_4x4x4_16b_bf16 v[212:215], v[208:209], v[192:193], v[212:215] cbsz:4 abid:8
    v_exp_f32 v145, v161
    v_mfma_f32_4x4x4_16b_bf16 v[140:143], v[228:229], v[228:229], v[140:143]
    v_mfma_f32_4x4x4_16b_bf16 v[212:215], v[208:209], v[194:195], v[212:215] cbsz:4 abid:12
    ds_read_u8 v230, v237 offset:80
    ds_read_u8 v232, v237 offset:88
    ds_read_b64_tr_b16 v[188:189], v236 offset:2080
    ds_read_b64_tr_b16 v[190:191], v236 offset:2592
    ds_read_b64_tr_b16 v[192:193], v236 offset:3136
    ds_read_b64_tr_b16 v[194:195], v236 offset:3648
    s_waitcnt vmcnt(4)
    ds_read_b128 v[180:183], v234 offset:4160
    ds_read_b128 v[184:187], v235 offset:4160
    s_add_u32 m0, s52, 2080
    v_exp_f32 v146, v162
    v_exp_f32 v147, v163
    v_rcp_f32 v132, v132
    v_rcp_f32 v133, v133
    v_mfma_f32_4x4x4_16b_bf16 v[144:147], v[228:229], v[228:229], v[144:147]
    v_rcp_f32 v134, v134
    v_cvt_pk_bf16_f32 v132, v132, v133
    s_waitcnt lgkmcnt(2)
    buffer_load_dwordx4 v[230:231], s[20:23], s35 idxen offen nt lds
    buffer_load_dwordx4 v[232:233], s[40:43], s35 idxen offen offset:1056 nt lds
    s_waitcnt lgkmcnt(0)
    v_mfma_f32_16x16x32_bf16 v[148:151], v[100:103], v[180:183], v[164:167]
    v_rcp_f32 v135, v135
    v_mfma_f32_16x16x32_bf16 v[152:155], v[108:111], v[180:183], v[168:171]
    v_rcp_f32 v136, v136
    v_cvt_pk_bf16_f32 v133, v134, v135
    v_mfma_f32_16x16x32_bf16 v[148:151], v[104:107], v[184:187], v[148:151]
    v_rcp_f32 v137, v137
    v_mfma_f32_16x16x32_bf16 v[152:155], v[112:115], v[184:187], v[152:155]
    v_rcp_f32 v138, v138
    v_cvt_pk_bf16_f32 v134, v136, v137
    v_mfma_f32_16x16x32_bf16 v[156:159], v[116:119], v[180:183], v[172:175]
    v_rcp_f32 v139, v139
    v_mfma_f32_16x16x32_bf16 v[160:163], v[124:127], v[180:183], v[176:179]
    v_rcp_f32 v140, v140
    v_cvt_pk_bf16_f32 v135, v138, v139
    v_mfma_f32_16x16x32_bf16 v[156:159], v[120:123], v[184:187], v[156:159]
    v_rcp_f32 v141, v141
    v_mfma_f32_16x16x32_bf16 v[160:163], v[128:131], v[184:187], v[160:163]
    v_rcp_f32 v142, v142
    v_cvt_pk_bf16_f32 v136, v140, v141
    v_mfma_f32_16x16x32_bf16 v[208:211], v[132:135], v[196:199], v[204:207]
    v_rcp_f32 v143, v143
    v_rcp_f32 v144, v144
    v_cvt_pk_bf16_f32 v137, v142, v143
    v_rcp_f32 v145, v145
    v_rcp_f32 v146, v146
    v_rcp_f32 v147, v147
    v_cvt_pk_bf16_f32 v138, v144, v145
    v_cvt_pk_bf16_f32 v139, v146, v147
    s_bitcmp1_b32 s36, 2
    s_cbranch_scc1 Lf_ev2
Lf_evd2:
    v_mfma_f32_16x16x32_bf16 v[208:211], v[136:139], v[200:203], v[208:211]
    v_exp_f32 v132, v148
    v_exp_f32 v133, v149
    v_exp_f32 v134, v150
    v_exp_f32 v135, v151
    v_exp_f32 v136, v152
    v_exp_f32 v137, v153
    v_mfma_f32_4x4x4_16b_bf16 v[132:135], v[228:229], v[228:229], v[132:135]
    v_exp_f32 v138, v154
    v_exp_f32 v139, v155
    v_cvt_pk_bf16_f32 v208, v208, v209
    v_cvt_pk_bf16_f32 v209, v210, v211
    v_exp_f32 v140, v156
    v_exp_f32 v141, v157
    v_mfma_f32_4x4x4_16b_bf16 v[212:215], v[208:209], v[188:189], v[212:215] cbsz:4 abid:0
    v_mfma_f32_4x4x4_16b_bf16 v[136:139], v[228:229], v[228:229], v[136:139]
    v_exp_f32 v142, v158
    v_mfma_f32_4x4x4_16b_bf16 v[212:215], v[208:209], v[190:191], v[212:215] cbsz:4 abid:4
    v_exp_f32 v143, v159
    v_exp_f32 v144, v160
    v_mfma_f32_4x4x4_16b_bf16 v[212:215], v[208:209], v[192:193], v[212:215] cbsz:4 abid:8
    v_exp_f32 v145, v161
    v_mfma_f32_4x4x4_16b_bf16 v[140:143], v[228:229], v[228:229], v[140:143]
    v_mfma_f32_4x4x4_16b_bf16 v[212:215], v[208:209], v[194:195], v[212:215] cbsz:4 abid:12
    ds_read_u8 v230, v237 offset:96
    ds_read_u8 v232, v237 offset:104
    ds_read_b64_tr_b16 v[188:189], v236 offset:4160
    ds_read_b64_tr_b16 v[190:191], v236 offset:4672
    ds_read_b64_tr_b16 v[192:193], v236 offset:5216
    ds_read_b64_tr_b16 v[194:195], v236 offset:5728
    s_waitcnt vmcnt(4)
    ds_read_b128 v[180:183], v234 offset:6240
    ds_read_b128 v[184:187], v235 offset:6240
    s_add_u32 m0, s52, 4160
    v_exp_f32 v146, v162
    v_exp_f32 v147, v163
    v_rcp_f32 v132, v132
    v_rcp_f32 v133, v133
    v_mfma_f32_4x4x4_16b_bf16 v[144:147], v[228:229], v[228:229], v[144:147]
    v_rcp_f32 v134, v134
    v_cvt_pk_bf16_f32 v132, v132, v133
    s_waitcnt lgkmcnt(2)
    buffer_load_dwordx4 v[230:231], s[20:23], s35 idxen offen nt lds
    buffer_load_dwordx4 v[232:233], s[40:43], s35 idxen offen offset:1056 nt lds
    s_waitcnt lgkmcnt(0)
    v_mfma_f32_16x16x32_bf16 v[148:151], v[100:103], v[180:183], v[164:167]
    v_rcp_f32 v135, v135
    v_mfma_f32_16x16x32_bf16 v[152:155], v[108:111], v[180:183], v[168:171]
    v_rcp_f32 v136, v136
    v_cvt_pk_bf16_f32 v133, v134, v135
    v_mfma_f32_16x16x32_bf16 v[148:151], v[104:107], v[184:187], v[148:151]
    v_rcp_f32 v137, v137
    v_mfma_f32_16x16x32_bf16 v[152:155], v[112:115], v[184:187], v[152:155]
    v_rcp_f32 v138, v138
    v_cvt_pk_bf16_f32 v134, v136, v137
    v_mfma_f32_16x16x32_bf16 v[156:159], v[116:119], v[180:183], v[172:175]
    v_rcp_f32 v139, v139
    v_mfma_f32_16x16x32_bf16 v[160:163], v[124:127], v[180:183], v[176:179]
    v_rcp_f32 v140, v140
    v_cvt_pk_bf16_f32 v135, v138, v139
    v_mfma_f32_16x16x32_bf16 v[156:159], v[120:123], v[184:187], v[156:159]
    v_rcp_f32 v141, v141
    v_mfma_f32_16x16x32_bf16 v[160:163], v[128:131], v[184:187], v[160:163]
    v_rcp_f32 v142, v142
    v_cvt_pk_bf16_f32 v136, v140, v141
    v_mfma_f32_16x16x32_bf16 v[208:211], v[132:135], v[196:199], v[204:207]
    v_rcp_f32 v143, v143
    v_rcp_f32 v144, v144
    v_cvt_pk_bf16_f32 v137, v142, v143
    v_rcp_f32 v145, v145
    v_rcp_f32 v146, v146
    v_rcp_f32 v147, v147
    v_cvt_pk_bf16_f32 v138, v144, v145
    v_cvt_pk_bf16_f32 v139, v146, v147
    s_bitcmp1_b32 s36, 3
    s_cbranch_scc1 Lf_ev3
Lf_evd3:
    v_mfma_f32_16x16x32_bf16 v[208:211], v[136:139], v[200:203], v[208:211]
    v_exp_f32 v132, v148
    v_exp_f32 v133, v149
    v_exp_f32 v134, v150
    v_exp_f32 v135, v151
    v_exp_f32 v136, v152
    v_exp_f32 v137, v153
    v_mfma_f32_4x4x4_16b_bf16 v[132:135], v[228:229], v[228:229], v[132:135]
    v_exp_f32 v138, v154
    v_exp_f32 v139, v155
    v_cvt_pk_bf16_f32 v208, v208, v209
    v_cvt_pk_bf16_f32 v209, v210, v211
    v_exp_f32 v140, v156
    v_exp_f32 v141, v157
    v_mfma_f32_4x4x4_16b_bf16 v[212:215], v[208:209], v[188:189], v[212:215] cbsz:4 abid:0
    v_mfma_f32_4x4x4_16b_bf16 v[136:139], v[228:229], v[228:229], v[136:139]
    v_exp_f32 v142, v158
    v_mfma_f32_4x4x4_16b_bf16 v[212:215], v[208:209], v[190:191], v[212:215] cbsz:4 abid:4
    v_exp_f32 v143, v159
    v_exp_f32 v144, v160
    v_mfma_f32_4x4x4_16b_bf16 v[212:215], v[208:209], v[192:193], v[212:215] cbsz:4 abid:8
    v_exp_f32 v145, v161
    v_mfma_f32_4x4x4_16b_bf16 v[140:143], v[228:229], v[228:229], v[140:143]
    v_mfma_f32_4x4x4_16b_bf16 v[212:215], v[208:209], v[194:195], v[212:215] cbsz:4 abid:12
    ds_read_u8 v230, v237 offset:112
    ds_read_u8 v232, v237 offset:120
    ds_read_b64_tr_b16 v[188:189], v236 offset:6240
    ds_read_b64_tr_b16 v[190:191], v236 offset:6752
    ds_read_b64_tr_b16 v[192:193], v236 offset:7296
    ds_read_b64_tr_b16 v[194:195], v236 offset:7808
    s_waitcnt vmcnt(4)
    ds_read_b128 v[180:183], v234 offset:0
    ds_read_b128 v[184:187], v235 offset:0
    s_add_u32 m0, s52, 6240
    v_exp_f32 v146, v162
    v_exp_f32 v147, v163
    v_rcp_f32 v132, v132
    v_rcp_f32 v133, v133
    v_mfma_f32_4x4x4_16b_bf16 v[144:147], v[228:229], v[228:229], v[144:147]
    v_rcp_f32 v134, v134
    v_cvt_pk_bf16_f32 v132, v132, v133
    s_waitcnt lgkmcnt(2)
    buffer_load_dwordx4 v[230:231], s[20:23], s35 idxen offen nt lds
    buffer_load_dwordx4 v[232:233], s[40:43], s35 idxen offen offset:1056 nt lds
    s_waitcnt lgkmcnt(0)
    v_mfma_f32_16x16x32_bf16 v[148:151], v[100:103], v[180:183], v[164:167]
    v_rcp_f32 v135, v135
    v_mfma_f32_16x16x32_bf16 v[152:155], v[108:111], v[180:183], v[168:171]
    v_rcp_f32 v136, v136
    v_cvt_pk_bf16_f32 v133, v134, v135
    v_mfma_f32_16x16x32_bf16 v[148:151], v[104:107], v[184:187], v[148:151]
    v_rcp_f32 v137, v137
    v_mfma_f32_16x16x32_bf16 v[152:155], v[112:115], v[184:187], v[152:155]
    v_rcp_f32 v138, v138
    v_cvt_pk_bf16_f32 v134, v136, v137
    v_mfma_f32_16x16x32_bf16 v[156:159], v[116:119], v[180:183], v[172:175]
    v_rcp_f32 v139, v139
    v_mfma_f32_16x16x32_bf16 v[160:163], v[124:127], v[180:183], v[176:179]
    v_rcp_f32 v140, v140
    v_cvt_pk_bf16_f32 v135, v138, v139
    v_mfma_f32_16x16x32_bf16 v[156:159], v[120:123], v[184:187], v[156:159]
    v_rcp_f32 v141, v141
    v_mfma_f32_16x16x32_bf16 v[160:163], v[128:131], v[184:187], v[160:163]
    v_rcp_f32 v142, v142
    v_cvt_pk_bf16_f32 v136, v140, v141
    v_mfma_f32_16x16x32_bf16 v[208:211], v[132:135], v[196:199], v[204:207]
    v_rcp_f32 v143, v143
    v_rcp_f32 v144, v144
    v_cvt_pk_bf16_f32 v137, v142, v143
    s_lshr_b64 s[56:57], s[56:57], 4
    s_lshr_b64 s[86:87], s[56:57], 2
    s_lshr_b64 s[36:37], s[56:57], 5
    s_or_b32 s36, s36, s86
    s_or_b32 s36, s36, s56
    v_add_u32 v237, 64, v237
    v_rcp_f32 v145, v145
    v_rcp_f32 v146, v146
    v_rcp_f32 v147, v147
    v_cvt_pk_bf16_f32 v138, v144, v145
    v_cvt_pk_bf16_f32 v139, v146, v147
    s_branch Lf_loop
Lf_ev0:
    s_bitcmp0_b64 s[56:57], 0
    s_cbranch_scc1 Lf_nf0
    v_cvt_pk_bf16_f32 v246, v212, v212
    v_mov_b32 v212, 0
    ds_write_b16 v240, v246
    v_add_u32 v240, 128, v240
Lf_nf0:
    s_bitcmp0_b64 s[56:57], 5
    s_cbranch_scc1 Lf_na0
    s_sub_u32 s60, s60, 1
    s_cbranch_scc0 Lf_ns0
    s_mov_b32 s49, 5
    s_call_b64 s[62:63], L_swap
    s_add_u32 s35, s35, s31
    s_min_u32 s35, s35, 419404800
    s_xor_b32 s31, s31, 0x63ff800
    s_bitcmp0_b64 s[56:57], 2
    s_cbranch_scc1 Lf_evd0
    s_waitcnt lgkmcnt(0)
    s_branch Lf_e10
Lf_ns0:
    s_add_u32 s35, s35, s31
    s_min_u32 s35, s35, 419404800
    s_xor_b32 s31, s31, 0x63ff800
Lf_na0:
    s_bitcmp0_b64 s[56:57], 2
    s_cbranch_scc1 Lf_evd0
Lf_e10:
    s_sub_u32 s61, s61, 1
    s_cbranch_scc1 Lf_last0
    s_bitcmp0_b32 s33, s61
    s_cbranch_scc1 Lf_nw0
    s_cmp_eq_u32 s61, 3
    s_cselect_b32 s66, s80, s81
    v_add_u32 v238, s66, v238
    v_add_u32 v239, s66, v239
    ds_read_u16 v224, v238 offset:0
    ds_read_u16 v225, v238 offset:8
    ds_read_u16 v226, v238 offset:64
    ds_read_u16 v227, v238 offset:72
    s_waitcnt lgkmcnt(0)
Lf_nw0:
    v_mul_u32_u24 v216, v224, v241
    v_mul_u32_u24 v217, v224, v242
    v_mul_u32_u24 v218, v225, v241
    v_mul_u32_u24 v219, v225, v242
    v_mul_u32_u24 v220, v226, v241
    v_mul_u32_u24 v221, v226, v242
    v_mul_u32_u24 v222, v227, v241
    v_mul_u32_u24 v223, v227, v242
    v_mfma_f32_4x4x4_16b_bf16 v[140:143], v[216:217], v[68:69], v[4:7]
    v_add_u32 v238, 128, v238
    ds_read_b128 v[164:167], v239 offset:0
    ds_read_b128 v[168:171], v239 offset:64
    v_mfma_f32_4x4x4_16b_bf16 v[144:147], v[218:219], v[70:71], v[8:11]
    ds_read_b128 v[172:175], v239 offset:128
    ds_read_b128 v[176:179], v239 offset:192
    ds_read_u16 v224, v238 offset:0
    ds_read_u16 v225, v238 offset:8
    ds_read_u16 v226, v238 offset:64
    ds_read_u16 v227, v238 offset:72
    v_mfma_f32_4x4x4_16b_bf16 v[246:249], v[220:221], v[72:73], v[12:15]
    v_cvt_pk_bf16_f32 v100, v140, v141
    v_cvt_pk_bf16_f32 v101, v142, v143
    v_mfma_f32_4x4x4_16b_bf16 v[250:253], v[222:223], v[74:75], v[16:19]
    v_cvt_pk_bf16_f32 v102, v144, v145
    v_cvt_pk_bf16_f32 v103, v146, v147
    v_mfma_f32_4x4x4_16b_bf16 v[140:143], v[216:217], v[76:77], v[20:23]
    v_cvt_pk_bf16_f32 v104, v246, v247
    v_cvt_pk_bf16_f32 v105, v248, v249
    v_mfma_f32_4x4x4_16b_bf16 v[144:147], v[218:219], v[78:79], v[24:27]
    v_cvt_pk_bf16_f32 v106, v250, v251
    v_cvt_pk_bf16_f32 v107, v252, v253
    v_mfma_f32_4x4x4_16b_bf16 v[246:249], v[220:221], v[80:81], v[28:31]
    v_cvt_pk_bf16_f32 v108, v140, v141
    v_cvt_pk_bf16_f32 v109, v142, v143
    v_mfma_f32_4x4x4_16b_bf16 v[250:253], v[222:223], v[82:83], v[32:35]
    v_cvt_pk_bf16_f32 v110, v144, v145
    v_cvt_pk_bf16_f32 v111, v146, v147
    v_mfma_f32_4x4x4_16b_bf16 v[140:143], v[216:217], v[84:85], v[36:39]
    v_cvt_pk_bf16_f32 v112, v246, v247
    v_cvt_pk_bf16_f32 v113, v248, v249
    v_mfma_f32_4x4x4_16b_bf16 v[144:147], v[218:219], v[86:87], v[40:43]
    v_cvt_pk_bf16_f32 v114, v250, v251
    v_cvt_pk_bf16_f32 v115, v252, v253
    v_mfma_f32_4x4x4_16b_bf16 v[246:249], v[220:221], v[88:89], v[44:47]
    v_cvt_pk_bf16_f32 v116, v140, v141
    v_cvt_pk_bf16_f32 v117, v142, v143
    v_mfma_f32_4x4x4_16b_bf16 v[250:253], v[222:223], v[90:91], v[48:51]
    v_cvt_pk_bf16_f32 v118, v144, v145
    v_cvt_pk_bf16_f32 v119, v146, v147
    v_mfma_f32_4x4x4_16b_bf16 v[140:143], v[216:217], v[92:93], v[52:55]
    v_cvt_pk_bf16_f32 v120, v246, v247
    v_cvt_pk_bf16_f32 v121, v248, v249
    v_mfma_f32_4x4x4_16b_bf16 v[144:147], v[218:219], v[94:95], v[56:59]
    v_cvt_pk_bf16_f32 v122, v250, v251
    v_cvt_pk_bf16_f32 v123, v252, v253
    v_mfma_f32_4x4x4_16b_bf16 v[246:249], v[220:221], v[96:97], v[60:63]
    v_cvt_pk_bf16_f32 v124, v140, v141
    v_cvt_pk_bf16_f32 v125, v142, v143
    v_mfma_f32_4x4x4_16b_bf16 v[250:253], v[222:223], v[98:99], v[64:67]
    v_cvt_pk_bf16_f32 v126, v144, v145
    v_cvt_pk_bf16_f32 v127, v146, v147
    v_cvt_pk_bf16_f32 v128, v246, v247
    v_cvt_pk_bf16_f32 v129, v248, v249
    v_add_u32 v239, 272, v239
    v_cvt_pk_bf16_f32 v130, v250, v251
    v_cvt_pk_bf16_f32 v131, v252, v253
    s_waitcnt lgkmcnt(0)
    s_branch Lf_evd0
Lf_ev1:
    s_bitcmp0_b64 s[56:57], 1
    s_cbranch_scc1 Lf_nf1
    v_cvt_pk_bf16_f32 v246, v212, v212
    v_mov_b32 v212, 0
    ds_write_b16 v240, v246
    v_add_u32 v240, 128, v240
Lf_nf1:
    s_bitcmp0_b64 s[56:57], 6
    s_cbranch_scc1 Lf_na1
    s_sub_u32 s60, s60, 1
    s_cbranch_scc0 Lf_ns1
    s_mov_b32 s49, 6
    s_call_b64 s[62:63], L_swap
    s_add_u32 s35, s35, s31
    s_min_u32 s35, s35, 419404800
    s_xor_b32 s31, s31, 0x63ff800
    s_bitcmp0_b64 s[56:57], 3
    s_cbranch_scc1 Lf_evd1
    s_waitcnt lgkmcnt(0)
    s_branch Lf_e11
Lf_ns1:
    s_add_u32 s35, s35, s31
    s_min_u32 s35, s35, 419404800
    s_xor_b32 s31, s31, 0x63ff800
Lf_na1:
    s_bitcmp0_b64 s[56:57], 3
    s_cbranch_scc1 Lf_evd1
Lf_e11:
    s_sub_u32 s61, s61, 1
    s_cbranch_scc1 Lf_last1
    s_bitcmp0_b32 s33, s61
    s_cbranch_scc1 Lf_nw1
    s_cmp_eq_u32 s61, 3
    s_cselect_b32 s66, s80, s81
    v_add_u32 v238, s66, v238
    v_add_u32 v239, s66, v239
    ds_read_u16 v224, v238 offset:0
    ds_read_u16 v225, v238 offset:8
    ds_read_u16 v226, v238 offset:64
    ds_read_u16 v227, v238 offset:72
    s_waitcnt lgkmcnt(0)
Lf_nw1:
    v_mul_u32_u24 v216, v224, v241
    v_mul_u32_u24 v217, v224, v242
    v_mul_u32_u24 v218, v225, v241
    v_mul_u32_u24 v219, v225, v242
    v_mul_u32_u24 v220, v226, v241
    v_mul_u32_u24 v221, v226, v242
    v_mul_u32_u24 v222, v227, v241
    v_mul_u32_u24 v223, v227, v242
    v_mfma_f32_4x4x4_16b_bf16 v[140:143], v[216:217], v[68:69], v[4:7]
    v_add_u32 v238, 128, v238
    ds_read_b128 v[164:167], v239 offset:0
    ds_read_b128 v[168:171], v239 offset:64
    v_mfma_f32_4x4x4_16b_bf16 v[144:147], v[218:219], v[70:71], v[8:11]
    ds_read_b128 v[172:175], v239 offset:128
    ds_read_b128 v[176:179], v239 offset:192
    ds_read_u16 v224, v238 offset:0
    ds_read_u16 v225, v238 offset:8
    ds_read_u16 v226, v238 offset:64
    ds_read_u16 v227, v238 offset:72
    v_mfma_f32_4x4x4_16b_bf16 v[246:249], v[220:221], v[72:73], v[12:15]
    v_cvt_pk_bf16_f32 v100, v140, v141
    v_cvt_pk_bf16_f32 v101, v142, v143
    v_mfma_f32_4x4x4_16b_bf16 v[250:253], v[222:223], v[74:75], v[16:19]
    v_cvt_pk_bf16_f32 v102, v144, v145
    v_cvt_pk_bf16_f32 v103, v146, v147
    v_mfma_f32_4x4x4_16b_bf16 v[140:143], v[216:217], v[76:77], v[20:23]
    v_cvt_pk_bf16_f32 v104, v246, v247
    v_cvt_pk_bf16_f32 v105, v248, v249
    v_mfma_f32_4x4x4_16b_bf16 v[144:147], v[218:219], v[78:79], v[24:27]
    v_cvt_pk_bf16_f32 v106, v250, v251
    v_cvt_pk_bf16_f32 v107, v252, v253
    v_mfma_f32_4x4x4_16b_bf16 v[246:249], v[220:221], v[80:81], v[28:31]
    v_cvt_pk_bf16_f32 v108, v140, v141
    v_cvt_pk_bf16_f32 v109, v142, v143
    v_mfma_f32_4x4x4_16b_bf16 v[250:253], v[222:223], v[82:83], v[32:35]
    v_cvt_pk_bf16_f32 v110, v144, v145
    v_cvt_pk_bf16_f32 v111, v146, v147
    v_mfma_f32_4x4x4_16b_bf16 v[140:143], v[216:217], v[84:85], v[36:39]
    v_cvt_pk_bf16_f32 v112, v246, v247
    v_cvt_pk_bf16_f32 v113, v248, v249
    v_mfma_f32_4x4x4_16b_bf16 v[144:147], v[218:219], v[86:87], v[40:43]
    v_cvt_pk_bf16_f32 v114, v250, v251
    v_cvt_pk_bf16_f32 v115, v252, v253
    v_mfma_f32_4x4x4_16b_bf16 v[246:249], v[220:221], v[88:89], v[44:47]
    v_cvt_pk_bf16_f32 v116, v140, v141
    v_cvt_pk_bf16_f32 v117, v142, v143
    v_mfma_f32_4x4x4_16b_bf16 v[250:253], v[222:223], v[90:91], v[48:51]
    v_cvt_pk_bf16_f32 v118, v144, v145
    v_cvt_pk_bf16_f32 v119, v146, v147
    v_mfma_f32_4x4x4_16b_bf16 v[140:143], v[216:217], v[92:93], v[52:55]
    v_cvt_pk_bf16_f32 v120, v246, v247
    v_cvt_pk_bf16_f32 v121, v248, v249
    v_mfma_f32_4x4x4_16b_bf16 v[144:147], v[218:219], v[94:95], v[56:59]
    v_cvt_pk_bf16_f32 v122, v250, v251
    v_cvt_pk_bf16_f32 v123, v252, v253
    v_mfma_f32_4x4x4_16b_bf16 v[246:249], v[220:221], v[96:97], v[60:63]
    v_cvt_pk_bf16_f32 v124, v140, v141
    v_cvt_pk_bf16_f32 v125, v142, v143
    v_mfma_f32_4x4x4_16b_bf16 v[250:253], v[222:223], v[98:99], v[64:67]
    v_cvt_pk_bf16_f32 v126, v144, v145
    v_cvt_pk_bf16_f32 v127, v146, v147
    v_cvt_pk_bf16_f32 v128, v246, v247
    v_cvt_pk_bf16_f32 v129, v248, v249
    v_add_u32 v239, 272, v239
    v_cvt_pk_bf16_f32 v130, v250, v251
    v_cvt_pk_bf16_f32 v131, v252, v253
    s_waitcnt lgkmcnt(0)
    s_branch Lf_evd1
Lf_ev2:
    s_bitcmp0_b64 s[56:57], 2
    s_cbranch_scc1 Lf_nf2
    v_cvt_pk_bf16_f32 v246, v212, v212
    v_mov_b32 v212, 0
    ds_write_b16 v240, v246
    v_add_u32 v240, 128, v240
Lf_nf2:
    s_bitcmp0_b64 s[56:57], 7
    s_cbranch_scc1 Lf_na2
    s_sub_u32 s60, s60, 1
    s_cbranch_scc0 Lf_ns2
    s_mov_b32 s49, 7
    s_call_b64 s[62:63], L_swap
    s_add_u32 s35, s35, s31
    s_min_u32 s35, s35, 419404800
    s_xor_b32 s31, s31, 0x63ff800
    s_bitcmp0_b64 s[56:57], 4
    s_cbranch_scc1 Lf_evd2
    s_waitcnt lgkmcnt(0)
    s_branch Lf_e12
Lf_ns2:
    s_add_u32 s35, s35, s31
    s_min_u32 s35, s35, 419404800
    s_xor_b32 s31, s31, 0x63ff800
Lf_na2:
    s_bitcmp0_b64 s[56:57], 4
    s_cbranch_scc1 Lf_evd2
Lf_e12:
    s_sub_u32 s61, s61, 1
    s_cbranch_scc1 Lf_last2
    s_bitcmp0_b32 s33, s61
    s_cbranch_scc1 Lf_nw2
    s_cmp_eq_u32 s61, 3
    s_cselect_b32 s66, s80, s81
    v_add_u32 v238, s66, v238
    v_add_u32 v239, s66, v239
    ds_read_u16 v224, v238 offset:0
    ds_read_u16 v225, v238 offset:8
    ds_read_u16 v226, v238 offset:64
    ds_read_u16 v227, v238 offset:72
    s_waitcnt lgkmcnt(0)
Lf_nw2:
    v_mul_u32_u24 v216, v224, v241
    v_mul_u32_u24 v217, v224, v242
    v_mul_u32_u24 v218, v225, v241
    v_mul_u32_u24 v219, v225, v242
    v_mul_u32_u24 v220, v226, v241
    v_mul_u32_u24 v221, v226, v242
    v_mul_u32_u24 v222, v227, v241
    v_mul_u32_u24 v223, v227, v242
    v_mfma_f32_4x4x4_16b_bf16 v[140:143], v[216:217], v[68:69], v[4:7]
    v_add_u32 v238, 128, v238
    ds_read_b128 v[164:167], v239 offset:0
    ds_read_b128 v[168:171], v239 offset:64
    v_mfma_f32_4x4x4_16b_bf16 v[144:147], v[218:219], v[70:71], v[8:11]
    ds_read_b128 v[172:175], v239 offset:128
    ds_read_b128 v[176:179], v239 offset:192
    ds_read_u16 v224, v238 offset:0
    ds_read_u16 v225, v238 offset:8
    ds_read_u16 v226, v238 offset:64
    ds_read_u16 v227, v238 offset:72
    v_mfma_f32_4x4x4_16b_bf16 v[246:249], v[220:221], v[72:73], v[12:15]
    v_cvt_pk_bf16_f32 v100, v140, v141
    v_cvt_pk_bf16_f32 v101, v142, v143
    v_mfma_f32_4x4x4_16b_bf16 v[250:253], v[222:223], v[74:75], v[16:19]
    v_cvt_pk_bf16_f32 v102, v144, v145
    v_cvt_pk_bf16_f32 v103, v146, v147
    v_mfma_f32_4x4x4_16b_bf16 v[140:143], v[216:217], v[76:77], v[20:23]
    v_cvt_pk_bf16_f32 v104, v246, v247
    v_cvt_pk_bf16_f32 v105, v248, v249
    v_mfma_f32_4x4x4_16b_bf16 v[144:147], v[218:219], v[78:79], v[24:27]
    v_cvt_pk_bf16_f32 v106, v250, v251
    v_cvt_pk_bf16_f32 v107, v252, v253
    v_mfma_f32_4x4x4_16b_bf16 v[246:249], v[220:221], v[80:81], v[28:31]
    v_cvt_pk_bf16_f32 v108, v140, v141
    v_cvt_pk_bf16_f32 v109, v142, v143
    v_mfma_f32_4x4x4_16b_bf16 v[250:253], v[222:223], v[82:83], v[32:35]
    v_cvt_pk_bf16_f32 v110, v144, v145
    v_cvt_pk_bf16_f32 v111, v146, v147
    v_mfma_f32_4x4x4_16b_bf16 v[140:143], v[216:217], v[84:85], v[36:39]
    v_cvt_pk_bf16_f32 v112, v246, v247
    v_cvt_pk_bf16_f32 v113, v248, v249
    v_mfma_f32_4x4x4_16b_bf16 v[144:147], v[218:219], v[86:87], v[40:43]
    v_cvt_pk_bf16_f32 v114, v250, v251
    v_cvt_pk_bf16_f32 v115, v252, v253
    v_mfma_f32_4x4x4_16b_bf16 v[246:249], v[220:221], v[88:89], v[44:47]
    v_cvt_pk_bf16_f32 v116, v140, v141
    v_cvt_pk_bf16_f32 v117, v142, v143
    v_mfma_f32_4x4x4_16b_bf16 v[250:253], v[222:223], v[90:91], v[48:51]
    v_cvt_pk_bf16_f32 v118, v144, v145
    v_cvt_pk_bf16_f32 v119, v146, v147
    v_mfma_f32_4x4x4_16b_bf16 v[140:143], v[216:217], v[92:93], v[52:55]
    v_cvt_pk_bf16_f32 v120, v246, v247
    v_cvt_pk_bf16_f32 v121, v248, v249
    v_mfma_f32_4x4x4_16b_bf16 v[144:147], v[218:219], v[94:95], v[56:59]
    v_cvt_pk_bf16_f32 v122, v250, v251
    v_cvt_pk_bf16_f32 v123, v252, v253
    v_mfma_f32_4x4x4_16b_bf16 v[246:249], v[220:221], v[96:97], v[60:63]
    v_cvt_pk_bf16_f32 v124, v140, v141
    v_cvt_pk_bf16_f32 v125, v142, v143
    v_mfma_f32_4x4x4_16b_bf16 v[250:253], v[222:223], v[98:99], v[64:67]
    v_cvt_pk_bf16_f32 v126, v144, v145
    v_cvt_pk_bf16_f32 v127, v146, v147
    v_cvt_pk_bf16_f32 v128, v246, v247
    v_cvt_pk_bf16_f32 v129, v248, v249
    v_add_u32 v239, 272, v239
    v_cvt_pk_bf16_f32 v130, v250, v251
    v_cvt_pk_bf16_f32 v131, v252, v253
    s_waitcnt lgkmcnt(0)
    s_branch Lf_evd2
Lf_ev3:
    s_bitcmp0_b64 s[56:57], 3
    s_cbranch_scc1 Lf_nf3
    v_cvt_pk_bf16_f32 v246, v212, v212
    v_mov_b32 v212, 0
    ds_write_b16 v240, v246
    v_add_u32 v240, 128, v240
Lf_nf3:
    s_bitcmp0_b64 s[56:57], 8
    s_cbranch_scc1 Lf_na3
    s_sub_u32 s60, s60, 1
    s_cbranch_scc0 Lf_ns3
    s_mov_b32 s49, 8
    s_call_b64 s[62:63], L_swap
    s_add_u32 s35, s35, s31
    s_min_u32 s35, s35, 419404800
    s_xor_b32 s31, s31, 0x63ff800
    s_bitcmp0_b64 s[56:57], 5
    s_cbranch_scc1 Lf_evd3
    s_waitcnt lgkmcnt(0)
    s_branch Lf_e13
Lf_ns3:
    s_add_u32 s35, s35, s31
    s_min_u32 s35, s35, 419404800
    s_xor_b32 s31, s31, 0x63ff800
Lf_na3:
    s_bitcmp0_b64 s[56:57], 5
    s_cbranch_scc1 Lf_evd3
Lf_e13:
    s_sub_u32 s61, s61, 1
    s_cbranch_scc1 Lf_last3
    s_bitcmp0_b32 s33, s61
    s_cbranch_scc1 Lf_nw3
    s_cmp_eq_u32 s61, 3
    s_cselect_b32 s66, s80, s81
    v_add_u32 v238, s66, v238
    v_add_u32 v239, s66, v239
    ds_read_u16 v224, v238 offset:0
    ds_read_u16 v225, v238 offset:8
    ds_read_u16 v226, v238 offset:64
    ds_read_u16 v227, v238 offset:72
    s_waitcnt lgkmcnt(0)
Lf_nw3:
    v_mul_u32_u24 v216, v224, v241
    v_mul_u32_u24 v217, v224, v242
    v_mul_u32_u24 v218, v225, v241
    v_mul_u32_u24 v219, v225, v242
    v_mul_u32_u24 v220, v226, v241
    v_mul_u32_u24 v221, v226, v242
    v_mul_u32_u24 v222, v227, v241
    v_mul_u32_u24 v223, v227, v242
    v_mfma_f32_4x4x4_16b_bf16 v[140:143], v[216:217], v[68:69], v[4:7]
    v_add_u32 v238, 128, v238
    ds_read_b128 v[164:167], v239 offset:0
    ds_read_b128 v[168:171], v239 offset:64
    v_mfma_f32_4x4x4_16b_bf16 v[144:147], v[218:219], v[70:71], v[8:11]
    ds_read_b128 v[172:175], v239 offset:128
    ds_read_b128 v[176:179], v239 offset:192
    ds_read_u16 v224, v238 offset:0
    ds_read_u16 v225, v238 offset:8
    ds_read_u16 v226, v238 offset:64
    ds_read_u16 v227, v238 offset:72
    v_mfma_f32_4x4x4_16b_bf16 v[246:249], v[220:221], v[72:73], v[12:15]
    v_cvt_pk_bf16_f32 v100, v140, v141
    v_cvt_pk_bf16_f32 v101, v142, v143
    v_mfma_f32_4x4x4_16b_bf16 v[250:253], v[222:223], v[74:75], v[16:19]
    v_cvt_pk_bf16_f32 v102, v144, v145
    v_cvt_pk_bf16_f32 v103, v146, v147
    v_mfma_f32_4x4x4_16b_bf16 v[140:143], v[216:217], v[76:77], v[20:23]
    v_cvt_pk_bf16_f32 v104, v246, v247
    v_cvt_pk_bf16_f32 v105, v248, v249
    v_mfma_f32_4x4x4_16b_bf16 v[144:147], v[218:219], v[78:79], v[24:27]
    v_cvt_pk_bf16_f32 v106, v250, v251
    v_cvt_pk_bf16_f32 v107, v252, v253
    v_mfma_f32_4x4x4_16b_bf16 v[246:249], v[220:221], v[80:81], v[28:31]
    v_cvt_pk_bf16_f32 v108, v140, v141
    v_cvt_pk_bf16_f32 v109, v142, v143
    v_mfma_f32_4x4x4_16b_bf16 v[250:253], v[222:223], v[82:83], v[32:35]
    v_cvt_pk_bf16_f32 v110, v144, v145
    v_cvt_pk_bf16_f32 v111, v146, v147
    v_mfma_f32_4x4x4_16b_bf16 v[140:143], v[216:217], v[84:85], v[36:39]
    v_cvt_pk_bf16_f32 v112, v246, v247
    v_cvt_pk_bf16_f32 v113, v248, v249
    v_mfma_f32_4x4x4_16b_bf16 v[144:147], v[218:219], v[86:87], v[40:43]
    v_cvt_pk_bf16_f32 v114, v250, v251
    v_cvt_pk_bf16_f32 v115, v252, v253
    v_mfma_f32_4x4x4_16b_bf16 v[246:249], v[220:221], v[88:89], v[44:47]
    v_cvt_pk_bf16_f32 v116, v140, v141
    v_cvt_pk_bf16_f32 v117, v142, v143
    v_mfma_f32_4x4x4_16b_bf16 v[250:253], v[222:223], v[90:91], v[48:51]
    v_cvt_pk_bf16_f32 v118, v144, v145
    v_cvt_pk_bf16_f32 v119, v146, v147
    v_mfma_f32_4x4x4_16b_bf16 v[140:143], v[216:217], v[92:93], v[52:55]
    v_cvt_pk_bf16_f32 v120, v246, v247
    v_cvt_pk_bf16_f32 v121, v248, v249
    v_mfma_f32_4x4x4_16b_bf16 v[144:147], v[218:219], v[94:95], v[56:59]
    v_cvt_pk_bf16_f32 v122, v250, v251
    v_cvt_pk_bf16_f32 v123, v252, v253
    v_mfma_f32_4x4x4_16b_bf16 v[246:249], v[220:221], v[96:97], v[60:63]
    v_cvt_pk_bf16_f32 v124, v140, v141
    v_cvt_pk_bf16_f32 v125, v142, v143
    v_mfma_f32_4x4x4_16b_bf16 v[250:253], v[222:223], v[98:99], v[64:67]
    v_cvt_pk_bf16_f32 v126, v144, v145
    v_cvt_pk_bf16_f32 v127, v146, v147
    v_cvt_pk_bf16_f32 v128, v246, v247
    v_cvt_pk_bf16_f32 v129, v248, v249
    v_add_u32 v239, 272, v239
    v_cvt_pk_bf16_f32 v130, v250, v251
    v_cvt_pk_bf16_f32 v131, v252, v253
    s_waitcnt lgkmcnt(0)
    s_branch Lf_evd3
Lf_last0:
    s_branch Lf_tail
Lf_last1:
    v_add_u32 v236, 2080, v236
    s_lshr_b64 s[56:57], s[56:57], 1
    s_branch Lf_tail
Lf_last2:
    v_add_u32 v236, 4160, v236
    s_lshr_b64 s[56:57], s[56:57], 2
    s_branch Lf_tail
Lf_last3:
    v_add_u32 v236, 6240, v236
    s_lshr_b64 s[56:57], s[56:57], 3
Lf_tail:
    v_mfma_f32_16x16x32_bf16 v[208:211], v[136:139], v[200:203], v[208:211]
    v_exp_f32 v132, v148
    v_exp_f32 v133, v149
    v_exp_f32 v134, v150
    v_exp_f32 v135, v151
    v_exp_f32 v136, v152
    v_exp_f32 v137, v153
    v_mfma_f32_4x4x4_16b_bf16 v[132:135], v[228:229], v[228:229], v[132:135]
    v_exp_f32 v138, v154
    v_exp_f32 v139, v155
    v_cvt_pk_bf16_f32 v208, v208, v209
    v_cvt_pk_bf16_f32 v209, v210, v211
    v_exp_f32 v140, v156
    v_exp_f32 v141, v157
    v_mfma_f32_4x4x4_16b_bf16 v[212:215], v[208:209], v[188:189], v[212:215] cbsz:4 abid:0
    v_mfma_f32_4x4x4_16b_bf16 v[136:139], v[228:229], v[228:229], v[136:139]
    v_exp_f32 v142, v158
    v_mfma_f32_4x4x4_16b_bf16 v[212:215], v[208:209], v[190:191], v[212:215] cbsz:4 abid:4
    v_exp_f32 v143, v159
    v_exp_f32 v144, v160
    v_mfma_f32_4x4x4_16b_bf16 v[212:215], v[208:209], v[192:193], v[212:215] cbsz:4 abid:8
    v_exp_f32 v145, v161
    v_mfma_f32_4x4x4_16b_bf16 v[140:143], v[228:229], v[228:229], v[140:143]
    v_mfma_f32_4x4x4_16b_bf16 v[212:215], v[208:209], v[194:195], v[212:215] cbsz:4 abid:12
    ds_read_b64_tr_b16 v[188:189], v236 offset:0
    ds_read_b64_tr_b16 v[190:191], v236 offset:512
    ds_read_b64_tr_b16 v[192:193], v236 offset:1056
    ds_read_b64_tr_b16 v[194:195], v236 offset:1568
    v_exp_f32 v146, v162
    v_exp_f32 v147, v163
    v_rcp_f32 v132, v132
    v_rcp_f32 v133, v133
    v_mfma_f32_4x4x4_16b_bf16 v[144:147], v[228:229], v[228:229], v[144:147]
    v_rcp_f32 v134, v134
    s_bitcmp0_b64 s[56:57], 1
    s_cbranch_scc1 Lf_tnf
    v_cvt_pk_bf16_f32 v246, v212, v212
    v_mov_b32 v212, 0
    ds_write_b16 v240, v246
    v_add_u32 v240, 128, v240
Lf_tnf:
    v_cvt_pk_bf16_f32 v132, v132, v133
    s_waitcnt lgkmcnt(0)
    v_rcp_f32 v135, v135
    v_rcp_f32 v136, v136
    v_cvt_pk_bf16_f32 v133, v134, v135
    v_rcp_f32 v137, v137
    v_rcp_f32 v138, v138
    v_cvt_pk_bf16_f32 v134, v136, v137
    v_rcp_f32 v139, v139
    v_rcp_f32 v140, v140
    v_cvt_pk_bf16_f32 v135, v138, v139
    v_rcp_f32 v141, v141
    v_rcp_f32 v142, v142
    v_cvt_pk_bf16_f32 v136, v140, v141
    v_mfma_f32_16x16x32_bf16 v[208:211], v[132:135], v[196:199], v[204:207]
    v_rcp_f32 v143, v143
    v_rcp_f32 v144, v144
    v_cvt_pk_bf16_f32 v137, v142, v143
    v_rcp_f32 v145, v145
    v_rcp_f32 v146, v146
    v_rcp_f32 v147, v147
    v_cvt_pk_bf16_f32 v138, v144, v145
    v_cvt_pk_bf16_f32 v139, v146, v147
    s_nop 1
    v_mfma_f32_16x16x32_bf16 v[208:211], v[136:139], v[200:203], v[208:211]
    s_nop 7
    v_cvt_pk_bf16_f32 v208, v208, v209
    v_cvt_pk_bf16_f32 v209, v210, v211
    s_nop 1
    v_mfma_f32_4x4x4_16b_bf16 v[212:215], v[208:209], v[188:189], v[212:215] cbsz:4 abid:0
    s_nop 1
    v_mfma_f32_4x4x4_16b_bf16 v[212:215], v[208:209], v[190:191], v[212:215] cbsz:4 abid:4
    s_nop 1
    v_mfma_f32_4x4x4_16b_bf16 v[212:215], v[208:209], v[192:193], v[212:215] cbsz:4 abid:8
    s_nop 1
    v_mfma_f32_4x4x4_16b_bf16 v[212:215], v[208:209], v[194:195], v[212:215] cbsz:4 abid:12
    s_nop 4
    v_cvt_pk_bf16_f32 v246, v212, v212
    ds_write_b16 v240, v246
L_store:
    s_add_u32 s66, s52, 14912
    v_lshl_add_u32 v247, v0, 4, s66
    s_lshl_b32 s66, s82, 5
    s_bfm_b64 exec, 16, 32
    v_add_u32 v243, s66, v243
    s_lshl_b32 s66, s83, 5
    s_bfm_b64 exec, 16, 48
    v_add_u32 v243, s66, v243
    s_mov_b64 exec, -1
    ds_read_b128 v[148:151], v247
    s_waitcnt lgkmcnt(0)
    global_store_dwordx4 v243, v[148:151], s[18:19] sc0 sc1
L_end:
    s_endpgm
L_general:
    s_waitcnt vmcnt(0)
    ds_read_b128 v[44:47], v246 offset:20480
    ds_read_b128 v[48:51], v246 offset:21504
    ds_read_b128 v[88:91], v246 offset:22528
    ds_read_b128 v[52:55], v246 offset:40960
    ds_read_b128 v[56:59], v246 offset:41984
    ds_read_b128 v[92:95], v246 offset:43008
    ds_read_b128 v[60:63], v246 offset:61440
    ds_read_b128 v[64:67], v246 offset:62464
    ds_read_b128 v[96:99], v246 offset:63488
    ds_read_u16 v224, v238 offset:0
    ds_read_u16 v225, v238 offset:8
    ds_read_u16 v226, v238 offset:64
    ds_read_u16 v227, v238 offset:72
    s_mul_i32 s35, s53, 51200
    s_movk_i32 s31, 25600
    s_mov_b32 s60, 3
    s_mov_b64 s[56:57], 0
    v_mov_b32 v148, -1
    v_mov_b32 v149, -1
    v_mov_b32 v150, -1
    v_mov_b32 v151, -1
    s_add_u32 s66, s52, 18432
    v_add_u32 v152, s66, v2
    ds_write_b128 v152, v[148:151]
    ds_write_b128 v152, v[148:151] offset:1024
    s_add_u32 s64, s52, 18448
    s_bfm_b64 s[28:29], 50, 0
    s_mul_i32 s66, s53, 800
    v_add_u32 v247, s66, v2
    s_mov_b64 exec, s[28:29]
    global_load_dwordx4 v[100:103], v247, s[8:9]
    v_add_u32 v247, 1638400, v247
    global_load_dwordx4 v[104:107], v247, s[8:9]
    v_add_u32 v247, 1638400, v247
    global_load_dwordx4 v[108:111], v247, s[8:9]
    v_add_u32 v247, 1638400, v247
    global_load_dwordx4 v[112:115], v247, s[8:9]
    v_add_u32 v247, 1638400, v247
    s_mov_b64 exec, -1
    v_cmp_lt_u32 vcc, 24, v0
    s_nop 1
    v_cndmask_b32 v145, 0, 1, vcc
    v_mul_u32_u24 v142, 25, v145
    v_sub_u32 v142, v0, v142
    v_mul_u32_u24 v142, 0x80008, v142
    v_add_u32 v141, 0x10000, v142
    v_add_u32 v143, 0x50004, v142
    v_add_u32 v144, 0x70006, v142
    v_add_u32 v142, 0x30002, v142
    s_waitcnt vmcnt(0)
    s_mov_b64 exec, s[28:29]
    v_cmp_neq_f16_sdwa s[68:69], v100, 0 src0_sel:WORD_0 src1_sel:WORD_0
    v_cmp_neq_f16_sdwa s[70:71], v100, 0 src0_sel:WORD_1 src1_sel:WORD_0
    v_cmp_neq_f16_sdwa s[72:73], v101, 0 src0_sel:WORD_0 src1_sel:WORD_0
    v_cmp_neq_f16_sdwa s[74:75], v101, 0 src0_sel:WORD_1 src1_sel:WORD_0
    v_cmp_neq_f16_sdwa s[76:77], v102, 0 src0_sel:WORD_0 src1_sel:WORD_0
    v_cmp_neq_f16_sdwa s[78:79], v102, 0 src0_sel:WORD_1 src1_sel:WORD_0
    v_cmp_neq_f16_sdwa s[80:81], v103, 0 src0_sel:WORD_0 src1_sel:WORD_0
    v_cmp_neq_f16_sdwa s[82:83], v103, 0 src0_sel:WORD_1 src1_sel:WORD_0
    s_mov_b64 exec, -1
    v_mov_b32 v132, s64
    v_mbcnt_lo_u32_b32 v132, s68, v132
    v_mbcnt_hi_u32_b32 v132, s69, v132
    v_mbcnt_lo_u32_b32 v132, s70, v132
    v_mbcnt_hi_u32_b32 v132, s71, v132
    v_mbcnt_lo_u32_b32 v132, s72, v132
    v_mbcnt_hi_u32_b32 v132, s73, v132
    v_mbcnt_lo_u32_b32 v132, s74, v132
    v_mbcnt_hi_u32_b32 v132, s75, v132
    v_mbcnt_lo_u32_b32 v132, s76, v132
    v_mbcnt_hi_u32_b32 v132, s77, v132
    v_mbcnt_lo_u32_b32 v132, s78, v132
    v_mbcnt_hi_u32_b32 v132, s79, v132
    v_mbcnt_lo_u32_b32 v132, s80, v132
    v_mbcnt_hi_u32_b32 v132, s81, v132
    v_mbcnt_lo_u32_b32 v132, s82, v132
    v_mbcnt_hi_u32_b32 v132, s83, v132
    s_add_u32 s55, s64, 16
    v_readlane_b32 s66, v132, 25
    v_readlane_b32 s67, v132, 63
    s_add_u32 s64, s66, 15
    s_and_b32 s64, s64, -16
    s_max_u32 s64, s64, s55
    s_sub_u32 s66, s64, s66
    v_mad_u32_u24 v132, v145, s66, v132
    s_mov_b32 s55, s64
    v_addc_co_u32 v133, vcc, 0, v132, s[68:69]
    v_addc_co_u32 v134, vcc, 0, v133, s[70:71]
    v_addc_co_u32 v135, vcc, 0, v134, s[72:73]
    v_addc_co_u32 v136, vcc, 0, v135, s[74:75]
    v_addc_co_u32 v137, vcc, 0, v136, s[76:77]
    v_addc_co_u32 v138, vcc, 0, v137, s[78:79]
    v_addc_co_u32 v139, vcc, 0, v138, s[80:81]
    s_add_u32 s67, s67, s66
    s_add_u32 s67, s67, 15
    s_and_b32 s67, s67, -16
    s_add_u32 s64, s64, 16
    s_max_u32 s64, s64, s67
    s_mov_b64 exec, s[68:69]
    ds_write_b8 v132, v141
    s_mov_b64 exec, s[70:71]
    ds_write_b8_d16_hi v133, v141
    s_mov_b64 exec, s[72:73]
    ds_write_b8 v134, v142
    s_mov_b64 exec, s[74:75]
    ds_write_b8_d16_hi v135, v142
    s_mov_b64 exec, s[76:77]
    ds_write_b8 v136, v143
    s_mov_b64 exec, s[78:79]
    ds_write_b8_d16_hi v137, v143
    s_mov_b64 exec, s[80:81]
    ds_write_b8 v138, v144
    s_mov_b64 exec, s[82:83]
    ds_write_b8_d16_hi v139, v144
    s_mov_b64 exec, -1
    s_lshr_b32 s95, s55, 4
    s_bitset1_b64 s[56:57], s95
    s_lshr_b32 s95, s64, 4
    s_bitset1_b64 s[56:57], s95
    s_mov_b64 exec, s[28:29]
    v_cmp_neq_f16_sdwa s[68:69], v104, 0 src0_sel:WORD_0 src1_sel:WORD_0
    v_cmp_neq_f16_sdwa s[70:71], v104, 0 src0_sel:WORD_1 src1_sel:WORD_0
    v_cmp_neq_f16_sdwa s[72:73], v105, 0 src0_sel:WORD_0 src1_sel:WORD_0
    v_cmp_neq_f16_sdwa s[74:75], v105, 0 src0_sel:WORD_1 src1_sel:WORD_0
    v_cmp_neq_f16_sdwa s[76:77], v106, 0 src0_sel:WORD_0 src1_sel:WORD_0
    v_cmp_neq_f16_sdwa s[78:79], v106, 0 src0_sel:WORD_1 src1_sel:WORD_0
    v_cmp_neq_f16_sdwa s[80:81], v107, 0 src0_sel:WORD_0 src1_sel:WORD_0
    v_cmp_neq_f16_sdwa s[82:83], v107, 0 src0_sel:WORD_1 src1_sel:WORD_0
    s_mov_b64 exec, -1
    v_mov_b32 v132, s64
    v_mbcnt_lo_u32_b32 v132, s68, v132
    v_mbcnt_hi_u32_b32 v132, s69, v132
    v_mbcnt_lo_u32_b32 v132, s70, v132
    v_mbcnt_hi_u32_b32 v132, s71, v132
    v_mbcnt_lo_u32_b32 v132, s72, v132
    v_mbcnt_hi_u32_b32 v132, s73, v132
    v_mbcnt_lo_u32_b32 v132, s74, v132
    v_mbcnt_hi_u32_b32 v132, s75, v132
    v_mbcnt_lo_u32_b32 v132, s76, v132
    v_mbcnt_hi_u32_b32 v132, s77, v132
    v_mbcnt_lo_u32_b32 v132, s78, v132
    v_mbcnt_hi_u32_b32 v132, s79, v132
    v_mbcnt_lo_u32_b32 v132, s80, v132
    v_mbcnt_hi_u32_b32 v132, s81, v132
    v_mbcnt_lo_u32_b32 v132, s82, v132
    v_mbcnt_hi_u32_b32 v132, s83, v132
    s_add_u32 s55, s64, 16
    v_readlane_b32 s66, v132, 25
    v_readlane_b32 s67, v132, 63
    s_add_u32 s64, s66, 15
    s_and_b32 s64, s64, -16
    s_max_u32 s64, s64, s55
    s_sub_u32 s66, s64, s66
    v_mad_u32_u24 v132, v145, s66, v132
    s_mov_b32 s55, s64
    v_addc_co_u32 v133, vcc, 0, v132, s[68:69]
    v_addc_co_u32 v134, vcc, 0, v133, s[70:71]
    v_addc_co_u32 v135, vcc, 0, v134, s[72:73]
    v_addc_co_u32 v136, vcc, 0, v135, s[74:75]
    v_addc_co_u32 v137, vcc, 0, v136, s[76:77]
    v_addc_co_u32 v138, vcc, 0, v137, s[78:79]
    v_addc_co_u32 v139, vcc, 0, v138, s[80:81]
    s_add_u32 s67, s67, s66
    s_add_u32 s67, s67, 15
    s_and_b32 s67, s67, -16
    s_add_u32 s64, s64, 16
    s_max_u32 s64, s64, s67
    s_mov_b64 exec, s[68:69]
    ds_write_b8 v132, v141
    s_mov_b64 exec, s[70:71]
    ds_write_b8_d16_hi v133, v141
    s_mov_b64 exec, s[72:73]
    ds_write_b8 v134, v142
    s_mov_b64 exec, s[74:75]
    ds_write_b8_d16_hi v135, v142
    s_mov_b64 exec, s[76:77]
    ds_write_b8 v136, v143
    s_mov_b64 exec, s[78:79]
    ds_write_b8_d16_hi v137, v143
    s_mov_b64 exec, s[80:81]
    ds_write_b8 v138, v144
    s_mov_b64 exec, s[82:83]
    ds_write_b8_d16_hi v139, v144
    s_mov_b64 exec, -1
    s_lshr_b32 s95, s55, 4
    s_bitset1_b64 s[56:57], s95
    s_lshr_b32 s95, s64, 4
    s_bitset1_b64 s[56:57], s95
    s_mov_b32 s44, s64
    s_mov_b64 exec, s[28:29]
    v_cmp_neq_f16_sdwa s[68:69], v108, 0 src0_sel:WORD_0 src1_sel:WORD_0
    v_cmp_neq_f16_sdwa s[70:71], v108, 0 src0_sel:WORD_1 src1_sel:WORD_0
    v_cmp_neq_f16_sdwa s[72:73], v109, 0 src0_sel:WORD_0 src1_sel:WORD_0
    v_cmp_neq_f16_sdwa s[74:75], v109, 0 src0_sel:WORD_1 src1_sel:WORD_0
    v_cmp_neq_f16_sdwa s[76:77], v110, 0 src0_sel:WORD_0 src1_sel:WORD_0
    v_cmp_neq_f16_sdwa s[78:79], v110, 0 src0_sel:WORD_1 src1_sel:WORD_0
    v_cmp_neq_f16_sdwa s[80:81], v111, 0 src0_sel:WORD_0 src1_sel:WORD_0
    v_cmp_neq_f16_sdwa s[82:83], v111, 0 src0_sel:WORD_1 src1_sel:WORD_0
    s_mov_b64 exec, -1
    v_mov_b32 v132, s64
    v_mbcnt_lo_u32_b32 v132, s68, v132
    v_mbcnt_hi_u32_b32 v132, s69, v132
    v_mbcnt_lo_u32_b32 v132, s70, v132
    v_mbcnt_hi_u32_b32 v132, s71, v132
    v_mbcnt_lo_u32_b32 v132, s72, v132
    v_mbcnt_hi_u32_b32 v132, s73, v132
    v_mbcnt_lo_u32_b32 v132, s74, v132
    v_mbcnt_hi_u32_b32 v132, s75, v132
    v_mbcnt_lo_u32_b32 v132, s76, v132
    v_mbcnt_hi_u32_b32 v132, s77, v132
    v_mbcnt_lo_u32_b32 v132, s78, v132
    v_mbcnt_hi_u32_b32 v132, s79, v132
    v_mbcnt_lo_u32_b32 v132, s80, v132
    v_mbcnt_hi_u32_b32 v132, s81, v132
    v_mbcnt_lo_u32_b32 v132, s82, v132
    v_mbcnt_hi_u32_b32 v132, s83, v132
    s_add_u32 s55, s64, 16
    v_readlane_b32 s66, v132, 25
    v_readlane_b32 s67, v132, 63
    s_add_u32 s64, s66, 15
    s_and_b32 s64, s64, -16
    s_max_u32 s64, s64, s55
    s_sub_u32 s66, s64, s66
    v_mad_u32_u24 v132, v145, s66, v132
    s_mov_b32 s55, s64
    v_addc_co_u32 v133, vcc, 0, v132, s[68:69]
    v_addc_co_u32 v134, vcc, 0, v133, s[70:71]
    v_addc_co_u32 v135, vcc, 0, v134, s[72:73]
    v_addc_co_u32 v136, vcc, 0, v135, s[74:75]
    v_addc_co_u32 v137, vcc, 0, v136, s[76:77]
    v_addc_co_u32 v138, vcc, 0, v137, s[78:79]
    v_addc_co_u32 v139, vcc, 0, v138, s[80:81]
    s_add_u32 s67, s67, s66
    s_add_u32 s67, s67, 15
    s_and_b32 s67, s67, -16
    s_add_u32 s64, s64, 16
    s_max_u32 s64, s64, s67
    s_mov_b64 exec, s[68:69]
    ds_write_b8 v132, v141
    s_mov_b64 exec, s[70:71]
    ds_write_b8_d16_hi v133, v141
    s_mov_b64 exec, s[72:73]
    ds_write_b8 v134, v142
    s_mov_b64 exec, s[74:75]
    ds_write_b8_d16_hi v135, v142
    s_mov_b64 exec, s[76:77]
    ds_write_b8 v136, v143
    s_mov_b64 exec, s[78:79]
    ds_write_b8_d16_hi v137, v143
    s_mov_b64 exec, s[80:81]
    ds_write_b8 v138, v144
    s_mov_b64 exec, s[82:83]
    ds_write_b8_d16_hi v139, v144
    s_mov_b64 exec, -1
    s_mov_b32 s45, s55
    s_mov_b32 s46, s64
    s_mov_b64 exec, s[28:29]
    v_cmp_neq_f16_sdwa s[68:69], v112, 0 src0_sel:WORD_0 src1_sel:WORD_0
    v_cmp_neq_f16_sdwa s[70:71], v112, 0 src0_sel:WORD_1 src1_sel:WORD_0
    v_cmp_neq_f16_sdwa s[72:73], v113, 0 src0_sel:WORD_0 src1_sel:WORD_0
    v_cmp_neq_f16_sdwa s[74:75], v113, 0 src0_sel:WORD_1 src1_sel:WORD_0
    v_cmp_neq_f16_sdwa s[76:77], v114, 0 src0_sel:WORD_0 src1_sel:WORD_0
    v_cmp_neq_f16_sdwa s[78:79], v114, 0 src0_sel:WORD_1 src1_sel:WORD_0
    v_cmp_neq_f16_sdwa s[80:81], v115, 0 src0_sel:WORD_0 src1_sel:WORD_0
    v_cmp_neq_f16_sdwa s[82:83], v115, 0 src0_sel:WORD_1 src1_sel:WORD_0
    s_mov_b64 exec, -1
    v_mov_b32 v132, s64
    v_mbcnt_lo_u32_b32 v132, s68, v132
    v_mbcnt_hi_u32_b32 v132, s69, v132
    v_mbcnt_lo_u32_b32 v132, s70, v132
    v_mbcnt_hi_u32_b32 v132, s71, v132
    v_mbcnt_lo_u32_b32 v132, s72, v132
    v_mbcnt_hi_u32_b32 v132, s73, v132
    v_mbcnt_lo_u32_b32 v132, s74, v132
    v_mbcnt_hi_u32_b32 v132, s75, v132
    v_mbcnt_lo_u32_b32 v132, s76, v132
    v_mbcnt_hi_u32_b32 v132, s77, v132
    v_mbcnt_lo_u32_b32 v132, s78, v132
    v_mbcnt_hi_u32_b32 v132, s79, v132
    v_mbcnt_lo_u32_b32 v132, s80, v132
    v_mbcnt_hi_u32_b32 v132, s81, v132
    v_mbcnt_lo_u32_b32 v132, s82, v132
    v_mbcnt_hi_u32_b32 v132, s83, v132
    s_add_u32 s55, s64, 16
    v_readlane_b32 s66, v132, 25
    v_readlane_b32 s67, v132, 63
    s_add_u32 s64, s66, 15
    s_and_b32 s64, s64, -16
    s_max_u32 s64, s64, s55
    s_sub_u32 s66, s64, s66
    v_mad_u32_u24 v132, v145, s66, v132
    s_mov_b32 s55, s64
    v_addc_co_u32 v133, vcc, 0, v132, s[68:69]
    v_addc_co_u32 v134, vcc, 0, v133, s[70:71]
    v_addc_co_u32 v135, vcc, 0, v134, s[72:73]
    v_addc_co_u32 v136, vcc, 0, v135, s[74:75]
    v_addc_co_u32 v137, vcc, 0, v136, s[76:77]
    v_addc_co_u32 v138, vcc, 0, v137, s[78:79]
    v_addc_co_u32 v139, vcc, 0, v138, s[80:81]
    s_add_u32 s67, s67, s66
    s_add_u32 s67, s67, 15
    s_and_b32 s67, s67, -16
    s_add_u32 s64, s64, 16
    s_max_u32 s64, s64, s67
    s_mov_b64 exec, s[68:69]
    ds_write_b8 v132, v141
    s_mov_b64 exec, s[70:71]
    ds_write_b8_d16_hi v133, v141
    s_mov_b64 exec, s[72:73]
    ds_write_b8 v134, v142
    s_mov_b64 exec, s[74:75]
    ds_write_b8_d16_hi v135, v142
    s_mov_b64 exec, s[76:77]
    ds_write_b8 v136, v143
    s_mov_b64 exec, s[78:79]
    ds_write_b8_d16_hi v137, v143
    s_mov_b64 exec, s[80:81]
    ds_write_b8 v138, v144
    s_mov_b64 exec, s[82:83]
    ds_write_b8_d16_hi v139, v144
    s_mov_b64 exec, -1
    s_mov_b32 s47, s55
    s_mov_b32 s48, s64
    s_mov_b32 s94, 0
    s_mov_b64 s[84:85], -1
    s_branch L_listed
Ls_loop:
Ls_mid:
    s_bitcmp1_b32 s36, 0
    s_cbranch_scc1 Ls_ev0
Ls_evd0:
    v_mfma_f32_16x16x32_bf16 v[208:211], v[136:139], v[200:203], v[208:211]
    ds_read_b32 v246, v244 offset:0
    s_waitcnt lgkmcnt(0)
    v_bfe_u32 v247, v246, 0, 8
    v_lshlrev_b32 v247, 1, v247
    v_bfe_u32 v248, v246, 8, 8
    v_lshlrev_b32 v248, 1, v248
    v_bfe_u32 v249, v246, 16, 8
    v_lshlrev_b32 v249, 1, v249
    v_bfe_u32 v250, v246, 24, 8
    v_lshlrev_b32 v250, 1, v250
    buffer_load_ushort v247, v247, s[24:27], 0 offen
    buffer_load_ushort v248, v248, s[24:27], 0 offen
    buffer_load_ushort v249, v249, s[24:27], 0 offen
    buffer_load_ushort v250, v250, s[24:27], 0 offen
    s_waitcnt vmcnt(0)
    v_lshlrev_b32 v247, 16, v247
    v_mul_f32 v208, v208, v247
    v_lshlrev_b32 v248, 16, v248
    v_mul_f32 v209, v209, v248
    v_lshlrev_b32 v249, 16, v249
    v_mul_f32 v210, v210, v249
    v_lshlrev_b32 v250, 16, v250
    v_mul_f32 v211, v211, v250
    v_exp_f32 v132, v148
    v_exp_f32 v133, v149
    v_exp_f32 v134, v150
    v_exp_f32 v135, v151
    v_exp_f32 v136, v152
    v_exp_f32 v137, v153
    v_mfma_f32_4x4x4_16b_bf16 v[132:135], v[228:229], v[228:229], v[132:135]
    v_exp_f32 v138, v154
    v_exp_f32 v139, v155
    v_cvt_pk_bf16_f32 v208, v208, v209
    v_cvt_pk_bf16_f32 v209, v210, v211
    v_exp_f32 v140, v156
    v_exp_f32 v141, v157
    v_mfma_f32_4x4x4_16b_bf16 v[212:215], v[208:209], v[188:189], v[212:215] cbsz:4 abid:0
    v_mfma_f32_4x4x4_16b_bf16 v[136:139], v[228:229], v[228:229], v[136:139]
    v_exp_f32 v142, v158
    v_mfma_f32_4x4x4_16b_bf16 v[212:215], v[208:209], v[190:191], v[212:215] cbsz:4 abid:4
    v_exp_f32 v143, v159
    v_exp_f32 v144, v160
    v_mfma_f32_4x4x4_16b_bf16 v[212:215], v[208:209], v[192:193], v[212:215] cbsz:4 abid:8
    v_exp_f32 v145, v161
    v_mfma_f32_4x4x4_16b_bf16 v[140:143], v[228:229], v[228:229], v[140:143]
    v_mfma_f32_4x4x4_16b_bf16 v[212:215], v[208:209], v[194:195], v[212:215] cbsz:4 abid:12
    ds_add_rtn_u32 v1, v2, v3
    ds_read_u8 v230, v237 offset:64
    ds_read_u8 v232, v237 offset:72
    ds_read_b64_tr_b16 v[188:189], v236 offset:0
    ds_read_b64_tr_b16 v[190:191], v236 offset:512
    ds_read_b64_tr_b16 v[192:193], v236 offset:1056
    ds_read_b64_tr_b16 v[194:195], v236 offset:1568
    s_waitcnt vmcnt(4)
    ds_read_b128 v[180:183], v234 offset:2080
    ds_read_b128 v[184:187], v235 offset:2080
    s_add_u32 m0, s52, 0
    v_exp_f32 v146, v162
    v_exp_f32 v147, v163
    v_rcp_f32 v132, v132
    v_rcp_f32 v133, v133
    v_mfma_f32_4x4x4_16b_bf16 v[144:147], v[228:229], v[228:229], v[144:147]
    v_rcp_f32 v134, v134
    v_cvt_pk_bf16_f32 v132, v132, v133
    s_waitcnt lgkmcnt(2)
    buffer_load_dwordx4 v[230:231], s[20:23], s35 idxen offen nt lds
    buffer_load_dwordx4 v[232:233], s[40:43], s35 idxen offen offset:1056 nt lds
    s_waitcnt lgkmcnt(0)
    v_mfma_f32_16x16x32_bf16 v[148:151], v[100:103], v[180:183], v[164:167]
    v_rcp_f32 v135, v135
    v_mfma_f32_16x16x32_bf16 v[152:155], v[108:111], v[180:183], v[168:171]
    v_rcp_f32 v136, v136
    v_cvt_pk_bf16_f32 v133, v134, v135
    v_mfma_f32_16x16x32_bf16 v[148:151], v[104:107], v[184:187], v[148:151]
    v_rcp_f32 v137, v137
    v_readfirstlane_b32 s66, v1
    s_setprio 0
    s_cmp_gt_i32 s66, 0
    s_cbranch_scc0 Ls_lo0
    s_setprio 1
Ls_lo0:
    v_mfma_f32_16x16x32_bf16 v[152:155], v[112:115], v[184:187], v[152:155]
    v_rcp_f32 v138, v138
    v_cvt_pk_bf16_f32 v134, v136, v137
    v_mfma_f32_16x16x32_bf16 v[156:159], v[116:119], v[180:183], v[172:175]
    v_rcp_f32 v139, v139
    v_mfma_f32_16x16x32_bf16 v[160:163], v[124:127], v[180:183], v[176:179]
    v_rcp_f32 v140, v140
    v_cvt_pk_bf16_f32 v135, v138, v139
    v_mfma_f32_16x16x32_bf16 v[156:159], v[120:123], v[184:187], v[156:159]
    v_rcp_f32 v141, v141
    v_mfma_f32_16x16x32_bf16 v[160:163], v[128:131], v[184:187], v[160:163]
    v_rcp_f32 v142, v142
    v_cvt_pk_bf16_f32 v136, v140, v141
    v_mfma_f32_16x16x32_bf16 v[208:211], v[132:135], v[196:199], v[204:207]
    v_rcp_f32 v143, v143
    v_rcp_f32 v144, v144
    v_cvt_pk_bf16_f32 v137, v142, v143
    v_rcp_f32 v145, v145
    v_rcp_f32 v146, v146
    v_rcp_f32 v147, v147
    v_cvt_pk_bf16_f32 v138, v144, v145
    v_cvt_pk_bf16_f32 v139, v146, v147
    s_bitcmp1_b32 s36, 1
    s_cbranch_scc1 Ls_ev1
Ls_evd1:
    v_mfma_f32_16x16x32_bf16 v[208:211], v[136:139], v[200:203], v[208:211]
    ds_read_b32 v246, v244 offset:16
    s_waitcnt lgkmcnt(0)
    v_bfe_u32 v247, v246, 0, 8
    v_lshlrev_b32 v247, 1, v247
    v_bfe_u32 v248, v246, 8, 8
    v_lshlrev_b32 v248, 1, v248
    v_bfe_u32 v249, v246, 16, 8
    v_lshlrev_b32 v249, 1, v249
    v_bfe_u32 v250, v246, 24, 8
    v_lshlrev_b32 v250, 1, v250
    buffer_load_ushort v247, v247, s[24:27], 0 offen
    buffer_load_ushort v248, v248, s[24:27], 0 offen
    buffer_load_ushort v249, v249, s[24:27], 0 offen
    buffer_load_ushort v250, v250, s[24:27], 0 offen
    s_waitcnt vmcnt(0)
    v_lshlrev_b32 v247, 16, v247
    v_mul_f32 v208, v208, v247
    v_lshlrev_b32 v248, 16, v248
    v_mul_f32 v209, v209, v248
    v_lshlrev_b32 v249, 16, v249
    v_mul_f32 v210, v210, v249
    v_lshlrev_b32 v250, 16, v250
    v_mul_f32 v211, v211, v250
    v_exp_f32 v132, v148
    v_exp_f32 v133, v149
    v_exp_f32 v134, v150
    v_exp_f32 v135, v151
    v_exp_f32 v136, v152
    v_exp_f32 v137, v153
    v_mfma_f32_4x4x4_16b_bf16 v[132:135], v[228:229], v[228:229], v[132:135]
    v_exp_f32 v138, v154
    v_exp_f32 v139, v155
    v_cvt_pk_bf16_f32 v208, v208, v209
    v_cvt_pk_bf16_f32 v209, v210, v211
    v_exp_f32 v140, v156
    v_exp_f32 v141, v157
    v_mfma_f32_4x4x4_16b_bf16 v[212:215], v[208:209], v[188:189], v[212:215] cbsz:4 abid:0
    v_mfma_f32_4x4x4_16b_bf16 v[136:139], v[228:229], v[228:229], v[136:139]
    v_exp_f32 v142, v158
    v_mfma_f32_4x4x4_16b_bf16 v[212:215], v[208:209], v[190:191], v[212:215] cbsz:4 abid:4
    v_exp_f32 v143, v159
    v_exp_f32 v144, v160
    v_mfma_f32_4x4x4_16b_bf16 v[212:215], v[208:209], v[192:193], v[212:215] cbsz:4 abid:8
    v_exp_f32 v145, v161
    v_mfma_f32_4x4x4_16b_bf16 v[140:143], v[228:229], v[228:229], v[140:143]
    v_mfma_f32_4x4x4_16b_bf16 v[212:215], v[208:209], v[194:195], v[212:215] cbsz:4 abid:12
    ds_read_u8 v230, v237 offset:80
    ds_read_u8 v232, v237 offset:88
    ds_read_b64_tr_b16 v[188:189], v236 offset:2080
    ds_read_b64_tr_b16 v[190:191], v236 offset:2592
    ds_read_b64_tr_b16 v[192:193], v236 offset:3136
    ds_read_b64_tr_b16 v[194:195], v236 offset:3648
    s_waitcnt vmcnt(4)
    ds_read_b128 v[180:183], v234 offset:4160
    ds_read_b128 v[184:187], v235 offset:4160
    s_add_u32 m0, s52, 2080
    v_exp_f32 v146, v162
    v_exp_f32 v147, v163
    v_rcp_f32 v132, v132
    v_rcp_f32 v133, v133
    v_mfma_f32_4x4x4_16b_bf16 v[144:147], v[228:229], v[228:229], v[144:147]
    v_rcp_f32 v134, v134
    v_cvt_pk_bf16_f32 v132, v132, v133
    s_waitcnt lgkmcnt(2)
    buffer_load_dwordx4 v[230:231], s[20:23], s35 idxen offen nt lds
    buffer_load_dwordx4 v[232:233], s[40:43], s35 idxen offen offset:1056 nt lds
    s_waitcnt lgkmcnt(0)
    v_mfma_f32_16x16x32_bf16 v[148:151], v[100:103], v[180:183], v[164:167]
    v_rcp_f32 v135, v135
    v_mfma_f32_16x16x32_bf16 v[152:155], v[108:111], v[180:183], v[168:171]
    v_rcp_f32 v136, v136
    v_cvt_pk_bf16_f32 v133, v134, v135
    v_mfma_f32_16x16x32_bf16 v[148:151], v[104:107], v[184:187], v[148:151]
    v_rcp_f32 v137, v137
    v_mfma_f32_16x16x32_bf16 v[152:155], v[112:115], v[184:187], v[152:155]
    v_rcp_f32 v138, v138
    v_cvt_pk_bf16_f32 v134, v136, v137
    v_mfma_f32_16x16x32_bf16 v[156:159], v[116:119], v[180:183], v[172:175]
    v_rcp_f32 v139, v139
    v_mfma_f32_16x16x32_bf16 v[160:163], v[124:127], v[180:183], v[176:179]
    v_rcp_f32 v140, v140
    v_cvt_pk_bf16_f32 v135, v138, v139
    v_mfma_f32_16x16x32_bf16 v[156:159], v[120:123], v[184:187], v[156:159]
    v_rcp_f32 v141, v141
    v_mfma_f32_16x16x32_bf16 v[160:163], v[128:131], v[184:187], v[160:163]
    v_rcp_f32 v142, v142
    v_cvt_pk_bf16_f32 v136, v140, v141
    v_mfma_f32_16x16x32_bf16 v[208:211], v[132:135], v[196:199], v[204:207]
    v_rcp_f32 v143, v143
    v_rcp_f32 v144, v144
    v_cvt_pk_bf16_f32 v137, v142, v143
    v_rcp_f32 v145, v145
    v_rcp_f32 v146, v146
    v_rcp_f32 v147, v147
    v_cvt_pk_bf16_f32 v138, v144, v145
    v_cvt_pk_bf16_f32 v139, v146, v147
    s_bitcmp1_b32 s36, 2
    s_cbranch_scc1 Ls_ev2
Ls_evd2:
    v_mfma_f32_16x16x32_bf16 v[208:211], v[136:139], v[200:203], v[208:211]
    ds_read_b32 v246, v244 offset:32
    s_waitcnt lgkmcnt(0)
    v_bfe_u32 v247, v246, 0, 8
    v_lshlrev_b32 v247, 1, v247
    v_bfe_u32 v248, v246, 8, 8
    v_lshlrev_b32 v248, 1, v248
    v_bfe_u32 v249, v246, 16, 8
    v_lshlrev_b32 v249, 1, v249
    v_bfe_u32 v250, v246, 24, 8
    v_lshlrev_b32 v250, 1, v250
    buffer_load_ushort v247, v247, s[24:27], 0 offen
    buffer_load_ushort v248, v248, s[24:27], 0 offen
    buffer_load_ushort v249, v249, s[24:27], 0 offen
    buffer_load_ushort v250, v250, s[24:27], 0 offen
    s_waitcnt vmcnt(0)
    v_lshlrev_b32 v247, 16, v247
    v_mul_f32 v208, v208, v247
    v_lshlrev_b32 v248, 16, v248
    v_mul_f32 v209, v209, v248
    v_lshlrev_b32 v249, 16, v249
    v_mul_f32 v210, v210, v249
    v_lshlrev_b32 v250, 16, v250
    v_mul_f32 v211, v211, v250
    v_exp_f32 v132, v148
    v_exp_f32 v133, v149
    v_exp_f32 v134, v150
    v_exp_f32 v135, v151
    v_exp_f32 v136, v152
    v_exp_f32 v137, v153
    v_mfma_f32_4x4x4_16b_bf16 v[132:135], v[228:229], v[228:229], v[132:135]
    v_exp_f32 v138, v154
    v_exp_f32 v139, v155
    v_cvt_pk_bf16_f32 v208, v208, v209
    v_cvt_pk_bf16_f32 v209, v210, v211
    v_exp_f32 v140, v156
    v_exp_f32 v141, v157
    v_mfma_f32_4x4x4_16b_bf16 v[212:215], v[208:209], v[188:189], v[212:215] cbsz:4 abid:0
    v_mfma_f32_4x4x4_16b_bf16 v[136:139], v[228:229], v[228:229], v[136:139]
    v_exp_f32 v142, v158
    v_mfma_f32_4x4x4_16b_bf16 v[212:215], v[208:209], v[190:191], v[212:215] cbsz:4 abid:4
    v_exp_f32 v143, v159
    v_exp_f32 v144, v160
    v_mfma_f32_4x4x4_16b_bf16 v[212:215], v[208:209], v[192:193], v[212:215] cbsz:4 abid:8
    v_exp_f32 v145, v161
    v_mfma_f32_4x4x4_16b_bf16 v[140:143], v[228:229], v[228:229], v[140:143]
    v_mfma_f32_4x4x4_16b_bf16 v[212:215], v[208:209], v[194:195], v[212:215] cbsz:4 abid:12
    ds_read_u8 v230, v237 offset:96
    ds_read_u8 v232, v237 offset:104
    ds_read_b64_tr_b16 v[188:189], v236 offset:4160
    ds_read_b64_tr_b16 v[190:191], v236 offset:4672
    ds_read_b64_tr_b16 v[192:193], v236 offset:5216
    ds_read_b64_tr_b16 v[194:195], v236 offset:5728
    s_waitcnt vmcnt(4)
    ds_read_b128 v[180:183], v234 offset:6240
    ds_read_b128 v[184:187], v235 offset:6240
    s_add_u32 m0, s52, 4160
    v_exp_f32 v146, v162
    v_exp_f32 v147, v163
    v_rcp_f32 v132, v132
    v_rcp_f32 v133, v133
    v_mfma_f32_4x4x4_16b_bf16 v[144:147], v[228:229], v[228:229], v[144:147]
    v_rcp_f32 v134, v134
    v_cvt_pk_bf16_f32 v132, v132, v133
    s_waitcnt lgkmcnt(2)
    buffer_load_dwordx4 v[230:231], s[20:23], s35 idxen offen nt lds
    buffer_load_dwordx4 v[232:233], s[40:43], s35 idxen offen offset:1056 nt lds
    s_waitcnt lgkmcnt(0)
    v_mfma_f32_16x16x32_bf16 v[148:151], v[100:103], v[180:183], v[164:167]
    v_rcp_f32 v135, v135
    v_mfma_f32_16x16x32_bf16 v[152:155], v[108:111], v[180:183], v[168:171]
    v_rcp_f32 v136, v136
    v_cvt_pk_bf16_f32 v133, v134, v135
    v_mfma_f32_16x16x32_bf16 v[148:151], v[104:107], v[184:187], v[148:151]
    v_rcp_f32 v137, v137
    v_mfma_f32_16x16x32_bf16 v[152:155], v[112:115], v[184:187], v[152:155]
    v_rcp_f32 v138, v138
    v_cvt_pk_bf16_f32 v134, v136, v137
    v_mfma_f32_16x16x32_bf16 v[156:159], v[116:119], v[180:183], v[172:175]
    v_rcp_f32 v139, v139
    v_mfma_f32_16x16x32_bf16 v[160:163], v[124:127], v[180:183], v[176:179]
    v_rcp_f32 v140, v140
    v_cvt_pk_bf16_f32 v135, v138, v139
    v_mfma_f32_16x16x32_bf16 v[156:159], v[120:123], v[184:187], v[156:159]
    v_rcp_f32 v141, v141
    v_mfma_f32_16x16x32_bf16 v[160:163], v[128:131], v[184:187], v[160:163]
    v_rcp_f32 v142, v142
    v_cvt_pk_bf16_f32 v136, v140, v141
    v_mfma_f32_16x16x32_bf16 v[208:211], v[132:135], v[196:199], v[204:207]
    v_rcp_f32 v143, v143
    v_rcp_f32 v144, v144
    v_cvt_pk_bf16_f32 v137, v142, v143
    v_rcp_f32 v145, v145
    v_rcp_f32 v146, v146
    v_rcp_f32 v147, v147
    v_cvt_pk_bf16_f32 v138, v144, v145
    v_cvt_pk_bf16_f32 v139, v146, v147
    s_bitcmp1_b32 s36, 3
    s_cbranch_scc1 Ls_ev3
Ls_evd3:
    v_mfma_f32_16x16x32_bf16 v[208:211], v[136:139], v[200:203], v[208:211]
    ds_read_b32 v246, v244 offset:48
    s_waitcnt lgkmcnt(0)
    v_bfe_u32 v247, v246, 0, 8
    v_lshlrev_b32 v247, 1, v247
    v_bfe_u32 v248, v246, 8, 8
    v_lshlrev_b32 v248, 1, v248
    v_bfe_u32 v249, v246, 16, 8
    v_lshlrev_b32 v249, 1, v249
    v_bfe_u32 v250, v246, 24, 8
    v_lshlrev_b32 v250, 1, v250
    buffer_load_ushort v247, v247, s[24:27], 0 offen
    buffer_load_ushort v248, v248, s[24:27], 0 offen
    buffer_load_ushort v249, v249, s[24:27], 0 offen
    buffer_load_ushort v250, v250, s[24:27], 0 offen
    s_waitcnt vmcnt(0)
    v_lshlrev_b32 v247, 16, v247
    v_mul_f32 v208, v208, v247
    v_lshlrev_b32 v248, 16, v248
    v_mul_f32 v209, v209, v248
    v_lshlrev_b32 v249, 16, v249
    v_mul_f32 v210, v210, v249
    v_lshlrev_b32 v250, 16, v250
    v_mul_f32 v211, v211, v250
    v_exp_f32 v132, v148
    v_exp_f32 v133, v149
    v_exp_f32 v134, v150
    v_exp_f32 v135, v151
    v_exp_f32 v136, v152
    v_exp_f32 v137, v153
    v_mfma_f32_4x4x4_16b_bf16 v[132:135], v[228:229], v[228:229], v[132:135]
    v_exp_f32 v138, v154
    v_exp_f32 v139, v155
    v_cvt_pk_bf16_f32 v208, v208, v209
    v_cvt_pk_bf16_f32 v209, v210, v211
    v_exp_f32 v140, v156
    v_exp_f32 v141, v157
    v_mfma_f32_4x4x4_16b_bf16 v[212:215], v[208:209], v[188:189], v[212:215] cbsz:4 abid:0
    v_mfma_f32_4x4x4_16b_bf16 v[136:139], v[228:229], v[228:229], v[136:139]
    v_exp_f32 v142, v158
    v_mfma_f32_4x4x4_16b_bf16 v[212:215], v[208:209], v[190:191], v[212:215] cbsz:4 abid:4
    v_exp_f32 v143, v159
    v_exp_f32 v144, v160
    v_mfma_f32_4x4x4_16b_bf16 v[212:215], v[208:209], v[192:193], v[212:215] cbsz:4 abid:8
    v_exp_f32 v145, v161
    v_mfma_f32_4x4x4_16b_bf16 v[140:143], v[228:229], v[228:229], v[140:143]
    v_mfma_f32_4x4x4_16b_bf16 v[212:215], v[208:209], v[194:195], v[212:215] cbsz:4 abid:12
    ds_read_u8 v230, v237 offset:112
    ds_read_u8 v232, v237 offset:120
    ds_read_b64_tr_b16 v[188:189], v236 offset:6240
    ds_read_b64_tr_b16 v[190:191], v236 offset:6752
    ds_read_b64_tr_b16 v[192:193], v236 offset:7296
    ds_read_b64_tr_b16 v[194:195], v236 offset:7808
    s_waitcnt vmcnt(4)
    ds_read_b128 v[180:183], v234 offset:0
    ds_read_b128 v[184:187], v235 offset:0
    s_add_u32 m0, s52, 6240
    v_exp_f32 v146, v162
    v_exp_f32 v147, v163
    v_rcp_f32 v132, v132
    v_rcp_f32 v133, v133
    v_mfma_f32_4x4x4_16b_bf16 v[144:147], v[228:229], v[228:229], v[144:147]
    v_rcp_f32 v134, v134
    v_cvt_pk_bf16_f32 v132, v132, v133
    s_waitcnt lgkmcnt(2)
    buffer_load_dwordx4 v[230:231], s[20:23], s35 idxen offen nt lds
    buffer_load_dwordx4 v[232:233], s[40:43], s35 idxen offen offset:1056 nt lds
    s_waitcnt lgkmcnt(0)
    v_mfma_f32_16x16x32_bf16 v[148:151], v[100:103], v[180:183], v[164:167]
    v_rcp_f32 v135, v135
    v_mfma_f32_16x16x32_bf16 v[152:155], v[108:111], v[180:183], v[168:171]
    v_rcp_f32 v136, v136
    v_cvt_pk_bf16_f32 v133, v134, v135
    v_mfma_f32_16x16x32_bf16 v[148:151], v[104:107], v[184:187], v[148:151]
    v_rcp_f32 v137, v137
    v_mfma_f32_16x16x32_bf16 v[152:155], v[112:115], v[184:187], v[152:155]
    v_rcp_f32 v138, v138
    v_cvt_pk_bf16_f32 v134, v136, v137
    v_mfma_f32_16x16x32_bf16 v[156:159], v[116:119], v[180:183], v[172:175]
    v_rcp_f32 v139, v139
    v_mfma_f32_16x16x32_bf16 v[160:163], v[124:127], v[180:183], v[176:179]
    v_rcp_f32 v140, v140
    v_cvt_pk_bf16_f32 v135, v138, v139
    v_mfma_f32_16x16x32_bf16 v[156:159], v[120:123], v[184:187], v[156:159]
    v_rcp_f32 v141, v141
    v_mfma_f32_16x16x32_bf16 v[160:163], v[128:131], v[184:187], v[160:163]
    v_rcp_f32 v142, v142
    v_cvt_pk_bf16_f32 v136, v140, v141
    v_mfma_f32_16x16x32_bf16 v[208:211], v[132:135], v[196:199], v[204:207]
    v_rcp_f32 v143, v143
    v_rcp_f32 v144, v144
    v_cvt_pk_bf16_f32 v137, v142, v143
    s_lshr_b64 s[56:57], s[56:57], 4
    s_lshr_b64 s[86:87], s[56:57], 2
    s_lshr_b64 s[36:37], s[56:57], 5
    s_or_b32 s36, s36, s86
    s_or_b32 s36, s36, s56
    v_add_u32 v237, 64, v237
    v_add_u32 v244, 64, v244
    v_rcp_f32 v145, v145
    v_rcp_f32 v146, v146
    v_rcp_f32 v147, v147
    v_cvt_pk_bf16_f32 v138, v144, v145
    v_cvt_pk_bf16_f32 v139, v146, v147
    s_branch Ls_loop
Ls_ev0:
    s_bitcmp0_b64 s[56:57], 0
    s_cbranch_scc1 Ls_nf0
    v_cvt_pk_bf16_f32 v246, v212, v212
    v_mov_b32 v212, 0
    ds_write_b16 v240, v246
    v_add_u32 v240, 128, v240
    s_add_u32 s24, s24, s32
    s_addc_u32 s25, s25, 0
    s_xor_b32 s32, s32, 0x18ffe0
Ls_nf0:
    s_bitcmp0_b64 s[56:57], 5
    s_cbranch_scc1 Ls_na0
    s_sub_u32 s60, s60, 1
    s_cbranch_scc0 Ls_ns0
    s_mov_b32 s49, 5
    s_call_b64 s[62:63], L_swap
    s_add_u32 s35, s35, s31
    s_min_u32 s35, s35, 419404800
    s_xor_b32 s31, s31, 0x63ff800
    s_bitcmp0_b64 s[56:57], 2
    s_cbranch_scc1 Ls_evd0
    s_waitcnt lgkmcnt(0)
    s_branch Ls_e10
Ls_ns0:
    s_add_u32 s35, s35, s31
    s_min_u32 s35, s35, 419404800
    s_xor_b32 s31, s31, 0x63ff800
Ls_na0:
    s_bitcmp0_b64 s[56:57], 2
    s_cbranch_scc1 Ls_evd0
Ls_e10:
    s_sub_u32 s61, s61, 1
    s_cbranch_scc1 Ls_last0
    s_bitcmp0_b32 s33, s61
    s_cbranch_scc1 Ls_nw0
    s_cmp_eq_u32 s61, 3
    s_cselect_b32 s66, s80, s81
    v_add_u32 v238, s66, v238
    v_add_u32 v239, s66, v239
    ds_read_u16 v224, v238 offset:0
    ds_read_u16 v225, v238 offset:8
    ds_read_u16 v226, v238 offset:64
    ds_read_u16 v227, v238 offset:72
    s_waitcnt lgkmcnt(0)
Ls_nw0:
    v_mul_u32_u24 v216, v224, v241
    v_mul_u32_u24 v217, v224, v242
    v_mul_u32_u24 v218, v225, v241
    v_mul_u32_u24 v219, v225, v242
    v_mul_u32_u24 v220, v226, v241
    v_mul_u32_u24 v221, v226, v242
    v_mul_u32_u24 v222, v227, v241
    v_mul_u32_u24 v223, v227, v242
    v_mfma_f32_4x4x4_16b_bf16 v[140:143], v[216:217], v[68:69], v[4:7]
    v_add_u32 v238, 128, v238
    ds_read_b128 v[164:167], v239 offset:0
    ds_read_b128 v[168:171], v239 offset:64
    v_mfma_f32_4x4x4_16b_bf16 v[144:147], v[218:219], v[70:71], v[8:11]
    ds_read_b128 v[172:175], v239 offset:128
    ds_read_b128 v[176:179], v239 offset:192
    ds_read_u16 v224, v238 offset:0
    ds_read_u16 v225, v238 offset:8
    ds_read_u16 v226, v238 offset:64
    ds_read_u16 v227, v238 offset:72
    v_mfma_f32_4x4x4_16b_bf16 v[246:249], v[220:221], v[72:73], v[12:15]
    v_cvt_pk_bf16_f32 v100, v140, v141
    v_cvt_pk_bf16_f32 v101, v142, v143
    v_mfma_f32_4x4x4_16b_bf16 v[250:253], v[222:223], v[74:75], v[16:19]
    v_cvt_pk_bf16_f32 v102, v144, v145
    v_cvt_pk_bf16_f32 v103, v146, v147
    v_mfma_f32_4x4x4_16b_bf16 v[140:143], v[216:217], v[76:77], v[20:23]
    v_cvt_pk_bf16_f32 v104, v246, v247
    v_cvt_pk_bf16_f32 v105, v248, v249
    v_mfma_f32_4x4x4_16b_bf16 v[144:147], v[218:219], v[78:79], v[24:27]
    v_cvt_pk_bf16_f32 v106, v250, v251
    v_cvt_pk_bf16_f32 v107, v252, v253
    v_mfma_f32_4x4x4_16b_bf16 v[246:249], v[220:221], v[80:81], v[28:31]
    v_cvt_pk_bf16_f32 v108, v140, v141
    v_cvt_pk_bf16_f32 v109, v142, v143
    v_mfma_f32_4x4x4_16b_bf16 v[250:253], v[222:223], v[82:83], v[32:35]
    v_cvt_pk_bf16_f32 v110, v144, v145
    v_cvt_pk_bf16_f32 v111, v146, v147
    v_mfma_f32_4x4x4_16b_bf16 v[140:143], v[216:217], v[84:85], v[36:39]
    v_cvt_pk_bf16_f32 v112, v246, v247
    v_cvt_pk_bf16_f32 v113, v248, v249
    v_mfma_f32_4x4x4_16b_bf16 v[144:147], v[218:219], v[86:87], v[40:43]
    v_cvt_pk_bf16_f32 v114, v250, v251
    v_cvt_pk_bf16_f32 v115, v252, v253
    v_mfma_f32_4x4x4_16b_bf16 v[246:249], v[220:221], v[88:89], v[44:47]
    v_cvt_pk_bf16_f32 v116, v140, v141
    v_cvt_pk_bf16_f32 v117, v142, v143
    v_mfma_f32_4x4x4_16b_bf16 v[250:253], v[222:223], v[90:91], v[48:51]
    v_cvt_pk_bf16_f32 v118, v144, v145
    v_cvt_pk_bf16_f32 v119, v146, v147
    v_mfma_f32_4x4x4_16b_bf16 v[140:143], v[216:217], v[92:93], v[52:55]
    v_cvt_pk_bf16_f32 v120, v246, v247
    v_cvt_pk_bf16_f32 v121, v248, v249
    v_mfma_f32_4x4x4_16b_bf16 v[144:147], v[218:219], v[94:95], v[56:59]
    v_cvt_pk_bf16_f32 v122, v250, v251
    v_cvt_pk_bf16_f32 v123, v252, v253
    v_mfma_f32_4x4x4_16b_bf16 v[246:249], v[220:221], v[96:97], v[60:63]
    v_cvt_pk_bf16_f32 v124, v140, v141
    v_cvt_pk_bf16_f32 v125, v142, v143
    v_mfma_f32_4x4x4_16b_bf16 v[250:253], v[222:223], v[98:99], v[64:67]
    v_cvt_pk_bf16_f32 v126, v144, v145
    v_cvt_pk_bf16_f32 v127, v146, v147
    v_cvt_pk_bf16_f32 v128, v246, v247
    v_cvt_pk_bf16_f32 v129, v248, v249
    v_add_u32 v239, 272, v239
    v_cvt_pk_bf16_f32 v130, v250, v251
    v_cvt_pk_bf16_f32 v131, v252, v253
    s_waitcnt lgkmcnt(0)
    s_branch Ls_evd0
Ls_ev1:
    s_bitcmp0_b64 s[56:57], 1
    s_cbranch_scc1 Ls_nf1
    v_cvt_pk_bf16_f32 v246, v212, v212
    v_mov_b32 v212, 0
    ds_write_b16 v240, v246
    v_add_u32 v240, 128, v240
    s_add_u32 s24, s24, s32
    s_addc_u32 s25, s25, 0
    s_xor_b32 s32, s32, 0x18ffe0
Ls_nf1:
    s_bitcmp0_b64 s[56:57], 6
    s_cbranch_scc1 Ls_na1
    s_sub_u32 s60, s60, 1
    s_cbranch_scc0 Ls_ns1
    s_mov_b32 s49, 6
    s_call_b64 s[62:63], L_swap
    s_add_u32 s35, s35, s31
    s_min_u32 s35, s35, 419404800
    s_xor_b32 s31, s31, 0x63ff800
    s_bitcmp0_b64 s[56:57], 3
    s_cbranch_scc1 Ls_evd1
    s_waitcnt lgkmcnt(0)
    s_branch Ls_e11
Ls_ns1:
    s_add_u32 s35, s35, s31
    s_min_u32 s35, s35, 419404800
    s_xor_b32 s31, s31, 0x63ff800
Ls_na1:
    s_bitcmp0_b64 s[56:57], 3
    s_cbranch_scc1 Ls_evd1
Ls_e11:
    s_sub_u32 s61, s61, 1
    s_cbranch_scc1 Ls_last1
    s_bitcmp0_b32 s33, s61
    s_cbranch_scc1 Ls_nw1
    s_cmp_eq_u32 s61, 3
    s_cselect_b32 s66, s80, s81
    v_add_u32 v238, s66, v238
    v_add_u32 v239, s66, v239
    ds_read_u16 v224, v238 offset:0
    ds_read_u16 v225, v238 offset:8
    ds_read_u16 v226, v238 offset:64
    ds_read_u16 v227, v238 offset:72
    s_waitcnt lgkmcnt(0)
Ls_nw1:
    v_mul_u32_u24 v216, v224, v241
    v_mul_u32_u24 v217, v224, v242
    v_mul_u32_u24 v218, v225, v241
    v_mul_u32_u24 v219, v225, v242
    v_mul_u32_u24 v220, v226, v241
    v_mul_u32_u24 v221, v226, v242
    v_mul_u32_u24 v222, v227, v241
    v_mul_u32_u24 v223, v227, v242
    v_mfma_f32_4x4x4_16b_bf16 v[140:143], v[216:217], v[68:69], v[4:7]
    v_add_u32 v238, 128, v238
    ds_read_b128 v[164:167], v239 offset:0
    ds_read_b128 v[168:171], v239 offset:64
    v_mfma_f32_4x4x4_16b_bf16 v[144:147], v[218:219], v[70:71], v[8:11]
    ds_read_b128 v[172:175], v239 offset:128
    ds_read_b128 v[176:179], v239 offset:192
    ds_read_u16 v224, v238 offset:0
    ds_read_u16 v225, v238 offset:8
    ds_read_u16 v226, v238 offset:64
    ds_read_u16 v227, v238 offset:72
    v_mfma_f32_4x4x4_16b_bf16 v[246:249], v[220:221], v[72:73], v[12:15]
    v_cvt_pk_bf16_f32 v100, v140, v141
    v_cvt_pk_bf16_f32 v101, v142, v143
    v_mfma_f32_4x4x4_16b_bf16 v[250:253], v[222:223], v[74:75], v[16:19]
    v_cvt_pk_bf16_f32 v102, v144, v145
    v_cvt_pk_bf16_f32 v103, v146, v147
    v_mfma_f32_4x4x4_16b_bf16 v[140:143], v[216:217], v[76:77], v[20:23]
    v_cvt_pk_bf16_f32 v104, v246, v247
    v_cvt_pk_bf16_f32 v105, v248, v249
    v_mfma_f32_4x4x4_16b_bf16 v[144:147], v[218:219], v[78:79], v[24:27]
    v_cvt_pk_bf16_f32 v106, v250, v251
    v_cvt_pk_bf16_f32 v107, v252, v253
    v_mfma_f32_4x4x4_16b_bf16 v[246:249], v[220:221], v[80:81], v[28:31]
    v_cvt_pk_bf16_f32 v108, v140, v141
    v_cvt_pk_bf16_f32 v109, v142, v143
    v_mfma_f32_4x4x4_16b_bf16 v[250:253], v[222:223], v[82:83], v[32:35]
    v_cvt_pk_bf16_f32 v110, v144, v145
    v_cvt_pk_bf16_f32 v111, v146, v147
    v_mfma_f32_4x4x4_16b_bf16 v[140:143], v[216:217], v[84:85], v[36:39]
    v_cvt_pk_bf16_f32 v112, v246, v247
    v_cvt_pk_bf16_f32 v113, v248, v249
    v_mfma_f32_4x4x4_16b_bf16 v[144:147], v[218:219], v[86:87], v[40:43]
    v_cvt_pk_bf16_f32 v114, v250, v251
    v_cvt_pk_bf16_f32 v115, v252, v253
    v_mfma_f32_4x4x4_16b_bf16 v[246:249], v[220:221], v[88:89], v[44:47]
    v_cvt_pk_bf16_f32 v116, v140, v141
    v_cvt_pk_bf16_f32 v117, v142, v143
    v_mfma_f32_4x4x4_16b_bf16 v[250:253], v[222:223], v[90:91], v[48:51]
    v_cvt_pk_bf16_f32 v118, v144, v145
    v_cvt_pk_bf16_f32 v119, v146, v147
    v_mfma_f32_4x4x4_16b_bf16 v[140:143], v[216:217], v[92:93], v[52:55]
    v_cvt_pk_bf16_f32 v120, v246, v247
    v_cvt_pk_bf16_f32 v121, v248, v249
    v_mfma_f32_4x4x4_16b_bf16 v[144:147], v[218:219], v[94:95], v[56:59]
    v_cvt_pk_bf16_f32 v122, v250, v251
    v_cvt_pk_bf16_f32 v123, v252, v253
    v_mfma_f32_4x4x4_16b_bf16 v[246:249], v[220:221], v[96:97], v[60:63]
    v_cvt_pk_bf16_f32 v124, v140, v141
    v_cvt_pk_bf16_f32 v125, v142, v143
    v_mfma_f32_4x4x4_16b_bf16 v[250:253], v[222:223], v[98:99], v[64:67]
    v_cvt_pk_bf16_f32 v126, v144, v145
    v_cvt_pk_bf16_f32 v127, v146, v147
    v_cvt_pk_bf16_f32 v128, v246, v247
    v_cvt_pk_bf16_f32 v129, v248, v249
    v_add_u32 v239, 272, v239
    v_cvt_pk_bf16_f32 v130, v250, v251
    v_cvt_pk_bf16_f32 v131, v252, v253
    s_waitcnt lgkmcnt(0)
    s_branch Ls_evd1
Ls_ev2:
    s_bitcmp0_b64 s[56:57], 2
    s_cbranch_scc1 Ls_nf2
    v_cvt_pk_bf16_f32 v246, v212, v212
    v_mov_b32 v212, 0
    ds_write_b16 v240, v246
    v_add_u32 v240, 128, v240
    s_add_u32 s24, s24, s32
    s_addc_u32 s25, s25, 0
    s_xor_b32 s32, s32, 0x18ffe0
Ls_nf2:
    s_bitcmp0_b64 s[56:57], 7
    s_cbranch_scc1 Ls_na2
    s_sub_u32 s60, s60, 1
    s_cbranch_scc0 Ls_ns2
    s_mov_b32 s49, 7
    s_call_b64 s[62:63], L_swap
    s_add_u32 s35, s35, s31
    s_min_u32 s35, s35, 419404800
    s_xor_b32 s31, s31, 0x63ff800
    s_bitcmp0_b64 s[56:57], 4
    s_cbranch_scc1 Ls_evd2
    s_waitcnt lgkmcnt(0)
    s_branch Ls_e12
Ls_ns2:
    s_add_u32 s35, s35, s31
    s_min_u32 s35, s35, 419404800
    s_xor_b32 s31, s31, 0x63ff800
Ls_na2:
    s_bitcmp0_b64 s[56:57], 4
    s_cbranch_scc1 Ls_evd2
Ls_e12:
    s_sub_u32 s61, s61, 1
    s_cbranch_scc1 Ls_last2
    s_bitcmp0_b32 s33, s61
    s_cbranch_scc1 Ls_nw2
    s_cmp_eq_u32 s61, 3
    s_cselect_b32 s66, s80, s81
    v_add_u32 v238, s66, v238
    v_add_u32 v239, s66, v239
    ds_read_u16 v224, v238 offset:0
    ds_read_u16 v225, v238 offset:8
    ds_read_u16 v226, v238 offset:64
    ds_read_u16 v227, v238 offset:72
    s_waitcnt lgkmcnt(0)
Ls_nw2:
    v_mul_u32_u24 v216, v224, v241
    v_mul_u32_u24 v217, v224, v242
    v_mul_u32_u24 v218, v225, v241
    v_mul_u32_u24 v219, v225, v242
    v_mul_u32_u24 v220, v226, v241
    v_mul_u32_u24 v221, v226, v242
    v_mul_u32_u24 v222, v227, v241
    v_mul_u32_u24 v223, v227, v242
    v_mfma_f32_4x4x4_16b_bf16 v[140:143], v[216:217], v[68:69], v[4:7]
    v_add_u32 v238, 128, v238
    ds_read_b128 v[164:167], v239 offset:0
    ds_read_b128 v[168:171], v239 offset:64
    v_mfma_f32_4x4x4_16b_bf16 v[144:147], v[218:219], v[70:71], v[8:11]
    ds_read_b128 v[172:175], v239 offset:128
    ds_read_b128 v[176:179], v239 offset:192
    ds_read_u16 v224, v238 offset:0
    ds_read_u16 v225, v238 offset:8
    ds_read_u16 v226, v238 offset:64
    ds_read_u16 v227, v238 offset:72
    v_mfma_f32_4x4x4_16b_bf16 v[246:249], v[220:221], v[72:73], v[12:15]
    v_cvt_pk_bf16_f32 v100, v140, v141
    v_cvt_pk_bf16_f32 v101, v142, v143
    v_mfma_f32_4x4x4_16b_bf16 v[250:253], v[222:223], v[74:75], v[16:19]
    v_cvt_pk_bf16_f32 v102, v144, v145
    v_cvt_pk_bf16_f32 v103, v146, v147
    v_mfma_f32_4x4x4_16b_bf16 v[140:143], v[216:217], v[76:77], v[20:23]
    v_cvt_pk_bf16_f32 v104, v246, v247
    v_cvt_pk_bf16_f32 v105, v248, v249
    v_mfma_f32_4x4x4_16b_bf16 v[144:147], v[218:219], v[78:79], v[24:27]
    v_cvt_pk_bf16_f32 v106, v250, v251
    v_cvt_pk_bf16_f32 v107, v252, v253
    v_mfma_f32_4x4x4_16b_bf16 v[246:249], v[220:221], v[80:81], v[28:31]
    v_cvt_pk_bf16_f32 v108, v140, v141
    v_cvt_pk_bf16_f32 v109, v142, v143
    v_mfma_f32_4x4x4_16b_bf16 v[250:253], v[222:223], v[82:83], v[32:35]
    v_cvt_pk_bf16_f32 v110, v144, v145
    v_cvt_pk_bf16_f32 v111, v146, v147
    v_mfma_f32_4x4x4_16b_bf16 v[140:143], v[216:217], v[84:85], v[36:39]
    v_cvt_pk_bf16_f32 v112, v246, v247
    v_cvt_pk_bf16_f32 v113, v248, v249
    v_mfma_f32_4x4x4_16b_bf16 v[144:147], v[218:219], v[86:87], v[40:43]
    v_cvt_pk_bf16_f32 v114, v250, v251
    v_cvt_pk_bf16_f32 v115, v252, v253
    v_mfma_f32_4x4x4_16b_bf16 v[246:249], v[220:221], v[88:89], v[44:47]
    v_cvt_pk_bf16_f32 v116, v140, v141
    v_cvt_pk_bf16_f32 v117, v142, v143
    v_mfma_f32_4x4x4_16b_bf16 v[250:253], v[222:223], v[90:91], v[48:51]
    v_cvt_pk_bf16_f32 v118, v144, v145
    v_cvt_pk_bf16_f32 v119, v146, v147
    v_mfma_f32_4x4x4_16b_bf16 v[140:143], v[216:217], v[92:93], v[52:55]
    v_cvt_pk_bf16_f32 v120, v246, v247
    v_cvt_pk_bf16_f32 v121, v248, v249
    v_mfma_f32_4x4x4_16b_bf16 v[144:147], v[218:219], v[94:95], v[56:59]
    v_cvt_pk_bf16_f32 v122, v250, v251
    v_cvt_pk_bf16_f32 v123, v252, v253
    v_mfma_f32_4x4x4_16b_bf16 v[246:249], v[220:221], v[96:97], v[60:63]
    v_cvt_pk_bf16_f32 v124, v140, v141
    v_cvt_pk_bf16_f32 v125, v142, v143
    v_mfma_f32_4x4x4_16b_bf16 v[250:253], v[222:223], v[98:99], v[64:67]
    v_cvt_pk_bf16_f32 v126, v144, v145
    v_cvt_pk_bf16_f32 v127, v146, v147
    v_cvt_pk_bf16_f32 v128, v246, v247
    v_cvt_pk_bf16_f32 v129, v248, v249
    v_add_u32 v239, 272, v239
    v_cvt_pk_bf16_f32 v130, v250, v251
    v_cvt_pk_bf16_f32 v131, v252, v253
    s_waitcnt lgkmcnt(0)
    s_branch Ls_evd2
Ls_ev3:
    s_bitcmp0_b64 s[56:57], 3
    s_cbranch_scc1 Ls_nf3
    v_cvt_pk_bf16_f32 v246, v212, v212
    v_mov_b32 v212, 0
    ds_write_b16 v240, v246
    v_add_u32 v240, 128, v240
    s_add_u32 s24, s24, s32
    s_addc_u32 s25, s25, 0
    s_xor_b32 s32, s32, 0x18ffe0
Ls_nf3:
    s_bitcmp0_b64 s[56:57], 8
    s_cbranch_scc1 Ls_na3
    s_sub_u32 s60, s60, 1
    s_cbranch_scc0 Ls_ns3
    s_mov_b32 s49, 8
    s_call_b64 s[62:63], L_swap
    s_add_u32 s35, s35, s31
    s_min_u32 s35, s35, 419404800
    s_xor_b32 s31, s31, 0x63ff800
    s_bitcmp0_b64 s[56:57], 5
    s_cbranch_scc1 Ls_evd3
    s_waitcnt lgkmcnt(0)
    s_branch Ls_e13
Ls_ns3:
    s_add_u32 s35, s35, s31
    s_min_u32 s35, s35, 419404800
    s_xor_b32 s31, s31, 0x63ff800
Ls_na3:
    s_bitcmp0_b64 s[56:57], 5
    s_cbranch_scc1 Ls_evd3
Ls_e13:
    s_sub_u32 s61, s61, 1
    s_cbranch_scc1 Ls_last3
    s_bitcmp0_b32 s33, s61
    s_cbranch_scc1 Ls_nw3
    s_cmp_eq_u32 s61, 3
    s_cselect_b32 s66, s80, s81
    v_add_u32 v238, s66, v238
    v_add_u32 v239, s66, v239
    ds_read_u16 v224, v238 offset:0
    ds_read_u16 v225, v238 offset:8
    ds_read_u16 v226, v238 offset:64
    ds_read_u16 v227, v238 offset:72
    s_waitcnt lgkmcnt(0)
Ls_nw3:
    v_mul_u32_u24 v216, v224, v241
    v_mul_u32_u24 v217, v224, v242
    v_mul_u32_u24 v218, v225, v241
    v_mul_u32_u24 v219, v225, v242
    v_mul_u32_u24 v220, v226, v241
    v_mul_u32_u24 v221, v226, v242
    v_mul_u32_u24 v222, v227, v241
    v_mul_u32_u24 v223, v227, v242
    v_mfma_f32_4x4x4_16b_bf16 v[140:143], v[216:217], v[68:69], v[4:7]
    v_add_u32 v238, 128, v238
    ds_read_b128 v[164:167], v239 offset:0
    ds_read_b128 v[168:171], v239 offset:64
    v_mfma_f32_4x4x4_16b_bf16 v[144:147], v[218:219], v[70:71], v[8:11]
    ds_read_b128 v[172:175], v239 offset:128
    ds_read_b128 v[176:179], v239 offset:192
    ds_read_u16 v224, v238 offset:0
    ds_read_u16 v225, v238 offset:8
    ds_read_u16 v226, v238 offset:64
    ds_read_u16 v227, v238 offset:72
    v_mfma_f32_4x4x4_16b_bf16 v[246:249], v[220:221], v[72:73], v[12:15]
    v_cvt_pk_bf16_f32 v100, v140, v141
    v_cvt_pk_bf16_f32 v101, v142, v143
    v_mfma_f32_4x4x4_16b_bf16 v[250:253], v[222:223], v[74:75], v[16:19]
    v_cvt_pk_bf16_f32 v102, v144, v145
    v_cvt_pk_bf16_f32 v103, v146, v147
    v_mfma_f32_4x4x4_16b_bf16 v[140:143], v[216:217], v[76:77], v[20:23]
    v_cvt_pk_bf16_f32 v104, v246, v247
    v_cvt_pk_bf16_f32 v105, v248, v249
    v_mfma_f32_4x4x4_16b_bf16 v[144:147], v[218:219], v[78:79], v[24:27]
    v_cvt_pk_bf16_f32 v106, v250, v251
    v_cvt_pk_bf16_f32 v107, v252, v253
    v_mfma_f32_4x4x4_16b_bf16 v[246:249], v[220:221], v[80:81], v[28:31]
    v_cvt_pk_bf16_f32 v108, v140, v141
    v_cvt_pk_bf16_f32 v109, v142, v143
    v_mfma_f32_4x4x4_16b_bf16 v[250:253], v[222:223], v[82:83], v[32:35]
    v_cvt_pk_bf16_f32 v110, v144, v145
    v_cvt_pk_bf16_f32 v111, v146, v147
    v_mfma_f32_4x4x4_16b_bf16 v[140:143], v[216:217], v[84:85], v[36:39]
    v_cvt_pk_bf16_f32 v112, v246, v247
    v_cvt_pk_bf16_f32 v113, v248, v249
    v_mfma_f32_4x4x4_16b_bf16 v[144:147], v[218:219], v[86:87], v[40:43]
    v_cvt_pk_bf16_f32 v114, v250, v251
    v_cvt_pk_bf16_f32 v115, v252, v253
    v_mfma_f32_4x4x4_16b_bf16 v[246:249], v[220:221], v[88:89], v[44:47]
    v_cvt_pk_bf16_f32 v116, v140, v141
    v_cvt_pk_bf16_f32 v117, v142, v143
    v_mfma_f32_4x4x4_16b_bf16 v[250:253], v[222:223], v[90:91], v[48:51]
    v_cvt_pk_bf16_f32 v118, v144, v145
    v_cvt_pk_bf16_f32 v119, v146, v147
    v_mfma_f32_4x4x4_16b_bf16 v[140:143], v[216:217], v[92:93], v[52:55]
    v_cvt_pk_bf16_f32 v120, v246, v247
    v_cvt_pk_bf16_f32 v121, v248, v249
    v_mfma_f32_4x4x4_16b_bf16 v[144:147], v[218:219], v[94:95], v[56:59]
    v_cvt_pk_bf16_f32 v122, v250, v251
    v_cvt_pk_bf16_f32 v123, v252, v253
    v_mfma_f32_4x4x4_16b_bf16 v[246:249], v[220:221], v[96:97], v[60:63]
    v_cvt_pk_bf16_f32 v124, v140, v141
    v_cvt_pk_bf16_f32 v125, v142, v143
    v_mfma_f32_4x4x4_16b_bf16 v[250:253], v[222:223], v[98:99], v[64:67]
    v_cvt_pk_bf16_f32 v126, v144, v145
    v_cvt_pk_bf16_f32 v127, v146, v147
    v_cvt_pk_bf16_f32 v128, v246, v247
    v_cvt_pk_bf16_f32 v129, v248, v249
    v_add_u32 v239, 272, v239
    v_cvt_pk_bf16_f32 v130, v250, v251
    v_cvt_pk_bf16_f32 v131, v252, v253
    s_waitcnt lgkmcnt(0)
    s_branch Ls_evd3
Ls_last0:
    s_branch Ls_tail
Ls_last1:
    v_add_u32 v236, 2080, v236
    s_lshr_b64 s[56:57], s[56:57], 1
    v_add_u32 v244, 16, v244
    s_branch Ls_tail
Ls_last2:
    v_add_u32 v236, 4160, v236
    s_lshr_b64 s[56:57], s[56:57], 2
    v_add_u32 v244, 32, v244
    s_branch Ls_tail
Ls_last3:
    v_add_u32 v236, 6240, v236
    s_lshr_b64 s[56:57], s[56:57], 3
    v_add_u32 v244, 48, v244
Ls_tail:
    v_mfma_f32_16x16x32_bf16 v[208:211], v[136:139], v[200:203], v[208:211]
    ds_read_b32 v246, v244 offset:0
    s_waitcnt lgkmcnt(0)
    v_bfe_u32 v247, v246, 0, 8
    v_lshlrev_b32 v247, 1, v247
    v_bfe_u32 v248, v246, 8, 8
    v_lshlrev_b32 v248, 1, v248
    v_bfe_u32 v249, v246, 16, 8
    v_lshlrev_b32 v249, 1, v249
    v_bfe_u32 v250, v246, 24, 8
    v_lshlrev_b32 v250, 1, v250
    buffer_load_ushort v247, v247, s[24:27], 0 offen
    buffer_load_ushort v248, v248, s[24:27], 0 offen
    buffer_load_ushort v249, v249, s[24:27], 0 offen
    buffer_load_ushort v250, v250, s[24:27], 0 offen
    s_waitcnt vmcnt(0)
    v_lshlrev_b32 v247, 16, v247
    v_mul_f32 v208, v208, v247
    v_lshlrev_b32 v248, 16, v248
    v_mul_f32 v209, v209, v248
    v_lshlrev_b32 v249, 16, v249
    v_mul_f32 v210, v210, v249
    v_lshlrev_b32 v250, 16, v250
    v_mul_f32 v211, v211, v250
    v_exp_f32 v132, v148
    v_exp_f32 v133, v149
    v_exp_f32 v134, v150
    v_exp_f32 v135, v151
    v_exp_f32 v136, v152
    v_exp_f32 v137, v153
    v_mfma_f32_4x4x4_16b_bf16 v[132:135], v[228:229], v[228:229], v[132:135]
    v_exp_f32 v138, v154
    v_exp_f32 v139, v155
    v_cvt_pk_bf16_f32 v208, v208, v209
    v_cvt_pk_bf16_f32 v209, v210, v211
    v_exp_f32 v140, v156
    v_exp_f32 v141, v157
    v_mfma_f32_4x4x4_16b_bf16 v[212:215], v[208:209], v[188:189], v[212:215] cbsz:4 abid:0
    v_mfma_f32_4x4x4_16b_bf16 v[136:139], v[228:229], v[228:229], v[136:139]
    v_exp_f32 v142, v158
    v_mfma_f32_4x4x4_16b_bf16 v[212:215], v[208:209], v[190:191], v[212:215] cbsz:4 abid:4
    v_exp_f32 v143, v159
    v_exp_f32 v144, v160
    v_mfma_f32_4x4x4_16b_bf16 v[212:215], v[208:209], v[192:193], v[212:215] cbsz:4 abid:8
    v_exp_f32 v145, v161
    v_mfma_f32_4x4x4_16b_bf16 v[140:143], v[228:229], v[228:229], v[140:143]
    v_mfma_f32_4x4x4_16b_bf16 v[212:215], v[208:209], v[194:195], v[212:215] cbsz:4 abid:12
    ds_read_b64_tr_b16 v[188:189], v236 offset:0
    ds_read_b64_tr_b16 v[190:191], v236 offset:512
    ds_read_b64_tr_b16 v[192:193], v236 offset:1056
    ds_read_b64_tr_b16 v[194:195], v236 offset:1568
    v_exp_f32 v146, v162
    v_exp_f32 v147, v163
    v_rcp_f32 v132, v132
    v_rcp_f32 v133, v133
    v_mfma_f32_4x4x4_16b_bf16 v[144:147], v[228:229], v[228:229], v[144:147]
    v_rcp_f32 v134, v134
    s_bitcmp0_b64 s[56:57], 1
    s_cbranch_scc1 Ls_tnf
    v_cvt_pk_bf16_f32 v246, v212, v212
    v_mov_b32 v212, 0
    ds_write_b16 v240, v246
    v_add_u32 v240, 128, v240
    s_add_u32 s24, s24, s32
    s_addc_u32 s25, s25, 0
    s_xor_b32 s32, s32, 0x18ffe0
Ls_tnf:
    v_cvt_pk_bf16_f32 v132, v132, v133
    s_waitcnt lgkmcnt(0)
    v_rcp_f32 v135, v135
    v_rcp_f32 v136, v136
    v_cvt_pk_bf16_f32 v133, v134, v135
    v_rcp_f32 v137, v137
    v_rcp_f32 v138, v138
    v_cvt_pk_bf16_f32 v134, v136, v137
    v_rcp_f32 v139, v139
    v_rcp_f32 v140, v140
    v_cvt_pk_bf16_f32 v135, v138, v139
    v_rcp_f32 v141, v141
    v_rcp_f32 v142, v142
    v_cvt_pk_bf16_f32 v136, v140, v141
    v_mfma_f32_16x16x32_bf16 v[208:211], v[132:135], v[196:199], v[204:207]
    v_rcp_f32 v143, v143
    v_rcp_f32 v144, v144
    v_cvt_pk_bf16_f32 v137, v142, v143
    v_rcp_f32 v145, v145
    v_rcp_f32 v146, v146
    v_rcp_f32 v147, v147
    v_cvt_pk_bf16_f32 v138, v144, v145
    v_cvt_pk_bf16_f32 v139, v146, v147
    s_nop 1
    v_mfma_f32_16x16x32_bf16 v[208:211], v[136:139], v[200:203], v[208:211]
    ds_read_b32 v246, v244 offset:16
    s_waitcnt lgkmcnt(0)
    v_bfe_u32 v247, v246, 0, 8
    v_lshlrev_b32 v247, 1, v247
    v_bfe_u32 v248, v246, 8, 8
    v_lshlrev_b32 v248, 1, v248
    v_bfe_u32 v249, v246, 16, 8
    v_lshlrev_b32 v249, 1, v249
    v_bfe_u32 v250, v246, 24, 8
    v_lshlrev_b32 v250, 1, v250
    buffer_load_ushort v247, v247, s[24:27], 0 offen
    buffer_load_ushort v248, v248, s[24:27], 0 offen
    buffer_load_ushort v249, v249, s[24:27], 0 offen
    buffer_load_ushort v250, v250, s[24:27], 0 offen
    s_waitcnt vmcnt(0)
    v_lshlrev_b32 v247, 16, v247
    v_mul_f32 v208, v208, v247
    v_lshlrev_b32 v248, 16, v248
    v_mul_f32 v209, v209, v248
    v_lshlrev_b32 v249, 16, v249
    v_mul_f32 v210, v210, v249
    v_lshlrev_b32 v250, 16, v250
    v_mul_f32 v211, v211, v250
    v_cvt_pk_bf16_f32 v208, v208, v209
    v_cvt_pk_bf16_f32 v209, v210, v211
    s_nop 1
    v_mfma_f32_4x4x4_16b_bf16 v[212:215], v[208:209], v[188:189], v[212:215] cbsz:4 abid:0
    s_nop 1
    v_mfma_f32_4x4x4_16b_bf16 v[212:215], v[208:209], v[190:191], v[212:215] cbsz:4 abid:4
    s_nop 1
    v_mfma_f32_4x4x4_16b_bf16 v[212:215], v[208:209], v[192:193], v[212:215] cbsz:4 abid:8
    s_nop 1
    v_mfma_f32_4x4x4_16b_bf16 v[212:215], v[208:209], v[194:195], v[212:215] cbsz:4 abid:12
    s_nop 4
    v_cvt_pk_bf16_f32 v246, v212, v212
    ds_write_b16 v240, v246
    s_branch L_store
.section .rodata,"a"
.p2align 6
.amdhsa_kernel standalone__sequential_behavior_din__recsys_kernel
  .amdhsa_next_free_vgpr 256
  .amdhsa_next_free_sgpr 102
  .amdhsa_accum_offset 256
  .amdhsa_group_segment_fixed_size 0
  .amdhsa_kernarg_size 80
  .amdhsa_user_sgpr_count 2
  .amdhsa_user_sgpr_kernarg_segment_ptr 1
  .amdhsa_system_sgpr_workgroup_id_x 1
.end_amdhsa_kernel
```

```asm
; @launch grid=(256,1,1) block=(512,1,1) lds=163840
.amdgcn_target "amdgcn-amd-amdhsa--gfx950"
.text
.globl standalone__sequential_behavior_din__recsys_kernel
.p2align 8
.type standalone__sequential_behavior_din__recsys_kernel,@function
standalone__sequential_behavior_din__recsys_kernel:
    s_load_dwordx16 s[4:19], s[0:1], 0
    s_cmp_ge_u32 s2, 256
    s_cbranch_scc1 L_end
    v_lshrrev_b32 v1, 6, v0
    v_and_b32 v0, 63, v0
    v_readfirstlane_b32 s54, v1
    s_lshl_b32 s53, s2, 3
    v_lshlrev_b32 v2, 4, v0
    v_lshrrev_b32 v1, 4, v0
    v_and_b32 v3, 0xf0, v2
    v_lshlrev_b32 v3, 2, v3
    v_lshl_add_u32 v130, v1, 4, v3
    v_bfrev_b32 v3, 1
    s_add_u32 s53, s53, s54
    s_movk_i32 s66, 800
    v_cmp_gt_u32 vcc, s66, v130
    s_mul_i32 s93, s53, 800
    s_mul_i32 s52, s54, 20480
    s_mov_b64 s[28:29], vcc
    v_cndmask_b32 v3, v3, v130, vcc
    v_and_b32 v248, 16, v0
    v_lshlrev_b32 v246, 1, v248
    v_xor_b32 v246, v246, v2
    v_and_b32 v243, 0xf0, v2
    v_lshl_add_u32 v243, v1, 19, v243
    s_lshl_b32 s66, s53, 8
    v_add_u32 v243, s66, v243
    s_lshl_b32 s67, s54, 12
    s_add_u32 m0, s52, 8320
    s_mov_b32 s26, 6553600
    s_mov_b32 s27, 0x20000
    s_waitcnt lgkmcnt(0)
    s_mov_b32 s24, s8
    s_and_b32 s25, s9, 0xffff
    s_cmp_ge_u32 s54, 4
    s_cbranch_scc1 L_young0
    buffer_load_dwordx4 v[100:103], v3, s[24:27], s93 offen nt
L_young0:
    global_load_lds_dwordx4 v243, s[4:5] nt
    s_add_u32 m0, s52, 4160
    s_add_u32 s10, s10, s67
    s_addc_u32 s11, s11, 0
    v_xor_b32 v247, 64, v246
    global_load_lds_dwordx4 v246, s[10:11] offset:0
    global_load_lds_dwordx4 v247, s[10:11] offset:1024
    global_load_lds_dwordx4 v246, s[10:11] offset:2048
    global_load_lds_dwordx4 v247, s[10:11] offset:3072
    s_load_dword s30, s[16:17], 0
    s_and_b32 s67, s54, 3
    v_and_b32 v250, 3, v0
    s_mov_b32 s20, s6
    s_and_b32 s21, s7, 0xffff
    s_or_b32 s21, s21, 0x800000
    s_mov_b32 s22, 200
    s_mov_b32 s23, 0x20000
    s_sub_u32 s40, s20, 1056
    s_subb_u32 s41, s21, 0
    s_mov_b32 s42, 200
    s_mov_b32 s43, 0x20000
    s_mul_i32 s35, s53, 51200
    s_movk_i32 s31, 25600
    s_mov_b32 s60, 3
    s_mov_b64 s[56:57], 0
    v_mov_b32 v148, -1
    v_mov_b32 v149, -1
    v_mov_b32 v150, -1
    v_mov_b32 v151, -1
    s_add_u32 s66, s52, 18432
    v_add_u32 v152, s66, v2
    ds_write_b128 v152, v[148:151]
    ds_write_b128 v152, v[148:151] offset:1024
    s_add_u32 s64, s52, 18448
    v_mov_b32 v153, -1
    v_mov_b32 v154, -1
    v_mov_b32 v155, -1
    v_lshrrev_b32 v237, 3, v0
    v_add_u32 v237, s64, v237
    v_lshl_add_u32 v244, v1, 2, s66
    v_and_b32 v231, 0x70, v2
    v_lshlrev_b32 v248, 2, v248
    v_xor_b32 v231, v231, v248
    v_mov_b32 v233, v231
    s_movk_i32 s66, 400
    v_cmp_le_u32 vcc, s66, v130
    v_lshrrev_b32 v126, 1, v130
    s_movk_i32 s66, -200
    v_cndmask_b32 v130, 0, 1, vcc
    v_mad_i32_i24 v126, v130, s66, v126
    v_mul_u32_u24 v127, 0x10001, v126
    v_add_u32 v126, 0x10000, v127
    v_add_u32 v128, 0x50004, v127
    v_add_u32 v129, 0x70006, v127
    v_add_u32 v127, 0x30002, v127
    v_mov_b32 v131, 0xbfe0bfe0
    s_mov_b32 s86, 0xfff0ffff
    s_mov_b32 s87, 0xf000ff00
    s_mov_b32 s88, 0xff00fff0
    s_mov_b32 s89, 0xf000
    s_mov_b32 s90, 0xf0000f
    s_mov_b32 s91, 0xf0000f00
    s_mov_b32 s84, 0x11111113
    s_mov_b32 s85, 0x11111111
    v_cndmask_b32 v116, 0, v131, s[86:87]
    v_cndmask_b32 v120, 0, v131, s[88:89]
    v_cndmask_b32 v117, 0, v131, s[86:87]
    v_cndmask_b32 v121, 0, v131, s[88:89]
    v_cndmask_b32 v122, 0, v131, s[84:85]
    v_cndmask_b32 v123, 0, v131, s[84:85]
    v_cndmask_b32 v124, 0, v131, s[84:85]
    v_cndmask_b32 v125, 0, v131, s[84:85]
    v_lshlrev_b32 v246, 4, v250
    v_sub_u32 v246, 48, v246
    s_mov_b32 s86, 0xbfe0bfe0
    s_mov_b32 s87, 0xf0bfe0
    v_lshrrev_b64 v[118:119], v246, s[86:87]
    v_mov_b32 v131, 0
    s_mov_b64 s[84:85], 0
    v_cndmask_b32 v118, v120, v118, s[90:91]
    v_cndmask_b32 v119, v121, v119, s[90:91]
    s_mov_b32 s61, 7
    s_mov_b32 s92, 0xbfb8aa3b
    v_and_b32 v251, 15, v0
    v_bfe_u32 v252, v0, 2, 2
    v_lshlrev_b32 v253, 3, v250
    v_lshl_add_u32 v253, v252, 7, v253
    v_and_b32 v246, 24, v0
    v_lshlrev_b32 v246, 2, v246
    v_xor_b32 v246, v253, v246
    v_lshl_add_u32 v246, v1, 10, v246
    s_lshl_b32 s66, s67, 5
    v_xor_b32 v66, s66, v246
    v_add_u32 v66, 45120, v66
    s_lshr_b32 s66, s54, 1
    s_lshl_b32 s66, s66, 5
    v_xor_b32 v64, s66, v246
    s_and_b32 s66, s54, 1
    s_mul_i32 s66, s66, 20480
    s_add_u32 s66, s66, 4160
    v_add_u32 v64, s66, v64
    v_add_u32 v65, 81920, v64
    s_and_b32 s66, s54, 4
    v_lshrrev_b32 v246, 3, v251
    v_add_u32 v246, s66, v246
    v_mul_u32_u24 v246, 20480, v246
    v_lshl_add_u32 v246, v1, 4, v246
    v_and_b32 v247, 7, v0
    v_lshl_add_u32 v67, v247, 7, v246
    v_and_b32 v247, 1, v0
    v_lshlrev_b32 v247, 4, v247
    v_lshlrev_b32 v247, v247, 1
    v_cmp_gt_u32 vcc, 2, v250
    v_mov_b32 v229, 0
    v_mov_b32 v228, 0x3f80
    v_cndmask_b32 v241, 0, v247, vcc
    v_cmp_eq_u32 vcc, 0, v251
    v_sub_u32 v242, v247, v241
    v_mul_u32_u24 v218, 0x3f80, v241
    v_cndmask_b32 v220, 0, -1, vcc
    v_mul_u32_u24 v219, 0x3f80, v242
    s_and_b32 s66, s54, 3
    s_lshl_b32 s66, s66, 6
    s_add_u32 s66, s66, 9344
    v_and_b32 v247, 7, v0
    v_mul_u32_u24 v247, 144, v247
    v_add3_u32 v98, v67, v247, s66
    s_add_u32 s66, s52, 14592
    v_lshl_add_u32 v221, v0, 2, s66
    ds_write_b32 v221, v229
    s_xor_b32 s66, s54, 4
    s_mul_i32 s66, s66, 20480
    s_add_u32 s66, s66, 14592
    v_writelane_b32 v221, s66, 1
    v_add_u32 v222, s52, v2
    s_mov_b64 exec, 15
    ds_write_b32 v222, v229 offset:14848
    s_mov_b64 exec, -1
    v_and_b32 v247, 8, v0
    v_lshlrev_b32 v247, 2, v247
    v_lshl_add_u32 v247, v251, 7, v247
    v_add_u32 v247, s52, v247
    v_and_b32 v248, 2, v0
    v_lshlrev_b32 v248, 1, v248
    v_xor_b32 v248, v248, v1
    v_lshl_add_u32 v234, v248, 4, v247
    v_xor_b32 v248, 4, v248
    v_lshl_add_u32 v235, v248, 4, v247
    v_and_b32 v247, 8, v0
    v_lshlrev_b32 v247, 3, v247
    v_lshl_add_u32 v248, v1, 5, v253
    v_xor_b32 v248, v248, v247
    v_add_u32 v236, s52, v248
    s_add_u32 s66, s52, 8320
    v_lshl_add_u32 v238, v250, 1, s66
    v_lshl_add_u32 v238, v1, 4, v238
    s_add_u32 s66, s52, 14912
    v_lshl_add_u32 v240, v0, 1, s66
    s_add_u32 s66, s52, 9344
    v_lshl_add_u32 v239, v1, 4, s66
    v_mov_b32 v188, 0
    v_mov_b32 v189, 0
    v_mov_b32 v190, 0
    v_mov_b32 v191, 0
    v_mov_b32 v192, 0
    v_mov_b32 v193, 0
    v_mov_b32 v194, 0
    v_mov_b32 v195, 0
    v_mov_b32 v208, 0
    v_mov_b32 v212, 0
    v_mov_b32 v209, 0
    v_mov_b32 v213, 0
    v_mov_b32 v210, 0
    v_mov_b32 v214, 0
    v_mov_b32 v211, 0
    v_mov_b32 v215, 0
    s_and_b32 s66, s54, 3
    s_lshl_b32 s66, s66, 5
    v_lshl_add_u32 v249, v1, 3, s66
    global_load_dwordx2 v[96:97], v249, s[12:13]
    s_cmp_ge_u32 s54, 4
    s_cbranch_scc0 L_old3z
    buffer_load_dwordx4 v[100:103], v3, s[24:27], s93 offen nt
L_old3z:
    s_cmp_ge_u32 s54, 4
    s_cbranch_scc1 L_young1
    s_waitcnt vmcnt(6) lgkmcnt(0)
    s_call_b64 s[62:63], L_fp
    s_waitcnt vmcnt(5)
    s_branch L_old1
L_young1:
    s_waitcnt vmcnt(2)
L_old1:
    s_waitcnt lgkmcnt(0)
    s_barrier
    ds_read_b64_tr_b16 v[16:17], v66 offset:0
    ds_read_b64_tr_b16 v[18:19], v66 offset:512
    ds_read_b64_tr_b16 v[20:21], v66 offset:20480
    ds_read_b64_tr_b16 v[22:23], v66 offset:20992
    ds_read_b64_tr_b16 v[24:25], v66 offset:40960
    ds_read_b64_tr_b16 v[26:27], v66 offset:41472
    ds_read_b64_tr_b16 v[28:29], v66 offset:61440
    ds_read_b64_tr_b16 v[30:31], v66 offset:61952
    ds_read_b128 v[32:35], v67 offset:8320
    ds_read_b128 v[36:39], v67 offset:8384
    ds_read_b128 v[40:43], v67 offset:49280
    ds_read_b128 v[44:47], v67 offset:49344
    ds_read_b64_tr_b16 v[4:5], v64 offset:0
    ds_read_b64_tr_b16 v[8:9], v65 offset:0
    ds_read_b64_tr_b16 v[12:13], v65 offset:40960
    ds_read_b64_tr_b16 v[6:7], v64 offset:512
    ds_read_b64_tr_b16 v[10:11], v65 offset:512
    ds_read_b64_tr_b16 v[14:15], v65 offset:41472
    s_cmp_ge_u32 s54, 4
    s_cbranch_scc1 L_young2
    s_waitcnt vmcnt(4)
    s_branch L_old2
L_young2:
    s_waitcnt vmcnt(1)
L_old2:
    s_add_u32 s93, s93, 1638400
    buffer_load_dwordx4 v[104:107], v3, s[24:27], s93 offen nt
    s_add_u32 s93, s93, 1638400
    buffer_load_dwordx4 v[108:111], v3, s[24:27], s93 offen nt
    s_add_u32 s93, s93, 1638400
    buffer_load_dwordx4 v[112:115], v3, s[24:27], s93 offen nt
    v_lshlrev_b32 v249, 3, v1
    v_lshl_add_u32 v249, v250, 5, v249
    global_load_dwordx2 v[216:217], v249, s[14:15]
    v_lshlrev_b32 v48, 16, v96
    v_and_b32 v49, 0xffff0000, v96
    v_lshlrev_b32 v50, 16, v97
    v_and_b32 v51, 0xffff0000, v97
    s_lshl_b32 s30, s30, 16
    v_and_b32 v204, s30, v220
    v_and_b32 v205, s30, v220
    v_and_b32 v206, s30, v220
    v_and_b32 v207, s30, v220
    s_waitcnt lgkmcnt(0)
    v_xor_b32 v24, 0x80008000, v24
    v_xor_b32 v25, 0x80008000, v25
    v_xor_b32 v26, 0x80008000, v26
    v_xor_b32 v27, 0x80008000, v27
    v_xor_b32 v28, 0x80008000, v28
    v_xor_b32 v29, 0x80008000, v29
    v_xor_b32 v30, 0x80008000, v30
    v_xor_b32 v31, 0x80008000, v31
    v_mfma_f32_4x4x4_16b_bf16 v[56:59], v[218:219], v[4:5], 0
    v_mfma_f32_4x4x4_16b_bf16 v[68:71], v[218:219], v[12:13], 0
    v_mfma_f32_4x4x4_16b_bf16 v[60:63], v[218:219], v[6:7], 0
    v_mfma_f32_4x4x4_16b_bf16 v[72:75], v[218:219], v[14:15], 0
    v_mfma_f32_4x4x4_16b_bf16 v[56:59], v[218:219], v[8:9], v[56:59]
    v_mfma_f32_4x4x4_16b_bf16 v[60:63], v[218:219], v[10:11], v[60:63]
    v_mfma_f32_16x16x32_bf16 v[52:55], v[16:19], v[40:43], v[48:51]
    v_mfma_f32_16x16x32_bf16 v[52:55], v[20:23], v[44:47], v[52:55]
    v_mfma_f32_16x16x32_bf16 v[52:55], v[24:27], v[40:43], v[52:55]
    v_mfma_f32_16x16x32_bf16 v[52:55], v[28:31], v[44:47], v[52:55]
    v_mfma_f32_16x16x32_bf16 v[48:51], v[16:19], v[32:35], v[48:51]
    v_mfma_f32_16x16x32_bf16 v[48:51], v[20:23], v[36:39], v[48:51]
    v_mfma_f32_16x16x32_bf16 v[48:51], v[24:27], v[32:35], v[48:51]
    v_mfma_f32_16x16x32_bf16 v[48:51], v[28:31], v[36:39], v[48:51]
    v_mul_f32 v56, s92, v56
    v_mul_f32 v57, s92, v57
    v_mul_f32 v58, s92, v58
    v_mul_f32 v59, s92, v59
    v_mul_f32 v60, s92, v60
    v_mul_f32 v61, s92, v61
    v_mul_f32 v62, s92, v62
    v_mul_f32 v63, s92, v63
    v_mul_f32 v68, s92, v68
    v_mul_f32 v69, s92, v69
    v_mul_f32 v70, s92, v70
    v_mul_f32 v71, s92, v71
    v_mul_f32 v72, s92, v72
    v_mul_f32 v73, s92, v73
    v_mul_f32 v74, s92, v74
    v_mul_f32 v75, s92, v75
    s_add_u32 s66, s52, 11520
    v_add_u32 v3, s66, v2
    v_cvt_pk_bf16_f32 v68, v68, v69
    v_cvt_pk_bf16_f32 v69, v70, v71
    v_cvt_pk_bf16_f32 v70, v72, v73
    v_cvt_pk_bf16_f32 v71, v74, v75
    v_mul_f32 v48, s92, v48
    v_mul_f32 v49, s92, v49
    v_mul_f32 v50, s92, v50
    v_mul_f32 v51, s92, v51
    v_mul_f32 v52, s92, v52
    v_mul_f32 v53, s92, v53
    v_mul_f32 v54, s92, v54
    v_mul_f32 v55, s92, v55
    ds_write_b128 v3, v[56:59]
    ds_write_b128 v3, v[60:63] offset:1024
    ds_write_b128 v3, v[68:71] offset:2048
    ds_write_b128 v98, v[48:51]
    ds_write_b128 v98, v[52:55] offset:40960
    v_add_u32 v3, 11520, v2
    v_add_u32 v246, 81920, v3
    s_waitcnt lgkmcnt(0)
    s_barrier
    s_cmp_ge_u32 s54, 4
    s_cbranch_scc0 L_old3
    s_waitcnt vmcnt(4)
    s_call_b64 s[62:63], L_fp
    s_branch L_yng3
L_old3:
    s_call_b64 s[62:63], L_t23
L_yng3:
    ds_read_b128 v[4:7], v3 offset:0
    ds_read_b128 v[8:11], v3 offset:1024
    ds_read_b128 v[68:71], v3 offset:2048
    ds_read_b128 v[12:15], v3 offset:20480
    ds_read_b128 v[16:19], v3 offset:21504
    ds_read_b128 v[72:75], v3 offset:22528
    ds_read_b128 v[20:23], v3 offset:40960
    ds_read_b128 v[24:27], v3 offset:41984
    ds_read_b128 v[76:79], v3 offset:43008
    s_waitcnt vmcnt(4)
    v_mfma_i32_16x16x64_i8 v[172:175], v[122:125], v[104:107], 0
    v_mfma_i32_16x16x64_i8 v[176:179], v[122:125], v[108:111], 0
    v_mfma_i32_16x16x64_i8 v[180:183], v[122:125], v[112:115], 0
    v_and_b32 v160, 0x800080, v104
    v_mul_u32_u24 v160, 0x7f, v160
    v_bitop3_b32 v131, v104, v160, v131 bitop3:0xbe
    v_and_b32 v161, 0x800080, v105
    v_mul_u32_u24 v161, 0x7f, v161
    v_bitop3_b32 v131, v105, v161, v131 bitop3:0xbe
    v_and_b32 v160, 0x800080, v106
    v_mul_u32_u24 v160, 0x7f, v160
    v_bitop3_b32 v131, v106, v160, v131 bitop3:0xbe
    v_mov_b32_dpp v184, v172 row_shr:1 row_mask:0xf bank_mask:0xf bound_ctrl:0
    v_mov_b32_dpp v185, v176 row_shr:1 row_mask:0xf bank_mask:0xf bound_ctrl:0
    v_mov_b32_dpp v186, v180 row_shr:1 row_mask:0xf bank_mask:0xf bound_ctrl:0
    v_add_u32_dpp v184, v184, v184 row_shr:1 row_mask:0xf bank_mask:0xf bound_ctrl:0
    v_add_u32_dpp v185, v185, v185 row_shr:1 row_mask:0xf bank_mask:0xf bound_ctrl:0
    v_add_u32_dpp v186, v186, v186 row_shr:1 row_mask:0xf bank_mask:0xf bound_ctrl:0
    v_add_u32_dpp v184, v184, v184 row_shr:2 row_mask:0xf bank_mask:0xf bound_ctrl:0
    v_add_u32_dpp v185, v185, v185 row_shr:2 row_mask:0xf bank_mask:0xf bound_ctrl:0
    v_add_u32_dpp v186, v186, v186 row_shr:2 row_mask:0xf bank_mask:0xf bound_ctrl:0
    v_add_u32_dpp v184, v184, v184 row_shr:4 row_mask:0xf bank_mask:0xf bound_ctrl:0
    v_add_u32_dpp v185, v185, v185 row_shr:4 row_mask:0xf bank_mask:0xf bound_ctrl:0
    v_add_u32_dpp v186, v186, v186 row_shr:4 row_mask:0xf bank_mask:0xf bound_ctrl:0
    v_add_u32_dpp v184, v184, v184 row_shr:8 row_mask:0xf bank_mask:0xf bound_ctrl:0
    v_add_u32_dpp v185, v185, v185 row_shr:8 row_mask:0xf bank_mask:0xf bound_ctrl:0
    v_add_u32_dpp v186, v186, v186 row_shr:8 row_mask:0xf bank_mask:0xf bound_ctrl:0
    ds_read_b128 v[28:31], v3 offset:61440
    ds_read_b128 v[32:35], v3 offset:62464
    ds_read_b128 v[80:83], v3 offset:63488
    ds_read_b128 v[36:39], v246 offset:0
    ds_read_b128 v[40:43], v246 offset:1024
    ds_read_b128 v[84:87], v246 offset:2048
    v_and_b32 v161, 0x800080, v107
    v_mul_u32_u24 v161, 0x7f, v161
    v_bitop3_b32 v131, v107, v161, v131 bitop3:0xbe
    v_and_b32 v160, 0x800080, v108
    v_mul_u32_u24 v160, 0x7f, v160
    v_bitop3_b32 v131, v108, v160, v131 bitop3:0xbe
    v_and_b32 v161, 0x800080, v109
    v_mul_u32_u24 v161, 0x7f, v161
    v_bitop3_b32 v131, v109, v161, v131 bitop3:0xbe
    v_and_b32 v160, 0x800080, v110
    v_mul_u32_u24 v160, 0x7f, v160
    v_bitop3_b32 v131, v110, v160, v131 bitop3:0xbe
    v_and_b32 v161, 0x800080, v111
    v_mul_u32_u24 v161, 0x7f, v161
    v_bitop3_b32 v131, v111, v161, v131 bitop3:0xbe
    v_and_b32 v160, 0x800080, v112
    v_mul_u32_u24 v160, 0x7f, v160
    v_bitop3_b32 v131, v112, v160, v131 bitop3:0xbe
    v_and_b32 v161, 0x800080, v113
    v_mul_u32_u24 v161, 0x7f, v161
    v_bitop3_b32 v131, v113, v161, v131 bitop3:0xbe
    v_and_b32 v160, 0x800080, v114
    v_mul_u32_u24 v160, 0x7f, v160
    v_bitop3_b32 v131, v114, v160, v131 bitop3:0xbe
    v_and_b32 v161, 0x800080, v115
    v_mul_u32_u24 v161, 0x7f, v161
    v_bitop3_b32 v131, v115, v161, v131 bitop3:0xbe
    v_cmp_ne_u32 vcc, 0, v131
    v_readlane_b32 s68, v184, 6
    v_readlane_b32 s69, v173, 6
    v_readlane_b32 s70, v184, 15
    v_readlane_b32 s72, v185, 6
    v_readlane_b32 s73, v177, 6
    v_readlane_b32 s74, v185, 15
    v_readlane_b32 s76, v186, 6
    v_readlane_b32 s77, v181, 6
    v_readlane_b32 s78, v186, 15
    s_cbranch_vccnz L_general
    s_add_u32 s66, s68, s69
    s_add_u32 s66, s66, s64
    s_add_u32 s67, s66, 15
    s_and_b32 s67, s67, -16
    s_add_u32 s55, s64, 16
    s_max_u32 s67, s67, s55
    s_sub_u32 s66, s67, s66
    v_mad_u32_u24 v184, v130, s66, v184
    s_sub_u32 s55, s64, 2048
    v_add_u32 v172, s55, v184
    v_add_u32 v173, s55, v184
    v_add_u32 v174, s55, v184
    v_add_u32 v175, s55, v184
    s_add_u32 s64, s64, s70
    s_add_u32 s64, s64, s66
    v_mfma_i32_16x16x64_i8 v[132:135], v[118:121], v[104:107], v[172:175]
    v_mfma_i32_16x16x64_i8 v[136:139], v[116:119], v[104:107], v[172:175]
    s_add_u32 s64, s64, 15
    s_and_b32 s64, s64, -16
    s_add_u32 s55, s67, 16
    s_max_u32 s64, s64, s55
    s_lshr_b32 s95, s67, 4
    s_bitset1_b64 s[56:57], s95
    s_lshr_b32 s95, s64, 4
    s_bitset1_b64 s[56:57], s95
    s_mov_b32 s44, s64
    s_add_u32 s66, s72, s73
    s_add_u32 s66, s66, s64
    s_add_u32 s67, s66, 15
    s_and_b32 s67, s67, -16
    s_add_u32 s55, s64, 16
    s_max_u32 s67, s67, s55
    s_sub_u32 s66, s67, s66
    v_mad_u32_u24 v185, v130, s66, v185
    s_sub_u32 s55, s64, 2048
    v_add_u32 v176, s55, v185
    v_add_u32 v177, s55, v185
    v_add_u32 v178, s55, v185
    v_add_u32 v179, s55, v185
    s_add_u32 s64, s64, s74
    s_add_u32 s64, s64, s66
    v_mfma_i32_16x16x64_i8 v[140:143], v[118:121], v[108:111], v[176:179]
    v_mfma_i32_16x16x64_i8 v[144:147], v[116:119], v[108:111], v[176:179]
    s_add_u32 s64, s64, 15
    s_and_b32 s64, s64, -16
    s_add_u32 s55, s67, 16
    s_max_u32 s64, s64, s55
    s_mov_b32 s45, s67
    s_mov_b32 s46, s64
    ds_write_b8 v132, v126
    ds_write_b8_d16_hi v133, v126
    ds_write_b8 v134, v127
    ds_write_b8_d16_hi v135, v127
    ds_write_b8 v136, v128
    ds_write_b8_d16_hi v137, v128
    ds_write_b8 v138, v129
    ds_write_b8_d16_hi v139, v129
    s_add_u32 s66, s76, s77
    s_add_u32 s66, s66, s64
    s_add_u32 s67, s66, 15
    s_and_b32 s67, s67, -16
    s_add_u32 s55, s64, 16
    s_max_u32 s67, s67, s55
    s_sub_u32 s66, s67, s66
    v_mad_u32_u24 v186, v130, s66, v186
    s_sub_u32 s55, s64, 2048
    v_add_u32 v180, s55, v186
    v_add_u32 v181, s55, v186
    v_add_u32 v182, s55, v186
    v_add_u32 v183, s55, v186
    s_add_u32 s64, s64, s78
    s_add_u32 s64, s64, s66
    v_mfma_i32_16x16x64_i8 v[164:167], v[118:121], v[112:115], v[180:183]
    v_mfma_i32_16x16x64_i8 v[168:171], v[116:119], v[112:115], v[180:183]
    s_add_u32 s64, s64, 15
    s_and_b32 s64, s64, -16
    s_add_u32 s55, s67, 16
    s_max_u32 s64, s64, s55
    s_mov_b32 s47, s67
    s_mov_b32 s48, s64
    ds_write_b8 v140, v126
    ds_write_b8_d16_hi v141, v126
    ds_write_b8 v142, v127
    ds_write_b8_d16_hi v143, v127
    ds_write_b8 v144, v128
    ds_write_b8_d16_hi v145, v128
    ds_write_b8 v146, v129
    ds_write_b8_d16_hi v147, v129
    ds_read_b128 v[44:47], v246 offset:20480
    ds_read_b128 v[48:51], v246 offset:21504
    ds_read_b128 v[88:91], v246 offset:22528
    ds_read_b128 v[52:55], v246 offset:40960
    ds_read_b128 v[56:59], v246 offset:41984
    ds_read_b128 v[92:95], v246 offset:43008
    ds_read_b128 v[60:63], v246 offset:61440
    ds_read_b128 v[64:67], v246 offset:62464
    ds_read_b128 v[96:99], v246 offset:63488
    ds_read_u16 v224, v238 offset:0
    ds_read_u16 v225, v238 offset:8
    ds_read_u16 v226, v238 offset:64
    ds_read_u16 v227, v238 offset:72
    ds_write_b8 v164, v126
    ds_write_b8_d16_hi v165, v126
    ds_write_b8 v166, v127
    ds_write_b8_d16_hi v167, v127
    ds_write_b8 v168, v128
    ds_write_b8_d16_hi v169, v128
    ds_write_b8 v170, v129
    ds_write_b8_d16_hi v171, v129
    s_cmp_ge_u32 s54, 4
    s_cbranch_scc0 L_old3b
    s_call_b64 s[62:63], L_t23
L_old3b:
L_listed:
    s_and_b32 s55, s84, 0x40000000
    s_or_b32 s55, s55, s54
    s_bitset1_b32 s55, 31
    s_and_b32 s66, s74, 0x1ff
    s_lshl_b32 s66, s66, 3
    s_or_b32 s66, s66, s55
    s_and_b32 s67, s78, 0x1ff
    s_lshl_b32 s67, s67, 3
    s_or_b32 s67, s67, s55
    v_mov_b32 v132, s66
    v_mov_b32 v133, s44
    v_mov_b32 v134, s45
    v_mov_b32 v135, s46
    v_writelane_b32 v132, s67, 1
    v_writelane_b32 v133, s46, 1
    v_writelane_b32 v134, s47, 1
    v_writelane_b32 v135, s48, 1
    s_mov_b64 exec, 3
    ds_write_b128 v222, v[132:135] offset:14848
    s_mov_b64 exec, -1
    s_sub_u32 s68, s46, s44
    s_sub_u32 s69, s48, s46
    s_lshl_b32 s50, s54, 3
    s_mov_b32 s51, 0
    s_mov_b32 s33, 0
    s_sub_u32 s66, s64, s52
    s_sub_u32 s66, s66, 18448
    s_lshr_b32 s66, s66, 3
    s_lshr_b32 s67, s54, 2
    s_mul_i32 s67, s67, 2
    s_add_u32 s66, s66, s67
    s_sub_u32 s67, 0, s66
    v_mov_b32 v2, v221
    v_mov_b32 v1, s66
    v_mov_b32 v3, -8
    v_writelane_b32 v1, s67, 1
    v_writelane_b32 v3, 8, 1
    ds_add_u32 v2, v1
    v_bfrev_b32 v245, -2
    v_writelane_b32 v245, 0, 0
    s_cmp_eq_u32 s94, 1
    s_cbranch_scc1 L_nolate
    ds_read_u8 v148, v237 offset:0
    ds_read_u8 v149, v237 offset:8
    ds_read_u8 v150, v237 offset:16
    ds_read_u8 v151, v237 offset:24
    ds_read_u8 v152, v237 offset:32
    ds_read_u8 v153, v237 offset:40
    ds_read_u8 v154, v237 offset:48
    ds_read_u8 v155, v237 offset:56
    s_waitcnt lgkmcnt(0)
    s_add_u32 m0, s52, 0
    v_mov_b32 v230, v148
    v_mov_b32 v232, v149
    buffer_load_dwordx4 v[230:231], s[20:23], s35 idxen offen nt lds
    buffer_load_dwordx4 v[232:233], s[40:43], s35 idxen offen offset:1056 nt lds
    s_bitcmp0_b64 s[56:57], 2
    s_cbranch_scc1 L_noadvl1
    s_add_u32 s35, s35, s31
    s_min_u32 s35, s35, 419404800
    s_xor_b32 s31, s31, 0x63ff800
    s_sub_u32 s60, s60, 1
L_noadvl1:
    s_add_u32 m0, s52, 2080
    v_mov_b32 v230, v150
    v_mov_b32 v232, v151
    buffer_load_dwordx4 v[230:231], s[20:23], s35 idxen offen nt lds
    buffer_load_dwordx4 v[232:233], s[40:43], s35 idxen offen offset:1056 nt lds
    s_bitcmp0_b64 s[56:57], 3
    s_cbranch_scc1 L_noadvl2
    s_add_u32 s35, s35, s31
    s_min_u32 s35, s35, 419404800
    s_xor_b32 s31, s31, 0x63ff800
    s_sub_u32 s60, s60, 1
L_noadvl2:
    s_add_u32 m0, s52, 4160
    v_mov_b32 v230, v152
    v_mov_b32 v232, v153
    buffer_load_dwordx4 v[230:231], s[20:23], s35 idxen offen nt lds
    buffer_load_dwordx4 v[232:233], s[40:43], s35 idxen offen offset:1056 nt lds
    s_bitcmp0_b64 s[56:57], 4
    s_cbranch_scc1 L_noadvl3
    s_add_u32 s35, s35, s31
    s_min_u32 s35, s35, 419404800
    s_xor_b32 s31, s31, 0x63ff800
    s_sub_u32 s60, s60, 1
L_noadvl3:
    s_add_u32 m0, s52, 6240
    v_mov_b32 v230, v154
    v_mov_b32 v232, v155
    buffer_load_dwordx4 v[230:231], s[20:23], s35 idxen offen nt lds
    buffer_load_dwordx4 v[232:233], s[40:43], s35 idxen offen offset:1056 nt lds
L_nolate:
    v_and_b32_dpp v196, v216, v220 quad_perm:[0,0,0,0] row_mask:0xf bank_mask:0xf
    v_and_b32_dpp v197, v217, v220 quad_perm:[0,0,0,0] row_mask:0xf bank_mask:0xf
    v_and_b32_dpp v198, v216, v220 quad_perm:[1,1,1,1] row_mask:0xf bank_mask:0xf
    v_and_b32_dpp v199, v217, v220 quad_perm:[1,1,1,1] row_mask:0xf bank_mask:0xf
    v_and_b32_dpp v200, v216, v220 quad_perm:[2,2,2,2] row_mask:0xf bank_mask:0xf
    v_and_b32_dpp v201, v217, v220 quad_perm:[2,2,2,2] row_mask:0xf bank_mask:0xf
    v_and_b32_dpp v202, v216, v220 quad_perm:[3,3,3,3] row_mask:0xf bank_mask:0xf
    v_and_b32_dpp v203, v217, v220 quad_perm:[3,3,3,3] row_mask:0xf bank_mask:0xf
    s_waitcnt vmcnt(6) lgkmcnt(0)
    ds_read_b128 v[180:183], v234 offset:0
    ds_read_b128 v[184:187], v235 offset:0
    v_mul_u32_u24 v216, v224, v241
    v_mul_u32_u24 v217, v224, v242
    v_mul_u32_u24 v218, v225, v241
    v_mul_u32_u24 v219, v225, v242
    v_mul_u32_u24 v220, v226, v241
    v_mul_u32_u24 v221, v226, v242
    v_mul_u32_u24 v222, v227, v241
    v_mul_u32_u24 v223, v227, v242
    v_mfma_f32_4x4x4_16b_bf16 v[140:143], v[216:217], v[68:69], v[4:7]
    v_add_u32 v238, 128, v238
    ds_read_b128 v[164:167], v239 offset:0
    ds_read_b128 v[168:171], v239 offset:64
    v_mfma_f32_4x4x4_16b_bf16 v[144:147], v[218:219], v[70:71], v[8:11]
    ds_read_b128 v[172:175], v239 offset:128
    ds_read_b128 v[176:179], v239 offset:192
    ds_read_u16 v224, v238 offset:0
    ds_read_u16 v225, v238 offset:8
    ds_read_u16 v226, v238 offset:64
    ds_read_u16 v227, v238 offset:72
    v_mfma_f32_4x4x4_16b_bf16 v[246:249], v[220:221], v[72:73], v[12:15]
    v_cvt_pk_bf16_f32 v100, v140, v141
    v_cvt_pk_bf16_f32 v101, v142, v143
    v_mfma_f32_4x4x4_16b_bf16 v[250:253], v[222:223], v[74:75], v[16:19]
    v_cvt_pk_bf16_f32 v102, v144, v145
    v_cvt_pk_bf16_f32 v103, v146, v147
    v_mfma_f32_4x4x4_16b_bf16 v[140:143], v[216:217], v[76:77], v[20:23]
    v_cvt_pk_bf16_f32 v104, v246, v247
    v_cvt_pk_bf16_f32 v105, v248, v249
    v_mfma_f32_4x4x4_16b_bf16 v[144:147], v[218:219], v[78:79], v[24:27]
    v_cvt_pk_bf16_f32 v106, v250, v251
    v_cvt_pk_bf16_f32 v107, v252, v253
    v_mfma_f32_4x4x4_16b_bf16 v[246:249], v[220:221], v[80:81], v[28:31]
    v_cvt_pk_bf16_f32 v108, v140, v141
    v_cvt_pk_bf16_f32 v109, v142, v143
    v_mfma_f32_4x4x4_16b_bf16 v[250:253], v[222:223], v[82:83], v[32:35]
    v_cvt_pk_bf16_f32 v110, v144, v145
    v_cvt_pk_bf16_f32 v111, v146, v147
    v_mfma_f32_4x4x4_16b_bf16 v[140:143], v[216:217], v[84:85], v[36:39]
    v_cvt_pk_bf16_f32 v112, v246, v247
    v_cvt_pk_bf16_f32 v113, v248, v249
    v_mfma_f32_4x4x4_16b_bf16 v[144:147], v[218:219], v[86:87], v[40:43]
    v_cvt_pk_bf16_f32 v114, v250, v251
    v_cvt_pk_bf16_f32 v115, v252, v253
    v_mfma_f32_4x4x4_16b_bf16 v[246:249], v[220:221], v[88:89], v[44:47]
    v_cvt_pk_bf16_f32 v116, v140, v141
    v_cvt_pk_bf16_f32 v117, v142, v143
    v_mfma_f32_4x4x4_16b_bf16 v[250:253], v[222:223], v[90:91], v[48:51]
    v_cvt_pk_bf16_f32 v118, v144, v145
    v_cvt_pk_bf16_f32 v119, v146, v147
    v_mfma_f32_4x4x4_16b_bf16 v[140:143], v[216:217], v[92:93], v[52:55]
    v_cvt_pk_bf16_f32 v120, v246, v247
    v_cvt_pk_bf16_f32 v121, v248, v249
    v_mfma_f32_4x4x4_16b_bf16 v[144:147], v[218:219], v[94:95], v[56:59]
    v_cvt_pk_bf16_f32 v122, v250, v251
    v_cvt_pk_bf16_f32 v123, v252, v253
    v_mfma_f32_4x4x4_16b_bf16 v[246:249], v[220:221], v[96:97], v[60:63]
    v_cvt_pk_bf16_f32 v124, v140, v141
    v_cvt_pk_bf16_f32 v125, v142, v143
    v_mfma_f32_4x4x4_16b_bf16 v[250:253], v[222:223], v[98:99], v[64:67]
    v_cvt_pk_bf16_f32 v126, v144, v145
    v_cvt_pk_bf16_f32 v127, v146, v147
    v_cvt_pk_bf16_f32 v128, v246, v247
    v_cvt_pk_bf16_f32 v129, v248, v249
    v_add_u32 v239, 272, v239
    v_cvt_pk_bf16_f32 v130, v250, v251
    v_cvt_pk_bf16_f32 v131, v252, v253
    s_waitcnt lgkmcnt(0)
    v_mfma_f32_16x16x32_bf16 v[148:151], v[100:103], v[180:183], v[164:167]
    v_mfma_f32_16x16x32_bf16 v[148:151], v[104:107], v[184:187], v[148:151]
    v_mfma_f32_16x16x32_bf16 v[152:155], v[108:111], v[180:183], v[168:171]
    v_mfma_f32_16x16x32_bf16 v[152:155], v[112:115], v[184:187], v[152:155]
    v_mfma_f32_16x16x32_bf16 v[156:159], v[116:119], v[180:183], v[172:175]
    v_mfma_f32_16x16x32_bf16 v[156:159], v[120:123], v[184:187], v[156:159]
    v_mfma_f32_16x16x32_bf16 v[160:163], v[124:127], v[180:183], v[176:179]
    v_mfma_f32_16x16x32_bf16 v[160:163], v[128:131], v[184:187], v[160:163]
    v_mov_b32 v136, 0
    v_mov_b32 v137, 0
    v_mov_b32 v138, 0
    v_mov_b32 v139, 0
    s_lshr_b64 s[86:87], s[56:57], 2
    s_lshr_b64 s[36:37], s[56:57], 5
    s_or_b32 s36, s36, s86
    s_or_b32 s36, s36, s56
    s_cmp_lg_u64 s[84:85], 0
    s_cbranch_scc0 Lf_mid
    s_mul_i32 s66, s53, 800
    s_add_u32 s8, s8, s66
    s_addc_u32 s9, s9, 0
    s_mov_b32 s24, s8
    s_and_b32 s25, s9, 0xffff
    s_mov_b32 s26, 400
    s_mov_b32 s27, 0x20000
    s_movk_i32 s32, 400
    s_branch Ls_mid
L_fp:
    v_mfma_i32_16x16x64_i8 v[172:175], v[122:125], v[100:103], 0
    v_and_b32 v160, 0x800080, v100
    v_mul_u32_u24 v160, 0x7f, v160
    v_bitop3_b32 v131, v100, v160, v131 bitop3:0xbe
    v_and_b32 v161, 0x800080, v101
    v_mul_u32_u24 v161, 0x7f, v161
    v_bitop3_b32 v131, v101, v161, v131 bitop3:0xbe
    v_and_b32 v160, 0x800080, v102
    v_mul_u32_u24 v160, 0x7f, v160
    v_mov_b32_dpp v184, v172 row_shr:1 row_mask:0xf bank_mask:0xf bound_ctrl:0
    v_bitop3_b32 v131, v102, v160, v131 bitop3:0xbe
    s_nop 0
    v_add_u32_dpp v184, v184, v184 row_shr:1 row_mask:0xf bank_mask:0xf bound_ctrl:0
    v_and_b32 v161, 0x800080, v103
    s_nop 0
    v_add_u32_dpp v184, v184, v184 row_shr:2 row_mask:0xf bank_mask:0xf bound_ctrl:0
    v_mul_u32_u24 v161, 0x7f, v161
    s_nop 0
    v_add_u32_dpp v184, v184, v184 row_shr:4 row_mask:0xf bank_mask:0xf bound_ctrl:0
    v_bitop3_b32 v131, v103, v161, v131 bitop3:0xbe
    s_nop 0
    v_add_u32_dpp v184, v184, v184 row_shr:8 row_mask:0xf bank_mask:0xf bound_ctrl:0
    v_cmp_ne_u32 vcc, 0, v131
    v_readlane_b32 s68, v184, 6
    v_readlane_b32 s69, v173, 6
    v_readlane_b32 s70, v184, 15
    s_mov_b32 s94, 0
    s_cbranch_vccnz L_late
    s_add_u32 s66, s68, s69
    s_add_u32 s66, s66, s64
    s_add_u32 s67, s66, 15
    s_and_b32 s67, s67, -16
    s_add_u32 s55, s64, 16
    s_max_u32 s67, s67, s55
    s_sub_u32 s66, s67, s66
    v_mad_u32_u24 v184, v130, s66, v184
    s_sub_u32 s55, s64, 2048
    v_add_u32 v172, s55, v184
    v_add_u32 v173, s55, v184
    v_add_u32 v174, s55, v184
    v_add_u32 v175, s55, v184
    s_add_u32 s64, s64, s70
    s_add_u32 s64, s64, s66
    v_mfma_i32_16x16x64_i8 v[132:135], v[118:121], v[100:103], v[172:175]
    v_mfma_i32_16x16x64_i8 v[136:139], v[116:119], v[100:103], v[172:175]
    s_add_u32 s64, s64, 15
    s_and_b32 s64, s64, -16
    s_add_u32 s55, s67, 16
    s_max_u32 s64, s64, s55
    s_lshr_b32 s95, s67, 4
    s_bitset1_b64 s[56:57], s95
    s_lshr_b32 s95, s64, 4
    s_bitset1_b64 s[56:57], s95
    s_add_u32 s66, s52, 18512
    s_cmp_ge_u32 s64, s66
    ds_write_b8 v132, v126
    ds_write_b8_d16_hi v133, v126
    ds_write_b8 v134, v127
    ds_write_b8_d16_hi v135, v127
    ds_write_b8 v136, v128
    ds_write_b8_d16_hi v137, v128
    ds_write_b8 v138, v129
    ds_write_b8_d16_hi v139, v129
    s_cbranch_scc0 L_late
    s_mov_b32 s94, 1
    ds_read_u8 v148, v237 offset:0
    ds_read_u8 v149, v237 offset:8
    ds_read_u8 v150, v237 offset:16
    ds_read_u8 v151, v237 offset:24
    ds_read_u8 v152, v237 offset:32
    ds_read_u8 v153, v237 offset:40
    ds_read_u8 v154, v237 offset:48
    ds_read_u8 v155, v237 offset:56
    s_waitcnt lgkmcnt(0)
    s_add_u32 m0, s52, 0
    v_mov_b32 v230, v148
    v_mov_b32 v232, v149
    buffer_load_dwordx4 v[230:231], s[20:23], s35 idxen offen nt lds
    buffer_load_dwordx4 v[232:233], s[40:43], s35 idxen offen offset:1056 nt lds
    s_bitcmp0_b64 s[56:57], 2
    s_cbranch_scc1 L_noadve1
    s_add_u32 s35, s35, s31
    s_min_u32 s35, s35, 419404800
    s_xor_b32 s31, s31, 0x63ff800
    s_sub_u32 s60, s60, 1
L_noadve1:
    s_add_u32 m0, s52, 2080
    v_mov_b32 v230, v150
    v_mov_b32 v232, v151
    buffer_load_dwordx4 v[230:231], s[20:23], s35 idxen offen nt lds
    buffer_load_dwordx4 v[232:233], s[40:43], s35 idxen offen offset:1056 nt lds
    s_setpc_b64 s[62:63]
L_late:
    s_waitcnt vmcnt(0)
    s_setpc_b64 s[62:63]
L_swap:
    v_lshrrev_b32 v140, 3, v0
    v_and_b32 v141, 7, v0
    v_mul_u32_u24 v140, 20480, v140
    v_mul_u32_u24 v141, 20480, v141
    v_add_u32 v140, s51, v140
    v_add_u32 v141, s51, v141
    v_mov_b32 v143, 1
    s_mov_b64 exec, 1
    ds_add_rtn_u32 v143, v140, v143 offset:14880
    s_mov_b64 exec, -1
L_swap_poll:
    ds_read_b32 v142, v141 offset:14848
    ds_read_b128 v[144:147], v140 offset:14848
    v_and_b32 v248, 56, v0
    s_waitcnt lgkmcnt(0)
    v_cmp_le_i32 vcc, 0, v142
    v_cmp_gt_u32 s[86:87], v142, v144
    v_lshlrev_b32 v249, 1, v142
    v_readfirstlane_b32 s66, v143
    s_cbranch_vccnz L_swap_poll
    v_lshrrev_b64 v[246:247], v248, s[86:87]
    v_cmp_gt_i32 s[88:89], 0, v249
    v_and_b32 v246, 0xff, v246
    v_bcnt_u32_b32 v246, v246, 0
    v_cmp_eq_u32 vcc, s66, v246
    s_lshl_b32 s67, s54, 3
    s_ff1_i32_b64 s66, vcc
    s_cmp_lg_u64 s[88:89], 0
    s_cselect_b32 s66, s67, s66
    s_sub_u32 s95, s66, s50
    s_mov_b32 s50, s66
    s_sub_u32 s83, s66, s67
    v_readlane_b32 s67, v146, s66
    v_readlane_b32 s55, v147, s66
    v_readlane_b32 s66, v145, s66
    s_mul_i32 s81, s95, 2560
    s_mul_i32 s95, s95, 6400
    s_add_u32 s35, s35, s95
    s_sub_u32 s95, s66, s44
    v_add_u32 v237, s95, v237
    s_mov_b32 s44, s55
    s_sub_u32 s67, s67, s66
    s_sub_u32 s55, s55, s66
    s_sub_u32 s95, s55, s68
    s_lshr_b32 s67, s67, 4
    s_add_u32 s67, s67, s49
    s_bitset1_b64 s[56:57], s67
    s_lshr_b32 s55, s55, 4
    s_add_u32 s55, s55, s49
    s_bitset1_b64 s[56:57], s55
    s_lshr_b64 s[86:87], s[56:57], 2
    s_lshr_b64 s[36:37], s[56:57], 5
    s_or_b32 s36, s36, s86
    s_or_b32 s36, s36, s56
    s_ashr_i32 s95, s95, 3
    v_mov_b32 v140, s95
    s_sub_u32 s95, 0, s95
    v_writelane_b32 v140, s95, 1
    ds_add_u32 v2, v140
    s_cmp_eq_u32 s51, 0
    s_cselect_b32 s80, s81, s80
    s_cselect_b32 s82, s83, s82
    s_cselect_b32 s60, 1, 8
    s_cselect_b32 s66, 4, 2
    s_mov_b32 s68, s69
    s_mov_b32 s51, 16
    s_cmp_eq_u32 s61, s66
    s_cbranch_scc1 L_swap_now
    s_sub_u32 s66, s66, 1
    s_bitset1_b32 s33, s66
    s_setpc_b64 s[62:63]
L_swap_now:
    v_add_u32 v238, s81, v238
    v_add_u32 v239, s81, v239
    ds_read_u16 v224, v238 offset:0
    ds_read_u16 v225, v238 offset:8
    ds_read_u16 v226, v238 offset:64
    ds_read_u16 v227, v238 offset:72
    s_setpc_b64 s[62:63]
L_t23:
    s_cmp_eq_u32 s94, 0
    s_cbranch_scc1 L_skip23
    s_bitcmp0_b64 s[56:57], 3
    s_cbranch_scc1 L_noadve2
    s_add_u32 s35, s35, s31
    s_min_u32 s35, s35, 419404800
    s_xor_b32 s31, s31, 0x63ff800
    s_sub_u32 s60, s60, 1
L_noadve2:
    s_add_u32 m0, s52, 4160
    v_mov_b32 v230, v152
    v_mov_b32 v232, v153
    buffer_load_dwordx4 v[230:231], s[20:23], s35 idxen offen nt lds
    buffer_load_dwordx4 v[232:233], s[40:43], s35 idxen offen offset:1056 nt lds
    s_bitcmp0_b64 s[56:57], 4
    s_cbranch_scc1 L_noadve3
    s_add_u32 s35, s35, s31
    s_min_u32 s35, s35, 419404800
    s_xor_b32 s31, s31, 0x63ff800
    s_sub_u32 s60, s60, 1
L_noadve3:
    s_add_u32 m0, s52, 6240
    v_mov_b32 v230, v154
    v_mov_b32 v232, v155
    buffer_load_dwordx4 v[230:231], s[20:23], s35 idxen offen nt lds
    buffer_load_dwordx4 v[232:233], s[40:43], s35 idxen offen offset:1056 nt lds
    s_setpc_b64 s[62:63]
L_skip23:
    s_waitcnt vmcnt(0)
    s_setpc_b64 s[62:63]
.p2align 6
Lf_loop:
Lf_mid:
    s_bitcmp1_b32 s36, 0
    s_cbranch_scc1 Lf_ev0
Lf_evd0:
    v_mfma_f32_16x16x32_bf16 v[208:211], v[136:139], v[200:203], v[208:211]
    v_exp_f32 v132, v148
    v_exp_f32 v133, v149
    v_exp_f32 v134, v150
    v_exp_f32 v135, v151
    v_exp_f32 v136, v152
    v_exp_f32 v137, v153
    v_mfma_f32_4x4x4_16b_bf16 v[132:135], v[228:229], v[228:229], v[132:135]
    v_exp_f32 v138, v154
    v_exp_f32 v139, v155
    v_cvt_pk_bf16_f32 v208, v208, v209
    v_cvt_pk_bf16_f32 v209, v210, v211
    v_exp_f32 v140, v156
    v_exp_f32 v141, v157
    v_mfma_f32_4x4x4_16b_bf16 v[212:215], v[208:209], v[188:189], v[212:215] cbsz:4 abid:0
    v_mfma_f32_4x4x4_16b_bf16 v[136:139], v[228:229], v[228:229], v[136:139]
    v_exp_f32 v142, v158
    v_mfma_f32_4x4x4_16b_bf16 v[212:215], v[208:209], v[190:191], v[212:215] cbsz:4 abid:4
    v_exp_f32 v143, v159
    v_exp_f32 v144, v160
    v_mfma_f32_4x4x4_16b_bf16 v[212:215], v[208:209], v[192:193], v[212:215] cbsz:4 abid:8
    v_exp_f32 v145, v161
    v_mfma_f32_4x4x4_16b_bf16 v[140:143], v[228:229], v[228:229], v[140:143]
    v_mfma_f32_4x4x4_16b_bf16 v[212:215], v[208:209], v[194:195], v[212:215] cbsz:4 abid:12
    ds_add_rtn_u32 v1, v2, v3
    ds_read_u8 v230, v237 offset:64
    ds_read_u8 v232, v237 offset:72
    ds_read_b64_tr_b16 v[188:189], v236 offset:0
    ds_read_b64_tr_b16 v[190:191], v236 offset:512
    ds_read_b64_tr_b16 v[192:193], v236 offset:1056
    ds_read_b64_tr_b16 v[194:195], v236 offset:1568
    s_waitcnt vmcnt(4)
    ds_read_b128 v[180:183], v234 offset:2080
    ds_read_b128 v[184:187], v235 offset:2080
    s_add_u32 m0, s52, 0
    v_exp_f32 v146, v162
    v_exp_f32 v147, v163
    v_rcp_f32 v132, v132
    v_rcp_f32 v133, v133
    v_mfma_f32_4x4x4_16b_bf16 v[144:147], v[228:229], v[228:229], v[144:147]
    v_rcp_f32 v134, v134
    v_cvt_pk_bf16_f32 v132, v132, v133
    s_waitcnt lgkmcnt(2)
    buffer_load_dwordx4 v[230:231], s[20:23], s35 idxen offen nt lds
    buffer_load_dwordx4 v[232:233], s[40:43], s35 idxen offen offset:1056 nt lds
    s_waitcnt lgkmcnt(0)
    v_mfma_f32_16x16x32_bf16 v[148:151], v[100:103], v[180:183], v[164:167]
    v_rcp_f32 v135, v135
    v_mfma_f32_16x16x32_bf16 v[152:155], v[108:111], v[180:183], v[168:171]
    v_rcp_f32 v136, v136
    v_cvt_pk_bf16_f32 v133, v134, v135
    v_mfma_f32_16x16x32_bf16 v[148:151], v[104:107], v[184:187], v[148:151]
    v_rcp_f32 v137, v137
    v_cmp_gt_i32 vcc, v1, v245
    s_setprio 0
    s_cbranch_vccz Lf_lo0
    s_setprio 1
Lf_lo0:
    v_mfma_f32_16x16x32_bf16 v[152:155], v[112:115], v[184:187], v[152:155]
    v_rcp_f32 v138, v138
    v_cvt_pk_bf16_f32 v134, v136, v137
    v_mfma_f32_16x16x32_bf16 v[156:159], v[116:119], v[180:183], v[172:175]
    v_rcp_f32 v139, v139
    v_mfma_f32_16x16x32_bf16 v[160:163], v[124:127], v[180:183], v[176:179]
    v_rcp_f32 v140, v140
    v_cvt_pk_bf16_f32 v135, v138, v139
    v_mfma_f32_16x16x32_bf16 v[156:159], v[120:123], v[184:187], v[156:159]
    v_rcp_f32 v141, v141
    v_mfma_f32_16x16x32_bf16 v[160:163], v[128:131], v[184:187], v[160:163]
    v_rcp_f32 v142, v142
    v_cvt_pk_bf16_f32 v136, v140, v141
    v_mfma_f32_16x16x32_bf16 v[208:211], v[132:135], v[196:199], v[204:207]
    v_rcp_f32 v143, v143
    v_rcp_f32 v144, v144
    v_cvt_pk_bf16_f32 v137, v142, v143
    v_rcp_f32 v145, v145
    v_rcp_f32 v146, v146
    v_rcp_f32 v147, v147
    v_cvt_pk_bf16_f32 v138, v144, v145
    v_cvt_pk_bf16_f32 v139, v146, v147
    s_bitcmp1_b32 s36, 1
    s_cbranch_scc1 Lf_ev1
Lf_evd1:
    v_mfma_f32_16x16x32_bf16 v[208:211], v[136:139], v[200:203], v[208:211]
    v_exp_f32 v132, v148
    v_exp_f32 v133, v149
    v_exp_f32 v134, v150
    v_exp_f32 v135, v151
    v_exp_f32 v136, v152
    v_exp_f32 v137, v153
    v_mfma_f32_4x4x4_16b_bf16 v[132:135], v[228:229], v[228:229], v[132:135]
    v_exp_f32 v138, v154
    v_exp_f32 v139, v155
    v_cvt_pk_bf16_f32 v208, v208, v209
    v_cvt_pk_bf16_f32 v209, v210, v211
    v_exp_f32 v140, v156
    v_exp_f32 v141, v157
    v_mfma_f32_4x4x4_16b_bf16 v[212:215], v[208:209], v[188:189], v[212:215] cbsz:4 abid:0
    v_mfma_f32_4x4x4_16b_bf16 v[136:139], v[228:229], v[228:229], v[136:139]
    v_exp_f32 v142, v158
    v_mfma_f32_4x4x4_16b_bf16 v[212:215], v[208:209], v[190:191], v[212:215] cbsz:4 abid:4
    v_exp_f32 v143, v159
    v_exp_f32 v144, v160
    v_mfma_f32_4x4x4_16b_bf16 v[212:215], v[208:209], v[192:193], v[212:215] cbsz:4 abid:8
    v_exp_f32 v145, v161
    v_mfma_f32_4x4x4_16b_bf16 v[140:143], v[228:229], v[228:229], v[140:143]
    v_mfma_f32_4x4x4_16b_bf16 v[212:215], v[208:209], v[194:195], v[212:215] cbsz:4 abid:12
    ds_read_u8 v230, v237 offset:80
    ds_read_u8 v232, v237 offset:88
    ds_read_b64_tr_b16 v[188:189], v236 offset:2080
    ds_read_b64_tr_b16 v[190:191], v236 offset:2592
    ds_read_b64_tr_b16 v[192:193], v236 offset:3136
    ds_read_b64_tr_b16 v[194:195], v236 offset:3648
    s_waitcnt vmcnt(4)
    ds_read_b128 v[180:183], v234 offset:4160
    ds_read_b128 v[184:187], v235 offset:4160
    s_add_u32 m0, s52, 2080
    v_exp_f32 v146, v162
    v_exp_f32 v147, v163
    v_rcp_f32 v132, v132
    v_rcp_f32 v133, v133
    v_mfma_f32_4x4x4_16b_bf16 v[144:147], v[228:229], v[228:229], v[144:147]
    v_rcp_f32 v134, v134
    v_cvt_pk_bf16_f32 v132, v132, v133
    s_waitcnt lgkmcnt(2)
    buffer_load_dwordx4 v[230:231], s[20:23], s35 idxen offen nt lds
    buffer_load_dwordx4 v[232:233], s[40:43], s35 idxen offen offset:1056 nt lds
    s_waitcnt lgkmcnt(0)
    v_mfma_f32_16x16x32_bf16 v[148:151], v[100:103], v[180:183], v[164:167]
    v_rcp_f32 v135, v135
    v_mfma_f32_16x16x32_bf16 v[152:155], v[108:111], v[180:183], v[168:171]
    v_rcp_f32 v136, v136
    v_cvt_pk_bf16_f32 v133, v134, v135
    v_mfma_f32_16x16x32_bf16 v[148:151], v[104:107], v[184:187], v[148:151]
    v_rcp_f32 v137, v137
    v_mfma_f32_16x16x32_bf16 v[152:155], v[112:115], v[184:187], v[152:155]
    v_rcp_f32 v138, v138
    v_cvt_pk_bf16_f32 v134, v136, v137
    v_mfma_f32_16x16x32_bf16 v[156:159], v[116:119], v[180:183], v[172:175]
    v_rcp_f32 v139, v139
    v_mfma_f32_16x16x32_bf16 v[160:163], v[124:127], v[180:183], v[176:179]
    v_rcp_f32 v140, v140
    v_cvt_pk_bf16_f32 v135, v138, v139
    v_mfma_f32_16x16x32_bf16 v[156:159], v[120:123], v[184:187], v[156:159]
    v_rcp_f32 v141, v141
    v_mfma_f32_16x16x32_bf16 v[160:163], v[128:131], v[184:187], v[160:163]
    v_rcp_f32 v142, v142
    v_cvt_pk_bf16_f32 v136, v140, v141
    v_mfma_f32_16x16x32_bf16 v[208:211], v[132:135], v[196:199], v[204:207]
    v_rcp_f32 v143, v143
    v_rcp_f32 v144, v144
    v_cvt_pk_bf16_f32 v137, v142, v143
    v_rcp_f32 v145, v145
    v_rcp_f32 v146, v146
    v_rcp_f32 v147, v147
    v_cvt_pk_bf16_f32 v138, v144, v145
    v_cvt_pk_bf16_f32 v139, v146, v147
    s_bitcmp1_b32 s36, 2
    s_cbranch_scc1 Lf_ev2
Lf_evd2:
    v_mfma_f32_16x16x32_bf16 v[208:211], v[136:139], v[200:203], v[208:211]
    v_exp_f32 v132, v148
    v_exp_f32 v133, v149
    v_exp_f32 v134, v150
    v_exp_f32 v135, v151
    v_exp_f32 v136, v152
    v_exp_f32 v137, v153
    v_mfma_f32_4x4x4_16b_bf16 v[132:135], v[228:229], v[228:229], v[132:135]
    v_exp_f32 v138, v154
    v_exp_f32 v139, v155
    v_cvt_pk_bf16_f32 v208, v208, v209
    v_cvt_pk_bf16_f32 v209, v210, v211
    v_exp_f32 v140, v156
    v_exp_f32 v141, v157
    v_mfma_f32_4x4x4_16b_bf16 v[212:215], v[208:209], v[188:189], v[212:215] cbsz:4 abid:0
    v_mfma_f32_4x4x4_16b_bf16 v[136:139], v[228:229], v[228:229], v[136:139]
    v_exp_f32 v142, v158
    v_mfma_f32_4x4x4_16b_bf16 v[212:215], v[208:209], v[190:191], v[212:215] cbsz:4 abid:4
    v_exp_f32 v143, v159
    v_exp_f32 v144, v160
    v_mfma_f32_4x4x4_16b_bf16 v[212:215], v[208:209], v[192:193], v[212:215] cbsz:4 abid:8
    v_exp_f32 v145, v161
    v_mfma_f32_4x4x4_16b_bf16 v[140:143], v[228:229], v[228:229], v[140:143]
    v_mfma_f32_4x4x4_16b_bf16 v[212:215], v[208:209], v[194:195], v[212:215] cbsz:4 abid:12
    ds_read_u8 v230, v237 offset:96
    ds_read_u8 v232, v237 offset:104
    ds_read_b64_tr_b16 v[188:189], v236 offset:4160
    ds_read_b64_tr_b16 v[190:191], v236 offset:4672
    ds_read_b64_tr_b16 v[192:193], v236 offset:5216
    ds_read_b64_tr_b16 v[194:195], v236 offset:5728
    s_waitcnt vmcnt(4)
    ds_read_b128 v[180:183], v234 offset:6240
    ds_read_b128 v[184:187], v235 offset:6240
    s_add_u32 m0, s52, 4160
    v_exp_f32 v146, v162
    v_exp_f32 v147, v163
    v_rcp_f32 v132, v132
    v_rcp_f32 v133, v133
    v_mfma_f32_4x4x4_16b_bf16 v[144:147], v[228:229], v[228:229], v[144:147]
    v_rcp_f32 v134, v134
    v_cvt_pk_bf16_f32 v132, v132, v133
    s_waitcnt lgkmcnt(2)
    buffer_load_dwordx4 v[230:231], s[20:23], s35 idxen offen nt lds
    buffer_load_dwordx4 v[232:233], s[40:43], s35 idxen offen offset:1056 nt lds
    s_waitcnt lgkmcnt(0)
    v_mfma_f32_16x16x32_bf16 v[148:151], v[100:103], v[180:183], v[164:167]
    v_rcp_f32 v135, v135
    v_mfma_f32_16x16x32_bf16 v[152:155], v[108:111], v[180:183], v[168:171]
    v_rcp_f32 v136, v136
    v_cvt_pk_bf16_f32 v133, v134, v135
    v_mfma_f32_16x16x32_bf16 v[148:151], v[104:107], v[184:187], v[148:151]
    v_rcp_f32 v137, v137
    v_mfma_f32_16x16x32_bf16 v[152:155], v[112:115], v[184:187], v[152:155]
    v_rcp_f32 v138, v138
    v_cvt_pk_bf16_f32 v134, v136, v137
    v_mfma_f32_16x16x32_bf16 v[156:159], v[116:119], v[180:183], v[172:175]
    v_rcp_f32 v139, v139
    v_mfma_f32_16x16x32_bf16 v[160:163], v[124:127], v[180:183], v[176:179]
    v_rcp_f32 v140, v140
    v_cvt_pk_bf16_f32 v135, v138, v139
    v_mfma_f32_16x16x32_bf16 v[156:159], v[120:123], v[184:187], v[156:159]
    v_rcp_f32 v141, v141
    v_mfma_f32_16x16x32_bf16 v[160:163], v[128:131], v[184:187], v[160:163]
    v_rcp_f32 v142, v142
    v_cvt_pk_bf16_f32 v136, v140, v141
    v_mfma_f32_16x16x32_bf16 v[208:211], v[132:135], v[196:199], v[204:207]
    v_rcp_f32 v143, v143
    v_rcp_f32 v144, v144
    v_cvt_pk_bf16_f32 v137, v142, v143
    v_rcp_f32 v145, v145
    v_rcp_f32 v146, v146
    v_rcp_f32 v147, v147
    v_cvt_pk_bf16_f32 v138, v144, v145
    v_cvt_pk_bf16_f32 v139, v146, v147
    s_bitcmp1_b32 s36, 3
    s_cbranch_scc1 Lf_ev3
Lf_evd3:
    v_mfma_f32_16x16x32_bf16 v[208:211], v[136:139], v[200:203], v[208:211]
    v_exp_f32 v132, v148
    v_exp_f32 v133, v149
    v_exp_f32 v134, v150
    v_exp_f32 v135, v151
    v_exp_f32 v136, v152
    v_exp_f32 v137, v153
    v_mfma_f32_4x4x4_16b_bf16 v[132:135], v[228:229], v[228:229], v[132:135]
    v_exp_f32 v138, v154
    v_exp_f32 v139, v155
    v_cvt_pk_bf16_f32 v208, v208, v209
    v_cvt_pk_bf16_f32 v209, v210, v211
    v_exp_f32 v140, v156
    v_exp_f32 v141, v157
    v_mfma_f32_4x4x4_16b_bf16 v[212:215], v[208:209], v[188:189], v[212:215] cbsz:4 abid:0
    v_mfma_f32_4x4x4_16b_bf16 v[136:139], v[228:229], v[228:229], v[136:139]
    v_exp_f32 v142, v158
    v_mfma_f32_4x4x4_16b_bf16 v[212:215], v[208:209], v[190:191], v[212:215] cbsz:4 abid:4
    v_exp_f32 v143, v159
    v_exp_f32 v144, v160
    v_mfma_f32_4x4x4_16b_bf16 v[212:215], v[208:209], v[192:193], v[212:215] cbsz:4 abid:8
    v_exp_f32 v145, v161
    v_mfma_f32_4x4x4_16b_bf16 v[140:143], v[228:229], v[228:229], v[140:143]
    v_mfma_f32_4x4x4_16b_bf16 v[212:215], v[208:209], v[194:195], v[212:215] cbsz:4 abid:12
    ds_read_u8 v230, v237 offset:112
    ds_read_u8 v232, v237 offset:120
    ds_read_b64_tr_b16 v[188:189], v236 offset:6240
    ds_read_b64_tr_b16 v[190:191], v236 offset:6752
    ds_read_b64_tr_b16 v[192:193], v236 offset:7296
    ds_read_b64_tr_b16 v[194:195], v236 offset:7808
    s_waitcnt vmcnt(4)
    ds_read_b128 v[180:183], v234 offset:0
    ds_read_b128 v[184:187], v235 offset:0
    s_add_u32 m0, s52, 6240
    v_exp_f32 v146, v162
    v_exp_f32 v147, v163
    v_rcp_f32 v132, v132
    v_rcp_f32 v133, v133
    v_mfma_f32_4x4x4_16b_bf16 v[144:147], v[228:229], v[228:229], v[144:147]
    v_rcp_f32 v134, v134
    v_cvt_pk_bf16_f32 v132, v132, v133
    s_waitcnt lgkmcnt(2)
    buffer_load_dwordx4 v[230:231], s[20:23], s35 idxen offen nt lds
    buffer_load_dwordx4 v[232:233], s[40:43], s35 idxen offen offset:1056 nt lds
    s_waitcnt lgkmcnt(0)
    v_mfma_f32_16x16x32_bf16 v[148:151], v[100:103], v[180:183], v[164:167]
    v_rcp_f32 v135, v135
    v_mfma_f32_16x16x32_bf16 v[152:155], v[108:111], v[180:183], v[168:171]
    v_rcp_f32 v136, v136
    v_cvt_pk_bf16_f32 v133, v134, v135
    v_mfma_f32_16x16x32_bf16 v[148:151], v[104:107], v[184:187], v[148:151]
    v_rcp_f32 v137, v137
    v_mfma_f32_16x16x32_bf16 v[152:155], v[112:115], v[184:187], v[152:155]
    v_rcp_f32 v138, v138
    v_cvt_pk_bf16_f32 v134, v136, v137
    v_mfma_f32_16x16x32_bf16 v[156:159], v[116:119], v[180:183], v[172:175]
    v_rcp_f32 v139, v139
    v_mfma_f32_16x16x32_bf16 v[160:163], v[124:127], v[180:183], v[176:179]
    v_rcp_f32 v140, v140
    v_cvt_pk_bf16_f32 v135, v138, v139
    v_mfma_f32_16x16x32_bf16 v[156:159], v[120:123], v[184:187], v[156:159]
    v_rcp_f32 v141, v141
    v_mfma_f32_16x16x32_bf16 v[160:163], v[128:131], v[184:187], v[160:163]
    v_rcp_f32 v142, v142
    v_cvt_pk_bf16_f32 v136, v140, v141
    v_mfma_f32_16x16x32_bf16 v[208:211], v[132:135], v[196:199], v[204:207]
    v_rcp_f32 v143, v143
    v_rcp_f32 v144, v144
    v_cvt_pk_bf16_f32 v137, v142, v143
    s_lshr_b64 s[56:57], s[56:57], 4
    s_lshr_b64 s[86:87], s[56:57], 2
    s_lshr_b64 s[36:37], s[56:57], 5
    s_or_b32 s36, s36, s86
    s_or_b32 s36, s36, s56
    v_add_u32 v237, 64, v237
    v_rcp_f32 v145, v145
    v_rcp_f32 v146, v146
    v_rcp_f32 v147, v147
    v_cvt_pk_bf16_f32 v138, v144, v145
    v_cvt_pk_bf16_f32 v139, v146, v147
    s_branch Lf_loop
Lf_ev0:
    s_bitcmp0_b64 s[56:57], 0
    s_cbranch_scc1 Lf_nf0
    v_cvt_pk_bf16_f32 v246, v212, v212
    v_mov_b32 v212, 0
    ds_write_b16 v240, v246
    v_add_u32 v240, 128, v240
Lf_nf0:
    s_bitcmp0_b64 s[56:57], 5
    s_cbranch_scc1 Lf_na0
    s_sub_u32 s60, s60, 1
    s_cbranch_scc0 Lf_ns0
    s_mov_b32 s49, 5
    s_call_b64 s[62:63], L_swap
    s_add_u32 s35, s35, s31
    s_min_u32 s35, s35, 419404800
    s_xor_b32 s31, s31, 0x63ff800
    s_bitcmp0_b64 s[56:57], 2
    s_cbranch_scc1 Lf_evd0
    s_waitcnt lgkmcnt(0)
    s_branch Lf_e10
Lf_ns0:
    s_add_u32 s35, s35, s31
    s_min_u32 s35, s35, 419404800
    s_xor_b32 s31, s31, 0x63ff800
Lf_na0:
    s_bitcmp0_b64 s[56:57], 2
    s_cbranch_scc1 Lf_evd0
Lf_e10:
    s_sub_u32 s61, s61, 1
    s_cbranch_scc1 Lf_last0
    s_bitcmp0_b32 s33, s61
    s_cbranch_scc1 Lf_nw0
    s_cmp_eq_u32 s61, 3
    s_cselect_b32 s66, s80, s81
    v_add_u32 v238, s66, v238
    v_add_u32 v239, s66, v239
    ds_read_u16 v224, v238 offset:0
    ds_read_u16 v225, v238 offset:8
    ds_read_u16 v226, v238 offset:64
    ds_read_u16 v227, v238 offset:72
    s_waitcnt lgkmcnt(0)
Lf_nw0:
    v_mul_u32_u24 v216, v224, v241
    v_mul_u32_u24 v217, v224, v242
    v_mul_u32_u24 v218, v225, v241
    v_mul_u32_u24 v219, v225, v242
    v_mul_u32_u24 v220, v226, v241
    v_mul_u32_u24 v221, v226, v242
    v_mul_u32_u24 v222, v227, v241
    v_mul_u32_u24 v223, v227, v242
    v_mfma_f32_4x4x4_16b_bf16 v[140:143], v[216:217], v[68:69], v[4:7]
    v_add_u32 v238, 128, v238
    ds_read_b128 v[164:167], v239 offset:0
    ds_read_b128 v[168:171], v239 offset:64
    v_mfma_f32_4x4x4_16b_bf16 v[144:147], v[218:219], v[70:71], v[8:11]
    ds_read_b128 v[172:175], v239 offset:128
    ds_read_b128 v[176:179], v239 offset:192
    ds_read_u16 v224, v238 offset:0
    ds_read_u16 v225, v238 offset:8
    ds_read_u16 v226, v238 offset:64
    ds_read_u16 v227, v238 offset:72
    v_mfma_f32_4x4x4_16b_bf16 v[246:249], v[220:221], v[72:73], v[12:15]
    v_cvt_pk_bf16_f32 v100, v140, v141
    v_cvt_pk_bf16_f32 v101, v142, v143
    v_mfma_f32_4x4x4_16b_bf16 v[250:253], v[222:223], v[74:75], v[16:19]
    v_cvt_pk_bf16_f32 v102, v144, v145
    v_cvt_pk_bf16_f32 v103, v146, v147
    v_mfma_f32_4x4x4_16b_bf16 v[140:143], v[216:217], v[76:77], v[20:23]
    v_cvt_pk_bf16_f32 v104, v246, v247
    v_cvt_pk_bf16_f32 v105, v248, v249
    v_mfma_f32_4x4x4_16b_bf16 v[144:147], v[218:219], v[78:79], v[24:27]
    v_cvt_pk_bf16_f32 v106, v250, v251
    v_cvt_pk_bf16_f32 v107, v252, v253
    v_mfma_f32_4x4x4_16b_bf16 v[246:249], v[220:221], v[80:81], v[28:31]
    v_cvt_pk_bf16_f32 v108, v140, v141
    v_cvt_pk_bf16_f32 v109, v142, v143
    v_mfma_f32_4x4x4_16b_bf16 v[250:253], v[222:223], v[82:83], v[32:35]
    v_cvt_pk_bf16_f32 v110, v144, v145
    v_cvt_pk_bf16_f32 v111, v146, v147
    v_mfma_f32_4x4x4_16b_bf16 v[140:143], v[216:217], v[84:85], v[36:39]
    v_cvt_pk_bf16_f32 v112, v246, v247
    v_cvt_pk_bf16_f32 v113, v248, v249
    v_mfma_f32_4x4x4_16b_bf16 v[144:147], v[218:219], v[86:87], v[40:43]
    v_cvt_pk_bf16_f32 v114, v250, v251
    v_cvt_pk_bf16_f32 v115, v252, v253
    v_mfma_f32_4x4x4_16b_bf16 v[246:249], v[220:221], v[88:89], v[44:47]
    v_cvt_pk_bf16_f32 v116, v140, v141
    v_cvt_pk_bf16_f32 v117, v142, v143
    v_mfma_f32_4x4x4_16b_bf16 v[250:253], v[222:223], v[90:91], v[48:51]
    v_cvt_pk_bf16_f32 v118, v144, v145
    v_cvt_pk_bf16_f32 v119, v146, v147
    v_mfma_f32_4x4x4_16b_bf16 v[140:143], v[216:217], v[92:93], v[52:55]
    v_cvt_pk_bf16_f32 v120, v246, v247
    v_cvt_pk_bf16_f32 v121, v248, v249
    v_mfma_f32_4x4x4_16b_bf16 v[144:147], v[218:219], v[94:95], v[56:59]
    v_cvt_pk_bf16_f32 v122, v250, v251
    v_cvt_pk_bf16_f32 v123, v252, v253
    v_mfma_f32_4x4x4_16b_bf16 v[246:249], v[220:221], v[96:97], v[60:63]
    v_cvt_pk_bf16_f32 v124, v140, v141
    v_cvt_pk_bf16_f32 v125, v142, v143
    v_mfma_f32_4x4x4_16b_bf16 v[250:253], v[222:223], v[98:99], v[64:67]
    v_cvt_pk_bf16_f32 v126, v144, v145
    v_cvt_pk_bf16_f32 v127, v146, v147
    v_cvt_pk_bf16_f32 v128, v246, v247
    v_cvt_pk_bf16_f32 v129, v248, v249
    v_add_u32 v239, 272, v239
    v_cvt_pk_bf16_f32 v130, v250, v251
    v_cvt_pk_bf16_f32 v131, v252, v253
    s_waitcnt lgkmcnt(0)
    s_branch Lf_evd0
Lf_ev1:
    s_bitcmp0_b64 s[56:57], 1
    s_cbranch_scc1 Lf_nf1
    v_cvt_pk_bf16_f32 v246, v212, v212
    v_mov_b32 v212, 0
    ds_write_b16 v240, v246
    v_add_u32 v240, 128, v240
Lf_nf1:
    s_bitcmp0_b64 s[56:57], 6
    s_cbranch_scc1 Lf_na1
    s_sub_u32 s60, s60, 1
    s_cbranch_scc0 Lf_ns1
    s_mov_b32 s49, 6
    s_call_b64 s[62:63], L_swap
    s_add_u32 s35, s35, s31
    s_min_u32 s35, s35, 419404800
    s_xor_b32 s31, s31, 0x63ff800
    s_bitcmp0_b64 s[56:57], 3
    s_cbranch_scc1 Lf_evd1
    s_waitcnt lgkmcnt(0)
    s_branch Lf_e11
Lf_ns1:
    s_add_u32 s35, s35, s31
    s_min_u32 s35, s35, 419404800
    s_xor_b32 s31, s31, 0x63ff800
Lf_na1:
    s_bitcmp0_b64 s[56:57], 3
    s_cbranch_scc1 Lf_evd1
Lf_e11:
    s_sub_u32 s61, s61, 1
    s_cbranch_scc1 Lf_last1
    s_bitcmp0_b32 s33, s61
    s_cbranch_scc1 Lf_nw1
    s_cmp_eq_u32 s61, 3
    s_cselect_b32 s66, s80, s81
    v_add_u32 v238, s66, v238
    v_add_u32 v239, s66, v239
    ds_read_u16 v224, v238 offset:0
    ds_read_u16 v225, v238 offset:8
    ds_read_u16 v226, v238 offset:64
    ds_read_u16 v227, v238 offset:72
    s_waitcnt lgkmcnt(0)
Lf_nw1:
    v_mul_u32_u24 v216, v224, v241
    v_mul_u32_u24 v217, v224, v242
    v_mul_u32_u24 v218, v225, v241
    v_mul_u32_u24 v219, v225, v242
    v_mul_u32_u24 v220, v226, v241
    v_mul_u32_u24 v221, v226, v242
    v_mul_u32_u24 v222, v227, v241
    v_mul_u32_u24 v223, v227, v242
    v_mfma_f32_4x4x4_16b_bf16 v[140:143], v[216:217], v[68:69], v[4:7]
    v_add_u32 v238, 128, v238
    ds_read_b128 v[164:167], v239 offset:0
    ds_read_b128 v[168:171], v239 offset:64
    v_mfma_f32_4x4x4_16b_bf16 v[144:147], v[218:219], v[70:71], v[8:11]
    ds_read_b128 v[172:175], v239 offset:128
    ds_read_b128 v[176:179], v239 offset:192
    ds_read_u16 v224, v238 offset:0
    ds_read_u16 v225, v238 offset:8
    ds_read_u16 v226, v238 offset:64
    ds_read_u16 v227, v238 offset:72
    v_mfma_f32_4x4x4_16b_bf16 v[246:249], v[220:221], v[72:73], v[12:15]
    v_cvt_pk_bf16_f32 v100, v140, v141
    v_cvt_pk_bf16_f32 v101, v142, v143
    v_mfma_f32_4x4x4_16b_bf16 v[250:253], v[222:223], v[74:75], v[16:19]
    v_cvt_pk_bf16_f32 v102, v144, v145
    v_cvt_pk_bf16_f32 v103, v146, v147
    v_mfma_f32_4x4x4_16b_bf16 v[140:143], v[216:217], v[76:77], v[20:23]
    v_cvt_pk_bf16_f32 v104, v246, v247
    v_cvt_pk_bf16_f32 v105, v248, v249
    v_mfma_f32_4x4x4_16b_bf16 v[144:147], v[218:219], v[78:79], v[24:27]
    v_cvt_pk_bf16_f32 v106, v250, v251
    v_cvt_pk_bf16_f32 v107, v252, v253
    v_mfma_f32_4x4x4_16b_bf16 v[246:249], v[220:221], v[80:81], v[28:31]
    v_cvt_pk_bf16_f32 v108, v140, v141
    v_cvt_pk_bf16_f32 v109, v142, v143
    v_mfma_f32_4x4x4_16b_bf16 v[250:253], v[222:223], v[82:83], v[32:35]
    v_cvt_pk_bf16_f32 v110, v144, v145
    v_cvt_pk_bf16_f32 v111, v146, v147
    v_mfma_f32_4x4x4_16b_bf16 v[140:143], v[216:217], v[84:85], v[36:39]
    v_cvt_pk_bf16_f32 v112, v246, v247
    v_cvt_pk_bf16_f32 v113, v248, v249
    v_mfma_f32_4x4x4_16b_bf16 v[144:147], v[218:219], v[86:87], v[40:43]
    v_cvt_pk_bf16_f32 v114, v250, v251
    v_cvt_pk_bf16_f32 v115, v252, v253
    v_mfma_f32_4x4x4_16b_bf16 v[246:249], v[220:221], v[88:89], v[44:47]
    v_cvt_pk_bf16_f32 v116, v140, v141
    v_cvt_pk_bf16_f32 v117, v142, v143
    v_mfma_f32_4x4x4_16b_bf16 v[250:253], v[222:223], v[90:91], v[48:51]
    v_cvt_pk_bf16_f32 v118, v144, v145
    v_cvt_pk_bf16_f32 v119, v146, v147
    v_mfma_f32_4x4x4_16b_bf16 v[140:143], v[216:217], v[92:93], v[52:55]
    v_cvt_pk_bf16_f32 v120, v246, v247
    v_cvt_pk_bf16_f32 v121, v248, v249
    v_mfma_f32_4x4x4_16b_bf16 v[144:147], v[218:219], v[94:95], v[56:59]
    v_cvt_pk_bf16_f32 v122, v250, v251
    v_cvt_pk_bf16_f32 v123, v252, v253
    v_mfma_f32_4x4x4_16b_bf16 v[246:249], v[220:221], v[96:97], v[60:63]
    v_cvt_pk_bf16_f32 v124, v140, v141
    v_cvt_pk_bf16_f32 v125, v142, v143
    v_mfma_f32_4x4x4_16b_bf16 v[250:253], v[222:223], v[98:99], v[64:67]
    v_cvt_pk_bf16_f32 v126, v144, v145
    v_cvt_pk_bf16_f32 v127, v146, v147
    v_cvt_pk_bf16_f32 v128, v246, v247
    v_cvt_pk_bf16_f32 v129, v248, v249
    v_add_u32 v239, 272, v239
    v_cvt_pk_bf16_f32 v130, v250, v251
    v_cvt_pk_bf16_f32 v131, v252, v253
    s_waitcnt lgkmcnt(0)
    s_branch Lf_evd1
Lf_ev2:
    s_bitcmp0_b64 s[56:57], 2
    s_cbranch_scc1 Lf_nf2
    v_cvt_pk_bf16_f32 v246, v212, v212
    v_mov_b32 v212, 0
    ds_write_b16 v240, v246
    v_add_u32 v240, 128, v240
Lf_nf2:
    s_bitcmp0_b64 s[56:57], 7
    s_cbranch_scc1 Lf_na2
    s_sub_u32 s60, s60, 1
    s_cbranch_scc0 Lf_ns2
    s_mov_b32 s49, 7
    s_call_b64 s[62:63], L_swap
    s_add_u32 s35, s35, s31
    s_min_u32 s35, s35, 419404800
    s_xor_b32 s31, s31, 0x63ff800
    s_bitcmp0_b64 s[56:57], 4
    s_cbranch_scc1 Lf_evd2
    s_waitcnt lgkmcnt(0)
    s_branch Lf_e12
Lf_ns2:
    s_add_u32 s35, s35, s31
    s_min_u32 s35, s35, 419404800
    s_xor_b32 s31, s31, 0x63ff800
Lf_na2:
    s_bitcmp0_b64 s[56:57], 4
    s_cbranch_scc1 Lf_evd2
Lf_e12:
    s_sub_u32 s61, s61, 1
    s_cbranch_scc1 Lf_last2
    s_bitcmp0_b32 s33, s61
    s_cbranch_scc1 Lf_nw2
    s_cmp_eq_u32 s61, 3
    s_cselect_b32 s66, s80, s81
    v_add_u32 v238, s66, v238
    v_add_u32 v239, s66, v239
    ds_read_u16 v224, v238 offset:0
    ds_read_u16 v225, v238 offset:8
    ds_read_u16 v226, v238 offset:64
    ds_read_u16 v227, v238 offset:72
    s_waitcnt lgkmcnt(0)
Lf_nw2:
    v_mul_u32_u24 v216, v224, v241
    v_mul_u32_u24 v217, v224, v242
    v_mul_u32_u24 v218, v225, v241
    v_mul_u32_u24 v219, v225, v242
    v_mul_u32_u24 v220, v226, v241
    v_mul_u32_u24 v221, v226, v242
    v_mul_u32_u24 v222, v227, v241
    v_mul_u32_u24 v223, v227, v242
    v_mfma_f32_4x4x4_16b_bf16 v[140:143], v[216:217], v[68:69], v[4:7]
    v_add_u32 v238, 128, v238
    ds_read_b128 v[164:167], v239 offset:0
    ds_read_b128 v[168:171], v239 offset:64
    v_mfma_f32_4x4x4_16b_bf16 v[144:147], v[218:219], v[70:71], v[8:11]
    ds_read_b128 v[172:175], v239 offset:128
    ds_read_b128 v[176:179], v239 offset:192
    ds_read_u16 v224, v238 offset:0
    ds_read_u16 v225, v238 offset:8
    ds_read_u16 v226, v238 offset:64
    ds_read_u16 v227, v238 offset:72
    v_mfma_f32_4x4x4_16b_bf16 v[246:249], v[220:221], v[72:73], v[12:15]
    v_cvt_pk_bf16_f32 v100, v140, v141
    v_cvt_pk_bf16_f32 v101, v142, v143
    v_mfma_f32_4x4x4_16b_bf16 v[250:253], v[222:223], v[74:75], v[16:19]
    v_cvt_pk_bf16_f32 v102, v144, v145
    v_cvt_pk_bf16_f32 v103, v146, v147
    v_mfma_f32_4x4x4_16b_bf16 v[140:143], v[216:217], v[76:77], v[20:23]
    v_cvt_pk_bf16_f32 v104, v246, v247
    v_cvt_pk_bf16_f32 v105, v248, v249
    v_mfma_f32_4x4x4_16b_bf16 v[144:147], v[218:219], v[78:79], v[24:27]
    v_cvt_pk_bf16_f32 v106, v250, v251
    v_cvt_pk_bf16_f32 v107, v252, v253
    v_mfma_f32_4x4x4_16b_bf16 v[246:249], v[220:221], v[80:81], v[28:31]
    v_cvt_pk_bf16_f32 v108, v140, v141
    v_cvt_pk_bf16_f32 v109, v142, v143
    v_mfma_f32_4x4x4_16b_bf16 v[250:253], v[222:223], v[82:83], v[32:35]
    v_cvt_pk_bf16_f32 v110, v144, v145
    v_cvt_pk_bf16_f32 v111, v146, v147
    v_mfma_f32_4x4x4_16b_bf16 v[140:143], v[216:217], v[84:85], v[36:39]
    v_cvt_pk_bf16_f32 v112, v246, v247
    v_cvt_pk_bf16_f32 v113, v248, v249
    v_mfma_f32_4x4x4_16b_bf16 v[144:147], v[218:219], v[86:87], v[40:43]
    v_cvt_pk_bf16_f32 v114, v250, v251
    v_cvt_pk_bf16_f32 v115, v252, v253
    v_mfma_f32_4x4x4_16b_bf16 v[246:249], v[220:221], v[88:89], v[44:47]
    v_cvt_pk_bf16_f32 v116, v140, v141
    v_cvt_pk_bf16_f32 v117, v142, v143
    v_mfma_f32_4x4x4_16b_bf16 v[250:253], v[222:223], v[90:91], v[48:51]
    v_cvt_pk_bf16_f32 v118, v144, v145
    v_cvt_pk_bf16_f32 v119, v146, v147
    v_mfma_f32_4x4x4_16b_bf16 v[140:143], v[216:217], v[92:93], v[52:55]
    v_cvt_pk_bf16_f32 v120, v246, v247
    v_cvt_pk_bf16_f32 v121, v248, v249
    v_mfma_f32_4x4x4_16b_bf16 v[144:147], v[218:219], v[94:95], v[56:59]
    v_cvt_pk_bf16_f32 v122, v250, v251
    v_cvt_pk_bf16_f32 v123, v252, v253
    v_mfma_f32_4x4x4_16b_bf16 v[246:249], v[220:221], v[96:97], v[60:63]
    v_cvt_pk_bf16_f32 v124, v140, v141
    v_cvt_pk_bf16_f32 v125, v142, v143
    v_mfma_f32_4x4x4_16b_bf16 v[250:253], v[222:223], v[98:99], v[64:67]
    v_cvt_pk_bf16_f32 v126, v144, v145
    v_cvt_pk_bf16_f32 v127, v146, v147
    v_cvt_pk_bf16_f32 v128, v246, v247
    v_cvt_pk_bf16_f32 v129, v248, v249
    v_add_u32 v239, 272, v239
    v_cvt_pk_bf16_f32 v130, v250, v251
    v_cvt_pk_bf16_f32 v131, v252, v253
    s_waitcnt lgkmcnt(0)
    s_branch Lf_evd2
Lf_ev3:
    s_bitcmp0_b64 s[56:57], 3
    s_cbranch_scc1 Lf_nf3
    v_cvt_pk_bf16_f32 v246, v212, v212
    v_mov_b32 v212, 0
    ds_write_b16 v240, v246
    v_add_u32 v240, 128, v240
Lf_nf3:
    s_bitcmp0_b64 s[56:57], 8
    s_cbranch_scc1 Lf_na3
    s_sub_u32 s60, s60, 1
    s_cbranch_scc0 Lf_ns3
    s_mov_b32 s49, 8
    s_call_b64 s[62:63], L_swap
    s_add_u32 s35, s35, s31
    s_min_u32 s35, s35, 419404800
    s_xor_b32 s31, s31, 0x63ff800
    s_bitcmp0_b64 s[56:57], 5
    s_cbranch_scc1 Lf_evd3
    s_waitcnt lgkmcnt(0)
    s_branch Lf_e13
Lf_ns3:
    s_add_u32 s35, s35, s31
    s_min_u32 s35, s35, 419404800
    s_xor_b32 s31, s31, 0x63ff800
Lf_na3:
    s_bitcmp0_b64 s[56:57], 5
    s_cbranch_scc1 Lf_evd3
Lf_e13:
    s_sub_u32 s61, s61, 1
    s_cbranch_scc1 Lf_last3
    s_bitcmp0_b32 s33, s61
    s_cbranch_scc1 Lf_nw3
    s_cmp_eq_u32 s61, 3
    s_cselect_b32 s66, s80, s81
    v_add_u32 v238, s66, v238
    v_add_u32 v239, s66, v239
    ds_read_u16 v224, v238 offset:0
    ds_read_u16 v225, v238 offset:8
    ds_read_u16 v226, v238 offset:64
    ds_read_u16 v227, v238 offset:72
    s_waitcnt lgkmcnt(0)
Lf_nw3:
    v_mul_u32_u24 v216, v224, v241
    v_mul_u32_u24 v217, v224, v242
    v_mul_u32_u24 v218, v225, v241
    v_mul_u32_u24 v219, v225, v242
    v_mul_u32_u24 v220, v226, v241
    v_mul_u32_u24 v221, v226, v242
    v_mul_u32_u24 v222, v227, v241
    v_mul_u32_u24 v223, v227, v242
    v_mfma_f32_4x4x4_16b_bf16 v[140:143], v[216:217], v[68:69], v[4:7]
    v_add_u32 v238, 128, v238
    ds_read_b128 v[164:167], v239 offset:0
    ds_read_b128 v[168:171], v239 offset:64
    v_mfma_f32_4x4x4_16b_bf16 v[144:147], v[218:219], v[70:71], v[8:11]
    ds_read_b128 v[172:175], v239 offset:128
    ds_read_b128 v[176:179], v239 offset:192
    ds_read_u16 v224, v238 offset:0
    ds_read_u16 v225, v238 offset:8
    ds_read_u16 v226, v238 offset:64
    ds_read_u16 v227, v238 offset:72
    v_mfma_f32_4x4x4_16b_bf16 v[246:249], v[220:221], v[72:73], v[12:15]
    v_cvt_pk_bf16_f32 v100, v140, v141
    v_cvt_pk_bf16_f32 v101, v142, v143
    v_mfma_f32_4x4x4_16b_bf16 v[250:253], v[222:223], v[74:75], v[16:19]
    v_cvt_pk_bf16_f32 v102, v144, v145
    v_cvt_pk_bf16_f32 v103, v146, v147
    v_mfma_f32_4x4x4_16b_bf16 v[140:143], v[216:217], v[76:77], v[20:23]
    v_cvt_pk_bf16_f32 v104, v246, v247
    v_cvt_pk_bf16_f32 v105, v248, v249
    v_mfma_f32_4x4x4_16b_bf16 v[144:147], v[218:219], v[78:79], v[24:27]
    v_cvt_pk_bf16_f32 v106, v250, v251
    v_cvt_pk_bf16_f32 v107, v252, v253
    v_mfma_f32_4x4x4_16b_bf16 v[246:249], v[220:221], v[80:81], v[28:31]
    v_cvt_pk_bf16_f32 v108, v140, v141
    v_cvt_pk_bf16_f32 v109, v142, v143
    v_mfma_f32_4x4x4_16b_bf16 v[250:253], v[222:223], v[82:83], v[32:35]
    v_cvt_pk_bf16_f32 v110, v144, v145
    v_cvt_pk_bf16_f32 v111, v146, v147
    v_mfma_f32_4x4x4_16b_bf16 v[140:143], v[216:217], v[84:85], v[36:39]
    v_cvt_pk_bf16_f32 v112, v246, v247
    v_cvt_pk_bf16_f32 v113, v248, v249
    v_mfma_f32_4x4x4_16b_bf16 v[144:147], v[218:219], v[86:87], v[40:43]
    v_cvt_pk_bf16_f32 v114, v250, v251
    v_cvt_pk_bf16_f32 v115, v252, v253
    v_mfma_f32_4x4x4_16b_bf16 v[246:249], v[220:221], v[88:89], v[44:47]
    v_cvt_pk_bf16_f32 v116, v140, v141
    v_cvt_pk_bf16_f32 v117, v142, v143
    v_mfma_f32_4x4x4_16b_bf16 v[250:253], v[222:223], v[90:91], v[48:51]
    v_cvt_pk_bf16_f32 v118, v144, v145
    v_cvt_pk_bf16_f32 v119, v146, v147
    v_mfma_f32_4x4x4_16b_bf16 v[140:143], v[216:217], v[92:93], v[52:55]
    v_cvt_pk_bf16_f32 v120, v246, v247
    v_cvt_pk_bf16_f32 v121, v248, v249
    v_mfma_f32_4x4x4_16b_bf16 v[144:147], v[218:219], v[94:95], v[56:59]
    v_cvt_pk_bf16_f32 v122, v250, v251
    v_cvt_pk_bf16_f32 v123, v252, v253
    v_mfma_f32_4x4x4_16b_bf16 v[246:249], v[220:221], v[96:97], v[60:63]
    v_cvt_pk_bf16_f32 v124, v140, v141
    v_cvt_pk_bf16_f32 v125, v142, v143
    v_mfma_f32_4x4x4_16b_bf16 v[250:253], v[222:223], v[98:99], v[64:67]
    v_cvt_pk_bf16_f32 v126, v144, v145
    v_cvt_pk_bf16_f32 v127, v146, v147
    v_cvt_pk_bf16_f32 v128, v246, v247
    v_cvt_pk_bf16_f32 v129, v248, v249
    v_add_u32 v239, 272, v239
    v_cvt_pk_bf16_f32 v130, v250, v251
    v_cvt_pk_bf16_f32 v131, v252, v253
    s_waitcnt lgkmcnt(0)
    s_branch Lf_evd3
Lf_last0:
    s_branch Lf_tail
Lf_last1:
    v_add_u32 v236, 2080, v236
    s_lshr_b64 s[56:57], s[56:57], 1
    s_branch Lf_tail
Lf_last2:
    v_add_u32 v236, 4160, v236
    s_lshr_b64 s[56:57], s[56:57], 2
    s_branch Lf_tail
Lf_last3:
    v_add_u32 v236, 6240, v236
    s_lshr_b64 s[56:57], s[56:57], 3
Lf_tail:
    v_mfma_f32_16x16x32_bf16 v[208:211], v[136:139], v[200:203], v[208:211]
    v_exp_f32 v132, v148
    v_exp_f32 v133, v149
    v_exp_f32 v134, v150
    v_exp_f32 v135, v151
    v_exp_f32 v136, v152
    v_exp_f32 v137, v153
    v_mfma_f32_4x4x4_16b_bf16 v[132:135], v[228:229], v[228:229], v[132:135]
    v_exp_f32 v138, v154
    v_exp_f32 v139, v155
    v_cvt_pk_bf16_f32 v208, v208, v209
    v_cvt_pk_bf16_f32 v209, v210, v211
    v_exp_f32 v140, v156
    v_exp_f32 v141, v157
    v_mfma_f32_4x4x4_16b_bf16 v[212:215], v[208:209], v[188:189], v[212:215] cbsz:4 abid:0
    v_mfma_f32_4x4x4_16b_bf16 v[136:139], v[228:229], v[228:229], v[136:139]
    v_exp_f32 v142, v158
    v_mfma_f32_4x4x4_16b_bf16 v[212:215], v[208:209], v[190:191], v[212:215] cbsz:4 abid:4
    v_exp_f32 v143, v159
    v_exp_f32 v144, v160
    v_mfma_f32_4x4x4_16b_bf16 v[212:215], v[208:209], v[192:193], v[212:215] cbsz:4 abid:8
    v_exp_f32 v145, v161
    v_mfma_f32_4x4x4_16b_bf16 v[140:143], v[228:229], v[228:229], v[140:143]
    v_mfma_f32_4x4x4_16b_bf16 v[212:215], v[208:209], v[194:195], v[212:215] cbsz:4 abid:12
    ds_read_b64_tr_b16 v[188:189], v236 offset:0
    ds_read_b64_tr_b16 v[190:191], v236 offset:512
    ds_read_b64_tr_b16 v[192:193], v236 offset:1056
    ds_read_b64_tr_b16 v[194:195], v236 offset:1568
    v_exp_f32 v146, v162
    v_exp_f32 v147, v163
    v_rcp_f32 v132, v132
    v_rcp_f32 v133, v133
    v_mfma_f32_4x4x4_16b_bf16 v[144:147], v[228:229], v[228:229], v[144:147]
    v_rcp_f32 v134, v134
    s_bitcmp0_b64 s[56:57], 1
    s_cbranch_scc1 Lf_tnf
    v_cvt_pk_bf16_f32 v246, v212, v212
    v_mov_b32 v212, 0
    ds_write_b16 v240, v246
    v_add_u32 v240, 128, v240
Lf_tnf:
    v_cvt_pk_bf16_f32 v132, v132, v133
    s_waitcnt lgkmcnt(0)
    v_rcp_f32 v135, v135
    v_rcp_f32 v136, v136
    v_cvt_pk_bf16_f32 v133, v134, v135
    v_rcp_f32 v137, v137
    v_rcp_f32 v138, v138
    v_cvt_pk_bf16_f32 v134, v136, v137
    v_rcp_f32 v139, v139
    v_rcp_f32 v140, v140
    v_cvt_pk_bf16_f32 v135, v138, v139
    v_rcp_f32 v141, v141
    v_rcp_f32 v142, v142
    v_cvt_pk_bf16_f32 v136, v140, v141
    v_mfma_f32_16x16x32_bf16 v[208:211], v[132:135], v[196:199], v[204:207]
    v_rcp_f32 v143, v143
    v_rcp_f32 v144, v144
    v_cvt_pk_bf16_f32 v137, v142, v143
    v_rcp_f32 v145, v145
    v_rcp_f32 v146, v146
    v_rcp_f32 v147, v147
    v_cvt_pk_bf16_f32 v138, v144, v145
    v_cvt_pk_bf16_f32 v139, v146, v147
    s_nop 1
    v_mfma_f32_16x16x32_bf16 v[208:211], v[136:139], v[200:203], v[208:211]
    s_nop 7
    v_cvt_pk_bf16_f32 v208, v208, v209
    v_cvt_pk_bf16_f32 v209, v210, v211
    s_nop 1
    v_mfma_f32_4x4x4_16b_bf16 v[212:215], v[208:209], v[188:189], v[212:215] cbsz:4 abid:0
    s_nop 1
    v_mfma_f32_4x4x4_16b_bf16 v[212:215], v[208:209], v[190:191], v[212:215] cbsz:4 abid:4
    s_nop 1
    v_mfma_f32_4x4x4_16b_bf16 v[212:215], v[208:209], v[192:193], v[212:215] cbsz:4 abid:8
    s_nop 1
    v_mfma_f32_4x4x4_16b_bf16 v[212:215], v[208:209], v[194:195], v[212:215] cbsz:4 abid:12
    s_nop 4
    v_cvt_pk_bf16_f32 v246, v212, v212
    ds_write_b16 v240, v246
L_store:
    s_add_u32 s66, s52, 14912
    v_lshl_add_u32 v247, v0, 4, s66
    s_lshl_b32 s66, s82, 5
    s_bfm_b64 exec, 16, 32
    v_add_u32 v243, s66, v243
    s_lshl_b32 s66, s83, 5
    s_bfm_b64 exec, 16, 48
    v_add_u32 v243, s66, v243
    s_mov_b64 exec, -1
    ds_read_b128 v[148:151], v247
    s_waitcnt lgkmcnt(0)
    global_store_dwordx4 v243, v[148:151], s[18:19] sc0 sc1
L_end:
    s_endpgm
L_general:
    s_waitcnt vmcnt(0)
    ds_read_b128 v[44:47], v246 offset:20480
    ds_read_b128 v[48:51], v246 offset:21504
    ds_read_b128 v[88:91], v246 offset:22528
    ds_read_b128 v[52:55], v246 offset:40960
    ds_read_b128 v[56:59], v246 offset:41984
    ds_read_b128 v[92:95], v246 offset:43008
    ds_read_b128 v[60:63], v246 offset:61440
    ds_read_b128 v[64:67], v246 offset:62464
    ds_read_b128 v[96:99], v246 offset:63488
    ds_read_u16 v224, v238 offset:0
    ds_read_u16 v225, v238 offset:8
    ds_read_u16 v226, v238 offset:64
    ds_read_u16 v227, v238 offset:72
    s_mul_i32 s35, s53, 51200
    s_movk_i32 s31, 25600
    s_mov_b32 s60, 3
    s_mov_b64 s[56:57], 0
    v_mov_b32 v148, -1
    v_mov_b32 v149, -1
    v_mov_b32 v150, -1
    v_mov_b32 v151, -1
    s_add_u32 s66, s52, 18432
    v_add_u32 v152, s66, v2
    ds_write_b128 v152, v[148:151]
    ds_write_b128 v152, v[148:151] offset:1024
    s_add_u32 s64, s52, 18448
    s_bfm_b64 s[28:29], 50, 0
    s_mul_i32 s66, s53, 800
    v_add_u32 v247, s66, v2
    s_mov_b64 exec, s[28:29]
    global_load_dwordx4 v[100:103], v247, s[8:9]
    v_add_u32 v247, 1638400, v247
    global_load_dwordx4 v[104:107], v247, s[8:9]
    v_add_u32 v247, 1638400, v247
    global_load_dwordx4 v[108:111], v247, s[8:9]
    v_add_u32 v247, 1638400, v247
    global_load_dwordx4 v[112:115], v247, s[8:9]
    v_add_u32 v247, 1638400, v247
    s_mov_b64 exec, -1
    v_cmp_lt_u32 vcc, 24, v0
    s_nop 1
    v_cndmask_b32 v145, 0, 1, vcc
    v_mul_u32_u24 v142, 25, v145
    v_sub_u32 v142, v0, v142
    v_mul_u32_u24 v142, 0x80008, v142
    v_add_u32 v141, 0x10000, v142
    v_add_u32 v143, 0x50004, v142
    v_add_u32 v144, 0x70006, v142
    v_add_u32 v142, 0x30002, v142
    s_waitcnt vmcnt(0)
    s_mov_b64 exec, s[28:29]
    v_cmp_neq_f16_sdwa s[68:69], v100, 0 src0_sel:WORD_0 src1_sel:WORD_0
    v_cmp_neq_f16_sdwa s[70:71], v100, 0 src0_sel:WORD_1 src1_sel:WORD_0
    v_cmp_neq_f16_sdwa s[72:73], v101, 0 src0_sel:WORD_0 src1_sel:WORD_0
    v_cmp_neq_f16_sdwa s[74:75], v101, 0 src0_sel:WORD_1 src1_sel:WORD_0
    v_cmp_neq_f16_sdwa s[76:77], v102, 0 src0_sel:WORD_0 src1_sel:WORD_0
    v_cmp_neq_f16_sdwa s[78:79], v102, 0 src0_sel:WORD_1 src1_sel:WORD_0
    v_cmp_neq_f16_sdwa s[80:81], v103, 0 src0_sel:WORD_0 src1_sel:WORD_0
    v_cmp_neq_f16_sdwa s[82:83], v103, 0 src0_sel:WORD_1 src1_sel:WORD_0
    s_mov_b64 exec, -1
    v_mov_b32 v132, s64
    v_mbcnt_lo_u32_b32 v132, s68, v132
    v_mbcnt_hi_u32_b32 v132, s69, v132
    v_mbcnt_lo_u32_b32 v132, s70, v132
    v_mbcnt_hi_u32_b32 v132, s71, v132
    v_mbcnt_lo_u32_b32 v132, s72, v132
    v_mbcnt_hi_u32_b32 v132, s73, v132
    v_mbcnt_lo_u32_b32 v132, s74, v132
    v_mbcnt_hi_u32_b32 v132, s75, v132
    v_mbcnt_lo_u32_b32 v132, s76, v132
    v_mbcnt_hi_u32_b32 v132, s77, v132
    v_mbcnt_lo_u32_b32 v132, s78, v132
    v_mbcnt_hi_u32_b32 v132, s79, v132
    v_mbcnt_lo_u32_b32 v132, s80, v132
    v_mbcnt_hi_u32_b32 v132, s81, v132
    v_mbcnt_lo_u32_b32 v132, s82, v132
    v_mbcnt_hi_u32_b32 v132, s83, v132
    s_add_u32 s55, s64, 16
    v_readlane_b32 s66, v132, 25
    v_readlane_b32 s67, v132, 63
    s_add_u32 s64, s66, 15
    s_and_b32 s64, s64, -16
    s_max_u32 s64, s64, s55
    s_sub_u32 s66, s64, s66
    v_mad_u32_u24 v132, v145, s66, v132
    s_mov_b32 s55, s64
    v_addc_co_u32 v133, vcc, 0, v132, s[68:69]
    v_addc_co_u32 v134, vcc, 0, v133, s[70:71]
    v_addc_co_u32 v135, vcc, 0, v134, s[72:73]
    v_addc_co_u32 v136, vcc, 0, v135, s[74:75]
    v_addc_co_u32 v137, vcc, 0, v136, s[76:77]
    v_addc_co_u32 v138, vcc, 0, v137, s[78:79]
    v_addc_co_u32 v139, vcc, 0, v138, s[80:81]
    s_add_u32 s67, s67, s66
    s_add_u32 s67, s67, 15
    s_and_b32 s67, s67, -16
    s_add_u32 s64, s64, 16
    s_max_u32 s64, s64, s67
    s_mov_b64 exec, s[68:69]
    ds_write_b8 v132, v141
    s_mov_b64 exec, s[70:71]
    ds_write_b8_d16_hi v133, v141
    s_mov_b64 exec, s[72:73]
    ds_write_b8 v134, v142
    s_mov_b64 exec, s[74:75]
    ds_write_b8_d16_hi v135, v142
    s_mov_b64 exec, s[76:77]
    ds_write_b8 v136, v143
    s_mov_b64 exec, s[78:79]
    ds_write_b8_d16_hi v137, v143
    s_mov_b64 exec, s[80:81]
    ds_write_b8 v138, v144
    s_mov_b64 exec, s[82:83]
    ds_write_b8_d16_hi v139, v144
    s_mov_b64 exec, -1
    s_lshr_b32 s95, s55, 4
    s_bitset1_b64 s[56:57], s95
    s_lshr_b32 s95, s64, 4
    s_bitset1_b64 s[56:57], s95
    s_mov_b64 exec, s[28:29]
    v_cmp_neq_f16_sdwa s[68:69], v104, 0 src0_sel:WORD_0 src1_sel:WORD_0
    v_cmp_neq_f16_sdwa s[70:71], v104, 0 src0_sel:WORD_1 src1_sel:WORD_0
    v_cmp_neq_f16_sdwa s[72:73], v105, 0 src0_sel:WORD_0 src1_sel:WORD_0
    v_cmp_neq_f16_sdwa s[74:75], v105, 0 src0_sel:WORD_1 src1_sel:WORD_0
    v_cmp_neq_f16_sdwa s[76:77], v106, 0 src0_sel:WORD_0 src1_sel:WORD_0
    v_cmp_neq_f16_sdwa s[78:79], v106, 0 src0_sel:WORD_1 src1_sel:WORD_0
    v_cmp_neq_f16_sdwa s[80:81], v107, 0 src0_sel:WORD_0 src1_sel:WORD_0
    v_cmp_neq_f16_sdwa s[82:83], v107, 0 src0_sel:WORD_1 src1_sel:WORD_0
    s_mov_b64 exec, -1
    v_mov_b32 v132, s64
    v_mbcnt_lo_u32_b32 v132, s68, v132
    v_mbcnt_hi_u32_b32 v132, s69, v132
    v_mbcnt_lo_u32_b32 v132, s70, v132
    v_mbcnt_hi_u32_b32 v132, s71, v132
    v_mbcnt_lo_u32_b32 v132, s72, v132
    v_mbcnt_hi_u32_b32 v132, s73, v132
    v_mbcnt_lo_u32_b32 v132, s74, v132
    v_mbcnt_hi_u32_b32 v132, s75, v132
    v_mbcnt_lo_u32_b32 v132, s76, v132
    v_mbcnt_hi_u32_b32 v132, s77, v132
    v_mbcnt_lo_u32_b32 v132, s78, v132
    v_mbcnt_hi_u32_b32 v132, s79, v132
    v_mbcnt_lo_u32_b32 v132, s80, v132
    v_mbcnt_hi_u32_b32 v132, s81, v132
    v_mbcnt_lo_u32_b32 v132, s82, v132
    v_mbcnt_hi_u32_b32 v132, s83, v132
    s_add_u32 s55, s64, 16
    v_readlane_b32 s66, v132, 25
    v_readlane_b32 s67, v132, 63
    s_add_u32 s64, s66, 15
    s_and_b32 s64, s64, -16
    s_max_u32 s64, s64, s55
    s_sub_u32 s66, s64, s66
    v_mad_u32_u24 v132, v145, s66, v132
    s_mov_b32 s55, s64
    v_addc_co_u32 v133, vcc, 0, v132, s[68:69]
    v_addc_co_u32 v134, vcc, 0, v133, s[70:71]
    v_addc_co_u32 v135, vcc, 0, v134, s[72:73]
    v_addc_co_u32 v136, vcc, 0, v135, s[74:75]
    v_addc_co_u32 v137, vcc, 0, v136, s[76:77]
    v_addc_co_u32 v138, vcc, 0, v137, s[78:79]
    v_addc_co_u32 v139, vcc, 0, v138, s[80:81]
    s_add_u32 s67, s67, s66
    s_add_u32 s67, s67, 15
    s_and_b32 s67, s67, -16
    s_add_u32 s64, s64, 16
    s_max_u32 s64, s64, s67
    s_mov_b64 exec, s[68:69]
    ds_write_b8 v132, v141
    s_mov_b64 exec, s[70:71]
    ds_write_b8_d16_hi v133, v141
    s_mov_b64 exec, s[72:73]
    ds_write_b8 v134, v142
    s_mov_b64 exec, s[74:75]
    ds_write_b8_d16_hi v135, v142
    s_mov_b64 exec, s[76:77]
    ds_write_b8 v136, v143
    s_mov_b64 exec, s[78:79]
    ds_write_b8_d16_hi v137, v143
    s_mov_b64 exec, s[80:81]
    ds_write_b8 v138, v144
    s_mov_b64 exec, s[82:83]
    ds_write_b8_d16_hi v139, v144
    s_mov_b64 exec, -1
    s_lshr_b32 s95, s55, 4
    s_bitset1_b64 s[56:57], s95
    s_lshr_b32 s95, s64, 4
    s_bitset1_b64 s[56:57], s95
    s_mov_b32 s44, s64
    s_mov_b64 exec, s[28:29]
    v_cmp_neq_f16_sdwa s[68:69], v108, 0 src0_sel:WORD_0 src1_sel:WORD_0
    v_cmp_neq_f16_sdwa s[70:71], v108, 0 src0_sel:WORD_1 src1_sel:WORD_0
    v_cmp_neq_f16_sdwa s[72:73], v109, 0 src0_sel:WORD_0 src1_sel:WORD_0
    v_cmp_neq_f16_sdwa s[74:75], v109, 0 src0_sel:WORD_1 src1_sel:WORD_0
    v_cmp_neq_f16_sdwa s[76:77], v110, 0 src0_sel:WORD_0 src1_sel:WORD_0
    v_cmp_neq_f16_sdwa s[78:79], v110, 0 src0_sel:WORD_1 src1_sel:WORD_0
    v_cmp_neq_f16_sdwa s[80:81], v111, 0 src0_sel:WORD_0 src1_sel:WORD_0
    v_cmp_neq_f16_sdwa s[82:83], v111, 0 src0_sel:WORD_1 src1_sel:WORD_0
    s_mov_b64 exec, -1
    v_mov_b32 v132, s64
    v_mbcnt_lo_u32_b32 v132, s68, v132
    v_mbcnt_hi_u32_b32 v132, s69, v132
    v_mbcnt_lo_u32_b32 v132, s70, v132
    v_mbcnt_hi_u32_b32 v132, s71, v132
    v_mbcnt_lo_u32_b32 v132, s72, v132
    v_mbcnt_hi_u32_b32 v132, s73, v132
    v_mbcnt_lo_u32_b32 v132, s74, v132
    v_mbcnt_hi_u32_b32 v132, s75, v132
    v_mbcnt_lo_u32_b32 v132, s76, v132
    v_mbcnt_hi_u32_b32 v132, s77, v132
    v_mbcnt_lo_u32_b32 v132, s78, v132
    v_mbcnt_hi_u32_b32 v132, s79, v132
    v_mbcnt_lo_u32_b32 v132, s80, v132
    v_mbcnt_hi_u32_b32 v132, s81, v132
    v_mbcnt_lo_u32_b32 v132, s82, v132
    v_mbcnt_hi_u32_b32 v132, s83, v132
    s_add_u32 s55, s64, 16
    v_readlane_b32 s66, v132, 25
    v_readlane_b32 s67, v132, 63
    s_add_u32 s64, s66, 15
    s_and_b32 s64, s64, -16
    s_max_u32 s64, s64, s55
    s_sub_u32 s66, s64, s66
    v_mad_u32_u24 v132, v145, s66, v132
    s_mov_b32 s55, s64
    v_addc_co_u32 v133, vcc, 0, v132, s[68:69]
    v_addc_co_u32 v134, vcc, 0, v133, s[70:71]
    v_addc_co_u32 v135, vcc, 0, v134, s[72:73]
    v_addc_co_u32 v136, vcc, 0, v135, s[74:75]
    v_addc_co_u32 v137, vcc, 0, v136, s[76:77]
    v_addc_co_u32 v138, vcc, 0, v137, s[78:79]
    v_addc_co_u32 v139, vcc, 0, v138, s[80:81]
    s_add_u32 s67, s67, s66
    s_add_u32 s67, s67, 15
    s_and_b32 s67, s67, -16
    s_add_u32 s64, s64, 16
    s_max_u32 s64, s64, s67
    s_mov_b64 exec, s[68:69]
    ds_write_b8 v132, v141
    s_mov_b64 exec, s[70:71]
    ds_write_b8_d16_hi v133, v141
    s_mov_b64 exec, s[72:73]
    ds_write_b8 v134, v142
    s_mov_b64 exec, s[74:75]
    ds_write_b8_d16_hi v135, v142
    s_mov_b64 exec, s[76:77]
    ds_write_b8 v136, v143
    s_mov_b64 exec, s[78:79]
    ds_write_b8_d16_hi v137, v143
    s_mov_b64 exec, s[80:81]
    ds_write_b8 v138, v144
    s_mov_b64 exec, s[82:83]
    ds_write_b8_d16_hi v139, v144
    s_mov_b64 exec, -1
    s_mov_b32 s45, s55
    s_mov_b32 s46, s64
    s_mov_b64 exec, s[28:29]
    v_cmp_neq_f16_sdwa s[68:69], v112, 0 src0_sel:WORD_0 src1_sel:WORD_0
    v_cmp_neq_f16_sdwa s[70:71], v112, 0 src0_sel:WORD_1 src1_sel:WORD_0
    v_cmp_neq_f16_sdwa s[72:73], v113, 0 src0_sel:WORD_0 src1_sel:WORD_0
    v_cmp_neq_f16_sdwa s[74:75], v113, 0 src0_sel:WORD_1 src1_sel:WORD_0
    v_cmp_neq_f16_sdwa s[76:77], v114, 0 src0_sel:WORD_0 src1_sel:WORD_0
    v_cmp_neq_f16_sdwa s[78:79], v114, 0 src0_sel:WORD_1 src1_sel:WORD_0
    v_cmp_neq_f16_sdwa s[80:81], v115, 0 src0_sel:WORD_0 src1_sel:WORD_0
    v_cmp_neq_f16_sdwa s[82:83], v115, 0 src0_sel:WORD_1 src1_sel:WORD_0
    s_mov_b64 exec, -1
    v_mov_b32 v132, s64
    v_mbcnt_lo_u32_b32 v132, s68, v132
    v_mbcnt_hi_u32_b32 v132, s69, v132
    v_mbcnt_lo_u32_b32 v132, s70, v132
    v_mbcnt_hi_u32_b32 v132, s71, v132
    v_mbcnt_lo_u32_b32 v132, s72, v132
    v_mbcnt_hi_u32_b32 v132, s73, v132
    v_mbcnt_lo_u32_b32 v132, s74, v132
    v_mbcnt_hi_u32_b32 v132, s75, v132
    v_mbcnt_lo_u32_b32 v132, s76, v132
    v_mbcnt_hi_u32_b32 v132, s77, v132
    v_mbcnt_lo_u32_b32 v132, s78, v132
    v_mbcnt_hi_u32_b32 v132, s79, v132
    v_mbcnt_lo_u32_b32 v132, s80, v132
    v_mbcnt_hi_u32_b32 v132, s81, v132
    v_mbcnt_lo_u32_b32 v132, s82, v132
    v_mbcnt_hi_u32_b32 v132, s83, v132
    s_add_u32 s55, s64, 16
    v_readlane_b32 s66, v132, 25
    v_readlane_b32 s67, v132, 63
    s_add_u32 s64, s66, 15
    s_and_b32 s64, s64, -16
    s_max_u32 s64, s64, s55
    s_sub_u32 s66, s64, s66
    v_mad_u32_u24 v132, v145, s66, v132
    s_mov_b32 s55, s64
    v_addc_co_u32 v133, vcc, 0, v132, s[68:69]
    v_addc_co_u32 v134, vcc, 0, v133, s[70:71]
    v_addc_co_u32 v135, vcc, 0, v134, s[72:73]
    v_addc_co_u32 v136, vcc, 0, v135, s[74:75]
    v_addc_co_u32 v137, vcc, 0, v136, s[76:77]
    v_addc_co_u32 v138, vcc, 0, v137, s[78:79]
    v_addc_co_u32 v139, vcc, 0, v138, s[80:81]
    s_add_u32 s67, s67, s66
    s_add_u32 s67, s67, 15
    s_and_b32 s67, s67, -16
    s_add_u32 s64, s64, 16
    s_max_u32 s64, s64, s67
    s_mov_b64 exec, s[68:69]
    ds_write_b8 v132, v141
    s_mov_b64 exec, s[70:71]
    ds_write_b8_d16_hi v133, v141
    s_mov_b64 exec, s[72:73]
    ds_write_b8 v134, v142
    s_mov_b64 exec, s[74:75]
    ds_write_b8_d16_hi v135, v142
    s_mov_b64 exec, s[76:77]
    ds_write_b8 v136, v143
    s_mov_b64 exec, s[78:79]
    ds_write_b8_d16_hi v137, v143
    s_mov_b64 exec, s[80:81]
    ds_write_b8 v138, v144
    s_mov_b64 exec, s[82:83]
    ds_write_b8_d16_hi v139, v144
    s_mov_b64 exec, -1
    s_mov_b32 s47, s55
    s_mov_b32 s48, s64
    s_mov_b32 s94, 0
    s_mov_b64 s[84:85], -1
    s_branch L_listed
Ls_loop:
Ls_mid:
    s_bitcmp1_b32 s36, 0
    s_cbranch_scc1 Ls_ev0
Ls_evd0:
    v_mfma_f32_16x16x32_bf16 v[208:211], v[136:139], v[200:203], v[208:211]
    ds_read_b32 v246, v244 offset:0
    s_waitcnt lgkmcnt(0)
    v_bfe_u32 v247, v246, 0, 8
    v_lshlrev_b32 v247, 1, v247
    v_bfe_u32 v248, v246, 8, 8
    v_lshlrev_b32 v248, 1, v248
    v_bfe_u32 v249, v246, 16, 8
    v_lshlrev_b32 v249, 1, v249
    v_bfe_u32 v250, v246, 24, 8
    v_lshlrev_b32 v250, 1, v250
    buffer_load_ushort v247, v247, s[24:27], 0 offen
    buffer_load_ushort v248, v248, s[24:27], 0 offen
    buffer_load_ushort v249, v249, s[24:27], 0 offen
    buffer_load_ushort v250, v250, s[24:27], 0 offen
    s_waitcnt vmcnt(0)
    v_lshlrev_b32 v247, 16, v247
    v_mul_f32 v208, v208, v247
    v_lshlrev_b32 v248, 16, v248
    v_mul_f32 v209, v209, v248
    v_lshlrev_b32 v249, 16, v249
    v_mul_f32 v210, v210, v249
    v_lshlrev_b32 v250, 16, v250
    v_mul_f32 v211, v211, v250
    v_exp_f32 v132, v148
    v_exp_f32 v133, v149
    v_exp_f32 v134, v150
    v_exp_f32 v135, v151
    v_exp_f32 v136, v152
    v_exp_f32 v137, v153
    v_mfma_f32_4x4x4_16b_bf16 v[132:135], v[228:229], v[228:229], v[132:135]
    v_exp_f32 v138, v154
    v_exp_f32 v139, v155
    v_cvt_pk_bf16_f32 v208, v208, v209
    v_cvt_pk_bf16_f32 v209, v210, v211
    v_exp_f32 v140, v156
    v_exp_f32 v141, v157
    v_mfma_f32_4x4x4_16b_bf16 v[212:215], v[208:209], v[188:189], v[212:215] cbsz:4 abid:0
    v_mfma_f32_4x4x4_16b_bf16 v[136:139], v[228:229], v[228:229], v[136:139]
    v_exp_f32 v142, v158
    v_mfma_f32_4x4x4_16b_bf16 v[212:215], v[208:209], v[190:191], v[212:215] cbsz:4 abid:4
    v_exp_f32 v143, v159
    v_exp_f32 v144, v160
    v_mfma_f32_4x4x4_16b_bf16 v[212:215], v[208:209], v[192:193], v[212:215] cbsz:4 abid:8
    v_exp_f32 v145, v161
    v_mfma_f32_4x4x4_16b_bf16 v[140:143], v[228:229], v[228:229], v[140:143]
    v_mfma_f32_4x4x4_16b_bf16 v[212:215], v[208:209], v[194:195], v[212:215] cbsz:4 abid:12
    ds_add_rtn_u32 v1, v2, v3
    ds_read_u8 v230, v237 offset:64
    ds_read_u8 v232, v237 offset:72
    ds_read_b64_tr_b16 v[188:189], v236 offset:0
    ds_read_b64_tr_b16 v[190:191], v236 offset:512
    ds_read_b64_tr_b16 v[192:193], v236 offset:1056
    ds_read_b64_tr_b16 v[194:195], v236 offset:1568
    s_waitcnt vmcnt(4)
    ds_read_b128 v[180:183], v234 offset:2080
    ds_read_b128 v[184:187], v235 offset:2080
    s_add_u32 m0, s52, 0
    v_exp_f32 v146, v162
    v_exp_f32 v147, v163
    v_rcp_f32 v132, v132
    v_rcp_f32 v133, v133
    v_mfma_f32_4x4x4_16b_bf16 v[144:147], v[228:229], v[228:229], v[144:147]
    v_rcp_f32 v134, v134
    v_cvt_pk_bf16_f32 v132, v132, v133
    s_waitcnt lgkmcnt(2)
    buffer_load_dwordx4 v[230:231], s[20:23], s35 idxen offen nt lds
    buffer_load_dwordx4 v[232:233], s[40:43], s35 idxen offen offset:1056 nt lds
    s_waitcnt lgkmcnt(0)
    v_mfma_f32_16x16x32_bf16 v[148:151], v[100:103], v[180:183], v[164:167]
    v_rcp_f32 v135, v135
    v_mfma_f32_16x16x32_bf16 v[152:155], v[108:111], v[180:183], v[168:171]
    v_rcp_f32 v136, v136
    v_cvt_pk_bf16_f32 v133, v134, v135
    v_mfma_f32_16x16x32_bf16 v[148:151], v[104:107], v[184:187], v[148:151]
    v_rcp_f32 v137, v137
    v_cmp_gt_i32 vcc, v1, v245
    s_setprio 0
    s_cbranch_vccz Ls_lo0
    s_setprio 1
Ls_lo0:
    v_mfma_f32_16x16x32_bf16 v[152:155], v[112:115], v[184:187], v[152:155]
    v_rcp_f32 v138, v138
    v_cvt_pk_bf16_f32 v134, v136, v137
    v_mfma_f32_16x16x32_bf16 v[156:159], v[116:119], v[180:183], v[172:175]
    v_rcp_f32 v139, v139
    v_mfma_f32_16x16x32_bf16 v[160:163], v[124:127], v[180:183], v[176:179]
    v_rcp_f32 v140, v140
    v_cvt_pk_bf16_f32 v135, v138, v139
    v_mfma_f32_16x16x32_bf16 v[156:159], v[120:123], v[184:187], v[156:159]
    v_rcp_f32 v141, v141
    v_mfma_f32_16x16x32_bf16 v[160:163], v[128:131], v[184:187], v[160:163]
    v_rcp_f32 v142, v142
    v_cvt_pk_bf16_f32 v136, v140, v141
    v_mfma_f32_16x16x32_bf16 v[208:211], v[132:135], v[196:199], v[204:207]
    v_rcp_f32 v143, v143
    v_rcp_f32 v144, v144
    v_cvt_pk_bf16_f32 v137, v142, v143
    v_rcp_f32 v145, v145
    v_rcp_f32 v146, v146
    v_rcp_f32 v147, v147
    v_cvt_pk_bf16_f32 v138, v144, v145
    v_cvt_pk_bf16_f32 v139, v146, v147
    s_bitcmp1_b32 s36, 1
    s_cbranch_scc1 Ls_ev1
Ls_evd1:
    v_mfma_f32_16x16x32_bf16 v[208:211], v[136:139], v[200:203], v[208:211]
    ds_read_b32 v246, v244 offset:16
    s_waitcnt lgkmcnt(0)
    v_bfe_u32 v247, v246, 0, 8
    v_lshlrev_b32 v247, 1, v247
    v_bfe_u32 v248, v246, 8, 8
    v_lshlrev_b32 v248, 1, v248
    v_bfe_u32 v249, v246, 16, 8
    v_lshlrev_b32 v249, 1, v249
    v_bfe_u32 v250, v246, 24, 8
    v_lshlrev_b32 v250, 1, v250
    buffer_load_ushort v247, v247, s[24:27], 0 offen
    buffer_load_ushort v248, v248, s[24:27], 0 offen
    buffer_load_ushort v249, v249, s[24:27], 0 offen
    buffer_load_ushort v250, v250, s[24:27], 0 offen
    s_waitcnt vmcnt(0)
    v_lshlrev_b32 v247, 16, v247
    v_mul_f32 v208, v208, v247
    v_lshlrev_b32 v248, 16, v248
    v_mul_f32 v209, v209, v248
    v_lshlrev_b32 v249, 16, v249
    v_mul_f32 v210, v210, v249
    v_lshlrev_b32 v250, 16, v250
    v_mul_f32 v211, v211, v250
    v_exp_f32 v132, v148
    v_exp_f32 v133, v149
    v_exp_f32 v134, v150
    v_exp_f32 v135, v151
    v_exp_f32 v136, v152
    v_exp_f32 v137, v153
    v_mfma_f32_4x4x4_16b_bf16 v[132:135], v[228:229], v[228:229], v[132:135]
    v_exp_f32 v138, v154
    v_exp_f32 v139, v155
    v_cvt_pk_bf16_f32 v208, v208, v209
    v_cvt_pk_bf16_f32 v209, v210, v211
    v_exp_f32 v140, v156
    v_exp_f32 v141, v157
    v_mfma_f32_4x4x4_16b_bf16 v[212:215], v[208:209], v[188:189], v[212:215] cbsz:4 abid:0
    v_mfma_f32_4x4x4_16b_bf16 v[136:139], v[228:229], v[228:229], v[136:139]
    v_exp_f32 v142, v158
    v_mfma_f32_4x4x4_16b_bf16 v[212:215], v[208:209], v[190:191], v[212:215] cbsz:4 abid:4
    v_exp_f32 v143, v159
    v_exp_f32 v144, v160
    v_mfma_f32_4x4x4_16b_bf16 v[212:215], v[208:209], v[192:193], v[212:215] cbsz:4 abid:8
    v_exp_f32 v145, v161
    v_mfma_f32_4x4x4_16b_bf16 v[140:143], v[228:229], v[228:229], v[140:143]
    v_mfma_f32_4x4x4_16b_bf16 v[212:215], v[208:209], v[194:195], v[212:215] cbsz:4 abid:12
    ds_read_u8 v230, v237 offset:80
    ds_read_u8 v232, v237 offset:88
    ds_read_b64_tr_b16 v[188:189], v236 offset:2080
    ds_read_b64_tr_b16 v[190:191], v236 offset:2592
    ds_read_b64_tr_b16 v[192:193], v236 offset:3136
    ds_read_b64_tr_b16 v[194:195], v236 offset:3648
    s_waitcnt vmcnt(4)
    ds_read_b128 v[180:183], v234 offset:4160
    ds_read_b128 v[184:187], v235 offset:4160
    s_add_u32 m0, s52, 2080
    v_exp_f32 v146, v162
    v_exp_f32 v147, v163
    v_rcp_f32 v132, v132
    v_rcp_f32 v133, v133
    v_mfma_f32_4x4x4_16b_bf16 v[144:147], v[228:229], v[228:229], v[144:147]
    v_rcp_f32 v134, v134
    v_cvt_pk_bf16_f32 v132, v132, v133
    s_waitcnt lgkmcnt(2)
    buffer_load_dwordx4 v[230:231], s[20:23], s35 idxen offen nt lds
    buffer_load_dwordx4 v[232:233], s[40:43], s35 idxen offen offset:1056 nt lds
    s_waitcnt lgkmcnt(0)
    v_mfma_f32_16x16x32_bf16 v[148:151], v[100:103], v[180:183], v[164:167]
    v_rcp_f32 v135, v135
    v_mfma_f32_16x16x32_bf16 v[152:155], v[108:111], v[180:183], v[168:171]
    v_rcp_f32 v136, v136
    v_cvt_pk_bf16_f32 v133, v134, v135
    v_mfma_f32_16x16x32_bf16 v[148:151], v[104:107], v[184:187], v[148:151]
    v_rcp_f32 v137, v137
    v_mfma_f32_16x16x32_bf16 v[152:155], v[112:115], v[184:187], v[152:155]
    v_rcp_f32 v138, v138
    v_cvt_pk_bf16_f32 v134, v136, v137
    v_mfma_f32_16x16x32_bf16 v[156:159], v[116:119], v[180:183], v[172:175]
    v_rcp_f32 v139, v139
    v_mfma_f32_16x16x32_bf16 v[160:163], v[124:127], v[180:183], v[176:179]
    v_rcp_f32 v140, v140
    v_cvt_pk_bf16_f32 v135, v138, v139
    v_mfma_f32_16x16x32_bf16 v[156:159], v[120:123], v[184:187], v[156:159]
    v_rcp_f32 v141, v141
    v_mfma_f32_16x16x32_bf16 v[160:163], v[128:131], v[184:187], v[160:163]
    v_rcp_f32 v142, v142
    v_cvt_pk_bf16_f32 v136, v140, v141
    v_mfma_f32_16x16x32_bf16 v[208:211], v[132:135], v[196:199], v[204:207]
    v_rcp_f32 v143, v143
    v_rcp_f32 v144, v144
    v_cvt_pk_bf16_f32 v137, v142, v143
    v_rcp_f32 v145, v145
    v_rcp_f32 v146, v146
    v_rcp_f32 v147, v147
    v_cvt_pk_bf16_f32 v138, v144, v145
    v_cvt_pk_bf16_f32 v139, v146, v147
    s_bitcmp1_b32 s36, 2
    s_cbranch_scc1 Ls_ev2
Ls_evd2:
    v_mfma_f32_16x16x32_bf16 v[208:211], v[136:139], v[200:203], v[208:211]
    ds_read_b32 v246, v244 offset:32
    s_waitcnt lgkmcnt(0)
    v_bfe_u32 v247, v246, 0, 8
    v_lshlrev_b32 v247, 1, v247
    v_bfe_u32 v248, v246, 8, 8
    v_lshlrev_b32 v248, 1, v248
    v_bfe_u32 v249, v246, 16, 8
    v_lshlrev_b32 v249, 1, v249
    v_bfe_u32 v250, v246, 24, 8
    v_lshlrev_b32 v250, 1, v250
    buffer_load_ushort v247, v247, s[24:27], 0 offen
    buffer_load_ushort v248, v248, s[24:27], 0 offen
    buffer_load_ushort v249, v249, s[24:27], 0 offen
    buffer_load_ushort v250, v250, s[24:27], 0 offen
    s_waitcnt vmcnt(0)
    v_lshlrev_b32 v247, 16, v247
    v_mul_f32 v208, v208, v247
    v_lshlrev_b32 v248, 16, v248
    v_mul_f32 v209, v209, v248
    v_lshlrev_b32 v249, 16, v249
    v_mul_f32 v210, v210, v249
    v_lshlrev_b32 v250, 16, v250
    v_mul_f32 v211, v211, v250
    v_exp_f32 v132, v148
    v_exp_f32 v133, v149
    v_exp_f32 v134, v150
    v_exp_f32 v135, v151
    v_exp_f32 v136, v152
    v_exp_f32 v137, v153
    v_mfma_f32_4x4x4_16b_bf16 v[132:135], v[228:229], v[228:229], v[132:135]
    v_exp_f32 v138, v154
    v_exp_f32 v139, v155
    v_cvt_pk_bf16_f32 v208, v208, v209
    v_cvt_pk_bf16_f32 v209, v210, v211
    v_exp_f32 v140, v156
    v_exp_f32 v141, v157
    v_mfma_f32_4x4x4_16b_bf16 v[212:215], v[208:209], v[188:189], v[212:215] cbsz:4 abid:0
    v_mfma_f32_4x4x4_16b_bf16 v[136:139], v[228:229], v[228:229], v[136:139]
    v_exp_f32 v142, v158
    v_mfma_f32_4x4x4_16b_bf16 v[212:215], v[208:209], v[190:191], v[212:215] cbsz:4 abid:4
    v_exp_f32 v143, v159
    v_exp_f32 v144, v160
    v_mfma_f32_4x4x4_16b_bf16 v[212:215], v[208:209], v[192:193], v[212:215] cbsz:4 abid:8
    v_exp_f32 v145, v161
    v_mfma_f32_4x4x4_16b_bf16 v[140:143], v[228:229], v[228:229], v[140:143]
    v_mfma_f32_4x4x4_16b_bf16 v[212:215], v[208:209], v[194:195], v[212:215] cbsz:4 abid:12
    ds_read_u8 v230, v237 offset:96
    ds_read_u8 v232, v237 offset:104
    ds_read_b64_tr_b16 v[188:189], v236 offset:4160
    ds_read_b64_tr_b16 v[190:191], v236 offset:4672
    ds_read_b64_tr_b16 v[192:193], v236 offset:5216
    ds_read_b64_tr_b16 v[194:195], v236 offset:5728
    s_waitcnt vmcnt(4)
    ds_read_b128 v[180:183], v234 offset:6240
    ds_read_b128 v[184:187], v235 offset:6240
    s_add_u32 m0, s52, 4160
    v_exp_f32 v146, v162
    v_exp_f32 v147, v163
    v_rcp_f32 v132, v132
    v_rcp_f32 v133, v133
    v_mfma_f32_4x4x4_16b_bf16 v[144:147], v[228:229], v[228:229], v[144:147]
    v_rcp_f32 v134, v134
    v_cvt_pk_bf16_f32 v132, v132, v133
    s_waitcnt lgkmcnt(2)
    buffer_load_dwordx4 v[230:231], s[20:23], s35 idxen offen nt lds
    buffer_load_dwordx4 v[232:233], s[40:43], s35 idxen offen offset:1056 nt lds
    s_waitcnt lgkmcnt(0)
    v_mfma_f32_16x16x32_bf16 v[148:151], v[100:103], v[180:183], v[164:167]
    v_rcp_f32 v135, v135
    v_mfma_f32_16x16x32_bf16 v[152:155], v[108:111], v[180:183], v[168:171]
    v_rcp_f32 v136, v136
    v_cvt_pk_bf16_f32 v133, v134, v135
    v_mfma_f32_16x16x32_bf16 v[148:151], v[104:107], v[184:187], v[148:151]
    v_rcp_f32 v137, v137
    v_mfma_f32_16x16x32_bf16 v[152:155], v[112:115], v[184:187], v[152:155]
    v_rcp_f32 v138, v138
    v_cvt_pk_bf16_f32 v134, v136, v137
    v_mfma_f32_16x16x32_bf16 v[156:159], v[116:119], v[180:183], v[172:175]
    v_rcp_f32 v139, v139
    v_mfma_f32_16x16x32_bf16 v[160:163], v[124:127], v[180:183], v[176:179]
    v_rcp_f32 v140, v140
    v_cvt_pk_bf16_f32 v135, v138, v139
    v_mfma_f32_16x16x32_bf16 v[156:159], v[120:123], v[184:187], v[156:159]
    v_rcp_f32 v141, v141
    v_mfma_f32_16x16x32_bf16 v[160:163], v[128:131], v[184:187], v[160:163]
    v_rcp_f32 v142, v142
    v_cvt_pk_bf16_f32 v136, v140, v141
    v_mfma_f32_16x16x32_bf16 v[208:211], v[132:135], v[196:199], v[204:207]
    v_rcp_f32 v143, v143
    v_rcp_f32 v144, v144
    v_cvt_pk_bf16_f32 v137, v142, v143
    v_rcp_f32 v145, v145
    v_rcp_f32 v146, v146
    v_rcp_f32 v147, v147
    v_cvt_pk_bf16_f32 v138, v144, v145
    v_cvt_pk_bf16_f32 v139, v146, v147
    s_bitcmp1_b32 s36, 3
    s_cbranch_scc1 Ls_ev3
Ls_evd3:
    v_mfma_f32_16x16x32_bf16 v[208:211], v[136:139], v[200:203], v[208:211]
    ds_read_b32 v246, v244 offset:48
    s_waitcnt lgkmcnt(0)
    v_bfe_u32 v247, v246, 0, 8
    v_lshlrev_b32 v247, 1, v247
    v_bfe_u32 v248, v246, 8, 8
    v_lshlrev_b32 v248, 1, v248
    v_bfe_u32 v249, v246, 16, 8
    v_lshlrev_b32 v249, 1, v249
    v_bfe_u32 v250, v246, 24, 8
    v_lshlrev_b32 v250, 1, v250
    buffer_load_ushort v247, v247, s[24:27], 0 offen
    buffer_load_ushort v248, v248, s[24:27], 0 offen
    buffer_load_ushort v249, v249, s[24:27], 0 offen
    buffer_load_ushort v250, v250, s[24:27], 0 offen
    s_waitcnt vmcnt(0)
    v_lshlrev_b32 v247, 16, v247
    v_mul_f32 v208, v208, v247
    v_lshlrev_b32 v248, 16, v248
    v_mul_f32 v209, v209, v248
    v_lshlrev_b32 v249, 16, v249
    v_mul_f32 v210, v210, v249
    v_lshlrev_b32 v250, 16, v250
    v_mul_f32 v211, v211, v250
    v_exp_f32 v132, v148
    v_exp_f32 v133, v149
    v_exp_f32 v134, v150
    v_exp_f32 v135, v151
    v_exp_f32 v136, v152
    v_exp_f32 v137, v153
    v_mfma_f32_4x4x4_16b_bf16 v[132:135], v[228:229], v[228:229], v[132:135]
    v_exp_f32 v138, v154
    v_exp_f32 v139, v155
    v_cvt_pk_bf16_f32 v208, v208, v209
    v_cvt_pk_bf16_f32 v209, v210, v211
    v_exp_f32 v140, v156
    v_exp_f32 v141, v157
    v_mfma_f32_4x4x4_16b_bf16 v[212:215], v[208:209], v[188:189], v[212:215] cbsz:4 abid:0
    v_mfma_f32_4x4x4_16b_bf16 v[136:139], v[228:229], v[228:229], v[136:139]
    v_exp_f32 v142, v158
    v_mfma_f32_4x4x4_16b_bf16 v[212:215], v[208:209], v[190:191], v[212:215] cbsz:4 abid:4
    v_exp_f32 v143, v159
    v_exp_f32 v144, v160
    v_mfma_f32_4x4x4_16b_bf16 v[212:215], v[208:209], v[192:193], v[212:215] cbsz:4 abid:8
    v_exp_f32 v145, v161
    v_mfma_f32_4x4x4_16b_bf16 v[140:143], v[228:229], v[228:229], v[140:143]
    v_mfma_f32_4x4x4_16b_bf16 v[212:215], v[208:209], v[194:195], v[212:215] cbsz:4 abid:12
    ds_read_u8 v230, v237 offset:112
    ds_read_u8 v232, v237 offset:120
    ds_read_b64_tr_b16 v[188:189], v236 offset:6240
    ds_read_b64_tr_b16 v[190:191], v236 offset:6752
    ds_read_b64_tr_b16 v[192:193], v236 offset:7296
    ds_read_b64_tr_b16 v[194:195], v236 offset:7808
    s_waitcnt vmcnt(4)
    ds_read_b128 v[180:183], v234 offset:0
    ds_read_b128 v[184:187], v235 offset:0
    s_add_u32 m0, s52, 6240
    v_exp_f32 v146, v162
    v_exp_f32 v147, v163
    v_rcp_f32 v132, v132
    v_rcp_f32 v133, v133
    v_mfma_f32_4x4x4_16b_bf16 v[144:147], v[228:229], v[228:229], v[144:147]
    v_rcp_f32 v134, v134
    v_cvt_pk_bf16_f32 v132, v132, v133
    s_waitcnt lgkmcnt(2)
    buffer_load_dwordx4 v[230:231], s[20:23], s35 idxen offen nt lds
    buffer_load_dwordx4 v[232:233], s[40:43], s35 idxen offen offset:1056 nt lds
    s_waitcnt lgkmcnt(0)
    v_mfma_f32_16x16x32_bf16 v[148:151], v[100:103], v[180:183], v[164:167]
    v_rcp_f32 v135, v135
    v_mfma_f32_16x16x32_bf16 v[152:155], v[108:111], v[180:183], v[168:171]
    v_rcp_f32 v136, v136
    v_cvt_pk_bf16_f32 v133, v134, v135
    v_mfma_f32_16x16x32_bf16 v[148:151], v[104:107], v[184:187], v[148:151]
    v_rcp_f32 v137, v137
    v_mfma_f32_16x16x32_bf16 v[152:155], v[112:115], v[184:187], v[152:155]
    v_rcp_f32 v138, v138
    v_cvt_pk_bf16_f32 v134, v136, v137
    v_mfma_f32_16x16x32_bf16 v[156:159], v[116:119], v[180:183], v[172:175]
    v_rcp_f32 v139, v139
    v_mfma_f32_16x16x32_bf16 v[160:163], v[124:127], v[180:183], v[176:179]
    v_rcp_f32 v140, v140
    v_cvt_pk_bf16_f32 v135, v138, v139
    v_mfma_f32_16x16x32_bf16 v[156:159], v[120:123], v[184:187], v[156:159]
    v_rcp_f32 v141, v141
    v_mfma_f32_16x16x32_bf16 v[160:163], v[128:131], v[184:187], v[160:163]
    v_rcp_f32 v142, v142
    v_cvt_pk_bf16_f32 v136, v140, v141
    v_mfma_f32_16x16x32_bf16 v[208:211], v[132:135], v[196:199], v[204:207]
    v_rcp_f32 v143, v143
    v_rcp_f32 v144, v144
    v_cvt_pk_bf16_f32 v137, v142, v143
    s_lshr_b64 s[56:57], s[56:57], 4
    s_lshr_b64 s[86:87], s[56:57], 2
    s_lshr_b64 s[36:37], s[56:57], 5
    s_or_b32 s36, s36, s86
    s_or_b32 s36, s36, s56
    v_add_u32 v237, 64, v237
    v_add_u32 v244, 64, v244
    v_rcp_f32 v145, v145
    v_rcp_f32 v146, v146
    v_rcp_f32 v147, v147
    v_cvt_pk_bf16_f32 v138, v144, v145
    v_cvt_pk_bf16_f32 v139, v146, v147
    s_branch Ls_loop
Ls_ev0:
    s_bitcmp0_b64 s[56:57], 0
    s_cbranch_scc1 Ls_nf0
    v_cvt_pk_bf16_f32 v246, v212, v212
    v_mov_b32 v212, 0
    ds_write_b16 v240, v246
    v_add_u32 v240, 128, v240
    s_add_u32 s24, s24, s32
    s_addc_u32 s25, s25, 0
    s_xor_b32 s32, s32, 0x18ffe0
Ls_nf0:
    s_bitcmp0_b64 s[56:57], 5
    s_cbranch_scc1 Ls_na0
    s_sub_u32 s60, s60, 1
    s_cbranch_scc0 Ls_ns0
    s_mov_b32 s49, 5
    s_call_b64 s[62:63], L_swap
    s_add_u32 s35, s35, s31
    s_min_u32 s35, s35, 419404800
    s_xor_b32 s31, s31, 0x63ff800
    s_bitcmp0_b64 s[56:57], 2
    s_cbranch_scc1 Ls_evd0
    s_waitcnt lgkmcnt(0)
    s_branch Ls_e10
Ls_ns0:
    s_add_u32 s35, s35, s31
    s_min_u32 s35, s35, 419404800
    s_xor_b32 s31, s31, 0x63ff800
Ls_na0:
    s_bitcmp0_b64 s[56:57], 2
    s_cbranch_scc1 Ls_evd0
Ls_e10:
    s_sub_u32 s61, s61, 1
    s_cbranch_scc1 Ls_last0
    s_bitcmp0_b32 s33, s61
    s_cbranch_scc1 Ls_nw0
    s_cmp_eq_u32 s61, 3
    s_cselect_b32 s66, s80, s81
    v_add_u32 v238, s66, v238
    v_add_u32 v239, s66, v239
    ds_read_u16 v224, v238 offset:0
    ds_read_u16 v225, v238 offset:8
    ds_read_u16 v226, v238 offset:64
    ds_read_u16 v227, v238 offset:72
    s_waitcnt lgkmcnt(0)
Ls_nw0:
    v_mul_u32_u24 v216, v224, v241
    v_mul_u32_u24 v217, v224, v242
    v_mul_u32_u24 v218, v225, v241
    v_mul_u32_u24 v219, v225, v242
    v_mul_u32_u24 v220, v226, v241
    v_mul_u32_u24 v221, v226, v242
    v_mul_u32_u24 v222, v227, v241
    v_mul_u32_u24 v223, v227, v242
    v_mfma_f32_4x4x4_16b_bf16 v[140:143], v[216:217], v[68:69], v[4:7]
    v_add_u32 v238, 128, v238
    ds_read_b128 v[164:167], v239 offset:0
    ds_read_b128 v[168:171], v239 offset:64
    v_mfma_f32_4x4x4_16b_bf16 v[144:147], v[218:219], v[70:71], v[8:11]
    ds_read_b128 v[172:175], v239 offset:128
    ds_read_b128 v[176:179], v239 offset:192
    ds_read_u16 v224, v238 offset:0
    ds_read_u16 v225, v238 offset:8
    ds_read_u16 v226, v238 offset:64
    ds_read_u16 v227, v238 offset:72
    v_mfma_f32_4x4x4_16b_bf16 v[246:249], v[220:221], v[72:73], v[12:15]
    v_cvt_pk_bf16_f32 v100, v140, v141
    v_cvt_pk_bf16_f32 v101, v142, v143
    v_mfma_f32_4x4x4_16b_bf16 v[250:253], v[222:223], v[74:75], v[16:19]
    v_cvt_pk_bf16_f32 v102, v144, v145
    v_cvt_pk_bf16_f32 v103, v146, v147
    v_mfma_f32_4x4x4_16b_bf16 v[140:143], v[216:217], v[76:77], v[20:23]
    v_cvt_pk_bf16_f32 v104, v246, v247
    v_cvt_pk_bf16_f32 v105, v248, v249
    v_mfma_f32_4x4x4_16b_bf16 v[144:147], v[218:219], v[78:79], v[24:27]
    v_cvt_pk_bf16_f32 v106, v250, v251
    v_cvt_pk_bf16_f32 v107, v252, v253
    v_mfma_f32_4x4x4_16b_bf16 v[246:249], v[220:221], v[80:81], v[28:31]
    v_cvt_pk_bf16_f32 v108, v140, v141
    v_cvt_pk_bf16_f32 v109, v142, v143
    v_mfma_f32_4x4x4_16b_bf16 v[250:253], v[222:223], v[82:83], v[32:35]
    v_cvt_pk_bf16_f32 v110, v144, v145
    v_cvt_pk_bf16_f32 v111, v146, v147
    v_mfma_f32_4x4x4_16b_bf16 v[140:143], v[216:217], v[84:85], v[36:39]
    v_cvt_pk_bf16_f32 v112, v246, v247
    v_cvt_pk_bf16_f32 v113, v248, v249
    v_mfma_f32_4x4x4_16b_bf16 v[144:147], v[218:219], v[86:87], v[40:43]
    v_cvt_pk_bf16_f32 v114, v250, v251
    v_cvt_pk_bf16_f32 v115, v252, v253
    v_mfma_f32_4x4x4_16b_bf16 v[246:249], v[220:221], v[88:89], v[44:47]
    v_cvt_pk_bf16_f32 v116, v140, v141
    v_cvt_pk_bf16_f32 v117, v142, v143
    v_mfma_f32_4x4x4_16b_bf16 v[250:253], v[222:223], v[90:91], v[48:51]
    v_cvt_pk_bf16_f32 v118, v144, v145
    v_cvt_pk_bf16_f32 v119, v146, v147
    v_mfma_f32_4x4x4_16b_bf16 v[140:143], v[216:217], v[92:93], v[52:55]
    v_cvt_pk_bf16_f32 v120, v246, v247
    v_cvt_pk_bf16_f32 v121, v248, v249
    v_mfma_f32_4x4x4_16b_bf16 v[144:147], v[218:219], v[94:95], v[56:59]
    v_cvt_pk_bf16_f32 v122, v250, v251
    v_cvt_pk_bf16_f32 v123, v252, v253
    v_mfma_f32_4x4x4_16b_bf16 v[246:249], v[220:221], v[96:97], v[60:63]
    v_cvt_pk_bf16_f32 v124, v140, v141
    v_cvt_pk_bf16_f32 v125, v142, v143
    v_mfma_f32_4x4x4_16b_bf16 v[250:253], v[222:223], v[98:99], v[64:67]
    v_cvt_pk_bf16_f32 v126, v144, v145
    v_cvt_pk_bf16_f32 v127, v146, v147
    v_cvt_pk_bf16_f32 v128, v246, v247
    v_cvt_pk_bf16_f32 v129, v248, v249
    v_add_u32 v239, 272, v239
    v_cvt_pk_bf16_f32 v130, v250, v251
    v_cvt_pk_bf16_f32 v131, v252, v253
    s_waitcnt lgkmcnt(0)
    s_branch Ls_evd0
Ls_ev1:
    s_bitcmp0_b64 s[56:57], 1
    s_cbranch_scc1 Ls_nf1
    v_cvt_pk_bf16_f32 v246, v212, v212
    v_mov_b32 v212, 0
    ds_write_b16 v240, v246
    v_add_u32 v240, 128, v240
    s_add_u32 s24, s24, s32
    s_addc_u32 s25, s25, 0
    s_xor_b32 s32, s32, 0x18ffe0
Ls_nf1:
    s_bitcmp0_b64 s[56:57], 6
    s_cbranch_scc1 Ls_na1
    s_sub_u32 s60, s60, 1
    s_cbranch_scc0 Ls_ns1
    s_mov_b32 s49, 6
    s_call_b64 s[62:63], L_swap
    s_add_u32 s35, s35, s31
    s_min_u32 s35, s35, 419404800
    s_xor_b32 s31, s31, 0x63ff800
    s_bitcmp0_b64 s[56:57], 3
    s_cbranch_scc1 Ls_evd1
    s_waitcnt lgkmcnt(0)
    s_branch Ls_e11
Ls_ns1:
    s_add_u32 s35, s35, s31
    s_min_u32 s35, s35, 419404800
    s_xor_b32 s31, s31, 0x63ff800
Ls_na1:
    s_bitcmp0_b64 s[56:57], 3
    s_cbranch_scc1 Ls_evd1
Ls_e11:
    s_sub_u32 s61, s61, 1
    s_cbranch_scc1 Ls_last1
    s_bitcmp0_b32 s33, s61
    s_cbranch_scc1 Ls_nw1
    s_cmp_eq_u32 s61, 3
    s_cselect_b32 s66, s80, s81
    v_add_u32 v238, s66, v238
    v_add_u32 v239, s66, v239
    ds_read_u16 v224, v238 offset:0
    ds_read_u16 v225, v238 offset:8
    ds_read_u16 v226, v238 offset:64
    ds_read_u16 v227, v238 offset:72
    s_waitcnt lgkmcnt(0)
Ls_nw1:
    v_mul_u32_u24 v216, v224, v241
    v_mul_u32_u24 v217, v224, v242
    v_mul_u32_u24 v218, v225, v241
    v_mul_u32_u24 v219, v225, v242
    v_mul_u32_u24 v220, v226, v241
    v_mul_u32_u24 v221, v226, v242
    v_mul_u32_u24 v222, v227, v241
    v_mul_u32_u24 v223, v227, v242
    v_mfma_f32_4x4x4_16b_bf16 v[140:143], v[216:217], v[68:69], v[4:7]
    v_add_u32 v238, 128, v238
    ds_read_b128 v[164:167], v239 offset:0
    ds_read_b128 v[168:171], v239 offset:64
    v_mfma_f32_4x4x4_16b_bf16 v[144:147], v[218:219], v[70:71], v[8:11]
    ds_read_b128 v[172:175], v239 offset:128
    ds_read_b128 v[176:179], v239 offset:192
    ds_read_u16 v224, v238 offset:0
    ds_read_u16 v225, v238 offset:8
    ds_read_u16 v226, v238 offset:64
    ds_read_u16 v227, v238 offset:72
    v_mfma_f32_4x4x4_16b_bf16 v[246:249], v[220:221], v[72:73], v[12:15]
    v_cvt_pk_bf16_f32 v100, v140, v141
    v_cvt_pk_bf16_f32 v101, v142, v143
    v_mfma_f32_4x4x4_16b_bf16 v[250:253], v[222:223], v[74:75], v[16:19]
    v_cvt_pk_bf16_f32 v102, v144, v145
    v_cvt_pk_bf16_f32 v103, v146, v147
    v_mfma_f32_4x4x4_16b_bf16 v[140:143], v[216:217], v[76:77], v[20:23]
    v_cvt_pk_bf16_f32 v104, v246, v247
    v_cvt_pk_bf16_f32 v105, v248, v249
    v_mfma_f32_4x4x4_16b_bf16 v[144:147], v[218:219], v[78:79], v[24:27]
    v_cvt_pk_bf16_f32 v106, v250, v251
    v_cvt_pk_bf16_f32 v107, v252, v253
    v_mfma_f32_4x4x4_16b_bf16 v[246:249], v[220:221], v[80:81], v[28:31]
    v_cvt_pk_bf16_f32 v108, v140, v141
    v_cvt_pk_bf16_f32 v109, v142, v143
    v_mfma_f32_4x4x4_16b_bf16 v[250:253], v[222:223], v[82:83], v[32:35]
    v_cvt_pk_bf16_f32 v110, v144, v145
    v_cvt_pk_bf16_f32 v111, v146, v147
    v_mfma_f32_4x4x4_16b_bf16 v[140:143], v[216:217], v[84:85], v[36:39]
    v_cvt_pk_bf16_f32 v112, v246, v247
    v_cvt_pk_bf16_f32 v113, v248, v249
    v_mfma_f32_4x4x4_16b_bf16 v[144:147], v[218:219], v[86:87], v[40:43]
    v_cvt_pk_bf16_f32 v114, v250, v251
    v_cvt_pk_bf16_f32 v115, v252, v253
    v_mfma_f32_4x4x4_16b_bf16 v[246:249], v[220:221], v[88:89], v[44:47]
    v_cvt_pk_bf16_f32 v116, v140, v141
    v_cvt_pk_bf16_f32 v117, v142, v143
    v_mfma_f32_4x4x4_16b_bf16 v[250:253], v[222:223], v[90:91], v[48:51]
    v_cvt_pk_bf16_f32 v118, v144, v145
    v_cvt_pk_bf16_f32 v119, v146, v147
    v_mfma_f32_4x4x4_16b_bf16 v[140:143], v[216:217], v[92:93], v[52:55]
    v_cvt_pk_bf16_f32 v120, v246, v247
    v_cvt_pk_bf16_f32 v121, v248, v249
    v_mfma_f32_4x4x4_16b_bf16 v[144:147], v[218:219], v[94:95], v[56:59]
    v_cvt_pk_bf16_f32 v122, v250, v251
    v_cvt_pk_bf16_f32 v123, v252, v253
    v_mfma_f32_4x4x4_16b_bf16 v[246:249], v[220:221], v[96:97], v[60:63]
    v_cvt_pk_bf16_f32 v124, v140, v141
    v_cvt_pk_bf16_f32 v125, v142, v143
    v_mfma_f32_4x4x4_16b_bf16 v[250:253], v[222:223], v[98:99], v[64:67]
    v_cvt_pk_bf16_f32 v126, v144, v145
    v_cvt_pk_bf16_f32 v127, v146, v147
    v_cvt_pk_bf16_f32 v128, v246, v247
    v_cvt_pk_bf16_f32 v129, v248, v249
    v_add_u32 v239, 272, v239
    v_cvt_pk_bf16_f32 v130, v250, v251
    v_cvt_pk_bf16_f32 v131, v252, v253
    s_waitcnt lgkmcnt(0)
    s_branch Ls_evd1
Ls_ev2:
    s_bitcmp0_b64 s[56:57], 2
    s_cbranch_scc1 Ls_nf2
    v_cvt_pk_bf16_f32 v246, v212, v212
    v_mov_b32 v212, 0
    ds_write_b16 v240, v246
    v_add_u32 v240, 128, v240
    s_add_u32 s24, s24, s32
    s_addc_u32 s25, s25, 0
    s_xor_b32 s32, s32, 0x18ffe0
Ls_nf2:
    s_bitcmp0_b64 s[56:57], 7
    s_cbranch_scc1 Ls_na2
    s_sub_u32 s60, s60, 1
    s_cbranch_scc0 Ls_ns2
    s_mov_b32 s49, 7
    s_call_b64 s[62:63], L_swap
    s_add_u32 s35, s35, s31
    s_min_u32 s35, s35, 419404800
    s_xor_b32 s31, s31, 0x63ff800
    s_bitcmp0_b64 s[56:57], 4
    s_cbranch_scc1 Ls_evd2
    s_waitcnt lgkmcnt(0)
    s_branch Ls_e12
Ls_ns2:
    s_add_u32 s35, s35, s31
    s_min_u32 s35, s35, 419404800
    s_xor_b32 s31, s31, 0x63ff800
Ls_na2:
    s_bitcmp0_b64 s[56:57], 4
    s_cbranch_scc1 Ls_evd2
Ls_e12:
    s_sub_u32 s61, s61, 1
    s_cbranch_scc1 Ls_last2
    s_bitcmp0_b32 s33, s61
    s_cbranch_scc1 Ls_nw2
    s_cmp_eq_u32 s61, 3
    s_cselect_b32 s66, s80, s81
    v_add_u32 v238, s66, v238
    v_add_u32 v239, s66, v239
    ds_read_u16 v224, v238 offset:0
    ds_read_u16 v225, v238 offset:8
    ds_read_u16 v226, v238 offset:64
    ds_read_u16 v227, v238 offset:72
    s_waitcnt lgkmcnt(0)
Ls_nw2:
    v_mul_u32_u24 v216, v224, v241
    v_mul_u32_u24 v217, v224, v242
    v_mul_u32_u24 v218, v225, v241
    v_mul_u32_u24 v219, v225, v242
    v_mul_u32_u24 v220, v226, v241
    v_mul_u32_u24 v221, v226, v242
    v_mul_u32_u24 v222, v227, v241
    v_mul_u32_u24 v223, v227, v242
    v_mfma_f32_4x4x4_16b_bf16 v[140:143], v[216:217], v[68:69], v[4:7]
    v_add_u32 v238, 128, v238
    ds_read_b128 v[164:167], v239 offset:0
    ds_read_b128 v[168:171], v239 offset:64
    v_mfma_f32_4x4x4_16b_bf16 v[144:147], v[218:219], v[70:71], v[8:11]
    ds_read_b128 v[172:175], v239 offset:128
    ds_read_b128 v[176:179], v239 offset:192
    ds_read_u16 v224, v238 offset:0
    ds_read_u16 v225, v238 offset:8
    ds_read_u16 v226, v238 offset:64
    ds_read_u16 v227, v238 offset:72
    v_mfma_f32_4x4x4_16b_bf16 v[246:249], v[220:221], v[72:73], v[12:15]
    v_cvt_pk_bf16_f32 v100, v140, v141
    v_cvt_pk_bf16_f32 v101, v142, v143
    v_mfma_f32_4x4x4_16b_bf16 v[250:253], v[222:223], v[74:75], v[16:19]
    v_cvt_pk_bf16_f32 v102, v144, v145
    v_cvt_pk_bf16_f32 v103, v146, v147
    v_mfma_f32_4x4x4_16b_bf16 v[140:143], v[216:217], v[76:77], v[20:23]
    v_cvt_pk_bf16_f32 v104, v246, v247
    v_cvt_pk_bf16_f32 v105, v248, v249
    v_mfma_f32_4x4x4_16b_bf16 v[144:147], v[218:219], v[78:79], v[24:27]
    v_cvt_pk_bf16_f32 v106, v250, v251
    v_cvt_pk_bf16_f32 v107, v252, v253
    v_mfma_f32_4x4x4_16b_bf16 v[246:249], v[220:221], v[80:81], v[28:31]
    v_cvt_pk_bf16_f32 v108, v140, v141
    v_cvt_pk_bf16_f32 v109, v142, v143
    v_mfma_f32_4x4x4_16b_bf16 v[250:253], v[222:223], v[82:83], v[32:35]
    v_cvt_pk_bf16_f32 v110, v144, v145
    v_cvt_pk_bf16_f32 v111, v146, v147
    v_mfma_f32_4x4x4_16b_bf16 v[140:143], v[216:217], v[84:85], v[36:39]
    v_cvt_pk_bf16_f32 v112, v246, v247
    v_cvt_pk_bf16_f32 v113, v248, v249
    v_mfma_f32_4x4x4_16b_bf16 v[144:147], v[218:219], v[86:87], v[40:43]
    v_cvt_pk_bf16_f32 v114, v250, v251
    v_cvt_pk_bf16_f32 v115, v252, v253
    v_mfma_f32_4x4x4_16b_bf16 v[246:249], v[220:221], v[88:89], v[44:47]
    v_cvt_pk_bf16_f32 v116, v140, v141
    v_cvt_pk_bf16_f32 v117, v142, v143
    v_mfma_f32_4x4x4_16b_bf16 v[250:253], v[222:223], v[90:91], v[48:51]
    v_cvt_pk_bf16_f32 v118, v144, v145
    v_cvt_pk_bf16_f32 v119, v146, v147
    v_mfma_f32_4x4x4_16b_bf16 v[140:143], v[216:217], v[92:93], v[52:55]
    v_cvt_pk_bf16_f32 v120, v246, v247
    v_cvt_pk_bf16_f32 v121, v248, v249
    v_mfma_f32_4x4x4_16b_bf16 v[144:147], v[218:219], v[94:95], v[56:59]
    v_cvt_pk_bf16_f32 v122, v250, v251
    v_cvt_pk_bf16_f32 v123, v252, v253
    v_mfma_f32_4x4x4_16b_bf16 v[246:249], v[220:221], v[96:97], v[60:63]
    v_cvt_pk_bf16_f32 v124, v140, v141
    v_cvt_pk_bf16_f32 v125, v142, v143
    v_mfma_f32_4x4x4_16b_bf16 v[250:253], v[222:223], v[98:99], v[64:67]
    v_cvt_pk_bf16_f32 v126, v144, v145
    v_cvt_pk_bf16_f32 v127, v146, v147
    v_cvt_pk_bf16_f32 v128, v246, v247
    v_cvt_pk_bf16_f32 v129, v248, v249
    v_add_u32 v239, 272, v239
    v_cvt_pk_bf16_f32 v130, v250, v251
    v_cvt_pk_bf16_f32 v131, v252, v253
    s_waitcnt lgkmcnt(0)
    s_branch Ls_evd2
Ls_ev3:
    s_bitcmp0_b64 s[56:57], 3
    s_cbranch_scc1 Ls_nf3
    v_cvt_pk_bf16_f32 v246, v212, v212
    v_mov_b32 v212, 0
    ds_write_b16 v240, v246
    v_add_u32 v240, 128, v240
    s_add_u32 s24, s24, s32
    s_addc_u32 s25, s25, 0
    s_xor_b32 s32, s32, 0x18ffe0
Ls_nf3:
    s_bitcmp0_b64 s[56:57], 8
    s_cbranch_scc1 Ls_na3
    s_sub_u32 s60, s60, 1
    s_cbranch_scc0 Ls_ns3
    s_mov_b32 s49, 8
    s_call_b64 s[62:63], L_swap
    s_add_u32 s35, s35, s31
    s_min_u32 s35, s35, 419404800
    s_xor_b32 s31, s31, 0x63ff800
    s_bitcmp0_b64 s[56:57], 5
    s_cbranch_scc1 Ls_evd3
    s_waitcnt lgkmcnt(0)
    s_branch Ls_e13
Ls_ns3:
    s_add_u32 s35, s35, s31
    s_min_u32 s35, s35, 419404800
    s_xor_b32 s31, s31, 0x63ff800
Ls_na3:
    s_bitcmp0_b64 s[56:57], 5
    s_cbranch_scc1 Ls_evd3
Ls_e13:
    s_sub_u32 s61, s61, 1
    s_cbranch_scc1 Ls_last3
    s_bitcmp0_b32 s33, s61
    s_cbranch_scc1 Ls_nw3
    s_cmp_eq_u32 s61, 3
    s_cselect_b32 s66, s80, s81
    v_add_u32 v238, s66, v238
    v_add_u32 v239, s66, v239
    ds_read_u16 v224, v238 offset:0
    ds_read_u16 v225, v238 offset:8
    ds_read_u16 v226, v238 offset:64
    ds_read_u16 v227, v238 offset:72
    s_waitcnt lgkmcnt(0)
Ls_nw3:
    v_mul_u32_u24 v216, v224, v241
    v_mul_u32_u24 v217, v224, v242
    v_mul_u32_u24 v218, v225, v241
    v_mul_u32_u24 v219, v225, v242
    v_mul_u32_u24 v220, v226, v241
    v_mul_u32_u24 v221, v226, v242
    v_mul_u32_u24 v222, v227, v241
    v_mul_u32_u24 v223, v227, v242
    v_mfma_f32_4x4x4_16b_bf16 v[140:143], v[216:217], v[68:69], v[4:7]
    v_add_u32 v238, 128, v238
    ds_read_b128 v[164:167], v239 offset:0
    ds_read_b128 v[168:171], v239 offset:64
    v_mfma_f32_4x4x4_16b_bf16 v[144:147], v[218:219], v[70:71], v[8:11]
    ds_read_b128 v[172:175], v239 offset:128
    ds_read_b128 v[176:179], v239 offset:192
    ds_read_u16 v224, v238 offset:0
    ds_read_u16 v225, v238 offset:8
    ds_read_u16 v226, v238 offset:64
    ds_read_u16 v227, v238 offset:72
    v_mfma_f32_4x4x4_16b_bf16 v[246:249], v[220:221], v[72:73], v[12:15]
    v_cvt_pk_bf16_f32 v100, v140, v141
    v_cvt_pk_bf16_f32 v101, v142, v143
    v_mfma_f32_4x4x4_16b_bf16 v[250:253], v[222:223], v[74:75], v[16:19]
    v_cvt_pk_bf16_f32 v102, v144, v145
    v_cvt_pk_bf16_f32 v103, v146, v147
    v_mfma_f32_4x4x4_16b_bf16 v[140:143], v[216:217], v[76:77], v[20:23]
    v_cvt_pk_bf16_f32 v104, v246, v247
    v_cvt_pk_bf16_f32 v105, v248, v249
    v_mfma_f32_4x4x4_16b_bf16 v[144:147], v[218:219], v[78:79], v[24:27]
    v_cvt_pk_bf16_f32 v106, v250, v251
    v_cvt_pk_bf16_f32 v107, v252, v253
    v_mfma_f32_4x4x4_16b_bf16 v[246:249], v[220:221], v[80:81], v[28:31]
    v_cvt_pk_bf16_f32 v108, v140, v141
    v_cvt_pk_bf16_f32 v109, v142, v143
    v_mfma_f32_4x4x4_16b_bf16 v[250:253], v[222:223], v[82:83], v[32:35]
    v_cvt_pk_bf16_f32 v110, v144, v145
    v_cvt_pk_bf16_f32 v111, v146, v147
    v_mfma_f32_4x4x4_16b_bf16 v[140:143], v[216:217], v[84:85], v[36:39]
    v_cvt_pk_bf16_f32 v112, v246, v247
    v_cvt_pk_bf16_f32 v113, v248, v249
    v_mfma_f32_4x4x4_16b_bf16 v[144:147], v[218:219], v[86:87], v[40:43]
    v_cvt_pk_bf16_f32 v114, v250, v251
    v_cvt_pk_bf16_f32 v115, v252, v253
    v_mfma_f32_4x4x4_16b_bf16 v[246:249], v[220:221], v[88:89], v[44:47]
    v_cvt_pk_bf16_f32 v116, v140, v141
    v_cvt_pk_bf16_f32 v117, v142, v143
    v_mfma_f32_4x4x4_16b_bf16 v[250:253], v[222:223], v[90:91], v[48:51]
    v_cvt_pk_bf16_f32 v118, v144, v145
    v_cvt_pk_bf16_f32 v119, v146, v147
    v_mfma_f32_4x4x4_16b_bf16 v[140:143], v[216:217], v[92:93], v[52:55]
    v_cvt_pk_bf16_f32 v120, v246, v247
    v_cvt_pk_bf16_f32 v121, v248, v249
    v_mfma_f32_4x4x4_16b_bf16 v[144:147], v[218:219], v[94:95], v[56:59]
    v_cvt_pk_bf16_f32 v122, v250, v251
    v_cvt_pk_bf16_f32 v123, v252, v253
    v_mfma_f32_4x4x4_16b_bf16 v[246:249], v[220:221], v[96:97], v[60:63]
    v_cvt_pk_bf16_f32 v124, v140, v141
    v_cvt_pk_bf16_f32 v125, v142, v143
    v_mfma_f32_4x4x4_16b_bf16 v[250:253], v[222:223], v[98:99], v[64:67]
    v_cvt_pk_bf16_f32 v126, v144, v145
    v_cvt_pk_bf16_f32 v127, v146, v147
    v_cvt_pk_bf16_f32 v128, v246, v247
    v_cvt_pk_bf16_f32 v129, v248, v249
    v_add_u32 v239, 272, v239
    v_cvt_pk_bf16_f32 v130, v250, v251
    v_cvt_pk_bf16_f32 v131, v252, v253
    s_waitcnt lgkmcnt(0)
    s_branch Ls_evd3
Ls_last0:
    s_branch Ls_tail
Ls_last1:
    v_add_u32 v236, 2080, v236
    s_lshr_b64 s[56:57], s[56:57], 1
    v_add_u32 v244, 16, v244
    s_branch Ls_tail
Ls_last2:
    v_add_u32 v236, 4160, v236
    s_lshr_b64 s[56:57], s[56:57], 2
    v_add_u32 v244, 32, v244
    s_branch Ls_tail
Ls_last3:
    v_add_u32 v236, 6240, v236
    s_lshr_b64 s[56:57], s[56:57], 3
    v_add_u32 v244, 48, v244
Ls_tail:
    v_mfma_f32_16x16x32_bf16 v[208:211], v[136:139], v[200:203], v[208:211]
    ds_read_b32 v246, v244 offset:0
    s_waitcnt lgkmcnt(0)
    v_bfe_u32 v247, v246, 0, 8
    v_lshlrev_b32 v247, 1, v247
    v_bfe_u32 v248, v246, 8, 8
    v_lshlrev_b32 v248, 1, v248
    v_bfe_u32 v249, v246, 16, 8
    v_lshlrev_b32 v249, 1, v249
    v_bfe_u32 v250, v246, 24, 8
    v_lshlrev_b32 v250, 1, v250
    buffer_load_ushort v247, v247, s[24:27], 0 offen
    buffer_load_ushort v248, v248, s[24:27], 0 offen
    buffer_load_ushort v249, v249, s[24:27], 0 offen
    buffer_load_ushort v250, v250, s[24:27], 0 offen
    s_waitcnt vmcnt(0)
    v_lshlrev_b32 v247, 16, v247
    v_mul_f32 v208, v208, v247
    v_lshlrev_b32 v248, 16, v248
    v_mul_f32 v209, v209, v248
    v_lshlrev_b32 v249, 16, v249
    v_mul_f32 v210, v210, v249
    v_lshlrev_b32 v250, 16, v250
    v_mul_f32 v211, v211, v250
    v_exp_f32 v132, v148
    v_exp_f32 v133, v149
    v_exp_f32 v134, v150
    v_exp_f32 v135, v151
    v_exp_f32 v136, v152
    v_exp_f32 v137, v153
    v_mfma_f32_4x4x4_16b_bf16 v[132:135], v[228:229], v[228:229], v[132:135]
    v_exp_f32 v138, v154
    v_exp_f32 v139, v155
    v_cvt_pk_bf16_f32 v208, v208, v209
    v_cvt_pk_bf16_f32 v209, v210, v211
    v_exp_f32 v140, v156
    v_exp_f32 v141, v157
    v_mfma_f32_4x4x4_16b_bf16 v[212:215], v[208:209], v[188:189], v[212:215] cbsz:4 abid:0
    v_mfma_f32_4x4x4_16b_bf16 v[136:139], v[228:229], v[228:229], v[136:139]
    v_exp_f32 v142, v158
    v_mfma_f32_4x4x4_16b_bf16 v[212:215], v[208:209], v[190:191], v[212:215] cbsz:4 abid:4
    v_exp_f32 v143, v159
    v_exp_f32 v144, v160
    v_mfma_f32_4x4x4_16b_bf16 v[212:215], v[208:209], v[192:193], v[212:215] cbsz:4 abid:8
    v_exp_f32 v145, v161
    v_mfma_f32_4x4x4_16b_bf16 v[140:143], v[228:229], v[228:229], v[140:143]
    v_mfma_f32_4x4x4_16b_bf16 v[212:215], v[208:209], v[194:195], v[212:215] cbsz:4 abid:12
    ds_read_b64_tr_b16 v[188:189], v236 offset:0
    ds_read_b64_tr_b16 v[190:191], v236 offset:512
    ds_read_b64_tr_b16 v[192:193], v236 offset:1056
    ds_read_b64_tr_b16 v[194:195], v236 offset:1568
    v_exp_f32 v146, v162
    v_exp_f32 v147, v163
    v_rcp_f32 v132, v132
    v_rcp_f32 v133, v133
    v_mfma_f32_4x4x4_16b_bf16 v[144:147], v[228:229], v[228:229], v[144:147]
    v_rcp_f32 v134, v134
    s_bitcmp0_b64 s[56:57], 1
    s_cbranch_scc1 Ls_tnf
    v_cvt_pk_bf16_f32 v246, v212, v212
    v_mov_b32 v212, 0
    ds_write_b16 v240, v246
    v_add_u32 v240, 128, v240
    s_add_u32 s24, s24, s32
    s_addc_u32 s25, s25, 0
    s_xor_b32 s32, s32, 0x18ffe0
Ls_tnf:
    v_cvt_pk_bf16_f32 v132, v132, v133
    s_waitcnt lgkmcnt(0)
    v_rcp_f32 v135, v135
    v_rcp_f32 v136, v136
    v_cvt_pk_bf16_f32 v133, v134, v135
    v_rcp_f32 v137, v137
    v_rcp_f32 v138, v138
    v_cvt_pk_bf16_f32 v134, v136, v137
    v_rcp_f32 v139, v139
    v_rcp_f32 v140, v140
    v_cvt_pk_bf16_f32 v135, v138, v139
    v_rcp_f32 v141, v141
    v_rcp_f32 v142, v142
    v_cvt_pk_bf16_f32 v136, v140, v141
    v_mfma_f32_16x16x32_bf16 v[208:211], v[132:135], v[196:199], v[204:207]
    v_rcp_f32 v143, v143
    v_rcp_f32 v144, v144
    v_cvt_pk_bf16_f32 v137, v142, v143
    v_rcp_f32 v145, v145
    v_rcp_f32 v146, v146
    v_rcp_f32 v147, v147
    v_cvt_pk_bf16_f32 v138, v144, v145
    v_cvt_pk_bf16_f32 v139, v146, v147
    s_nop 1
    v_mfma_f32_16x16x32_bf16 v[208:211], v[136:139], v[200:203], v[208:211]
    ds_read_b32 v246, v244 offset:16
    s_waitcnt lgkmcnt(0)
    v_bfe_u32 v247, v246, 0, 8
    v_lshlrev_b32 v247, 1, v247
    v_bfe_u32 v248, v246, 8, 8
    v_lshlrev_b32 v248, 1, v248
    v_bfe_u32 v249, v246, 16, 8
    v_lshlrev_b32 v249, 1, v249
    v_bfe_u32 v250, v246, 24, 8
    v_lshlrev_b32 v250, 1, v250
    buffer_load_ushort v247, v247, s[24:27], 0 offen
    buffer_load_ushort v248, v248, s[24:27], 0 offen
    buffer_load_ushort v249, v249, s[24:27], 0 offen
    buffer_load_ushort v250, v250, s[24:27], 0 offen
    s_waitcnt vmcnt(0)
    v_lshlrev_b32 v247, 16, v247
    v_mul_f32 v208, v208, v247
    v_lshlrev_b32 v248, 16, v248
    v_mul_f32 v209, v209, v248
    v_lshlrev_b32 v249, 16, v249
    v_mul_f32 v210, v210, v249
    v_lshlrev_b32 v250, 16, v250
    v_mul_f32 v211, v211, v250
    v_cvt_pk_bf16_f32 v208, v208, v209
    v_cvt_pk_bf16_f32 v209, v210, v211
    s_nop 1
    v_mfma_f32_4x4x4_16b_bf16 v[212:215], v[208:209], v[188:189], v[212:215] cbsz:4 abid:0
    s_nop 1
    v_mfma_f32_4x4x4_16b_bf16 v[212:215], v[208:209], v[190:191], v[212:215] cbsz:4 abid:4
    s_nop 1
    v_mfma_f32_4x4x4_16b_bf16 v[212:215], v[208:209], v[192:193], v[212:215] cbsz:4 abid:8
    s_nop 1
    v_mfma_f32_4x4x4_16b_bf16 v[212:215], v[208:209], v[194:195], v[212:215] cbsz:4 abid:12
    s_nop 4
    v_cvt_pk_bf16_f32 v246, v212, v212
    ds_write_b16 v240, v246
    s_branch L_store
.section .rodata,"a"
.p2align 6
.amdhsa_kernel standalone__sequential_behavior_din__recsys_kernel
  .amdhsa_next_free_vgpr 256
  .amdhsa_next_free_sgpr 102
  .amdhsa_accum_offset 256
  .amdhsa_group_segment_fixed_size 0
  .amdhsa_kernarg_size 80
  .amdhsa_user_sgpr_count 2
  .amdhsa_user_sgpr_kernarg_segment_ptr 1
  .amdhsa_system_sgpr_workgroup_id_x 1
.end_amdhsa_kernel
```

```asm
; @launch grid=(256,1,1) block=(512,1,1) lds=163840
.amdgcn_target "amdgcn-amd-amdhsa--gfx950"
.text
.globl standalone__sequential_behavior_din__recsys_kernel
.p2align 8
.type standalone__sequential_behavior_din__recsys_kernel,@function
standalone__sequential_behavior_din__recsys_kernel:
    s_load_dwordx16 s[4:19], s[0:1], 0
    s_cmp_ge_u32 s2, 256
    s_cbranch_scc1 L_end
    v_lshrrev_b32 v1, 6, v0
    v_and_b32 v0, 63, v0
    v_readfirstlane_b32 s54, v1
    s_lshl_b32 s53, s2, 3
    v_lshlrev_b32 v2, 4, v0
    v_lshrrev_b32 v1, 4, v0
    v_and_b32 v3, 0xf0, v2
    v_lshlrev_b32 v3, 2, v3
    v_lshl_add_u32 v130, v1, 4, v3
    v_bfrev_b32 v3, 1
    s_add_u32 s53, s53, s54
    s_movk_i32 s66, 800
    v_cmp_gt_u32 vcc, s66, v130
    s_mul_i32 s93, s53, 800
    s_mul_i32 s52, s54, 20480
    s_mov_b64 s[28:29], vcc
    v_cndmask_b32 v3, v3, v130, vcc
    v_and_b32 v248, 16, v0
    v_lshlrev_b32 v246, 1, v248
    v_xor_b32 v246, v246, v2
    v_and_b32 v243, 0xf0, v2
    v_lshl_add_u32 v243, v1, 19, v243
    s_lshl_b32 s66, s53, 8
    v_add_u32 v243, s66, v243
    s_lshl_b32 s67, s54, 12
    s_add_u32 m0, s52, 8320
    s_mov_b32 s26, 6553600
    s_mov_b32 s27, 0x20000
    s_waitcnt lgkmcnt(0)
    s_mov_b32 s24, s8
    s_and_b32 s25, s9, 0xffff
    s_cmp_ge_u32 s54, 4
    s_cbranch_scc1 L_young0
    buffer_load_dwordx4 v[100:103], v3, s[24:27], s93 offen nt
L_young0:
    global_load_lds_dwordx4 v243, s[4:5] nt
    s_add_u32 m0, s52, 4160
    s_add_u32 s10, s10, s67
    s_addc_u32 s11, s11, 0
    v_xor_b32 v247, 64, v246
    global_load_lds_dwordx4 v246, s[10:11] offset:0
    global_load_lds_dwordx4 v247, s[10:11] offset:1024
    global_load_lds_dwordx4 v246, s[10:11] offset:2048
    global_load_lds_dwordx4 v247, s[10:11] offset:3072
    s_load_dword s30, s[16:17], 0
    s_and_b32 s67, s54, 3
    v_and_b32 v250, 3, v0
    s_mov_b32 s20, s6
    s_and_b32 s21, s7, 0xffff
    s_or_b32 s21, s21, 0x800000
    s_mov_b32 s22, 200
    s_mov_b32 s23, 0x20000
    s_sub_u32 s40, s20, 1056
    s_subb_u32 s41, s21, 0
    s_mov_b32 s42, 200
    s_mov_b32 s43, 0x20000
    s_mul_i32 s35, s53, 51200
    s_movk_i32 s31, 25600
    s_mov_b32 s60, 3
    s_mov_b64 s[56:57], 0
    v_mov_b32 v148, -1
    v_mov_b32 v149, -1
    v_mov_b32 v150, -1
    v_mov_b32 v151, -1
    s_add_u32 s66, s52, 18432
    v_add_u32 v152, s66, v2
    ds_write_b128 v152, v[148:151]
    ds_write_b128 v152, v[148:151] offset:1024
    s_add_u32 s64, s52, 18448
    v_mov_b32 v153, -1
    v_mov_b32 v154, -1
    v_mov_b32 v155, -1
    v_lshrrev_b32 v237, 3, v0
    v_add_u32 v237, s64, v237
    v_lshl_add_u32 v244, v1, 2, s66
    v_and_b32 v231, 0x70, v2
    v_lshlrev_b32 v248, 2, v248
    v_xor_b32 v231, v231, v248
    v_mov_b32 v233, v231
    s_movk_i32 s66, 400
    v_cmp_le_u32 vcc, s66, v130
    v_lshrrev_b32 v126, 1, v130
    s_movk_i32 s66, -200
    v_cndmask_b32 v130, 0, 1, vcc
    v_mad_i32_i24 v126, v130, s66, v126
    v_mul_u32_u24 v127, 0x10001, v126
    v_add_u32 v126, 0x10000, v127
    v_add_u32 v128, 0x50004, v127
    v_add_u32 v129, 0x70006, v127
    v_add_u32 v127, 0x30002, v127
    v_mov_b32 v131, 0xbfe0bfe0
    s_mov_b32 s86, 0xfff0ffff
    s_mov_b32 s87, 0xf000ff00
    s_mov_b32 s88, 0xff00fff0
    s_mov_b32 s89, 0xf000
    s_mov_b32 s90, 0xf0000f
    s_mov_b32 s91, 0xf0000f00
    s_mov_b32 s84, 0x11111113
    s_mov_b32 s85, 0x11111111
    v_cndmask_b32 v116, 0, v131, s[86:87]
    v_cndmask_b32 v120, 0, v131, s[88:89]
    v_cndmask_b32 v117, 0, v131, s[86:87]
    v_cndmask_b32 v121, 0, v131, s[88:89]
    v_cndmask_b32 v122, 0, v131, s[84:85]
    v_cndmask_b32 v123, 0, v131, s[84:85]
    v_cndmask_b32 v124, 0, v131, s[84:85]
    v_cndmask_b32 v125, 0, v131, s[84:85]
    v_lshlrev_b32 v246, 4, v250
    v_sub_u32 v246, 48, v246
    s_mov_b32 s86, 0xbfe0bfe0
    s_mov_b32 s87, 0xf0bfe0
    v_lshrrev_b64 v[118:119], v246, s[86:87]
    v_mov_b32 v131, 0
    s_mov_b64 s[84:85], 0
    v_cndmask_b32 v118, v120, v118, s[90:91]
    v_cndmask_b32 v119, v121, v119, s[90:91]
    s_mov_b32 s61, 7
    s_mov_b32 s92, 0xbfb8aa3b
    v_and_b32 v251, 15, v0
    v_bfe_u32 v252, v0, 2, 2
    v_lshlrev_b32 v253, 3, v250
    v_lshl_add_u32 v253, v252, 7, v253
    v_and_b32 v246, 24, v0
    v_lshlrev_b32 v246, 2, v246
    v_xor_b32 v246, v253, v246
    v_lshl_add_u32 v246, v1, 10, v246
    s_lshl_b32 s66, s67, 5
    v_xor_b32 v66, s66, v246
    v_add_u32 v66, 45120, v66
    s_lshr_b32 s66, s54, 1
    s_lshl_b32 s66, s66, 5
    v_xor_b32 v64, s66, v246
    s_and_b32 s66, s54, 1
    s_mul_i32 s66, s66, 20480
    s_add_u32 s66, s66, 4160
    v_add_u32 v64, s66, v64
    v_add_u32 v65, 81920, v64
    s_and_b32 s66, s54, 4
    v_lshrrev_b32 v246, 3, v251
    v_add_u32 v246, s66, v246
    v_mul_u32_u24 v246, 20480, v246
    v_lshl_add_u32 v246, v1, 4, v246
    v_and_b32 v247, 7, v0
    v_lshl_add_u32 v67, v247, 7, v246
    v_and_b32 v247, 1, v0
    v_lshlrev_b32 v247, 4, v247
    v_lshlrev_b32 v247, v247, 1
    v_cmp_gt_u32 vcc, 2, v250
    v_mov_b32 v229, 0
    v_mov_b32 v228, 0x3f80
    v_cndmask_b32 v241, 0, v247, vcc
    v_cmp_eq_u32 vcc, 0, v251
    v_sub_u32 v242, v247, v241
    v_mul_u32_u24 v218, 0x3f80, v241
    v_cndmask_b32 v220, 0, -1, vcc
    v_mul_u32_u24 v219, 0x3f80, v242
    s_and_b32 s66, s54, 3
    s_lshl_b32 s66, s66, 6
    s_add_u32 s66, s66, 9344
    v_and_b32 v247, 7, v0
    v_mul_u32_u24 v247, 144, v247
    v_add3_u32 v98, v67, v247, s66
    s_add_u32 s66, s52, 14592
    v_lshl_add_u32 v221, v0, 2, s66
    ds_write_b32 v221, v229
    s_xor_b32 s66, s54, 4
    s_mul_i32 s66, s66, 20480
    s_add_u32 s66, s66, 14592
    v_writelane_b32 v221, s66, 1
    v_add_u32 v222, s52, v2
    s_mov_b64 exec, 15
    ds_write_b32 v222, v229 offset:14848
    s_mov_b64 exec, -1
    v_and_b32 v247, 8, v0
    v_lshlrev_b32 v247, 2, v247
    v_lshl_add_u32 v247, v251, 7, v247
    v_add_u32 v247, s52, v247
    v_and_b32 v248, 2, v0
    v_lshlrev_b32 v248, 1, v248
    v_xor_b32 v248, v248, v1
    v_lshl_add_u32 v234, v248, 4, v247
    v_xor_b32 v248, 4, v248
    v_lshl_add_u32 v235, v248, 4, v247
    v_and_b32 v247, 8, v0
    v_lshlrev_b32 v247, 3, v247
    v_lshl_add_u32 v248, v1, 5, v253
    v_xor_b32 v248, v248, v247
    v_add_u32 v236, s52, v248
    s_add_u32 s66, s52, 8320
    v_lshl_add_u32 v238, v250, 1, s66
    v_lshl_add_u32 v238, v1, 4, v238
    s_add_u32 s66, s52, 14912
    v_lshl_add_u32 v240, v0, 1, s66
    s_add_u32 s66, s52, 9344
    v_lshl_add_u32 v239, v1, 4, s66
    v_mov_b32 v188, 0
    v_mov_b32 v189, 0
    v_mov_b32 v190, 0
    v_mov_b32 v191, 0
    v_mov_b32 v192, 0
    v_mov_b32 v193, 0
    v_mov_b32 v194, 0
    v_mov_b32 v195, 0
    v_mov_b32 v208, 0
    v_mov_b32 v212, 0
    v_mov_b32 v209, 0
    v_mov_b32 v213, 0
    v_mov_b32 v210, 0
    v_mov_b32 v214, 0
    v_mov_b32 v211, 0
    v_mov_b32 v215, 0
    s_and_b32 s66, s54, 3
    s_lshl_b32 s66, s66, 5
    v_lshl_add_u32 v249, v1, 3, s66
    global_load_dwordx2 v[96:97], v249, s[12:13]
    s_cmp_ge_u32 s54, 4
    s_cbranch_scc0 L_old3z
    buffer_load_dwordx4 v[100:103], v3, s[24:27], s93 offen nt
L_old3z:
    s_cmp_ge_u32 s54, 4
    s_cbranch_scc1 L_young1
    s_waitcnt vmcnt(6) lgkmcnt(0)
    s_call_b64 s[62:63], L_fp
    s_waitcnt vmcnt(5)
    s_branch L_old1
L_young1:
    s_waitcnt vmcnt(2)
L_old1:
    s_waitcnt lgkmcnt(0)
    s_barrier
    ds_read_b64_tr_b16 v[16:17], v66 offset:0
    ds_read_b64_tr_b16 v[18:19], v66 offset:512
    ds_read_b64_tr_b16 v[20:21], v66 offset:20480
    ds_read_b64_tr_b16 v[22:23], v66 offset:20992
    ds_read_b64_tr_b16 v[24:25], v66 offset:40960
    ds_read_b64_tr_b16 v[26:27], v66 offset:41472
    ds_read_b64_tr_b16 v[28:29], v66 offset:61440
    ds_read_b64_tr_b16 v[30:31], v66 offset:61952
    ds_read_b128 v[32:35], v67 offset:8320
    ds_read_b128 v[36:39], v67 offset:8384
    ds_read_b128 v[40:43], v67 offset:49280
    ds_read_b128 v[44:47], v67 offset:49344
    ds_read_b64_tr_b16 v[4:5], v64 offset:0
    ds_read_b64_tr_b16 v[8:9], v65 offset:0
    ds_read_b64_tr_b16 v[12:13], v65 offset:40960
    ds_read_b64_tr_b16 v[6:7], v64 offset:512
    ds_read_b64_tr_b16 v[10:11], v65 offset:512
    ds_read_b64_tr_b16 v[14:15], v65 offset:41472
    s_cmp_ge_u32 s54, 4
    s_cbranch_scc1 L_young2
    s_waitcnt vmcnt(4)
    s_branch L_old2
L_young2:
    s_waitcnt vmcnt(1)
L_old2:
    s_add_u32 s93, s93, 1638400
    buffer_load_dwordx4 v[104:107], v3, s[24:27], s93 offen nt
    s_add_u32 s93, s93, 1638400
    buffer_load_dwordx4 v[108:111], v3, s[24:27], s93 offen nt
    s_add_u32 s93, s93, 1638400
    buffer_load_dwordx4 v[112:115], v3, s[24:27], s93 offen nt
    v_lshlrev_b32 v249, 3, v1
    v_lshl_add_u32 v249, v250, 5, v249
    global_load_dwordx2 v[216:217], v249, s[14:15]
    v_lshlrev_b32 v48, 16, v96
    v_and_b32 v49, 0xffff0000, v96
    v_lshlrev_b32 v50, 16, v97
    v_and_b32 v51, 0xffff0000, v97
    s_lshl_b32 s30, s30, 16
    v_and_b32 v204, s30, v220
    v_and_b32 v205, s30, v220
    v_and_b32 v206, s30, v220
    v_and_b32 v207, s30, v220
    s_waitcnt lgkmcnt(0)
    v_xor_b32 v24, 0x80008000, v24
    v_xor_b32 v25, 0x80008000, v25
    v_xor_b32 v26, 0x80008000, v26
    v_xor_b32 v27, 0x80008000, v27
    v_xor_b32 v28, 0x80008000, v28
    v_xor_b32 v29, 0x80008000, v29
    v_xor_b32 v30, 0x80008000, v30
    v_xor_b32 v31, 0x80008000, v31
    v_mfma_f32_4x4x4_16b_bf16 v[56:59], v[218:219], v[4:5], 0
    v_mfma_f32_4x4x4_16b_bf16 v[68:71], v[218:219], v[12:13], 0
    v_mfma_f32_4x4x4_16b_bf16 v[60:63], v[218:219], v[6:7], 0
    v_mfma_f32_4x4x4_16b_bf16 v[72:75], v[218:219], v[14:15], 0
    v_mfma_f32_4x4x4_16b_bf16 v[56:59], v[218:219], v[8:9], v[56:59]
    v_mfma_f32_4x4x4_16b_bf16 v[60:63], v[218:219], v[10:11], v[60:63]
    v_mfma_f32_16x16x32_bf16 v[52:55], v[16:19], v[40:43], v[48:51]
    v_mfma_f32_16x16x32_bf16 v[52:55], v[20:23], v[44:47], v[52:55]
    v_mfma_f32_16x16x32_bf16 v[52:55], v[24:27], v[40:43], v[52:55]
    v_mfma_f32_16x16x32_bf16 v[52:55], v[28:31], v[44:47], v[52:55]
    v_mfma_f32_16x16x32_bf16 v[48:51], v[16:19], v[32:35], v[48:51]
    v_mfma_f32_16x16x32_bf16 v[48:51], v[20:23], v[36:39], v[48:51]
    v_mfma_f32_16x16x32_bf16 v[48:51], v[24:27], v[32:35], v[48:51]
    v_mfma_f32_16x16x32_bf16 v[48:51], v[28:31], v[36:39], v[48:51]
    v_mul_f32 v56, s92, v56
    v_mul_f32 v57, s92, v57
    v_mul_f32 v58, s92, v58
    v_mul_f32 v59, s92, v59
    v_mul_f32 v60, s92, v60
    v_mul_f32 v61, s92, v61
    v_mul_f32 v62, s92, v62
    v_mul_f32 v63, s92, v63
    v_mul_f32 v68, s92, v68
    v_mul_f32 v69, s92, v69
    v_mul_f32 v70, s92, v70
    v_mul_f32 v71, s92, v71
    v_mul_f32 v72, s92, v72
    v_mul_f32 v73, s92, v73
    v_mul_f32 v74, s92, v74
    v_mul_f32 v75, s92, v75
    s_add_u32 s66, s52, 11520
    v_add_u32 v3, s66, v2
    v_cvt_pk_bf16_f32 v68, v68, v69
    v_cvt_pk_bf16_f32 v69, v70, v71
    v_cvt_pk_bf16_f32 v70, v72, v73
    v_cvt_pk_bf16_f32 v71, v74, v75
    v_mul_f32 v48, s92, v48
    v_mul_f32 v49, s92, v49
    v_mul_f32 v50, s92, v50
    v_mul_f32 v51, s92, v51
    v_mul_f32 v52, s92, v52
    v_mul_f32 v53, s92, v53
    v_mul_f32 v54, s92, v54
    v_mul_f32 v55, s92, v55
    ds_write_b128 v3, v[56:59]
    ds_write_b128 v3, v[60:63] offset:1024
    ds_write_b128 v3, v[68:71] offset:2048
    ds_write_b128 v98, v[48:51]
    ds_write_b128 v98, v[52:55] offset:40960
    v_add_u32 v3, 11520, v2
    v_add_u32 v246, 81920, v3
    s_waitcnt lgkmcnt(0)
    s_barrier
    s_cmp_ge_u32 s54, 4
    s_cbranch_scc0 L_old3
    s_waitcnt vmcnt(4)
    s_call_b64 s[62:63], L_fp
    s_branch L_yng3
L_old3:
    s_call_b64 s[62:63], L_t23
L_yng3:
    ds_read_b128 v[4:7], v3 offset:0
    ds_read_b128 v[8:11], v3 offset:1024
    ds_read_b128 v[68:71], v3 offset:2048
    ds_read_b128 v[12:15], v3 offset:20480
    ds_read_b128 v[16:19], v3 offset:21504
    ds_read_b128 v[72:75], v3 offset:22528
    ds_read_b128 v[20:23], v3 offset:40960
    ds_read_b128 v[24:27], v3 offset:41984
    ds_read_b128 v[76:79], v3 offset:43008
    s_waitcnt vmcnt(4)
    v_mfma_i32_16x16x64_i8 v[172:175], v[122:125], v[104:107], 0
    v_mfma_i32_16x16x64_i8 v[176:179], v[122:125], v[108:111], 0
    v_mfma_i32_16x16x64_i8 v[180:183], v[122:125], v[112:115], 0
    v_and_b32 v160, 0x800080, v104
    v_mul_u32_u24 v160, 0x7f, v160
    v_bitop3_b32 v131, v104, v160, v131 bitop3:0xbe
    v_and_b32 v161, 0x800080, v105
    v_mul_u32_u24 v161, 0x7f, v161
    v_bitop3_b32 v131, v105, v161, v131 bitop3:0xbe
    v_and_b32 v160, 0x800080, v106
    v_mul_u32_u24 v160, 0x7f, v160
    v_bitop3_b32 v131, v106, v160, v131 bitop3:0xbe
    v_mov_b32_dpp v184, v172 row_shr:1 row_mask:0xf bank_mask:0xf bound_ctrl:0
    v_mov_b32_dpp v185, v176 row_shr:1 row_mask:0xf bank_mask:0xf bound_ctrl:0
    v_mov_b32_dpp v186, v180 row_shr:1 row_mask:0xf bank_mask:0xf bound_ctrl:0
    v_add_u32_dpp v184, v184, v184 row_shr:1 row_mask:0xf bank_mask:0xf bound_ctrl:0
    v_add_u32_dpp v185, v185, v185 row_shr:1 row_mask:0xf bank_mask:0xf bound_ctrl:0
    v_add_u32_dpp v186, v186, v186 row_shr:1 row_mask:0xf bank_mask:0xf bound_ctrl:0
    v_add_u32_dpp v184, v184, v184 row_shr:2 row_mask:0xf bank_mask:0xf bound_ctrl:0
    v_add_u32_dpp v185, v185, v185 row_shr:2 row_mask:0xf bank_mask:0xf bound_ctrl:0
    v_add_u32_dpp v186, v186, v186 row_shr:2 row_mask:0xf bank_mask:0xf bound_ctrl:0
    v_add_u32_dpp v184, v184, v184 row_shr:4 row_mask:0xf bank_mask:0xf bound_ctrl:0
    v_add_u32_dpp v185, v185, v185 row_shr:4 row_mask:0xf bank_mask:0xf bound_ctrl:0
    v_add_u32_dpp v186, v186, v186 row_shr:4 row_mask:0xf bank_mask:0xf bound_ctrl:0
    v_add_u32_dpp v184, v184, v184 row_shr:8 row_mask:0xf bank_mask:0xf bound_ctrl:0
    v_add_u32_dpp v185, v185, v185 row_shr:8 row_mask:0xf bank_mask:0xf bound_ctrl:0
    v_add_u32_dpp v186, v186, v186 row_shr:8 row_mask:0xf bank_mask:0xf bound_ctrl:0
    ds_read_b128 v[28:31], v3 offset:61440
    ds_read_b128 v[32:35], v3 offset:62464
    ds_read_b128 v[80:83], v3 offset:63488
    ds_read_b128 v[36:39], v246 offset:0
    ds_read_b128 v[40:43], v246 offset:1024
    ds_read_b128 v[84:87], v246 offset:2048
    v_and_b32 v161, 0x800080, v107
    v_mul_u32_u24 v161, 0x7f, v161
    v_bitop3_b32 v131, v107, v161, v131 bitop3:0xbe
    v_and_b32 v160, 0x800080, v108
    v_mul_u32_u24 v160, 0x7f, v160
    v_bitop3_b32 v131, v108, v160, v131 bitop3:0xbe
    v_and_b32 v161, 0x800080, v109
    v_mul_u32_u24 v161, 0x7f, v161
    v_bitop3_b32 v131, v109, v161, v131 bitop3:0xbe
    v_and_b32 v160, 0x800080, v110
    v_mul_u32_u24 v160, 0x7f, v160
    v_bitop3_b32 v131, v110, v160, v131 bitop3:0xbe
    v_and_b32 v161, 0x800080, v111
    v_mul_u32_u24 v161, 0x7f, v161
    v_bitop3_b32 v131, v111, v161, v131 bitop3:0xbe
    v_and_b32 v160, 0x800080, v112
    v_mul_u32_u24 v160, 0x7f, v160
    v_bitop3_b32 v131, v112, v160, v131 bitop3:0xbe
    v_and_b32 v161, 0x800080, v113
    v_mul_u32_u24 v161, 0x7f, v161
    v_bitop3_b32 v131, v113, v161, v131 bitop3:0xbe
    v_and_b32 v160, 0x800080, v114
    v_mul_u32_u24 v160, 0x7f, v160
    v_bitop3_b32 v131, v114, v160, v131 bitop3:0xbe
    v_and_b32 v161, 0x800080, v115
    v_mul_u32_u24 v161, 0x7f, v161
    v_bitop3_b32 v131, v115, v161, v131 bitop3:0xbe
    v_cmp_ne_u32 vcc, 0, v131
    v_readlane_b32 s68, v184, 6
    v_readlane_b32 s69, v173, 6
    v_readlane_b32 s70, v184, 15
    v_readlane_b32 s72, v185, 6
    v_readlane_b32 s73, v177, 6
    v_readlane_b32 s74, v185, 15
    v_readlane_b32 s76, v186, 6
    v_readlane_b32 s77, v181, 6
    v_readlane_b32 s78, v186, 15
    s_cbranch_vccnz L_general
    s_add_u32 s66, s68, s69
    s_add_u32 s66, s66, s64
    s_add_u32 s67, s66, 15
    s_and_b32 s67, s67, -16
    s_add_u32 s55, s64, 16
    s_max_u32 s67, s67, s55
    s_sub_u32 s66, s67, s66
    v_mad_u32_u24 v184, v130, s66, v184
    s_sub_u32 s55, s64, 2048
    v_add_u32 v172, s55, v184
    v_add_u32 v173, s55, v184
    v_add_u32 v174, s55, v184
    v_add_u32 v175, s55, v184
    s_add_u32 s64, s64, s70
    s_add_u32 s64, s64, s66
    v_mfma_i32_16x16x64_i8 v[132:135], v[118:121], v[104:107], v[172:175]
    v_mfma_i32_16x16x64_i8 v[136:139], v[116:119], v[104:107], v[172:175]
    s_add_u32 s64, s64, 15
    s_and_b32 s64, s64, -16
    s_add_u32 s55, s67, 16
    s_max_u32 s64, s64, s55
    s_lshr_b32 s95, s67, 4
    s_bitset1_b64 s[56:57], s95
    s_lshr_b32 s95, s64, 4
    s_bitset1_b64 s[56:57], s95
    s_mov_b32 s44, s64
    s_add_u32 s66, s72, s73
    s_add_u32 s66, s66, s64
    s_add_u32 s67, s66, 15
    s_and_b32 s67, s67, -16
    s_add_u32 s55, s64, 16
    s_max_u32 s67, s67, s55
    s_sub_u32 s66, s67, s66
    v_mad_u32_u24 v185, v130, s66, v185
    s_sub_u32 s55, s64, 2048
    v_add_u32 v176, s55, v185
    v_add_u32 v177, s55, v185
    v_add_u32 v178, s55, v185
    v_add_u32 v179, s55, v185
    s_add_u32 s64, s64, s74
    s_add_u32 s64, s64, s66
    v_mfma_i32_16x16x64_i8 v[140:143], v[118:121], v[108:111], v[176:179]
    v_mfma_i32_16x16x64_i8 v[144:147], v[116:119], v[108:111], v[176:179]
    s_add_u32 s64, s64, 15
    s_and_b32 s64, s64, -16
    s_add_u32 s55, s67, 16
    s_max_u32 s64, s64, s55
    s_mov_b32 s45, s67
    s_mov_b32 s46, s64
    ds_write_b8 v132, v126
    ds_write_b8_d16_hi v133, v126
    ds_write_b8 v134, v127
    ds_write_b8_d16_hi v135, v127
    ds_write_b8 v136, v128
    ds_write_b8_d16_hi v137, v128
    ds_write_b8 v138, v129
    ds_write_b8_d16_hi v139, v129
    s_add_u32 s66, s76, s77
    s_add_u32 s66, s66, s64
    s_add_u32 s67, s66, 15
    s_and_b32 s67, s67, -16
    s_add_u32 s55, s64, 16
    s_max_u32 s67, s67, s55
    s_sub_u32 s66, s67, s66
    v_mad_u32_u24 v186, v130, s66, v186
    s_sub_u32 s55, s64, 2048
    v_add_u32 v180, s55, v186
    v_add_u32 v181, s55, v186
    v_add_u32 v182, s55, v186
    v_add_u32 v183, s55, v186
    s_add_u32 s64, s64, s78
    s_add_u32 s64, s64, s66
    v_mfma_i32_16x16x64_i8 v[164:167], v[118:121], v[112:115], v[180:183]
    v_mfma_i32_16x16x64_i8 v[168:171], v[116:119], v[112:115], v[180:183]
    s_add_u32 s64, s64, 15
    s_and_b32 s64, s64, -16
    s_add_u32 s55, s67, 16
    s_max_u32 s64, s64, s55
    s_mov_b32 s47, s67
    s_mov_b32 s48, s64
    ds_write_b8 v140, v126
    ds_write_b8_d16_hi v141, v126
    ds_write_b8 v142, v127
    ds_write_b8_d16_hi v143, v127
    ds_write_b8 v144, v128
    ds_write_b8_d16_hi v145, v128
    ds_write_b8 v146, v129
    ds_write_b8_d16_hi v147, v129
    ds_read_b128 v[44:47], v246 offset:20480
    ds_read_b128 v[48:51], v246 offset:21504
    ds_read_b128 v[88:91], v246 offset:22528
    ds_read_b128 v[52:55], v246 offset:40960
    ds_read_b128 v[56:59], v246 offset:41984
    ds_read_b128 v[92:95], v246 offset:43008
    ds_read_b128 v[60:63], v246 offset:61440
    ds_read_b128 v[64:67], v246 offset:62464
    ds_read_b128 v[96:99], v246 offset:63488
    ds_read_u16 v224, v238 offset:0
    ds_read_u16 v225, v238 offset:8
    ds_read_u16 v226, v238 offset:64
    ds_read_u16 v227, v238 offset:72
    ds_write_b8 v164, v126
    ds_write_b8_d16_hi v165, v126
    ds_write_b8 v166, v127
    ds_write_b8_d16_hi v167, v127
    ds_write_b8 v168, v128
    ds_write_b8_d16_hi v169, v128
    ds_write_b8 v170, v129
    ds_write_b8_d16_hi v171, v129
    s_cmp_ge_u32 s54, 4
    s_cbranch_scc0 L_old3b
    s_call_b64 s[62:63], L_t23
L_old3b:
L_listed:
    s_and_b32 s55, s84, 0x40000000
    s_or_b32 s55, s55, s54
    s_bitset1_b32 s55, 31
    s_and_b32 s66, s74, 0x1ff
    s_lshl_b32 s66, s66, 3
    s_or_b32 s66, s66, s55
    s_and_b32 s67, s78, 0x1ff
    s_lshl_b32 s67, s67, 3
    s_or_b32 s67, s67, s55
    v_mov_b32 v132, s66
    v_mov_b32 v133, s44
    v_mov_b32 v134, s45
    v_mov_b32 v135, s46
    v_writelane_b32 v132, s67, 1
    v_writelane_b32 v133, s46, 1
    v_writelane_b32 v134, s47, 1
    v_writelane_b32 v135, s48, 1
    s_mov_b64 exec, 3
    ds_write_b128 v222, v[132:135] offset:14848
    s_mov_b64 exec, -1
    s_sub_u32 s68, s46, s44
    s_sub_u32 s69, s48, s46
    s_lshl_b32 s50, s54, 3
    s_mov_b32 s51, 0
    s_mov_b32 s33, 0
    s_sub_u32 s66, s64, s52
    s_sub_u32 s66, s66, 18448
    s_lshr_b32 s66, s66, 3
    s_lshr_b32 s67, s54, 2
    s_mul_i32 s67, s67, 2
    s_add_u32 s66, s66, s67
    s_sub_u32 s67, 0, s66
    v_mov_b32 v2, v221
    v_mov_b32 v1, s66
    v_mov_b32 v3, -8
    v_writelane_b32 v1, s67, 1
    v_writelane_b32 v3, 8, 1
    ds_add_u32 v2, v1
    v_bfrev_b32 v245, -2
    v_writelane_b32 v245, 0, 0
    s_cmp_eq_u32 s94, 1
    s_cbranch_scc1 L_nolate
    ds_read_u8 v148, v237 offset:0
    ds_read_u8 v149, v237 offset:8
    ds_read_u8 v150, v237 offset:16
    ds_read_u8 v151, v237 offset:24
    ds_read_u8 v152, v237 offset:32
    ds_read_u8 v153, v237 offset:40
    ds_read_u8 v154, v237 offset:48
    ds_read_u8 v155, v237 offset:56
    s_waitcnt lgkmcnt(0)
    s_add_u32 m0, s52, 0
    v_mov_b32 v230, v148
    v_mov_b32 v232, v149
    buffer_load_dwordx4 v[230:231], s[20:23], s35 idxen offen nt lds
    buffer_load_dwordx4 v[232:233], s[40:43], s35 idxen offen offset:1056 nt lds
    s_bitcmp0_b64 s[56:57], 2
    s_cbranch_scc1 L_noadvl1
    s_add_u32 s35, s35, s31
    s_min_u32 s35, s35, 419404800
    s_xor_b32 s31, s31, 0x63ff800
    s_sub_u32 s60, s60, 1
L_noadvl1:
    s_add_u32 m0, s52, 2080
    v_mov_b32 v230, v150
    v_mov_b32 v232, v151
    buffer_load_dwordx4 v[230:231], s[20:23], s35 idxen offen nt lds
    buffer_load_dwordx4 v[232:233], s[40:43], s35 idxen offen offset:1056 nt lds
    s_bitcmp0_b64 s[56:57], 3
    s_cbranch_scc1 L_noadvl2
    s_add_u32 s35, s35, s31
    s_min_u32 s35, s35, 419404800
    s_xor_b32 s31, s31, 0x63ff800
    s_sub_u32 s60, s60, 1
L_noadvl2:
    s_add_u32 m0, s52, 4160
    v_mov_b32 v230, v152
    v_mov_b32 v232, v153
    buffer_load_dwordx4 v[230:231], s[20:23], s35 idxen offen nt lds
    buffer_load_dwordx4 v[232:233], s[40:43], s35 idxen offen offset:1056 nt lds
    s_bitcmp0_b64 s[56:57], 4
    s_cbranch_scc1 L_noadvl3
    s_add_u32 s35, s35, s31
    s_min_u32 s35, s35, 419404800
    s_xor_b32 s31, s31, 0x63ff800
    s_sub_u32 s60, s60, 1
L_noadvl3:
    s_add_u32 m0, s52, 6240
    v_mov_b32 v230, v154
    v_mov_b32 v232, v155
    buffer_load_dwordx4 v[230:231], s[20:23], s35 idxen offen nt lds
    buffer_load_dwordx4 v[232:233], s[40:43], s35 idxen offen offset:1056 nt lds
L_nolate:
    v_and_b32_dpp v196, v216, v220 quad_perm:[0,0,0,0] row_mask:0xf bank_mask:0xf
    v_and_b32_dpp v197, v217, v220 quad_perm:[0,0,0,0] row_mask:0xf bank_mask:0xf
    v_and_b32_dpp v198, v216, v220 quad_perm:[1,1,1,1] row_mask:0xf bank_mask:0xf
    v_and_b32_dpp v199, v217, v220 quad_perm:[1,1,1,1] row_mask:0xf bank_mask:0xf
    v_and_b32_dpp v200, v216, v220 quad_perm:[2,2,2,2] row_mask:0xf bank_mask:0xf
    v_and_b32_dpp v201, v217, v220 quad_perm:[2,2,2,2] row_mask:0xf bank_mask:0xf
    v_and_b32_dpp v202, v216, v220 quad_perm:[3,3,3,3] row_mask:0xf bank_mask:0xf
    v_and_b32_dpp v203, v217, v220 quad_perm:[3,3,3,3] row_mask:0xf bank_mask:0xf
    s_waitcnt vmcnt(6) lgkmcnt(0)
    ds_read_b128 v[180:183], v234 offset:0
    ds_read_b128 v[184:187], v235 offset:0
    v_mul_u32_u24 v216, v224, v241
    v_mul_u32_u24 v217, v224, v242
    v_mul_u32_u24 v218, v225, v241
    v_mul_u32_u24 v219, v225, v242
    v_mul_u32_u24 v220, v226, v241
    v_mul_u32_u24 v221, v226, v242
    v_mul_u32_u24 v222, v227, v241
    v_mul_u32_u24 v223, v227, v242
    v_mfma_f32_4x4x4_16b_bf16 v[140:143], v[216:217], v[68:69], v[4:7]
    v_add_u32 v238, 128, v238
    ds_read_b128 v[164:167], v239 offset:0
    ds_read_b128 v[168:171], v239 offset:64
    v_mfma_f32_4x4x4_16b_bf16 v[144:147], v[218:219], v[70:71], v[8:11]
    ds_read_b128 v[172:175], v239 offset:128
    ds_read_b128 v[176:179], v239 offset:192
    ds_read_u16 v224, v238 offset:0
    ds_read_u16 v225, v238 offset:8
    ds_read_u16 v226, v238 offset:64
    ds_read_u16 v227, v238 offset:72
    v_mfma_f32_4x4x4_16b_bf16 v[246:249], v[220:221], v[72:73], v[12:15]
    v_cvt_pk_bf16_f32 v100, v140, v141
    v_cvt_pk_bf16_f32 v101, v142, v143
    v_mfma_f32_4x4x4_16b_bf16 v[250:253], v[222:223], v[74:75], v[16:19]
    v_cvt_pk_bf16_f32 v102, v144, v145
    v_cvt_pk_bf16_f32 v103, v146, v147
    v_mfma_f32_4x4x4_16b_bf16 v[140:143], v[216:217], v[76:77], v[20:23]
    v_cvt_pk_bf16_f32 v104, v246, v247
    v_cvt_pk_bf16_f32 v105, v248, v249
    v_mfma_f32_4x4x4_16b_bf16 v[144:147], v[218:219], v[78:79], v[24:27]
    v_cvt_pk_bf16_f32 v106, v250, v251
    v_cvt_pk_bf16_f32 v107, v252, v253
    v_mfma_f32_4x4x4_16b_bf16 v[246:249], v[220:221], v[80:81], v[28:31]
    v_cvt_pk_bf16_f32 v108, v140, v141
    v_cvt_pk_bf16_f32 v109, v142, v143
    v_mfma_f32_4x4x4_16b_bf16 v[250:253], v[222:223], v[82:83], v[32:35]
    v_cvt_pk_bf16_f32 v110, v144, v145
    v_cvt_pk_bf16_f32 v111, v146, v147
    v_mfma_f32_4x4x4_16b_bf16 v[140:143], v[216:217], v[84:85], v[36:39]
    v_cvt_pk_bf16_f32 v112, v246, v247
    v_cvt_pk_bf16_f32 v113, v248, v249
    v_mfma_f32_4x4x4_16b_bf16 v[144:147], v[218:219], v[86:87], v[40:43]
    v_cvt_pk_bf16_f32 v114, v250, v251
    v_cvt_pk_bf16_f32 v115, v252, v253
    v_mfma_f32_4x4x4_16b_bf16 v[246:249], v[220:221], v[88:89], v[44:47]
    v_cvt_pk_bf16_f32 v116, v140, v141
    v_cvt_pk_bf16_f32 v117, v142, v143
    v_mfma_f32_4x4x4_16b_bf16 v[250:253], v[222:223], v[90:91], v[48:51]
    v_cvt_pk_bf16_f32 v118, v144, v145
    v_cvt_pk_bf16_f32 v119, v146, v147
    v_mfma_f32_4x4x4_16b_bf16 v[140:143], v[216:217], v[92:93], v[52:55]
    v_cvt_pk_bf16_f32 v120, v246, v247
    v_cvt_pk_bf16_f32 v121, v248, v249
    v_mfma_f32_4x4x4_16b_bf16 v[144:147], v[218:219], v[94:95], v[56:59]
    v_cvt_pk_bf16_f32 v122, v250, v251
    v_cvt_pk_bf16_f32 v123, v252, v253
    v_mfma_f32_4x4x4_16b_bf16 v[246:249], v[220:221], v[96:97], v[60:63]
    v_cvt_pk_bf16_f32 v124, v140, v141
    v_cvt_pk_bf16_f32 v125, v142, v143
    v_mfma_f32_4x4x4_16b_bf16 v[250:253], v[222:223], v[98:99], v[64:67]
    v_cvt_pk_bf16_f32 v126, v144, v145
    v_cvt_pk_bf16_f32 v127, v146, v147
    v_cvt_pk_bf16_f32 v128, v246, v247
    v_cvt_pk_bf16_f32 v129, v248, v249
    v_add_u32 v239, 272, v239
    v_cvt_pk_bf16_f32 v130, v250, v251
    v_cvt_pk_bf16_f32 v131, v252, v253
    s_waitcnt lgkmcnt(0)
    v_mfma_f32_16x16x32_bf16 v[148:151], v[100:103], v[180:183], v[164:167]
    v_mfma_f32_16x16x32_bf16 v[148:151], v[104:107], v[184:187], v[148:151]
    v_mfma_f32_16x16x32_bf16 v[152:155], v[108:111], v[180:183], v[168:171]
    v_mfma_f32_16x16x32_bf16 v[152:155], v[112:115], v[184:187], v[152:155]
    v_mfma_f32_16x16x32_bf16 v[156:159], v[116:119], v[180:183], v[172:175]
    v_mfma_f32_16x16x32_bf16 v[156:159], v[120:123], v[184:187], v[156:159]
    v_mfma_f32_16x16x32_bf16 v[160:163], v[124:127], v[180:183], v[176:179]
    v_mfma_f32_16x16x32_bf16 v[160:163], v[128:131], v[184:187], v[160:163]
    v_mov_b32 v136, 0
    v_mov_b32 v137, 0
    v_mov_b32 v138, 0
    v_mov_b32 v139, 0
    s_lshr_b64 s[86:87], s[56:57], 2
    s_lshr_b64 s[36:37], s[56:57], 5
    s_or_b32 s37, s36, s86
    s_or_b32 s36, s37, s56
    s_cmp_lg_u64 s[84:85], 0
    s_cbranch_scc0 Lf_mid
    s_mul_i32 s66, s53, 800
    s_add_u32 s8, s8, s66
    s_addc_u32 s9, s9, 0
    s_mov_b32 s24, s8
    s_and_b32 s25, s9, 0xffff
    s_mov_b32 s26, 400
    s_mov_b32 s27, 0x20000
    s_movk_i32 s32, 400
    s_branch Ls_mid
L_fp:
    v_mfma_i32_16x16x64_i8 v[172:175], v[122:125], v[100:103], 0
    v_and_b32 v160, 0x800080, v100
    v_mul_u32_u24 v160, 0x7f, v160
    v_bitop3_b32 v131, v100, v160, v131 bitop3:0xbe
    v_and_b32 v161, 0x800080, v101
    v_mul_u32_u24 v161, 0x7f, v161
    v_bitop3_b32 v131, v101, v161, v131 bitop3:0xbe
    v_and_b32 v160, 0x800080, v102
    v_mul_u32_u24 v160, 0x7f, v160
    v_mov_b32_dpp v184, v172 row_shr:1 row_mask:0xf bank_mask:0xf bound_ctrl:0
    v_bitop3_b32 v131, v102, v160, v131 bitop3:0xbe
    s_nop 0
    v_add_u32_dpp v184, v184, v184 row_shr:1 row_mask:0xf bank_mask:0xf bound_ctrl:0
    v_and_b32 v161, 0x800080, v103
    s_nop 0
    v_add_u32_dpp v184, v184, v184 row_shr:2 row_mask:0xf bank_mask:0xf bound_ctrl:0
    v_mul_u32_u24 v161, 0x7f, v161
    s_nop 0
    v_add_u32_dpp v184, v184, v184 row_shr:4 row_mask:0xf bank_mask:0xf bound_ctrl:0
    v_bitop3_b32 v131, v103, v161, v131 bitop3:0xbe
    s_nop 0
    v_add_u32_dpp v184, v184, v184 row_shr:8 row_mask:0xf bank_mask:0xf bound_ctrl:0
    v_cmp_ne_u32 vcc, 0, v131
    v_readlane_b32 s68, v184, 6
    v_readlane_b32 s69, v173, 6
    v_readlane_b32 s70, v184, 15
    s_mov_b32 s94, 0
    s_cbranch_vccnz L_late
    s_add_u32 s66, s68, s69
    s_add_u32 s66, s66, s64
    s_add_u32 s67, s66, 15
    s_and_b32 s67, s67, -16
    s_add_u32 s55, s64, 16
    s_max_u32 s67, s67, s55
    s_sub_u32 s66, s67, s66
    v_mad_u32_u24 v184, v130, s66, v184
    s_sub_u32 s55, s64, 2048
    v_add_u32 v172, s55, v184
    v_add_u32 v173, s55, v184
    v_add_u32 v174, s55, v184
    v_add_u32 v175, s55, v184
    s_add_u32 s64, s64, s70
    s_add_u32 s64, s64, s66
    v_mfma_i32_16x16x64_i8 v[132:135], v[118:121], v[100:103], v[172:175]
    v_mfma_i32_16x16x64_i8 v[136:139], v[116:119], v[100:103], v[172:175]
    s_add_u32 s64, s64, 15
    s_and_b32 s64, s64, -16
    s_add_u32 s55, s67, 16
    s_max_u32 s64, s64, s55
    s_lshr_b32 s95, s67, 4
    s_bitset1_b64 s[56:57], s95
    s_lshr_b32 s95, s64, 4
    s_bitset1_b64 s[56:57], s95
    s_add_u32 s66, s52, 18512
    s_cmp_ge_u32 s64, s66
    ds_write_b8 v132, v126
    ds_write_b8_d16_hi v133, v126
    ds_write_b8 v134, v127
    ds_write_b8_d16_hi v135, v127
    ds_write_b8 v136, v128
    ds_write_b8_d16_hi v137, v128
    ds_write_b8 v138, v129
    ds_write_b8_d16_hi v139, v129
    s_cbranch_scc0 L_late
    s_mov_b32 s94, 1
    ds_read_u8 v148, v237 offset:0
    ds_read_u8 v149, v237 offset:8
    ds_read_u8 v150, v237 offset:16
    ds_read_u8 v151, v237 offset:24
    ds_read_u8 v152, v237 offset:32
    ds_read_u8 v153, v237 offset:40
    ds_read_u8 v154, v237 offset:48
    ds_read_u8 v155, v237 offset:56
    s_waitcnt lgkmcnt(0)
    s_add_u32 m0, s52, 0
    v_mov_b32 v230, v148
    v_mov_b32 v232, v149
    buffer_load_dwordx4 v[230:231], s[20:23], s35 idxen offen nt lds
    buffer_load_dwordx4 v[232:233], s[40:43], s35 idxen offen offset:1056 nt lds
    s_bitcmp0_b64 s[56:57], 2
    s_cbranch_scc1 L_noadve1
    s_add_u32 s35, s35, s31
    s_min_u32 s35, s35, 419404800
    s_xor_b32 s31, s31, 0x63ff800
    s_sub_u32 s60, s60, 1
L_noadve1:
    s_add_u32 m0, s52, 2080
    v_mov_b32 v230, v150
    v_mov_b32 v232, v151
    buffer_load_dwordx4 v[230:231], s[20:23], s35 idxen offen nt lds
    buffer_load_dwordx4 v[232:233], s[40:43], s35 idxen offen offset:1056 nt lds
    s_setpc_b64 s[62:63]
L_late:
    s_waitcnt vmcnt(0)
    s_setpc_b64 s[62:63]
L_swap:
    v_lshrrev_b32 v140, 3, v0
    v_and_b32 v141, 7, v0
    v_mul_u32_u24 v140, 20480, v140
    v_mul_u32_u24 v141, 20480, v141
    v_add_u32 v140, s51, v140
    v_add_u32 v141, s51, v141
    v_mov_b32 v143, 1
    s_mov_b64 exec, 1
    ds_add_rtn_u32 v143, v140, v143 offset:14880
    s_mov_b64 exec, -1
L_swap_poll:
    ds_read_b32 v142, v141 offset:14848
    ds_read_b128 v[144:147], v140 offset:14848
    v_and_b32 v248, 56, v0
    s_waitcnt lgkmcnt(0)
    v_cmp_le_i32 vcc, 0, v142
    v_cmp_gt_u32 s[86:87], v142, v144
    v_lshlrev_b32 v249, 1, v142
    v_readfirstlane_b32 s66, v143
    s_cbranch_vccnz L_swap_poll
    v_lshrrev_b64 v[246:247], v248, s[86:87]
    v_cmp_gt_i32 s[88:89], 0, v249
    v_and_b32 v246, 0xff, v246
    v_bcnt_u32_b32 v246, v246, 0
    v_cmp_eq_u32 vcc, s66, v246
    s_lshl_b32 s67, s54, 3
    s_ff1_i32_b64 s66, vcc
    s_cmp_lg_u64 s[88:89], 0
    s_cselect_b32 s66, s67, s66
    s_sub_u32 s95, s66, s50
    s_mov_b32 s50, s66
    s_sub_u32 s83, s66, s67
    v_readlane_b32 s67, v146, s66
    v_readlane_b32 s55, v147, s66
    v_readlane_b32 s66, v145, s66
    s_mul_i32 s81, s95, 2560
    s_mul_i32 s95, s95, 6400
    s_add_u32 s35, s35, s95
    s_sub_u32 s95, s66, s44
    v_add_u32 v237, s95, v237
    s_mov_b32 s44, s55
    s_sub_u32 s67, s67, s66
    s_sub_u32 s55, s55, s66
    s_sub_u32 s95, s55, s68
    s_lshr_b32 s67, s67, 4
    s_add_u32 s67, s67, s49
    s_bitset1_b64 s[56:57], s67
    s_lshr_b32 s55, s55, 4
    s_add_u32 s55, s55, s49
    s_bitset1_b64 s[56:57], s55
    s_lshr_b64 s[86:87], s[56:57], 2
    s_lshr_b64 s[36:37], s[56:57], 5
    s_or_b32 s37, s36, s86
    s_or_b32 s36, s37, s56
    s_ashr_i32 s95, s95, 3
    v_mov_b32 v140, s95
    s_sub_u32 s95, 0, s95
    v_writelane_b32 v140, s95, 1
    ds_add_u32 v2, v140
    s_cmp_eq_u32 s51, 0
    s_cselect_b32 s80, s81, s80
    s_cselect_b32 s82, s83, s82
    s_cselect_b32 s60, 1, 8
    s_cselect_b32 s66, 4, 2
    s_mov_b32 s68, s69
    s_mov_b32 s51, 16
    s_cmp_eq_u32 s61, s66
    s_cbranch_scc1 L_swap_now
    s_sub_u32 s66, s66, 1
    s_bitset1_b32 s33, s66
    s_setpc_b64 s[62:63]
L_swap_now:
    v_add_u32 v238, s81, v238
    v_add_u32 v239, s81, v239
    ds_read_u16 v224, v238 offset:0
    ds_read_u16 v225, v238 offset:8
    ds_read_u16 v226, v238 offset:64
    ds_read_u16 v227, v238 offset:72
    s_setpc_b64 s[62:63]
L_t23:
    s_cmp_eq_u32 s94, 0
    s_cbranch_scc1 L_skip23
    s_bitcmp0_b64 s[56:57], 3
    s_cbranch_scc1 L_noadve2
    s_add_u32 s35, s35, s31
    s_min_u32 s35, s35, 419404800
    s_xor_b32 s31, s31, 0x63ff800
    s_sub_u32 s60, s60, 1
L_noadve2:
    s_add_u32 m0, s52, 4160
    v_mov_b32 v230, v152
    v_mov_b32 v232, v153
    buffer_load_dwordx4 v[230:231], s[20:23], s35 idxen offen nt lds
    buffer_load_dwordx4 v[232:233], s[40:43], s35 idxen offen offset:1056 nt lds
    s_bitcmp0_b64 s[56:57], 4
    s_cbranch_scc1 L_noadve3
    s_add_u32 s35, s35, s31
    s_min_u32 s35, s35, 419404800
    s_xor_b32 s31, s31, 0x63ff800
    s_sub_u32 s60, s60, 1
L_noadve3:
    s_add_u32 m0, s52, 6240
    v_mov_b32 v230, v154
    v_mov_b32 v232, v155
    buffer_load_dwordx4 v[230:231], s[20:23], s35 idxen offen nt lds
    buffer_load_dwordx4 v[232:233], s[40:43], s35 idxen offen offset:1056 nt lds
    s_setpc_b64 s[62:63]
L_skip23:
    s_waitcnt vmcnt(0)
    s_setpc_b64 s[62:63]
.p2align 6
Lf_loop:
Lf_mid:
    s_bitcmp1_b32 s36, 0
    s_cbranch_scc1 Lf_ev0
Lf_evd0:
    v_mfma_f32_16x16x32_bf16 v[208:211], v[136:139], v[200:203], v[208:211]
    v_exp_f32 v132, v148
    v_exp_f32 v133, v149
    v_exp_f32 v134, v150
    v_exp_f32 v135, v151
    v_exp_f32 v136, v152
    v_exp_f32 v137, v153
    v_mfma_f32_4x4x4_16b_bf16 v[132:135], v[228:229], v[228:229], v[132:135]
    v_exp_f32 v138, v154
    v_exp_f32 v139, v155
    v_cvt_pk_bf16_f32 v208, v208, v209
    v_cvt_pk_bf16_f32 v209, v210, v211
    v_exp_f32 v140, v156
    v_exp_f32 v141, v157
    v_mfma_f32_4x4x4_16b_bf16 v[212:215], v[208:209], v[188:189], v[212:215] cbsz:4 abid:0
    v_mfma_f32_4x4x4_16b_bf16 v[136:139], v[228:229], v[228:229], v[136:139]
    v_exp_f32 v142, v158
    v_mfma_f32_4x4x4_16b_bf16 v[212:215], v[208:209], v[190:191], v[212:215] cbsz:4 abid:4
    v_exp_f32 v143, v159
    v_exp_f32 v144, v160
    v_mfma_f32_4x4x4_16b_bf16 v[212:215], v[208:209], v[192:193], v[212:215] cbsz:4 abid:8
    v_exp_f32 v145, v161
    v_mfma_f32_4x4x4_16b_bf16 v[140:143], v[228:229], v[228:229], v[140:143]
    v_mfma_f32_4x4x4_16b_bf16 v[212:215], v[208:209], v[194:195], v[212:215] cbsz:4 abid:12
    ds_add_rtn_u32 v1, v2, v3
    ds_read_u8 v230, v237 offset:64
    ds_read_u8 v232, v237 offset:72
    ds_read_b64_tr_b16 v[188:189], v236 offset:0
    ds_read_b64_tr_b16 v[190:191], v236 offset:512
    ds_read_b64_tr_b16 v[192:193], v236 offset:1056
    ds_read_b64_tr_b16 v[194:195], v236 offset:1568
    s_waitcnt vmcnt(4)
    ds_read_b128 v[180:183], v234 offset:2080
    ds_read_b128 v[184:187], v235 offset:2080
    s_add_u32 m0, s52, 0
    v_exp_f32 v146, v162
    v_exp_f32 v147, v163
    v_rcp_f32 v132, v132
    v_rcp_f32 v133, v133
    v_mfma_f32_4x4x4_16b_bf16 v[144:147], v[228:229], v[228:229], v[144:147]
    v_rcp_f32 v134, v134
    v_cvt_pk_bf16_f32 v132, v132, v133
    s_waitcnt lgkmcnt(2)
    buffer_load_dwordx4 v[230:231], s[20:23], s35 idxen offen nt lds
    buffer_load_dwordx4 v[232:233], s[40:43], s35 idxen offen offset:1056 nt lds
    s_waitcnt lgkmcnt(0)
    v_mfma_f32_16x16x32_bf16 v[148:151], v[100:103], v[180:183], v[164:167]
    v_rcp_f32 v135, v135
    v_mfma_f32_16x16x32_bf16 v[152:155], v[108:111], v[180:183], v[168:171]
    v_rcp_f32 v136, v136
    v_cvt_pk_bf16_f32 v133, v134, v135
    v_mfma_f32_16x16x32_bf16 v[148:151], v[104:107], v[184:187], v[148:151]
    v_rcp_f32 v137, v137
    v_cmp_gt_i32 vcc, v1, v245
    s_setprio 0
    s_cbranch_vccz Lf_lo0
    s_setprio 1
Lf_lo0:
    v_mfma_f32_16x16x32_bf16 v[152:155], v[112:115], v[184:187], v[152:155]
    v_rcp_f32 v138, v138
    v_cvt_pk_bf16_f32 v134, v136, v137
    v_mfma_f32_16x16x32_bf16 v[156:159], v[116:119], v[180:183], v[172:175]
    v_rcp_f32 v139, v139
    v_mfma_f32_16x16x32_bf16 v[160:163], v[124:127], v[180:183], v[176:179]
    v_rcp_f32 v140, v140
    v_cvt_pk_bf16_f32 v135, v138, v139
    v_mfma_f32_16x16x32_bf16 v[156:159], v[120:123], v[184:187], v[156:159]
    v_rcp_f32 v141, v141
    v_mfma_f32_16x16x32_bf16 v[160:163], v[128:131], v[184:187], v[160:163]
    v_rcp_f32 v142, v142
    v_cvt_pk_bf16_f32 v136, v140, v141
    v_mfma_f32_16x16x32_bf16 v[208:211], v[132:135], v[196:199], v[204:207]
    v_rcp_f32 v143, v143
    v_rcp_f32 v144, v144
    v_cvt_pk_bf16_f32 v137, v142, v143
    v_rcp_f32 v145, v145
    v_rcp_f32 v146, v146
    v_rcp_f32 v147, v147
    v_cvt_pk_bf16_f32 v138, v144, v145
    v_cvt_pk_bf16_f32 v139, v146, v147
    s_bitcmp1_b32 s36, 1
    s_cbranch_scc1 Lf_ev1
Lf_evd1:
    v_mfma_f32_16x16x32_bf16 v[208:211], v[136:139], v[200:203], v[208:211]
    v_exp_f32 v132, v148
    v_exp_f32 v133, v149
    v_exp_f32 v134, v150
    v_exp_f32 v135, v151
    v_exp_f32 v136, v152
    v_exp_f32 v137, v153
    v_mfma_f32_4x4x4_16b_bf16 v[132:135], v[228:229], v[228:229], v[132:135]
    v_exp_f32 v138, v154
    v_exp_f32 v139, v155
    v_cvt_pk_bf16_f32 v208, v208, v209
    v_cvt_pk_bf16_f32 v209, v210, v211
    v_exp_f32 v140, v156
    v_exp_f32 v141, v157
    v_mfma_f32_4x4x4_16b_bf16 v[212:215], v[208:209], v[188:189], v[212:215] cbsz:4 abid:0
    v_mfma_f32_4x4x4_16b_bf16 v[136:139], v[228:229], v[228:229], v[136:139]
    v_exp_f32 v142, v158
    v_mfma_f32_4x4x4_16b_bf16 v[212:215], v[208:209], v[190:191], v[212:215] cbsz:4 abid:4
    v_exp_f32 v143, v159
    v_exp_f32 v144, v160
    v_mfma_f32_4x4x4_16b_bf16 v[212:215], v[208:209], v[192:193], v[212:215] cbsz:4 abid:8
    v_exp_f32 v145, v161
    v_mfma_f32_4x4x4_16b_bf16 v[140:143], v[228:229], v[228:229], v[140:143]
    v_mfma_f32_4x4x4_16b_bf16 v[212:215], v[208:209], v[194:195], v[212:215] cbsz:4 abid:12
    ds_read_u8 v230, v237 offset:80
    ds_read_u8 v232, v237 offset:88
    ds_read_b64_tr_b16 v[188:189], v236 offset:2080
    ds_read_b64_tr_b16 v[190:191], v236 offset:2592
    ds_read_b64_tr_b16 v[192:193], v236 offset:3136
    ds_read_b64_tr_b16 v[194:195], v236 offset:3648
    s_waitcnt vmcnt(4)
    ds_read_b128 v[180:183], v234 offset:4160
    ds_read_b128 v[184:187], v235 offset:4160
    s_add_u32 m0, s52, 2080
    v_exp_f32 v146, v162
    v_exp_f32 v147, v163
    v_rcp_f32 v132, v132
    v_rcp_f32 v133, v133
    v_mfma_f32_4x4x4_16b_bf16 v[144:147], v[228:229], v[228:229], v[144:147]
    v_rcp_f32 v134, v134
    v_cvt_pk_bf16_f32 v132, v132, v133
    s_waitcnt lgkmcnt(2)
    buffer_load_dwordx4 v[230:231], s[20:23], s35 idxen offen nt lds
    buffer_load_dwordx4 v[232:233], s[40:43], s35 idxen offen offset:1056 nt lds
    s_waitcnt lgkmcnt(0)
    v_mfma_f32_16x16x32_bf16 v[148:151], v[100:103], v[180:183], v[164:167]
    v_rcp_f32 v135, v135
    v_mfma_f32_16x16x32_bf16 v[152:155], v[108:111], v[180:183], v[168:171]
    v_rcp_f32 v136, v136
    v_cvt_pk_bf16_f32 v133, v134, v135
    v_mfma_f32_16x16x32_bf16 v[148:151], v[104:107], v[184:187], v[148:151]
    v_rcp_f32 v137, v137
    v_mfma_f32_16x16x32_bf16 v[152:155], v[112:115], v[184:187], v[152:155]
    v_rcp_f32 v138, v138
    v_cvt_pk_bf16_f32 v134, v136, v137
    v_mfma_f32_16x16x32_bf16 v[156:159], v[116:119], v[180:183], v[172:175]
    v_rcp_f32 v139, v139
    v_mfma_f32_16x16x32_bf16 v[160:163], v[124:127], v[180:183], v[176:179]
    v_rcp_f32 v140, v140
    v_cvt_pk_bf16_f32 v135, v138, v139
    v_mfma_f32_16x16x32_bf16 v[156:159], v[120:123], v[184:187], v[156:159]
    v_rcp_f32 v141, v141
    v_mfma_f32_16x16x32_bf16 v[160:163], v[128:131], v[184:187], v[160:163]
    v_rcp_f32 v142, v142
    v_cvt_pk_bf16_f32 v136, v140, v141
    v_mfma_f32_16x16x32_bf16 v[208:211], v[132:135], v[196:199], v[204:207]
    v_rcp_f32 v143, v143
    v_rcp_f32 v144, v144
    v_cvt_pk_bf16_f32 v137, v142, v143
    v_rcp_f32 v145, v145
    v_rcp_f32 v146, v146
    v_rcp_f32 v147, v147
    v_cvt_pk_bf16_f32 v138, v144, v145
    v_cvt_pk_bf16_f32 v139, v146, v147
    s_bitcmp1_b32 s36, 2
    s_cbranch_scc1 Lf_ev2
Lf_evd2:
    v_mfma_f32_16x16x32_bf16 v[208:211], v[136:139], v[200:203], v[208:211]
    v_exp_f32 v132, v148
    v_exp_f32 v133, v149
    v_exp_f32 v134, v150
    v_exp_f32 v135, v151
    v_exp_f32 v136, v152
    v_exp_f32 v137, v153
    v_mfma_f32_4x4x4_16b_bf16 v[132:135], v[228:229], v[228:229], v[132:135]
    v_exp_f32 v138, v154
    v_exp_f32 v139, v155
    v_cvt_pk_bf16_f32 v208, v208, v209
    v_cvt_pk_bf16_f32 v209, v210, v211
    v_exp_f32 v140, v156
    v_exp_f32 v141, v157
    v_mfma_f32_4x4x4_16b_bf16 v[212:215], v[208:209], v[188:189], v[212:215] cbsz:4 abid:0
    v_mfma_f32_4x4x4_16b_bf16 v[136:139], v[228:229], v[228:229], v[136:139]
    v_exp_f32 v142, v158
    v_mfma_f32_4x4x4_16b_bf16 v[212:215], v[208:209], v[190:191], v[212:215] cbsz:4 abid:4
    v_exp_f32 v143, v159
    v_exp_f32 v144, v160
    v_mfma_f32_4x4x4_16b_bf16 v[212:215], v[208:209], v[192:193], v[212:215] cbsz:4 abid:8
    v_exp_f32 v145, v161
    v_mfma_f32_4x4x4_16b_bf16 v[140:143], v[228:229], v[228:229], v[140:143]
    v_mfma_f32_4x4x4_16b_bf16 v[212:215], v[208:209], v[194:195], v[212:215] cbsz:4 abid:12
    ds_read_u8 v230, v237 offset:96
    ds_read_u8 v232, v237 offset:104
    ds_read_b64_tr_b16 v[188:189], v236 offset:4160
    ds_read_b64_tr_b16 v[190:191], v236 offset:4672
    ds_read_b64_tr_b16 v[192:193], v236 offset:5216
    ds_read_b64_tr_b16 v[194:195], v236 offset:5728
    s_waitcnt vmcnt(4)
    ds_read_b128 v[180:183], v234 offset:6240
    ds_read_b128 v[184:187], v235 offset:6240
    s_add_u32 m0, s52, 4160
    v_exp_f32 v146, v162
    v_exp_f32 v147, v163
    v_rcp_f32 v132, v132
    v_rcp_f32 v133, v133
    v_mfma_f32_4x4x4_16b_bf16 v[144:147], v[228:229], v[228:229], v[144:147]
    v_rcp_f32 v134, v134
    v_cvt_pk_bf16_f32 v132, v132, v133
    s_waitcnt lgkmcnt(2)
    buffer_load_dwordx4 v[230:231], s[20:23], s35 idxen offen nt lds
    buffer_load_dwordx4 v[232:233], s[40:43], s35 idxen offen offset:1056 nt lds
    s_waitcnt lgkmcnt(0)
    v_mfma_f32_16x16x32_bf16 v[148:151], v[100:103], v[180:183], v[164:167]
    v_rcp_f32 v135, v135
    v_mfma_f32_16x16x32_bf16 v[152:155], v[108:111], v[180:183], v[168:171]
    v_rcp_f32 v136, v136
    v_cvt_pk_bf16_f32 v133, v134, v135
    v_mfma_f32_16x16x32_bf16 v[148:151], v[104:107], v[184:187], v[148:151]
    v_rcp_f32 v137, v137
    v_mfma_f32_16x16x32_bf16 v[152:155], v[112:115], v[184:187], v[152:155]
    v_rcp_f32 v138, v138
    v_cvt_pk_bf16_f32 v134, v136, v137
    v_mfma_f32_16x16x32_bf16 v[156:159], v[116:119], v[180:183], v[172:175]
    v_rcp_f32 v139, v139
    v_mfma_f32_16x16x32_bf16 v[160:163], v[124:127], v[180:183], v[176:179]
    v_rcp_f32 v140, v140
    v_cvt_pk_bf16_f32 v135, v138, v139
    v_mfma_f32_16x16x32_bf16 v[156:159], v[120:123], v[184:187], v[156:159]
    v_rcp_f32 v141, v141
    v_mfma_f32_16x16x32_bf16 v[160:163], v[128:131], v[184:187], v[160:163]
    v_rcp_f32 v142, v142
    v_cvt_pk_bf16_f32 v136, v140, v141
    v_mfma_f32_16x16x32_bf16 v[208:211], v[132:135], v[196:199], v[204:207]
    v_rcp_f32 v143, v143
    v_rcp_f32 v144, v144
    v_cvt_pk_bf16_f32 v137, v142, v143
    v_rcp_f32 v145, v145
    v_rcp_f32 v146, v146
    v_rcp_f32 v147, v147
    v_cvt_pk_bf16_f32 v138, v144, v145
    v_cvt_pk_bf16_f32 v139, v146, v147
    s_bitcmp1_b32 s36, 3
    s_cbranch_scc1 Lf_ev3
Lf_evd3:
    v_mfma_f32_16x16x32_bf16 v[208:211], v[136:139], v[200:203], v[208:211]
    v_exp_f32 v132, v148
    v_exp_f32 v133, v149
    v_exp_f32 v134, v150
    v_exp_f32 v135, v151
    v_exp_f32 v136, v152
    v_exp_f32 v137, v153
    v_mfma_f32_4x4x4_16b_bf16 v[132:135], v[228:229], v[228:229], v[132:135]
    v_exp_f32 v138, v154
    v_exp_f32 v139, v155
    v_cvt_pk_bf16_f32 v208, v208, v209
    v_cvt_pk_bf16_f32 v209, v210, v211
    v_exp_f32 v140, v156
    v_exp_f32 v141, v157
    v_mfma_f32_4x4x4_16b_bf16 v[212:215], v[208:209], v[188:189], v[212:215] cbsz:4 abid:0
    v_mfma_f32_4x4x4_16b_bf16 v[136:139], v[228:229], v[228:229], v[136:139]
    v_exp_f32 v142, v158
    v_mfma_f32_4x4x4_16b_bf16 v[212:215], v[208:209], v[190:191], v[212:215] cbsz:4 abid:4
    v_exp_f32 v143, v159
    v_exp_f32 v144, v160
    v_mfma_f32_4x4x4_16b_bf16 v[212:215], v[208:209], v[192:193], v[212:215] cbsz:4 abid:8
    v_exp_f32 v145, v161
    v_mfma_f32_4x4x4_16b_bf16 v[140:143], v[228:229], v[228:229], v[140:143]
    v_mfma_f32_4x4x4_16b_bf16 v[212:215], v[208:209], v[194:195], v[212:215] cbsz:4 abid:12
    ds_read_u8 v230, v237 offset:112
    ds_read_u8 v232, v237 offset:120
    ds_read_b64_tr_b16 v[188:189], v236 offset:6240
    ds_read_b64_tr_b16 v[190:191], v236 offset:6752
    ds_read_b64_tr_b16 v[192:193], v236 offset:7296
    ds_read_b64_tr_b16 v[194:195], v236 offset:7808
    s_waitcnt vmcnt(4)
    ds_read_b128 v[180:183], v234 offset:0
    ds_read_b128 v[184:187], v235 offset:0
    s_add_u32 m0, s52, 6240
    v_exp_f32 v146, v162
    v_exp_f32 v147, v163
    v_rcp_f32 v132, v132
    v_rcp_f32 v133, v133
    v_mfma_f32_4x4x4_16b_bf16 v[144:147], v[228:229], v[228:229], v[144:147]
    v_rcp_f32 v134, v134
    v_cvt_pk_bf16_f32 v132, v132, v133
    s_waitcnt lgkmcnt(2)
    buffer_load_dwordx4 v[230:231], s[20:23], s35 idxen offen nt lds
    buffer_load_dwordx4 v[232:233], s[40:43], s35 idxen offen offset:1056 nt lds
    s_waitcnt lgkmcnt(0)
    v_mfma_f32_16x16x32_bf16 v[148:151], v[100:103], v[180:183], v[164:167]
    v_rcp_f32 v135, v135
    v_mfma_f32_16x16x32_bf16 v[152:155], v[108:111], v[180:183], v[168:171]
    v_rcp_f32 v136, v136
    v_cvt_pk_bf16_f32 v133, v134, v135
    v_mfma_f32_16x16x32_bf16 v[148:151], v[104:107], v[184:187], v[148:151]
    v_rcp_f32 v137, v137
    v_mfma_f32_16x16x32_bf16 v[152:155], v[112:115], v[184:187], v[152:155]
    v_rcp_f32 v138, v138
    v_cvt_pk_bf16_f32 v134, v136, v137
    v_mfma_f32_16x16x32_bf16 v[156:159], v[116:119], v[180:183], v[172:175]
    v_rcp_f32 v139, v139
    v_mfma_f32_16x16x32_bf16 v[160:163], v[124:127], v[180:183], v[176:179]
    v_rcp_f32 v140, v140
    v_cvt_pk_bf16_f32 v135, v138, v139
    v_mfma_f32_16x16x32_bf16 v[156:159], v[120:123], v[184:187], v[156:159]
    v_rcp_f32 v141, v141
    v_mfma_f32_16x16x32_bf16 v[160:163], v[128:131], v[184:187], v[160:163]
    v_rcp_f32 v142, v142
    v_cvt_pk_bf16_f32 v136, v140, v141
    v_mfma_f32_16x16x32_bf16 v[208:211], v[132:135], v[196:199], v[204:207]
    v_rcp_f32 v143, v143
    v_rcp_f32 v144, v144
    v_cvt_pk_bf16_f32 v137, v142, v143
    s_lshr_b64 s[56:57], s[56:57], 4
    s_lshr_b64 s[86:87], s[56:57], 2
    s_lshr_b64 s[36:37], s[56:57], 5
    s_or_b32 s37, s36, s86
    s_or_b32 s36, s37, s56
    v_add_u32 v237, 64, v237
    v_rcp_f32 v145, v145
    v_rcp_f32 v146, v146
    v_rcp_f32 v147, v147
    v_cvt_pk_bf16_f32 v138, v144, v145
    v_cvt_pk_bf16_f32 v139, v146, v147
    s_branch Lf_loop
Lf_fl0:
    v_cvt_pk_bf16_f32 v246, v212, v212
    v_mov_b32 v212, 0
    ds_write_b16 v240, v246
    v_add_u32 v240, 128, v240
    s_bitcmp0_b32 s37, 0
    s_cbranch_scc1 Lf_evd0
    s_branch Lf_ev20
Lf_ev0:
    s_bitcmp1_b64 s[56:57], 0
    s_cbranch_scc1 Lf_fl0
Lf_ev20:
    s_bitcmp1_b64 s[56:57], 2
    s_cbranch_scc1 Lf_w0
    s_sub_u32 s60, s60, 1
    s_cbranch_scc0 Lf_nsa0
    s_mov_b32 s49, 5
    s_call_b64 s[62:63], L_swap
Lf_nsa0:
    s_add_u32 s35, s35, s31
    s_min_u32 s35, s35, 419404800
    s_xor_b32 s31, s31, 0x63ff800
    s_branch Lf_evd0
Lf_w0:
    s_bitcmp0_b64 s[56:57], 5
    s_cbranch_scc1 Lf_e10
    s_sub_u32 s60, s60, 1
    s_cbranch_scc0 Lf_nsb0
    s_mov_b32 s49, 5
    s_call_b64 s[62:63], L_swap
    s_waitcnt lgkmcnt(0)
Lf_nsb0:
    s_add_u32 s35, s35, s31
    s_min_u32 s35, s35, 419404800
    s_xor_b32 s31, s31, 0x63ff800
Lf_e10:
    s_sub_u32 s61, s61, 1
    s_cbranch_scc1 Lf_last0
    s_bitcmp0_b32 s33, s61
    s_cbranch_scc1 Lf_nw0
    s_cmp_eq_u32 s61, 3
    s_cselect_b32 s66, s80, s81
    v_add_u32 v238, s66, v238
    v_add_u32 v239, s66, v239
    ds_read_u16 v224, v238 offset:0
    ds_read_u16 v225, v238 offset:8
    ds_read_u16 v226, v238 offset:64
    ds_read_u16 v227, v238 offset:72
    s_waitcnt lgkmcnt(0)
Lf_nw0:
    v_mul_u32_u24 v216, v224, v241
    v_mul_u32_u24 v217, v224, v242
    v_mul_u32_u24 v218, v225, v241
    v_mul_u32_u24 v219, v225, v242
    v_mul_u32_u24 v220, v226, v241
    v_mul_u32_u24 v221, v226, v242
    v_mul_u32_u24 v222, v227, v241
    v_mul_u32_u24 v223, v227, v242
    v_mfma_f32_4x4x4_16b_bf16 v[140:143], v[216:217], v[68:69], v[4:7]
    v_add_u32 v238, 128, v238
    ds_read_b128 v[164:167], v239 offset:0
    ds_read_b128 v[168:171], v239 offset:64
    v_mfma_f32_4x4x4_16b_bf16 v[144:147], v[218:219], v[70:71], v[8:11]
    ds_read_b128 v[172:175], v239 offset:128
    ds_read_b128 v[176:179], v239 offset:192
    ds_read_u16 v224, v238 offset:0
    ds_read_u16 v225, v238 offset:8
    ds_read_u16 v226, v238 offset:64
    ds_read_u16 v227, v238 offset:72
    v_mfma_f32_4x4x4_16b_bf16 v[246:249], v[220:221], v[72:73], v[12:15]
    v_cvt_pk_bf16_f32 v100, v140, v141
    v_cvt_pk_bf16_f32 v101, v142, v143
    v_mfma_f32_4x4x4_16b_bf16 v[250:253], v[222:223], v[74:75], v[16:19]
    v_cvt_pk_bf16_f32 v102, v144, v145
    v_cvt_pk_bf16_f32 v103, v146, v147
    v_mfma_f32_4x4x4_16b_bf16 v[140:143], v[216:217], v[76:77], v[20:23]
    v_cvt_pk_bf16_f32 v104, v246, v247
    v_cvt_pk_bf16_f32 v105, v248, v249
    v_mfma_f32_4x4x4_16b_bf16 v[144:147], v[218:219], v[78:79], v[24:27]
    v_cvt_pk_bf16_f32 v106, v250, v251
    v_cvt_pk_bf16_f32 v107, v252, v253
    v_mfma_f32_4x4x4_16b_bf16 v[246:249], v[220:221], v[80:81], v[28:31]
    v_cvt_pk_bf16_f32 v108, v140, v141
    v_cvt_pk_bf16_f32 v109, v142, v143
    v_mfma_f32_4x4x4_16b_bf16 v[250:253], v[222:223], v[82:83], v[32:35]
    v_cvt_pk_bf16_f32 v110, v144, v145
    v_cvt_pk_bf16_f32 v111, v146, v147
    v_mfma_f32_4x4x4_16b_bf16 v[140:143], v[216:217], v[84:85], v[36:39]
    v_cvt_pk_bf16_f32 v112, v246, v247
    v_cvt_pk_bf16_f32 v113, v248, v249
    v_mfma_f32_4x4x4_16b_bf16 v[144:147], v[218:219], v[86:87], v[40:43]
    v_cvt_pk_bf16_f32 v114, v250, v251
    v_cvt_pk_bf16_f32 v115, v252, v253
    v_mfma_f32_4x4x4_16b_bf16 v[246:249], v[220:221], v[88:89], v[44:47]
    v_cvt_pk_bf16_f32 v116, v140, v141
    v_cvt_pk_bf16_f32 v117, v142, v143
    v_mfma_f32_4x4x4_16b_bf16 v[250:253], v[222:223], v[90:91], v[48:51]
    v_cvt_pk_bf16_f32 v118, v144, v145
    v_cvt_pk_bf16_f32 v119, v146, v147
    v_mfma_f32_4x4x4_16b_bf16 v[140:143], v[216:217], v[92:93], v[52:55]
    v_cvt_pk_bf16_f32 v120, v246, v247
    v_cvt_pk_bf16_f32 v121, v248, v249
    v_mfma_f32_4x4x4_16b_bf16 v[144:147], v[218:219], v[94:95], v[56:59]
    v_cvt_pk_bf16_f32 v122, v250, v251
    v_cvt_pk_bf16_f32 v123, v252, v253
    v_mfma_f32_4x4x4_16b_bf16 v[246:249], v[220:221], v[96:97], v[60:63]
    v_cvt_pk_bf16_f32 v124, v140, v141
    v_cvt_pk_bf16_f32 v125, v142, v143
    v_mfma_f32_4x4x4_16b_bf16 v[250:253], v[222:223], v[98:99], v[64:67]
    v_cvt_pk_bf16_f32 v126, v144, v145
    v_cvt_pk_bf16_f32 v127, v146, v147
    v_cvt_pk_bf16_f32 v128, v246, v247
    v_cvt_pk_bf16_f32 v129, v248, v249
    v_add_u32 v239, 272, v239
    v_cvt_pk_bf16_f32 v130, v250, v251
    v_cvt_pk_bf16_f32 v131, v252, v253
    s_waitcnt lgkmcnt(0)
    s_branch Lf_evd0
Lf_fl1:
    v_cvt_pk_bf16_f32 v246, v212, v212
    v_mov_b32 v212, 0
    ds_write_b16 v240, v246
    v_add_u32 v240, 128, v240
    s_bitcmp0_b32 s37, 1
    s_cbranch_scc1 Lf_evd1
    s_branch Lf_ev21
Lf_ev1:
    s_bitcmp1_b64 s[56:57], 1
    s_cbranch_scc1 Lf_fl1
Lf_ev21:
    s_bitcmp1_b64 s[56:57], 3
    s_cbranch_scc1 Lf_w1
    s_sub_u32 s60, s60, 1
    s_cbranch_scc0 Lf_nsa1
    s_mov_b32 s49, 6
    s_call_b64 s[62:63], L_swap
Lf_nsa1:
    s_add_u32 s35, s35, s31
    s_min_u32 s35, s35, 419404800
    s_xor_b32 s31, s31, 0x63ff800
    s_branch Lf_evd1
Lf_w1:
    s_bitcmp0_b64 s[56:57], 6
    s_cbranch_scc1 Lf_e11
    s_sub_u32 s60, s60, 1
    s_cbranch_scc0 Lf_nsb1
    s_mov_b32 s49, 6
    s_call_b64 s[62:63], L_swap
    s_waitcnt lgkmcnt(0)
Lf_nsb1:
    s_add_u32 s35, s35, s31
    s_min_u32 s35, s35, 419404800
    s_xor_b32 s31, s31, 0x63ff800
Lf_e11:
    s_sub_u32 s61, s61, 1
    s_cbranch_scc1 Lf_last1
    s_bitcmp0_b32 s33, s61
    s_cbranch_scc1 Lf_nw1
    s_cmp_eq_u32 s61, 3
    s_cselect_b32 s66, s80, s81
    v_add_u32 v238, s66, v238
    v_add_u32 v239, s66, v239
    ds_read_u16 v224, v238 offset:0
    ds_read_u16 v225, v238 offset:8
    ds_read_u16 v226, v238 offset:64
    ds_read_u16 v227, v238 offset:72
    s_waitcnt lgkmcnt(0)
Lf_nw1:
    v_mul_u32_u24 v216, v224, v241
    v_mul_u32_u24 v217, v224, v242
    v_mul_u32_u24 v218, v225, v241
    v_mul_u32_u24 v219, v225, v242
    v_mul_u32_u24 v220, v226, v241
    v_mul_u32_u24 v221, v226, v242
    v_mul_u32_u24 v222, v227, v241
    v_mul_u32_u24 v223, v227, v242
    v_mfma_f32_4x4x4_16b_bf16 v[140:143], v[216:217], v[68:69], v[4:7]
    v_add_u32 v238, 128, v238
    ds_read_b128 v[164:167], v239 offset:0
    ds_read_b128 v[168:171], v239 offset:64
    v_mfma_f32_4x4x4_16b_bf16 v[144:147], v[218:219], v[70:71], v[8:11]
    ds_read_b128 v[172:175], v239 offset:128
    ds_read_b128 v[176:179], v239 offset:192
    ds_read_u16 v224, v238 offset:0
    ds_read_u16 v225, v238 offset:8
    ds_read_u16 v226, v238 offset:64
    ds_read_u16 v227, v238 offset:72
    v_mfma_f32_4x4x4_16b_bf16 v[246:249], v[220:221], v[72:73], v[12:15]
    v_cvt_pk_bf16_f32 v100, v140, v141
    v_cvt_pk_bf16_f32 v101, v142, v143
    v_mfma_f32_4x4x4_16b_bf16 v[250:253], v[222:223], v[74:75], v[16:19]
    v_cvt_pk_bf16_f32 v102, v144, v145
    v_cvt_pk_bf16_f32 v103, v146, v147
    v_mfma_f32_4x4x4_16b_bf16 v[140:143], v[216:217], v[76:77], v[20:23]
    v_cvt_pk_bf16_f32 v104, v246, v247
    v_cvt_pk_bf16_f32 v105, v248, v249
    v_mfma_f32_4x4x4_16b_bf16 v[144:147], v[218:219], v[78:79], v[24:27]
    v_cvt_pk_bf16_f32 v106, v250, v251
    v_cvt_pk_bf16_f32 v107, v252, v253
    v_mfma_f32_4x4x4_16b_bf16 v[246:249], v[220:221], v[80:81], v[28:31]
    v_cvt_pk_bf16_f32 v108, v140, v141
    v_cvt_pk_bf16_f32 v109, v142, v143
    v_mfma_f32_4x4x4_16b_bf16 v[250:253], v[222:223], v[82:83], v[32:35]
    v_cvt_pk_bf16_f32 v110, v144, v145
    v_cvt_pk_bf16_f32 v111, v146, v147
    v_mfma_f32_4x4x4_16b_bf16 v[140:143], v[216:217], v[84:85], v[36:39]
    v_cvt_pk_bf16_f32 v112, v246, v247
    v_cvt_pk_bf16_f32 v113, v248, v249
    v_mfma_f32_4x4x4_16b_bf16 v[144:147], v[218:219], v[86:87], v[40:43]
    v_cvt_pk_bf16_f32 v114, v250, v251
    v_cvt_pk_bf16_f32 v115, v252, v253
    v_mfma_f32_4x4x4_16b_bf16 v[246:249], v[220:221], v[88:89], v[44:47]
    v_cvt_pk_bf16_f32 v116, v140, v141
    v_cvt_pk_bf16_f32 v117, v142, v143
    v_mfma_f32_4x4x4_16b_bf16 v[250:253], v[222:223], v[90:91], v[48:51]
    v_cvt_pk_bf16_f32 v118, v144, v145
    v_cvt_pk_bf16_f32 v119, v146, v147
    v_mfma_f32_4x4x4_16b_bf16 v[140:143], v[216:217], v[92:93], v[52:55]
    v_cvt_pk_bf16_f32 v120, v246, v247
    v_cvt_pk_bf16_f32 v121, v248, v249
    v_mfma_f32_4x4x4_16b_bf16 v[144:147], v[218:219], v[94:95], v[56:59]
    v_cvt_pk_bf16_f32 v122, v250, v251
    v_cvt_pk_bf16_f32 v123, v252, v253
    v_mfma_f32_4x4x4_16b_bf16 v[246:249], v[220:221], v[96:97], v[60:63]
    v_cvt_pk_bf16_f32 v124, v140, v141
    v_cvt_pk_bf16_f32 v125, v142, v143
    v_mfma_f32_4x4x4_16b_bf16 v[250:253], v[222:223], v[98:99], v[64:67]
    v_cvt_pk_bf16_f32 v126, v144, v145
    v_cvt_pk_bf16_f32 v127, v146, v147
    v_cvt_pk_bf16_f32 v128, v246, v247
    v_cvt_pk_bf16_f32 v129, v248, v249
    v_add_u32 v239, 272, v239
    v_cvt_pk_bf16_f32 v130, v250, v251
    v_cvt_pk_bf16_f32 v131, v252, v253
    s_waitcnt lgkmcnt(0)
    s_branch Lf_evd1
Lf_fl2:
    v_cvt_pk_bf16_f32 v246, v212, v212
    v_mov_b32 v212, 0
    ds_write_b16 v240, v246
    v_add_u32 v240, 128, v240
    s_bitcmp0_b32 s37, 2
    s_cbranch_scc1 Lf_evd2
    s_branch Lf_ev22
Lf_ev2:
    s_bitcmp1_b64 s[56:57], 2
    s_cbranch_scc1 Lf_fl2
Lf_ev22:
    s_bitcmp1_b64 s[56:57], 4
    s_cbranch_scc1 Lf_w2
    s_sub_u32 s60, s60, 1
    s_cbranch_scc0 Lf_nsa2
    s_mov_b32 s49, 7
    s_call_b64 s[62:63], L_swap
Lf_nsa2:
    s_add_u32 s35, s35, s31
    s_min_u32 s35, s35, 419404800
    s_xor_b32 s31, s31, 0x63ff800
    s_branch Lf_evd2
Lf_w2:
    s_bitcmp0_b64 s[56:57], 7
    s_cbranch_scc1 Lf_e12
    s_sub_u32 s60, s60, 1
    s_cbranch_scc0 Lf_nsb2
    s_mov_b32 s49, 7
    s_call_b64 s[62:63], L_swap
    s_waitcnt lgkmcnt(0)
Lf_nsb2:
    s_add_u32 s35, s35, s31
    s_min_u32 s35, s35, 419404800
    s_xor_b32 s31, s31, 0x63ff800
Lf_e12:
    s_sub_u32 s61, s61, 1
    s_cbranch_scc1 Lf_last2
    s_bitcmp0_b32 s33, s61
    s_cbranch_scc1 Lf_nw2
    s_cmp_eq_u32 s61, 3
    s_cselect_b32 s66, s80, s81
    v_add_u32 v238, s66, v238
    v_add_u32 v239, s66, v239
    ds_read_u16 v224, v238 offset:0
    ds_read_u16 v225, v238 offset:8
    ds_read_u16 v226, v238 offset:64
    ds_read_u16 v227, v238 offset:72
    s_waitcnt lgkmcnt(0)
Lf_nw2:
    v_mul_u32_u24 v216, v224, v241
    v_mul_u32_u24 v217, v224, v242
    v_mul_u32_u24 v218, v225, v241
    v_mul_u32_u24 v219, v225, v242
    v_mul_u32_u24 v220, v226, v241
    v_mul_u32_u24 v221, v226, v242
    v_mul_u32_u24 v222, v227, v241
    v_mul_u32_u24 v223, v227, v242
    v_mfma_f32_4x4x4_16b_bf16 v[140:143], v[216:217], v[68:69], v[4:7]
    v_add_u32 v238, 128, v238
    ds_read_b128 v[164:167], v239 offset:0
    ds_read_b128 v[168:171], v239 offset:64
    v_mfma_f32_4x4x4_16b_bf16 v[144:147], v[218:219], v[70:71], v[8:11]
    ds_read_b128 v[172:175], v239 offset:128
    ds_read_b128 v[176:179], v239 offset:192
    ds_read_u16 v224, v238 offset:0
    ds_read_u16 v225, v238 offset:8
    ds_read_u16 v226, v238 offset:64
    ds_read_u16 v227, v238 offset:72
    v_mfma_f32_4x4x4_16b_bf16 v[246:249], v[220:221], v[72:73], v[12:15]
    v_cvt_pk_bf16_f32 v100, v140, v141
    v_cvt_pk_bf16_f32 v101, v142, v143
    v_mfma_f32_4x4x4_16b_bf16 v[250:253], v[222:223], v[74:75], v[16:19]
    v_cvt_pk_bf16_f32 v102, v144, v145
    v_cvt_pk_bf16_f32 v103, v146, v147
    v_mfma_f32_4x4x4_16b_bf16 v[140:143], v[216:217], v[76:77], v[20:23]
    v_cvt_pk_bf16_f32 v104, v246, v247
    v_cvt_pk_bf16_f32 v105, v248, v249
    v_mfma_f32_4x4x4_16b_bf16 v[144:147], v[218:219], v[78:79], v[24:27]
    v_cvt_pk_bf16_f32 v106, v250, v251
    v_cvt_pk_bf16_f32 v107, v252, v253
    v_mfma_f32_4x4x4_16b_bf16 v[246:249], v[220:221], v[80:81], v[28:31]
    v_cvt_pk_bf16_f32 v108, v140, v141
    v_cvt_pk_bf16_f32 v109, v142, v143
    v_mfma_f32_4x4x4_16b_bf16 v[250:253], v[222:223], v[82:83], v[32:35]
    v_cvt_pk_bf16_f32 v110, v144, v145
    v_cvt_pk_bf16_f32 v111, v146, v147
    v_mfma_f32_4x4x4_16b_bf16 v[140:143], v[216:217], v[84:85], v[36:39]
    v_cvt_pk_bf16_f32 v112, v246, v247
    v_cvt_pk_bf16_f32 v113, v248, v249
    v_mfma_f32_4x4x4_16b_bf16 v[144:147], v[218:219], v[86:87], v[40:43]
    v_cvt_pk_bf16_f32 v114, v250, v251
    v_cvt_pk_bf16_f32 v115, v252, v253
    v_mfma_f32_4x4x4_16b_bf16 v[246:249], v[220:221], v[88:89], v[44:47]
    v_cvt_pk_bf16_f32 v116, v140, v141
    v_cvt_pk_bf16_f32 v117, v142, v143
    v_mfma_f32_4x4x4_16b_bf16 v[250:253], v[222:223], v[90:91], v[48:51]
    v_cvt_pk_bf16_f32 v118, v144, v145
    v_cvt_pk_bf16_f32 v119, v146, v147
    v_mfma_f32_4x4x4_16b_bf16 v[140:143], v[216:217], v[92:93], v[52:55]
    v_cvt_pk_bf16_f32 v120, v246, v247
    v_cvt_pk_bf16_f32 v121, v248, v249
    v_mfma_f32_4x4x4_16b_bf16 v[144:147], v[218:219], v[94:95], v[56:59]
    v_cvt_pk_bf16_f32 v122, v250, v251
    v_cvt_pk_bf16_f32 v123, v252, v253
    v_mfma_f32_4x4x4_16b_bf16 v[246:249], v[220:221], v[96:97], v[60:63]
    v_cvt_pk_bf16_f32 v124, v140, v141
    v_cvt_pk_bf16_f32 v125, v142, v143
    v_mfma_f32_4x4x4_16b_bf16 v[250:253], v[222:223], v[98:99], v[64:67]
    v_cvt_pk_bf16_f32 v126, v144, v145
    v_cvt_pk_bf16_f32 v127, v146, v147
    v_cvt_pk_bf16_f32 v128, v246, v247
    v_cvt_pk_bf16_f32 v129, v248, v249
    v_add_u32 v239, 272, v239
    v_cvt_pk_bf16_f32 v130, v250, v251
    v_cvt_pk_bf16_f32 v131, v252, v253
    s_waitcnt lgkmcnt(0)
    s_branch Lf_evd2
Lf_fl3:
    v_cvt_pk_bf16_f32 v246, v212, v212
    v_mov_b32 v212, 0
    ds_write_b16 v240, v246
    v_add_u32 v240, 128, v240
    s_bitcmp0_b32 s37, 3
    s_cbranch_scc1 Lf_evd3
    s_branch Lf_ev23
Lf_ev3:
    s_bitcmp1_b64 s[56:57], 3
    s_cbranch_scc1 Lf_fl3
Lf_ev23:
    s_bitcmp1_b64 s[56:57], 5
    s_cbranch_scc1 Lf_w3
    s_sub_u32 s60, s60, 1
    s_cbranch_scc0 Lf_nsa3
    s_mov_b32 s49, 8
    s_call_b64 s[62:63], L_swap
Lf_nsa3:
    s_add_u32 s35, s35, s31
    s_min_u32 s35, s35, 419404800
    s_xor_b32 s31, s31, 0x63ff800
    s_branch Lf_evd3
Lf_w3:
    s_bitcmp0_b64 s[56:57], 8
    s_cbranch_scc1 Lf_e13
    s_sub_u32 s60, s60, 1
    s_cbranch_scc0 Lf_nsb3
    s_mov_b32 s49, 8
    s_call_b64 s[62:63], L_swap
    s_waitcnt lgkmcnt(0)
Lf_nsb3:
    s_add_u32 s35, s35, s31
    s_min_u32 s35, s35, 419404800
    s_xor_b32 s31, s31, 0x63ff800
Lf_e13:
    s_sub_u32 s61, s61, 1
    s_cbranch_scc1 Lf_last3
    s_bitcmp0_b32 s33, s61
    s_cbranch_scc1 Lf_nw3
    s_cmp_eq_u32 s61, 3
    s_cselect_b32 s66, s80, s81
    v_add_u32 v238, s66, v238
    v_add_u32 v239, s66, v239
    ds_read_u16 v224, v238 offset:0
    ds_read_u16 v225, v238 offset:8
    ds_read_u16 v226, v238 offset:64
    ds_read_u16 v227, v238 offset:72
    s_waitcnt lgkmcnt(0)
Lf_nw3:
    v_mul_u32_u24 v216, v224, v241
    v_mul_u32_u24 v217, v224, v242
    v_mul_u32_u24 v218, v225, v241
    v_mul_u32_u24 v219, v225, v242
    v_mul_u32_u24 v220, v226, v241
    v_mul_u32_u24 v221, v226, v242
    v_mul_u32_u24 v222, v227, v241
    v_mul_u32_u24 v223, v227, v242
    v_mfma_f32_4x4x4_16b_bf16 v[140:143], v[216:217], v[68:69], v[4:7]
    v_add_u32 v238, 128, v238
    ds_read_b128 v[164:167], v239 offset:0
    ds_read_b128 v[168:171], v239 offset:64
    v_mfma_f32_4x4x4_16b_bf16 v[144:147], v[218:219], v[70:71], v[8:11]
    ds_read_b128 v[172:175], v239 offset:128
    ds_read_b128 v[176:179], v239 offset:192
    ds_read_u16 v224, v238 offset:0
    ds_read_u16 v225, v238 offset:8
    ds_read_u16 v226, v238 offset:64
    ds_read_u16 v227, v238 offset:72
    v_mfma_f32_4x4x4_16b_bf16 v[246:249], v[220:221], v[72:73], v[12:15]
    v_cvt_pk_bf16_f32 v100, v140, v141
    v_cvt_pk_bf16_f32 v101, v142, v143
    v_mfma_f32_4x4x4_16b_bf16 v[250:253], v[222:223], v[74:75], v[16:19]
    v_cvt_pk_bf16_f32 v102, v144, v145
    v_cvt_pk_bf16_f32 v103, v146, v147
    v_mfma_f32_4x4x4_16b_bf16 v[140:143], v[216:217], v[76:77], v[20:23]
    v_cvt_pk_bf16_f32 v104, v246, v247
    v_cvt_pk_bf16_f32 v105, v248, v249
    v_mfma_f32_4x4x4_16b_bf16 v[144:147], v[218:219], v[78:79], v[24:27]
    v_cvt_pk_bf16_f32 v106, v250, v251
    v_cvt_pk_bf16_f32 v107, v252, v253
    v_mfma_f32_4x4x4_16b_bf16 v[246:249], v[220:221], v[80:81], v[28:31]
    v_cvt_pk_bf16_f32 v108, v140, v141
    v_cvt_pk_bf16_f32 v109, v142, v143
    v_mfma_f32_4x4x4_16b_bf16 v[250:253], v[222:223], v[82:83], v[32:35]
    v_cvt_pk_bf16_f32 v110, v144, v145
    v_cvt_pk_bf16_f32 v111, v146, v147
    v_mfma_f32_4x4x4_16b_bf16 v[140:143], v[216:217], v[84:85], v[36:39]
    v_cvt_pk_bf16_f32 v112, v246, v247
    v_cvt_pk_bf16_f32 v113, v248, v249
    v_mfma_f32_4x4x4_16b_bf16 v[144:147], v[218:219], v[86:87], v[40:43]
    v_cvt_pk_bf16_f32 v114, v250, v251
    v_cvt_pk_bf16_f32 v115, v252, v253
    v_mfma_f32_4x4x4_16b_bf16 v[246:249], v[220:221], v[88:89], v[44:47]
    v_cvt_pk_bf16_f32 v116, v140, v141
    v_cvt_pk_bf16_f32 v117, v142, v143
    v_mfma_f32_4x4x4_16b_bf16 v[250:253], v[222:223], v[90:91], v[48:51]
    v_cvt_pk_bf16_f32 v118, v144, v145
    v_cvt_pk_bf16_f32 v119, v146, v147
    v_mfma_f32_4x4x4_16b_bf16 v[140:143], v[216:217], v[92:93], v[52:55]
    v_cvt_pk_bf16_f32 v120, v246, v247
    v_cvt_pk_bf16_f32 v121, v248, v249
    v_mfma_f32_4x4x4_16b_bf16 v[144:147], v[218:219], v[94:95], v[56:59]
    v_cvt_pk_bf16_f32 v122, v250, v251
    v_cvt_pk_bf16_f32 v123, v252, v253
    v_mfma_f32_4x4x4_16b_bf16 v[246:249], v[220:221], v[96:97], v[60:63]
    v_cvt_pk_bf16_f32 v124, v140, v141
    v_cvt_pk_bf16_f32 v125, v142, v143
    v_mfma_f32_4x4x4_16b_bf16 v[250:253], v[222:223], v[98:99], v[64:67]
    v_cvt_pk_bf16_f32 v126, v144, v145
    v_cvt_pk_bf16_f32 v127, v146, v147
    v_cvt_pk_bf16_f32 v128, v246, v247
    v_cvt_pk_bf16_f32 v129, v248, v249
    v_add_u32 v239, 272, v239
    v_cvt_pk_bf16_f32 v130, v250, v251
    v_cvt_pk_bf16_f32 v131, v252, v253
    s_waitcnt lgkmcnt(0)
    s_branch Lf_evd3
Lf_last0:
    s_branch Lf_tail
Lf_last1:
    v_add_u32 v236, 2080, v236
    s_lshr_b64 s[56:57], s[56:57], 1
    s_branch Lf_tail
Lf_last2:
    v_add_u32 v236, 4160, v236
    s_lshr_b64 s[56:57], s[56:57], 2
    s_branch Lf_tail
Lf_last3:
    v_add_u32 v236, 6240, v236
    s_lshr_b64 s[56:57], s[56:57], 3
Lf_tail:
    v_mfma_f32_16x16x32_bf16 v[208:211], v[136:139], v[200:203], v[208:211]
    v_exp_f32 v132, v148
    v_exp_f32 v133, v149
    v_exp_f32 v134, v150
    v_exp_f32 v135, v151
    v_exp_f32 v136, v152
    v_exp_f32 v137, v153
    v_mfma_f32_4x4x4_16b_bf16 v[132:135], v[228:229], v[228:229], v[132:135]
    v_exp_f32 v138, v154
    v_exp_f32 v139, v155
    v_cvt_pk_bf16_f32 v208, v208, v209
    v_cvt_pk_bf16_f32 v209, v210, v211
    v_exp_f32 v140, v156
    v_exp_f32 v141, v157
    v_mfma_f32_4x4x4_16b_bf16 v[212:215], v[208:209], v[188:189], v[212:215] cbsz:4 abid:0
    v_mfma_f32_4x4x4_16b_bf16 v[136:139], v[228:229], v[228:229], v[136:139]
    v_exp_f32 v142, v158
    v_mfma_f32_4x4x4_16b_bf16 v[212:215], v[208:209], v[190:191], v[212:215] cbsz:4 abid:4
    v_exp_f32 v143, v159
    v_exp_f32 v144, v160
    v_mfma_f32_4x4x4_16b_bf16 v[212:215], v[208:209], v[192:193], v[212:215] cbsz:4 abid:8
    v_exp_f32 v145, v161
    v_mfma_f32_4x4x4_16b_bf16 v[140:143], v[228:229], v[228:229], v[140:143]
    v_mfma_f32_4x4x4_16b_bf16 v[212:215], v[208:209], v[194:195], v[212:215] cbsz:4 abid:12
    ds_read_b64_tr_b16 v[188:189], v236 offset:0
    ds_read_b64_tr_b16 v[190:191], v236 offset:512
    ds_read_b64_tr_b16 v[192:193], v236 offset:1056
    ds_read_b64_tr_b16 v[194:195], v236 offset:1568
    v_exp_f32 v146, v162
    v_exp_f32 v147, v163
    v_rcp_f32 v132, v132
    v_rcp_f32 v133, v133
    v_mfma_f32_4x4x4_16b_bf16 v[144:147], v[228:229], v[228:229], v[144:147]
    v_rcp_f32 v134, v134
    s_bitcmp0_b64 s[56:57], 1
    s_cbranch_scc1 Lf_tnf
    v_cvt_pk_bf16_f32 v246, v212, v212
    v_mov_b32 v212, 0
    ds_write_b16 v240, v246
    v_add_u32 v240, 128, v240
Lf_tnf:
    v_cvt_pk_bf16_f32 v132, v132, v133
    s_waitcnt lgkmcnt(0)
    v_rcp_f32 v135, v135
    v_rcp_f32 v136, v136
    v_cvt_pk_bf16_f32 v133, v134, v135
    v_rcp_f32 v137, v137
    v_rcp_f32 v138, v138
    v_cvt_pk_bf16_f32 v134, v136, v137
    v_rcp_f32 v139, v139
    v_rcp_f32 v140, v140
    v_cvt_pk_bf16_f32 v135, v138, v139
    v_rcp_f32 v141, v141
    v_rcp_f32 v142, v142
    v_cvt_pk_bf16_f32 v136, v140, v141
    v_mfma_f32_16x16x32_bf16 v[208:211], v[132:135], v[196:199], v[204:207]
    v_rcp_f32 v143, v143
    v_rcp_f32 v144, v144
    v_cvt_pk_bf16_f32 v137, v142, v143
    v_rcp_f32 v145, v145
    v_rcp_f32 v146, v146
    v_rcp_f32 v147, v147
    v_cvt_pk_bf16_f32 v138, v144, v145
    v_cvt_pk_bf16_f32 v139, v146, v147
    s_nop 1
    v_mfma_f32_16x16x32_bf16 v[208:211], v[136:139], v[200:203], v[208:211]
    s_nop 7
    v_cvt_pk_bf16_f32 v208, v208, v209
    v_cvt_pk_bf16_f32 v209, v210, v211
    s_nop 1
    v_mfma_f32_4x4x4_16b_bf16 v[212:215], v[208:209], v[188:189], v[212:215] cbsz:4 abid:0
    s_nop 1
    v_mfma_f32_4x4x4_16b_bf16 v[212:215], v[208:209], v[190:191], v[212:215] cbsz:4 abid:4
    s_nop 1
    v_mfma_f32_4x4x4_16b_bf16 v[212:215], v[208:209], v[192:193], v[212:215] cbsz:4 abid:8
    s_nop 1
    v_mfma_f32_4x4x4_16b_bf16 v[212:215], v[208:209], v[194:195], v[212:215] cbsz:4 abid:12
    s_nop 4
    v_cvt_pk_bf16_f32 v246, v212, v212
    ds_write_b16 v240, v246
L_store:
    s_add_u32 s66, s52, 14912
    v_lshl_add_u32 v247, v0, 4, s66
    s_lshl_b32 s66, s82, 5
    s_bfm_b64 exec, 16, 32
    v_add_u32 v243, s66, v243
    s_lshl_b32 s66, s83, 5
    s_bfm_b64 exec, 16, 48
    v_add_u32 v243, s66, v243
    s_mov_b64 exec, -1
    ds_read_b128 v[148:151], v247
    s_waitcnt lgkmcnt(0)
    global_store_dwordx4 v243, v[148:151], s[18:19] sc0 sc1
L_end:
    s_endpgm
L_general:
    s_waitcnt vmcnt(0)
    ds_read_b128 v[44:47], v246 offset:20480
    ds_read_b128 v[48:51], v246 offset:21504
    ds_read_b128 v[88:91], v246 offset:22528
    ds_read_b128 v[52:55], v246 offset:40960
    ds_read_b128 v[56:59], v246 offset:41984
    ds_read_b128 v[92:95], v246 offset:43008
    ds_read_b128 v[60:63], v246 offset:61440
    ds_read_b128 v[64:67], v246 offset:62464
    ds_read_b128 v[96:99], v246 offset:63488
    ds_read_u16 v224, v238 offset:0
    ds_read_u16 v225, v238 offset:8
    ds_read_u16 v226, v238 offset:64
    ds_read_u16 v227, v238 offset:72
    s_mul_i32 s35, s53, 51200
    s_movk_i32 s31, 25600
    s_mov_b32 s60, 3
    s_mov_b64 s[56:57], 0
    v_mov_b32 v148, -1
    v_mov_b32 v149, -1
    v_mov_b32 v150, -1
    v_mov_b32 v151, -1
    s_add_u32 s66, s52, 18432
    v_add_u32 v152, s66, v2
    ds_write_b128 v152, v[148:151]
    ds_write_b128 v152, v[148:151] offset:1024
    s_add_u32 s64, s52, 18448
    s_bfm_b64 s[28:29], 50, 0
    s_mul_i32 s66, s53, 800
    v_add_u32 v247, s66, v2
    s_mov_b64 exec, s[28:29]
    global_load_dwordx4 v[100:103], v247, s[8:9]
    v_add_u32 v247, 1638400, v247
    global_load_dwordx4 v[104:107], v247, s[8:9]
    v_add_u32 v247, 1638400, v247
    global_load_dwordx4 v[108:111], v247, s[8:9]
    v_add_u32 v247, 1638400, v247
    global_load_dwordx4 v[112:115], v247, s[8:9]
    v_add_u32 v247, 1638400, v247
    s_mov_b64 exec, -1
    v_cmp_lt_u32 vcc, 24, v0
    s_nop 1
    v_cndmask_b32 v145, 0, 1, vcc
    v_mul_u32_u24 v142, 25, v145
    v_sub_u32 v142, v0, v142
    v_mul_u32_u24 v142, 0x80008, v142
    v_add_u32 v141, 0x10000, v142
    v_add_u32 v143, 0x50004, v142
    v_add_u32 v144, 0x70006, v142
    v_add_u32 v142, 0x30002, v142
    s_waitcnt vmcnt(0)
    s_mov_b64 exec, s[28:29]
    v_cmp_neq_f16_sdwa s[68:69], v100, 0 src0_sel:WORD_0 src1_sel:WORD_0
    v_cmp_neq_f16_sdwa s[70:71], v100, 0 src0_sel:WORD_1 src1_sel:WORD_0
    v_cmp_neq_f16_sdwa s[72:73], v101, 0 src0_sel:WORD_0 src1_sel:WORD_0
    v_cmp_neq_f16_sdwa s[74:75], v101, 0 src0_sel:WORD_1 src1_sel:WORD_0
    v_cmp_neq_f16_sdwa s[76:77], v102, 0 src0_sel:WORD_0 src1_sel:WORD_0
    v_cmp_neq_f16_sdwa s[78:79], v102, 0 src0_sel:WORD_1 src1_sel:WORD_0
    v_cmp_neq_f16_sdwa s[80:81], v103, 0 src0_sel:WORD_0 src1_sel:WORD_0
    v_cmp_neq_f16_sdwa s[82:83], v103, 0 src0_sel:WORD_1 src1_sel:WORD_0
    s_mov_b64 exec, -1
    v_mov_b32 v132, s64
    v_mbcnt_lo_u32_b32 v132, s68, v132
    v_mbcnt_hi_u32_b32 v132, s69, v132
    v_mbcnt_lo_u32_b32 v132, s70, v132
    v_mbcnt_hi_u32_b32 v132, s71, v132
    v_mbcnt_lo_u32_b32 v132, s72, v132
    v_mbcnt_hi_u32_b32 v132, s73, v132
    v_mbcnt_lo_u32_b32 v132, s74, v132
    v_mbcnt_hi_u32_b32 v132, s75, v132
    v_mbcnt_lo_u32_b32 v132, s76, v132
    v_mbcnt_hi_u32_b32 v132, s77, v132
    v_mbcnt_lo_u32_b32 v132, s78, v132
    v_mbcnt_hi_u32_b32 v132, s79, v132
    v_mbcnt_lo_u32_b32 v132, s80, v132
    v_mbcnt_hi_u32_b32 v132, s81, v132
    v_mbcnt_lo_u32_b32 v132, s82, v132
    v_mbcnt_hi_u32_b32 v132, s83, v132
    s_add_u32 s55, s64, 16
    v_readlane_b32 s66, v132, 25
    v_readlane_b32 s67, v132, 63
    s_add_u32 s64, s66, 15
    s_and_b32 s64, s64, -16
    s_max_u32 s64, s64, s55
    s_sub_u32 s66, s64, s66
    v_mad_u32_u24 v132, v145, s66, v132
    s_mov_b32 s55, s64
    v_addc_co_u32 v133, vcc, 0, v132, s[68:69]
    v_addc_co_u32 v134, vcc, 0, v133, s[70:71]
    v_addc_co_u32 v135, vcc, 0, v134, s[72:73]
    v_addc_co_u32 v136, vcc, 0, v135, s[74:75]
    v_addc_co_u32 v137, vcc, 0, v136, s[76:77]
    v_addc_co_u32 v138, vcc, 0, v137, s[78:79]
    v_addc_co_u32 v139, vcc, 0, v138, s[80:81]
    s_add_u32 s67, s67, s66
    s_add_u32 s67, s67, 15
    s_and_b32 s67, s67, -16
    s_add_u32 s64, s64, 16
    s_max_u32 s64, s64, s67
    s_mov_b64 exec, s[68:69]
    ds_write_b8 v132, v141
    s_mov_b64 exec, s[70:71]
    ds_write_b8_d16_hi v133, v141
    s_mov_b64 exec, s[72:73]
    ds_write_b8 v134, v142
    s_mov_b64 exec, s[74:75]
    ds_write_b8_d16_hi v135, v142
    s_mov_b64 exec, s[76:77]
    ds_write_b8 v136, v143
    s_mov_b64 exec, s[78:79]
    ds_write_b8_d16_hi v137, v143
    s_mov_b64 exec, s[80:81]
    ds_write_b8 v138, v144
    s_mov_b64 exec, s[82:83]
    ds_write_b8_d16_hi v139, v144
    s_mov_b64 exec, -1
    s_lshr_b32 s95, s55, 4
    s_bitset1_b64 s[56:57], s95
    s_lshr_b32 s95, s64, 4
    s_bitset1_b64 s[56:57], s95
    s_mov_b64 exec, s[28:29]
    v_cmp_neq_f16_sdwa s[68:69], v104, 0 src0_sel:WORD_0 src1_sel:WORD_0
    v_cmp_neq_f16_sdwa s[70:71], v104, 0 src0_sel:WORD_1 src1_sel:WORD_0
    v_cmp_neq_f16_sdwa s[72:73], v105, 0 src0_sel:WORD_0 src1_sel:WORD_0
    v_cmp_neq_f16_sdwa s[74:75], v105, 0 src0_sel:WORD_1 src1_sel:WORD_0
    v_cmp_neq_f16_sdwa s[76:77], v106, 0 src0_sel:WORD_0 src1_sel:WORD_0
    v_cmp_neq_f16_sdwa s[78:79], v106, 0 src0_sel:WORD_1 src1_sel:WORD_0
    v_cmp_neq_f16_sdwa s[80:81], v107, 0 src0_sel:WORD_0 src1_sel:WORD_0
    v_cmp_neq_f16_sdwa s[82:83], v107, 0 src0_sel:WORD_1 src1_sel:WORD_0
    s_mov_b64 exec, -1
    v_mov_b32 v132, s64
    v_mbcnt_lo_u32_b32 v132, s68, v132
    v_mbcnt_hi_u32_b32 v132, s69, v132
    v_mbcnt_lo_u32_b32 v132, s70, v132
    v_mbcnt_hi_u32_b32 v132, s71, v132
    v_mbcnt_lo_u32_b32 v132, s72, v132
    v_mbcnt_hi_u32_b32 v132, s73, v132
    v_mbcnt_lo_u32_b32 v132, s74, v132
    v_mbcnt_hi_u32_b32 v132, s75, v132
    v_mbcnt_lo_u32_b32 v132, s76, v132
    v_mbcnt_hi_u32_b32 v132, s77, v132
    v_mbcnt_lo_u32_b32 v132, s78, v132
    v_mbcnt_hi_u32_b32 v132, s79, v132
    v_mbcnt_lo_u32_b32 v132, s80, v132
    v_mbcnt_hi_u32_b32 v132, s81, v132
    v_mbcnt_lo_u32_b32 v132, s82, v132
    v_mbcnt_hi_u32_b32 v132, s83, v132
    s_add_u32 s55, s64, 16
    v_readlane_b32 s66, v132, 25
    v_readlane_b32 s67, v132, 63
    s_add_u32 s64, s66, 15
    s_and_b32 s64, s64, -16
    s_max_u32 s64, s64, s55
    s_sub_u32 s66, s64, s66
    v_mad_u32_u24 v132, v145, s66, v132
    s_mov_b32 s55, s64
    v_addc_co_u32 v133, vcc, 0, v132, s[68:69]
    v_addc_co_u32 v134, vcc, 0, v133, s[70:71]
    v_addc_co_u32 v135, vcc, 0, v134, s[72:73]
    v_addc_co_u32 v136, vcc, 0, v135, s[74:75]
    v_addc_co_u32 v137, vcc, 0, v136, s[76:77]
    v_addc_co_u32 v138, vcc, 0, v137, s[78:79]
    v_addc_co_u32 v139, vcc, 0, v138, s[80:81]
    s_add_u32 s67, s67, s66
    s_add_u32 s67, s67, 15
    s_and_b32 s67, s67, -16
    s_add_u32 s64, s64, 16
    s_max_u32 s64, s64, s67
    s_mov_b64 exec, s[68:69]
    ds_write_b8 v132, v141
    s_mov_b64 exec, s[70:71]
    ds_write_b8_d16_hi v133, v141
    s_mov_b64 exec, s[72:73]
    ds_write_b8 v134, v142
    s_mov_b64 exec, s[74:75]
    ds_write_b8_d16_hi v135, v142
    s_mov_b64 exec, s[76:77]
    ds_write_b8 v136, v143
    s_mov_b64 exec, s[78:79]
    ds_write_b8_d16_hi v137, v143
    s_mov_b64 exec, s[80:81]
    ds_write_b8 v138, v144
    s_mov_b64 exec, s[82:83]
    ds_write_b8_d16_hi v139, v144
    s_mov_b64 exec, -1
    s_lshr_b32 s95, s55, 4
    s_bitset1_b64 s[56:57], s95
    s_lshr_b32 s95, s64, 4
    s_bitset1_b64 s[56:57], s95
    s_mov_b32 s44, s64
    s_mov_b64 exec, s[28:29]
    v_cmp_neq_f16_sdwa s[68:69], v108, 0 src0_sel:WORD_0 src1_sel:WORD_0
    v_cmp_neq_f16_sdwa s[70:71], v108, 0 src0_sel:WORD_1 src1_sel:WORD_0
    v_cmp_neq_f16_sdwa s[72:73], v109, 0 src0_sel:WORD_0 src1_sel:WORD_0
    v_cmp_neq_f16_sdwa s[74:75], v109, 0 src0_sel:WORD_1 src1_sel:WORD_0
    v_cmp_neq_f16_sdwa s[76:77], v110, 0 src0_sel:WORD_0 src1_sel:WORD_0
    v_cmp_neq_f16_sdwa s[78:79], v110, 0 src0_sel:WORD_1 src1_sel:WORD_0
    v_cmp_neq_f16_sdwa s[80:81], v111, 0 src0_sel:WORD_0 src1_sel:WORD_0
    v_cmp_neq_f16_sdwa s[82:83], v111, 0 src0_sel:WORD_1 src1_sel:WORD_0
    s_mov_b64 exec, -1
    v_mov_b32 v132, s64
    v_mbcnt_lo_u32_b32 v132, s68, v132
    v_mbcnt_hi_u32_b32 v132, s69, v132
    v_mbcnt_lo_u32_b32 v132, s70, v132
    v_mbcnt_hi_u32_b32 v132, s71, v132
    v_mbcnt_lo_u32_b32 v132, s72, v132
    v_mbcnt_hi_u32_b32 v132, s73, v132
    v_mbcnt_lo_u32_b32 v132, s74, v132
    v_mbcnt_hi_u32_b32 v132, s75, v132
    v_mbcnt_lo_u32_b32 v132, s76, v132
    v_mbcnt_hi_u32_b32 v132, s77, v132
    v_mbcnt_lo_u32_b32 v132, s78, v132
    v_mbcnt_hi_u32_b32 v132, s79, v132
    v_mbcnt_lo_u32_b32 v132, s80, v132
    v_mbcnt_hi_u32_b32 v132, s81, v132
    v_mbcnt_lo_u32_b32 v132, s82, v132
    v_mbcnt_hi_u32_b32 v132, s83, v132
    s_add_u32 s55, s64, 16
    v_readlane_b32 s66, v132, 25
    v_readlane_b32 s67, v132, 63
    s_add_u32 s64, s66, 15
    s_and_b32 s64, s64, -16
    s_max_u32 s64, s64, s55
    s_sub_u32 s66, s64, s66
    v_mad_u32_u24 v132, v145, s66, v132
    s_mov_b32 s55, s64
    v_addc_co_u32 v133, vcc, 0, v132, s[68:69]
    v_addc_co_u32 v134, vcc, 0, v133, s[70:71]
    v_addc_co_u32 v135, vcc, 0, v134, s[72:73]
    v_addc_co_u32 v136, vcc, 0, v135, s[74:75]
    v_addc_co_u32 v137, vcc, 0, v136, s[76:77]
    v_addc_co_u32 v138, vcc, 0, v137, s[78:79]
    v_addc_co_u32 v139, vcc, 0, v138, s[80:81]
    s_add_u32 s67, s67, s66
    s_add_u32 s67, s67, 15
    s_and_b32 s67, s67, -16
    s_add_u32 s64, s64, 16
    s_max_u32 s64, s64, s67
    s_mov_b64 exec, s[68:69]
    ds_write_b8 v132, v141
    s_mov_b64 exec, s[70:71]
    ds_write_b8_d16_hi v133, v141
    s_mov_b64 exec, s[72:73]
    ds_write_b8 v134, v142
    s_mov_b64 exec, s[74:75]
    ds_write_b8_d16_hi v135, v142
    s_mov_b64 exec, s[76:77]
    ds_write_b8 v136, v143
    s_mov_b64 exec, s[78:79]
    ds_write_b8_d16_hi v137, v143
    s_mov_b64 exec, s[80:81]
    ds_write_b8 v138, v144
    s_mov_b64 exec, s[82:83]
    ds_write_b8_d16_hi v139, v144
    s_mov_b64 exec, -1
    s_mov_b32 s45, s55
    s_mov_b32 s46, s64
    s_mov_b64 exec, s[28:29]
    v_cmp_neq_f16_sdwa s[68:69], v112, 0 src0_sel:WORD_0 src1_sel:WORD_0
    v_cmp_neq_f16_sdwa s[70:71], v112, 0 src0_sel:WORD_1 src1_sel:WORD_0
    v_cmp_neq_f16_sdwa s[72:73], v113, 0 src0_sel:WORD_0 src1_sel:WORD_0
    v_cmp_neq_f16_sdwa s[74:75], v113, 0 src0_sel:WORD_1 src1_sel:WORD_0
    v_cmp_neq_f16_sdwa s[76:77], v114, 0 src0_sel:WORD_0 src1_sel:WORD_0
    v_cmp_neq_f16_sdwa s[78:79], v114, 0 src0_sel:WORD_1 src1_sel:WORD_0
    v_cmp_neq_f16_sdwa s[80:81], v115, 0 src0_sel:WORD_0 src1_sel:WORD_0
    v_cmp_neq_f16_sdwa s[82:83], v115, 0 src0_sel:WORD_1 src1_sel:WORD_0
    s_mov_b64 exec, -1
    v_mov_b32 v132, s64
    v_mbcnt_lo_u32_b32 v132, s68, v132
    v_mbcnt_hi_u32_b32 v132, s69, v132
    v_mbcnt_lo_u32_b32 v132, s70, v132
    v_mbcnt_hi_u32_b32 v132, s71, v132
    v_mbcnt_lo_u32_b32 v132, s72, v132
    v_mbcnt_hi_u32_b32 v132, s73, v132
    v_mbcnt_lo_u32_b32 v132, s74, v132
    v_mbcnt_hi_u32_b32 v132, s75, v132
    v_mbcnt_lo_u32_b32 v132, s76, v132
    v_mbcnt_hi_u32_b32 v132, s77, v132
    v_mbcnt_lo_u32_b32 v132, s78, v132
    v_mbcnt_hi_u32_b32 v132, s79, v132
    v_mbcnt_lo_u32_b32 v132, s80, v132
    v_mbcnt_hi_u32_b32 v132, s81, v132
    v_mbcnt_lo_u32_b32 v132, s82, v132
    v_mbcnt_hi_u32_b32 v132, s83, v132
    s_add_u32 s55, s64, 16
    v_readlane_b32 s66, v132, 25
    v_readlane_b32 s67, v132, 63
    s_add_u32 s64, s66, 15
    s_and_b32 s64, s64, -16
    s_max_u32 s64, s64, s55
    s_sub_u32 s66, s64, s66
    v_mad_u32_u24 v132, v145, s66, v132
    s_mov_b32 s55, s64
    v_addc_co_u32 v133, vcc, 0, v132, s[68:69]
    v_addc_co_u32 v134, vcc, 0, v133, s[70:71]
    v_addc_co_u32 v135, vcc, 0, v134, s[72:73]
    v_addc_co_u32 v136, vcc, 0, v135, s[74:75]
    v_addc_co_u32 v137, vcc, 0, v136, s[76:77]
    v_addc_co_u32 v138, vcc, 0, v137, s[78:79]
    v_addc_co_u32 v139, vcc, 0, v138, s[80:81]
    s_add_u32 s67, s67, s66
    s_add_u32 s67, s67, 15
    s_and_b32 s67, s67, -16
    s_add_u32 s64, s64, 16
    s_max_u32 s64, s64, s67
    s_mov_b64 exec, s[68:69]
    ds_write_b8 v132, v141
    s_mov_b64 exec, s[70:71]
    ds_write_b8_d16_hi v133, v141
    s_mov_b64 exec, s[72:73]
    ds_write_b8 v134, v142
    s_mov_b64 exec, s[74:75]
    ds_write_b8_d16_hi v135, v142
    s_mov_b64 exec, s[76:77]
    ds_write_b8 v136, v143
    s_mov_b64 exec, s[78:79]
    ds_write_b8_d16_hi v137, v143
    s_mov_b64 exec, s[80:81]
    ds_write_b8 v138, v144
    s_mov_b64 exec, s[82:83]
    ds_write_b8_d16_hi v139, v144
    s_mov_b64 exec, -1
    s_mov_b32 s47, s55
    s_mov_b32 s48, s64
    s_mov_b32 s94, 0
    s_mov_b64 s[84:85], -1
    s_branch L_listed
Ls_loop:
Ls_mid:
    s_bitcmp1_b32 s36, 0
    s_cbranch_scc1 Ls_ev0
Ls_evd0:
    v_mfma_f32_16x16x32_bf16 v[208:211], v[136:139], v[200:203], v[208:211]
    ds_read_b32 v246, v244 offset:0
    s_waitcnt lgkmcnt(0)
    v_bfe_u32 v247, v246, 0, 8
    v_lshlrev_b32 v247, 1, v247
    v_bfe_u32 v248, v246, 8, 8
    v_lshlrev_b32 v248, 1, v248
    v_bfe_u32 v249, v246, 16, 8
    v_lshlrev_b32 v249, 1, v249
    v_bfe_u32 v250, v246, 24, 8
    v_lshlrev_b32 v250, 1, v250
    buffer_load_ushort v247, v247, s[24:27], 0 offen
    buffer_load_ushort v248, v248, s[24:27], 0 offen
    buffer_load_ushort v249, v249, s[24:27], 0 offen
    buffer_load_ushort v250, v250, s[24:27], 0 offen
    s_waitcnt vmcnt(0)
    v_lshlrev_b32 v247, 16, v247
    v_mul_f32 v208, v208, v247
    v_lshlrev_b32 v248, 16, v248
    v_mul_f32 v209, v209, v248
    v_lshlrev_b32 v249, 16, v249
    v_mul_f32 v210, v210, v249
    v_lshlrev_b32 v250, 16, v250
    v_mul_f32 v211, v211, v250
    v_exp_f32 v132, v148
    v_exp_f32 v133, v149
    v_exp_f32 v134, v150
    v_exp_f32 v135, v151
    v_exp_f32 v136, v152
    v_exp_f32 v137, v153
    v_mfma_f32_4x4x4_16b_bf16 v[132:135], v[228:229], v[228:229], v[132:135]
    v_exp_f32 v138, v154
    v_exp_f32 v139, v155
    v_cvt_pk_bf16_f32 v208, v208, v209
    v_cvt_pk_bf16_f32 v209, v210, v211
    v_exp_f32 v140, v156
    v_exp_f32 v141, v157
    v_mfma_f32_4x4x4_16b_bf16 v[212:215], v[208:209], v[188:189], v[212:215] cbsz:4 abid:0
    v_mfma_f32_4x4x4_16b_bf16 v[136:139], v[228:229], v[228:229], v[136:139]
    v_exp_f32 v142, v158
    v_mfma_f32_4x4x4_16b_bf16 v[212:215], v[208:209], v[190:191], v[212:215] cbsz:4 abid:4
    v_exp_f32 v143, v159
    v_exp_f32 v144, v160
    v_mfma_f32_4x4x4_16b_bf16 v[212:215], v[208:209], v[192:193], v[212:215] cbsz:4 abid:8
    v_exp_f32 v145, v161
    v_mfma_f32_4x4x4_16b_bf16 v[140:143], v[228:229], v[228:229], v[140:143]
    v_mfma_f32_4x4x4_16b_bf16 v[212:215], v[208:209], v[194:195], v[212:215] cbsz:4 abid:12
    ds_add_rtn_u32 v1, v2, v3
    ds_read_u8 v230, v237 offset:64
    ds_read_u8 v232, v237 offset:72
    ds_read_b64_tr_b16 v[188:189], v236 offset:0
    ds_read_b64_tr_b16 v[190:191], v236 offset:512
    ds_read_b64_tr_b16 v[192:193], v236 offset:1056
    ds_read_b64_tr_b16 v[194:195], v236 offset:1568
    s_waitcnt vmcnt(4)
    ds_read_b128 v[180:183], v234 offset:2080
    ds_read_b128 v[184:187], v235 offset:2080
    s_add_u32 m0, s52, 0
    v_exp_f32 v146, v162
    v_exp_f32 v147, v163
    v_rcp_f32 v132, v132
    v_rcp_f32 v133, v133
    v_mfma_f32_4x4x4_16b_bf16 v[144:147], v[228:229], v[228:229], v[144:147]
    v_rcp_f32 v134, v134
    v_cvt_pk_bf16_f32 v132, v132, v133
    s_waitcnt lgkmcnt(2)
    buffer_load_dwordx4 v[230:231], s[20:23], s35 idxen offen nt lds
    buffer_load_dwordx4 v[232:233], s[40:43], s35 idxen offen offset:1056 nt lds
    s_waitcnt lgkmcnt(0)
    v_mfma_f32_16x16x32_bf16 v[148:151], v[100:103], v[180:183], v[164:167]
    v_rcp_f32 v135, v135
    v_mfma_f32_16x16x32_bf16 v[152:155], v[108:111], v[180:183], v[168:171]
    v_rcp_f32 v136, v136
    v_cvt_pk_bf16_f32 v133, v134, v135
    v_mfma_f32_16x16x32_bf16 v[148:151], v[104:107], v[184:187], v[148:151]
    v_rcp_f32 v137, v137
    v_cmp_gt_i32 vcc, v1, v245
    s_setprio 0
    s_cbranch_vccz Ls_lo0
    s_setprio 1
Ls_lo0:
    v_mfma_f32_16x16x32_bf16 v[152:155], v[112:115], v[184:187], v[152:155]
    v_rcp_f32 v138, v138
    v_cvt_pk_bf16_f32 v134, v136, v137
    v_mfma_f32_16x16x32_bf16 v[156:159], v[116:119], v[180:183], v[172:175]
    v_rcp_f32 v139, v139
    v_mfma_f32_16x16x32_bf16 v[160:163], v[124:127], v[180:183], v[176:179]
    v_rcp_f32 v140, v140
    v_cvt_pk_bf16_f32 v135, v138, v139
    v_mfma_f32_16x16x32_bf16 v[156:159], v[120:123], v[184:187], v[156:159]
    v_rcp_f32 v141, v141
    v_mfma_f32_16x16x32_bf16 v[160:163], v[128:131], v[184:187], v[160:163]
    v_rcp_f32 v142, v142
    v_cvt_pk_bf16_f32 v136, v140, v141
    v_mfma_f32_16x16x32_bf16 v[208:211], v[132:135], v[196:199], v[204:207]
    v_rcp_f32 v143, v143
    v_rcp_f32 v144, v144
    v_cvt_pk_bf16_f32 v137, v142, v143
    v_rcp_f32 v145, v145
    v_rcp_f32 v146, v146
    v_rcp_f32 v147, v147
    v_cvt_pk_bf16_f32 v138, v144, v145
    v_cvt_pk_bf16_f32 v139, v146, v147
    s_bitcmp1_b32 s36, 1
    s_cbranch_scc1 Ls_ev1
Ls_evd1:
    v_mfma_f32_16x16x32_bf16 v[208:211], v[136:139], v[200:203], v[208:211]
    ds_read_b32 v246, v244 offset:16
    s_waitcnt lgkmcnt(0)
    v_bfe_u32 v247, v246, 0, 8
    v_lshlrev_b32 v247, 1, v247
    v_bfe_u32 v248, v246, 8, 8
    v_lshlrev_b32 v248, 1, v248
    v_bfe_u32 v249, v246, 16, 8
    v_lshlrev_b32 v249, 1, v249
    v_bfe_u32 v250, v246, 24, 8
    v_lshlrev_b32 v250, 1, v250
    buffer_load_ushort v247, v247, s[24:27], 0 offen
    buffer_load_ushort v248, v248, s[24:27], 0 offen
    buffer_load_ushort v249, v249, s[24:27], 0 offen
    buffer_load_ushort v250, v250, s[24:27], 0 offen
    s_waitcnt vmcnt(0)
    v_lshlrev_b32 v247, 16, v247
    v_mul_f32 v208, v208, v247
    v_lshlrev_b32 v248, 16, v248
    v_mul_f32 v209, v209, v248
    v_lshlrev_b32 v249, 16, v249
    v_mul_f32 v210, v210, v249
    v_lshlrev_b32 v250, 16, v250
    v_mul_f32 v211, v211, v250
    v_exp_f32 v132, v148
    v_exp_f32 v133, v149
    v_exp_f32 v134, v150
    v_exp_f32 v135, v151
    v_exp_f32 v136, v152
    v_exp_f32 v137, v153
    v_mfma_f32_4x4x4_16b_bf16 v[132:135], v[228:229], v[228:229], v[132:135]
    v_exp_f32 v138, v154
    v_exp_f32 v139, v155
    v_cvt_pk_bf16_f32 v208, v208, v209
    v_cvt_pk_bf16_f32 v209, v210, v211
    v_exp_f32 v140, v156
    v_exp_f32 v141, v157
    v_mfma_f32_4x4x4_16b_bf16 v[212:215], v[208:209], v[188:189], v[212:215] cbsz:4 abid:0
    v_mfma_f32_4x4x4_16b_bf16 v[136:139], v[228:229], v[228:229], v[136:139]
    v_exp_f32 v142, v158
    v_mfma_f32_4x4x4_16b_bf16 v[212:215], v[208:209], v[190:191], v[212:215] cbsz:4 abid:4
    v_exp_f32 v143, v159
    v_exp_f32 v144, v160
    v_mfma_f32_4x4x4_16b_bf16 v[212:215], v[208:209], v[192:193], v[212:215] cbsz:4 abid:8
    v_exp_f32 v145, v161
    v_mfma_f32_4x4x4_16b_bf16 v[140:143], v[228:229], v[228:229], v[140:143]
    v_mfma_f32_4x4x4_16b_bf16 v[212:215], v[208:209], v[194:195], v[212:215] cbsz:4 abid:12
    ds_read_u8 v230, v237 offset:80
    ds_read_u8 v232, v237 offset:88
    ds_read_b64_tr_b16 v[188:189], v236 offset:2080
    ds_read_b64_tr_b16 v[190:191], v236 offset:2592
    ds_read_b64_tr_b16 v[192:193], v236 offset:3136
    ds_read_b64_tr_b16 v[194:195], v236 offset:3648
    s_waitcnt vmcnt(4)
    ds_read_b128 v[180:183], v234 offset:4160
    ds_read_b128 v[184:187], v235 offset:4160
    s_add_u32 m0, s52, 2080
    v_exp_f32 v146, v162
    v_exp_f32 v147, v163
    v_rcp_f32 v132, v132
    v_rcp_f32 v133, v133
    v_mfma_f32_4x4x4_16b_bf16 v[144:147], v[228:229], v[228:229], v[144:147]
    v_rcp_f32 v134, v134
    v_cvt_pk_bf16_f32 v132, v132, v133
    s_waitcnt lgkmcnt(2)
    buffer_load_dwordx4 v[230:231], s[20:23], s35 idxen offen nt lds
    buffer_load_dwordx4 v[232:233], s[40:43], s35 idxen offen offset:1056 nt lds
    s_waitcnt lgkmcnt(0)
    v_mfma_f32_16x16x32_bf16 v[148:151], v[100:103], v[180:183], v[164:167]
    v_rcp_f32 v135, v135
    v_mfma_f32_16x16x32_bf16 v[152:155], v[108:111], v[180:183], v[168:171]
    v_rcp_f32 v136, v136
    v_cvt_pk_bf16_f32 v133, v134, v135
    v_mfma_f32_16x16x32_bf16 v[148:151], v[104:107], v[184:187], v[148:151]
    v_rcp_f32 v137, v137
    v_mfma_f32_16x16x32_bf16 v[152:155], v[112:115], v[184:187], v[152:155]
    v_rcp_f32 v138, v138
    v_cvt_pk_bf16_f32 v134, v136, v137
    v_mfma_f32_16x16x32_bf16 v[156:159], v[116:119], v[180:183], v[172:175]
    v_rcp_f32 v139, v139
    v_mfma_f32_16x16x32_bf16 v[160:163], v[124:127], v[180:183], v[176:179]
    v_rcp_f32 v140, v140
    v_cvt_pk_bf16_f32 v135, v138, v139
    v_mfma_f32_16x16x32_bf16 v[156:159], v[120:123], v[184:187], v[156:159]
    v_rcp_f32 v141, v141
    v_mfma_f32_16x16x32_bf16 v[160:163], v[128:131], v[184:187], v[160:163]
    v_rcp_f32 v142, v142
    v_cvt_pk_bf16_f32 v136, v140, v141
    v_mfma_f32_16x16x32_bf16 v[208:211], v[132:135], v[196:199], v[204:207]
    v_rcp_f32 v143, v143
    v_rcp_f32 v144, v144
    v_cvt_pk_bf16_f32 v137, v142, v143
    v_rcp_f32 v145, v145
    v_rcp_f32 v146, v146
    v_rcp_f32 v147, v147
    v_cvt_pk_bf16_f32 v138, v144, v145
    v_cvt_pk_bf16_f32 v139, v146, v147
    s_bitcmp1_b32 s36, 2
    s_cbranch_scc1 Ls_ev2
Ls_evd2:
    v_mfma_f32_16x16x32_bf16 v[208:211], v[136:139], v[200:203], v[208:211]
    ds_read_b32 v246, v244 offset:32
    s_waitcnt lgkmcnt(0)
    v_bfe_u32 v247, v246, 0, 8
    v_lshlrev_b32 v247, 1, v247
    v_bfe_u32 v248, v246, 8, 8
    v_lshlrev_b32 v248, 1, v248
    v_bfe_u32 v249, v246, 16, 8
    v_lshlrev_b32 v249, 1, v249
    v_bfe_u32 v250, v246, 24, 8
    v_lshlrev_b32 v250, 1, v250
    buffer_load_ushort v247, v247, s[24:27], 0 offen
    buffer_load_ushort v248, v248, s[24:27], 0 offen
    buffer_load_ushort v249, v249, s[24:27], 0 offen
    buffer_load_ushort v250, v250, s[24:27], 0 offen
    s_waitcnt vmcnt(0)
    v_lshlrev_b32 v247, 16, v247
    v_mul_f32 v208, v208, v247
    v_lshlrev_b32 v248, 16, v248
    v_mul_f32 v209, v209, v248
    v_lshlrev_b32 v249, 16, v249
    v_mul_f32 v210, v210, v249
    v_lshlrev_b32 v250, 16, v250
    v_mul_f32 v211, v211, v250
    v_exp_f32 v132, v148
    v_exp_f32 v133, v149
    v_exp_f32 v134, v150
    v_exp_f32 v135, v151
    v_exp_f32 v136, v152
    v_exp_f32 v137, v153
    v_mfma_f32_4x4x4_16b_bf16 v[132:135], v[228:229], v[228:229], v[132:135]
    v_exp_f32 v138, v154
    v_exp_f32 v139, v155
    v_cvt_pk_bf16_f32 v208, v208, v209
    v_cvt_pk_bf16_f32 v209, v210, v211
    v_exp_f32 v140, v156
    v_exp_f32 v141, v157
    v_mfma_f32_4x4x4_16b_bf16 v[212:215], v[208:209], v[188:189], v[212:215] cbsz:4 abid:0
    v_mfma_f32_4x4x4_16b_bf16 v[136:139], v[228:229], v[228:229], v[136:139]
    v_exp_f32 v142, v158
    v_mfma_f32_4x4x4_16b_bf16 v[212:215], v[208:209], v[190:191], v[212:215] cbsz:4 abid:4
    v_exp_f32 v143, v159
    v_exp_f32 v144, v160
    v_mfma_f32_4x4x4_16b_bf16 v[212:215], v[208:209], v[192:193], v[212:215] cbsz:4 abid:8
    v_exp_f32 v145, v161
    v_mfma_f32_4x4x4_16b_bf16 v[140:143], v[228:229], v[228:229], v[140:143]
    v_mfma_f32_4x4x4_16b_bf16 v[212:215], v[208:209], v[194:195], v[212:215] cbsz:4 abid:12
    ds_read_u8 v230, v237 offset:96
    ds_read_u8 v232, v237 offset:104
    ds_read_b64_tr_b16 v[188:189], v236 offset:4160
    ds_read_b64_tr_b16 v[190:191], v236 offset:4672
    ds_read_b64_tr_b16 v[192:193], v236 offset:5216
    ds_read_b64_tr_b16 v[194:195], v236 offset:5728
    s_waitcnt vmcnt(4)
    ds_read_b128 v[180:183], v234 offset:6240
    ds_read_b128 v[184:187], v235 offset:6240
    s_add_u32 m0, s52, 4160
    v_exp_f32 v146, v162
    v_exp_f32 v147, v163
    v_rcp_f32 v132, v132
    v_rcp_f32 v133, v133
    v_mfma_f32_4x4x4_16b_bf16 v[144:147], v[228:229], v[228:229], v[144:147]
    v_rcp_f32 v134, v134
    v_cvt_pk_bf16_f32 v132, v132, v133
    s_waitcnt lgkmcnt(2)
    buffer_load_dwordx4 v[230:231], s[20:23], s35 idxen offen nt lds
    buffer_load_dwordx4 v[232:233], s[40:43], s35 idxen offen offset:1056 nt lds
    s_waitcnt lgkmcnt(0)
    v_mfma_f32_16x16x32_bf16 v[148:151], v[100:103], v[180:183], v[164:167]
    v_rcp_f32 v135, v135
    v_mfma_f32_16x16x32_bf16 v[152:155], v[108:111], v[180:183], v[168:171]
    v_rcp_f32 v136, v136
    v_cvt_pk_bf16_f32 v133, v134, v135
    v_mfma_f32_16x16x32_bf16 v[148:151], v[104:107], v[184:187], v[148:151]
    v_rcp_f32 v137, v137
    v_mfma_f32_16x16x32_bf16 v[152:155], v[112:115], v[184:187], v[152:155]
    v_rcp_f32 v138, v138
    v_cvt_pk_bf16_f32 v134, v136, v137
    v_mfma_f32_16x16x32_bf16 v[156:159], v[116:119], v[180:183], v[172:175]
    v_rcp_f32 v139, v139
    v_mfma_f32_16x16x32_bf16 v[160:163], v[124:127], v[180:183], v[176:179]
    v_rcp_f32 v140, v140
    v_cvt_pk_bf16_f32 v135, v138, v139
    v_mfma_f32_16x16x32_bf16 v[156:159], v[120:123], v[184:187], v[156:159]
    v_rcp_f32 v141, v141
    v_mfma_f32_16x16x32_bf16 v[160:163], v[128:131], v[184:187], v[160:163]
    v_rcp_f32 v142, v142
    v_cvt_pk_bf16_f32 v136, v140, v141
    v_mfma_f32_16x16x32_bf16 v[208:211], v[132:135], v[196:199], v[204:207]
    v_rcp_f32 v143, v143
    v_rcp_f32 v144, v144
    v_cvt_pk_bf16_f32 v137, v142, v143
    v_rcp_f32 v145, v145
    v_rcp_f32 v146, v146
    v_rcp_f32 v147, v147
    v_cvt_pk_bf16_f32 v138, v144, v145
    v_cvt_pk_bf16_f32 v139, v146, v147
    s_bitcmp1_b32 s36, 3
    s_cbranch_scc1 Ls_ev3
Ls_evd3:
    v_mfma_f32_16x16x32_bf16 v[208:211], v[136:139], v[200:203], v[208:211]
    ds_read_b32 v246, v244 offset:48
    s_waitcnt lgkmcnt(0)
    v_bfe_u32 v247, v246, 0, 8
    v_lshlrev_b32 v247, 1, v247
    v_bfe_u32 v248, v246, 8, 8
    v_lshlrev_b32 v248, 1, v248
    v_bfe_u32 v249, v246, 16, 8
    v_lshlrev_b32 v249, 1, v249
    v_bfe_u32 v250, v246, 24, 8
    v_lshlrev_b32 v250, 1, v250
    buffer_load_ushort v247, v247, s[24:27], 0 offen
    buffer_load_ushort v248, v248, s[24:27], 0 offen
    buffer_load_ushort v249, v249, s[24:27], 0 offen
    buffer_load_ushort v250, v250, s[24:27], 0 offen
    s_waitcnt vmcnt(0)
    v_lshlrev_b32 v247, 16, v247
    v_mul_f32 v208, v208, v247
    v_lshlrev_b32 v248, 16, v248
    v_mul_f32 v209, v209, v248
    v_lshlrev_b32 v249, 16, v249
    v_mul_f32 v210, v210, v249
    v_lshlrev_b32 v250, 16, v250
    v_mul_f32 v211, v211, v250
    v_exp_f32 v132, v148
    v_exp_f32 v133, v149
    v_exp_f32 v134, v150
    v_exp_f32 v135, v151
    v_exp_f32 v136, v152
    v_exp_f32 v137, v153
    v_mfma_f32_4x4x4_16b_bf16 v[132:135], v[228:229], v[228:229], v[132:135]
    v_exp_f32 v138, v154
    v_exp_f32 v139, v155
    v_cvt_pk_bf16_f32 v208, v208, v209
    v_cvt_pk_bf16_f32 v209, v210, v211
    v_exp_f32 v140, v156
    v_exp_f32 v141, v157
    v_mfma_f32_4x4x4_16b_bf16 v[212:215], v[208:209], v[188:189], v[212:215] cbsz:4 abid:0
    v_mfma_f32_4x4x4_16b_bf16 v[136:139], v[228:229], v[228:229], v[136:139]
    v_exp_f32 v142, v158
    v_mfma_f32_4x4x4_16b_bf16 v[212:215], v[208:209], v[190:191], v[212:215] cbsz:4 abid:4
    v_exp_f32 v143, v159
    v_exp_f32 v144, v160
    v_mfma_f32_4x4x4_16b_bf16 v[212:215], v[208:209], v[192:193], v[212:215] cbsz:4 abid:8
    v_exp_f32 v145, v161
    v_mfma_f32_4x4x4_16b_bf16 v[140:143], v[228:229], v[228:229], v[140:143]
    v_mfma_f32_4x4x4_16b_bf16 v[212:215], v[208:209], v[194:195], v[212:215] cbsz:4 abid:12
    ds_read_u8 v230, v237 offset:112
    ds_read_u8 v232, v237 offset:120
    ds_read_b64_tr_b16 v[188:189], v236 offset:6240
    ds_read_b64_tr_b16 v[190:191], v236 offset:6752
    ds_read_b64_tr_b16 v[192:193], v236 offset:7296
    ds_read_b64_tr_b16 v[194:195], v236 offset:7808
    s_waitcnt vmcnt(4)
    ds_read_b128 v[180:183], v234 offset:0
    ds_read_b128 v[184:187], v235 offset:0
    s_add_u32 m0, s52, 6240
    v_exp_f32 v146, v162
    v_exp_f32 v147, v163
    v_rcp_f32 v132, v132
    v_rcp_f32 v133, v133
    v_mfma_f32_4x4x4_16b_bf16 v[144:147], v[228:229], v[228:229], v[144:147]
    v_rcp_f32 v134, v134
    v_cvt_pk_bf16_f32 v132, v132, v133
    s_waitcnt lgkmcnt(2)
    buffer_load_dwordx4 v[230:231], s[20:23], s35 idxen offen nt lds
    buffer_load_dwordx4 v[232:233], s[40:43], s35 idxen offen offset:1056 nt lds
    s_waitcnt lgkmcnt(0)
    v_mfma_f32_16x16x32_bf16 v[148:151], v[100:103], v[180:183], v[164:167]
    v_rcp_f32 v135, v135
    v_mfma_f32_16x16x32_bf16 v[152:155], v[108:111], v[180:183], v[168:171]
    v_rcp_f32 v136, v136
    v_cvt_pk_bf16_f32 v133, v134, v135
    v_mfma_f32_16x16x32_bf16 v[148:151], v[104:107], v[184:187], v[148:151]
    v_rcp_f32 v137, v137
    v_mfma_f32_16x16x32_bf16 v[152:155], v[112:115], v[184:187], v[152:155]
    v_rcp_f32 v138, v138
    v_cvt_pk_bf16_f32 v134, v136, v137
    v_mfma_f32_16x16x32_bf16 v[156:159], v[116:119], v[180:183], v[172:175]
    v_rcp_f32 v139, v139
    v_mfma_f32_16x16x32_bf16 v[160:163], v[124:127], v[180:183], v[176:179]
    v_rcp_f32 v140, v140
    v_cvt_pk_bf16_f32 v135, v138, v139
    v_mfma_f32_16x16x32_bf16 v[156:159], v[120:123], v[184:187], v[156:159]
    v_rcp_f32 v141, v141
    v_mfma_f32_16x16x32_bf16 v[160:163], v[128:131], v[184:187], v[160:163]
    v_rcp_f32 v142, v142
    v_cvt_pk_bf16_f32 v136, v140, v141
    v_mfma_f32_16x16x32_bf16 v[208:211], v[132:135], v[196:199], v[204:207]
    v_rcp_f32 v143, v143
    v_rcp_f32 v144, v144
    v_cvt_pk_bf16_f32 v137, v142, v143
    s_lshr_b64 s[56:57], s[56:57], 4
    s_lshr_b64 s[86:87], s[56:57], 2
    s_lshr_b64 s[36:37], s[56:57], 5
    s_or_b32 s37, s36, s86
    s_or_b32 s36, s37, s56
    v_add_u32 v237, 64, v237
    v_add_u32 v244, 64, v244
    v_rcp_f32 v145, v145
    v_rcp_f32 v146, v146
    v_rcp_f32 v147, v147
    v_cvt_pk_bf16_f32 v138, v144, v145
    v_cvt_pk_bf16_f32 v139, v146, v147
    s_branch Ls_loop
Ls_fl0:
    v_cvt_pk_bf16_f32 v246, v212, v212
    v_mov_b32 v212, 0
    ds_write_b16 v240, v246
    v_add_u32 v240, 128, v240
    s_add_u32 s24, s24, s32
    s_addc_u32 s25, s25, 0
    s_xor_b32 s32, s32, 0x18ffe0
    s_bitcmp0_b32 s37, 0
    s_cbranch_scc1 Ls_evd0
    s_branch Ls_ev20
Ls_ev0:
    s_bitcmp1_b64 s[56:57], 0
    s_cbranch_scc1 Ls_fl0
Ls_ev20:
    s_bitcmp1_b64 s[56:57], 2
    s_cbranch_scc1 Ls_w0
    s_sub_u32 s60, s60, 1
    s_cbranch_scc0 Ls_nsa0
    s_mov_b32 s49, 5
    s_call_b64 s[62:63], L_swap
Ls_nsa0:
    s_add_u32 s35, s35, s31
    s_min_u32 s35, s35, 419404800
    s_xor_b32 s31, s31, 0x63ff800
    s_branch Ls_evd0
Ls_w0:
    s_bitcmp0_b64 s[56:57], 5
    s_cbranch_scc1 Ls_e10
    s_sub_u32 s60, s60, 1
    s_cbranch_scc0 Ls_nsb0
    s_mov_b32 s49, 5
    s_call_b64 s[62:63], L_swap
    s_waitcnt lgkmcnt(0)
Ls_nsb0:
    s_add_u32 s35, s35, s31
    s_min_u32 s35, s35, 419404800
    s_xor_b32 s31, s31, 0x63ff800
Ls_e10:
    s_sub_u32 s61, s61, 1
    s_cbranch_scc1 Ls_last0
    s_bitcmp0_b32 s33, s61
    s_cbranch_scc1 Ls_nw0
    s_cmp_eq_u32 s61, 3
    s_cselect_b32 s66, s80, s81
    v_add_u32 v238, s66, v238
    v_add_u32 v239, s66, v239
    ds_read_u16 v224, v238 offset:0
    ds_read_u16 v225, v238 offset:8
    ds_read_u16 v226, v238 offset:64
    ds_read_u16 v227, v238 offset:72
    s_waitcnt lgkmcnt(0)
Ls_nw0:
    v_mul_u32_u24 v216, v224, v241
    v_mul_u32_u24 v217, v224, v242
    v_mul_u32_u24 v218, v225, v241
    v_mul_u32_u24 v219, v225, v242
    v_mul_u32_u24 v220, v226, v241
    v_mul_u32_u24 v221, v226, v242
    v_mul_u32_u24 v222, v227, v241
    v_mul_u32_u24 v223, v227, v242
    v_mfma_f32_4x4x4_16b_bf16 v[140:143], v[216:217], v[68:69], v[4:7]
    v_add_u32 v238, 128, v238
    ds_read_b128 v[164:167], v239 offset:0
    ds_read_b128 v[168:171], v239 offset:64
    v_mfma_f32_4x4x4_16b_bf16 v[144:147], v[218:219], v[70:71], v[8:11]
    ds_read_b128 v[172:175], v239 offset:128
    ds_read_b128 v[176:179], v239 offset:192
    ds_read_u16 v224, v238 offset:0
    ds_read_u16 v225, v238 offset:8
    ds_read_u16 v226, v238 offset:64
    ds_read_u16 v227, v238 offset:72
    v_mfma_f32_4x4x4_16b_bf16 v[246:249], v[220:221], v[72:73], v[12:15]
    v_cvt_pk_bf16_f32 v100, v140, v141
    v_cvt_pk_bf16_f32 v101, v142, v143
    v_mfma_f32_4x4x4_16b_bf16 v[250:253], v[222:223], v[74:75], v[16:19]
    v_cvt_pk_bf16_f32 v102, v144, v145
    v_cvt_pk_bf16_f32 v103, v146, v147
    v_mfma_f32_4x4x4_16b_bf16 v[140:143], v[216:217], v[76:77], v[20:23]
    v_cvt_pk_bf16_f32 v104, v246, v247
    v_cvt_pk_bf16_f32 v105, v248, v249
    v_mfma_f32_4x4x4_16b_bf16 v[144:147], v[218:219], v[78:79], v[24:27]
    v_cvt_pk_bf16_f32 v106, v250, v251
    v_cvt_pk_bf16_f32 v107, v252, v253
    v_mfma_f32_4x4x4_16b_bf16 v[246:249], v[220:221], v[80:81], v[28:31]
    v_cvt_pk_bf16_f32 v108, v140, v141
    v_cvt_pk_bf16_f32 v109, v142, v143
    v_mfma_f32_4x4x4_16b_bf16 v[250:253], v[222:223], v[82:83], v[32:35]
    v_cvt_pk_bf16_f32 v110, v144, v145
    v_cvt_pk_bf16_f32 v111, v146, v147
    v_mfma_f32_4x4x4_16b_bf16 v[140:143], v[216:217], v[84:85], v[36:39]
    v_cvt_pk_bf16_f32 v112, v246, v247
    v_cvt_pk_bf16_f32 v113, v248, v249
    v_mfma_f32_4x4x4_16b_bf16 v[144:147], v[218:219], v[86:87], v[40:43]
    v_cvt_pk_bf16_f32 v114, v250, v251
    v_cvt_pk_bf16_f32 v115, v252, v253
    v_mfma_f32_4x4x4_16b_bf16 v[246:249], v[220:221], v[88:89], v[44:47]
    v_cvt_pk_bf16_f32 v116, v140, v141
    v_cvt_pk_bf16_f32 v117, v142, v143
    v_mfma_f32_4x4x4_16b_bf16 v[250:253], v[222:223], v[90:91], v[48:51]
    v_cvt_pk_bf16_f32 v118, v144, v145
    v_cvt_pk_bf16_f32 v119, v146, v147
    v_mfma_f32_4x4x4_16b_bf16 v[140:143], v[216:217], v[92:93], v[52:55]
    v_cvt_pk_bf16_f32 v120, v246, v247
    v_cvt_pk_bf16_f32 v121, v248, v249
    v_mfma_f32_4x4x4_16b_bf16 v[144:147], v[218:219], v[94:95], v[56:59]
    v_cvt_pk_bf16_f32 v122, v250, v251
    v_cvt_pk_bf16_f32 v123, v252, v253
    v_mfma_f32_4x4x4_16b_bf16 v[246:249], v[220:221], v[96:97], v[60:63]
    v_cvt_pk_bf16_f32 v124, v140, v141
    v_cvt_pk_bf16_f32 v125, v142, v143
    v_mfma_f32_4x4x4_16b_bf16 v[250:253], v[222:223], v[98:99], v[64:67]
    v_cvt_pk_bf16_f32 v126, v144, v145
    v_cvt_pk_bf16_f32 v127, v146, v147
    v_cvt_pk_bf16_f32 v128, v246, v247
    v_cvt_pk_bf16_f32 v129, v248, v249
    v_add_u32 v239, 272, v239
    v_cvt_pk_bf16_f32 v130, v250, v251
    v_cvt_pk_bf16_f32 v131, v252, v253
    s_waitcnt lgkmcnt(0)
    s_branch Ls_evd0
Ls_fl1:
    v_cvt_pk_bf16_f32 v246, v212, v212
    v_mov_b32 v212, 0
    ds_write_b16 v240, v246
    v_add_u32 v240, 128, v240
    s_add_u32 s24, s24, s32
    s_addc_u32 s25, s25, 0
    s_xor_b32 s32, s32, 0x18ffe0
    s_bitcmp0_b32 s37, 1
    s_cbranch_scc1 Ls_evd1
    s_branch Ls_ev21
Ls_ev1:
    s_bitcmp1_b64 s[56:57], 1
    s_cbranch_scc1 Ls_fl1
Ls_ev21:
    s_bitcmp1_b64 s[56:57], 3
    s_cbranch_scc1 Ls_w1
    s_sub_u32 s60, s60, 1
    s_cbranch_scc0 Ls_nsa1
    s_mov_b32 s49, 6
    s_call_b64 s[62:63], L_swap
Ls_nsa1:
    s_add_u32 s35, s35, s31
    s_min_u32 s35, s35, 419404800
    s_xor_b32 s31, s31, 0x63ff800
    s_branch Ls_evd1
Ls_w1:
    s_bitcmp0_b64 s[56:57], 6
    s_cbranch_scc1 Ls_e11
    s_sub_u32 s60, s60, 1
    s_cbranch_scc0 Ls_nsb1
    s_mov_b32 s49, 6
    s_call_b64 s[62:63], L_swap
    s_waitcnt lgkmcnt(0)
Ls_nsb1:
    s_add_u32 s35, s35, s31
    s_min_u32 s35, s35, 419404800
    s_xor_b32 s31, s31, 0x63ff800
Ls_e11:
    s_sub_u32 s61, s61, 1
    s_cbranch_scc1 Ls_last1
    s_bitcmp0_b32 s33, s61
    s_cbranch_scc1 Ls_nw1
    s_cmp_eq_u32 s61, 3
    s_cselect_b32 s66, s80, s81
    v_add_u32 v238, s66, v238
    v_add_u32 v239, s66, v239
    ds_read_u16 v224, v238 offset:0
    ds_read_u16 v225, v238 offset:8
    ds_read_u16 v226, v238 offset:64
    ds_read_u16 v227, v238 offset:72
    s_waitcnt lgkmcnt(0)
Ls_nw1:
    v_mul_u32_u24 v216, v224, v241
    v_mul_u32_u24 v217, v224, v242
    v_mul_u32_u24 v218, v225, v241
    v_mul_u32_u24 v219, v225, v242
    v_mul_u32_u24 v220, v226, v241
    v_mul_u32_u24 v221, v226, v242
    v_mul_u32_u24 v222, v227, v241
    v_mul_u32_u24 v223, v227, v242
    v_mfma_f32_4x4x4_16b_bf16 v[140:143], v[216:217], v[68:69], v[4:7]
    v_add_u32 v238, 128, v238
    ds_read_b128 v[164:167], v239 offset:0
    ds_read_b128 v[168:171], v239 offset:64
    v_mfma_f32_4x4x4_16b_bf16 v[144:147], v[218:219], v[70:71], v[8:11]
    ds_read_b128 v[172:175], v239 offset:128
    ds_read_b128 v[176:179], v239 offset:192
    ds_read_u16 v224, v238 offset:0
    ds_read_u16 v225, v238 offset:8
    ds_read_u16 v226, v238 offset:64
    ds_read_u16 v227, v238 offset:72
    v_mfma_f32_4x4x4_16b_bf16 v[246:249], v[220:221], v[72:73], v[12:15]
    v_cvt_pk_bf16_f32 v100, v140, v141
    v_cvt_pk_bf16_f32 v101, v142, v143
    v_mfma_f32_4x4x4_16b_bf16 v[250:253], v[222:223], v[74:75], v[16:19]
    v_cvt_pk_bf16_f32 v102, v144, v145
    v_cvt_pk_bf16_f32 v103, v146, v147
    v_mfma_f32_4x4x4_16b_bf16 v[140:143], v[216:217], v[76:77], v[20:23]
    v_cvt_pk_bf16_f32 v104, v246, v247
    v_cvt_pk_bf16_f32 v105, v248, v249
    v_mfma_f32_4x4x4_16b_bf16 v[144:147], v[218:219], v[78:79], v[24:27]
    v_cvt_pk_bf16_f32 v106, v250, v251
    v_cvt_pk_bf16_f32 v107, v252, v253
    v_mfma_f32_4x4x4_16b_bf16 v[246:249], v[220:221], v[80:81], v[28:31]
    v_cvt_pk_bf16_f32 v108, v140, v141
    v_cvt_pk_bf16_f32 v109, v142, v143
    v_mfma_f32_4x4x4_16b_bf16 v[250:253], v[222:223], v[82:83], v[32:35]
    v_cvt_pk_bf16_f32 v110, v144, v145
    v_cvt_pk_bf16_f32 v111, v146, v147
    v_mfma_f32_4x4x4_16b_bf16 v[140:143], v[216:217], v[84:85], v[36:39]
    v_cvt_pk_bf16_f32 v112, v246, v247
    v_cvt_pk_bf16_f32 v113, v248, v249
    v_mfma_f32_4x4x4_16b_bf16 v[144:147], v[218:219], v[86:87], v[40:43]
    v_cvt_pk_bf16_f32 v114, v250, v251
    v_cvt_pk_bf16_f32 v115, v252, v253
    v_mfma_f32_4x4x4_16b_bf16 v[246:249], v[220:221], v[88:89], v[44:47]
    v_cvt_pk_bf16_f32 v116, v140, v141
    v_cvt_pk_bf16_f32 v117, v142, v143
    v_mfma_f32_4x4x4_16b_bf16 v[250:253], v[222:223], v[90:91], v[48:51]
    v_cvt_pk_bf16_f32 v118, v144, v145
    v_cvt_pk_bf16_f32 v119, v146, v147
    v_mfma_f32_4x4x4_16b_bf16 v[140:143], v[216:217], v[92:93], v[52:55]
    v_cvt_pk_bf16_f32 v120, v246, v247
    v_cvt_pk_bf16_f32 v121, v248, v249
    v_mfma_f32_4x4x4_16b_bf16 v[144:147], v[218:219], v[94:95], v[56:59]
    v_cvt_pk_bf16_f32 v122, v250, v251
    v_cvt_pk_bf16_f32 v123, v252, v253
    v_mfma_f32_4x4x4_16b_bf16 v[246:249], v[220:221], v[96:97], v[60:63]
    v_cvt_pk_bf16_f32 v124, v140, v141
    v_cvt_pk_bf16_f32 v125, v142, v143
    v_mfma_f32_4x4x4_16b_bf16 v[250:253], v[222:223], v[98:99], v[64:67]
    v_cvt_pk_bf16_f32 v126, v144, v145
    v_cvt_pk_bf16_f32 v127, v146, v147
    v_cvt_pk_bf16_f32 v128, v246, v247
    v_cvt_pk_bf16_f32 v129, v248, v249
    v_add_u32 v239, 272, v239
    v_cvt_pk_bf16_f32 v130, v250, v251
    v_cvt_pk_bf16_f32 v131, v252, v253
    s_waitcnt lgkmcnt(0)
    s_branch Ls_evd1
Ls_fl2:
    v_cvt_pk_bf16_f32 v246, v212, v212
    v_mov_b32 v212, 0
    ds_write_b16 v240, v246
    v_add_u32 v240, 128, v240
    s_add_u32 s24, s24, s32
    s_addc_u32 s25, s25, 0
    s_xor_b32 s32, s32, 0x18ffe0
    s_bitcmp0_b32 s37, 2
    s_cbranch_scc1 Ls_evd2
    s_branch Ls_ev22
Ls_ev2:
    s_bitcmp1_b64 s[56:57], 2
    s_cbranch_scc1 Ls_fl2
Ls_ev22:
    s_bitcmp1_b64 s[56:57], 4
    s_cbranch_scc1 Ls_w2
    s_sub_u32 s60, s60, 1
    s_cbranch_scc0 Ls_nsa2
    s_mov_b32 s49, 7
    s_call_b64 s[62:63], L_swap
Ls_nsa2:
    s_add_u32 s35, s35, s31
    s_min_u32 s35, s35, 419404800
    s_xor_b32 s31, s31, 0x63ff800
    s_branch Ls_evd2
Ls_w2:
    s_bitcmp0_b64 s[56:57], 7
    s_cbranch_scc1 Ls_e12
    s_sub_u32 s60, s60, 1
    s_cbranch_scc0 Ls_nsb2
    s_mov_b32 s49, 7
    s_call_b64 s[62:63], L_swap
    s_waitcnt lgkmcnt(0)
Ls_nsb2:
    s_add_u32 s35, s35, s31
    s_min_u32 s35, s35, 419404800
    s_xor_b32 s31, s31, 0x63ff800
Ls_e12:
    s_sub_u32 s61, s61, 1
    s_cbranch_scc1 Ls_last2
    s_bitcmp0_b32 s33, s61
    s_cbranch_scc1 Ls_nw2
    s_cmp_eq_u32 s61, 3
    s_cselect_b32 s66, s80, s81
    v_add_u32 v238, s66, v238
    v_add_u32 v239, s66, v239
    ds_read_u16 v224, v238 offset:0
    ds_read_u16 v225, v238 offset:8
    ds_read_u16 v226, v238 offset:64
    ds_read_u16 v227, v238 offset:72
    s_waitcnt lgkmcnt(0)
Ls_nw2:
    v_mul_u32_u24 v216, v224, v241
    v_mul_u32_u24 v217, v224, v242
    v_mul_u32_u24 v218, v225, v241
    v_mul_u32_u24 v219, v225, v242
    v_mul_u32_u24 v220, v226, v241
    v_mul_u32_u24 v221, v226, v242
    v_mul_u32_u24 v222, v227, v241
    v_mul_u32_u24 v223, v227, v242
    v_mfma_f32_4x4x4_16b_bf16 v[140:143], v[216:217], v[68:69], v[4:7]
    v_add_u32 v238, 128, v238
    ds_read_b128 v[164:167], v239 offset:0
    ds_read_b128 v[168:171], v239 offset:64
    v_mfma_f32_4x4x4_16b_bf16 v[144:147], v[218:219], v[70:71], v[8:11]
    ds_read_b128 v[172:175], v239 offset:128
    ds_read_b128 v[176:179], v239 offset:192
    ds_read_u16 v224, v238 offset:0
    ds_read_u16 v225, v238 offset:8
    ds_read_u16 v226, v238 offset:64
    ds_read_u16 v227, v238 offset:72
    v_mfma_f32_4x4x4_16b_bf16 v[246:249], v[220:221], v[72:73], v[12:15]
    v_cvt_pk_bf16_f32 v100, v140, v141
    v_cvt_pk_bf16_f32 v101, v142, v143
    v_mfma_f32_4x4x4_16b_bf16 v[250:253], v[222:223], v[74:75], v[16:19]
    v_cvt_pk_bf16_f32 v102, v144, v145
    v_cvt_pk_bf16_f32 v103, v146, v147
    v_mfma_f32_4x4x4_16b_bf16 v[140:143], v[216:217], v[76:77], v[20:23]
    v_cvt_pk_bf16_f32 v104, v246, v247
    v_cvt_pk_bf16_f32 v105, v248, v249
    v_mfma_f32_4x4x4_16b_bf16 v[144:147], v[218:219], v[78:79], v[24:27]
    v_cvt_pk_bf16_f32 v106, v250, v251
    v_cvt_pk_bf16_f32 v107, v252, v253
    v_mfma_f32_4x4x4_16b_bf16 v[246:249], v[220:221], v[80:81], v[28:31]
    v_cvt_pk_bf16_f32 v108, v140, v141
    v_cvt_pk_bf16_f32 v109, v142, v143
    v_mfma_f32_4x4x4_16b_bf16 v[250:253], v[222:223], v[82:83], v[32:35]
    v_cvt_pk_bf16_f32 v110, v144, v145
    v_cvt_pk_bf16_f32 v111, v146, v147
    v_mfma_f32_4x4x4_16b_bf16 v[140:143], v[216:217], v[84:85], v[36:39]
    v_cvt_pk_bf16_f32 v112, v246, v247
    v_cvt_pk_bf16_f32 v113, v248, v249
    v_mfma_f32_4x4x4_16b_bf16 v[144:147], v[218:219], v[86:87], v[40:43]
    v_cvt_pk_bf16_f32 v114, v250, v251
    v_cvt_pk_bf16_f32 v115, v252, v253
    v_mfma_f32_4x4x4_16b_bf16 v[246:249], v[220:221], v[88:89], v[44:47]
    v_cvt_pk_bf16_f32 v116, v140, v141
    v_cvt_pk_bf16_f32 v117, v142, v143
    v_mfma_f32_4x4x4_16b_bf16 v[250:253], v[222:223], v[90:91], v[48:51]
    v_cvt_pk_bf16_f32 v118, v144, v145
    v_cvt_pk_bf16_f32 v119, v146, v147
    v_mfma_f32_4x4x4_16b_bf16 v[140:143], v[216:217], v[92:93], v[52:55]
    v_cvt_pk_bf16_f32 v120, v246, v247
    v_cvt_pk_bf16_f32 v121, v248, v249
    v_mfma_f32_4x4x4_16b_bf16 v[144:147], v[218:219], v[94:95], v[56:59]
    v_cvt_pk_bf16_f32 v122, v250, v251
    v_cvt_pk_bf16_f32 v123, v252, v253
    v_mfma_f32_4x4x4_16b_bf16 v[246:249], v[220:221], v[96:97], v[60:63]
    v_cvt_pk_bf16_f32 v124, v140, v141
    v_cvt_pk_bf16_f32 v125, v142, v143
    v_mfma_f32_4x4x4_16b_bf16 v[250:253], v[222:223], v[98:99], v[64:67]
    v_cvt_pk_bf16_f32 v126, v144, v145
    v_cvt_pk_bf16_f32 v127, v146, v147
    v_cvt_pk_bf16_f32 v128, v246, v247
    v_cvt_pk_bf16_f32 v129, v248, v249
    v_add_u32 v239, 272, v239
    v_cvt_pk_bf16_f32 v130, v250, v251
    v_cvt_pk_bf16_f32 v131, v252, v253
    s_waitcnt lgkmcnt(0)
    s_branch Ls_evd2
Ls_fl3:
    v_cvt_pk_bf16_f32 v246, v212, v212
    v_mov_b32 v212, 0
    ds_write_b16 v240, v246
    v_add_u32 v240, 128, v240
    s_add_u32 s24, s24, s32
    s_addc_u32 s25, s25, 0
    s_xor_b32 s32, s32, 0x18ffe0
    s_bitcmp0_b32 s37, 3
    s_cbranch_scc1 Ls_evd3
    s_branch Ls_ev23
Ls_ev3:
    s_bitcmp1_b64 s[56:57], 3
    s_cbranch_scc1 Ls_fl3
Ls_ev23:
    s_bitcmp1_b64 s[56:57], 5
    s_cbranch_scc1 Ls_w3
    s_sub_u32 s60, s60, 1
    s_cbranch_scc0 Ls_nsa3
    s_mov_b32 s49, 8
    s_call_b64 s[62:63], L_swap
Ls_nsa3:
    s_add_u32 s35, s35, s31
    s_min_u32 s35, s35, 419404800
    s_xor_b32 s31, s31, 0x63ff800
    s_branch Ls_evd3
Ls_w3:
    s_bitcmp0_b64 s[56:57], 8
    s_cbranch_scc1 Ls_e13
    s_sub_u32 s60, s60, 1
    s_cbranch_scc0 Ls_nsb3
    s_mov_b32 s49, 8
    s_call_b64 s[62:63], L_swap
    s_waitcnt lgkmcnt(0)
Ls_nsb3:
    s_add_u32 s35, s35, s31
    s_min_u32 s35, s35, 419404800
    s_xor_b32 s31, s31, 0x63ff800
Ls_e13:
    s_sub_u32 s61, s61, 1
    s_cbranch_scc1 Ls_last3
    s_bitcmp0_b32 s33, s61
    s_cbranch_scc1 Ls_nw3
    s_cmp_eq_u32 s61, 3
    s_cselect_b32 s66, s80, s81
    v_add_u32 v238, s66, v238
    v_add_u32 v239, s66, v239
    ds_read_u16 v224, v238 offset:0
    ds_read_u16 v225, v238 offset:8
    ds_read_u16 v226, v238 offset:64
    ds_read_u16 v227, v238 offset:72
    s_waitcnt lgkmcnt(0)
Ls_nw3:
    v_mul_u32_u24 v216, v224, v241
    v_mul_u32_u24 v217, v224, v242
    v_mul_u32_u24 v218, v225, v241
    v_mul_u32_u24 v219, v225, v242
    v_mul_u32_u24 v220, v226, v241
    v_mul_u32_u24 v221, v226, v242
    v_mul_u32_u24 v222, v227, v241
    v_mul_u32_u24 v223, v227, v242
    v_mfma_f32_4x4x4_16b_bf16 v[140:143], v[216:217], v[68:69], v[4:7]
    v_add_u32 v238, 128, v238
    ds_read_b128 v[164:167], v239 offset:0
    ds_read_b128 v[168:171], v239 offset:64
    v_mfma_f32_4x4x4_16b_bf16 v[144:147], v[218:219], v[70:71], v[8:11]
    ds_read_b128 v[172:175], v239 offset:128
    ds_read_b128 v[176:179], v239 offset:192
    ds_read_u16 v224, v238 offset:0
    ds_read_u16 v225, v238 offset:8
    ds_read_u16 v226, v238 offset:64
    ds_read_u16 v227, v238 offset:72
    v_mfma_f32_4x4x4_16b_bf16 v[246:249], v[220:221], v[72:73], v[12:15]
    v_cvt_pk_bf16_f32 v100, v140, v141
    v_cvt_pk_bf16_f32 v101, v142, v143
    v_mfma_f32_4x4x4_16b_bf16 v[250:253], v[222:223], v[74:75], v[16:19]
    v_cvt_pk_bf16_f32 v102, v144, v145
    v_cvt_pk_bf16_f32 v103, v146, v147
    v_mfma_f32_4x4x4_16b_bf16 v[140:143], v[216:217], v[76:77], v[20:23]
    v_cvt_pk_bf16_f32 v104, v246, v247
    v_cvt_pk_bf16_f32 v105, v248, v249
    v_mfma_f32_4x4x4_16b_bf16 v[144:147], v[218:219], v[78:79], v[24:27]
    v_cvt_pk_bf16_f32 v106, v250, v251
    v_cvt_pk_bf16_f32 v107, v252, v253
    v_mfma_f32_4x4x4_16b_bf16 v[246:249], v[220:221], v[80:81], v[28:31]
    v_cvt_pk_bf16_f32 v108, v140, v141
    v_cvt_pk_bf16_f32 v109, v142, v143
    v_mfma_f32_4x4x4_16b_bf16 v[250:253], v[222:223], v[82:83], v[32:35]
    v_cvt_pk_bf16_f32 v110, v144, v145
    v_cvt_pk_bf16_f32 v111, v146, v147
    v_mfma_f32_4x4x4_16b_bf16 v[140:143], v[216:217], v[84:85], v[36:39]
    v_cvt_pk_bf16_f32 v112, v246, v247
    v_cvt_pk_bf16_f32 v113, v248, v249
    v_mfma_f32_4x4x4_16b_bf16 v[144:147], v[218:219], v[86:87], v[40:43]
    v_cvt_pk_bf16_f32 v114, v250, v251
    v_cvt_pk_bf16_f32 v115, v252, v253
    v_mfma_f32_4x4x4_16b_bf16 v[246:249], v[220:221], v[88:89], v[44:47]
    v_cvt_pk_bf16_f32 v116, v140, v141
    v_cvt_pk_bf16_f32 v117, v142, v143
    v_mfma_f32_4x4x4_16b_bf16 v[250:253], v[222:223], v[90:91], v[48:51]
    v_cvt_pk_bf16_f32 v118, v144, v145
    v_cvt_pk_bf16_f32 v119, v146, v147
    v_mfma_f32_4x4x4_16b_bf16 v[140:143], v[216:217], v[92:93], v[52:55]
    v_cvt_pk_bf16_f32 v120, v246, v247
    v_cvt_pk_bf16_f32 v121, v248, v249
    v_mfma_f32_4x4x4_16b_bf16 v[144:147], v[218:219], v[94:95], v[56:59]
    v_cvt_pk_bf16_f32 v122, v250, v251
    v_cvt_pk_bf16_f32 v123, v252, v253
    v_mfma_f32_4x4x4_16b_bf16 v[246:249], v[220:221], v[96:97], v[60:63]
    v_cvt_pk_bf16_f32 v124, v140, v141
    v_cvt_pk_bf16_f32 v125, v142, v143
    v_mfma_f32_4x4x4_16b_bf16 v[250:253], v[222:223], v[98:99], v[64:67]
    v_cvt_pk_bf16_f32 v126, v144, v145
    v_cvt_pk_bf16_f32 v127, v146, v147
    v_cvt_pk_bf16_f32 v128, v246, v247
    v_cvt_pk_bf16_f32 v129, v248, v249
    v_add_u32 v239, 272, v239
    v_cvt_pk_bf16_f32 v130, v250, v251
    v_cvt_pk_bf16_f32 v131, v252, v253
    s_waitcnt lgkmcnt(0)
    s_branch Ls_evd3
Ls_last0:
    s_branch Ls_tail
Ls_last1:
    v_add_u32 v236, 2080, v236
    s_lshr_b64 s[56:57], s[56:57], 1
    v_add_u32 v244, 16, v244
    s_branch Ls_tail
Ls_last2:
    v_add_u32 v236, 4160, v236
    s_lshr_b64 s[56:57], s[56:57], 2
    v_add_u32 v244, 32, v244
    s_branch Ls_tail
Ls_last3:
    v_add_u32 v236, 6240, v236
    s_lshr_b64 s[56:57], s[56:57], 3
    v_add_u32 v244, 48, v244
Ls_tail:
    v_mfma_f32_16x16x32_bf16 v[208:211], v[136:139], v[200:203], v[208:211]
    ds_read_b32 v246, v244 offset:0
    s_waitcnt lgkmcnt(0)
    v_bfe_u32 v247, v246, 0, 8
    v_lshlrev_b32 v247, 1, v247
    v_bfe_u32 v248, v246, 8, 8
    v_lshlrev_b32 v248, 1, v248
    v_bfe_u32 v249, v246, 16, 8
    v_lshlrev_b32 v249, 1, v249
    v_bfe_u32 v250, v246, 24, 8
    v_lshlrev_b32 v250, 1, v250
    buffer_load_ushort v247, v247, s[24:27], 0 offen
    buffer_load_ushort v248, v248, s[24:27], 0 offen
    buffer_load_ushort v249, v249, s[24:27], 0 offen
    buffer_load_ushort v250, v250, s[24:27], 0 offen
    s_waitcnt vmcnt(0)
    v_lshlrev_b32 v247, 16, v247
    v_mul_f32 v208, v208, v247
    v_lshlrev_b32 v248, 16, v248
    v_mul_f32 v209, v209, v248
    v_lshlrev_b32 v249, 16, v249
    v_mul_f32 v210, v210, v249
    v_lshlrev_b32 v250, 16, v250
    v_mul_f32 v211, v211, v250
    v_exp_f32 v132, v148
    v_exp_f32 v133, v149
    v_exp_f32 v134, v150
    v_exp_f32 v135, v151
    v_exp_f32 v136, v152
    v_exp_f32 v137, v153
    v_mfma_f32_4x4x4_16b_bf16 v[132:135], v[228:229], v[228:229], v[132:135]
    v_exp_f32 v138, v154
    v_exp_f32 v139, v155
    v_cvt_pk_bf16_f32 v208, v208, v209
    v_cvt_pk_bf16_f32 v209, v210, v211
    v_exp_f32 v140, v156
    v_exp_f32 v141, v157
    v_mfma_f32_4x4x4_16b_bf16 v[212:215], v[208:209], v[188:189], v[212:215] cbsz:4 abid:0
    v_mfma_f32_4x4x4_16b_bf16 v[136:139], v[228:229], v[228:229], v[136:139]
    v_exp_f32 v142, v158
    v_mfma_f32_4x4x4_16b_bf16 v[212:215], v[208:209], v[190:191], v[212:215] cbsz:4 abid:4
    v_exp_f32 v143, v159
    v_exp_f32 v144, v160
    v_mfma_f32_4x4x4_16b_bf16 v[212:215], v[208:209], v[192:193], v[212:215] cbsz:4 abid:8
    v_exp_f32 v145, v161
    v_mfma_f32_4x4x4_16b_bf16 v[140:143], v[228:229], v[228:229], v[140:143]
    v_mfma_f32_4x4x4_16b_bf16 v[212:215], v[208:209], v[194:195], v[212:215] cbsz:4 abid:12
    ds_read_b64_tr_b16 v[188:189], v236 offset:0
    ds_read_b64_tr_b16 v[190:191], v236 offset:512
    ds_read_b64_tr_b16 v[192:193], v236 offset:1056
    ds_read_b64_tr_b16 v[194:195], v236 offset:1568
    v_exp_f32 v146, v162
    v_exp_f32 v147, v163
    v_rcp_f32 v132, v132
    v_rcp_f32 v133, v133
    v_mfma_f32_4x4x4_16b_bf16 v[144:147], v[228:229], v[228:229], v[144:147]
    v_rcp_f32 v134, v134
    s_bitcmp0_b64 s[56:57], 1
    s_cbranch_scc1 Ls_tnf
    v_cvt_pk_bf16_f32 v246, v212, v212
    v_mov_b32 v212, 0
    ds_write_b16 v240, v246
    v_add_u32 v240, 128, v240
    s_add_u32 s24, s24, s32
    s_addc_u32 s25, s25, 0
    s_xor_b32 s32, s32, 0x18ffe0
Ls_tnf:
    v_cvt_pk_bf16_f32 v132, v132, v133
    s_waitcnt lgkmcnt(0)
    v_rcp_f32 v135, v135
    v_rcp_f32 v136, v136
    v_cvt_pk_bf16_f32 v133, v134, v135
    v_rcp_f32 v137, v137
    v_rcp_f32 v138, v138
    v_cvt_pk_bf16_f32 v134, v136, v137
    v_rcp_f32 v139, v139
    v_rcp_f32 v140, v140
    v_cvt_pk_bf16_f32 v135, v138, v139
    v_rcp_f32 v141, v141
    v_rcp_f32 v142, v142
    v_cvt_pk_bf16_f32 v136, v140, v141
    v_mfma_f32_16x16x32_bf16 v[208:211], v[132:135], v[196:199], v[204:207]
    v_rcp_f32 v143, v143
    v_rcp_f32 v144, v144
    v_cvt_pk_bf16_f32 v137, v142, v143
    v_rcp_f32 v145, v145
    v_rcp_f32 v146, v146
    v_rcp_f32 v147, v147
    v_cvt_pk_bf16_f32 v138, v144, v145
    v_cvt_pk_bf16_f32 v139, v146, v147
    s_nop 1
    v_mfma_f32_16x16x32_bf16 v[208:211], v[136:139], v[200:203], v[208:211]
    ds_read_b32 v246, v244 offset:16
    s_waitcnt lgkmcnt(0)
    v_bfe_u32 v247, v246, 0, 8
    v_lshlrev_b32 v247, 1, v247
    v_bfe_u32 v248, v246, 8, 8
    v_lshlrev_b32 v248, 1, v248
    v_bfe_u32 v249, v246, 16, 8
    v_lshlrev_b32 v249, 1, v249
    v_bfe_u32 v250, v246, 24, 8
    v_lshlrev_b32 v250, 1, v250
    buffer_load_ushort v247, v247, s[24:27], 0 offen
    buffer_load_ushort v248, v248, s[24:27], 0 offen
    buffer_load_ushort v249, v249, s[24:27], 0 offen
    buffer_load_ushort v250, v250, s[24:27], 0 offen
    s_waitcnt vmcnt(0)
    v_lshlrev_b32 v247, 16, v247
    v_mul_f32 v208, v208, v247
    v_lshlrev_b32 v248, 16, v248
    v_mul_f32 v209, v209, v248
    v_lshlrev_b32 v249, 16, v249
    v_mul_f32 v210, v210, v249
    v_lshlrev_b32 v250, 16, v250
    v_mul_f32 v211, v211, v250
    v_cvt_pk_bf16_f32 v208, v208, v209
    v_cvt_pk_bf16_f32 v209, v210, v211
    s_nop 1
    v_mfma_f32_4x4x4_16b_bf16 v[212:215], v[208:209], v[188:189], v[212:215] cbsz:4 abid:0
    s_nop 1
    v_mfma_f32_4x4x4_16b_bf16 v[212:215], v[208:209], v[190:191], v[212:215] cbsz:4 abid:4
    s_nop 1
    v_mfma_f32_4x4x4_16b_bf16 v[212:215], v[208:209], v[192:193], v[212:215] cbsz:4 abid:8
    s_nop 1
    v_mfma_f32_4x4x4_16b_bf16 v[212:215], v[208:209], v[194:195], v[212:215] cbsz:4 abid:12
    s_nop 4
    v_cvt_pk_bf16_f32 v246, v212, v212
    ds_write_b16 v240, v246
    s_branch L_store
.section .rodata,"a"
.p2align 6
.amdhsa_kernel standalone__sequential_behavior_din__recsys_kernel
  .amdhsa_next_free_vgpr 256
  .amdhsa_next_free_sgpr 102
  .amdhsa_accum_offset 256
  .amdhsa_group_segment_fixed_size 0
  .amdhsa_kernarg_size 80
  .amdhsa_user_sgpr_count 2
  .amdhsa_user_sgpr_kernarg_segment_ptr 1
  .amdhsa_system_sgpr_workgroup_id_x 1
.end_amdhsa_kernel
```

```asm
; @launch grid=(256,1,1) block=(512,1,1) lds=163840
.amdgcn_target "amdgcn-amd-amdhsa--gfx950"
.text
.globl standalone__sequential_behavior_din__recsys_kernel
.p2align 8
.type standalone__sequential_behavior_din__recsys_kernel,@function
standalone__sequential_behavior_din__recsys_kernel:
    s_load_dwordx16 s[4:19], s[0:1], 0
    s_cmp_ge_u32 s2, 256
    s_cbranch_scc1 L_end
    v_lshrrev_b32 v1, 6, v0
    v_and_b32 v0, 63, v0
    v_readfirstlane_b32 s54, v1
    s_lshl_b32 s53, s2, 3
    v_lshlrev_b32 v2, 4, v0
    v_lshrrev_b32 v1, 4, v0
    v_and_b32 v3, 0xf0, v2
    v_lshlrev_b32 v3, 2, v3
    v_lshl_add_u32 v130, v1, 4, v3
    v_bfrev_b32 v3, 1
    s_add_u32 s53, s53, s54
    s_movk_i32 s66, 800
    v_cmp_gt_u32 vcc, s66, v130
    s_mul_i32 s93, s53, 800
    s_mul_i32 s52, s54, 20480
    s_mov_b64 s[28:29], vcc
    v_cndmask_b32 v3, v3, v130, vcc
    v_and_b32 v248, 16, v0
    v_lshlrev_b32 v246, 1, v248
    v_xor_b32 v246, v246, v2
    v_and_b32 v243, 0xf0, v2
    v_lshl_add_u32 v243, v1, 19, v243
    s_lshl_b32 s66, s53, 8
    v_add_u32 v243, s66, v243
    s_lshl_b32 s67, s54, 12
    s_add_u32 m0, s52, 8320
    s_mov_b32 s26, 6553600
    s_mov_b32 s27, 0x20000
    s_waitcnt lgkmcnt(0)
    s_mov_b32 s24, s8
    s_and_b32 s25, s9, 0xffff
    s_cmp_ge_u32 s54, 4
    s_cbranch_scc1 L_young0
    buffer_load_dwordx4 v[100:103], v3, s[24:27], s93 offen nt
L_young0:
    global_load_lds_dwordx4 v243, s[4:5] nt
    s_add_u32 m0, s52, 4160
    s_add_u32 s10, s10, s67
    s_addc_u32 s11, s11, 0
    v_xor_b32 v247, 64, v246
    global_load_lds_dwordx4 v246, s[10:11] offset:0
    global_load_lds_dwordx4 v247, s[10:11] offset:1024
    global_load_lds_dwordx4 v246, s[10:11] offset:2048
    global_load_lds_dwordx4 v247, s[10:11] offset:3072
    s_load_dword s30, s[16:17], 0
    s_and_b32 s67, s54, 3
    v_and_b32 v250, 3, v0
    s_mov_b32 s20, s6
    s_and_b32 s21, s7, 0xffff
    s_or_b32 s21, s21, 0x800000
    s_mov_b32 s22, 200
    s_mov_b32 s23, 0x20000
    s_sub_u32 s40, s20, 1056
    s_subb_u32 s41, s21, 0
    s_mov_b32 s42, 200
    s_mov_b32 s43, 0x20000
    s_mul_i32 s35, s53, 51200
    s_movk_i32 s31, 25600
    s_mov_b32 s60, 3
    s_mov_b64 s[56:57], 0
    v_mov_b32 v148, -1
    v_mov_b32 v149, -1
    v_mov_b32 v150, -1
    v_mov_b32 v151, -1
    s_add_u32 s66, s52, 18432
    v_add_u32 v152, s66, v2
    ds_write_b128 v152, v[148:151]
    ds_write_b128 v152, v[148:151] offset:1024
    s_add_u32 s64, s52, 18448
    v_mov_b32 v153, -1
    v_mov_b32 v154, -1
    v_mov_b32 v155, -1
    v_lshrrev_b32 v237, 3, v0
    v_add_u32 v237, s64, v237
    v_lshl_add_u32 v244, v1, 2, s66
    v_and_b32 v231, 0x70, v2
    v_lshlrev_b32 v248, 2, v248
    v_xor_b32 v231, v231, v248
    v_mov_b32 v233, v231
    s_movk_i32 s66, 400
    v_cmp_le_u32 vcc, s66, v130
    v_lshrrev_b32 v126, 1, v130
    s_movk_i32 s66, -200
    v_cndmask_b32 v130, 0, 1, vcc
    v_mad_i32_i24 v126, v130, s66, v126
    v_mul_u32_u24 v127, 0x10001, v126
    v_add_u32 v126, 0x10000, v127
    v_add_u32 v128, 0x50004, v127
    v_add_u32 v129, 0x70006, v127
    v_add_u32 v127, 0x30002, v127
    v_mov_b32 v131, 0xbfe0bfe0
    s_mov_b32 s86, 0xfff0ffff
    s_mov_b32 s87, 0xf000ff00
    s_mov_b32 s88, 0xff00fff0
    s_mov_b32 s89, 0xf000
    s_mov_b32 s90, 0xf0000f
    s_mov_b32 s91, 0xf0000f00
    s_mov_b32 s84, 0x11111113
    s_mov_b32 s85, 0x11111111
    v_cndmask_b32 v116, 0, v131, s[86:87]
    v_cndmask_b32 v120, 0, v131, s[88:89]
    v_cndmask_b32 v117, 0, v131, s[86:87]
    v_cndmask_b32 v121, 0, v131, s[88:89]
    v_cndmask_b32 v122, 0, v131, s[84:85]
    v_cndmask_b32 v123, 0, v131, s[84:85]
    v_cndmask_b32 v124, 0, v131, s[84:85]
    v_cndmask_b32 v125, 0, v131, s[84:85]
    v_lshlrev_b32 v246, 4, v250
    v_sub_u32 v246, 48, v246
    s_mov_b32 s86, 0xbfe0bfe0
    s_mov_b32 s87, 0xf0bfe0
    v_lshrrev_b64 v[118:119], v246, s[86:87]
    v_mov_b32 v131, 0
    s_mov_b64 s[84:85], 0
    v_cndmask_b32 v118, v120, v118, s[90:91]
    v_cndmask_b32 v119, v121, v119, s[90:91]
    s_mov_b32 s61, 7
    s_mov_b32 s92, 0xbfb8aa3b
    v_and_b32 v251, 15, v0
    v_bfe_u32 v252, v0, 2, 2
    v_lshlrev_b32 v253, 3, v250
    v_lshl_add_u32 v253, v252, 7, v253
    v_and_b32 v246, 24, v0
    v_lshlrev_b32 v246, 2, v246
    v_xor_b32 v246, v253, v246
    v_lshl_add_u32 v246, v1, 10, v246
    s_lshl_b32 s66, s67, 5
    v_xor_b32 v66, s66, v246
    v_add_u32 v66, 45120, v66
    s_lshr_b32 s66, s54, 1
    s_lshl_b32 s66, s66, 5
    v_xor_b32 v64, s66, v246
    s_and_b32 s66, s54, 1
    s_mul_i32 s66, s66, 20480
    s_add_u32 s66, s66, 4160
    v_add_u32 v64, s66, v64
    v_add_u32 v65, 81920, v64
    s_and_b32 s66, s54, 4
    v_lshrrev_b32 v246, 3, v251
    v_add_u32 v246, s66, v246
    v_mul_u32_u24 v246, 20480, v246
    v_lshl_add_u32 v246, v1, 4, v246
    v_and_b32 v247, 7, v0
    v_lshl_add_u32 v67, v247, 7, v246
    v_and_b32 v247, 1, v0
    v_lshlrev_b32 v247, 4, v247
    v_lshlrev_b32 v247, v247, 1
    v_cmp_gt_u32 vcc, 2, v250
    v_mov_b32 v229, 0
    v_mov_b32 v228, 0x3f80
    v_cndmask_b32 v241, 0, v247, vcc
    v_cmp_eq_u32 vcc, 0, v251
    v_sub_u32 v242, v247, v241
    v_mul_u32_u24 v218, 0x3f80, v241
    v_cndmask_b32 v220, 0, -1, vcc
    v_mul_u32_u24 v219, 0x3f80, v242
    s_and_b32 s66, s54, 3
    s_lshl_b32 s66, s66, 6
    s_add_u32 s66, s66, 9344
    v_and_b32 v247, 7, v0
    v_mul_u32_u24 v247, 144, v247
    v_add3_u32 v98, v67, v247, s66
    s_add_u32 s66, s52, 14592
    v_lshl_add_u32 v221, v0, 2, s66
    ds_write_b32 v221, v229
    s_xor_b32 s66, s54, 4
    s_mul_i32 s66, s66, 20480
    s_add_u32 s66, s66, 14592
    v_writelane_b32 v221, s66, 1
    v_add_u32 v222, s52, v2
    s_mov_b64 exec, 15
    ds_write_b32 v222, v229 offset:14848
    s_mov_b64 exec, -1
    v_and_b32 v247, 8, v0
    v_lshlrev_b32 v247, 2, v247
    v_lshl_add_u32 v247, v251, 7, v247
    v_add_u32 v247, s52, v247
    v_and_b32 v248, 2, v0
    v_lshlrev_b32 v248, 1, v248
    v_xor_b32 v248, v248, v1
    v_lshl_add_u32 v234, v248, 4, v247
    v_xor_b32 v248, 4, v248
    v_lshl_add_u32 v235, v248, 4, v247
    v_and_b32 v247, 8, v0
    v_lshlrev_b32 v247, 3, v247
    v_lshl_add_u32 v248, v1, 5, v253
    v_xor_b32 v248, v248, v247
    v_add_u32 v236, s52, v248
    s_add_u32 s66, s52, 8320
    v_lshl_add_u32 v238, v250, 1, s66
    v_lshl_add_u32 v238, v1, 4, v238
    s_add_u32 s66, s52, 14912
    v_lshl_add_u32 v240, v0, 1, s66
    s_add_u32 s66, s52, 9344
    v_lshl_add_u32 v239, v1, 4, s66
    v_mov_b32 v188, 0
    v_mov_b32 v189, 0
    v_mov_b32 v190, 0
    v_mov_b32 v191, 0
    v_mov_b32 v192, 0
    v_mov_b32 v193, 0
    v_mov_b32 v194, 0
    v_mov_b32 v195, 0
    v_mov_b32 v208, 0
    v_mov_b32 v212, 0
    v_mov_b32 v209, 0
    v_mov_b32 v213, 0
    v_mov_b32 v210, 0
    v_mov_b32 v214, 0
    v_mov_b32 v211, 0
    v_mov_b32 v215, 0
    s_and_b32 s66, s54, 3
    s_lshl_b32 s66, s66, 5
    v_lshl_add_u32 v249, v1, 3, s66
    global_load_dwordx2 v[96:97], v249, s[12:13]
    s_cmp_ge_u32 s54, 4
    s_cbranch_scc0 L_old3z
    buffer_load_dwordx4 v[100:103], v3, s[24:27], s93 offen nt
L_old3z:
    s_cmp_ge_u32 s54, 4
    s_cbranch_scc1 L_young1
    s_waitcnt vmcnt(6) lgkmcnt(0)
    s_call_b64 s[62:63], L_fp
    s_waitcnt vmcnt(5)
    s_branch L_old1
L_young1:
    s_waitcnt vmcnt(2)
L_old1:
    s_waitcnt lgkmcnt(0)
    s_barrier
    ds_read_b64_tr_b16 v[16:17], v66 offset:0
    ds_read_b64_tr_b16 v[18:19], v66 offset:512
    ds_read_b64_tr_b16 v[20:21], v66 offset:20480
    ds_read_b64_tr_b16 v[22:23], v66 offset:20992
    ds_read_b64_tr_b16 v[24:25], v66 offset:40960
    ds_read_b64_tr_b16 v[26:27], v66 offset:41472
    ds_read_b64_tr_b16 v[28:29], v66 offset:61440
    ds_read_b64_tr_b16 v[30:31], v66 offset:61952
    ds_read_b128 v[32:35], v67 offset:8320
    ds_read_b128 v[36:39], v67 offset:8384
    ds_read_b128 v[40:43], v67 offset:49280
    ds_read_b128 v[44:47], v67 offset:49344
    ds_read_b64_tr_b16 v[4:5], v64 offset:0
    ds_read_b64_tr_b16 v[8:9], v65 offset:0
    ds_read_b64_tr_b16 v[12:13], v65 offset:40960
    ds_read_b64_tr_b16 v[6:7], v64 offset:512
    ds_read_b64_tr_b16 v[10:11], v65 offset:512
    ds_read_b64_tr_b16 v[14:15], v65 offset:41472
    s_cmp_ge_u32 s54, 4
    s_cbranch_scc1 L_young2
    s_waitcnt vmcnt(4)
    s_branch L_old2
L_young2:
    s_waitcnt vmcnt(1)
L_old2:
    s_add_u32 s93, s93, 1638400
    buffer_load_dwordx4 v[104:107], v3, s[24:27], s93 offen nt
    s_add_u32 s93, s93, 1638400
    buffer_load_dwordx4 v[108:111], v3, s[24:27], s93 offen nt
    s_add_u32 s93, s93, 1638400
    buffer_load_dwordx4 v[112:115], v3, s[24:27], s93 offen nt
    v_lshlrev_b32 v249, 3, v1
    v_lshl_add_u32 v249, v250, 5, v249
    global_load_dwordx2 v[216:217], v249, s[14:15]
    v_lshlrev_b32 v48, 16, v96
    v_and_b32 v49, 0xffff0000, v96
    v_lshlrev_b32 v50, 16, v97
    v_and_b32 v51, 0xffff0000, v97
    s_lshl_b32 s30, s30, 16
    v_and_b32 v204, s30, v220
    v_and_b32 v205, s30, v220
    v_and_b32 v206, s30, v220
    v_and_b32 v207, s30, v220
    s_waitcnt lgkmcnt(0)
    v_xor_b32 v24, 0x80008000, v24
    v_xor_b32 v25, 0x80008000, v25
    v_xor_b32 v26, 0x80008000, v26
    v_xor_b32 v27, 0x80008000, v27
    v_xor_b32 v28, 0x80008000, v28
    v_xor_b32 v29, 0x80008000, v29
    v_xor_b32 v30, 0x80008000, v30
    v_xor_b32 v31, 0x80008000, v31
    v_mfma_f32_4x4x4_16b_bf16 v[56:59], v[218:219], v[4:5], 0
    v_mfma_f32_4x4x4_16b_bf16 v[68:71], v[218:219], v[12:13], 0
    v_mfma_f32_4x4x4_16b_bf16 v[60:63], v[218:219], v[6:7], 0
    v_mfma_f32_4x4x4_16b_bf16 v[72:75], v[218:219], v[14:15], 0
    v_mfma_f32_4x4x4_16b_bf16 v[56:59], v[218:219], v[8:9], v[56:59]
    v_mfma_f32_4x4x4_16b_bf16 v[60:63], v[218:219], v[10:11], v[60:63]
    v_mfma_f32_16x16x32_bf16 v[52:55], v[16:19], v[40:43], v[48:51]
    v_mfma_f32_16x16x32_bf16 v[52:55], v[20:23], v[44:47], v[52:55]
    v_mfma_f32_16x16x32_bf16 v[52:55], v[24:27], v[40:43], v[52:55]
    v_mfma_f32_16x16x32_bf16 v[52:55], v[28:31], v[44:47], v[52:55]
    v_mfma_f32_16x16x32_bf16 v[48:51], v[16:19], v[32:35], v[48:51]
    v_mfma_f32_16x16x32_bf16 v[48:51], v[20:23], v[36:39], v[48:51]
    v_mfma_f32_16x16x32_bf16 v[48:51], v[24:27], v[32:35], v[48:51]
    v_mfma_f32_16x16x32_bf16 v[48:51], v[28:31], v[36:39], v[48:51]
    v_mul_f32 v56, s92, v56
    v_mul_f32 v57, s92, v57
    v_mul_f32 v58, s92, v58
    v_mul_f32 v59, s92, v59
    v_mul_f32 v60, s92, v60
    v_mul_f32 v61, s92, v61
    v_mul_f32 v62, s92, v62
    v_mul_f32 v63, s92, v63
    v_mul_f32 v68, s92, v68
    v_mul_f32 v69, s92, v69
    v_mul_f32 v70, s92, v70
    v_mul_f32 v71, s92, v71
    v_mul_f32 v72, s92, v72
    v_mul_f32 v73, s92, v73
    v_mul_f32 v74, s92, v74
    v_mul_f32 v75, s92, v75
    s_add_u32 s66, s52, 11520
    v_add_u32 v3, s66, v2
    v_cvt_pk_bf16_f32 v68, v68, v69
    v_cvt_pk_bf16_f32 v69, v70, v71
    v_cvt_pk_bf16_f32 v70, v72, v73
    v_cvt_pk_bf16_f32 v71, v74, v75
    v_mul_f32 v48, s92, v48
    v_mul_f32 v49, s92, v49
    v_mul_f32 v50, s92, v50
    v_mul_f32 v51, s92, v51
    v_mul_f32 v52, s92, v52
    v_mul_f32 v53, s92, v53
    v_mul_f32 v54, s92, v54
    v_mul_f32 v55, s92, v55
    ds_write_b128 v3, v[56:59]
    ds_write_b128 v3, v[60:63] offset:1024
    ds_write_b128 v3, v[68:71] offset:2048
    ds_write_b128 v98, v[48:51]
    ds_write_b128 v98, v[52:55] offset:40960
    v_add_u32 v3, 11520, v2
    v_add_u32 v246, 81920, v3
    s_waitcnt lgkmcnt(0)
    s_barrier
    s_cmp_ge_u32 s54, 4
    s_cbranch_scc0 L_old3
    s_waitcnt vmcnt(4)
    s_call_b64 s[62:63], L_fp
    s_branch L_yng3
L_old3:
    s_call_b64 s[62:63], L_t23
L_yng3:
    ds_read_b128 v[4:7], v3 offset:0
    ds_read_b128 v[8:11], v3 offset:1024
    ds_read_b128 v[68:71], v3 offset:2048
    ds_read_b128 v[12:15], v3 offset:20480
    ds_read_b128 v[16:19], v3 offset:21504
    ds_read_b128 v[72:75], v3 offset:22528
    ds_read_b128 v[20:23], v3 offset:40960
    ds_read_b128 v[24:27], v3 offset:41984
    ds_read_b128 v[76:79], v3 offset:43008
    s_waitcnt vmcnt(2)
    v_mfma_i32_16x16x64_i8 v[172:175], v[122:125], v[104:107], 0
    v_mfma_i32_16x16x64_i8 v[176:179], v[122:125], v[108:111], 0
    v_mfma_i32_16x16x64_i8 v[180:183], v[122:125], v[112:115], 0
    v_and_b32 v160, 0x800080, v104
    v_mul_u32_u24 v160, 0x7f, v160
    v_bitop3_b32 v131, v104, v160, v131 bitop3:0xbe
    v_and_b32 v161, 0x800080, v105
    v_mul_u32_u24 v161, 0x7f, v161
    v_bitop3_b32 v131, v105, v161, v131 bitop3:0xbe
    v_and_b32 v160, 0x800080, v106
    v_mul_u32_u24 v160, 0x7f, v160
    v_bitop3_b32 v131, v106, v160, v131 bitop3:0xbe
    v_mov_b32_dpp v184, v172 row_shr:1 row_mask:0xf bank_mask:0xf bound_ctrl:0
    v_mov_b32_dpp v185, v176 row_shr:1 row_mask:0xf bank_mask:0xf bound_ctrl:0
    v_mov_b32_dpp v186, v180 row_shr:1 row_mask:0xf bank_mask:0xf bound_ctrl:0
    v_add_u32_dpp v184, v184, v184 row_shr:1 row_mask:0xf bank_mask:0xf bound_ctrl:0
    v_add_u32_dpp v185, v185, v185 row_shr:1 row_mask:0xf bank_mask:0xf bound_ctrl:0
    v_add_u32_dpp v186, v186, v186 row_shr:1 row_mask:0xf bank_mask:0xf bound_ctrl:0
    v_add_u32_dpp v184, v184, v184 row_shr:2 row_mask:0xf bank_mask:0xf bound_ctrl:0
    v_add_u32_dpp v185, v185, v185 row_shr:2 row_mask:0xf bank_mask:0xf bound_ctrl:0
    v_add_u32_dpp v186, v186, v186 row_shr:2 row_mask:0xf bank_mask:0xf bound_ctrl:0
    v_add_u32_dpp v184, v184, v184 row_shr:4 row_mask:0xf bank_mask:0xf bound_ctrl:0
    v_add_u32_dpp v185, v185, v185 row_shr:4 row_mask:0xf bank_mask:0xf bound_ctrl:0
    v_add_u32_dpp v186, v186, v186 row_shr:4 row_mask:0xf bank_mask:0xf bound_ctrl:0
    v_add_u32_dpp v184, v184, v184 row_shr:8 row_mask:0xf bank_mask:0xf bound_ctrl:0
    v_add_u32_dpp v185, v185, v185 row_shr:8 row_mask:0xf bank_mask:0xf bound_ctrl:0
    v_add_u32_dpp v186, v186, v186 row_shr:8 row_mask:0xf bank_mask:0xf bound_ctrl:0
    ds_read_b128 v[28:31], v3 offset:61440
    ds_read_b128 v[32:35], v3 offset:62464
    ds_read_b128 v[80:83], v3 offset:63488
    ds_read_b128 v[36:39], v246 offset:0
    ds_read_b128 v[40:43], v246 offset:1024
    ds_read_b128 v[84:87], v246 offset:2048
    v_and_b32 v161, 0x800080, v107
    v_mul_u32_u24 v161, 0x7f, v161
    v_bitop3_b32 v131, v107, v161, v131 bitop3:0xbe
    v_and_b32 v160, 0x800080, v108
    v_mul_u32_u24 v160, 0x7f, v160
    v_bitop3_b32 v131, v108, v160, v131 bitop3:0xbe
    v_and_b32 v161, 0x800080, v109
    v_mul_u32_u24 v161, 0x7f, v161
    v_bitop3_b32 v131, v109, v161, v131 bitop3:0xbe
    v_and_b32 v160, 0x800080, v110
    v_mul_u32_u24 v160, 0x7f, v160
    v_bitop3_b32 v131, v110, v160, v131 bitop3:0xbe
    v_and_b32 v161, 0x800080, v111
    v_mul_u32_u24 v161, 0x7f, v161
    v_bitop3_b32 v131, v111, v161, v131 bitop3:0xbe
    v_and_b32 v160, 0x800080, v112
    v_mul_u32_u24 v160, 0x7f, v160
    v_bitop3_b32 v131, v112, v160, v131 bitop3:0xbe
    v_and_b32 v161, 0x800080, v113
    v_mul_u32_u24 v161, 0x7f, v161
    v_bitop3_b32 v131, v113, v161, v131 bitop3:0xbe
    v_and_b32 v160, 0x800080, v114
    v_mul_u32_u24 v160, 0x7f, v160
    v_bitop3_b32 v131, v114, v160, v131 bitop3:0xbe
    v_and_b32 v161, 0x800080, v115
    v_mul_u32_u24 v161, 0x7f, v161
    v_bitop3_b32 v131, v115, v161, v131 bitop3:0xbe
    v_cmp_ne_u32 vcc, 0, v131
    v_readlane_b32 s68, v184, 6
    v_readlane_b32 s69, v173, 6
    v_readlane_b32 s70, v184, 15
    v_readlane_b32 s72, v185, 6
    v_readlane_b32 s73, v177, 6
    v_readlane_b32 s74, v185, 15
    v_readlane_b32 s76, v186, 6
    v_readlane_b32 s77, v181, 6
    v_readlane_b32 s78, v186, 15
    s_cbranch_vccnz L_general
    s_add_u32 s66, s68, s69
    s_add_u32 s66, s66, s64
    s_add_u32 s67, s66, 15
    s_and_b32 s67, s67, -16
    s_add_u32 s55, s64, 16
    s_max_u32 s67, s67, s55
    s_sub_u32 s66, s67, s66
    v_mad_u32_u24 v184, v130, s66, v184
    s_sub_u32 s55, s64, 2048
    v_add_u32 v172, s55, v184
    v_add_u32 v173, s55, v184
    v_add_u32 v174, s55, v184
    v_add_u32 v175, s55, v184
    s_add_u32 s64, s64, s70
    s_add_u32 s64, s64, s66
    v_mfma_i32_16x16x64_i8 v[132:135], v[118:121], v[104:107], v[172:175]
    v_mfma_i32_16x16x64_i8 v[136:139], v[116:119], v[104:107], v[172:175]
    s_add_u32 s64, s64, 15
    s_and_b32 s64, s64, -16
    s_add_u32 s55, s67, 16
    s_max_u32 s64, s64, s55
    s_lshr_b32 s95, s67, 4
    s_bitset1_b64 s[56:57], s95
    s_lshr_b32 s95, s64, 4
    s_bitset1_b64 s[56:57], s95
    s_mov_b32 s44, s64
    s_add_u32 s66, s72, s73
    s_add_u32 s66, s66, s64
    s_add_u32 s67, s66, 15
    s_and_b32 s67, s67, -16
    s_add_u32 s55, s64, 16
    s_max_u32 s67, s67, s55
    s_sub_u32 s66, s67, s66
    v_mad_u32_u24 v185, v130, s66, v185
    s_sub_u32 s55, s64, 2048
    v_add_u32 v176, s55, v185
    v_add_u32 v177, s55, v185
    v_add_u32 v178, s55, v185
    v_add_u32 v179, s55, v185
    s_add_u32 s64, s64, s74
    s_add_u32 s64, s64, s66
    v_mfma_i32_16x16x64_i8 v[140:143], v[118:121], v[108:111], v[176:179]
    v_mfma_i32_16x16x64_i8 v[144:147], v[116:119], v[108:111], v[176:179]
    s_add_u32 s64, s64, 15
    s_and_b32 s64, s64, -16
    s_add_u32 s55, s67, 16
    s_max_u32 s64, s64, s55
    s_mov_b32 s45, s67
    s_mov_b32 s46, s64
    ds_write_b8 v132, v126
    ds_write_b8_d16_hi v133, v126
    ds_write_b8 v134, v127
    ds_write_b8_d16_hi v135, v127
    ds_write_b8 v136, v128
    ds_write_b8_d16_hi v137, v128
    ds_write_b8 v138, v129
    ds_write_b8_d16_hi v139, v129
    s_add_u32 s66, s76, s77
    s_add_u32 s66, s66, s64
    s_add_u32 s67, s66, 15
    s_and_b32 s67, s67, -16
    s_add_u32 s55, s64, 16
    s_max_u32 s67, s67, s55
    s_sub_u32 s66, s67, s66
    v_mad_u32_u24 v186, v130, s66, v186
    s_sub_u32 s55, s64, 2048
    v_add_u32 v180, s55, v186
    v_add_u32 v181, s55, v186
    v_add_u32 v182, s55, v186
    v_add_u32 v183, s55, v186
    s_add_u32 s64, s64, s78
    s_add_u32 s64, s64, s66
    v_mfma_i32_16x16x64_i8 v[164:167], v[118:121], v[112:115], v[180:183]
    v_mfma_i32_16x16x64_i8 v[168:171], v[116:119], v[112:115], v[180:183]
    s_add_u32 s64, s64, 15
    s_and_b32 s64, s64, -16
    s_add_u32 s55, s67, 16
    s_max_u32 s64, s64, s55
    s_mov_b32 s47, s67
    s_mov_b32 s48, s64
    ds_write_b8 v140, v126
    ds_write_b8_d16_hi v141, v126
    ds_write_b8 v142, v127
    ds_write_b8_d16_hi v143, v127
    ds_write_b8 v144, v128
    ds_write_b8_d16_hi v145, v128
    ds_write_b8 v146, v129
    ds_write_b8_d16_hi v147, v129
    ds_read_b128 v[44:47], v246 offset:20480
    ds_read_b128 v[48:51], v246 offset:21504
    ds_read_b128 v[88:91], v246 offset:22528
    ds_read_b128 v[52:55], v246 offset:40960
    ds_read_b128 v[56:59], v246 offset:41984
    ds_read_b128 v[92:95], v246 offset:43008
    ds_read_b128 v[60:63], v246 offset:61440
    ds_read_b128 v[64:67], v246 offset:62464
    ds_read_b128 v[96:99], v246 offset:63488
    ds_read_u16 v224, v238 offset:0
    ds_read_u16 v225, v238 offset:8
    ds_read_u16 v226, v238 offset:64
    ds_read_u16 v227, v238 offset:72
    ds_write_b8 v164, v126
    ds_write_b8_d16_hi v165, v126
    ds_write_b8 v166, v127
    ds_write_b8_d16_hi v167, v127
    ds_write_b8 v168, v128
    ds_write_b8_d16_hi v169, v128
    ds_write_b8 v170, v129
    ds_write_b8_d16_hi v171, v129
    s_cmp_ge_u32 s54, 4
    s_cbranch_scc0 L_old3b
    s_call_b64 s[62:63], L_t23
L_old3b:
L_listed:
    s_and_b32 s55, s84, 0x40000000
    s_or_b32 s55, s55, s54
    s_bitset1_b32 s55, 31
    s_and_b32 s66, s74, 0x1ff
    s_lshl_b32 s66, s66, 3
    s_or_b32 s66, s66, s55
    s_and_b32 s67, s78, 0x1ff
    s_lshl_b32 s67, s67, 3
    s_or_b32 s67, s67, s55
    v_mov_b32 v132, s66
    v_mov_b32 v133, s44
    v_mov_b32 v134, s45
    v_mov_b32 v135, s46
    v_writelane_b32 v132, s67, 1
    v_writelane_b32 v133, s46, 1
    v_writelane_b32 v134, s47, 1
    v_writelane_b32 v135, s48, 1
    s_mov_b64 exec, 3
    ds_write_b128 v222, v[132:135] offset:14848
    s_mov_b64 exec, -1
    s_sub_u32 s68, s46, s44
    s_sub_u32 s69, s48, s46
    s_lshl_b32 s50, s54, 3
    s_mov_b32 s51, 0
    s_mov_b32 s33, 0
    s_sub_u32 s66, s64, s52
    s_sub_u32 s66, s66, 18448
    s_lshr_b32 s66, s66, 3
    s_lshr_b32 s67, s54, 2
    s_mul_i32 s67, s67, 2
    s_add_u32 s66, s66, s67
    s_sub_u32 s67, 0, s66
    v_mov_b32 v2, v221
    v_mov_b32 v1, s66
    v_mov_b32 v3, -8
    v_writelane_b32 v1, s67, 1
    v_writelane_b32 v3, 8, 1
    ds_add_u32 v2, v1
    v_bfrev_b32 v245, -2
    v_writelane_b32 v245, 0, 0
    s_cmp_eq_u32 s94, 1
    s_cbranch_scc1 L_nolate
    ds_read_u8 v148, v237 offset:0
    ds_read_u8 v149, v237 offset:8
    ds_read_u8 v150, v237 offset:16
    ds_read_u8 v151, v237 offset:24
    ds_read_u8 v152, v237 offset:32
    ds_read_u8 v153, v237 offset:40
    s_waitcnt lgkmcnt(0)
    s_add_u32 m0, s52, 0
    v_mov_b32 v230, v148
    v_mov_b32 v232, v149
    buffer_load_dwordx4 v[230:231], s[20:23], s35 idxen offen nt lds
    buffer_load_dwordx4 v[232:233], s[40:43], s35 idxen offen offset:1056 nt lds
    s_bitcmp0_b64 s[56:57], 2
    s_cbranch_scc1 L_noadvl1
    s_add_u32 s35, s35, s31
    s_min_u32 s35, s35, 419404800
    s_xor_b32 s31, s31, 0x63ff800
    s_sub_u32 s60, s60, 1
L_noadvl1:
    s_add_u32 m0, s52, 2080
    v_mov_b32 v230, v150
    v_mov_b32 v232, v151
    buffer_load_dwordx4 v[230:231], s[20:23], s35 idxen offen nt lds
    buffer_load_dwordx4 v[232:233], s[40:43], s35 idxen offen offset:1056 nt lds
    s_bitcmp0_b64 s[56:57], 3
    s_cbranch_scc1 L_noadvl2
    s_add_u32 s35, s35, s31
    s_min_u32 s35, s35, 419404800
    s_xor_b32 s31, s31, 0x63ff800
    s_sub_u32 s60, s60, 1
L_noadvl2:
    s_add_u32 m0, s52, 4160
    v_mov_b32 v230, v152
    v_mov_b32 v232, v153
    buffer_load_dwordx4 v[230:231], s[20:23], s35 idxen offen nt lds
    buffer_load_dwordx4 v[232:233], s[40:43], s35 idxen offen offset:1056 nt lds
L_nolate:
    v_and_b32_dpp v196, v216, v220 quad_perm:[0,0,0,0] row_mask:0xf bank_mask:0xf
    v_and_b32_dpp v197, v217, v220 quad_perm:[0,0,0,0] row_mask:0xf bank_mask:0xf
    v_and_b32_dpp v198, v216, v220 quad_perm:[1,1,1,1] row_mask:0xf bank_mask:0xf
    v_and_b32_dpp v199, v217, v220 quad_perm:[1,1,1,1] row_mask:0xf bank_mask:0xf
    v_and_b32_dpp v200, v216, v220 quad_perm:[2,2,2,2] row_mask:0xf bank_mask:0xf
    v_and_b32_dpp v201, v217, v220 quad_perm:[2,2,2,2] row_mask:0xf bank_mask:0xf
    v_and_b32_dpp v202, v216, v220 quad_perm:[3,3,3,3] row_mask:0xf bank_mask:0xf
    v_and_b32_dpp v203, v217, v220 quad_perm:[3,3,3,3] row_mask:0xf bank_mask:0xf
    s_waitcnt vmcnt(4) lgkmcnt(0)
    ds_read_b128 v[180:183], v234 offset:0
    ds_read_b128 v[184:187], v235 offset:0
    v_mul_u32_u24 v216, v224, v241
    v_mul_u32_u24 v217, v224, v242
    v_mul_u32_u24 v218, v225, v241
    v_mul_u32_u24 v219, v225, v242
    v_mul_u32_u24 v220, v226, v241
    v_mul_u32_u24 v221, v226, v242
    v_mul_u32_u24 v222, v227, v241
    v_mul_u32_u24 v223, v227, v242
    v_mfma_f32_4x4x4_16b_bf16 v[140:143], v[216:217], v[68:69], v[4:7]
    v_add_u32 v238, 128, v238
    ds_read_b128 v[164:167], v239 offset:0
    ds_read_b128 v[168:171], v239 offset:64
    v_mfma_f32_4x4x4_16b_bf16 v[144:147], v[218:219], v[70:71], v[8:11]
    ds_read_b128 v[172:175], v239 offset:128
    ds_read_b128 v[176:179], v239 offset:192
    ds_read_u16 v224, v238 offset:0
    ds_read_u16 v225, v238 offset:8
    ds_read_u16 v226, v238 offset:64
    ds_read_u16 v227, v238 offset:72
    v_mfma_f32_4x4x4_16b_bf16 v[246:249], v[220:221], v[72:73], v[12:15]
    v_cvt_pk_bf16_f32 v100, v140, v141
    v_cvt_pk_bf16_f32 v101, v142, v143
    v_mfma_f32_4x4x4_16b_bf16 v[250:253], v[222:223], v[74:75], v[16:19]
    v_cvt_pk_bf16_f32 v102, v144, v145
    v_cvt_pk_bf16_f32 v103, v146, v147
    v_mfma_f32_4x4x4_16b_bf16 v[140:143], v[216:217], v[76:77], v[20:23]
    v_cvt_pk_bf16_f32 v104, v246, v247
    v_cvt_pk_bf16_f32 v105, v248, v249
    v_mfma_f32_4x4x4_16b_bf16 v[144:147], v[218:219], v[78:79], v[24:27]
    v_cvt_pk_bf16_f32 v106, v250, v251
    v_cvt_pk_bf16_f32 v107, v252, v253
    v_mfma_f32_4x4x4_16b_bf16 v[246:249], v[220:221], v[80:81], v[28:31]
    v_cvt_pk_bf16_f32 v108, v140, v141
    v_cvt_pk_bf16_f32 v109, v142, v143
    v_mfma_f32_4x4x4_16b_bf16 v[250:253], v[222:223], v[82:83], v[32:35]
    v_cvt_pk_bf16_f32 v110, v144, v145
    v_cvt_pk_bf16_f32 v111, v146, v147
    v_mfma_f32_4x4x4_16b_bf16 v[140:143], v[216:217], v[84:85], v[36:39]
    v_cvt_pk_bf16_f32 v112, v246, v247
    v_cvt_pk_bf16_f32 v113, v248, v249
    v_mfma_f32_4x4x4_16b_bf16 v[144:147], v[218:219], v[86:87], v[40:43]
    v_cvt_pk_bf16_f32 v114, v250, v251
    v_cvt_pk_bf16_f32 v115, v252, v253
    v_mfma_f32_4x4x4_16b_bf16 v[246:249], v[220:221], v[88:89], v[44:47]
    v_cvt_pk_bf16_f32 v116, v140, v141
    v_cvt_pk_bf16_f32 v117, v142, v143
    v_mfma_f32_4x4x4_16b_bf16 v[250:253], v[222:223], v[90:91], v[48:51]
    v_cvt_pk_bf16_f32 v118, v144, v145
    v_cvt_pk_bf16_f32 v119, v146, v147
    v_mfma_f32_4x4x4_16b_bf16 v[140:143], v[216:217], v[92:93], v[52:55]
    v_cvt_pk_bf16_f32 v120, v246, v247
    v_cvt_pk_bf16_f32 v121, v248, v249
    v_mfma_f32_4x4x4_16b_bf16 v[144:147], v[218:219], v[94:95], v[56:59]
    v_cvt_pk_bf16_f32 v122, v250, v251
    v_cvt_pk_bf16_f32 v123, v252, v253
    v_mfma_f32_4x4x4_16b_bf16 v[246:249], v[220:221], v[96:97], v[60:63]
    v_cvt_pk_bf16_f32 v124, v140, v141
    v_cvt_pk_bf16_f32 v125, v142, v143
    v_mfma_f32_4x4x4_16b_bf16 v[250:253], v[222:223], v[98:99], v[64:67]
    v_cvt_pk_bf16_f32 v126, v144, v145
    v_cvt_pk_bf16_f32 v127, v146, v147
    v_cvt_pk_bf16_f32 v128, v246, v247
    v_cvt_pk_bf16_f32 v129, v248, v249
    v_add_u32 v239, 272, v239
    v_cvt_pk_bf16_f32 v130, v250, v251
    v_cvt_pk_bf16_f32 v131, v252, v253
    s_waitcnt lgkmcnt(0)
    v_mfma_f32_16x16x32_bf16 v[148:151], v[100:103], v[180:183], v[164:167]
    v_mfma_f32_16x16x32_bf16 v[148:151], v[104:107], v[184:187], v[148:151]
    v_mfma_f32_16x16x32_bf16 v[152:155], v[108:111], v[180:183], v[168:171]
    v_mfma_f32_16x16x32_bf16 v[152:155], v[112:115], v[184:187], v[152:155]
    v_mfma_f32_16x16x32_bf16 v[156:159], v[116:119], v[180:183], v[172:175]
    v_mfma_f32_16x16x32_bf16 v[156:159], v[120:123], v[184:187], v[156:159]
    v_mfma_f32_16x16x32_bf16 v[160:163], v[124:127], v[180:183], v[176:179]
    v_mfma_f32_16x16x32_bf16 v[160:163], v[128:131], v[184:187], v[160:163]
    v_mov_b32 v136, 0
    v_mov_b32 v137, 0
    v_mov_b32 v138, 0
    v_mov_b32 v139, 0
    s_lshr_b64 s[86:87], s[56:57], 2
    s_lshr_b64 s[36:37], s[56:57], 4
    s_or_b32 s37, s36, s86
    s_or_b32 s36, s37, s56
    s_cmp_lg_u64 s[84:85], 0
    s_cbranch_scc0 Lf_mid
    s_mul_i32 s66, s53, 800
    s_add_u32 s8, s8, s66
    s_addc_u32 s9, s9, 0
    s_mov_b32 s24, s8
    s_and_b32 s25, s9, 0xffff
    s_mov_b32 s26, 400
    s_mov_b32 s27, 0x20000
    s_movk_i32 s32, 400
    s_branch Ls_mid
L_fp:
    v_mfma_i32_16x16x64_i8 v[172:175], v[122:125], v[100:103], 0
    v_and_b32 v160, 0x800080, v100
    v_mul_u32_u24 v160, 0x7f, v160
    v_bitop3_b32 v131, v100, v160, v131 bitop3:0xbe
    v_and_b32 v161, 0x800080, v101
    v_mul_u32_u24 v161, 0x7f, v161
    v_bitop3_b32 v131, v101, v161, v131 bitop3:0xbe
    v_and_b32 v160, 0x800080, v102
    v_mul_u32_u24 v160, 0x7f, v160
    v_mov_b32_dpp v184, v172 row_shr:1 row_mask:0xf bank_mask:0xf bound_ctrl:0
    v_bitop3_b32 v131, v102, v160, v131 bitop3:0xbe
    s_nop 0
    v_add_u32_dpp v184, v184, v184 row_shr:1 row_mask:0xf bank_mask:0xf bound_ctrl:0
    v_and_b32 v161, 0x800080, v103
    s_nop 0
    v_add_u32_dpp v184, v184, v184 row_shr:2 row_mask:0xf bank_mask:0xf bound_ctrl:0
    v_mul_u32_u24 v161, 0x7f, v161
    s_nop 0
    v_add_u32_dpp v184, v184, v184 row_shr:4 row_mask:0xf bank_mask:0xf bound_ctrl:0
    v_bitop3_b32 v131, v103, v161, v131 bitop3:0xbe
    s_nop 0
    v_add_u32_dpp v184, v184, v184 row_shr:8 row_mask:0xf bank_mask:0xf bound_ctrl:0
    v_cmp_ne_u32 vcc, 0, v131
    v_readlane_b32 s68, v184, 6
    v_readlane_b32 s69, v173, 6
    v_readlane_b32 s70, v184, 15
    s_mov_b32 s94, 0
    s_cbranch_vccnz L_late
    s_add_u32 s66, s68, s69
    s_add_u32 s66, s66, s64
    s_add_u32 s67, s66, 15
    s_and_b32 s67, s67, -16
    s_add_u32 s55, s64, 16
    s_max_u32 s67, s67, s55
    s_sub_u32 s66, s67, s66
    v_mad_u32_u24 v184, v130, s66, v184
    s_sub_u32 s55, s64, 2048
    v_add_u32 v172, s55, v184
    v_add_u32 v173, s55, v184
    v_add_u32 v174, s55, v184
    v_add_u32 v175, s55, v184
    s_add_u32 s64, s64, s70
    s_add_u32 s64, s64, s66
    v_mfma_i32_16x16x64_i8 v[132:135], v[118:121], v[100:103], v[172:175]
    v_mfma_i32_16x16x64_i8 v[136:139], v[116:119], v[100:103], v[172:175]
    s_add_u32 s64, s64, 15
    s_and_b32 s64, s64, -16
    s_add_u32 s55, s67, 16
    s_max_u32 s64, s64, s55
    s_lshr_b32 s95, s67, 4
    s_bitset1_b64 s[56:57], s95
    s_lshr_b32 s95, s64, 4
    s_bitset1_b64 s[56:57], s95
    s_add_u32 s66, s52, 18496
    s_cmp_ge_u32 s64, s66
    ds_write_b8 v132, v126
    ds_write_b8_d16_hi v133, v126
    ds_write_b8 v134, v127
    ds_write_b8_d16_hi v135, v127
    ds_write_b8 v136, v128
    ds_write_b8_d16_hi v137, v128
    ds_write_b8 v138, v129
    ds_write_b8_d16_hi v139, v129
    s_cbranch_scc0 L_late
    s_mov_b32 s94, 1
    ds_read_u8 v148, v237 offset:0
    ds_read_u8 v149, v237 offset:8
    ds_read_u8 v150, v237 offset:16
    ds_read_u8 v151, v237 offset:24
    ds_read_u8 v152, v237 offset:32
    ds_read_u8 v153, v237 offset:40
    s_waitcnt lgkmcnt(0)
    s_add_u32 m0, s52, 0
    v_mov_b32 v230, v148
    v_mov_b32 v232, v149
    buffer_load_dwordx4 v[230:231], s[20:23], s35 idxen offen nt lds
    buffer_load_dwordx4 v[232:233], s[40:43], s35 idxen offen offset:1056 nt lds
    s_bitcmp0_b64 s[56:57], 2
    s_cbranch_scc1 L_noadve1
    s_add_u32 s35, s35, s31
    s_min_u32 s35, s35, 419404800
    s_xor_b32 s31, s31, 0x63ff800
    s_sub_u32 s60, s60, 1
L_noadve1:
    s_add_u32 m0, s52, 2080
    v_mov_b32 v230, v150
    v_mov_b32 v232, v151
    buffer_load_dwordx4 v[230:231], s[20:23], s35 idxen offen nt lds
    buffer_load_dwordx4 v[232:233], s[40:43], s35 idxen offen offset:1056 nt lds
    s_setpc_b64 s[62:63]
L_late:
    s_waitcnt vmcnt(0)
    s_setpc_b64 s[62:63]
L_swap:
    v_lshrrev_b32 v140, 3, v0
    v_and_b32 v141, 7, v0
    v_mul_u32_u24 v140, 20480, v140
    v_mul_u32_u24 v141, 20480, v141
    v_add_u32 v140, s51, v140
    v_add_u32 v141, s51, v141
    v_mov_b32 v143, 1
    s_mov_b64 exec, 1
    ds_add_rtn_u32 v143, v140, v143 offset:14880
    s_mov_b64 exec, -1
L_swap_poll:
    ds_read_b32 v142, v141 offset:14848
    ds_read_b128 v[144:147], v140 offset:14848
    v_and_b32 v248, 56, v0
    s_waitcnt lgkmcnt(0)
    v_cmp_le_i32 vcc, 0, v142
    v_cmp_gt_u32 s[86:87], v142, v144
    v_lshlrev_b32 v249, 1, v142
    v_readfirstlane_b32 s66, v143
    s_cbranch_vccnz L_swap_poll
    v_lshrrev_b64 v[246:247], v248, s[86:87]
    v_cmp_gt_i32 s[88:89], 0, v249
    v_and_b32 v246, 0xff, v246
    v_bcnt_u32_b32 v246, v246, 0
    v_cmp_eq_u32 vcc, s66, v246
    s_lshl_b32 s67, s54, 3
    s_ff1_i32_b64 s66, vcc
    s_cmp_lg_u64 s[88:89], 0
    s_cselect_b32 s66, s67, s66
    s_sub_u32 s95, s66, s50
    s_mov_b32 s50, s66
    s_sub_u32 s83, s66, s67
    v_readlane_b32 s67, v146, s66
    v_readlane_b32 s55, v147, s66
    v_readlane_b32 s66, v145, s66
    s_mul_i32 s81, s95, 2560
    s_mul_i32 s95, s95, 6400
    s_add_u32 s35, s35, s95
    s_sub_u32 s95, s66, s44
    v_add_u32 v237, s95, v237
    s_mov_b32 s44, s55
    s_sub_u32 s67, s67, s66
    s_sub_u32 s55, s55, s66
    s_sub_u32 s95, s55, s68
    s_lshr_b32 s67, s67, 4
    s_add_u32 s67, s67, s49
    s_bitset1_b64 s[56:57], s67
    s_lshr_b32 s55, s55, 4
    s_add_u32 s55, s55, s49
    s_bitset1_b64 s[56:57], s55
    s_lshr_b64 s[86:87], s[56:57], 2
    s_lshr_b64 s[36:37], s[56:57], 4
    s_or_b32 s37, s36, s86
    s_or_b32 s36, s37, s56
    s_ashr_i32 s95, s95, 3
    v_mov_b32 v140, s95
    s_sub_u32 s95, 0, s95
    v_writelane_b32 v140, s95, 1
    ds_add_u32 v2, v140
    s_cmp_eq_u32 s51, 0
    s_cselect_b32 s80, s81, s80
    s_cselect_b32 s82, s83, s82
    s_cselect_b32 s60, 1, 8
    s_cselect_b32 s66, 4, 2
    s_mov_b32 s68, s69
    s_mov_b32 s51, 16
    s_cmp_eq_u32 s61, s66
    s_cbranch_scc1 L_swap_now
    s_sub_u32 s66, s66, 1
    s_bitset1_b32 s33, s66
    s_setpc_b64 s[62:63]
L_swap_now:
    v_add_u32 v238, s81, v238
    v_add_u32 v239, s81, v239
    ds_read_u16 v224, v238 offset:0
    ds_read_u16 v225, v238 offset:8
    ds_read_u16 v226, v238 offset:64
    ds_read_u16 v227, v238 offset:72
    s_setpc_b64 s[62:63]
L_t23:
    s_cmp_eq_u32 s94, 0
    s_cbranch_scc1 L_skip23
    s_bitcmp0_b64 s[56:57], 3
    s_cbranch_scc1 L_noadve2
    s_add_u32 s35, s35, s31
    s_min_u32 s35, s35, 419404800
    s_xor_b32 s31, s31, 0x63ff800
    s_sub_u32 s60, s60, 1
L_noadve2:
    s_add_u32 m0, s52, 4160
    v_mov_b32 v230, v152
    v_mov_b32 v232, v153
    buffer_load_dwordx4 v[230:231], s[20:23], s35 idxen offen nt lds
    buffer_load_dwordx4 v[232:233], s[40:43], s35 idxen offen offset:1056 nt lds
    s_setpc_b64 s[62:63]
L_skip23:
    s_waitcnt vmcnt(0)
    s_setpc_b64 s[62:63]
.p2align 6
Lf_loop:
Lf_mid:
    s_bitcmp1_b32 s36, 0
    s_cbranch_scc1 Lf_ev0
Lf_evd0:
    v_mfma_f32_16x16x32_bf16 v[208:211], v[136:139], v[200:203], v[208:211]
    v_exp_f32 v132, v148
    v_exp_f32 v133, v149
    v_exp_f32 v134, v150
    v_exp_f32 v135, v151
    v_exp_f32 v136, v152
    v_exp_f32 v137, v153
    v_mfma_f32_4x4x4_16b_bf16 v[132:135], v[228:229], v[228:229], v[132:135]
    v_exp_f32 v138, v154
    v_exp_f32 v139, v155
    v_cvt_pk_bf16_f32 v208, v208, v209
    v_cvt_pk_bf16_f32 v209, v210, v211
    v_exp_f32 v140, v156
    v_exp_f32 v141, v157
    v_mfma_f32_4x4x4_16b_bf16 v[212:215], v[208:209], v[188:189], v[212:215] cbsz:4 abid:0
    v_mfma_f32_4x4x4_16b_bf16 v[136:139], v[228:229], v[228:229], v[136:139]
    v_exp_f32 v142, v158
    v_mfma_f32_4x4x4_16b_bf16 v[212:215], v[208:209], v[190:191], v[212:215] cbsz:4 abid:4
    v_exp_f32 v143, v159
    v_exp_f32 v144, v160
    v_mfma_f32_4x4x4_16b_bf16 v[212:215], v[208:209], v[192:193], v[212:215] cbsz:4 abid:8
    v_exp_f32 v145, v161
    v_mfma_f32_4x4x4_16b_bf16 v[140:143], v[228:229], v[228:229], v[140:143]
    v_mfma_f32_4x4x4_16b_bf16 v[212:215], v[208:209], v[194:195], v[212:215] cbsz:4 abid:12
    ds_add_rtn_u32 v1, v2, v3
    ds_read_u8 v230, v237 offset:48
    ds_read_u8 v232, v237 offset:56
    ds_read_b64_tr_b16 v[188:189], v236 offset:0
    ds_read_b64_tr_b16 v[190:191], v236 offset:512
    ds_read_b64_tr_b16 v[192:193], v236 offset:1056
    ds_read_b64_tr_b16 v[194:195], v236 offset:1568
    s_waitcnt vmcnt(2)
    ds_read_b128 v[180:183], v234 offset:2080
    ds_read_b128 v[184:187], v235 offset:2080
    s_add_u32 m0, s52, 6240
    v_exp_f32 v146, v162
    v_exp_f32 v147, v163
    v_rcp_f32 v132, v132
    v_rcp_f32 v133, v133
    v_mfma_f32_4x4x4_16b_bf16 v[144:147], v[228:229], v[228:229], v[144:147]
    v_rcp_f32 v134, v134
    v_cvt_pk_bf16_f32 v132, v132, v133
    s_waitcnt lgkmcnt(6)
    buffer_load_dwordx4 v[230:231], s[20:23], s35 idxen offen nt lds
    buffer_load_dwordx4 v[232:233], s[40:43], s35 idxen offen offset:1056 nt lds
    s_waitcnt lgkmcnt(0)
    v_mfma_f32_16x16x32_bf16 v[148:151], v[100:103], v[180:183], v[164:167]
    v_rcp_f32 v135, v135
    v_mfma_f32_16x16x32_bf16 v[152:155], v[108:111], v[180:183], v[168:171]
    v_rcp_f32 v136, v136
    v_cvt_pk_bf16_f32 v133, v134, v135
    v_mfma_f32_16x16x32_bf16 v[148:151], v[104:107], v[184:187], v[148:151]
    v_rcp_f32 v137, v137
    v_cmp_gt_i32 vcc, v1, v245
    s_setprio 0
    s_cbranch_vccz Lf_lo0
    s_setprio 1
Lf_lo0:
    v_mfma_f32_16x16x32_bf16 v[152:155], v[112:115], v[184:187], v[152:155]
    v_rcp_f32 v138, v138
    v_cvt_pk_bf16_f32 v134, v136, v137
    v_mfma_f32_16x16x32_bf16 v[156:159], v[116:119], v[180:183], v[172:175]
    v_rcp_f32 v139, v139
    v_mfma_f32_16x16x32_bf16 v[160:163], v[124:127], v[180:183], v[176:179]
    v_rcp_f32 v140, v140
    v_cvt_pk_bf16_f32 v135, v138, v139
    v_mfma_f32_16x16x32_bf16 v[156:159], v[120:123], v[184:187], v[156:159]
    v_rcp_f32 v141, v141
    v_mfma_f32_16x16x32_bf16 v[160:163], v[128:131], v[184:187], v[160:163]
    v_rcp_f32 v142, v142
    v_cvt_pk_bf16_f32 v136, v140, v141
    v_mfma_f32_16x16x32_bf16 v[208:211], v[132:135], v[196:199], v[204:207]
    v_rcp_f32 v143, v143
    v_rcp_f32 v144, v144
    v_cvt_pk_bf16_f32 v137, v142, v143
    v_rcp_f32 v145, v145
    v_rcp_f32 v146, v146
    v_rcp_f32 v147, v147
    v_cvt_pk_bf16_f32 v138, v144, v145
    v_cvt_pk_bf16_f32 v139, v146, v147
    s_bitcmp1_b32 s36, 1
    s_cbranch_scc1 Lf_ev1
Lf_evd1:
    v_mfma_f32_16x16x32_bf16 v[208:211], v[136:139], v[200:203], v[208:211]
    v_exp_f32 v132, v148
    v_exp_f32 v133, v149
    v_exp_f32 v134, v150
    v_exp_f32 v135, v151
    v_exp_f32 v136, v152
    v_exp_f32 v137, v153
    v_mfma_f32_4x4x4_16b_bf16 v[132:135], v[228:229], v[228:229], v[132:135]
    v_exp_f32 v138, v154
    v_exp_f32 v139, v155
    v_cvt_pk_bf16_f32 v208, v208, v209
    v_cvt_pk_bf16_f32 v209, v210, v211
    v_exp_f32 v140, v156
    v_exp_f32 v141, v157
    v_mfma_f32_4x4x4_16b_bf16 v[212:215], v[208:209], v[188:189], v[212:215] cbsz:4 abid:0
    v_mfma_f32_4x4x4_16b_bf16 v[136:139], v[228:229], v[228:229], v[136:139]
    v_exp_f32 v142, v158
    v_mfma_f32_4x4x4_16b_bf16 v[212:215], v[208:209], v[190:191], v[212:215] cbsz:4 abid:4
    v_exp_f32 v143, v159
    v_exp_f32 v144, v160
    v_mfma_f32_4x4x4_16b_bf16 v[212:215], v[208:209], v[192:193], v[212:215] cbsz:4 abid:8
    v_exp_f32 v145, v161
    v_mfma_f32_4x4x4_16b_bf16 v[140:143], v[228:229], v[228:229], v[140:143]
    v_mfma_f32_4x4x4_16b_bf16 v[212:215], v[208:209], v[194:195], v[212:215] cbsz:4 abid:12
    ds_read_u8 v230, v237 offset:64
    ds_read_u8 v232, v237 offset:72
    ds_read_b64_tr_b16 v[188:189], v236 offset:2080
    ds_read_b64_tr_b16 v[190:191], v236 offset:2592
    ds_read_b64_tr_b16 v[192:193], v236 offset:3136
    ds_read_b64_tr_b16 v[194:195], v236 offset:3648
    s_waitcnt vmcnt(2)
    ds_read_b128 v[180:183], v234 offset:4160
    ds_read_b128 v[184:187], v235 offset:4160
    s_add_u32 m0, s52, 0
    v_exp_f32 v146, v162
    v_exp_f32 v147, v163
    v_rcp_f32 v132, v132
    v_rcp_f32 v133, v133
    v_mfma_f32_4x4x4_16b_bf16 v[144:147], v[228:229], v[228:229], v[144:147]
    v_rcp_f32 v134, v134
    v_cvt_pk_bf16_f32 v132, v132, v133
    s_waitcnt lgkmcnt(6)
    buffer_load_dwordx4 v[230:231], s[20:23], s35 idxen offen nt lds
    buffer_load_dwordx4 v[232:233], s[40:43], s35 idxen offen offset:1056 nt lds
    s_waitcnt lgkmcnt(0)
    v_mfma_f32_16x16x32_bf16 v[148:151], v[100:103], v[180:183], v[164:167]
    v_rcp_f32 v135, v135
    v_mfma_f32_16x16x32_bf16 v[152:155], v[108:111], v[180:183], v[168:171]
    v_rcp_f32 v136, v136
    v_cvt_pk_bf16_f32 v133, v134, v135
    v_mfma_f32_16x16x32_bf16 v[148:151], v[104:107], v[184:187], v[148:151]
    v_rcp_f32 v137, v137
    v_mfma_f32_16x16x32_bf16 v[152:155], v[112:115], v[184:187], v[152:155]
    v_rcp_f32 v138, v138
    v_cvt_pk_bf16_f32 v134, v136, v137
    v_mfma_f32_16x16x32_bf16 v[156:159], v[116:119], v[180:183], v[172:175]
    v_rcp_f32 v139, v139
    v_mfma_f32_16x16x32_bf16 v[160:163], v[124:127], v[180:183], v[176:179]
    v_rcp_f32 v140, v140
    v_cvt_pk_bf16_f32 v135, v138, v139
    v_mfma_f32_16x16x32_bf16 v[156:159], v[120:123], v[184:187], v[156:159]
    v_rcp_f32 v141, v141
    v_mfma_f32_16x16x32_bf16 v[160:163], v[128:131], v[184:187], v[160:163]
    v_rcp_f32 v142, v142
    v_cvt_pk_bf16_f32 v136, v140, v141
    v_mfma_f32_16x16x32_bf16 v[208:211], v[132:135], v[196:199], v[204:207]
    v_rcp_f32 v143, v143
    v_rcp_f32 v144, v144
    v_cvt_pk_bf16_f32 v137, v142, v143
    v_rcp_f32 v145, v145
    v_rcp_f32 v146, v146
    v_rcp_f32 v147, v147
    v_cvt_pk_bf16_f32 v138, v144, v145
    v_cvt_pk_bf16_f32 v139, v146, v147
    s_bitcmp1_b32 s36, 2
    s_cbranch_scc1 Lf_ev2
Lf_evd2:
    v_mfma_f32_16x16x32_bf16 v[208:211], v[136:139], v[200:203], v[208:211]
    v_exp_f32 v132, v148
    v_exp_f32 v133, v149
    v_exp_f32 v134, v150
    v_exp_f32 v135, v151
    v_exp_f32 v136, v152
    v_exp_f32 v137, v153
    v_mfma_f32_4x4x4_16b_bf16 v[132:135], v[228:229], v[228:229], v[132:135]
    v_exp_f32 v138, v154
    v_exp_f32 v139, v155
    v_cvt_pk_bf16_f32 v208, v208, v209
    v_cvt_pk_bf16_f32 v209, v210, v211
    v_exp_f32 v140, v156
    v_exp_f32 v141, v157
    v_mfma_f32_4x4x4_16b_bf16 v[212:215], v[208:209], v[188:189], v[212:215] cbsz:4 abid:0
    v_mfma_f32_4x4x4_16b_bf16 v[136:139], v[228:229], v[228:229], v[136:139]
    v_exp_f32 v142, v158
    v_mfma_f32_4x4x4_16b_bf16 v[212:215], v[208:209], v[190:191], v[212:215] cbsz:4 abid:4
    v_exp_f32 v143, v159
    v_exp_f32 v144, v160
    v_mfma_f32_4x4x4_16b_bf16 v[212:215], v[208:209], v[192:193], v[212:215] cbsz:4 abid:8
    v_exp_f32 v145, v161
    v_mfma_f32_4x4x4_16b_bf16 v[140:143], v[228:229], v[228:229], v[140:143]
    v_mfma_f32_4x4x4_16b_bf16 v[212:215], v[208:209], v[194:195], v[212:215] cbsz:4 abid:12
    ds_read_u8 v230, v237 offset:80
    ds_read_u8 v232, v237 offset:88
    ds_read_b64_tr_b16 v[188:189], v236 offset:4160
    ds_read_b64_tr_b16 v[190:191], v236 offset:4672
    ds_read_b64_tr_b16 v[192:193], v236 offset:5216
    ds_read_b64_tr_b16 v[194:195], v236 offset:5728
    s_waitcnt vmcnt(2)
    ds_read_b128 v[180:183], v234 offset:6240
    ds_read_b128 v[184:187], v235 offset:6240
    s_add_u32 m0, s52, 2080
    v_exp_f32 v146, v162
    v_exp_f32 v147, v163
    v_rcp_f32 v132, v132
    v_rcp_f32 v133, v133
    v_mfma_f32_4x4x4_16b_bf16 v[144:147], v[228:229], v[228:229], v[144:147]
    v_rcp_f32 v134, v134
    v_cvt_pk_bf16_f32 v132, v132, v133
    s_waitcnt lgkmcnt(6)
    buffer_load_dwordx4 v[230:231], s[20:23], s35 idxen offen nt lds
    buffer_load_dwordx4 v[232:233], s[40:43], s35 idxen offen offset:1056 nt lds
    s_waitcnt lgkmcnt(0)
    v_mfma_f32_16x16x32_bf16 v[148:151], v[100:103], v[180:183], v[164:167]
    v_rcp_f32 v135, v135
    v_mfma_f32_16x16x32_bf16 v[152:155], v[108:111], v[180:183], v[168:171]
    v_rcp_f32 v136, v136
    v_cvt_pk_bf16_f32 v133, v134, v135
    v_mfma_f32_16x16x32_bf16 v[148:151], v[104:107], v[184:187], v[148:151]
    v_rcp_f32 v137, v137
    v_mfma_f32_16x16x32_bf16 v[152:155], v[112:115], v[184:187], v[152:155]
    v_rcp_f32 v138, v138
    v_cvt_pk_bf16_f32 v134, v136, v137
    v_mfma_f32_16x16x32_bf16 v[156:159], v[116:119], v[180:183], v[172:175]
    v_rcp_f32 v139, v139
    v_mfma_f32_16x16x32_bf16 v[160:163], v[124:127], v[180:183], v[176:179]
    v_rcp_f32 v140, v140
    v_cvt_pk_bf16_f32 v135, v138, v139
    v_mfma_f32_16x16x32_bf16 v[156:159], v[120:123], v[184:187], v[156:159]
    v_rcp_f32 v141, v141
    v_mfma_f32_16x16x32_bf16 v[160:163], v[128:131], v[184:187], v[160:163]
    v_rcp_f32 v142, v142
    v_cvt_pk_bf16_f32 v136, v140, v141
    v_mfma_f32_16x16x32_bf16 v[208:211], v[132:135], v[196:199], v[204:207]
    v_rcp_f32 v143, v143
    v_rcp_f32 v144, v144
    v_cvt_pk_bf16_f32 v137, v142, v143
    v_rcp_f32 v145, v145
    v_rcp_f32 v146, v146
    v_rcp_f32 v147, v147
    v_cvt_pk_bf16_f32 v138, v144, v145
    v_cvt_pk_bf16_f32 v139, v146, v147
    s_bitcmp1_b32 s36, 3
    s_cbranch_scc1 Lf_ev3
Lf_evd3:
    v_mfma_f32_16x16x32_bf16 v[208:211], v[136:139], v[200:203], v[208:211]
    v_exp_f32 v132, v148
    v_exp_f32 v133, v149
    v_exp_f32 v134, v150
    v_exp_f32 v135, v151
    v_exp_f32 v136, v152
    v_exp_f32 v137, v153
    v_mfma_f32_4x4x4_16b_bf16 v[132:135], v[228:229], v[228:229], v[132:135]
    v_exp_f32 v138, v154
    v_exp_f32 v139, v155
    v_cvt_pk_bf16_f32 v208, v208, v209
    v_cvt_pk_bf16_f32 v209, v210, v211
    v_exp_f32 v140, v156
    v_exp_f32 v141, v157
    v_mfma_f32_4x4x4_16b_bf16 v[212:215], v[208:209], v[188:189], v[212:215] cbsz:4 abid:0
    v_mfma_f32_4x4x4_16b_bf16 v[136:139], v[228:229], v[228:229], v[136:139]
    v_exp_f32 v142, v158
    v_mfma_f32_4x4x4_16b_bf16 v[212:215], v[208:209], v[190:191], v[212:215] cbsz:4 abid:4
    v_exp_f32 v143, v159
    v_exp_f32 v144, v160
    v_mfma_f32_4x4x4_16b_bf16 v[212:215], v[208:209], v[192:193], v[212:215] cbsz:4 abid:8
    v_exp_f32 v145, v161
    v_mfma_f32_4x4x4_16b_bf16 v[140:143], v[228:229], v[228:229], v[140:143]
    v_mfma_f32_4x4x4_16b_bf16 v[212:215], v[208:209], v[194:195], v[212:215] cbsz:4 abid:12
    ds_read_u8 v230, v237 offset:96
    ds_read_u8 v232, v237 offset:104
    ds_read_b64_tr_b16 v[188:189], v236 offset:6240
    ds_read_b64_tr_b16 v[190:191], v236 offset:6752
    ds_read_b64_tr_b16 v[192:193], v236 offset:7296
    ds_read_b64_tr_b16 v[194:195], v236 offset:7808
    s_waitcnt vmcnt(2)
    ds_read_b128 v[180:183], v234 offset:0
    ds_read_b128 v[184:187], v235 offset:0
    s_add_u32 m0, s52, 4160
    v_exp_f32 v146, v162
    v_exp_f32 v147, v163
    v_rcp_f32 v132, v132
    v_rcp_f32 v133, v133
    v_mfma_f32_4x4x4_16b_bf16 v[144:147], v[228:229], v[228:229], v[144:147]
    v_rcp_f32 v134, v134
    v_cvt_pk_bf16_f32 v132, v132, v133
    s_waitcnt lgkmcnt(6)
    buffer_load_dwordx4 v[230:231], s[20:23], s35 idxen offen nt lds
    buffer_load_dwordx4 v[232:233], s[40:43], s35 idxen offen offset:1056 nt lds
    s_waitcnt lgkmcnt(0)
    v_mfma_f32_16x16x32_bf16 v[148:151], v[100:103], v[180:183], v[164:167]
    v_rcp_f32 v135, v135
    v_mfma_f32_16x16x32_bf16 v[152:155], v[108:111], v[180:183], v[168:171]
    v_rcp_f32 v136, v136
    v_cvt_pk_bf16_f32 v133, v134, v135
    v_mfma_f32_16x16x32_bf16 v[148:151], v[104:107], v[184:187], v[148:151]
    v_rcp_f32 v137, v137
    v_mfma_f32_16x16x32_bf16 v[152:155], v[112:115], v[184:187], v[152:155]
    v_rcp_f32 v138, v138
    v_cvt_pk_bf16_f32 v134, v136, v137
    v_mfma_f32_16x16x32_bf16 v[156:159], v[116:119], v[180:183], v[172:175]
    v_rcp_f32 v139, v139
    v_mfma_f32_16x16x32_bf16 v[160:163], v[124:127], v[180:183], v[176:179]
    v_rcp_f32 v140, v140
    v_cvt_pk_bf16_f32 v135, v138, v139
    v_mfma_f32_16x16x32_bf16 v[156:159], v[120:123], v[184:187], v[156:159]
    v_rcp_f32 v141, v141
    v_mfma_f32_16x16x32_bf16 v[160:163], v[128:131], v[184:187], v[160:163]
    v_rcp_f32 v142, v142
    v_cvt_pk_bf16_f32 v136, v140, v141
    v_mfma_f32_16x16x32_bf16 v[208:211], v[132:135], v[196:199], v[204:207]
    v_rcp_f32 v143, v143
    v_rcp_f32 v144, v144
    v_cvt_pk_bf16_f32 v137, v142, v143
    s_lshr_b64 s[56:57], s[56:57], 4
    s_lshr_b64 s[86:87], s[56:57], 2
    s_lshr_b64 s[36:37], s[56:57], 4
    s_or_b32 s37, s36, s86
    s_or_b32 s36, s37, s56
    v_add_u32 v237, 64, v237
    v_rcp_f32 v145, v145
    v_rcp_f32 v146, v146
    v_rcp_f32 v147, v147
    v_cvt_pk_bf16_f32 v138, v144, v145
    v_cvt_pk_bf16_f32 v139, v146, v147
    s_branch Lf_loop
Lf_fl0:
    v_cvt_pk_bf16_f32 v246, v212, v212
    v_mov_b32 v212, 0
    ds_write_b16 v240, v246
    v_add_u32 v240, 128, v240
    s_bitcmp0_b32 s37, 0
    s_cbranch_scc1 Lf_evd0
    s_branch Lf_ev20
Lf_ev0:
    s_bitcmp1_b64 s[56:57], 0
    s_cbranch_scc1 Lf_fl0
Lf_ev20:
    s_bitcmp1_b64 s[56:57], 2
    s_cbranch_scc1 Lf_w0
    s_sub_u32 s60, s60, 1
    s_cbranch_scc0 Lf_nsa0
    s_mov_b32 s49, 4
    s_call_b64 s[62:63], L_swap
Lf_nsa0:
    s_add_u32 s35, s35, s31
    s_min_u32 s35, s35, 419404800
    s_xor_b32 s31, s31, 0x63ff800
    s_branch Lf_evd0
Lf_w0:
    s_bitcmp0_b64 s[56:57], 4
    s_cbranch_scc1 Lf_e10
    s_sub_u32 s60, s60, 1
    s_cbranch_scc0 Lf_nsb0
    s_mov_b32 s49, 4
    s_call_b64 s[62:63], L_swap
    s_waitcnt lgkmcnt(0)
Lf_nsb0:
    s_add_u32 s35, s35, s31
    s_min_u32 s35, s35, 419404800
    s_xor_b32 s31, s31, 0x63ff800
Lf_e10:
    s_sub_u32 s61, s61, 1
    s_cbranch_scc1 Lf_last0
    s_bitcmp0_b32 s33, s61
    s_cbranch_scc1 Lf_nw0
    s_cmp_eq_u32 s61, 3
    s_cselect_b32 s66, s80, s81
    v_add_u32 v238, s66, v238
    v_add_u32 v239, s66, v239
    ds_read_u16 v224, v238 offset:0
    ds_read_u16 v225, v238 offset:8
    ds_read_u16 v226, v238 offset:64
    ds_read_u16 v227, v238 offset:72
    s_waitcnt lgkmcnt(0)
Lf_nw0:
    v_mul_u32_u24 v216, v224, v241
    v_mul_u32_u24 v217, v224, v242
    v_mul_u32_u24 v218, v225, v241
    v_mul_u32_u24 v219, v225, v242
    v_mul_u32_u24 v220, v226, v241
    v_mul_u32_u24 v221, v226, v242
    v_mul_u32_u24 v222, v227, v241
    v_mul_u32_u24 v223, v227, v242
    v_mfma_f32_4x4x4_16b_bf16 v[140:143], v[216:217], v[68:69], v[4:7]
    v_add_u32 v238, 128, v238
    ds_read_b128 v[164:167], v239 offset:0
    ds_read_b128 v[168:171], v239 offset:64
    v_mfma_f32_4x4x4_16b_bf16 v[144:147], v[218:219], v[70:71], v[8:11]
    ds_read_b128 v[172:175], v239 offset:128
    ds_read_b128 v[176:179], v239 offset:192
    ds_read_u16 v224, v238 offset:0
    ds_read_u16 v225, v238 offset:8
    ds_read_u16 v226, v238 offset:64
    ds_read_u16 v227, v238 offset:72
    v_mfma_f32_4x4x4_16b_bf16 v[246:249], v[220:221], v[72:73], v[12:15]
    v_cvt_pk_bf16_f32 v100, v140, v141
    v_cvt_pk_bf16_f32 v101, v142, v143
    v_mfma_f32_4x4x4_16b_bf16 v[250:253], v[222:223], v[74:75], v[16:19]
    v_cvt_pk_bf16_f32 v102, v144, v145
    v_cvt_pk_bf16_f32 v103, v146, v147
    v_mfma_f32_4x4x4_16b_bf16 v[140:143], v[216:217], v[76:77], v[20:23]
    v_cvt_pk_bf16_f32 v104, v246, v247
    v_cvt_pk_bf16_f32 v105, v248, v249
    v_mfma_f32_4x4x4_16b_bf16 v[144:147], v[218:219], v[78:79], v[24:27]
    v_cvt_pk_bf16_f32 v106, v250, v251
    v_cvt_pk_bf16_f32 v107, v252, v253
    v_mfma_f32_4x4x4_16b_bf16 v[246:249], v[220:221], v[80:81], v[28:31]
    v_cvt_pk_bf16_f32 v108, v140, v141
    v_cvt_pk_bf16_f32 v109, v142, v143
    v_mfma_f32_4x4x4_16b_bf16 v[250:253], v[222:223], v[82:83], v[32:35]
    v_cvt_pk_bf16_f32 v110, v144, v145
    v_cvt_pk_bf16_f32 v111, v146, v147
    v_mfma_f32_4x4x4_16b_bf16 v[140:143], v[216:217], v[84:85], v[36:39]
    v_cvt_pk_bf16_f32 v112, v246, v247
    v_cvt_pk_bf16_f32 v113, v248, v249
    v_mfma_f32_4x4x4_16b_bf16 v[144:147], v[218:219], v[86:87], v[40:43]
    v_cvt_pk_bf16_f32 v114, v250, v251
    v_cvt_pk_bf16_f32 v115, v252, v253
    v_mfma_f32_4x4x4_16b_bf16 v[246:249], v[220:221], v[88:89], v[44:47]
    v_cvt_pk_bf16_f32 v116, v140, v141
    v_cvt_pk_bf16_f32 v117, v142, v143
    v_mfma_f32_4x4x4_16b_bf16 v[250:253], v[222:223], v[90:91], v[48:51]
    v_cvt_pk_bf16_f32 v118, v144, v145
    v_cvt_pk_bf16_f32 v119, v146, v147
    v_mfma_f32_4x4x4_16b_bf16 v[140:143], v[216:217], v[92:93], v[52:55]
    v_cvt_pk_bf16_f32 v120, v246, v247
    v_cvt_pk_bf16_f32 v121, v248, v249
    v_mfma_f32_4x4x4_16b_bf16 v[144:147], v[218:219], v[94:95], v[56:59]
    v_cvt_pk_bf16_f32 v122, v250, v251
    v_cvt_pk_bf16_f32 v123, v252, v253
    v_mfma_f32_4x4x4_16b_bf16 v[246:249], v[220:221], v[96:97], v[60:63]
    v_cvt_pk_bf16_f32 v124, v140, v141
    v_cvt_pk_bf16_f32 v125, v142, v143
    v_mfma_f32_4x4x4_16b_bf16 v[250:253], v[222:223], v[98:99], v[64:67]
    v_cvt_pk_bf16_f32 v126, v144, v145
    v_cvt_pk_bf16_f32 v127, v146, v147
    v_cvt_pk_bf16_f32 v128, v246, v247
    v_cvt_pk_bf16_f32 v129, v248, v249
    v_add_u32 v239, 272, v239
    v_cvt_pk_bf16_f32 v130, v250, v251
    v_cvt_pk_bf16_f32 v131, v252, v253
    s_waitcnt lgkmcnt(0)
    s_branch Lf_evd0
Lf_fl1:
    v_cvt_pk_bf16_f32 v246, v212, v212
    v_mov_b32 v212, 0
    ds_write_b16 v240, v246
    v_add_u32 v240, 128, v240
    s_bitcmp0_b32 s37, 1
    s_cbranch_scc1 Lf_evd1
    s_branch Lf_ev21
Lf_ev1:
    s_bitcmp1_b64 s[56:57], 1
    s_cbranch_scc1 Lf_fl1
Lf_ev21:
    s_bitcmp1_b64 s[56:57], 3
    s_cbranch_scc1 Lf_w1
    s_sub_u32 s60, s60, 1
    s_cbranch_scc0 Lf_nsa1
    s_mov_b32 s49, 5
    s_call_b64 s[62:63], L_swap
Lf_nsa1:
    s_add_u32 s35, s35, s31
    s_min_u32 s35, s35, 419404800
    s_xor_b32 s31, s31, 0x63ff800
    s_branch Lf_evd1
Lf_w1:
    s_bitcmp0_b64 s[56:57], 5
    s_cbranch_scc1 Lf_e11
    s_sub_u32 s60, s60, 1
    s_cbranch_scc0 Lf_nsb1
    s_mov_b32 s49, 5
    s_call_b64 s[62:63], L_swap
    s_waitcnt lgkmcnt(0)
Lf_nsb1:
    s_add_u32 s35, s35, s31
    s_min_u32 s35, s35, 419404800
    s_xor_b32 s31, s31, 0x63ff800
Lf_e11:
    s_sub_u32 s61, s61, 1
    s_cbranch_scc1 Lf_last1
    s_bitcmp0_b32 s33, s61
    s_cbranch_scc1 Lf_nw1
    s_cmp_eq_u32 s61, 3
    s_cselect_b32 s66, s80, s81
    v_add_u32 v238, s66, v238
    v_add_u32 v239, s66, v239
    ds_read_u16 v224, v238 offset:0
    ds_read_u16 v225, v238 offset:8
    ds_read_u16 v226, v238 offset:64
    ds_read_u16 v227, v238 offset:72
    s_waitcnt lgkmcnt(0)
Lf_nw1:
    v_mul_u32_u24 v216, v224, v241
    v_mul_u32_u24 v217, v224, v242
    v_mul_u32_u24 v218, v225, v241
    v_mul_u32_u24 v219, v225, v242
    v_mul_u32_u24 v220, v226, v241
    v_mul_u32_u24 v221, v226, v242
    v_mul_u32_u24 v222, v227, v241
    v_mul_u32_u24 v223, v227, v242
    v_mfma_f32_4x4x4_16b_bf16 v[140:143], v[216:217], v[68:69], v[4:7]
    v_add_u32 v238, 128, v238
    ds_read_b128 v[164:167], v239 offset:0
    ds_read_b128 v[168:171], v239 offset:64
    v_mfma_f32_4x4x4_16b_bf16 v[144:147], v[218:219], v[70:71], v[8:11]
    ds_read_b128 v[172:175], v239 offset:128
    ds_read_b128 v[176:179], v239 offset:192
    ds_read_u16 v224, v238 offset:0
    ds_read_u16 v225, v238 offset:8
    ds_read_u16 v226, v238 offset:64
    ds_read_u16 v227, v238 offset:72
    v_mfma_f32_4x4x4_16b_bf16 v[246:249], v[220:221], v[72:73], v[12:15]
    v_cvt_pk_bf16_f32 v100, v140, v141
    v_cvt_pk_bf16_f32 v101, v142, v143
    v_mfma_f32_4x4x4_16b_bf16 v[250:253], v[222:223], v[74:75], v[16:19]
    v_cvt_pk_bf16_f32 v102, v144, v145
    v_cvt_pk_bf16_f32 v103, v146, v147
    v_mfma_f32_4x4x4_16b_bf16 v[140:143], v[216:217], v[76:77], v[20:23]
    v_cvt_pk_bf16_f32 v104, v246, v247
    v_cvt_pk_bf16_f32 v105, v248, v249
    v_mfma_f32_4x4x4_16b_bf16 v[144:147], v[218:219], v[78:79], v[24:27]
    v_cvt_pk_bf16_f32 v106, v250, v251
    v_cvt_pk_bf16_f32 v107, v252, v253
    v_mfma_f32_4x4x4_16b_bf16 v[246:249], v[220:221], v[80:81], v[28:31]
    v_cvt_pk_bf16_f32 v108, v140, v141
    v_cvt_pk_bf16_f32 v109, v142, v143
    v_mfma_f32_4x4x4_16b_bf16 v[250:253], v[222:223], v[82:83], v[32:35]
    v_cvt_pk_bf16_f32 v110, v144, v145
    v_cvt_pk_bf16_f32 v111, v146, v147
    v_mfma_f32_4x4x4_16b_bf16 v[140:143], v[216:217], v[84:85], v[36:39]
    v_cvt_pk_bf16_f32 v112, v246, v247
    v_cvt_pk_bf16_f32 v113, v248, v249
    v_mfma_f32_4x4x4_16b_bf16 v[144:147], v[218:219], v[86:87], v[40:43]
    v_cvt_pk_bf16_f32 v114, v250, v251
    v_cvt_pk_bf16_f32 v115, v252, v253
    v_mfma_f32_4x4x4_16b_bf16 v[246:249], v[220:221], v[88:89], v[44:47]
    v_cvt_pk_bf16_f32 v116, v140, v141
    v_cvt_pk_bf16_f32 v117, v142, v143
    v_mfma_f32_4x4x4_16b_bf16 v[250:253], v[222:223], v[90:91], v[48:51]
    v_cvt_pk_bf16_f32 v118, v144, v145
    v_cvt_pk_bf16_f32 v119, v146, v147
    v_mfma_f32_4x4x4_16b_bf16 v[140:143], v[216:217], v[92:93], v[52:55]
    v_cvt_pk_bf16_f32 v120, v246, v247
    v_cvt_pk_bf16_f32 v121, v248, v249
    v_mfma_f32_4x4x4_16b_bf16 v[144:147], v[218:219], v[94:95], v[56:59]
    v_cvt_pk_bf16_f32 v122, v250, v251
    v_cvt_pk_bf16_f32 v123, v252, v253
    v_mfma_f32_4x4x4_16b_bf16 v[246:249], v[220:221], v[96:97], v[60:63]
    v_cvt_pk_bf16_f32 v124, v140, v141
    v_cvt_pk_bf16_f32 v125, v142, v143
    v_mfma_f32_4x4x4_16b_bf16 v[250:253], v[222:223], v[98:99], v[64:67]
    v_cvt_pk_bf16_f32 v126, v144, v145
    v_cvt_pk_bf16_f32 v127, v146, v147
    v_cvt_pk_bf16_f32 v128, v246, v247
    v_cvt_pk_bf16_f32 v129, v248, v249
    v_add_u32 v239, 272, v239
    v_cvt_pk_bf16_f32 v130, v250, v251
    v_cvt_pk_bf16_f32 v131, v252, v253
    s_waitcnt lgkmcnt(0)
    s_branch Lf_evd1
Lf_fl2:
    v_cvt_pk_bf16_f32 v246, v212, v212
    v_mov_b32 v212, 0
    ds_write_b16 v240, v246
    v_add_u32 v240, 128, v240
    s_bitcmp0_b32 s37, 2
    s_cbranch_scc1 Lf_evd2
    s_branch Lf_ev22
Lf_ev2:
    s_bitcmp1_b64 s[56:57], 2
    s_cbranch_scc1 Lf_fl2
Lf_ev22:
    s_bitcmp1_b64 s[56:57], 4
    s_cbranch_scc1 Lf_w2
    s_sub_u32 s60, s60, 1
    s_cbranch_scc0 Lf_nsa2
    s_mov_b32 s49, 6
    s_call_b64 s[62:63], L_swap
Lf_nsa2:
    s_add_u32 s35, s35, s31
    s_min_u32 s35, s35, 419404800
    s_xor_b32 s31, s31, 0x63ff800
    s_branch Lf_evd2
Lf_w2:
    s_bitcmp0_b64 s[56:57], 6
    s_cbranch_scc1 Lf_e12
    s_sub_u32 s60, s60, 1
    s_cbranch_scc0 Lf_nsb2
    s_mov_b32 s49, 6
    s_call_b64 s[62:63], L_swap
    s_waitcnt lgkmcnt(0)
Lf_nsb2:
    s_add_u32 s35, s35, s31
    s_min_u32 s35, s35, 419404800
    s_xor_b32 s31, s31, 0x63ff800
Lf_e12:
    s_sub_u32 s61, s61, 1
    s_cbranch_scc1 Lf_last2
    s_bitcmp0_b32 s33, s61
    s_cbranch_scc1 Lf_nw2
    s_cmp_eq_u32 s61, 3
    s_cselect_b32 s66, s80, s81
    v_add_u32 v238, s66, v238
    v_add_u32 v239, s66, v239
    ds_read_u16 v224, v238 offset:0
    ds_read_u16 v225, v238 offset:8
    ds_read_u16 v226, v238 offset:64
    ds_read_u16 v227, v238 offset:72
    s_waitcnt lgkmcnt(0)
Lf_nw2:
    v_mul_u32_u24 v216, v224, v241
    v_mul_u32_u24 v217, v224, v242
    v_mul_u32_u24 v218, v225, v241
    v_mul_u32_u24 v219, v225, v242
    v_mul_u32_u24 v220, v226, v241
    v_mul_u32_u24 v221, v226, v242
    v_mul_u32_u24 v222, v227, v241
    v_mul_u32_u24 v223, v227, v242
    v_mfma_f32_4x4x4_16b_bf16 v[140:143], v[216:217], v[68:69], v[4:7]
    v_add_u32 v238, 128, v238
    ds_read_b128 v[164:167], v239 offset:0
    ds_read_b128 v[168:171], v239 offset:64
    v_mfma_f32_4x4x4_16b_bf16 v[144:147], v[218:219], v[70:71], v[8:11]
    ds_read_b128 v[172:175], v239 offset:128
    ds_read_b128 v[176:179], v239 offset:192
    ds_read_u16 v224, v238 offset:0
    ds_read_u16 v225, v238 offset:8
    ds_read_u16 v226, v238 offset:64
    ds_read_u16 v227, v238 offset:72
    v_mfma_f32_4x4x4_16b_bf16 v[246:249], v[220:221], v[72:73], v[12:15]
    v_cvt_pk_bf16_f32 v100, v140, v141
    v_cvt_pk_bf16_f32 v101, v142, v143
    v_mfma_f32_4x4x4_16b_bf16 v[250:253], v[222:223], v[74:75], v[16:19]
    v_cvt_pk_bf16_f32 v102, v144, v145
    v_cvt_pk_bf16_f32 v103, v146, v147
    v_mfma_f32_4x4x4_16b_bf16 v[140:143], v[216:217], v[76:77], v[20:23]
    v_cvt_pk_bf16_f32 v104, v246, v247
    v_cvt_pk_bf16_f32 v105, v248, v249
    v_mfma_f32_4x4x4_16b_bf16 v[144:147], v[218:219], v[78:79], v[24:27]
    v_cvt_pk_bf16_f32 v106, v250, v251
    v_cvt_pk_bf16_f32 v107, v252, v253
    v_mfma_f32_4x4x4_16b_bf16 v[246:249], v[220:221], v[80:81], v[28:31]
    v_cvt_pk_bf16_f32 v108, v140, v141
    v_cvt_pk_bf16_f32 v109, v142, v143
    v_mfma_f32_4x4x4_16b_bf16 v[250:253], v[222:223], v[82:83], v[32:35]
    v_cvt_pk_bf16_f32 v110, v144, v145
    v_cvt_pk_bf16_f32 v111, v146, v147
    v_mfma_f32_4x4x4_16b_bf16 v[140:143], v[216:217], v[84:85], v[36:39]
    v_cvt_pk_bf16_f32 v112, v246, v247
    v_cvt_pk_bf16_f32 v113, v248, v249
    v_mfma_f32_4x4x4_16b_bf16 v[144:147], v[218:219], v[86:87], v[40:43]
    v_cvt_pk_bf16_f32 v114, v250, v251
    v_cvt_pk_bf16_f32 v115, v252, v253
    v_mfma_f32_4x4x4_16b_bf16 v[246:249], v[220:221], v[88:89], v[44:47]
    v_cvt_pk_bf16_f32 v116, v140, v141
    v_cvt_pk_bf16_f32 v117, v142, v143
    v_mfma_f32_4x4x4_16b_bf16 v[250:253], v[222:223], v[90:91], v[48:51]
    v_cvt_pk_bf16_f32 v118, v144, v145
    v_cvt_pk_bf16_f32 v119, v146, v147
    v_mfma_f32_4x4x4_16b_bf16 v[140:143], v[216:217], v[92:93], v[52:55]
    v_cvt_pk_bf16_f32 v120, v246, v247
    v_cvt_pk_bf16_f32 v121, v248, v249
    v_mfma_f32_4x4x4_16b_bf16 v[144:147], v[218:219], v[94:95], v[56:59]
    v_cvt_pk_bf16_f32 v122, v250, v251
    v_cvt_pk_bf16_f32 v123, v252, v253
    v_mfma_f32_4x4x4_16b_bf16 v[246:249], v[220:221], v[96:97], v[60:63]
    v_cvt_pk_bf16_f32 v124, v140, v141
    v_cvt_pk_bf16_f32 v125, v142, v143
    v_mfma_f32_4x4x4_16b_bf16 v[250:253], v[222:223], v[98:99], v[64:67]
    v_cvt_pk_bf16_f32 v126, v144, v145
    v_cvt_pk_bf16_f32 v127, v146, v147
    v_cvt_pk_bf16_f32 v128, v246, v247
    v_cvt_pk_bf16_f32 v129, v248, v249
    v_add_u32 v239, 272, v239
    v_cvt_pk_bf16_f32 v130, v250, v251
    v_cvt_pk_bf16_f32 v131, v252, v253
    s_waitcnt lgkmcnt(0)
    s_branch Lf_evd2
Lf_fl3:
    v_cvt_pk_bf16_f32 v246, v212, v212
    v_mov_b32 v212, 0
    ds_write_b16 v240, v246
    v_add_u32 v240, 128, v240
    s_bitcmp0_b32 s37, 3
    s_cbranch_scc1 Lf_evd3
    s_branch Lf_ev23
Lf_ev3:
    s_bitcmp1_b64 s[56:57], 3
    s_cbranch_scc1 Lf_fl3
Lf_ev23:
    s_bitcmp1_b64 s[56:57], 5
    s_cbranch_scc1 Lf_w3
    s_sub_u32 s60, s60, 1
    s_cbranch_scc0 Lf_nsa3
    s_mov_b32 s49, 7
    s_call_b64 s[62:63], L_swap
Lf_nsa3:
    s_add_u32 s35, s35, s31
    s_min_u32 s35, s35, 419404800
    s_xor_b32 s31, s31, 0x63ff800
    s_branch Lf_evd3
Lf_w3:
    s_bitcmp0_b64 s[56:57], 7
    s_cbranch_scc1 Lf_e13
    s_sub_u32 s60, s60, 1
    s_cbranch_scc0 Lf_nsb3
    s_mov_b32 s49, 7
    s_call_b64 s[62:63], L_swap
    s_waitcnt lgkmcnt(0)
Lf_nsb3:
    s_add_u32 s35, s35, s31
    s_min_u32 s35, s35, 419404800
    s_xor_b32 s31, s31, 0x63ff800
Lf_e13:
    s_sub_u32 s61, s61, 1
    s_cbranch_scc1 Lf_last3
    s_bitcmp0_b32 s33, s61
    s_cbranch_scc1 Lf_nw3
    s_cmp_eq_u32 s61, 3
    s_cselect_b32 s66, s80, s81
    v_add_u32 v238, s66, v238
    v_add_u32 v239, s66, v239
    ds_read_u16 v224, v238 offset:0
    ds_read_u16 v225, v238 offset:8
    ds_read_u16 v226, v238 offset:64
    ds_read_u16 v227, v238 offset:72
    s_waitcnt lgkmcnt(0)
Lf_nw3:
    v_mul_u32_u24 v216, v224, v241
    v_mul_u32_u24 v217, v224, v242
    v_mul_u32_u24 v218, v225, v241
    v_mul_u32_u24 v219, v225, v242
    v_mul_u32_u24 v220, v226, v241
    v_mul_u32_u24 v221, v226, v242
    v_mul_u32_u24 v222, v227, v241
    v_mul_u32_u24 v223, v227, v242
    v_mfma_f32_4x4x4_16b_bf16 v[140:143], v[216:217], v[68:69], v[4:7]
    v_add_u32 v238, 128, v238
    ds_read_b128 v[164:167], v239 offset:0
    ds_read_b128 v[168:171], v239 offset:64
    v_mfma_f32_4x4x4_16b_bf16 v[144:147], v[218:219], v[70:71], v[8:11]
    ds_read_b128 v[172:175], v239 offset:128
    ds_read_b128 v[176:179], v239 offset:192
    ds_read_u16 v224, v238 offset:0
    ds_read_u16 v225, v238 offset:8
    ds_read_u16 v226, v238 offset:64
    ds_read_u16 v227, v238 offset:72
    v_mfma_f32_4x4x4_16b_bf16 v[246:249], v[220:221], v[72:73], v[12:15]
    v_cvt_pk_bf16_f32 v100, v140, v141
    v_cvt_pk_bf16_f32 v101, v142, v143
    v_mfma_f32_4x4x4_16b_bf16 v[250:253], v[222:223], v[74:75], v[16:19]
    v_cvt_pk_bf16_f32 v102, v144, v145
    v_cvt_pk_bf16_f32 v103, v146, v147
    v_mfma_f32_4x4x4_16b_bf16 v[140:143], v[216:217], v[76:77], v[20:23]
    v_cvt_pk_bf16_f32 v104, v246, v247
    v_cvt_pk_bf16_f32 v105, v248, v249
    v_mfma_f32_4x4x4_16b_bf16 v[144:147], v[218:219], v[78:79], v[24:27]
    v_cvt_pk_bf16_f32 v106, v250, v251
    v_cvt_pk_bf16_f32 v107, v252, v253
    v_mfma_f32_4x4x4_16b_bf16 v[246:249], v[220:221], v[80:81], v[28:31]
    v_cvt_pk_bf16_f32 v108, v140, v141
    v_cvt_pk_bf16_f32 v109, v142, v143
    v_mfma_f32_4x4x4_16b_bf16 v[250:253], v[222:223], v[82:83], v[32:35]
    v_cvt_pk_bf16_f32 v110, v144, v145
    v_cvt_pk_bf16_f32 v111, v146, v147
    v_mfma_f32_4x4x4_16b_bf16 v[140:143], v[216:217], v[84:85], v[36:39]
    v_cvt_pk_bf16_f32 v112, v246, v247
    v_cvt_pk_bf16_f32 v113, v248, v249
    v_mfma_f32_4x4x4_16b_bf16 v[144:147], v[218:219], v[86:87], v[40:43]
    v_cvt_pk_bf16_f32 v114, v250, v251
    v_cvt_pk_bf16_f32 v115, v252, v253
    v_mfma_f32_4x4x4_16b_bf16 v[246:249], v[220:221], v[88:89], v[44:47]
    v_cvt_pk_bf16_f32 v116, v140, v141
    v_cvt_pk_bf16_f32 v117, v142, v143
    v_mfma_f32_4x4x4_16b_bf16 v[250:253], v[222:223], v[90:91], v[48:51]
    v_cvt_pk_bf16_f32 v118, v144, v145
    v_cvt_pk_bf16_f32 v119, v146, v147
    v_mfma_f32_4x4x4_16b_bf16 v[140:143], v[216:217], v[92:93], v[52:55]
    v_cvt_pk_bf16_f32 v120, v246, v247
    v_cvt_pk_bf16_f32 v121, v248, v249
    v_mfma_f32_4x4x4_16b_bf16 v[144:147], v[218:219], v[94:95], v[56:59]
    v_cvt_pk_bf16_f32 v122, v250, v251
    v_cvt_pk_bf16_f32 v123, v252, v253
    v_mfma_f32_4x4x4_16b_bf16 v[246:249], v[220:221], v[96:97], v[60:63]
    v_cvt_pk_bf16_f32 v124, v140, v141
    v_cvt_pk_bf16_f32 v125, v142, v143
    v_mfma_f32_4x4x4_16b_bf16 v[250:253], v[222:223], v[98:99], v[64:67]
    v_cvt_pk_bf16_f32 v126, v144, v145
    v_cvt_pk_bf16_f32 v127, v146, v147
    v_cvt_pk_bf16_f32 v128, v246, v247
    v_cvt_pk_bf16_f32 v129, v248, v249
    v_add_u32 v239, 272, v239
    v_cvt_pk_bf16_f32 v130, v250, v251
    v_cvt_pk_bf16_f32 v131, v252, v253
    s_waitcnt lgkmcnt(0)
    s_branch Lf_evd3
Lf_last0:
    s_branch Lf_tail
Lf_last1:
    v_add_u32 v236, 2080, v236
    s_lshr_b64 s[56:57], s[56:57], 1
    s_branch Lf_tail
Lf_last2:
    v_add_u32 v236, 4160, v236
    s_lshr_b64 s[56:57], s[56:57], 2
    s_branch Lf_tail
Lf_last3:
    v_add_u32 v236, 6240, v236
    s_lshr_b64 s[56:57], s[56:57], 3
Lf_tail:
    v_mfma_f32_16x16x32_bf16 v[208:211], v[136:139], v[200:203], v[208:211]
    v_exp_f32 v132, v148
    v_exp_f32 v133, v149
    v_exp_f32 v134, v150
    v_exp_f32 v135, v151
    v_exp_f32 v136, v152
    v_exp_f32 v137, v153
    v_mfma_f32_4x4x4_16b_bf16 v[132:135], v[228:229], v[228:229], v[132:135]
    v_exp_f32 v138, v154
    v_exp_f32 v139, v155
    v_cvt_pk_bf16_f32 v208, v208, v209
    v_cvt_pk_bf16_f32 v209, v210, v211
    v_exp_f32 v140, v156
    v_exp_f32 v141, v157
    v_mfma_f32_4x4x4_16b_bf16 v[212:215], v[208:209], v[188:189], v[212:215] cbsz:4 abid:0
    v_mfma_f32_4x4x4_16b_bf16 v[136:139], v[228:229], v[228:229], v[136:139]
    v_exp_f32 v142, v158
    v_mfma_f32_4x4x4_16b_bf16 v[212:215], v[208:209], v[190:191], v[212:215] cbsz:4 abid:4
    v_exp_f32 v143, v159
    v_exp_f32 v144, v160
    v_mfma_f32_4x4x4_16b_bf16 v[212:215], v[208:209], v[192:193], v[212:215] cbsz:4 abid:8
    v_exp_f32 v145, v161
    v_mfma_f32_4x4x4_16b_bf16 v[140:143], v[228:229], v[228:229], v[140:143]
    v_mfma_f32_4x4x4_16b_bf16 v[212:215], v[208:209], v[194:195], v[212:215] cbsz:4 abid:12
    ds_read_b64_tr_b16 v[188:189], v236 offset:0
    ds_read_b64_tr_b16 v[190:191], v236 offset:512
    ds_read_b64_tr_b16 v[192:193], v236 offset:1056
    ds_read_b64_tr_b16 v[194:195], v236 offset:1568
    v_exp_f32 v146, v162
    v_exp_f32 v147, v163
    v_rcp_f32 v132, v132
    v_rcp_f32 v133, v133
    v_mfma_f32_4x4x4_16b_bf16 v[144:147], v[228:229], v[228:229], v[144:147]
    v_rcp_f32 v134, v134
    s_bitcmp0_b64 s[56:57], 1
    s_cbranch_scc1 Lf_tnf
    v_cvt_pk_bf16_f32 v246, v212, v212
    v_mov_b32 v212, 0
    ds_write_b16 v240, v246
    v_add_u32 v240, 128, v240
Lf_tnf:
    v_cvt_pk_bf16_f32 v132, v132, v133
    s_waitcnt lgkmcnt(0)
    v_rcp_f32 v135, v135
    v_rcp_f32 v136, v136
    v_cvt_pk_bf16_f32 v133, v134, v135
    v_rcp_f32 v137, v137
    v_rcp_f32 v138, v138
    v_cvt_pk_bf16_f32 v134, v136, v137
    v_rcp_f32 v139, v139
    v_rcp_f32 v140, v140
    v_cvt_pk_bf16_f32 v135, v138, v139
    v_rcp_f32 v141, v141
    v_rcp_f32 v142, v142
    v_cvt_pk_bf16_f32 v136, v140, v141
    v_mfma_f32_16x16x32_bf16 v[208:211], v[132:135], v[196:199], v[204:207]
    v_rcp_f32 v143, v143
    v_rcp_f32 v144, v144
    v_cvt_pk_bf16_f32 v137, v142, v143
    v_rcp_f32 v145, v145
    v_rcp_f32 v146, v146
    v_rcp_f32 v147, v147
    v_cvt_pk_bf16_f32 v138, v144, v145
    v_cvt_pk_bf16_f32 v139, v146, v147
    s_nop 1
    v_mfma_f32_16x16x32_bf16 v[208:211], v[136:139], v[200:203], v[208:211]
    s_nop 7
    v_cvt_pk_bf16_f32 v208, v208, v209
    v_cvt_pk_bf16_f32 v209, v210, v211
    s_nop 1
    v_mfma_f32_4x4x4_16b_bf16 v[212:215], v[208:209], v[188:189], v[212:215] cbsz:4 abid:0
    s_nop 1
    v_mfma_f32_4x4x4_16b_bf16 v[212:215], v[208:209], v[190:191], v[212:215] cbsz:4 abid:4
    s_nop 1
    v_mfma_f32_4x4x4_16b_bf16 v[212:215], v[208:209], v[192:193], v[212:215] cbsz:4 abid:8
    s_nop 1
    v_mfma_f32_4x4x4_16b_bf16 v[212:215], v[208:209], v[194:195], v[212:215] cbsz:4 abid:12
    s_nop 4
    v_cvt_pk_bf16_f32 v246, v212, v212
    ds_write_b16 v240, v246
L_store:
    s_add_u32 s66, s52, 14912
    v_lshl_add_u32 v247, v0, 4, s66
    s_lshl_b32 s66, s82, 5
    s_bfm_b64 exec, 16, 32
    v_add_u32 v243, s66, v243
    s_lshl_b32 s66, s83, 5
    s_bfm_b64 exec, 16, 48
    v_add_u32 v243, s66, v243
    s_mov_b64 exec, -1
    ds_read_b128 v[148:151], v247
    s_waitcnt lgkmcnt(0)
    global_store_dwordx4 v243, v[148:151], s[18:19] sc0 sc1
L_end:
    s_endpgm
L_general:
    s_waitcnt vmcnt(0)
    ds_read_b128 v[44:47], v246 offset:20480
    ds_read_b128 v[48:51], v246 offset:21504
    ds_read_b128 v[88:91], v246 offset:22528
    ds_read_b128 v[52:55], v246 offset:40960
    ds_read_b128 v[56:59], v246 offset:41984
    ds_read_b128 v[92:95], v246 offset:43008
    ds_read_b128 v[60:63], v246 offset:61440
    ds_read_b128 v[64:67], v246 offset:62464
    ds_read_b128 v[96:99], v246 offset:63488
    ds_read_u16 v224, v238 offset:0
    ds_read_u16 v225, v238 offset:8
    ds_read_u16 v226, v238 offset:64
    ds_read_u16 v227, v238 offset:72
    s_mul_i32 s35, s53, 51200
    s_movk_i32 s31, 25600
    s_mov_b32 s60, 3
    s_mov_b64 s[56:57], 0
    v_mov_b32 v148, -1
    v_mov_b32 v149, -1
    v_mov_b32 v150, -1
    v_mov_b32 v151, -1
    s_add_u32 s66, s52, 18432
    v_add_u32 v152, s66, v2
    ds_write_b128 v152, v[148:151]
    ds_write_b128 v152, v[148:151] offset:1024
    s_add_u32 s64, s52, 18448
    s_bfm_b64 s[28:29], 50, 0
    s_mul_i32 s66, s53, 800
    v_add_u32 v247, s66, v2
    s_mov_b64 exec, s[28:29]
    global_load_dwordx4 v[100:103], v247, s[8:9]
    v_add_u32 v247, 1638400, v247
    global_load_dwordx4 v[104:107], v247, s[8:9]
    v_add_u32 v247, 1638400, v247
    global_load_dwordx4 v[108:111], v247, s[8:9]
    v_add_u32 v247, 1638400, v247
    global_load_dwordx4 v[112:115], v247, s[8:9]
    v_add_u32 v247, 1638400, v247
    s_mov_b64 exec, -1
    v_cmp_lt_u32 vcc, 24, v0
    s_nop 1
    v_cndmask_b32 v145, 0, 1, vcc
    v_mul_u32_u24 v142, 25, v145
    v_sub_u32 v142, v0, v142
    v_mul_u32_u24 v142, 0x80008, v142
    v_add_u32 v141, 0x10000, v142
    v_add_u32 v143, 0x50004, v142
    v_add_u32 v144, 0x70006, v142
    v_add_u32 v142, 0x30002, v142
    s_waitcnt vmcnt(0)
    s_mov_b64 exec, s[28:29]
    v_cmp_neq_f16_sdwa s[68:69], v100, 0 src0_sel:WORD_0 src1_sel:WORD_0
    v_cmp_neq_f16_sdwa s[70:71], v100, 0 src0_sel:WORD_1 src1_sel:WORD_0
    v_cmp_neq_f16_sdwa s[72:73], v101, 0 src0_sel:WORD_0 src1_sel:WORD_0
    v_cmp_neq_f16_sdwa s[74:75], v101, 0 src0_sel:WORD_1 src1_sel:WORD_0
    v_cmp_neq_f16_sdwa s[76:77], v102, 0 src0_sel:WORD_0 src1_sel:WORD_0
    v_cmp_neq_f16_sdwa s[78:79], v102, 0 src0_sel:WORD_1 src1_sel:WORD_0
    v_cmp_neq_f16_sdwa s[80:81], v103, 0 src0_sel:WORD_0 src1_sel:WORD_0
    v_cmp_neq_f16_sdwa s[82:83], v103, 0 src0_sel:WORD_1 src1_sel:WORD_0
    s_mov_b64 exec, -1
    v_mov_b32 v132, s64
    v_mbcnt_lo_u32_b32 v132, s68, v132
    v_mbcnt_hi_u32_b32 v132, s69, v132
    v_mbcnt_lo_u32_b32 v132, s70, v132
    v_mbcnt_hi_u32_b32 v132, s71, v132
    v_mbcnt_lo_u32_b32 v132, s72, v132
    v_mbcnt_hi_u32_b32 v132, s73, v132
    v_mbcnt_lo_u32_b32 v132, s74, v132
    v_mbcnt_hi_u32_b32 v132, s75, v132
    v_mbcnt_lo_u32_b32 v132, s76, v132
    v_mbcnt_hi_u32_b32 v132, s77, v132
    v_mbcnt_lo_u32_b32 v132, s78, v132
    v_mbcnt_hi_u32_b32 v132, s79, v132
    v_mbcnt_lo_u32_b32 v132, s80, v132
    v_mbcnt_hi_u32_b32 v132, s81, v132
    v_mbcnt_lo_u32_b32 v132, s82, v132
    v_mbcnt_hi_u32_b32 v132, s83, v132
    s_add_u32 s55, s64, 16
    v_readlane_b32 s66, v132, 25
    v_readlane_b32 s67, v132, 63
    s_add_u32 s64, s66, 15
    s_and_b32 s64, s64, -16
    s_max_u32 s64, s64, s55
    s_sub_u32 s66, s64, s66
    v_mad_u32_u24 v132, v145, s66, v132
    s_mov_b32 s55, s64
    v_addc_co_u32 v133, vcc, 0, v132, s[68:69]
    v_addc_co_u32 v134, vcc, 0, v133, s[70:71]
    v_addc_co_u32 v135, vcc, 0, v134, s[72:73]
    v_addc_co_u32 v136, vcc, 0, v135, s[74:75]
    v_addc_co_u32 v137, vcc, 0, v136, s[76:77]
    v_addc_co_u32 v138, vcc, 0, v137, s[78:79]
    v_addc_co_u32 v139, vcc, 0, v138, s[80:81]
    s_add_u32 s67, s67, s66
    s_add_u32 s67, s67, 15
    s_and_b32 s67, s67, -16
    s_add_u32 s64, s64, 16
    s_max_u32 s64, s64, s67
    s_mov_b64 exec, s[68:69]
    ds_write_b8 v132, v141
    s_mov_b64 exec, s[70:71]
    ds_write_b8_d16_hi v133, v141
    s_mov_b64 exec, s[72:73]
    ds_write_b8 v134, v142
    s_mov_b64 exec, s[74:75]
    ds_write_b8_d16_hi v135, v142
    s_mov_b64 exec, s[76:77]
    ds_write_b8 v136, v143
    s_mov_b64 exec, s[78:79]
    ds_write_b8_d16_hi v137, v143
    s_mov_b64 exec, s[80:81]
    ds_write_b8 v138, v144
    s_mov_b64 exec, s[82:83]
    ds_write_b8_d16_hi v139, v144
    s_mov_b64 exec, -1
    s_lshr_b32 s95, s55, 4
    s_bitset1_b64 s[56:57], s95
    s_lshr_b32 s95, s64, 4
    s_bitset1_b64 s[56:57], s95
    s_mov_b64 exec, s[28:29]
    v_cmp_neq_f16_sdwa s[68:69], v104, 0 src0_sel:WORD_0 src1_sel:WORD_0
    v_cmp_neq_f16_sdwa s[70:71], v104, 0 src0_sel:WORD_1 src1_sel:WORD_0
    v_cmp_neq_f16_sdwa s[72:73], v105, 0 src0_sel:WORD_0 src1_sel:WORD_0
    v_cmp_neq_f16_sdwa s[74:75], v105, 0 src0_sel:WORD_1 src1_sel:WORD_0
    v_cmp_neq_f16_sdwa s[76:77], v106, 0 src0_sel:WORD_0 src1_sel:WORD_0
    v_cmp_neq_f16_sdwa s[78:79], v106, 0 src0_sel:WORD_1 src1_sel:WORD_0
    v_cmp_neq_f16_sdwa s[80:81], v107, 0 src0_sel:WORD_0 src1_sel:WORD_0
    v_cmp_neq_f16_sdwa s[82:83], v107, 0 src0_sel:WORD_1 src1_sel:WORD_0
    s_mov_b64 exec, -1
    v_mov_b32 v132, s64
    v_mbcnt_lo_u32_b32 v132, s68, v132
    v_mbcnt_hi_u32_b32 v132, s69, v132
    v_mbcnt_lo_u32_b32 v132, s70, v132
    v_mbcnt_hi_u32_b32 v132, s71, v132
    v_mbcnt_lo_u32_b32 v132, s72, v132
    v_mbcnt_hi_u32_b32 v132, s73, v132
    v_mbcnt_lo_u32_b32 v132, s74, v132
    v_mbcnt_hi_u32_b32 v132, s75, v132
    v_mbcnt_lo_u32_b32 v132, s76, v132
    v_mbcnt_hi_u32_b32 v132, s77, v132
    v_mbcnt_lo_u32_b32 v132, s78, v132
    v_mbcnt_hi_u32_b32 v132, s79, v132
    v_mbcnt_lo_u32_b32 v132, s80, v132
    v_mbcnt_hi_u32_b32 v132, s81, v132
    v_mbcnt_lo_u32_b32 v132, s82, v132
    v_mbcnt_hi_u32_b32 v132, s83, v132
    s_add_u32 s55, s64, 16
    v_readlane_b32 s66, v132, 25
    v_readlane_b32 s67, v132, 63
    s_add_u32 s64, s66, 15
    s_and_b32 s64, s64, -16
    s_max_u32 s64, s64, s55
    s_sub_u32 s66, s64, s66
    v_mad_u32_u24 v132, v145, s66, v132
    s_mov_b32 s55, s64
    v_addc_co_u32 v133, vcc, 0, v132, s[68:69]
    v_addc_co_u32 v134, vcc, 0, v133, s[70:71]
    v_addc_co_u32 v135, vcc, 0, v134, s[72:73]
    v_addc_co_u32 v136, vcc, 0, v135, s[74:75]
    v_addc_co_u32 v137, vcc, 0, v136, s[76:77]
    v_addc_co_u32 v138, vcc, 0, v137, s[78:79]
    v_addc_co_u32 v139, vcc, 0, v138, s[80:81]
    s_add_u32 s67, s67, s66
    s_add_u32 s67, s67, 15
    s_and_b32 s67, s67, -16
    s_add_u32 s64, s64, 16
    s_max_u32 s64, s64, s67
    s_mov_b64 exec, s[68:69]
    ds_write_b8 v132, v141
    s_mov_b64 exec, s[70:71]
    ds_write_b8_d16_hi v133, v141
    s_mov_b64 exec, s[72:73]
    ds_write_b8 v134, v142
    s_mov_b64 exec, s[74:75]
    ds_write_b8_d16_hi v135, v142
    s_mov_b64 exec, s[76:77]
    ds_write_b8 v136, v143
    s_mov_b64 exec, s[78:79]
    ds_write_b8_d16_hi v137, v143
    s_mov_b64 exec, s[80:81]
    ds_write_b8 v138, v144
    s_mov_b64 exec, s[82:83]
    ds_write_b8_d16_hi v139, v144
    s_mov_b64 exec, -1
    s_lshr_b32 s95, s55, 4
    s_bitset1_b64 s[56:57], s95
    s_lshr_b32 s95, s64, 4
    s_bitset1_b64 s[56:57], s95
    s_mov_b32 s44, s64
    s_mov_b64 exec, s[28:29]
    v_cmp_neq_f16_sdwa s[68:69], v108, 0 src0_sel:WORD_0 src1_sel:WORD_0
    v_cmp_neq_f16_sdwa s[70:71], v108, 0 src0_sel:WORD_1 src1_sel:WORD_0
    v_cmp_neq_f16_sdwa s[72:73], v109, 0 src0_sel:WORD_0 src1_sel:WORD_0
    v_cmp_neq_f16_sdwa s[74:75], v109, 0 src0_sel:WORD_1 src1_sel:WORD_0
    v_cmp_neq_f16_sdwa s[76:77], v110, 0 src0_sel:WORD_0 src1_sel:WORD_0
    v_cmp_neq_f16_sdwa s[78:79], v110, 0 src0_sel:WORD_1 src1_sel:WORD_0
    v_cmp_neq_f16_sdwa s[80:81], v111, 0 src0_sel:WORD_0 src1_sel:WORD_0
    v_cmp_neq_f16_sdwa s[82:83], v111, 0 src0_sel:WORD_1 src1_sel:WORD_0
    s_mov_b64 exec, -1
    v_mov_b32 v132, s64
    v_mbcnt_lo_u32_b32 v132, s68, v132
    v_mbcnt_hi_u32_b32 v132, s69, v132
    v_mbcnt_lo_u32_b32 v132, s70, v132
    v_mbcnt_hi_u32_b32 v132, s71, v132
    v_mbcnt_lo_u32_b32 v132, s72, v132
    v_mbcnt_hi_u32_b32 v132, s73, v132
    v_mbcnt_lo_u32_b32 v132, s74, v132
    v_mbcnt_hi_u32_b32 v132, s75, v132
    v_mbcnt_lo_u32_b32 v132, s76, v132
    v_mbcnt_hi_u32_b32 v132, s77, v132
    v_mbcnt_lo_u32_b32 v132, s78, v132
    v_mbcnt_hi_u32_b32 v132, s79, v132
    v_mbcnt_lo_u32_b32 v132, s80, v132
    v_mbcnt_hi_u32_b32 v132, s81, v132
    v_mbcnt_lo_u32_b32 v132, s82, v132
    v_mbcnt_hi_u32_b32 v132, s83, v132
    s_add_u32 s55, s64, 16
    v_readlane_b32 s66, v132, 25
    v_readlane_b32 s67, v132, 63
    s_add_u32 s64, s66, 15
    s_and_b32 s64, s64, -16
    s_max_u32 s64, s64, s55
    s_sub_u32 s66, s64, s66
    v_mad_u32_u24 v132, v145, s66, v132
    s_mov_b32 s55, s64
    v_addc_co_u32 v133, vcc, 0, v132, s[68:69]
    v_addc_co_u32 v134, vcc, 0, v133, s[70:71]
    v_addc_co_u32 v135, vcc, 0, v134, s[72:73]
    v_addc_co_u32 v136, vcc, 0, v135, s[74:75]
    v_addc_co_u32 v137, vcc, 0, v136, s[76:77]
    v_addc_co_u32 v138, vcc, 0, v137, s[78:79]
    v_addc_co_u32 v139, vcc, 0, v138, s[80:81]
    s_add_u32 s67, s67, s66
    s_add_u32 s67, s67, 15
    s_and_b32 s67, s67, -16
    s_add_u32 s64, s64, 16
    s_max_u32 s64, s64, s67
    s_mov_b64 exec, s[68:69]
    ds_write_b8 v132, v141
    s_mov_b64 exec, s[70:71]
    ds_write_b8_d16_hi v133, v141
    s_mov_b64 exec, s[72:73]
    ds_write_b8 v134, v142
    s_mov_b64 exec, s[74:75]
    ds_write_b8_d16_hi v135, v142
    s_mov_b64 exec, s[76:77]
    ds_write_b8 v136, v143
    s_mov_b64 exec, s[78:79]
    ds_write_b8_d16_hi v137, v143
    s_mov_b64 exec, s[80:81]
    ds_write_b8 v138, v144
    s_mov_b64 exec, s[82:83]
    ds_write_b8_d16_hi v139, v144
    s_mov_b64 exec, -1
    s_mov_b32 s45, s55
    s_mov_b32 s46, s64
    s_mov_b64 exec, s[28:29]
    v_cmp_neq_f16_sdwa s[68:69], v112, 0 src0_sel:WORD_0 src1_sel:WORD_0
    v_cmp_neq_f16_sdwa s[70:71], v112, 0 src0_sel:WORD_1 src1_sel:WORD_0
    v_cmp_neq_f16_sdwa s[72:73], v113, 0 src0_sel:WORD_0 src1_sel:WORD_0
    v_cmp_neq_f16_sdwa s[74:75], v113, 0 src0_sel:WORD_1 src1_sel:WORD_0
    v_cmp_neq_f16_sdwa s[76:77], v114, 0 src0_sel:WORD_0 src1_sel:WORD_0
    v_cmp_neq_f16_sdwa s[78:79], v114, 0 src0_sel:WORD_1 src1_sel:WORD_0
    v_cmp_neq_f16_sdwa s[80:81], v115, 0 src0_sel:WORD_0 src1_sel:WORD_0
    v_cmp_neq_f16_sdwa s[82:83], v115, 0 src0_sel:WORD_1 src1_sel:WORD_0
    s_mov_b64 exec, -1
    v_mov_b32 v132, s64
    v_mbcnt_lo_u32_b32 v132, s68, v132
    v_mbcnt_hi_u32_b32 v132, s69, v132
    v_mbcnt_lo_u32_b32 v132, s70, v132
    v_mbcnt_hi_u32_b32 v132, s71, v132
    v_mbcnt_lo_u32_b32 v132, s72, v132
    v_mbcnt_hi_u32_b32 v132, s73, v132
    v_mbcnt_lo_u32_b32 v132, s74, v132
    v_mbcnt_hi_u32_b32 v132, s75, v132
    v_mbcnt_lo_u32_b32 v132, s76, v132
    v_mbcnt_hi_u32_b32 v132, s77, v132
    v_mbcnt_lo_u32_b32 v132, s78, v132
    v_mbcnt_hi_u32_b32 v132, s79, v132
    v_mbcnt_lo_u32_b32 v132, s80, v132
    v_mbcnt_hi_u32_b32 v132, s81, v132
    v_mbcnt_lo_u32_b32 v132, s82, v132
    v_mbcnt_hi_u32_b32 v132, s83, v132
    s_add_u32 s55, s64, 16
    v_readlane_b32 s66, v132, 25
    v_readlane_b32 s67, v132, 63
    s_add_u32 s64, s66, 15
    s_and_b32 s64, s64, -16
    s_max_u32 s64, s64, s55
    s_sub_u32 s66, s64, s66
    v_mad_u32_u24 v132, v145, s66, v132
    s_mov_b32 s55, s64
    v_addc_co_u32 v133, vcc, 0, v132, s[68:69]
    v_addc_co_u32 v134, vcc, 0, v133, s[70:71]
    v_addc_co_u32 v135, vcc, 0, v134, s[72:73]
    v_addc_co_u32 v136, vcc, 0, v135, s[74:75]
    v_addc_co_u32 v137, vcc, 0, v136, s[76:77]
    v_addc_co_u32 v138, vcc, 0, v137, s[78:79]
    v_addc_co_u32 v139, vcc, 0, v138, s[80:81]
    s_add_u32 s67, s67, s66
    s_add_u32 s67, s67, 15
    s_and_b32 s67, s67, -16
    s_add_u32 s64, s64, 16
    s_max_u32 s64, s64, s67
    s_mov_b64 exec, s[68:69]
    ds_write_b8 v132, v141
    s_mov_b64 exec, s[70:71]
    ds_write_b8_d16_hi v133, v141
    s_mov_b64 exec, s[72:73]
    ds_write_b8 v134, v142
    s_mov_b64 exec, s[74:75]
    ds_write_b8_d16_hi v135, v142
    s_mov_b64 exec, s[76:77]
    ds_write_b8 v136, v143
    s_mov_b64 exec, s[78:79]
    ds_write_b8_d16_hi v137, v143
    s_mov_b64 exec, s[80:81]
    ds_write_b8 v138, v144
    s_mov_b64 exec, s[82:83]
    ds_write_b8_d16_hi v139, v144
    s_mov_b64 exec, -1
    s_mov_b32 s47, s55
    s_mov_b32 s48, s64
    s_mov_b32 s94, 0
    s_mov_b64 s[84:85], -1
    s_branch L_listed
Ls_loop:
Ls_mid:
    s_bitcmp1_b32 s36, 0
    s_cbranch_scc1 Ls_ev0
Ls_evd0:
    v_mfma_f32_16x16x32_bf16 v[208:211], v[136:139], v[200:203], v[208:211]
    ds_read_b32 v246, v244 offset:0
    s_waitcnt lgkmcnt(0)
    v_bfe_u32 v247, v246, 0, 8
    v_lshlrev_b32 v247, 1, v247
    v_bfe_u32 v248, v246, 8, 8
    v_lshlrev_b32 v248, 1, v248
    v_bfe_u32 v249, v246, 16, 8
    v_lshlrev_b32 v249, 1, v249
    v_bfe_u32 v250, v246, 24, 8
    v_lshlrev_b32 v250, 1, v250
    buffer_load_ushort v247, v247, s[24:27], 0 offen
    buffer_load_ushort v248, v248, s[24:27], 0 offen
    buffer_load_ushort v249, v249, s[24:27], 0 offen
    buffer_load_ushort v250, v250, s[24:27], 0 offen
    s_waitcnt vmcnt(0)
    v_lshlrev_b32 v247, 16, v247
    v_mul_f32 v208, v208, v247
    v_lshlrev_b32 v248, 16, v248
    v_mul_f32 v209, v209, v248
    v_lshlrev_b32 v249, 16, v249
    v_mul_f32 v210, v210, v249
    v_lshlrev_b32 v250, 16, v250
    v_mul_f32 v211, v211, v250
    v_exp_f32 v132, v148
    v_exp_f32 v133, v149
    v_exp_f32 v134, v150
    v_exp_f32 v135, v151
    v_exp_f32 v136, v152
    v_exp_f32 v137, v153
    v_mfma_f32_4x4x4_16b_bf16 v[132:135], v[228:229], v[228:229], v[132:135]
    v_exp_f32 v138, v154
    v_exp_f32 v139, v155
    v_cvt_pk_bf16_f32 v208, v208, v209
    v_cvt_pk_bf16_f32 v209, v210, v211
    v_exp_f32 v140, v156
    v_exp_f32 v141, v157
    v_mfma_f32_4x4x4_16b_bf16 v[212:215], v[208:209], v[188:189], v[212:215] cbsz:4 abid:0
    v_mfma_f32_4x4x4_16b_bf16 v[136:139], v[228:229], v[228:229], v[136:139]
    v_exp_f32 v142, v158
    v_mfma_f32_4x4x4_16b_bf16 v[212:215], v[208:209], v[190:191], v[212:215] cbsz:4 abid:4
    v_exp_f32 v143, v159
    v_exp_f32 v144, v160
    v_mfma_f32_4x4x4_16b_bf16 v[212:215], v[208:209], v[192:193], v[212:215] cbsz:4 abid:8
    v_exp_f32 v145, v161
    v_mfma_f32_4x4x4_16b_bf16 v[140:143], v[228:229], v[228:229], v[140:143]
    v_mfma_f32_4x4x4_16b_bf16 v[212:215], v[208:209], v[194:195], v[212:215] cbsz:4 abid:12
    ds_add_rtn_u32 v1, v2, v3
    ds_read_u8 v230, v237 offset:48
    ds_read_u8 v232, v237 offset:56
    ds_read_b64_tr_b16 v[188:189], v236 offset:0
    ds_read_b64_tr_b16 v[190:191], v236 offset:512
    ds_read_b64_tr_b16 v[192:193], v236 offset:1056
    ds_read_b64_tr_b16 v[194:195], v236 offset:1568
    s_waitcnt vmcnt(2)
    ds_read_b128 v[180:183], v234 offset:2080
    ds_read_b128 v[184:187], v235 offset:2080
    s_add_u32 m0, s52, 6240
    v_exp_f32 v146, v162
    v_exp_f32 v147, v163
    v_rcp_f32 v132, v132
    v_rcp_f32 v133, v133
    v_mfma_f32_4x4x4_16b_bf16 v[144:147], v[228:229], v[228:229], v[144:147]
    v_rcp_f32 v134, v134
    v_cvt_pk_bf16_f32 v132, v132, v133
    s_waitcnt lgkmcnt(6)
    buffer_load_dwordx4 v[230:231], s[20:23], s35 idxen offen nt lds
    buffer_load_dwordx4 v[232:233], s[40:43], s35 idxen offen offset:1056 nt lds
    s_waitcnt lgkmcnt(0)
    v_mfma_f32_16x16x32_bf16 v[148:151], v[100:103], v[180:183], v[164:167]
    v_rcp_f32 v135, v135
    v_mfma_f32_16x16x32_bf16 v[152:155], v[108:111], v[180:183], v[168:171]
    v_rcp_f32 v136, v136
    v_cvt_pk_bf16_f32 v133, v134, v135
    v_mfma_f32_16x16x32_bf16 v[148:151], v[104:107], v[184:187], v[148:151]
    v_rcp_f32 v137, v137
    v_cmp_gt_i32 vcc, v1, v245
    s_setprio 0
    s_cbranch_vccz Ls_lo0
    s_setprio 1
Ls_lo0:
    v_mfma_f32_16x16x32_bf16 v[152:155], v[112:115], v[184:187], v[152:155]
    v_rcp_f32 v138, v138
    v_cvt_pk_bf16_f32 v134, v136, v137
    v_mfma_f32_16x16x32_bf16 v[156:159], v[116:119], v[180:183], v[172:175]
    v_rcp_f32 v139, v139
    v_mfma_f32_16x16x32_bf16 v[160:163], v[124:127], v[180:183], v[176:179]
    v_rcp_f32 v140, v140
    v_cvt_pk_bf16_f32 v135, v138, v139
    v_mfma_f32_16x16x32_bf16 v[156:159], v[120:123], v[184:187], v[156:159]
    v_rcp_f32 v141, v141
    v_mfma_f32_16x16x32_bf16 v[160:163], v[128:131], v[184:187], v[160:163]
    v_rcp_f32 v142, v142
    v_cvt_pk_bf16_f32 v136, v140, v141
    v_mfma_f32_16x16x32_bf16 v[208:211], v[132:135], v[196:199], v[204:207]
    v_rcp_f32 v143, v143
    v_rcp_f32 v144, v144
    v_cvt_pk_bf16_f32 v137, v142, v143
    v_rcp_f32 v145, v145
    v_rcp_f32 v146, v146
    v_rcp_f32 v147, v147
    v_cvt_pk_bf16_f32 v138, v144, v145
    v_cvt_pk_bf16_f32 v139, v146, v147
    s_bitcmp1_b32 s36, 1
    s_cbranch_scc1 Ls_ev1
Ls_evd1:
    v_mfma_f32_16x16x32_bf16 v[208:211], v[136:139], v[200:203], v[208:211]
    ds_read_b32 v246, v244 offset:16
    s_waitcnt lgkmcnt(0)
    v_bfe_u32 v247, v246, 0, 8
    v_lshlrev_b32 v247, 1, v247
    v_bfe_u32 v248, v246, 8, 8
    v_lshlrev_b32 v248, 1, v248
    v_bfe_u32 v249, v246, 16, 8
    v_lshlrev_b32 v249, 1, v249
    v_bfe_u32 v250, v246, 24, 8
    v_lshlrev_b32 v250, 1, v250
    buffer_load_ushort v247, v247, s[24:27], 0 offen
    buffer_load_ushort v248, v248, s[24:27], 0 offen
    buffer_load_ushort v249, v249, s[24:27], 0 offen
    buffer_load_ushort v250, v250, s[24:27], 0 offen
    s_waitcnt vmcnt(0)
    v_lshlrev_b32 v247, 16, v247
    v_mul_f32 v208, v208, v247
    v_lshlrev_b32 v248, 16, v248
    v_mul_f32 v209, v209, v248
    v_lshlrev_b32 v249, 16, v249
    v_mul_f32 v210, v210, v249
    v_lshlrev_b32 v250, 16, v250
    v_mul_f32 v211, v211, v250
    v_exp_f32 v132, v148
    v_exp_f32 v133, v149
    v_exp_f32 v134, v150
    v_exp_f32 v135, v151
    v_exp_f32 v136, v152
    v_exp_f32 v137, v153
    v_mfma_f32_4x4x4_16b_bf16 v[132:135], v[228:229], v[228:229], v[132:135]
    v_exp_f32 v138, v154
    v_exp_f32 v139, v155
    v_cvt_pk_bf16_f32 v208, v208, v209
    v_cvt_pk_bf16_f32 v209, v210, v211
    v_exp_f32 v140, v156
    v_exp_f32 v141, v157
    v_mfma_f32_4x4x4_16b_bf16 v[212:215], v[208:209], v[188:189], v[212:215] cbsz:4 abid:0
    v_mfma_f32_4x4x4_16b_bf16 v[136:139], v[228:229], v[228:229], v[136:139]
    v_exp_f32 v142, v158
    v_mfma_f32_4x4x4_16b_bf16 v[212:215], v[208:209], v[190:191], v[212:215] cbsz:4 abid:4
    v_exp_f32 v143, v159
    v_exp_f32 v144, v160
    v_mfma_f32_4x4x4_16b_bf16 v[212:215], v[208:209], v[192:193], v[212:215] cbsz:4 abid:8
    v_exp_f32 v145, v161
    v_mfma_f32_4x4x4_16b_bf16 v[140:143], v[228:229], v[228:229], v[140:143]
    v_mfma_f32_4x4x4_16b_bf16 v[212:215], v[208:209], v[194:195], v[212:215] cbsz:4 abid:12
    ds_read_u8 v230, v237 offset:64
    ds_read_u8 v232, v237 offset:72
    ds_read_b64_tr_b16 v[188:189], v236 offset:2080
    ds_read_b64_tr_b16 v[190:191], v236 offset:2592
    ds_read_b64_tr_b16 v[192:193], v236 offset:3136
    ds_read_b64_tr_b16 v[194:195], v236 offset:3648
    s_waitcnt vmcnt(2)
    ds_read_b128 v[180:183], v234 offset:4160
    ds_read_b128 v[184:187], v235 offset:4160
    s_add_u32 m0, s52, 0
    v_exp_f32 v146, v162
    v_exp_f32 v147, v163
    v_rcp_f32 v132, v132
    v_rcp_f32 v133, v133
    v_mfma_f32_4x4x4_16b_bf16 v[144:147], v[228:229], v[228:229], v[144:147]
    v_rcp_f32 v134, v134
    v_cvt_pk_bf16_f32 v132, v132, v133
    s_waitcnt lgkmcnt(6)
    buffer_load_dwordx4 v[230:231], s[20:23], s35 idxen offen nt lds
    buffer_load_dwordx4 v[232:233], s[40:43], s35 idxen offen offset:1056 nt lds
    s_waitcnt lgkmcnt(0)
    v_mfma_f32_16x16x32_bf16 v[148:151], v[100:103], v[180:183], v[164:167]
    v_rcp_f32 v135, v135
    v_mfma_f32_16x16x32_bf16 v[152:155], v[108:111], v[180:183], v[168:171]
    v_rcp_f32 v136, v136
    v_cvt_pk_bf16_f32 v133, v134, v135
    v_mfma_f32_16x16x32_bf16 v[148:151], v[104:107], v[184:187], v[148:151]
    v_rcp_f32 v137, v137
    v_mfma_f32_16x16x32_bf16 v[152:155], v[112:115], v[184:187], v[152:155]
    v_rcp_f32 v138, v138
    v_cvt_pk_bf16_f32 v134, v136, v137
    v_mfma_f32_16x16x32_bf16 v[156:159], v[116:119], v[180:183], v[172:175]
    v_rcp_f32 v139, v139
    v_mfma_f32_16x16x32_bf16 v[160:163], v[124:127], v[180:183], v[176:179]
    v_rcp_f32 v140, v140
    v_cvt_pk_bf16_f32 v135, v138, v139
    v_mfma_f32_16x16x32_bf16 v[156:159], v[120:123], v[184:187], v[156:159]
    v_rcp_f32 v141, v141
    v_mfma_f32_16x16x32_bf16 v[160:163], v[128:131], v[184:187], v[160:163]
    v_rcp_f32 v142, v142
    v_cvt_pk_bf16_f32 v136, v140, v141
    v_mfma_f32_16x16x32_bf16 v[208:211], v[132:135], v[196:199], v[204:207]
    v_rcp_f32 v143, v143
    v_rcp_f32 v144, v144
    v_cvt_pk_bf16_f32 v137, v142, v143
    v_rcp_f32 v145, v145
    v_rcp_f32 v146, v146
    v_rcp_f32 v147, v147
    v_cvt_pk_bf16_f32 v138, v144, v145
    v_cvt_pk_bf16_f32 v139, v146, v147
    s_bitcmp1_b32 s36, 2
    s_cbranch_scc1 Ls_ev2
Ls_evd2:
    v_mfma_f32_16x16x32_bf16 v[208:211], v[136:139], v[200:203], v[208:211]
    ds_read_b32 v246, v244 offset:32
    s_waitcnt lgkmcnt(0)
    v_bfe_u32 v247, v246, 0, 8
    v_lshlrev_b32 v247, 1, v247
    v_bfe_u32 v248, v246, 8, 8
    v_lshlrev_b32 v248, 1, v248
    v_bfe_u32 v249, v246, 16, 8
    v_lshlrev_b32 v249, 1, v249
    v_bfe_u32 v250, v246, 24, 8
    v_lshlrev_b32 v250, 1, v250
    buffer_load_ushort v247, v247, s[24:27], 0 offen
    buffer_load_ushort v248, v248, s[24:27], 0 offen
    buffer_load_ushort v249, v249, s[24:27], 0 offen
    buffer_load_ushort v250, v250, s[24:27], 0 offen
    s_waitcnt vmcnt(0)
    v_lshlrev_b32 v247, 16, v247
    v_mul_f32 v208, v208, v247
    v_lshlrev_b32 v248, 16, v248
    v_mul_f32 v209, v209, v248
    v_lshlrev_b32 v249, 16, v249
    v_mul_f32 v210, v210, v249
    v_lshlrev_b32 v250, 16, v250
    v_mul_f32 v211, v211, v250
    v_exp_f32 v132, v148
    v_exp_f32 v133, v149
    v_exp_f32 v134, v150
    v_exp_f32 v135, v151
    v_exp_f32 v136, v152
    v_exp_f32 v137, v153
    v_mfma_f32_4x4x4_16b_bf16 v[132:135], v[228:229], v[228:229], v[132:135]
    v_exp_f32 v138, v154
    v_exp_f32 v139, v155
    v_cvt_pk_bf16_f32 v208, v208, v209
    v_cvt_pk_bf16_f32 v209, v210, v211
    v_exp_f32 v140, v156
    v_exp_f32 v141, v157
    v_mfma_f32_4x4x4_16b_bf16 v[212:215], v[208:209], v[188:189], v[212:215] cbsz:4 abid:0
    v_mfma_f32_4x4x4_16b_bf16 v[136:139], v[228:229], v[228:229], v[136:139]
    v_exp_f32 v142, v158
    v_mfma_f32_4x4x4_16b_bf16 v[212:215], v[208:209], v[190:191], v[212:215] cbsz:4 abid:4
    v_exp_f32 v143, v159
    v_exp_f32 v144, v160
    v_mfma_f32_4x4x4_16b_bf16 v[212:215], v[208:209], v[192:193], v[212:215] cbsz:4 abid:8
    v_exp_f32 v145, v161
    v_mfma_f32_4x4x4_16b_bf16 v[140:143], v[228:229], v[228:229], v[140:143]
    v_mfma_f32_4x4x4_16b_bf16 v[212:215], v[208:209], v[194:195], v[212:215] cbsz:4 abid:12
    ds_read_u8 v230, v237 offset:80
    ds_read_u8 v232, v237 offset:88
    ds_read_b64_tr_b16 v[188:189], v236 offset:4160
    ds_read_b64_tr_b16 v[190:191], v236 offset:4672
    ds_read_b64_tr_b16 v[192:193], v236 offset:5216
    ds_read_b64_tr_b16 v[194:195], v236 offset:5728
    s_waitcnt vmcnt(2)
    ds_read_b128 v[180:183], v234 offset:6240
    ds_read_b128 v[184:187], v235 offset:6240
    s_add_u32 m0, s52, 2080
    v_exp_f32 v146, v162
    v_exp_f32 v147, v163
    v_rcp_f32 v132, v132
    v_rcp_f32 v133, v133
    v_mfma_f32_4x4x4_16b_bf16 v[144:147], v[228:229], v[228:229], v[144:147]
    v_rcp_f32 v134, v134
    v_cvt_pk_bf16_f32 v132, v132, v133
    s_waitcnt lgkmcnt(6)
    buffer_load_dwordx4 v[230:231], s[20:23], s35 idxen offen nt lds
    buffer_load_dwordx4 v[232:233], s[40:43], s35 idxen offen offset:1056 nt lds
    s_waitcnt lgkmcnt(0)
    v_mfma_f32_16x16x32_bf16 v[148:151], v[100:103], v[180:183], v[164:167]
    v_rcp_f32 v135, v135
    v_mfma_f32_16x16x32_bf16 v[152:155], v[108:111], v[180:183], v[168:171]
    v_rcp_f32 v136, v136
    v_cvt_pk_bf16_f32 v133, v134, v135
    v_mfma_f32_16x16x32_bf16 v[148:151], v[104:107], v[184:187], v[148:151]
    v_rcp_f32 v137, v137
    v_mfma_f32_16x16x32_bf16 v[152:155], v[112:115], v[184:187], v[152:155]
    v_rcp_f32 v138, v138
    v_cvt_pk_bf16_f32 v134, v136, v137
    v_mfma_f32_16x16x32_bf16 v[156:159], v[116:119], v[180:183], v[172:175]
    v_rcp_f32 v139, v139
    v_mfma_f32_16x16x32_bf16 v[160:163], v[124:127], v[180:183], v[176:179]
    v_rcp_f32 v140, v140
    v_cvt_pk_bf16_f32 v135, v138, v139
    v_mfma_f32_16x16x32_bf16 v[156:159], v[120:123], v[184:187], v[156:159]
    v_rcp_f32 v141, v141
    v_mfma_f32_16x16x32_bf16 v[160:163], v[128:131], v[184:187], v[160:163]
    v_rcp_f32 v142, v142
    v_cvt_pk_bf16_f32 v136, v140, v141
    v_mfma_f32_16x16x32_bf16 v[208:211], v[132:135], v[196:199], v[204:207]
    v_rcp_f32 v143, v143
    v_rcp_f32 v144, v144
    v_cvt_pk_bf16_f32 v137, v142, v143
    v_rcp_f32 v145, v145
    v_rcp_f32 v146, v146
    v_rcp_f32 v147, v147
    v_cvt_pk_bf16_f32 v138, v144, v145
    v_cvt_pk_bf16_f32 v139, v146, v147
    s_bitcmp1_b32 s36, 3
    s_cbranch_scc1 Ls_ev3
Ls_evd3:
    v_mfma_f32_16x16x32_bf16 v[208:211], v[136:139], v[200:203], v[208:211]
    ds_read_b32 v246, v244 offset:48
    s_waitcnt lgkmcnt(0)
    v_bfe_u32 v247, v246, 0, 8
    v_lshlrev_b32 v247, 1, v247
    v_bfe_u32 v248, v246, 8, 8
    v_lshlrev_b32 v248, 1, v248
    v_bfe_u32 v249, v246, 16, 8
    v_lshlrev_b32 v249, 1, v249
    v_bfe_u32 v250, v246, 24, 8
    v_lshlrev_b32 v250, 1, v250
    buffer_load_ushort v247, v247, s[24:27], 0 offen
    buffer_load_ushort v248, v248, s[24:27], 0 offen
    buffer_load_ushort v249, v249, s[24:27], 0 offen
    buffer_load_ushort v250, v250, s[24:27], 0 offen
    s_waitcnt vmcnt(0)
    v_lshlrev_b32 v247, 16, v247
    v_mul_f32 v208, v208, v247
    v_lshlrev_b32 v248, 16, v248
    v_mul_f32 v209, v209, v248
    v_lshlrev_b32 v249, 16, v249
    v_mul_f32 v210, v210, v249
    v_lshlrev_b32 v250, 16, v250
    v_mul_f32 v211, v211, v250
    v_exp_f32 v132, v148
    v_exp_f32 v133, v149
    v_exp_f32 v134, v150
    v_exp_f32 v135, v151
    v_exp_f32 v136, v152
    v_exp_f32 v137, v153
    v_mfma_f32_4x4x4_16b_bf16 v[132:135], v[228:229], v[228:229], v[132:135]
    v_exp_f32 v138, v154
    v_exp_f32 v139, v155
    v_cvt_pk_bf16_f32 v208, v208, v209
    v_cvt_pk_bf16_f32 v209, v210, v211
    v_exp_f32 v140, v156
    v_exp_f32 v141, v157
    v_mfma_f32_4x4x4_16b_bf16 v[212:215], v[208:209], v[188:189], v[212:215] cbsz:4 abid:0
    v_mfma_f32_4x4x4_16b_bf16 v[136:139], v[228:229], v[228:229], v[136:139]
    v_exp_f32 v142, v158
    v_mfma_f32_4x4x4_16b_bf16 v[212:215], v[208:209], v[190:191], v[212:215] cbsz:4 abid:4
    v_exp_f32 v143, v159
    v_exp_f32 v144, v160
    v_mfma_f32_4x4x4_16b_bf16 v[212:215], v[208:209], v[192:193], v[212:215] cbsz:4 abid:8
    v_exp_f32 v145, v161
    v_mfma_f32_4x4x4_16b_bf16 v[140:143], v[228:229], v[228:229], v[140:143]
    v_mfma_f32_4x4x4_16b_bf16 v[212:215], v[208:209], v[194:195], v[212:215] cbsz:4 abid:12
    ds_read_u8 v230, v237 offset:96
    ds_read_u8 v232, v237 offset:104
    ds_read_b64_tr_b16 v[188:189], v236 offset:6240
    ds_read_b64_tr_b16 v[190:191], v236 offset:6752
    ds_read_b64_tr_b16 v[192:193], v236 offset:7296
    ds_read_b64_tr_b16 v[194:195], v236 offset:7808
    s_waitcnt vmcnt(2)
    ds_read_b128 v[180:183], v234 offset:0
    ds_read_b128 v[184:187], v235 offset:0
    s_add_u32 m0, s52, 4160
    v_exp_f32 v146, v162
    v_exp_f32 v147, v163
    v_rcp_f32 v132, v132
    v_rcp_f32 v133, v133
    v_mfma_f32_4x4x4_16b_bf16 v[144:147], v[228:229], v[228:229], v[144:147]
    v_rcp_f32 v134, v134
    v_cvt_pk_bf16_f32 v132, v132, v133
    s_waitcnt lgkmcnt(6)
    buffer_load_dwordx4 v[230:231], s[20:23], s35 idxen offen nt lds
    buffer_load_dwordx4 v[232:233], s[40:43], s35 idxen offen offset:1056 nt lds
    s_waitcnt lgkmcnt(0)
    v_mfma_f32_16x16x32_bf16 v[148:151], v[100:103], v[180:183], v[164:167]
    v_rcp_f32 v135, v135
    v_mfma_f32_16x16x32_bf16 v[152:155], v[108:111], v[180:183], v[168:171]
    v_rcp_f32 v136, v136
    v_cvt_pk_bf16_f32 v133, v134, v135
    v_mfma_f32_16x16x32_bf16 v[148:151], v[104:107], v[184:187], v[148:151]
    v_rcp_f32 v137, v137
    v_mfma_f32_16x16x32_bf16 v[152:155], v[112:115], v[184:187], v[152:155]
    v_rcp_f32 v138, v138
    v_cvt_pk_bf16_f32 v134, v136, v137
    v_mfma_f32_16x16x32_bf16 v[156:159], v[116:119], v[180:183], v[172:175]
    v_rcp_f32 v139, v139
    v_mfma_f32_16x16x32_bf16 v[160:163], v[124:127], v[180:183], v[176:179]
    v_rcp_f32 v140, v140
    v_cvt_pk_bf16_f32 v135, v138, v139
    v_mfma_f32_16x16x32_bf16 v[156:159], v[120:123], v[184:187], v[156:159]
    v_rcp_f32 v141, v141
    v_mfma_f32_16x16x32_bf16 v[160:163], v[128:131], v[184:187], v[160:163]
    v_rcp_f32 v142, v142
    v_cvt_pk_bf16_f32 v136, v140, v141
    v_mfma_f32_16x16x32_bf16 v[208:211], v[132:135], v[196:199], v[204:207]
    v_rcp_f32 v143, v143
    v_rcp_f32 v144, v144
    v_cvt_pk_bf16_f32 v137, v142, v143
    s_lshr_b64 s[56:57], s[56:57], 4
    s_lshr_b64 s[86:87], s[56:57], 2
    s_lshr_b64 s[36:37], s[56:57], 4
    s_or_b32 s37, s36, s86
    s_or_b32 s36, s37, s56
    v_add_u32 v237, 64, v237
    v_add_u32 v244, 64, v244
    v_rcp_f32 v145, v145
    v_rcp_f32 v146, v146
    v_rcp_f32 v147, v147
    v_cvt_pk_bf16_f32 v138, v144, v145
    v_cvt_pk_bf16_f32 v139, v146, v147
    s_branch Ls_loop
Ls_fl0:
    v_cvt_pk_bf16_f32 v246, v212, v212
    v_mov_b32 v212, 0
    ds_write_b16 v240, v246
    v_add_u32 v240, 128, v240
    s_add_u32 s24, s24, s32
    s_addc_u32 s25, s25, 0
    s_xor_b32 s32, s32, 0x18ffe0
    s_bitcmp0_b32 s37, 0
    s_cbranch_scc1 Ls_evd0
    s_branch Ls_ev20
Ls_ev0:
    s_bitcmp1_b64 s[56:57], 0
    s_cbranch_scc1 Ls_fl0
Ls_ev20:
    s_bitcmp1_b64 s[56:57], 2
    s_cbranch_scc1 Ls_w0
    s_sub_u32 s60, s60, 1
    s_cbranch_scc0 Ls_nsa0
    s_mov_b32 s49, 4
    s_call_b64 s[62:63], L_swap
Ls_nsa0:
    s_add_u32 s35, s35, s31
    s_min_u32 s35, s35, 419404800
    s_xor_b32 s31, s31, 0x63ff800
    s_branch Ls_evd0
Ls_w0:
    s_bitcmp0_b64 s[56:57], 4
    s_cbranch_scc1 Ls_e10
    s_sub_u32 s60, s60, 1
    s_cbranch_scc0 Ls_nsb0
    s_mov_b32 s49, 4
    s_call_b64 s[62:63], L_swap
    s_waitcnt lgkmcnt(0)
Ls_nsb0:
    s_add_u32 s35, s35, s31
    s_min_u32 s35, s35, 419404800
    s_xor_b32 s31, s31, 0x63ff800
Ls_e10:
    s_sub_u32 s61, s61, 1
    s_cbranch_scc1 Ls_last0
    s_bitcmp0_b32 s33, s61
    s_cbranch_scc1 Ls_nw0
    s_cmp_eq_u32 s61, 3
    s_cselect_b32 s66, s80, s81
    v_add_u32 v238, s66, v238
    v_add_u32 v239, s66, v239
    ds_read_u16 v224, v238 offset:0
    ds_read_u16 v225, v238 offset:8
    ds_read_u16 v226, v238 offset:64
    ds_read_u16 v227, v238 offset:72
    s_waitcnt lgkmcnt(0)
Ls_nw0:
    v_mul_u32_u24 v216, v224, v241
    v_mul_u32_u24 v217, v224, v242
    v_mul_u32_u24 v218, v225, v241
    v_mul_u32_u24 v219, v225, v242
    v_mul_u32_u24 v220, v226, v241
    v_mul_u32_u24 v221, v226, v242
    v_mul_u32_u24 v222, v227, v241
    v_mul_u32_u24 v223, v227, v242
    v_mfma_f32_4x4x4_16b_bf16 v[140:143], v[216:217], v[68:69], v[4:7]
    v_add_u32 v238, 128, v238
    ds_read_b128 v[164:167], v239 offset:0
    ds_read_b128 v[168:171], v239 offset:64
    v_mfma_f32_4x4x4_16b_bf16 v[144:147], v[218:219], v[70:71], v[8:11]
    ds_read_b128 v[172:175], v239 offset:128
    ds_read_b128 v[176:179], v239 offset:192
    ds_read_u16 v224, v238 offset:0
    ds_read_u16 v225, v238 offset:8
    ds_read_u16 v226, v238 offset:64
    ds_read_u16 v227, v238 offset:72
    v_mfma_f32_4x4x4_16b_bf16 v[246:249], v[220:221], v[72:73], v[12:15]
    v_cvt_pk_bf16_f32 v100, v140, v141
    v_cvt_pk_bf16_f32 v101, v142, v143
    v_mfma_f32_4x4x4_16b_bf16 v[250:253], v[222:223], v[74:75], v[16:19]
    v_cvt_pk_bf16_f32 v102, v144, v145
    v_cvt_pk_bf16_f32 v103, v146, v147
    v_mfma_f32_4x4x4_16b_bf16 v[140:143], v[216:217], v[76:77], v[20:23]
    v_cvt_pk_bf16_f32 v104, v246, v247
    v_cvt_pk_bf16_f32 v105, v248, v249
    v_mfma_f32_4x4x4_16b_bf16 v[144:147], v[218:219], v[78:79], v[24:27]
    v_cvt_pk_bf16_f32 v106, v250, v251
    v_cvt_pk_bf16_f32 v107, v252, v253
    v_mfma_f32_4x4x4_16b_bf16 v[246:249], v[220:221], v[80:81], v[28:31]
    v_cvt_pk_bf16_f32 v108, v140, v141
    v_cvt_pk_bf16_f32 v109, v142, v143
    v_mfma_f32_4x4x4_16b_bf16 v[250:253], v[222:223], v[82:83], v[32:35]
    v_cvt_pk_bf16_f32 v110, v144, v145
    v_cvt_pk_bf16_f32 v111, v146, v147
    v_mfma_f32_4x4x4_16b_bf16 v[140:143], v[216:217], v[84:85], v[36:39]
    v_cvt_pk_bf16_f32 v112, v246, v247
    v_cvt_pk_bf16_f32 v113, v248, v249
    v_mfma_f32_4x4x4_16b_bf16 v[144:147], v[218:219], v[86:87], v[40:43]
    v_cvt_pk_bf16_f32 v114, v250, v251
    v_cvt_pk_bf16_f32 v115, v252, v253
    v_mfma_f32_4x4x4_16b_bf16 v[246:249], v[220:221], v[88:89], v[44:47]
    v_cvt_pk_bf16_f32 v116, v140, v141
    v_cvt_pk_bf16_f32 v117, v142, v143
    v_mfma_f32_4x4x4_16b_bf16 v[250:253], v[222:223], v[90:91], v[48:51]
    v_cvt_pk_bf16_f32 v118, v144, v145
    v_cvt_pk_bf16_f32 v119, v146, v147
    v_mfma_f32_4x4x4_16b_bf16 v[140:143], v[216:217], v[92:93], v[52:55]
    v_cvt_pk_bf16_f32 v120, v246, v247
    v_cvt_pk_bf16_f32 v121, v248, v249
    v_mfma_f32_4x4x4_16b_bf16 v[144:147], v[218:219], v[94:95], v[56:59]
    v_cvt_pk_bf16_f32 v122, v250, v251
    v_cvt_pk_bf16_f32 v123, v252, v253
    v_mfma_f32_4x4x4_16b_bf16 v[246:249], v[220:221], v[96:97], v[60:63]
    v_cvt_pk_bf16_f32 v124, v140, v141
    v_cvt_pk_bf16_f32 v125, v142, v143
    v_mfma_f32_4x4x4_16b_bf16 v[250:253], v[222:223], v[98:99], v[64:67]
    v_cvt_pk_bf16_f32 v126, v144, v145
    v_cvt_pk_bf16_f32 v127, v146, v147
    v_cvt_pk_bf16_f32 v128, v246, v247
    v_cvt_pk_bf16_f32 v129, v248, v249
    v_add_u32 v239, 272, v239
    v_cvt_pk_bf16_f32 v130, v250, v251
    v_cvt_pk_bf16_f32 v131, v252, v253
    s_waitcnt lgkmcnt(0)
    s_branch Ls_evd0
Ls_fl1:
    v_cvt_pk_bf16_f32 v246, v212, v212
    v_mov_b32 v212, 0
    ds_write_b16 v240, v246
    v_add_u32 v240, 128, v240
    s_add_u32 s24, s24, s32
    s_addc_u32 s25, s25, 0
    s_xor_b32 s32, s32, 0x18ffe0
    s_bitcmp0_b32 s37, 1
    s_cbranch_scc1 Ls_evd1
    s_branch Ls_ev21
Ls_ev1:
    s_bitcmp1_b64 s[56:57], 1
    s_cbranch_scc1 Ls_fl1
Ls_ev21:
    s_bitcmp1_b64 s[56:57], 3
    s_cbranch_scc1 Ls_w1
    s_sub_u32 s60, s60, 1
    s_cbranch_scc0 Ls_nsa1
    s_mov_b32 s49, 5
    s_call_b64 s[62:63], L_swap
Ls_nsa1:
    s_add_u32 s35, s35, s31
    s_min_u32 s35, s35, 419404800
    s_xor_b32 s31, s31, 0x63ff800
    s_branch Ls_evd1
Ls_w1:
    s_bitcmp0_b64 s[56:57], 5
    s_cbranch_scc1 Ls_e11
    s_sub_u32 s60, s60, 1
    s_cbranch_scc0 Ls_nsb1
    s_mov_b32 s49, 5
    s_call_b64 s[62:63], L_swap
    s_waitcnt lgkmcnt(0)
Ls_nsb1:
    s_add_u32 s35, s35, s31
    s_min_u32 s35, s35, 419404800
    s_xor_b32 s31, s31, 0x63ff800
Ls_e11:
    s_sub_u32 s61, s61, 1
    s_cbranch_scc1 Ls_last1
    s_bitcmp0_b32 s33, s61
    s_cbranch_scc1 Ls_nw1
    s_cmp_eq_u32 s61, 3
    s_cselect_b32 s66, s80, s81
    v_add_u32 v238, s66, v238
    v_add_u32 v239, s66, v239
    ds_read_u16 v224, v238 offset:0
    ds_read_u16 v225, v238 offset:8
    ds_read_u16 v226, v238 offset:64
    ds_read_u16 v227, v238 offset:72
    s_waitcnt lgkmcnt(0)
Ls_nw1:
    v_mul_u32_u24 v216, v224, v241
    v_mul_u32_u24 v217, v224, v242
    v_mul_u32_u24 v218, v225, v241
    v_mul_u32_u24 v219, v225, v242
    v_mul_u32_u24 v220, v226, v241
    v_mul_u32_u24 v221, v226, v242
    v_mul_u32_u24 v222, v227, v241
    v_mul_u32_u24 v223, v227, v242
    v_mfma_f32_4x4x4_16b_bf16 v[140:143], v[216:217], v[68:69], v[4:7]
    v_add_u32 v238, 128, v238
    ds_read_b128 v[164:167], v239 offset:0
    ds_read_b128 v[168:171], v239 offset:64
    v_mfma_f32_4x4x4_16b_bf16 v[144:147], v[218:219], v[70:71], v[8:11]
    ds_read_b128 v[172:175], v239 offset:128
    ds_read_b128 v[176:179], v239 offset:192
    ds_read_u16 v224, v238 offset:0
    ds_read_u16 v225, v238 offset:8
    ds_read_u16 v226, v238 offset:64
    ds_read_u16 v227, v238 offset:72
    v_mfma_f32_4x4x4_16b_bf16 v[246:249], v[220:221], v[72:73], v[12:15]
    v_cvt_pk_bf16_f32 v100, v140, v141
    v_cvt_pk_bf16_f32 v101, v142, v143
    v_mfma_f32_4x4x4_16b_bf16 v[250:253], v[222:223], v[74:75], v[16:19]
    v_cvt_pk_bf16_f32 v102, v144, v145
    v_cvt_pk_bf16_f32 v103, v146, v147
    v_mfma_f32_4x4x4_16b_bf16 v[140:143], v[216:217], v[76:77], v[20:23]
    v_cvt_pk_bf16_f32 v104, v246, v247
    v_cvt_pk_bf16_f32 v105, v248, v249
    v_mfma_f32_4x4x4_16b_bf16 v[144:147], v[218:219], v[78:79], v[24:27]
    v_cvt_pk_bf16_f32 v106, v250, v251
    v_cvt_pk_bf16_f32 v107, v252, v253
    v_mfma_f32_4x4x4_16b_bf16 v[246:249], v[220:221], v[80:81], v[28:31]
    v_cvt_pk_bf16_f32 v108, v140, v141
    v_cvt_pk_bf16_f32 v109, v142, v143
    v_mfma_f32_4x4x4_16b_bf16 v[250:253], v[222:223], v[82:83], v[32:35]
    v_cvt_pk_bf16_f32 v110, v144, v145
    v_cvt_pk_bf16_f32 v111, v146, v147
    v_mfma_f32_4x4x4_16b_bf16 v[140:143], v[216:217], v[84:85], v[36:39]
    v_cvt_pk_bf16_f32 v112, v246, v247
    v_cvt_pk_bf16_f32 v113, v248, v249
    v_mfma_f32_4x4x4_16b_bf16 v[144:147], v[218:219], v[86:87], v[40:43]
    v_cvt_pk_bf16_f32 v114, v250, v251
    v_cvt_pk_bf16_f32 v115, v252, v253
    v_mfma_f32_4x4x4_16b_bf16 v[246:249], v[220:221], v[88:89], v[44:47]
    v_cvt_pk_bf16_f32 v116, v140, v141
    v_cvt_pk_bf16_f32 v117, v142, v143
    v_mfma_f32_4x4x4_16b_bf16 v[250:253], v[222:223], v[90:91], v[48:51]
    v_cvt_pk_bf16_f32 v118, v144, v145
    v_cvt_pk_bf16_f32 v119, v146, v147
    v_mfma_f32_4x4x4_16b_bf16 v[140:143], v[216:217], v[92:93], v[52:55]
    v_cvt_pk_bf16_f32 v120, v246, v247
    v_cvt_pk_bf16_f32 v121, v248, v249
    v_mfma_f32_4x4x4_16b_bf16 v[144:147], v[218:219], v[94:95], v[56:59]
    v_cvt_pk_bf16_f32 v122, v250, v251
    v_cvt_pk_bf16_f32 v123, v252, v253
    v_mfma_f32_4x4x4_16b_bf16 v[246:249], v[220:221], v[96:97], v[60:63]
    v_cvt_pk_bf16_f32 v124, v140, v141
    v_cvt_pk_bf16_f32 v125, v142, v143
    v_mfma_f32_4x4x4_16b_bf16 v[250:253], v[222:223], v[98:99], v[64:67]
    v_cvt_pk_bf16_f32 v126, v144, v145
    v_cvt_pk_bf16_f32 v127, v146, v147
    v_cvt_pk_bf16_f32 v128, v246, v247
    v_cvt_pk_bf16_f32 v129, v248, v249
    v_add_u32 v239, 272, v239
    v_cvt_pk_bf16_f32 v130, v250, v251
    v_cvt_pk_bf16_f32 v131, v252, v253
    s_waitcnt lgkmcnt(0)
    s_branch Ls_evd1
Ls_fl2:
    v_cvt_pk_bf16_f32 v246, v212, v212
    v_mov_b32 v212, 0
    ds_write_b16 v240, v246
    v_add_u32 v240, 128, v240
    s_add_u32 s24, s24, s32
    s_addc_u32 s25, s25, 0
    s_xor_b32 s32, s32, 0x18ffe0
    s_bitcmp0_b32 s37, 2
    s_cbranch_scc1 Ls_evd2
    s_branch Ls_ev22
Ls_ev2:
    s_bitcmp1_b64 s[56:57], 2
    s_cbranch_scc1 Ls_fl2
Ls_ev22:
    s_bitcmp1_b64 s[56:57], 4
    s_cbranch_scc1 Ls_w2
    s_sub_u32 s60, s60, 1
    s_cbranch_scc0 Ls_nsa2
    s_mov_b32 s49, 6
    s_call_b64 s[62:63], L_swap
Ls_nsa2:
    s_add_u32 s35, s35, s31
    s_min_u32 s35, s35, 419404800
    s_xor_b32 s31, s31, 0x63ff800
    s_branch Ls_evd2
Ls_w2:
    s_bitcmp0_b64 s[56:57], 6
    s_cbranch_scc1 Ls_e12
    s_sub_u32 s60, s60, 1
    s_cbranch_scc0 Ls_nsb2
    s_mov_b32 s49, 6
    s_call_b64 s[62:63], L_swap
    s_waitcnt lgkmcnt(0)
Ls_nsb2:
    s_add_u32 s35, s35, s31
    s_min_u32 s35, s35, 419404800
    s_xor_b32 s31, s31, 0x63ff800
Ls_e12:
    s_sub_u32 s61, s61, 1
    s_cbranch_scc1 Ls_last2
    s_bitcmp0_b32 s33, s61
    s_cbranch_scc1 Ls_nw2
    s_cmp_eq_u32 s61, 3
    s_cselect_b32 s66, s80, s81
    v_add_u32 v238, s66, v238
    v_add_u32 v239, s66, v239
    ds_read_u16 v224, v238 offset:0
    ds_read_u16 v225, v238 offset:8
    ds_read_u16 v226, v238 offset:64
    ds_read_u16 v227, v238 offset:72
    s_waitcnt lgkmcnt(0)
Ls_nw2:
    v_mul_u32_u24 v216, v224, v241
    v_mul_u32_u24 v217, v224, v242
    v_mul_u32_u24 v218, v225, v241
    v_mul_u32_u24 v219, v225, v242
    v_mul_u32_u24 v220, v226, v241
    v_mul_u32_u24 v221, v226, v242
    v_mul_u32_u24 v222, v227, v241
    v_mul_u32_u24 v223, v227, v242
    v_mfma_f32_4x4x4_16b_bf16 v[140:143], v[216:217], v[68:69], v[4:7]
    v_add_u32 v238, 128, v238
    ds_read_b128 v[164:167], v239 offset:0
    ds_read_b128 v[168:171], v239 offset:64
    v_mfma_f32_4x4x4_16b_bf16 v[144:147], v[218:219], v[70:71], v[8:11]
    ds_read_b128 v[172:175], v239 offset:128
    ds_read_b128 v[176:179], v239 offset:192
    ds_read_u16 v224, v238 offset:0
    ds_read_u16 v225, v238 offset:8
    ds_read_u16 v226, v238 offset:64
    ds_read_u16 v227, v238 offset:72
    v_mfma_f32_4x4x4_16b_bf16 v[246:249], v[220:221], v[72:73], v[12:15]
    v_cvt_pk_bf16_f32 v100, v140, v141
    v_cvt_pk_bf16_f32 v101, v142, v143
    v_mfma_f32_4x4x4_16b_bf16 v[250:253], v[222:223], v[74:75], v[16:19]
    v_cvt_pk_bf16_f32 v102, v144, v145
    v_cvt_pk_bf16_f32 v103, v146, v147
    v_mfma_f32_4x4x4_16b_bf16 v[140:143], v[216:217], v[76:77], v[20:23]
    v_cvt_pk_bf16_f32 v104, v246, v247
    v_cvt_pk_bf16_f32 v105, v248, v249
    v_mfma_f32_4x4x4_16b_bf16 v[144:147], v[218:219], v[78:79], v[24:27]
    v_cvt_pk_bf16_f32 v106, v250, v251
    v_cvt_pk_bf16_f32 v107, v252, v253
    v_mfma_f32_4x4x4_16b_bf16 v[246:249], v[220:221], v[80:81], v[28:31]
    v_cvt_pk_bf16_f32 v108, v140, v141
    v_cvt_pk_bf16_f32 v109, v142, v143
    v_mfma_f32_4x4x4_16b_bf16 v[250:253], v[222:223], v[82:83], v[32:35]
    v_cvt_pk_bf16_f32 v110, v144, v145
    v_cvt_pk_bf16_f32 v111, v146, v147
    v_mfma_f32_4x4x4_16b_bf16 v[140:143], v[216:217], v[84:85], v[36:39]
    v_cvt_pk_bf16_f32 v112, v246, v247
    v_cvt_pk_bf16_f32 v113, v248, v249
    v_mfma_f32_4x4x4_16b_bf16 v[144:147], v[218:219], v[86:87], v[40:43]
    v_cvt_pk_bf16_f32 v114, v250, v251
    v_cvt_pk_bf16_f32 v115, v252, v253
    v_mfma_f32_4x4x4_16b_bf16 v[246:249], v[220:221], v[88:89], v[44:47]
    v_cvt_pk_bf16_f32 v116, v140, v141
    v_cvt_pk_bf16_f32 v117, v142, v143
    v_mfma_f32_4x4x4_16b_bf16 v[250:253], v[222:223], v[90:91], v[48:51]
    v_cvt_pk_bf16_f32 v118, v144, v145
    v_cvt_pk_bf16_f32 v119, v146, v147
    v_mfma_f32_4x4x4_16b_bf16 v[140:143], v[216:217], v[92:93], v[52:55]
    v_cvt_pk_bf16_f32 v120, v246, v247
    v_cvt_pk_bf16_f32 v121, v248, v249
    v_mfma_f32_4x4x4_16b_bf16 v[144:147], v[218:219], v[94:95], v[56:59]
    v_cvt_pk_bf16_f32 v122, v250, v251
    v_cvt_pk_bf16_f32 v123, v252, v253
    v_mfma_f32_4x4x4_16b_bf16 v[246:249], v[220:221], v[96:97], v[60:63]
    v_cvt_pk_bf16_f32 v124, v140, v141
    v_cvt_pk_bf16_f32 v125, v142, v143
    v_mfma_f32_4x4x4_16b_bf16 v[250:253], v[222:223], v[98:99], v[64:67]
    v_cvt_pk_bf16_f32 v126, v144, v145
    v_cvt_pk_bf16_f32 v127, v146, v147
    v_cvt_pk_bf16_f32 v128, v246, v247
    v_cvt_pk_bf16_f32 v129, v248, v249
    v_add_u32 v239, 272, v239
    v_cvt_pk_bf16_f32 v130, v250, v251
    v_cvt_pk_bf16_f32 v131, v252, v253
    s_waitcnt lgkmcnt(0)
    s_branch Ls_evd2
Ls_fl3:
    v_cvt_pk_bf16_f32 v246, v212, v212
    v_mov_b32 v212, 0
    ds_write_b16 v240, v246
    v_add_u32 v240, 128, v240
    s_add_u32 s24, s24, s32
    s_addc_u32 s25, s25, 0
    s_xor_b32 s32, s32, 0x18ffe0
    s_bitcmp0_b32 s37, 3
    s_cbranch_scc1 Ls_evd3
    s_branch Ls_ev23
Ls_ev3:
    s_bitcmp1_b64 s[56:57], 3
    s_cbranch_scc1 Ls_fl3
Ls_ev23:
    s_bitcmp1_b64 s[56:57], 5
    s_cbranch_scc1 Ls_w3
    s_sub_u32 s60, s60, 1
    s_cbranch_scc0 Ls_nsa3
    s_mov_b32 s49, 7
    s_call_b64 s[62:63], L_swap
Ls_nsa3:
    s_add_u32 s35, s35, s31
    s_min_u32 s35, s35, 419404800
    s_xor_b32 s31, s31, 0x63ff800
    s_branch Ls_evd3
Ls_w3:
    s_bitcmp0_b64 s[56:57], 7
    s_cbranch_scc1 Ls_e13
    s_sub_u32 s60, s60, 1
    s_cbranch_scc0 Ls_nsb3
    s_mov_b32 s49, 7
    s_call_b64 s[62:63], L_swap
    s_waitcnt lgkmcnt(0)
Ls_nsb3:
    s_add_u32 s35, s35, s31
    s_min_u32 s35, s35, 419404800
    s_xor_b32 s31, s31, 0x63ff800
Ls_e13:
    s_sub_u32 s61, s61, 1
    s_cbranch_scc1 Ls_last3
    s_bitcmp0_b32 s33, s61
    s_cbranch_scc1 Ls_nw3
    s_cmp_eq_u32 s61, 3
    s_cselect_b32 s66, s80, s81
    v_add_u32 v238, s66, v238
    v_add_u32 v239, s66, v239
    ds_read_u16 v224, v238 offset:0
    ds_read_u16 v225, v238 offset:8
    ds_read_u16 v226, v238 offset:64
    ds_read_u16 v227, v238 offset:72
    s_waitcnt lgkmcnt(0)
Ls_nw3:
    v_mul_u32_u24 v216, v224, v241
    v_mul_u32_u24 v217, v224, v242
    v_mul_u32_u24 v218, v225, v241
    v_mul_u32_u24 v219, v225, v242
    v_mul_u32_u24 v220, v226, v241
    v_mul_u32_u24 v221, v226, v242
    v_mul_u32_u24 v222, v227, v241
    v_mul_u32_u24 v223, v227, v242
    v_mfma_f32_4x4x4_16b_bf16 v[140:143], v[216:217], v[68:69], v[4:7]
    v_add_u32 v238, 128, v238
    ds_read_b128 v[164:167], v239 offset:0
    ds_read_b128 v[168:171], v239 offset:64
    v_mfma_f32_4x4x4_16b_bf16 v[144:147], v[218:219], v[70:71], v[8:11]
    ds_read_b128 v[172:175], v239 offset:128
    ds_read_b128 v[176:179], v239 offset:192
    ds_read_u16 v224, v238 offset:0
    ds_read_u16 v225, v238 offset:8
    ds_read_u16 v226, v238 offset:64
    ds_read_u16 v227, v238 offset:72
    v_mfma_f32_4x4x4_16b_bf16 v[246:249], v[220:221], v[72:73], v[12:15]
    v_cvt_pk_bf16_f32 v100, v140, v141
    v_cvt_pk_bf16_f32 v101, v142, v143
    v_mfma_f32_4x4x4_16b_bf16 v[250:253], v[222:223], v[74:75], v[16:19]
    v_cvt_pk_bf16_f32 v102, v144, v145
    v_cvt_pk_bf16_f32 v103, v146, v147
    v_mfma_f32_4x4x4_16b_bf16 v[140:143], v[216:217], v[76:77], v[20:23]
    v_cvt_pk_bf16_f32 v104, v246, v247
    v_cvt_pk_bf16_f32 v105, v248, v249
    v_mfma_f32_4x4x4_16b_bf16 v[144:147], v[218:219], v[78:79], v[24:27]
    v_cvt_pk_bf16_f32 v106, v250, v251
    v_cvt_pk_bf16_f32 v107, v252, v253
    v_mfma_f32_4x4x4_16b_bf16 v[246:249], v[220:221], v[80:81], v[28:31]
    v_cvt_pk_bf16_f32 v108, v140, v141
    v_cvt_pk_bf16_f32 v109, v142, v143
    v_mfma_f32_4x4x4_16b_bf16 v[250:253], v[222:223], v[82:83], v[32:35]
    v_cvt_pk_bf16_f32 v110, v144, v145
    v_cvt_pk_bf16_f32 v111, v146, v147
    v_mfma_f32_4x4x4_16b_bf16 v[140:143], v[216:217], v[84:85], v[36:39]
    v_cvt_pk_bf16_f32 v112, v246, v247
    v_cvt_pk_bf16_f32 v113, v248, v249
    v_mfma_f32_4x4x4_16b_bf16 v[144:147], v[218:219], v[86:87], v[40:43]
    v_cvt_pk_bf16_f32 v114, v250, v251
    v_cvt_pk_bf16_f32 v115, v252, v253
    v_mfma_f32_4x4x4_16b_bf16 v[246:249], v[220:221], v[88:89], v[44:47]
    v_cvt_pk_bf16_f32 v116, v140, v141
    v_cvt_pk_bf16_f32 v117, v142, v143
    v_mfma_f32_4x4x4_16b_bf16 v[250:253], v[222:223], v[90:91], v[48:51]
    v_cvt_pk_bf16_f32 v118, v144, v145
    v_cvt_pk_bf16_f32 v119, v146, v147
    v_mfma_f32_4x4x4_16b_bf16 v[140:143], v[216:217], v[92:93], v[52:55]
    v_cvt_pk_bf16_f32 v120, v246, v247
    v_cvt_pk_bf16_f32 v121, v248, v249
    v_mfma_f32_4x4x4_16b_bf16 v[144:147], v[218:219], v[94:95], v[56:59]
    v_cvt_pk_bf16_f32 v122, v250, v251
    v_cvt_pk_bf16_f32 v123, v252, v253
    v_mfma_f32_4x4x4_16b_bf16 v[246:249], v[220:221], v[96:97], v[60:63]
    v_cvt_pk_bf16_f32 v124, v140, v141
    v_cvt_pk_bf16_f32 v125, v142, v143
    v_mfma_f32_4x4x4_16b_bf16 v[250:253], v[222:223], v[98:99], v[64:67]
    v_cvt_pk_bf16_f32 v126, v144, v145
    v_cvt_pk_bf16_f32 v127, v146, v147
    v_cvt_pk_bf16_f32 v128, v246, v247
    v_cvt_pk_bf16_f32 v129, v248, v249
    v_add_u32 v239, 272, v239
    v_cvt_pk_bf16_f32 v130, v250, v251
    v_cvt_pk_bf16_f32 v131, v252, v253
    s_waitcnt lgkmcnt(0)
    s_branch Ls_evd3
Ls_last0:
    s_branch Ls_tail
Ls_last1:
    v_add_u32 v236, 2080, v236
    s_lshr_b64 s[56:57], s[56:57], 1
    v_add_u32 v244, 16, v244
    s_branch Ls_tail
Ls_last2:
    v_add_u32 v236, 4160, v236
    s_lshr_b64 s[56:57], s[56:57], 2
    v_add_u32 v244, 32, v244
    s_branch Ls_tail
Ls_last3:
    v_add_u32 v236, 6240, v236
    s_lshr_b64 s[56:57], s[56:57], 3
    v_add_u32 v244, 48, v244
Ls_tail:
    v_mfma_f32_16x16x32_bf16 v[208:211], v[136:139], v[200:203], v[208:211]
    ds_read_b32 v246, v244 offset:0
    s_waitcnt lgkmcnt(0)
    v_bfe_u32 v247, v246, 0, 8
    v_lshlrev_b32 v247, 1, v247
    v_bfe_u32 v248, v246, 8, 8
    v_lshlrev_b32 v248, 1, v248
    v_bfe_u32 v249, v246, 16, 8
    v_lshlrev_b32 v249, 1, v249
    v_bfe_u32 v250, v246, 24, 8
    v_lshlrev_b32 v250, 1, v250
    buffer_load_ushort v247, v247, s[24:27], 0 offen
    buffer_load_ushort v248, v248, s[24:27], 0 offen
    buffer_load_ushort v249, v249, s[24:27], 0 offen
    buffer_load_ushort v250, v250, s[24:27], 0 offen
    s_waitcnt vmcnt(0)
    v_lshlrev_b32 v247, 16, v247
    v_mul_f32 v208, v208, v247
    v_lshlrev_b32 v248, 16, v248
    v_mul_f32 v209, v209, v248
    v_lshlrev_b32 v249, 16, v249
    v_mul_f32 v210, v210, v249
    v_lshlrev_b32 v250, 16, v250
    v_mul_f32 v211, v211, v250
    v_exp_f32 v132, v148
    v_exp_f32 v133, v149
    v_exp_f32 v134, v150
    v_exp_f32 v135, v151
    v_exp_f32 v136, v152
    v_exp_f32 v137, v153
    v_mfma_f32_4x4x4_16b_bf16 v[132:135], v[228:229], v[228:229], v[132:135]
    v_exp_f32 v138, v154
    v_exp_f32 v139, v155
    v_cvt_pk_bf16_f32 v208, v208, v209
    v_cvt_pk_bf16_f32 v209, v210, v211
    v_exp_f32 v140, v156
    v_exp_f32 v141, v157
    v_mfma_f32_4x4x4_16b_bf16 v[212:215], v[208:209], v[188:189], v[212:215] cbsz:4 abid:0
    v_mfma_f32_4x4x4_16b_bf16 v[136:139], v[228:229], v[228:229], v[136:139]
    v_exp_f32 v142, v158
    v_mfma_f32_4x4x4_16b_bf16 v[212:215], v[208:209], v[190:191], v[212:215] cbsz:4 abid:4
    v_exp_f32 v143, v159
    v_exp_f32 v144, v160
    v_mfma_f32_4x4x4_16b_bf16 v[212:215], v[208:209], v[192:193], v[212:215] cbsz:4 abid:8
    v_exp_f32 v145, v161
    v_mfma_f32_4x4x4_16b_bf16 v[140:143], v[228:229], v[228:229], v[140:143]
    v_mfma_f32_4x4x4_16b_bf16 v[212:215], v[208:209], v[194:195], v[212:215] cbsz:4 abid:12
    ds_read_b64_tr_b16 v[188:189], v236 offset:0
    ds_read_b64_tr_b16 v[190:191], v236 offset:512
    ds_read_b64_tr_b16 v[192:193], v236 offset:1056
    ds_read_b64_tr_b16 v[194:195], v236 offset:1568
    v_exp_f32 v146, v162
    v_exp_f32 v147, v163
    v_rcp_f32 v132, v132
    v_rcp_f32 v133, v133
    v_mfma_f32_4x4x4_16b_bf16 v[144:147], v[228:229], v[228:229], v[144:147]
    v_rcp_f32 v134, v134
    s_bitcmp0_b64 s[56:57], 1
    s_cbranch_scc1 Ls_tnf
    v_cvt_pk_bf16_f32 v246, v212, v212
    v_mov_b32 v212, 0
    ds_write_b16 v240, v246
    v_add_u32 v240, 128, v240
    s_add_u32 s24, s24, s32
    s_addc_u32 s25, s25, 0
    s_xor_b32 s32, s32, 0x18ffe0
Ls_tnf:
    v_cvt_pk_bf16_f32 v132, v132, v133
    s_waitcnt lgkmcnt(0)
    v_rcp_f32 v135, v135
    v_rcp_f32 v136, v136
    v_cvt_pk_bf16_f32 v133, v134, v135
    v_rcp_f32 v137, v137
    v_rcp_f32 v138, v138
    v_cvt_pk_bf16_f32 v134, v136, v137
    v_rcp_f32 v139, v139
    v_rcp_f32 v140, v140
    v_cvt_pk_bf16_f32 v135, v138, v139
    v_rcp_f32 v141, v141
    v_rcp_f32 v142, v142
    v_cvt_pk_bf16_f32 v136, v140, v141
    v_mfma_f32_16x16x32_bf16 v[208:211], v[132:135], v[196:199], v[204:207]
    v_rcp_f32 v143, v143
    v_rcp_f32 v144, v144
    v_cvt_pk_bf16_f32 v137, v142, v143
    v_rcp_f32 v145, v145
    v_rcp_f32 v146, v146
    v_rcp_f32 v147, v147
    v_cvt_pk_bf16_f32 v138, v144, v145
    v_cvt_pk_bf16_f32 v139, v146, v147
    s_nop 1
    v_mfma_f32_16x16x32_bf16 v[208:211], v[136:139], v[200:203], v[208:211]
    ds_read_b32 v246, v244 offset:16
    s_waitcnt lgkmcnt(0)
    v_bfe_u32 v247, v246, 0, 8
    v_lshlrev_b32 v247, 1, v247
    v_bfe_u32 v248, v246, 8, 8
    v_lshlrev_b32 v248, 1, v248
    v_bfe_u32 v249, v246, 16, 8
    v_lshlrev_b32 v249, 1, v249
    v_bfe_u32 v250, v246, 24, 8
    v_lshlrev_b32 v250, 1, v250
    buffer_load_ushort v247, v247, s[24:27], 0 offen
    buffer_load_ushort v248, v248, s[24:27], 0 offen
    buffer_load_ushort v249, v249, s[24:27], 0 offen
    buffer_load_ushort v250, v250, s[24:27], 0 offen
    s_waitcnt vmcnt(0)
    v_lshlrev_b32 v247, 16, v247
    v_mul_f32 v208, v208, v247
    v_lshlrev_b32 v248, 16, v248
    v_mul_f32 v209, v209, v248
    v_lshlrev_b32 v249, 16, v249
    v_mul_f32 v210, v210, v249
    v_lshlrev_b32 v250, 16, v250
    v_mul_f32 v211, v211, v250
    v_cvt_pk_bf16_f32 v208, v208, v209
    v_cvt_pk_bf16_f32 v209, v210, v211
    s_nop 1
    v_mfma_f32_4x4x4_16b_bf16 v[212:215], v[208:209], v[188:189], v[212:215] cbsz:4 abid:0
    s_nop 1
    v_mfma_f32_4x4x4_16b_bf16 v[212:215], v[208:209], v[190:191], v[212:215] cbsz:4 abid:4
    s_nop 1
    v_mfma_f32_4x4x4_16b_bf16 v[212:215], v[208:209], v[192:193], v[212:215] cbsz:4 abid:8
    s_nop 1
    v_mfma_f32_4x4x4_16b_bf16 v[212:215], v[208:209], v[194:195], v[212:215] cbsz:4 abid:12
    s_nop 4
    v_cvt_pk_bf16_f32 v246, v212, v212
    ds_write_b16 v240, v246
    s_branch L_store
.section .rodata,"a"
.p2align 6
.amdhsa_kernel standalone__sequential_behavior_din__recsys_kernel
  .amdhsa_next_free_vgpr 256
  .amdhsa_next_free_sgpr 102
  .amdhsa_accum_offset 256
  .amdhsa_group_segment_fixed_size 0
  .amdhsa_kernarg_size 80
  .amdhsa_user_sgpr_count 2
  .amdhsa_user_sgpr_kernarg_segment_ptr 1
  .amdhsa_system_sgpr_workgroup_id_x 1
.end_amdhsa_kernel
```

```asm
; @launch grid=(256,1,1) block=(512,1,1) lds=163840
.amdgcn_target "amdgcn-amd-amdhsa--gfx950"
.text
.globl standalone__sequential_behavior_din__recsys_kernel
.p2align 8
.type standalone__sequential_behavior_din__recsys_kernel,@function
standalone__sequential_behavior_din__recsys_kernel:
    s_load_dwordx16 s[4:19], s[0:1], 0
    s_cmp_ge_u32 s2, 256
    s_cbranch_scc1 L_end
    v_lshrrev_b32 v1, 6, v0
    v_and_b32 v0, 63, v0
    v_readfirstlane_b32 s54, v1
    s_lshl_b32 s53, s2, 3
    v_lshlrev_b32 v2, 4, v0
    v_lshrrev_b32 v1, 4, v0
    v_and_b32 v3, 0xf0, v2
    v_lshlrev_b32 v3, 2, v3
    v_lshl_add_u32 v130, v1, 4, v3
    v_bfrev_b32 v3, 1
    s_add_u32 s53, s53, s54
    s_movk_i32 s66, 800
    v_cmp_gt_u32 vcc, s66, v130
    s_mul_i32 s93, s53, 800
    s_mul_i32 s52, s54, 20480
    s_mov_b64 s[28:29], vcc
    v_cndmask_b32 v3, v3, v130, vcc
    v_and_b32 v248, 16, v0
    v_lshlrev_b32 v246, 1, v248
    v_xor_b32 v246, v246, v2
    v_and_b32 v243, 0xf0, v2
    v_lshl_add_u32 v243, v1, 19, v243
    s_lshl_b32 s66, s53, 8
    v_add_u32 v243, s66, v243
    s_lshl_b32 s67, s54, 12
    s_add_u32 m0, s52, 8320
    s_mov_b32 s26, 6553600
    s_mov_b32 s27, 0x20000
    s_waitcnt lgkmcnt(0)
    s_mov_b32 s24, s8
    s_and_b32 s25, s9, 0xffff
    s_cmp_ge_u32 s54, 4
    s_cbranch_scc1 L_young0
    buffer_load_dwordx4 v[100:103], v3, s[24:27], s93 offen nt
L_young0:
    global_load_lds_dwordx4 v243, s[4:5] nt
    s_add_u32 m0, s52, 4160
    s_add_u32 s10, s10, s67
    s_addc_u32 s11, s11, 0
    v_xor_b32 v247, 64, v246
    global_load_lds_dwordx4 v246, s[10:11] offset:0
    global_load_lds_dwordx4 v247, s[10:11] offset:1024
    global_load_lds_dwordx4 v246, s[10:11] offset:2048
    global_load_lds_dwordx4 v247, s[10:11] offset:3072
    s_load_dword s30, s[16:17], 0
    s_and_b32 s67, s54, 3
    v_and_b32 v250, 3, v0
    s_mov_b32 s20, s6
    s_and_b32 s21, s7, 0xffff
    s_or_b32 s21, s21, 0x800000
    s_mov_b32 s22, 200
    s_mov_b32 s23, 0x20000
    s_sub_u32 s40, s20, 1056
    s_subb_u32 s41, s21, 0
    s_mov_b32 s42, 200
    s_mov_b32 s43, 0x20000
    s_mul_i32 s35, s53, 51200
    s_movk_i32 s31, 25600
    s_mov_b32 s60, 3
    s_mov_b64 s[56:57], 0
    v_mov_b32 v148, -1
    v_mov_b32 v149, -1
    v_mov_b32 v150, -1
    v_mov_b32 v151, -1
    s_add_u32 s66, s52, 18432
    v_add_u32 v152, s66, v2
    ds_write_b128 v152, v[148:151]
    ds_write_b128 v152, v[148:151] offset:1024
    s_add_u32 s64, s52, 18448
    v_mov_b32 v153, -1
    v_mov_b32 v154, -1
    v_mov_b32 v155, -1
    v_lshrrev_b32 v237, 3, v0
    v_add_u32 v237, s64, v237
    v_lshl_add_u32 v244, v1, 2, s66
    v_and_b32 v231, 0x70, v2
    v_lshlrev_b32 v248, 2, v248
    v_xor_b32 v231, v231, v248
    v_mov_b32 v233, v231
    s_movk_i32 s66, 400
    v_cmp_le_u32 vcc, s66, v130
    v_lshrrev_b32 v126, 1, v130
    s_movk_i32 s66, -200
    v_cndmask_b32 v130, 0, 1, vcc
    v_mad_i32_i24 v126, v130, s66, v126
    v_mul_u32_u24 v127, 0x10001, v126
    v_add_u32 v126, 0x10000, v127
    v_add_u32 v128, 0x50004, v127
    v_add_u32 v129, 0x70006, v127
    v_add_u32 v127, 0x30002, v127
    v_mov_b32 v131, 0xbfe0bfe0
    s_mov_b32 s86, 0xfff0ffff
    s_mov_b32 s87, 0xf000ff00
    s_mov_b32 s88, 0xff00fff0
    s_mov_b32 s89, 0xf000
    s_mov_b32 s90, 0xf0000f
    s_mov_b32 s91, 0xf0000f00
    s_mov_b32 s84, 0x11111113
    s_mov_b32 s85, 0x11111111
    v_cndmask_b32 v116, 0, v131, s[86:87]
    v_cndmask_b32 v120, 0, v131, s[88:89]
    v_cndmask_b32 v117, 0, v131, s[86:87]
    v_cndmask_b32 v121, 0, v131, s[88:89]
    v_cndmask_b32 v122, 0, v131, s[84:85]
    v_cndmask_b32 v123, 0, v131, s[84:85]
    v_cndmask_b32 v124, 0, v131, s[84:85]
    v_cndmask_b32 v125, 0, v131, s[84:85]
    v_lshlrev_b32 v246, 4, v250
    v_sub_u32 v246, 48, v246
    s_mov_b32 s86, 0xbfe0bfe0
    s_mov_b32 s87, 0xf0bfe0
    v_lshrrev_b64 v[118:119], v246, s[86:87]
    v_mov_b32 v131, 0
    s_mov_b64 s[84:85], 0
    v_cndmask_b32 v118, v120, v118, s[90:91]
    v_cndmask_b32 v119, v121, v119, s[90:91]
    s_mov_b32 s61, 7
    s_mov_b32 s92, 0xbfb8aa3b
    v_and_b32 v251, 15, v0
    v_bfe_u32 v252, v0, 2, 2
    v_lshlrev_b32 v253, 3, v250
    v_lshl_add_u32 v253, v252, 7, v253
    v_and_b32 v246, 24, v0
    v_lshlrev_b32 v246, 2, v246
    v_xor_b32 v246, v253, v246
    v_lshl_add_u32 v246, v1, 10, v246
    s_lshl_b32 s66, s67, 5
    v_xor_b32 v66, s66, v246
    v_add_u32 v66, 45120, v66
    s_lshr_b32 s66, s54, 1
    s_lshl_b32 s66, s66, 5
    v_xor_b32 v64, s66, v246
    s_and_b32 s66, s54, 1
    s_mul_i32 s66, s66, 20480
    s_add_u32 s66, s66, 4160
    v_add_u32 v64, s66, v64
    v_add_u32 v65, 81920, v64
    s_and_b32 s66, s54, 4
    v_lshrrev_b32 v246, 3, v251
    v_add_u32 v246, s66, v246
    v_mul_u32_u24 v246, 20480, v246
    v_lshl_add_u32 v246, v1, 4, v246
    v_and_b32 v247, 7, v0
    v_lshl_add_u32 v67, v247, 7, v246
    v_and_b32 v247, 1, v0
    v_lshlrev_b32 v247, 4, v247
    v_lshlrev_b32 v247, v247, 1
    v_cmp_gt_u32 vcc, 2, v250
    v_mov_b32 v229, 0
    v_mov_b32 v228, 0x3f80
    v_cndmask_b32 v241, 0, v247, vcc
    v_cmp_eq_u32 vcc, 0, v251
    v_sub_u32 v242, v247, v241
    v_mul_u32_u24 v218, 0x3f80, v241
    v_cndmask_b32 v220, 0, -1, vcc
    v_mul_u32_u24 v219, 0x3f80, v242
    s_and_b32 s66, s54, 3
    s_lshl_b32 s66, s66, 6
    s_add_u32 s66, s66, 9344
    v_and_b32 v247, 7, v0
    v_mul_u32_u24 v247, 144, v247
    v_add3_u32 v98, v67, v247, s66
    s_add_u32 s66, s52, 14592
    v_lshl_add_u32 v221, v0, 2, s66
    ds_write_b32 v221, v229
    s_xor_b32 s66, s54, 4
    s_mul_i32 s66, s66, 20480
    s_add_u32 s66, s66, 14592
    v_writelane_b32 v221, s66, 1
    v_add_u32 v222, s52, v2
    s_mov_b64 exec, 15
    ds_write_b32 v222, v229 offset:14848
    s_mov_b64 exec, -1
    v_and_b32 v247, 8, v0
    v_lshlrev_b32 v247, 2, v247
    v_lshl_add_u32 v247, v251, 7, v247
    v_add_u32 v247, s52, v247
    v_and_b32 v248, 2, v0
    v_lshlrev_b32 v248, 1, v248
    v_xor_b32 v248, v248, v1
    v_lshl_add_u32 v234, v248, 4, v247
    v_xor_b32 v248, 4, v248
    v_lshl_add_u32 v235, v248, 4, v247
    v_and_b32 v247, 8, v0
    v_lshlrev_b32 v247, 3, v247
    v_lshl_add_u32 v248, v1, 5, v253
    v_xor_b32 v248, v248, v247
    v_add_u32 v236, s52, v248
    s_add_u32 s66, s52, 8320
    v_lshl_add_u32 v238, v250, 1, s66
    v_lshl_add_u32 v238, v1, 4, v238
    s_add_u32 s66, s52, 14912
    v_lshl_add_u32 v240, v0, 1, s66
    s_add_u32 s66, s52, 9344
    v_lshl_add_u32 v239, v1, 4, s66
    v_mov_b32 v188, 0
    v_mov_b32 v189, 0
    v_mov_b32 v190, 0
    v_mov_b32 v191, 0
    v_mov_b32 v192, 0
    v_mov_b32 v193, 0
    v_mov_b32 v194, 0
    v_mov_b32 v195, 0
    v_mov_b32 v208, 0
    v_mov_b32 v212, 0
    v_mov_b32 v209, 0
    v_mov_b32 v213, 0
    v_mov_b32 v210, 0
    v_mov_b32 v214, 0
    v_mov_b32 v211, 0
    v_mov_b32 v215, 0
    s_and_b32 s66, s54, 3
    s_lshl_b32 s66, s66, 5
    v_lshl_add_u32 v249, v1, 3, s66
    global_load_dwordx2 v[96:97], v249, s[12:13]
    s_cmp_ge_u32 s54, 4
    s_cbranch_scc0 L_old3z
    buffer_load_dwordx4 v[100:103], v3, s[24:27], s93 offen nt
L_old3z:
    s_cmp_ge_u32 s54, 4
    s_cbranch_scc1 L_young1
    s_waitcnt vmcnt(6) lgkmcnt(0)
    s_call_b64 s[62:63], L_fp
    s_waitcnt vmcnt(5)
    s_branch L_old1
L_young1:
    s_waitcnt vmcnt(2)
L_old1:
    s_waitcnt lgkmcnt(0)
    s_barrier
    ds_read_b64_tr_b16 v[16:17], v66 offset:0
    ds_read_b64_tr_b16 v[18:19], v66 offset:512
    ds_read_b64_tr_b16 v[20:21], v66 offset:20480
    ds_read_b64_tr_b16 v[22:23], v66 offset:20992
    ds_read_b64_tr_b16 v[24:25], v66 offset:40960
    ds_read_b64_tr_b16 v[26:27], v66 offset:41472
    ds_read_b64_tr_b16 v[28:29], v66 offset:61440
    ds_read_b64_tr_b16 v[30:31], v66 offset:61952
    ds_read_b128 v[32:35], v67 offset:8320
    ds_read_b128 v[36:39], v67 offset:8384
    ds_read_b128 v[40:43], v67 offset:49280
    ds_read_b128 v[44:47], v67 offset:49344
    ds_read_b64_tr_b16 v[4:5], v64 offset:0
    ds_read_b64_tr_b16 v[8:9], v65 offset:0
    ds_read_b64_tr_b16 v[12:13], v65 offset:40960
    ds_read_b64_tr_b16 v[6:7], v64 offset:512
    ds_read_b64_tr_b16 v[10:11], v65 offset:512
    ds_read_b64_tr_b16 v[14:15], v65 offset:41472
    s_cmp_ge_u32 s54, 4
    s_cbranch_scc1 L_young2
    s_waitcnt vmcnt(4)
    s_branch L_old2
L_young2:
    s_waitcnt vmcnt(1)
L_old2:
    s_add_u32 s93, s93, 1638400
    buffer_load_dwordx4 v[104:107], v3, s[24:27], s93 offen nt
    s_add_u32 s93, s93, 1638400
    buffer_load_dwordx4 v[108:111], v3, s[24:27], s93 offen nt
    s_add_u32 s93, s93, 1638400
    buffer_load_dwordx4 v[112:115], v3, s[24:27], s93 offen nt
    v_lshlrev_b32 v249, 3, v1
    v_lshl_add_u32 v249, v250, 5, v249
    global_load_dwordx2 v[216:217], v249, s[14:15]
    v_lshlrev_b32 v48, 16, v96
    v_and_b32 v49, 0xffff0000, v96
    v_lshlrev_b32 v50, 16, v97
    v_and_b32 v51, 0xffff0000, v97
    s_lshl_b32 s30, s30, 16
    v_and_b32 v204, s30, v220
    v_and_b32 v205, s30, v220
    v_and_b32 v206, s30, v220
    v_and_b32 v207, s30, v220
    s_waitcnt lgkmcnt(0)
    v_xor_b32 v24, 0x80008000, v24
    v_xor_b32 v25, 0x80008000, v25
    v_xor_b32 v26, 0x80008000, v26
    v_xor_b32 v27, 0x80008000, v27
    v_xor_b32 v28, 0x80008000, v28
    v_xor_b32 v29, 0x80008000, v29
    v_xor_b32 v30, 0x80008000, v30
    v_xor_b32 v31, 0x80008000, v31
    v_mfma_f32_4x4x4_16b_bf16 v[56:59], v[218:219], v[4:5], 0
    v_mfma_f32_4x4x4_16b_bf16 v[68:71], v[218:219], v[12:13], 0
    v_mfma_f32_4x4x4_16b_bf16 v[60:63], v[218:219], v[6:7], 0
    v_mfma_f32_4x4x4_16b_bf16 v[72:75], v[218:219], v[14:15], 0
    v_mfma_f32_4x4x4_16b_bf16 v[56:59], v[218:219], v[8:9], v[56:59]
    v_mfma_f32_4x4x4_16b_bf16 v[60:63], v[218:219], v[10:11], v[60:63]
    v_mfma_f32_16x16x32_bf16 v[52:55], v[16:19], v[40:43], v[48:51]
    v_mfma_f32_16x16x32_bf16 v[52:55], v[20:23], v[44:47], v[52:55]
    v_mfma_f32_16x16x32_bf16 v[52:55], v[24:27], v[40:43], v[52:55]
    v_mfma_f32_16x16x32_bf16 v[52:55], v[28:31], v[44:47], v[52:55]
    v_mfma_f32_16x16x32_bf16 v[48:51], v[16:19], v[32:35], v[48:51]
    v_mfma_f32_16x16x32_bf16 v[48:51], v[20:23], v[36:39], v[48:51]
    v_mfma_f32_16x16x32_bf16 v[48:51], v[24:27], v[32:35], v[48:51]
    v_mfma_f32_16x16x32_bf16 v[48:51], v[28:31], v[36:39], v[48:51]
    v_mul_f32 v56, s92, v56
    v_mul_f32 v57, s92, v57
    v_mul_f32 v58, s92, v58
    v_mul_f32 v59, s92, v59
    v_mul_f32 v60, s92, v60
    v_mul_f32 v61, s92, v61
    v_mul_f32 v62, s92, v62
    v_mul_f32 v63, s92, v63
    v_mul_f32 v68, s92, v68
    v_mul_f32 v69, s92, v69
    v_mul_f32 v70, s92, v70
    v_mul_f32 v71, s92, v71
    v_mul_f32 v72, s92, v72
    v_mul_f32 v73, s92, v73
    v_mul_f32 v74, s92, v74
    v_mul_f32 v75, s92, v75
    s_add_u32 s66, s52, 11520
    v_add_u32 v3, s66, v2
    v_cvt_pk_bf16_f32 v68, v68, v69
    v_cvt_pk_bf16_f32 v69, v70, v71
    v_cvt_pk_bf16_f32 v70, v72, v73
    v_cvt_pk_bf16_f32 v71, v74, v75
    v_mul_f32 v48, s92, v48
    v_mul_f32 v49, s92, v49
    v_mul_f32 v50, s92, v50
    v_mul_f32 v51, s92, v51
    v_mul_f32 v52, s92, v52
    v_mul_f32 v53, s92, v53
    v_mul_f32 v54, s92, v54
    v_mul_f32 v55, s92, v55
    ds_write_b128 v3, v[56:59]
    ds_write_b128 v3, v[60:63] offset:1024
    ds_write_b128 v3, v[68:71] offset:2048
    ds_write_b128 v98, v[48:51]
    ds_write_b128 v98, v[52:55] offset:40960
    v_add_u32 v3, 11520, v2
    v_add_u32 v246, 81920, v3
    s_waitcnt lgkmcnt(0)
    s_barrier
    s_cmp_ge_u32 s54, 4
    s_cbranch_scc0 L_old3
    s_waitcnt vmcnt(4)
    s_call_b64 s[62:63], L_fp
    s_branch L_yng3
L_old3:
    s_call_b64 s[62:63], L_t23
L_yng3:
    ds_read_b128 v[4:7], v3 offset:0
    ds_read_b128 v[8:11], v3 offset:1024
    ds_read_b128 v[68:71], v3 offset:2048
    ds_read_b128 v[12:15], v3 offset:20480
    ds_read_b128 v[16:19], v3 offset:21504
    ds_read_b128 v[72:75], v3 offset:22528
    ds_read_b128 v[20:23], v3 offset:40960
    ds_read_b128 v[24:27], v3 offset:41984
    ds_read_b128 v[76:79], v3 offset:43008
    s_waitcnt vmcnt(4)
    v_mfma_i32_16x16x64_i8 v[172:175], v[122:125], v[104:107], 0
    v_mfma_i32_16x16x64_i8 v[176:179], v[122:125], v[108:111], 0
    v_mfma_i32_16x16x64_i8 v[180:183], v[122:125], v[112:115], 0
    v_and_b32 v160, 0x800080, v104
    v_mul_u32_u24 v160, 0x7f, v160
    v_bitop3_b32 v131, v104, v160, v131 bitop3:0xbe
    v_and_b32 v161, 0x800080, v105
    v_mul_u32_u24 v161, 0x7f, v161
    v_bitop3_b32 v131, v105, v161, v131 bitop3:0xbe
    v_and_b32 v160, 0x800080, v106
    v_mul_u32_u24 v160, 0x7f, v160
    v_bitop3_b32 v131, v106, v160, v131 bitop3:0xbe
    v_mov_b32_dpp v184, v172 row_shr:1 row_mask:0xf bank_mask:0xf bound_ctrl:0
    v_mov_b32_dpp v185, v176 row_shr:1 row_mask:0xf bank_mask:0xf bound_ctrl:0
    v_mov_b32_dpp v186, v180 row_shr:1 row_mask:0xf bank_mask:0xf bound_ctrl:0
    v_add_u32_dpp v184, v184, v184 row_shr:1 row_mask:0xf bank_mask:0xf bound_ctrl:0
    v_add_u32_dpp v185, v185, v185 row_shr:1 row_mask:0xf bank_mask:0xf bound_ctrl:0
    v_add_u32_dpp v186, v186, v186 row_shr:1 row_mask:0xf bank_mask:0xf bound_ctrl:0
    v_add_u32_dpp v184, v184, v184 row_shr:2 row_mask:0xf bank_mask:0xf bound_ctrl:0
    v_add_u32_dpp v185, v185, v185 row_shr:2 row_mask:0xf bank_mask:0xf bound_ctrl:0
    v_add_u32_dpp v186, v186, v186 row_shr:2 row_mask:0xf bank_mask:0xf bound_ctrl:0
    v_add_u32_dpp v184, v184, v184 row_shr:4 row_mask:0xf bank_mask:0xf bound_ctrl:0
    v_add_u32_dpp v185, v185, v185 row_shr:4 row_mask:0xf bank_mask:0xf bound_ctrl:0
    v_add_u32_dpp v186, v186, v186 row_shr:4 row_mask:0xf bank_mask:0xf bound_ctrl:0
    v_add_u32_dpp v184, v184, v184 row_shr:8 row_mask:0xf bank_mask:0xf bound_ctrl:0
    v_add_u32_dpp v185, v185, v185 row_shr:8 row_mask:0xf bank_mask:0xf bound_ctrl:0
    v_add_u32_dpp v186, v186, v186 row_shr:8 row_mask:0xf bank_mask:0xf bound_ctrl:0
    ds_read_b128 v[28:31], v3 offset:61440
    ds_read_b128 v[32:35], v3 offset:62464
    ds_read_b128 v[80:83], v3 offset:63488
    ds_read_b128 v[36:39], v246 offset:0
    ds_read_b128 v[40:43], v246 offset:1024
    ds_read_b128 v[84:87], v246 offset:2048
    v_and_b32 v161, 0x800080, v107
    v_mul_u32_u24 v161, 0x7f, v161
    v_bitop3_b32 v131, v107, v161, v131 bitop3:0xbe
    v_and_b32 v160, 0x800080, v108
    v_mul_u32_u24 v160, 0x7f, v160
    v_bitop3_b32 v131, v108, v160, v131 bitop3:0xbe
    v_and_b32 v161, 0x800080, v109
    v_mul_u32_u24 v161, 0x7f, v161
    v_bitop3_b32 v131, v109, v161, v131 bitop3:0xbe
    v_and_b32 v160, 0x800080, v110
    v_mul_u32_u24 v160, 0x7f, v160
    v_bitop3_b32 v131, v110, v160, v131 bitop3:0xbe
    v_and_b32 v161, 0x800080, v111
    v_mul_u32_u24 v161, 0x7f, v161
    v_bitop3_b32 v131, v111, v161, v131 bitop3:0xbe
    v_and_b32 v160, 0x800080, v112
    v_mul_u32_u24 v160, 0x7f, v160
    v_bitop3_b32 v131, v112, v160, v131 bitop3:0xbe
    v_and_b32 v161, 0x800080, v113
    v_mul_u32_u24 v161, 0x7f, v161
    v_bitop3_b32 v131, v113, v161, v131 bitop3:0xbe
    v_and_b32 v160, 0x800080, v114
    v_mul_u32_u24 v160, 0x7f, v160
    v_bitop3_b32 v131, v114, v160, v131 bitop3:0xbe
    v_and_b32 v161, 0x800080, v115
    v_mul_u32_u24 v161, 0x7f, v161
    v_bitop3_b32 v131, v115, v161, v131 bitop3:0xbe
    v_cmp_ne_u32 vcc, 0, v131
    v_readlane_b32 s68, v184, 6
    v_readlane_b32 s69, v173, 6
    v_readlane_b32 s70, v184, 15
    v_readlane_b32 s72, v185, 6
    v_readlane_b32 s73, v177, 6
    v_readlane_b32 s74, v185, 15
    v_readlane_b32 s76, v186, 6
    v_readlane_b32 s77, v181, 6
    v_readlane_b32 s78, v186, 15
    s_cbranch_vccnz L_general
    s_add_u32 s66, s68, s69
    s_add_u32 s66, s66, s64
    s_add_u32 s67, s66, 15
    s_and_b32 s67, s67, -16
    s_add_u32 s55, s64, 16
    s_max_u32 s67, s67, s55
    s_sub_u32 s66, s67, s66
    v_mad_u32_u24 v184, v130, s66, v184
    s_sub_u32 s55, s64, 2048
    v_add_u32 v172, s55, v184
    v_add_u32 v173, s55, v184
    v_add_u32 v174, s55, v184
    v_add_u32 v175, s55, v184
    s_add_u32 s64, s64, s70
    s_add_u32 s64, s64, s66
    v_mfma_i32_16x16x64_i8 v[132:135], v[118:121], v[104:107], v[172:175]
    v_mfma_i32_16x16x64_i8 v[136:139], v[116:119], v[104:107], v[172:175]
    s_add_u32 s64, s64, 15
    s_and_b32 s64, s64, -16
    s_add_u32 s55, s67, 16
    s_max_u32 s64, s64, s55
    s_lshr_b32 s95, s67, 4
    s_bitset1_b64 s[56:57], s95
    s_lshr_b32 s95, s64, 4
    s_bitset1_b64 s[56:57], s95
    s_mov_b32 s44, s64
    s_add_u32 s66, s72, s73
    s_add_u32 s66, s66, s64
    s_add_u32 s67, s66, 15
    s_and_b32 s67, s67, -16
    s_add_u32 s55, s64, 16
    s_max_u32 s67, s67, s55
    s_sub_u32 s66, s67, s66
    v_mad_u32_u24 v185, v130, s66, v185
    s_sub_u32 s55, s64, 2048
    v_add_u32 v176, s55, v185
    v_add_u32 v177, s55, v185
    v_add_u32 v178, s55, v185
    v_add_u32 v179, s55, v185
    s_add_u32 s64, s64, s74
    s_add_u32 s64, s64, s66
    v_mfma_i32_16x16x64_i8 v[140:143], v[118:121], v[108:111], v[176:179]
    v_mfma_i32_16x16x64_i8 v[144:147], v[116:119], v[108:111], v[176:179]
    s_add_u32 s64, s64, 15
    s_and_b32 s64, s64, -16
    s_add_u32 s55, s67, 16
    s_max_u32 s64, s64, s55
    s_mov_b32 s45, s67
    s_mov_b32 s46, s64
    ds_write_b8 v132, v126
    ds_write_b8_d16_hi v133, v126
    ds_write_b8 v134, v127
    ds_write_b8_d16_hi v135, v127
    ds_write_b8 v136, v128
    ds_write_b8_d16_hi v137, v128
    ds_write_b8 v138, v129
    ds_write_b8_d16_hi v139, v129
    s_add_u32 s66, s76, s77
    s_add_u32 s66, s66, s64
    s_add_u32 s67, s66, 15
    s_and_b32 s67, s67, -16
    s_add_u32 s55, s64, 16
    s_max_u32 s67, s67, s55
    s_sub_u32 s66, s67, s66
    v_mad_u32_u24 v186, v130, s66, v186
    s_sub_u32 s55, s64, 2048
    v_add_u32 v180, s55, v186
    v_add_u32 v181, s55, v186
    v_add_u32 v182, s55, v186
    v_add_u32 v183, s55, v186
    s_add_u32 s64, s64, s78
    s_add_u32 s64, s64, s66
    v_mfma_i32_16x16x64_i8 v[164:167], v[118:121], v[112:115], v[180:183]
    v_mfma_i32_16x16x64_i8 v[168:171], v[116:119], v[112:115], v[180:183]
    s_add_u32 s64, s64, 15
    s_and_b32 s64, s64, -16
    s_add_u32 s55, s67, 16
    s_max_u32 s64, s64, s55
    s_mov_b32 s47, s67
    s_mov_b32 s48, s64
    ds_write_b8 v140, v126
    ds_write_b8_d16_hi v141, v126
    ds_write_b8 v142, v127
    ds_write_b8_d16_hi v143, v127
    ds_write_b8 v144, v128
    ds_write_b8_d16_hi v145, v128
    ds_write_b8 v146, v129
    ds_write_b8_d16_hi v147, v129
    ds_read_b128 v[44:47], v246 offset:20480
    ds_read_b128 v[48:51], v246 offset:21504
    ds_read_b128 v[88:91], v246 offset:22528
    ds_read_b128 v[52:55], v246 offset:40960
    ds_read_b128 v[56:59], v246 offset:41984
    ds_read_b128 v[92:95], v246 offset:43008
    ds_read_b128 v[60:63], v246 offset:61440
    ds_read_b128 v[64:67], v246 offset:62464
    ds_read_b128 v[96:99], v246 offset:63488
    ds_read_u16 v224, v238 offset:0
    ds_read_u16 v225, v238 offset:8
    ds_read_u16 v226, v238 offset:64
    ds_read_u16 v227, v238 offset:72
    ds_write_b8 v164, v126
    ds_write_b8_d16_hi v165, v126
    ds_write_b8 v166, v127
    ds_write_b8_d16_hi v167, v127
    ds_write_b8 v168, v128
    ds_write_b8_d16_hi v169, v128
    ds_write_b8 v170, v129
    ds_write_b8_d16_hi v171, v129
    s_cmp_ge_u32 s54, 4
    s_cbranch_scc0 L_old3b
    s_call_b64 s[62:63], L_t23
L_old3b:
L_listed:
    s_and_b32 s55, s84, 0x40000000
    s_or_b32 s55, s55, s54
    s_bitset1_b32 s55, 31
    s_and_b32 s66, s74, 0x1ff
    s_lshl_b32 s66, s66, 3
    s_or_b32 s66, s66, s55
    s_and_b32 s67, s78, 0x1ff
    s_lshl_b32 s67, s67, 3
    s_or_b32 s67, s67, s55
    v_mov_b32 v132, s66
    v_mov_b32 v133, s44
    v_mov_b32 v134, s45
    v_mov_b32 v135, s46
    v_writelane_b32 v132, s67, 1
    v_writelane_b32 v133, s46, 1
    v_writelane_b32 v134, s47, 1
    v_writelane_b32 v135, s48, 1
    s_mov_b64 exec, 3
    ds_write_b128 v222, v[132:135] offset:14848
    s_mov_b64 exec, -1
    s_sub_u32 s68, s46, s44
    s_sub_u32 s69, s48, s46
    s_lshl_b32 s50, s54, 3
    s_mov_b32 s51, 0
    s_mov_b32 s33, 0
    s_sub_u32 s66, s64, s52
    s_sub_u32 s66, s66, 18448
    s_lshr_b32 s66, s66, 3
    s_lshr_b32 s67, s54, 2
    s_mul_i32 s67, s67, 2
    s_add_u32 s66, s66, s67
    s_sub_u32 s67, 0, s66
    v_mov_b32 v2, v221
    v_mov_b32 v1, s66
    v_mov_b32 v3, -8
    v_writelane_b32 v1, s67, 1
    v_writelane_b32 v3, 8, 1
    ds_add_u32 v2, v1
    v_bfrev_b32 v245, -2
    v_writelane_b32 v245, 0, 0
    s_cmp_eq_u32 s94, 1
    s_cbranch_scc1 L_nolate
    ds_read_u8 v148, v237 offset:0
    ds_read_u8 v149, v237 offset:8
    ds_read_u8 v150, v237 offset:16
    ds_read_u8 v151, v237 offset:24
    ds_read_u8 v152, v237 offset:32
    ds_read_u8 v153, v237 offset:40
    ds_read_u8 v154, v237 offset:48
    ds_read_u8 v155, v237 offset:56
    s_waitcnt lgkmcnt(0)
    s_add_u32 m0, s52, 0
    v_mov_b32 v230, v148
    v_mov_b32 v232, v149
    buffer_load_dwordx4 v[230:231], s[20:23], s35 idxen offen nt lds
    buffer_load_dwordx4 v[232:233], s[40:43], s35 idxen offen offset:1056 nt lds
    s_bitcmp0_b64 s[56:57], 2
    s_cbranch_scc1 L_noadvl1
    s_add_u32 s35, s35, s31
    s_min_u32 s35, s35, 419404800
    s_xor_b32 s31, s31, 0x63ff800
    s_sub_u32 s60, s60, 1
L_noadvl1:
    s_add_u32 m0, s52, 2080
    v_mov_b32 v230, v150
    v_mov_b32 v232, v151
    buffer_load_dwordx4 v[230:231], s[20:23], s35 idxen offen nt lds
    buffer_load_dwordx4 v[232:233], s[40:43], s35 idxen offen offset:1056 nt lds
    s_bitcmp0_b64 s[56:57], 3
    s_cbranch_scc1 L_noadvl2
    s_add_u32 s35, s35, s31
    s_min_u32 s35, s35, 419404800
    s_xor_b32 s31, s31, 0x63ff800
    s_sub_u32 s60, s60, 1
L_noadvl2:
    s_add_u32 m0, s52, 4160
    v_mov_b32 v230, v152
    v_mov_b32 v232, v153
    buffer_load_dwordx4 v[230:231], s[20:23], s35 idxen offen nt lds
    buffer_load_dwordx4 v[232:233], s[40:43], s35 idxen offen offset:1056 nt lds
    s_bitcmp0_b64 s[56:57], 4
    s_cbranch_scc1 L_noadvl3
    s_add_u32 s35, s35, s31
    s_min_u32 s35, s35, 419404800
    s_xor_b32 s31, s31, 0x63ff800
    s_sub_u32 s60, s60, 1
L_noadvl3:
    s_add_u32 m0, s52, 6240
    v_mov_b32 v230, v154
    v_mov_b32 v232, v155
    buffer_load_dwordx4 v[230:231], s[20:23], s35 idxen offen nt lds
    buffer_load_dwordx4 v[232:233], s[40:43], s35 idxen offen offset:1056 nt lds
L_nolate:
    v_and_b32_dpp v196, v216, v220 quad_perm:[0,0,0,0] row_mask:0xf bank_mask:0xf
    v_and_b32_dpp v197, v217, v220 quad_perm:[0,0,0,0] row_mask:0xf bank_mask:0xf
    v_and_b32_dpp v198, v216, v220 quad_perm:[1,1,1,1] row_mask:0xf bank_mask:0xf
    v_and_b32_dpp v199, v217, v220 quad_perm:[1,1,1,1] row_mask:0xf bank_mask:0xf
    v_and_b32_dpp v200, v216, v220 quad_perm:[2,2,2,2] row_mask:0xf bank_mask:0xf
    v_and_b32_dpp v201, v217, v220 quad_perm:[2,2,2,2] row_mask:0xf bank_mask:0xf
    v_and_b32_dpp v202, v216, v220 quad_perm:[3,3,3,3] row_mask:0xf bank_mask:0xf
    v_and_b32_dpp v203, v217, v220 quad_perm:[3,3,3,3] row_mask:0xf bank_mask:0xf
    s_waitcnt vmcnt(6) lgkmcnt(0)
    ds_read_b128 v[180:183], v234 offset:0
    ds_read_b128 v[184:187], v235 offset:0
    v_mul_u32_u24 v216, v224, v241
    v_mul_u32_u24 v217, v224, v242
    v_mul_u32_u24 v218, v225, v241
    v_mul_u32_u24 v219, v225, v242
    v_mul_u32_u24 v220, v226, v241
    v_mul_u32_u24 v221, v226, v242
    v_mul_u32_u24 v222, v227, v241
    v_mul_u32_u24 v223, v227, v242
    v_mfma_f32_4x4x4_16b_bf16 v[140:143], v[216:217], v[68:69], v[4:7]
    v_add_u32 v238, 128, v238
    ds_read_b128 v[164:167], v239 offset:0
    ds_read_b128 v[168:171], v239 offset:64
    v_mfma_f32_4x4x4_16b_bf16 v[144:147], v[218:219], v[70:71], v[8:11]
    ds_read_b128 v[172:175], v239 offset:128
    ds_read_b128 v[176:179], v239 offset:192
    ds_read_u16 v224, v238 offset:0
    ds_read_u16 v225, v238 offset:8
    ds_read_u16 v226, v238 offset:64
    ds_read_u16 v227, v238 offset:72
    v_mfma_f32_4x4x4_16b_bf16 v[246:249], v[220:221], v[72:73], v[12:15]
    v_cvt_pk_bf16_f32 v100, v140, v141
    v_cvt_pk_bf16_f32 v101, v142, v143
    v_mfma_f32_4x4x4_16b_bf16 v[250:253], v[222:223], v[74:75], v[16:19]
    v_cvt_pk_bf16_f32 v102, v144, v145
    v_cvt_pk_bf16_f32 v103, v146, v147
    v_mfma_f32_4x4x4_16b_bf16 v[140:143], v[216:217], v[76:77], v[20:23]
    v_cvt_pk_bf16_f32 v104, v246, v247
    v_cvt_pk_bf16_f32 v105, v248, v249
    v_mfma_f32_4x4x4_16b_bf16 v[144:147], v[218:219], v[78:79], v[24:27]
    v_cvt_pk_bf16_f32 v106, v250, v251
    v_cvt_pk_bf16_f32 v107, v252, v253
    v_mfma_f32_4x4x4_16b_bf16 v[246:249], v[220:221], v[80:81], v[28:31]
    v_cvt_pk_bf16_f32 v108, v140, v141
    v_cvt_pk_bf16_f32 v109, v142, v143
    v_mfma_f32_4x4x4_16b_bf16 v[250:253], v[222:223], v[82:83], v[32:35]
    v_cvt_pk_bf16_f32 v110, v144, v145
    v_cvt_pk_bf16_f32 v111, v146, v147
    v_mfma_f32_4x4x4_16b_bf16 v[140:143], v[216:217], v[84:85], v[36:39]
    v_cvt_pk_bf16_f32 v112, v246, v247
    v_cvt_pk_bf16_f32 v113, v248, v249
    v_mfma_f32_4x4x4_16b_bf16 v[144:147], v[218:219], v[86:87], v[40:43]
    v_cvt_pk_bf16_f32 v114, v250, v251
    v_cvt_pk_bf16_f32 v115, v252, v253
    v_mfma_f32_4x4x4_16b_bf16 v[246:249], v[220:221], v[88:89], v[44:47]
    v_cvt_pk_bf16_f32 v116, v140, v141
    v_cvt_pk_bf16_f32 v117, v142, v143
    v_mfma_f32_4x4x4_16b_bf16 v[250:253], v[222:223], v[90:91], v[48:51]
    v_cvt_pk_bf16_f32 v118, v144, v145
    v_cvt_pk_bf16_f32 v119, v146, v147
    v_mfma_f32_4x4x4_16b_bf16 v[140:143], v[216:217], v[92:93], v[52:55]
    v_cvt_pk_bf16_f32 v120, v246, v247
    v_cvt_pk_bf16_f32 v121, v248, v249
    v_mfma_f32_4x4x4_16b_bf16 v[144:147], v[218:219], v[94:95], v[56:59]
    v_cvt_pk_bf16_f32 v122, v250, v251
    v_cvt_pk_bf16_f32 v123, v252, v253
    v_mfma_f32_4x4x4_16b_bf16 v[246:249], v[220:221], v[96:97], v[60:63]
    v_cvt_pk_bf16_f32 v124, v140, v141
    v_cvt_pk_bf16_f32 v125, v142, v143
    v_mfma_f32_4x4x4_16b_bf16 v[250:253], v[222:223], v[98:99], v[64:67]
    v_cvt_pk_bf16_f32 v126, v144, v145
    v_cvt_pk_bf16_f32 v127, v146, v147
    v_cvt_pk_bf16_f32 v128, v246, v247
    v_cvt_pk_bf16_f32 v129, v248, v249
    v_add_u32 v239, 272, v239
    v_cvt_pk_bf16_f32 v130, v250, v251
    v_cvt_pk_bf16_f32 v131, v252, v253
    s_waitcnt lgkmcnt(0)
    v_mfma_f32_16x16x32_bf16 v[148:151], v[100:103], v[180:183], v[164:167]
    v_mfma_f32_16x16x32_bf16 v[148:151], v[104:107], v[184:187], v[148:151]
    v_mfma_f32_16x16x32_bf16 v[152:155], v[108:111], v[180:183], v[168:171]
    v_mfma_f32_16x16x32_bf16 v[152:155], v[112:115], v[184:187], v[152:155]
    v_mfma_f32_16x16x32_bf16 v[156:159], v[116:119], v[180:183], v[172:175]
    v_mfma_f32_16x16x32_bf16 v[156:159], v[120:123], v[184:187], v[156:159]
    v_mfma_f32_16x16x32_bf16 v[160:163], v[124:127], v[180:183], v[176:179]
    v_mfma_f32_16x16x32_bf16 v[160:163], v[128:131], v[184:187], v[160:163]
    v_mov_b32 v136, 0
    v_mov_b32 v137, 0
    v_mov_b32 v138, 0
    v_mov_b32 v139, 0
    s_lshr_b64 s[86:87], s[56:57], 2
    s_lshr_b64 s[36:37], s[56:57], 5
    s_or_b32 s37, s36, s86
    s_or_b32 s36, s37, s56
    s_cmp_lg_u64 s[84:85], 0
    s_cbranch_scc0 Lf_mid
    s_mul_i32 s66, s53, 800
    s_add_u32 s8, s8, s66
    s_addc_u32 s9, s9, 0
    s_mov_b32 s24, s8
    s_and_b32 s25, s9, 0xffff
    s_mov_b32 s26, 400
    s_mov_b32 s27, 0x20000
    s_movk_i32 s32, 400
    s_branch Ls_mid
L_fp:
    v_mfma_i32_16x16x64_i8 v[172:175], v[122:125], v[100:103], 0
    v_and_b32 v160, 0x800080, v100
    v_mul_u32_u24 v160, 0x7f, v160
    v_bitop3_b32 v131, v100, v160, v131 bitop3:0xbe
    v_and_b32 v161, 0x800080, v101
    v_mul_u32_u24 v161, 0x7f, v161
    v_bitop3_b32 v131, v101, v161, v131 bitop3:0xbe
    v_and_b32 v160, 0x800080, v102
    v_mul_u32_u24 v160, 0x7f, v160
    v_mov_b32_dpp v184, v172 row_shr:1 row_mask:0xf bank_mask:0xf bound_ctrl:0
    v_bitop3_b32 v131, v102, v160, v131 bitop3:0xbe
    s_nop 0
    v_add_u32_dpp v184, v184, v184 row_shr:1 row_mask:0xf bank_mask:0xf bound_ctrl:0
    v_and_b32 v161, 0x800080, v103
    s_nop 0
    v_add_u32_dpp v184, v184, v184 row_shr:2 row_mask:0xf bank_mask:0xf bound_ctrl:0
    v_mul_u32_u24 v161, 0x7f, v161
    s_nop 0
    v_add_u32_dpp v184, v184, v184 row_shr:4 row_mask:0xf bank_mask:0xf bound_ctrl:0
    v_bitop3_b32 v131, v103, v161, v131 bitop3:0xbe
    s_nop 0
    v_add_u32_dpp v184, v184, v184 row_shr:8 row_mask:0xf bank_mask:0xf bound_ctrl:0
    v_cmp_ne_u32 vcc, 0, v131
    v_readlane_b32 s68, v184, 6
    v_readlane_b32 s69, v173, 6
    v_readlane_b32 s70, v184, 15
    s_mov_b32 s94, 0
    s_cbranch_vccnz L_late
    s_add_u32 s66, s68, s69
    s_add_u32 s66, s66, s64
    s_add_u32 s67, s66, 15
    s_and_b32 s67, s67, -16
    s_add_u32 s55, s64, 16
    s_max_u32 s67, s67, s55
    s_sub_u32 s66, s67, s66
    v_mad_u32_u24 v184, v130, s66, v184
    s_sub_u32 s55, s64, 2048
    v_add_u32 v172, s55, v184
    v_add_u32 v173, s55, v184
    v_add_u32 v174, s55, v184
    v_add_u32 v175, s55, v184
    s_add_u32 s64, s64, s70
    s_add_u32 s64, s64, s66
    v_mfma_i32_16x16x64_i8 v[132:135], v[118:121], v[100:103], v[172:175]
    v_mfma_i32_16x16x64_i8 v[136:139], v[116:119], v[100:103], v[172:175]
    s_add_u32 s64, s64, 15
    s_and_b32 s64, s64, -16
    s_add_u32 s55, s67, 16
    s_max_u32 s64, s64, s55
    s_lshr_b32 s95, s67, 4
    s_bitset1_b64 s[56:57], s95
    s_lshr_b32 s95, s64, 4
    s_bitset1_b64 s[56:57], s95
    s_add_u32 s66, s52, 18512
    s_cmp_ge_u32 s64, s66
    ds_write_b8 v132, v126
    ds_write_b8_d16_hi v133, v126
    ds_write_b8 v134, v127
    ds_write_b8_d16_hi v135, v127
    ds_write_b8 v136, v128
    ds_write_b8_d16_hi v137, v128
    ds_write_b8 v138, v129
    ds_write_b8_d16_hi v139, v129
    s_cbranch_scc0 L_late
    s_mov_b32 s94, 1
    ds_read_u8 v148, v237 offset:0
    ds_read_u8 v149, v237 offset:8
    ds_read_u8 v150, v237 offset:16
    ds_read_u8 v151, v237 offset:24
    ds_read_u8 v152, v237 offset:32
    ds_read_u8 v153, v237 offset:40
    ds_read_u8 v154, v237 offset:48
    ds_read_u8 v155, v237 offset:56
    s_waitcnt lgkmcnt(0)
    s_add_u32 m0, s52, 0
    v_mov_b32 v230, v148
    v_mov_b32 v232, v149
    buffer_load_dwordx4 v[230:231], s[20:23], s35 idxen offen nt lds
    buffer_load_dwordx4 v[232:233], s[40:43], s35 idxen offen offset:1056 nt lds
    s_bitcmp0_b64 s[56:57], 2
    s_cbranch_scc1 L_noadve1
    s_add_u32 s35, s35, s31
    s_min_u32 s35, s35, 419404800
    s_xor_b32 s31, s31, 0x63ff800
    s_sub_u32 s60, s60, 1
L_noadve1:
    s_add_u32 m0, s52, 2080
    v_mov_b32 v230, v150
    v_mov_b32 v232, v151
    buffer_load_dwordx4 v[230:231], s[20:23], s35 idxen offen nt lds
    buffer_load_dwordx4 v[232:233], s[40:43], s35 idxen offen offset:1056 nt lds
    s_setpc_b64 s[62:63]
L_late:
    s_waitcnt vmcnt(0)
    s_setpc_b64 s[62:63]
L_swap:
    v_lshrrev_b32 v140, 3, v0
    v_and_b32 v141, 7, v0
    v_mul_u32_u24 v140, 20480, v140
    v_mul_u32_u24 v141, 20480, v141
    v_add_u32 v140, s51, v140
    v_add_u32 v141, s51, v141
    v_mov_b32 v143, 1
    s_mov_b64 exec, 1
    ds_add_rtn_u32 v143, v140, v143 offset:14880
    s_mov_b64 exec, -1
L_swap_poll:
    ds_read_b32 v142, v141 offset:14848
    ds_read_b128 v[144:147], v140 offset:14848
    v_and_b32 v248, 56, v0
    s_waitcnt lgkmcnt(0)
    v_cmp_le_i32 vcc, 0, v142
    v_cmp_gt_u32 s[86:87], v142, v144
    v_lshlrev_b32 v249, 1, v142
    v_readfirstlane_b32 s66, v143
    s_cbranch_vccnz L_swap_poll
    v_lshrrev_b64 v[246:247], v248, s[86:87]
    v_cmp_gt_i32 s[88:89], 0, v249
    v_and_b32 v246, 0xff, v246
    v_bcnt_u32_b32 v246, v246, 0
    v_cmp_eq_u32 vcc, s66, v246
    s_lshl_b32 s67, s54, 3
    s_ff1_i32_b64 s66, vcc
    s_cmp_lg_u64 s[88:89], 0
    s_cselect_b32 s66, s67, s66
    s_sub_u32 s95, s66, s50
    s_mov_b32 s50, s66
    s_sub_u32 s83, s66, s67
    v_readlane_b32 s67, v146, s66
    v_readlane_b32 s55, v147, s66
    v_readlane_b32 s66, v145, s66
    s_mul_i32 s81, s95, 2560
    s_mul_i32 s95, s95, 6400
    s_add_u32 s35, s35, s95
    s_sub_u32 s95, s66, s44
    v_add_u32 v237, s95, v237
    s_mov_b32 s44, s55
    s_sub_u32 s67, s67, s66
    s_sub_u32 s55, s55, s66
    s_sub_u32 s95, s55, s68
    s_lshr_b32 s67, s67, 4
    s_add_u32 s67, s67, s49
    s_bitset1_b64 s[56:57], s67
    s_lshr_b32 s55, s55, 4
    s_add_u32 s55, s55, s49
    s_bitset1_b64 s[56:57], s55
    s_lshr_b64 s[86:87], s[56:57], 2
    s_lshr_b64 s[36:37], s[56:57], 5
    s_or_b32 s37, s36, s86
    s_or_b32 s36, s37, s56
    s_ashr_i32 s95, s95, 3
    v_mov_b32 v140, s95
    s_sub_u32 s95, 0, s95
    v_writelane_b32 v140, s95, 1
    ds_add_u32 v2, v140
    s_cmp_eq_u32 s51, 0
    s_cselect_b32 s80, s81, s80
    s_cselect_b32 s82, s83, s82
    s_cselect_b32 s60, 1, 8
    s_cselect_b32 s66, 4, 2
    s_mov_b32 s68, s69
    s_mov_b32 s51, 16
    s_cmp_eq_u32 s61, s66
    s_cbranch_scc1 L_swap_now
    s_sub_u32 s66, s66, 1
    s_bitset1_b32 s33, s66
    s_setpc_b64 s[62:63]
L_swap_now:
    v_add_u32 v238, s81, v238
    v_add_u32 v239, s81, v239
    ds_read_u16 v224, v238 offset:0
    ds_read_u16 v225, v238 offset:8
    ds_read_u16 v226, v238 offset:64
    ds_read_u16 v227, v238 offset:72
    s_setpc_b64 s[62:63]
L_t23:
    s_cmp_eq_u32 s94, 0
    s_cbranch_scc1 L_skip23
    s_bitcmp0_b64 s[56:57], 3
    s_cbranch_scc1 L_noadve2
    s_add_u32 s35, s35, s31
    s_min_u32 s35, s35, 419404800
    s_xor_b32 s31, s31, 0x63ff800
    s_sub_u32 s60, s60, 1
L_noadve2:
    s_add_u32 m0, s52, 4160
    v_mov_b32 v230, v152
    v_mov_b32 v232, v153
    buffer_load_dwordx4 v[230:231], s[20:23], s35 idxen offen nt lds
    buffer_load_dwordx4 v[232:233], s[40:43], s35 idxen offen offset:1056 nt lds
    s_bitcmp0_b64 s[56:57], 4
    s_cbranch_scc1 L_noadve3
    s_add_u32 s35, s35, s31
    s_min_u32 s35, s35, 419404800
    s_xor_b32 s31, s31, 0x63ff800
    s_sub_u32 s60, s60, 1
L_noadve3:
    s_add_u32 m0, s52, 6240
    v_mov_b32 v230, v154
    v_mov_b32 v232, v155
    buffer_load_dwordx4 v[230:231], s[20:23], s35 idxen offen nt lds
    buffer_load_dwordx4 v[232:233], s[40:43], s35 idxen offen offset:1056 nt lds
    s_setpc_b64 s[62:63]
L_skip23:
    s_waitcnt vmcnt(0)
    s_setpc_b64 s[62:63]
.p2align 6
Lf_loop:
Lf_mid:
    s_bitcmp1_b32 s36, 0
    s_cbranch_scc1 Lf_ev0
Lf_evd0:
    v_mfma_f32_16x16x32_bf16 v[208:211], v[136:139], v[200:203], v[208:211]
    v_exp_f32 v132, v148
    v_exp_f32 v133, v149
    v_exp_f32 v134, v150
    v_exp_f32 v135, v151
    v_exp_f32 v136, v152
    v_exp_f32 v137, v153
    v_mfma_f32_4x4x4_16b_bf16 v[132:135], v[228:229], v[228:229], v[132:135]
    v_exp_f32 v138, v154
    v_exp_f32 v139, v155
    v_cvt_pk_bf16_f32 v208, v208, v209
    v_cvt_pk_bf16_f32 v209, v210, v211
    v_exp_f32 v140, v156
    v_exp_f32 v141, v157
    v_mfma_f32_4x4x4_16b_bf16 v[212:215], v[208:209], v[188:189], v[212:215] cbsz:4 abid:0
    v_mfma_f32_4x4x4_16b_bf16 v[136:139], v[228:229], v[228:229], v[136:139]
    v_exp_f32 v142, v158
    v_mfma_f32_4x4x4_16b_bf16 v[212:215], v[208:209], v[190:191], v[212:215] cbsz:4 abid:4
    v_exp_f32 v143, v159
    v_exp_f32 v144, v160
    v_mfma_f32_4x4x4_16b_bf16 v[212:215], v[208:209], v[192:193], v[212:215] cbsz:4 abid:8
    v_exp_f32 v145, v161
    v_mfma_f32_4x4x4_16b_bf16 v[140:143], v[228:229], v[228:229], v[140:143]
    v_mfma_f32_4x4x4_16b_bf16 v[212:215], v[208:209], v[194:195], v[212:215] cbsz:4 abid:12
    ds_add_rtn_u32 v1, v2, v3
    ds_read_u8 v230, v237 offset:64
    ds_read_u8 v232, v237 offset:72
    ds_read_b64_tr_b16 v[188:189], v236 offset:0
    ds_read_b64_tr_b16 v[190:191], v236 offset:512
    ds_read_b64_tr_b16 v[192:193], v236 offset:1056
    ds_read_b64_tr_b16 v[194:195], v236 offset:1568
    s_waitcnt vmcnt(4)
    ds_read_b128 v[180:183], v234 offset:2080
    ds_read_b128 v[184:187], v235 offset:2080
    s_add_u32 m0, s52, 0
    v_exp_f32 v146, v162
    v_exp_f32 v147, v163
    v_rcp_f32 v132, v132
    v_rcp_f32 v133, v133
    v_mfma_f32_4x4x4_16b_bf16 v[144:147], v[228:229], v[228:229], v[144:147]
    v_rcp_f32 v134, v134
    v_cvt_pk_bf16_f32 v132, v132, v133
    s_waitcnt lgkmcnt(0)
    v_mfma_f32_16x16x32_bf16 v[148:151], v[100:103], v[180:183], v[164:167]
    v_rcp_f32 v135, v135
    v_mfma_f32_16x16x32_bf16 v[152:155], v[108:111], v[180:183], v[168:171]
    v_rcp_f32 v136, v136
    v_cvt_pk_bf16_f32 v133, v134, v135
    v_mfma_f32_16x16x32_bf16 v[148:151], v[104:107], v[184:187], v[148:151]
    v_rcp_f32 v137, v137
    v_cmp_gt_i32 vcc, v1, v245
    s_setprio 0
    s_cbranch_vccz Lf_lo0
    s_setprio 1
Lf_lo0:
    v_mfma_f32_16x16x32_bf16 v[152:155], v[112:115], v[184:187], v[152:155]
    v_rcp_f32 v138, v138
    v_cvt_pk_bf16_f32 v134, v136, v137
    v_mfma_f32_16x16x32_bf16 v[156:159], v[116:119], v[180:183], v[172:175]
    v_rcp_f32 v139, v139
    v_mfma_f32_16x16x32_bf16 v[160:163], v[124:127], v[180:183], v[176:179]
    v_rcp_f32 v140, v140
    v_cvt_pk_bf16_f32 v135, v138, v139
    v_mfma_f32_16x16x32_bf16 v[156:159], v[120:123], v[184:187], v[156:159]
    v_rcp_f32 v141, v141
    v_mfma_f32_16x16x32_bf16 v[160:163], v[128:131], v[184:187], v[160:163]
    v_rcp_f32 v142, v142
    v_cvt_pk_bf16_f32 v136, v140, v141
    v_mfma_f32_16x16x32_bf16 v[208:211], v[132:135], v[196:199], v[204:207]
    v_rcp_f32 v143, v143
    v_rcp_f32 v144, v144
    v_cvt_pk_bf16_f32 v137, v142, v143
    v_rcp_f32 v145, v145
    v_rcp_f32 v146, v146
    v_rcp_f32 v147, v147
    v_cvt_pk_bf16_f32 v138, v144, v145
    v_cvt_pk_bf16_f32 v139, v146, v147
    buffer_load_dwordx4 v[230:231], s[20:23], s35 idxen offen nt lds
    buffer_load_dwordx4 v[232:233], s[40:43], s35 idxen offen offset:1056 nt lds
    s_bitcmp1_b32 s36, 1
    s_cbranch_scc1 Lf_ev1
Lf_evd1:
    v_mfma_f32_16x16x32_bf16 v[208:211], v[136:139], v[200:203], v[208:211]
    v_exp_f32 v132, v148
    v_exp_f32 v133, v149
    v_exp_f32 v134, v150
    v_exp_f32 v135, v151
    v_exp_f32 v136, v152
    v_exp_f32 v137, v153
    v_mfma_f32_4x4x4_16b_bf16 v[132:135], v[228:229], v[228:229], v[132:135]
    v_exp_f32 v138, v154
    v_exp_f32 v139, v155
    v_cvt_pk_bf16_f32 v208, v208, v209
    v_cvt_pk_bf16_f32 v209, v210, v211
    v_exp_f32 v140, v156
    v_exp_f32 v141, v157
    v_mfma_f32_4x4x4_16b_bf16 v[212:215], v[208:209], v[188:189], v[212:215] cbsz:4 abid:0
    v_mfma_f32_4x4x4_16b_bf16 v[136:139], v[228:229], v[228:229], v[136:139]
    v_exp_f32 v142, v158
    v_mfma_f32_4x4x4_16b_bf16 v[212:215], v[208:209], v[190:191], v[212:215] cbsz:4 abid:4
    v_exp_f32 v143, v159
    v_exp_f32 v144, v160
    v_mfma_f32_4x4x4_16b_bf16 v[212:215], v[208:209], v[192:193], v[212:215] cbsz:4 abid:8
    v_exp_f32 v145, v161
    v_mfma_f32_4x4x4_16b_bf16 v[140:143], v[228:229], v[228:229], v[140:143]
    v_mfma_f32_4x4x4_16b_bf16 v[212:215], v[208:209], v[194:195], v[212:215] cbsz:4 abid:12
    ds_read_u8 v230, v237 offset:80
    ds_read_u8 v232, v237 offset:88
    ds_read_b64_tr_b16 v[188:189], v236 offset:2080
    ds_read_b64_tr_b16 v[190:191], v236 offset:2592
    ds_read_b64_tr_b16 v[192:193], v236 offset:3136
    ds_read_b64_tr_b16 v[194:195], v236 offset:3648
    s_waitcnt vmcnt(4)
    ds_read_b128 v[180:183], v234 offset:4160
    ds_read_b128 v[184:187], v235 offset:4160
    s_add_u32 m0, s52, 2080
    v_exp_f32 v146, v162
    v_exp_f32 v147, v163
    v_rcp_f32 v132, v132
    v_rcp_f32 v133, v133
    v_mfma_f32_4x4x4_16b_bf16 v[144:147], v[228:229], v[228:229], v[144:147]
    v_rcp_f32 v134, v134
    v_cvt_pk_bf16_f32 v132, v132, v133
    s_waitcnt lgkmcnt(0)
    v_mfma_f32_16x16x32_bf16 v[148:151], v[100:103], v[180:183], v[164:167]
    v_rcp_f32 v135, v135
    v_mfma_f32_16x16x32_bf16 v[152:155], v[108:111], v[180:183], v[168:171]
    v_rcp_f32 v136, v136
    v_cvt_pk_bf16_f32 v133, v134, v135
    v_mfma_f32_16x16x32_bf16 v[148:151], v[104:107], v[184:187], v[148:151]
    v_rcp_f32 v137, v137
    v_mfma_f32_16x16x32_bf16 v[152:155], v[112:115], v[184:187], v[152:155]
    v_rcp_f32 v138, v138
    v_cvt_pk_bf16_f32 v134, v136, v137
    v_mfma_f32_16x16x32_bf16 v[156:159], v[116:119], v[180:183], v[172:175]
    v_rcp_f32 v139, v139
    v_mfma_f32_16x16x32_bf16 v[160:163], v[124:127], v[180:183], v[176:179]
    v_rcp_f32 v140, v140
    v_cvt_pk_bf16_f32 v135, v138, v139
    v_mfma_f32_16x16x32_bf16 v[156:159], v[120:123], v[184:187], v[156:159]
    v_rcp_f32 v141, v141
    v_mfma_f32_16x16x32_bf16 v[160:163], v[128:131], v[184:187], v[160:163]
    v_rcp_f32 v142, v142
    v_cvt_pk_bf16_f32 v136, v140, v141
    v_mfma_f32_16x16x32_bf16 v[208:211], v[132:135], v[196:199], v[204:207]
    v_rcp_f32 v143, v143
    v_rcp_f32 v144, v144
    v_cvt_pk_bf16_f32 v137, v142, v143
    v_rcp_f32 v145, v145
    v_rcp_f32 v146, v146
    v_rcp_f32 v147, v147
    v_cvt_pk_bf16_f32 v138, v144, v145
    v_cvt_pk_bf16_f32 v139, v146, v147
    buffer_load_dwordx4 v[230:231], s[20:23], s35 idxen offen nt lds
    buffer_load_dwordx4 v[232:233], s[40:43], s35 idxen offen offset:1056 nt lds
    s_bitcmp1_b32 s36, 2
    s_cbranch_scc1 Lf_ev2
Lf_evd2:
    v_mfma_f32_16x16x32_bf16 v[208:211], v[136:139], v[200:203], v[208:211]
    v_exp_f32 v132, v148
    v_exp_f32 v133, v149
    v_exp_f32 v134, v150
    v_exp_f32 v135, v151
    v_exp_f32 v136, v152
    v_exp_f32 v137, v153
    v_mfma_f32_4x4x4_16b_bf16 v[132:135], v[228:229], v[228:229], v[132:135]
    v_exp_f32 v138, v154
    v_exp_f32 v139, v155
    v_cvt_pk_bf16_f32 v208, v208, v209
    v_cvt_pk_bf16_f32 v209, v210, v211
    v_exp_f32 v140, v156
    v_exp_f32 v141, v157
    v_mfma_f32_4x4x4_16b_bf16 v[212:215], v[208:209], v[188:189], v[212:215] cbsz:4 abid:0
    v_mfma_f32_4x4x4_16b_bf16 v[136:139], v[228:229], v[228:229], v[136:139]
    v_exp_f32 v142, v158
    v_mfma_f32_4x4x4_16b_bf16 v[212:215], v[208:209], v[190:191], v[212:215] cbsz:4 abid:4
    v_exp_f32 v143, v159
    v_exp_f32 v144, v160
    v_mfma_f32_4x4x4_16b_bf16 v[212:215], v[208:209], v[192:193], v[212:215] cbsz:4 abid:8
    v_exp_f32 v145, v161
    v_mfma_f32_4x4x4_16b_bf16 v[140:143], v[228:229], v[228:229], v[140:143]
    v_mfma_f32_4x4x4_16b_bf16 v[212:215], v[208:209], v[194:195], v[212:215] cbsz:4 abid:12
    ds_read_u8 v230, v237 offset:96
    ds_read_u8 v232, v237 offset:104
    ds_read_b64_tr_b16 v[188:189], v236 offset:4160
    ds_read_b64_tr_b16 v[190:191], v236 offset:4672
    ds_read_b64_tr_b16 v[192:193], v236 offset:5216
    ds_read_b64_tr_b16 v[194:195], v236 offset:5728
    s_waitcnt vmcnt(4)
    ds_read_b128 v[180:183], v234 offset:6240
    ds_read_b128 v[184:187], v235 offset:6240
    s_add_u32 m0, s52, 4160
    v_exp_f32 v146, v162
    v_exp_f32 v147, v163
    v_rcp_f32 v132, v132
    v_rcp_f32 v133, v133
    v_mfma_f32_4x4x4_16b_bf16 v[144:147], v[228:229], v[228:229], v[144:147]
    v_rcp_f32 v134, v134
    v_cvt_pk_bf16_f32 v132, v132, v133
    s_waitcnt lgkmcnt(0)
    v_mfma_f32_16x16x32_bf16 v[148:151], v[100:103], v[180:183], v[164:167]
    v_rcp_f32 v135, v135
    v_mfma_f32_16x16x32_bf16 v[152:155], v[108:111], v[180:183], v[168:171]
    v_rcp_f32 v136, v136
    v_cvt_pk_bf16_f32 v133, v134, v135
    v_mfma_f32_16x16x32_bf16 v[148:151], v[104:107], v[184:187], v[148:151]
    v_rcp_f32 v137, v137
    v_mfma_f32_16x16x32_bf16 v[152:155], v[112:115], v[184:187], v[152:155]
    v_rcp_f32 v138, v138
    v_cvt_pk_bf16_f32 v134, v136, v137
    v_mfma_f32_16x16x32_bf16 v[156:159], v[116:119], v[180:183], v[172:175]
    v_rcp_f32 v139, v139
    v_mfma_f32_16x16x32_bf16 v[160:163], v[124:127], v[180:183], v[176:179]
    v_rcp_f32 v140, v140
    v_cvt_pk_bf16_f32 v135, v138, v139
    v_mfma_f32_16x16x32_bf16 v[156:159], v[120:123], v[184:187], v[156:159]
    v_rcp_f32 v141, v141
    v_mfma_f32_16x16x32_bf16 v[160:163], v[128:131], v[184:187], v[160:163]
    v_rcp_f32 v142, v142
    v_cvt_pk_bf16_f32 v136, v140, v141
    v_mfma_f32_16x16x32_bf16 v[208:211], v[132:135], v[196:199], v[204:207]
    v_rcp_f32 v143, v143
    v_rcp_f32 v144, v144
    v_cvt_pk_bf16_f32 v137, v142, v143
    v_rcp_f32 v145, v145
    v_rcp_f32 v146, v146
    v_rcp_f32 v147, v147
    v_cvt_pk_bf16_f32 v138, v144, v145
    v_cvt_pk_bf16_f32 v139, v146, v147
    buffer_load_dwordx4 v[230:231], s[20:23], s35 idxen offen nt lds
    buffer_load_dwordx4 v[232:233], s[40:43], s35 idxen offen offset:1056 nt lds
    s_bitcmp1_b32 s36, 3
    s_cbranch_scc1 Lf_ev3
Lf_evd3:
    v_mfma_f32_16x16x32_bf16 v[208:211], v[136:139], v[200:203], v[208:211]
    v_exp_f32 v132, v148
    v_exp_f32 v133, v149
    v_exp_f32 v134, v150
    v_exp_f32 v135, v151
    v_exp_f32 v136, v152
    v_exp_f32 v137, v153
    v_mfma_f32_4x4x4_16b_bf16 v[132:135], v[228:229], v[228:229], v[132:135]
    v_exp_f32 v138, v154
    v_exp_f32 v139, v155
    v_cvt_pk_bf16_f32 v208, v208, v209
    v_cvt_pk_bf16_f32 v209, v210, v211
    v_exp_f32 v140, v156
    v_exp_f32 v141, v157
    v_mfma_f32_4x4x4_16b_bf16 v[212:215], v[208:209], v[188:189], v[212:215] cbsz:4 abid:0
    v_mfma_f32_4x4x4_16b_bf16 v[136:139], v[228:229], v[228:229], v[136:139]
    v_exp_f32 v142, v158
    v_mfma_f32_4x4x4_16b_bf16 v[212:215], v[208:209], v[190:191], v[212:215] cbsz:4 abid:4
    v_exp_f32 v143, v159
    v_exp_f32 v144, v160
    v_mfma_f32_4x4x4_16b_bf16 v[212:215], v[208:209], v[192:193], v[212:215] cbsz:4 abid:8
    v_exp_f32 v145, v161
    v_mfma_f32_4x4x4_16b_bf16 v[140:143], v[228:229], v[228:229], v[140:143]
    v_mfma_f32_4x4x4_16b_bf16 v[212:215], v[208:209], v[194:195], v[212:215] cbsz:4 abid:12
    ds_read_u8 v230, v237 offset:112
    ds_read_u8 v232, v237 offset:120
    ds_read_b64_tr_b16 v[188:189], v236 offset:6240
    ds_read_b64_tr_b16 v[190:191], v236 offset:6752
    ds_read_b64_tr_b16 v[192:193], v236 offset:7296
    ds_read_b64_tr_b16 v[194:195], v236 offset:7808
    s_waitcnt vmcnt(4)
    ds_read_b128 v[180:183], v234 offset:0
    ds_read_b128 v[184:187], v235 offset:0
    s_add_u32 m0, s52, 6240
    v_exp_f32 v146, v162
    v_exp_f32 v147, v163
    v_rcp_f32 v132, v132
    v_rcp_f32 v133, v133
    v_mfma_f32_4x4x4_16b_bf16 v[144:147], v[228:229], v[228:229], v[144:147]
    v_rcp_f32 v134, v134
    v_cvt_pk_bf16_f32 v132, v132, v133
    s_waitcnt lgkmcnt(0)
    v_mfma_f32_16x16x32_bf16 v[148:151], v[100:103], v[180:183], v[164:167]
    v_rcp_f32 v135, v135
    v_mfma_f32_16x16x32_bf16 v[152:155], v[108:111], v[180:183], v[168:171]
    v_rcp_f32 v136, v136
    v_cvt_pk_bf16_f32 v133, v134, v135
    v_mfma_f32_16x16x32_bf16 v[148:151], v[104:107], v[184:187], v[148:151]
    v_rcp_f32 v137, v137
    v_mfma_f32_16x16x32_bf16 v[152:155], v[112:115], v[184:187], v[152:155]
    v_rcp_f32 v138, v138
    v_cvt_pk_bf16_f32 v134, v136, v137
    v_mfma_f32_16x16x32_bf16 v[156:159], v[116:119], v[180:183], v[172:175]
    v_rcp_f32 v139, v139
    v_mfma_f32_16x16x32_bf16 v[160:163], v[124:127], v[180:183], v[176:179]
    v_rcp_f32 v140, v140
    v_cvt_pk_bf16_f32 v135, v138, v139
    v_mfma_f32_16x16x32_bf16 v[156:159], v[120:123], v[184:187], v[156:159]
    v_rcp_f32 v141, v141
    v_mfma_f32_16x16x32_bf16 v[160:163], v[128:131], v[184:187], v[160:163]
    v_rcp_f32 v142, v142
    v_cvt_pk_bf16_f32 v136, v140, v141
    v_mfma_f32_16x16x32_bf16 v[208:211], v[132:135], v[196:199], v[204:207]
    v_rcp_f32 v143, v143
    v_rcp_f32 v144, v144
    v_cvt_pk_bf16_f32 v137, v142, v143
    s_lshr_b64 s[56:57], s[56:57], 4
    s_lshr_b64 s[86:87], s[56:57], 2
    s_lshr_b64 s[36:37], s[56:57], 5
    s_or_b32 s37, s36, s86
    s_or_b32 s36, s37, s56
    v_add_u32 v237, 64, v237
    v_rcp_f32 v145, v145
    v_rcp_f32 v146, v146
    v_rcp_f32 v147, v147
    v_cvt_pk_bf16_f32 v138, v144, v145
    v_cvt_pk_bf16_f32 v139, v146, v147
    buffer_load_dwordx4 v[230:231], s[20:23], s35 idxen offen nt lds
    buffer_load_dwordx4 v[232:233], s[40:43], s35 idxen offen offset:1056 nt lds
    s_branch Lf_loop
Lf_fl0:
    v_cvt_pk_bf16_f32 v246, v212, v212
    v_mov_b32 v212, 0
    ds_write_b16 v240, v246
    v_add_u32 v240, 128, v240
    s_bitcmp0_b32 s37, 0
    s_cbranch_scc1 Lf_evd0
    s_branch Lf_ev20
Lf_ev0:
    s_bitcmp1_b64 s[56:57], 0
    s_cbranch_scc1 Lf_fl0
Lf_ev20:
    s_bitcmp1_b64 s[56:57], 2
    s_cbranch_scc1 Lf_w0
    s_sub_u32 s60, s60, 1
    s_cbranch_scc0 Lf_nsa0
    s_mov_b32 s49, 5
    s_call_b64 s[62:63], L_swap
Lf_nsa0:
    s_add_u32 s35, s35, s31
    s_min_u32 s35, s35, 419404800
    s_xor_b32 s31, s31, 0x63ff800
    s_branch Lf_evd0
Lf_w0:
    s_bitcmp0_b64 s[56:57], 5
    s_cbranch_scc1 Lf_e10
    s_sub_u32 s60, s60, 1
    s_cbranch_scc0 Lf_nsb0
    s_mov_b32 s49, 5
    s_call_b64 s[62:63], L_swap
    s_waitcnt lgkmcnt(0)
Lf_nsb0:
    s_add_u32 s35, s35, s31
    s_min_u32 s35, s35, 419404800
    s_xor_b32 s31, s31, 0x63ff800
Lf_e10:
    s_sub_u32 s61, s61, 1
    s_cbranch_scc1 Lf_last0
    s_bitcmp0_b32 s33, s61
    s_cbranch_scc1 Lf_nw0
    s_cmp_eq_u32 s61, 3
    s_cselect_b32 s66, s80, s81
    v_add_u32 v238, s66, v238
    v_add_u32 v239, s66, v239
    ds_read_u16 v224, v238 offset:0
    ds_read_u16 v225, v238 offset:8
    ds_read_u16 v226, v238 offset:64
    ds_read_u16 v227, v238 offset:72
    s_waitcnt lgkmcnt(0)
Lf_nw0:
    v_mul_u32_u24 v216, v224, v241
    v_mul_u32_u24 v217, v224, v242
    v_mul_u32_u24 v218, v225, v241
    v_mul_u32_u24 v219, v225, v242
    v_mul_u32_u24 v220, v226, v241
    v_mul_u32_u24 v221, v226, v242
    v_mul_u32_u24 v222, v227, v241
    v_mul_u32_u24 v223, v227, v242
    v_mfma_f32_4x4x4_16b_bf16 v[140:143], v[216:217], v[68:69], v[4:7]
    v_add_u32 v238, 128, v238
    ds_read_b128 v[164:167], v239 offset:0
    ds_read_b128 v[168:171], v239 offset:64
    v_mfma_f32_4x4x4_16b_bf16 v[144:147], v[218:219], v[70:71], v[8:11]
    ds_read_b128 v[172:175], v239 offset:128
    ds_read_b128 v[176:179], v239 offset:192
    ds_read_u16 v224, v238 offset:0
    ds_read_u16 v225, v238 offset:8
    ds_read_u16 v226, v238 offset:64
    ds_read_u16 v227, v238 offset:72
    v_mfma_f32_4x4x4_16b_bf16 v[246:249], v[220:221], v[72:73], v[12:15]
    v_cvt_pk_bf16_f32 v100, v140, v141
    v_cvt_pk_bf16_f32 v101, v142, v143
    v_mfma_f32_4x4x4_16b_bf16 v[250:253], v[222:223], v[74:75], v[16:19]
    v_cvt_pk_bf16_f32 v102, v144, v145
    v_cvt_pk_bf16_f32 v103, v146, v147
    v_mfma_f32_4x4x4_16b_bf16 v[140:143], v[216:217], v[76:77], v[20:23]
    v_cvt_pk_bf16_f32 v104, v246, v247
    v_cvt_pk_bf16_f32 v105, v248, v249
    v_mfma_f32_4x4x4_16b_bf16 v[144:147], v[218:219], v[78:79], v[24:27]
    v_cvt_pk_bf16_f32 v106, v250, v251
    v_cvt_pk_bf16_f32 v107, v252, v253
    v_mfma_f32_4x4x4_16b_bf16 v[246:249], v[220:221], v[80:81], v[28:31]
    v_cvt_pk_bf16_f32 v108, v140, v141
    v_cvt_pk_bf16_f32 v109, v142, v143
    v_mfma_f32_4x4x4_16b_bf16 v[250:253], v[222:223], v[82:83], v[32:35]
    v_cvt_pk_bf16_f32 v110, v144, v145
    v_cvt_pk_bf16_f32 v111, v146, v147
    v_mfma_f32_4x4x4_16b_bf16 v[140:143], v[216:217], v[84:85], v[36:39]
    v_cvt_pk_bf16_f32 v112, v246, v247
    v_cvt_pk_bf16_f32 v113, v248, v249
    v_mfma_f32_4x4x4_16b_bf16 v[144:147], v[218:219], v[86:87], v[40:43]
    v_cvt_pk_bf16_f32 v114, v250, v251
    v_cvt_pk_bf16_f32 v115, v252, v253
    v_mfma_f32_4x4x4_16b_bf16 v[246:249], v[220:221], v[88:89], v[44:47]
    v_cvt_pk_bf16_f32 v116, v140, v141
    v_cvt_pk_bf16_f32 v117, v142, v143
    v_mfma_f32_4x4x4_16b_bf16 v[250:253], v[222:223], v[90:91], v[48:51]
    v_cvt_pk_bf16_f32 v118, v144, v145
    v_cvt_pk_bf16_f32 v119, v146, v147
    v_mfma_f32_4x4x4_16b_bf16 v[140:143], v[216:217], v[92:93], v[52:55]
    v_cvt_pk_bf16_f32 v120, v246, v247
    v_cvt_pk_bf16_f32 v121, v248, v249
    v_mfma_f32_4x4x4_16b_bf16 v[144:147], v[218:219], v[94:95], v[56:59]
    v_cvt_pk_bf16_f32 v122, v250, v251
    v_cvt_pk_bf16_f32 v123, v252, v253
    v_mfma_f32_4x4x4_16b_bf16 v[246:249], v[220:221], v[96:97], v[60:63]
    v_cvt_pk_bf16_f32 v124, v140, v141
    v_cvt_pk_bf16_f32 v125, v142, v143
    v_mfma_f32_4x4x4_16b_bf16 v[250:253], v[222:223], v[98:99], v[64:67]
    v_cvt_pk_bf16_f32 v126, v144, v145
    v_cvt_pk_bf16_f32 v127, v146, v147
    v_cvt_pk_bf16_f32 v128, v246, v247
    v_cvt_pk_bf16_f32 v129, v248, v249
    v_add_u32 v239, 272, v239
    v_cvt_pk_bf16_f32 v130, v250, v251
    v_cvt_pk_bf16_f32 v131, v252, v253
    s_waitcnt lgkmcnt(0)
    s_branch Lf_evd0
Lf_fl1:
    v_cvt_pk_bf16_f32 v246, v212, v212
    v_mov_b32 v212, 0
    ds_write_b16 v240, v246
    v_add_u32 v240, 128, v240
    s_bitcmp0_b32 s37, 1
    s_cbranch_scc1 Lf_evd1
    s_branch Lf_ev21
Lf_ev1:
    s_bitcmp1_b64 s[56:57], 1
    s_cbranch_scc1 Lf_fl1
Lf_ev21:
    s_bitcmp1_b64 s[56:57], 3
    s_cbranch_scc1 Lf_w1
    s_sub_u32 s60, s60, 1
    s_cbranch_scc0 Lf_nsa1
    s_mov_b32 s49, 6
    s_call_b64 s[62:63], L_swap
Lf_nsa1:
    s_add_u32 s35, s35, s31
    s_min_u32 s35, s35, 419404800
    s_xor_b32 s31, s31, 0x63ff800
    s_branch Lf_evd1
Lf_w1:
    s_bitcmp0_b64 s[56:57], 6
    s_cbranch_scc1 Lf_e11
    s_sub_u32 s60, s60, 1
    s_cbranch_scc0 Lf_nsb1
    s_mov_b32 s49, 6
    s_call_b64 s[62:63], L_swap
    s_waitcnt lgkmcnt(0)
Lf_nsb1:
    s_add_u32 s35, s35, s31
    s_min_u32 s35, s35, 419404800
    s_xor_b32 s31, s31, 0x63ff800
Lf_e11:
    s_sub_u32 s61, s61, 1
    s_cbranch_scc1 Lf_last1
    s_bitcmp0_b32 s33, s61
    s_cbranch_scc1 Lf_nw1
    s_cmp_eq_u32 s61, 3
    s_cselect_b32 s66, s80, s81
    v_add_u32 v238, s66, v238
    v_add_u32 v239, s66, v239
    ds_read_u16 v224, v238 offset:0
    ds_read_u16 v225, v238 offset:8
    ds_read_u16 v226, v238 offset:64
    ds_read_u16 v227, v238 offset:72
    s_waitcnt lgkmcnt(0)
Lf_nw1:
    v_mul_u32_u24 v216, v224, v241
    v_mul_u32_u24 v217, v224, v242
    v_mul_u32_u24 v218, v225, v241
    v_mul_u32_u24 v219, v225, v242
    v_mul_u32_u24 v220, v226, v241
    v_mul_u32_u24 v221, v226, v242
    v_mul_u32_u24 v222, v227, v241
    v_mul_u32_u24 v223, v227, v242
    v_mfma_f32_4x4x4_16b_bf16 v[140:143], v[216:217], v[68:69], v[4:7]
    v_add_u32 v238, 128, v238
    ds_read_b128 v[164:167], v239 offset:0
    ds_read_b128 v[168:171], v239 offset:64
    v_mfma_f32_4x4x4_16b_bf16 v[144:147], v[218:219], v[70:71], v[8:11]
    ds_read_b128 v[172:175], v239 offset:128
    ds_read_b128 v[176:179], v239 offset:192
    ds_read_u16 v224, v238 offset:0
    ds_read_u16 v225, v238 offset:8
    ds_read_u16 v226, v238 offset:64
    ds_read_u16 v227, v238 offset:72
    v_mfma_f32_4x4x4_16b_bf16 v[246:249], v[220:221], v[72:73], v[12:15]
    v_cvt_pk_bf16_f32 v100, v140, v141
    v_cvt_pk_bf16_f32 v101, v142, v143
    v_mfma_f32_4x4x4_16b_bf16 v[250:253], v[222:223], v[74:75], v[16:19]
    v_cvt_pk_bf16_f32 v102, v144, v145
    v_cvt_pk_bf16_f32 v103, v146, v147
    v_mfma_f32_4x4x4_16b_bf16 v[140:143], v[216:217], v[76:77], v[20:23]
    v_cvt_pk_bf16_f32 v104, v246, v247
    v_cvt_pk_bf16_f32 v105, v248, v249
    v_mfma_f32_4x4x4_16b_bf16 v[144:147], v[218:219], v[78:79], v[24:27]
    v_cvt_pk_bf16_f32 v106, v250, v251
    v_cvt_pk_bf16_f32 v107, v252, v253
    v_mfma_f32_4x4x4_16b_bf16 v[246:249], v[220:221], v[80:81], v[28:31]
    v_cvt_pk_bf16_f32 v108, v140, v141
    v_cvt_pk_bf16_f32 v109, v142, v143
    v_mfma_f32_4x4x4_16b_bf16 v[250:253], v[222:223], v[82:83], v[32:35]
    v_cvt_pk_bf16_f32 v110, v144, v145
    v_cvt_pk_bf16_f32 v111, v146, v147
    v_mfma_f32_4x4x4_16b_bf16 v[140:143], v[216:217], v[84:85], v[36:39]
    v_cvt_pk_bf16_f32 v112, v246, v247
    v_cvt_pk_bf16_f32 v113, v248, v249
    v_mfma_f32_4x4x4_16b_bf16 v[144:147], v[218:219], v[86:87], v[40:43]
    v_cvt_pk_bf16_f32 v114, v250, v251
    v_cvt_pk_bf16_f32 v115, v252, v253
    v_mfma_f32_4x4x4_16b_bf16 v[246:249], v[220:221], v[88:89], v[44:47]
    v_cvt_pk_bf16_f32 v116, v140, v141
    v_cvt_pk_bf16_f32 v117, v142, v143
    v_mfma_f32_4x4x4_16b_bf16 v[250:253], v[222:223], v[90:91], v[48:51]
    v_cvt_pk_bf16_f32 v118, v144, v145
    v_cvt_pk_bf16_f32 v119, v146, v147
    v_mfma_f32_4x4x4_16b_bf16 v[140:143], v[216:217], v[92:93], v[52:55]
    v_cvt_pk_bf16_f32 v120, v246, v247
    v_cvt_pk_bf16_f32 v121, v248, v249
    v_mfma_f32_4x4x4_16b_bf16 v[144:147], v[218:219], v[94:95], v[56:59]
    v_cvt_pk_bf16_f32 v122, v250, v251
    v_cvt_pk_bf16_f32 v123, v252, v253
    v_mfma_f32_4x4x4_16b_bf16 v[246:249], v[220:221], v[96:97], v[60:63]
    v_cvt_pk_bf16_f32 v124, v140, v141
    v_cvt_pk_bf16_f32 v125, v142, v143
    v_mfma_f32_4x4x4_16b_bf16 v[250:253], v[222:223], v[98:99], v[64:67]
    v_cvt_pk_bf16_f32 v126, v144, v145
    v_cvt_pk_bf16_f32 v127, v146, v147
    v_cvt_pk_bf16_f32 v128, v246, v247
    v_cvt_pk_bf16_f32 v129, v248, v249
    v_add_u32 v239, 272, v239
    v_cvt_pk_bf16_f32 v130, v250, v251
    v_cvt_pk_bf16_f32 v131, v252, v253
    s_waitcnt lgkmcnt(0)
    s_branch Lf_evd1
Lf_fl2:
    v_cvt_pk_bf16_f32 v246, v212, v212
    v_mov_b32 v212, 0
    ds_write_b16 v240, v246
    v_add_u32 v240, 128, v240
    s_bitcmp0_b32 s37, 2
    s_cbranch_scc1 Lf_evd2
    s_branch Lf_ev22
Lf_ev2:
    s_bitcmp1_b64 s[56:57], 2
    s_cbranch_scc1 Lf_fl2
Lf_ev22:
    s_bitcmp1_b64 s[56:57], 4
    s_cbranch_scc1 Lf_w2
    s_sub_u32 s60, s60, 1
    s_cbranch_scc0 Lf_nsa2
    s_mov_b32 s49, 7
    s_call_b64 s[62:63], L_swap
Lf_nsa2:
    s_add_u32 s35, s35, s31
    s_min_u32 s35, s35, 419404800
    s_xor_b32 s31, s31, 0x63ff800
    s_branch Lf_evd2
Lf_w2:
    s_bitcmp0_b64 s[56:57], 7
    s_cbranch_scc1 Lf_e12
    s_sub_u32 s60, s60, 1
    s_cbranch_scc0 Lf_nsb2
    s_mov_b32 s49, 7
    s_call_b64 s[62:63], L_swap
    s_waitcnt lgkmcnt(0)
Lf_nsb2:
    s_add_u32 s35, s35, s31
    s_min_u32 s35, s35, 419404800
    s_xor_b32 s31, s31, 0x63ff800
Lf_e12:
    s_sub_u32 s61, s61, 1
    s_cbranch_scc1 Lf_last2
    s_bitcmp0_b32 s33, s61
    s_cbranch_scc1 Lf_nw2
    s_cmp_eq_u32 s61, 3
    s_cselect_b32 s66, s80, s81
    v_add_u32 v238, s66, v238
    v_add_u32 v239, s66, v239
    ds_read_u16 v224, v238 offset:0
    ds_read_u16 v225, v238 offset:8
    ds_read_u16 v226, v238 offset:64
    ds_read_u16 v227, v238 offset:72
    s_waitcnt lgkmcnt(0)
Lf_nw2:
    v_mul_u32_u24 v216, v224, v241
    v_mul_u32_u24 v217, v224, v242
    v_mul_u32_u24 v218, v225, v241
    v_mul_u32_u24 v219, v225, v242
    v_mul_u32_u24 v220, v226, v241
    v_mul_u32_u24 v221, v226, v242
    v_mul_u32_u24 v222, v227, v241
    v_mul_u32_u24 v223, v227, v242
    v_mfma_f32_4x4x4_16b_bf16 v[140:143], v[216:217], v[68:69], v[4:7]
    v_add_u32 v238, 128, v238
    ds_read_b128 v[164:167], v239 offset:0
    ds_read_b128 v[168:171], v239 offset:64
    v_mfma_f32_4x4x4_16b_bf16 v[144:147], v[218:219], v[70:71], v[8:11]
    ds_read_b128 v[172:175], v239 offset:128
    ds_read_b128 v[176:179], v239 offset:192
    ds_read_u16 v224, v238 offset:0
    ds_read_u16 v225, v238 offset:8
    ds_read_u16 v226, v238 offset:64
    ds_read_u16 v227, v238 offset:72
    v_mfma_f32_4x4x4_16b_bf16 v[246:249], v[220:221], v[72:73], v[12:15]
    v_cvt_pk_bf16_f32 v100, v140, v141
    v_cvt_pk_bf16_f32 v101, v142, v143
    v_mfma_f32_4x4x4_16b_bf16 v[250:253], v[222:223], v[74:75], v[16:19]
    v_cvt_pk_bf16_f32 v102, v144, v145
    v_cvt_pk_bf16_f32 v103, v146, v147
    v_mfma_f32_4x4x4_16b_bf16 v[140:143], v[216:217], v[76:77], v[20:23]
    v_cvt_pk_bf16_f32 v104, v246, v247
    v_cvt_pk_bf16_f32 v105, v248, v249
    v_mfma_f32_4x4x4_16b_bf16 v[144:147], v[218:219], v[78:79], v[24:27]
    v_cvt_pk_bf16_f32 v106, v250, v251
    v_cvt_pk_bf16_f32 v107, v252, v253
    v_mfma_f32_4x4x4_16b_bf16 v[246:249], v[220:221], v[80:81], v[28:31]
    v_cvt_pk_bf16_f32 v108, v140, v141
    v_cvt_pk_bf16_f32 v109, v142, v143
    v_mfma_f32_4x4x4_16b_bf16 v[250:253], v[222:223], v[82:83], v[32:35]
    v_cvt_pk_bf16_f32 v110, v144, v145
    v_cvt_pk_bf16_f32 v111, v146, v147
    v_mfma_f32_4x4x4_16b_bf16 v[140:143], v[216:217], v[84:85], v[36:39]
    v_cvt_pk_bf16_f32 v112, v246, v247
    v_cvt_pk_bf16_f32 v113, v248, v249
    v_mfma_f32_4x4x4_16b_bf16 v[144:147], v[218:219], v[86:87], v[40:43]
    v_cvt_pk_bf16_f32 v114, v250, v251
    v_cvt_pk_bf16_f32 v115, v252, v253
    v_mfma_f32_4x4x4_16b_bf16 v[246:249], v[220:221], v[88:89], v[44:47]
    v_cvt_pk_bf16_f32 v116, v140, v141
    v_cvt_pk_bf16_f32 v117, v142, v143
    v_mfma_f32_4x4x4_16b_bf16 v[250:253], v[222:223], v[90:91], v[48:51]
    v_cvt_pk_bf16_f32 v118, v144, v145
    v_cvt_pk_bf16_f32 v119, v146, v147
    v_mfma_f32_4x4x4_16b_bf16 v[140:143], v[216:217], v[92:93], v[52:55]
    v_cvt_pk_bf16_f32 v120, v246, v247
    v_cvt_pk_bf16_f32 v121, v248, v249
    v_mfma_f32_4x4x4_16b_bf16 v[144:147], v[218:219], v[94:95], v[56:59]
    v_cvt_pk_bf16_f32 v122, v250, v251
    v_cvt_pk_bf16_f32 v123, v252, v253
    v_mfma_f32_4x4x4_16b_bf16 v[246:249], v[220:221], v[96:97], v[60:63]
    v_cvt_pk_bf16_f32 v124, v140, v141
    v_cvt_pk_bf16_f32 v125, v142, v143
    v_mfma_f32_4x4x4_16b_bf16 v[250:253], v[222:223], v[98:99], v[64:67]
    v_cvt_pk_bf16_f32 v126, v144, v145
    v_cvt_pk_bf16_f32 v127, v146, v147
    v_cvt_pk_bf16_f32 v128, v246, v247
    v_cvt_pk_bf16_f32 v129, v248, v249
    v_add_u32 v239, 272, v239
    v_cvt_pk_bf16_f32 v130, v250, v251
    v_cvt_pk_bf16_f32 v131, v252, v253
    s_waitcnt lgkmcnt(0)
    s_branch Lf_evd2
Lf_fl3:
    v_cvt_pk_bf16_f32 v246, v212, v212
    v_mov_b32 v212, 0
    ds_write_b16 v240, v246
    v_add_u32 v240, 128, v240
    s_bitcmp0_b32 s37, 3
    s_cbranch_scc1 Lf_evd3
    s_branch Lf_ev23
Lf_ev3:
    s_bitcmp1_b64 s[56:57], 3
    s_cbranch_scc1 Lf_fl3
Lf_ev23:
    s_bitcmp1_b64 s[56:57], 5
    s_cbranch_scc1 Lf_w3
    s_sub_u32 s60, s60, 1
    s_cbranch_scc0 Lf_nsa3
    s_mov_b32 s49, 8
    s_call_b64 s[62:63], L_swap
Lf_nsa3:
    s_add_u32 s35, s35, s31
    s_min_u32 s35, s35, 419404800
    s_xor_b32 s31, s31, 0x63ff800
    s_branch Lf_evd3
Lf_w3:
    s_bitcmp0_b64 s[56:57], 8
    s_cbranch_scc1 Lf_e13
    s_sub_u32 s60, s60, 1
    s_cbranch_scc0 Lf_nsb3
    s_mov_b32 s49, 8
    s_call_b64 s[62:63], L_swap
    s_waitcnt lgkmcnt(0)
Lf_nsb3:
    s_add_u32 s35, s35, s31
    s_min_u32 s35, s35, 419404800
    s_xor_b32 s31, s31, 0x63ff800
Lf_e13:
    s_sub_u32 s61, s61, 1
    s_cbranch_scc1 Lf_last3
    s_bitcmp0_b32 s33, s61
    s_cbranch_scc1 Lf_nw3
    s_cmp_eq_u32 s61, 3
    s_cselect_b32 s66, s80, s81
    v_add_u32 v238, s66, v238
    v_add_u32 v239, s66, v239
    ds_read_u16 v224, v238 offset:0
    ds_read_u16 v225, v238 offset:8
    ds_read_u16 v226, v238 offset:64
    ds_read_u16 v227, v238 offset:72
    s_waitcnt lgkmcnt(0)
Lf_nw3:
    v_mul_u32_u24 v216, v224, v241
    v_mul_u32_u24 v217, v224, v242
    v_mul_u32_u24 v218, v225, v241
    v_mul_u32_u24 v219, v225, v242
    v_mul_u32_u24 v220, v226, v241
    v_mul_u32_u24 v221, v226, v242
    v_mul_u32_u24 v222, v227, v241
    v_mul_u32_u24 v223, v227, v242
    v_mfma_f32_4x4x4_16b_bf16 v[140:143], v[216:217], v[68:69], v[4:7]
    v_add_u32 v238, 128, v238
    ds_read_b128 v[164:167], v239 offset:0
    ds_read_b128 v[168:171], v239 offset:64
    v_mfma_f32_4x4x4_16b_bf16 v[144:147], v[218:219], v[70:71], v[8:11]
    ds_read_b128 v[172:175], v239 offset:128
    ds_read_b128 v[176:179], v239 offset:192
    ds_read_u16 v224, v238 offset:0
    ds_read_u16 v225, v238 offset:8
    ds_read_u16 v226, v238 offset:64
    ds_read_u16 v227, v238 offset:72
    v_mfma_f32_4x4x4_16b_bf16 v[246:249], v[220:221], v[72:73], v[12:15]
    v_cvt_pk_bf16_f32 v100, v140, v141
    v_cvt_pk_bf16_f32 v101, v142, v143
    v_mfma_f32_4x4x4_16b_bf16 v[250:253], v[222:223], v[74:75], v[16:19]
    v_cvt_pk_bf16_f32 v102, v144, v145
    v_cvt_pk_bf16_f32 v103, v146, v147
    v_mfma_f32_4x4x4_16b_bf16 v[140:143], v[216:217], v[76:77], v[20:23]
    v_cvt_pk_bf16_f32 v104, v246, v247
    v_cvt_pk_bf16_f32 v105, v248, v249
    v_mfma_f32_4x4x4_16b_bf16 v[144:147], v[218:219], v[78:79], v[24:27]
    v_cvt_pk_bf16_f32 v106, v250, v251
    v_cvt_pk_bf16_f32 v107, v252, v253
    v_mfma_f32_4x4x4_16b_bf16 v[246:249], v[220:221], v[80:81], v[28:31]
    v_cvt_pk_bf16_f32 v108, v140, v141
    v_cvt_pk_bf16_f32 v109, v142, v143
    v_mfma_f32_4x4x4_16b_bf16 v[250:253], v[222:223], v[82:83], v[32:35]
    v_cvt_pk_bf16_f32 v110, v144, v145
    v_cvt_pk_bf16_f32 v111, v146, v147
    v_mfma_f32_4x4x4_16b_bf16 v[140:143], v[216:217], v[84:85], v[36:39]
    v_cvt_pk_bf16_f32 v112, v246, v247
    v_cvt_pk_bf16_f32 v113, v248, v249
    v_mfma_f32_4x4x4_16b_bf16 v[144:147], v[218:219], v[86:87], v[40:43]
    v_cvt_pk_bf16_f32 v114, v250, v251
    v_cvt_pk_bf16_f32 v115, v252, v253
    v_mfma_f32_4x4x4_16b_bf16 v[246:249], v[220:221], v[88:89], v[44:47]
    v_cvt_pk_bf16_f32 v116, v140, v141
    v_cvt_pk_bf16_f32 v117, v142, v143
    v_mfma_f32_4x4x4_16b_bf16 v[250:253], v[222:223], v[90:91], v[48:51]
    v_cvt_pk_bf16_f32 v118, v144, v145
    v_cvt_pk_bf16_f32 v119, v146, v147
    v_mfma_f32_4x4x4_16b_bf16 v[140:143], v[216:217], v[92:93], v[52:55]
    v_cvt_pk_bf16_f32 v120, v246, v247
    v_cvt_pk_bf16_f32 v121, v248, v249
    v_mfma_f32_4x4x4_16b_bf16 v[144:147], v[218:219], v[94:95], v[56:59]
    v_cvt_pk_bf16_f32 v122, v250, v251
    v_cvt_pk_bf16_f32 v123, v252, v253
    v_mfma_f32_4x4x4_16b_bf16 v[246:249], v[220:221], v[96:97], v[60:63]
    v_cvt_pk_bf16_f32 v124, v140, v141
    v_cvt_pk_bf16_f32 v125, v142, v143
    v_mfma_f32_4x4x4_16b_bf16 v[250:253], v[222:223], v[98:99], v[64:67]
    v_cvt_pk_bf16_f32 v126, v144, v145
    v_cvt_pk_bf16_f32 v127, v146, v147
    v_cvt_pk_bf16_f32 v128, v246, v247
    v_cvt_pk_bf16_f32 v129, v248, v249
    v_add_u32 v239, 272, v239
    v_cvt_pk_bf16_f32 v130, v250, v251
    v_cvt_pk_bf16_f32 v131, v252, v253
    s_waitcnt lgkmcnt(0)
    s_branch Lf_evd3
Lf_last0:
    s_branch Lf_tail
Lf_last1:
    v_add_u32 v236, 2080, v236
    s_lshr_b64 s[56:57], s[56:57], 1
    s_branch Lf_tail
Lf_last2:
    v_add_u32 v236, 4160, v236
    s_lshr_b64 s[56:57], s[56:57], 2
    s_branch Lf_tail
Lf_last3:
    v_add_u32 v236, 6240, v236
    s_lshr_b64 s[56:57], s[56:57], 3
Lf_tail:
    v_mfma_f32_16x16x32_bf16 v[208:211], v[136:139], v[200:203], v[208:211]
    v_exp_f32 v132, v148
    v_exp_f32 v133, v149
    v_exp_f32 v134, v150
    v_exp_f32 v135, v151
    v_exp_f32 v136, v152
    v_exp_f32 v137, v153
    v_mfma_f32_4x4x4_16b_bf16 v[132:135], v[228:229], v[228:229], v[132:135]
    v_exp_f32 v138, v154
    v_exp_f32 v139, v155
    v_cvt_pk_bf16_f32 v208, v208, v209
    v_cvt_pk_bf16_f32 v209, v210, v211
    v_exp_f32 v140, v156
    v_exp_f32 v141, v157
    v_mfma_f32_4x4x4_16b_bf16 v[212:215], v[208:209], v[188:189], v[212:215] cbsz:4 abid:0
    v_mfma_f32_4x4x4_16b_bf16 v[136:139], v[228:229], v[228:229], v[136:139]
    v_exp_f32 v142, v158
    v_mfma_f32_4x4x4_16b_bf16 v[212:215], v[208:209], v[190:191], v[212:215] cbsz:4 abid:4
    v_exp_f32 v143, v159
    v_exp_f32 v144, v160
    v_mfma_f32_4x4x4_16b_bf16 v[212:215], v[208:209], v[192:193], v[212:215] cbsz:4 abid:8
    v_exp_f32 v145, v161
    v_mfma_f32_4x4x4_16b_bf16 v[140:143], v[228:229], v[228:229], v[140:143]
    v_mfma_f32_4x4x4_16b_bf16 v[212:215], v[208:209], v[194:195], v[212:215] cbsz:4 abid:12
    ds_read_b64_tr_b16 v[188:189], v236 offset:0
    ds_read_b64_tr_b16 v[190:191], v236 offset:512
    ds_read_b64_tr_b16 v[192:193], v236 offset:1056
    ds_read_b64_tr_b16 v[194:195], v236 offset:1568
    v_exp_f32 v146, v162
    v_exp_f32 v147, v163
    v_rcp_f32 v132, v132
    v_rcp_f32 v133, v133
    v_mfma_f32_4x4x4_16b_bf16 v[144:147], v[228:229], v[228:229], v[144:147]
    v_rcp_f32 v134, v134
    s_bitcmp0_b64 s[56:57], 1
    s_cbranch_scc1 Lf_tnf
    v_cvt_pk_bf16_f32 v246, v212, v212
    v_mov_b32 v212, 0
    ds_write_b16 v240, v246
    v_add_u32 v240, 128, v240
Lf_tnf:
    v_cvt_pk_bf16_f32 v132, v132, v133
    s_waitcnt lgkmcnt(0)
    v_rcp_f32 v135, v135
    v_rcp_f32 v136, v136
    v_cvt_pk_bf16_f32 v133, v134, v135
    v_rcp_f32 v137, v137
    v_rcp_f32 v138, v138
    v_cvt_pk_bf16_f32 v134, v136, v137
    v_rcp_f32 v139, v139
    v_rcp_f32 v140, v140
    v_cvt_pk_bf16_f32 v135, v138, v139
    v_rcp_f32 v141, v141
    v_rcp_f32 v142, v142
    v_cvt_pk_bf16_f32 v136, v140, v141
    v_mfma_f32_16x16x32_bf16 v[208:211], v[132:135], v[196:199], v[204:207]
    v_rcp_f32 v143, v143
    v_rcp_f32 v144, v144
    v_cvt_pk_bf16_f32 v137, v142, v143
    v_rcp_f32 v145, v145
    v_rcp_f32 v146, v146
    v_rcp_f32 v147, v147
    v_cvt_pk_bf16_f32 v138, v144, v145
    v_cvt_pk_bf16_f32 v139, v146, v147
    s_nop 1
    v_mfma_f32_16x16x32_bf16 v[208:211], v[136:139], v[200:203], v[208:211]
    s_nop 7
    v_cvt_pk_bf16_f32 v208, v208, v209
    v_cvt_pk_bf16_f32 v209, v210, v211
    s_nop 1
    v_mfma_f32_4x4x4_16b_bf16 v[212:215], v[208:209], v[188:189], v[212:215] cbsz:4 abid:0
    s_nop 1
    v_mfma_f32_4x4x4_16b_bf16 v[212:215], v[208:209], v[190:191], v[212:215] cbsz:4 abid:4
    s_nop 1
    v_mfma_f32_4x4x4_16b_bf16 v[212:215], v[208:209], v[192:193], v[212:215] cbsz:4 abid:8
    s_nop 1
    v_mfma_f32_4x4x4_16b_bf16 v[212:215], v[208:209], v[194:195], v[212:215] cbsz:4 abid:12
    s_nop 4
    v_cvt_pk_bf16_f32 v246, v212, v212
    ds_write_b16 v240, v246
L_store:
    s_add_u32 s66, s52, 14912
    v_lshl_add_u32 v247, v0, 4, s66
    s_lshl_b32 s66, s82, 5
    s_bfm_b64 exec, 16, 32
    v_add_u32 v243, s66, v243
    s_lshl_b32 s66, s83, 5
    s_bfm_b64 exec, 16, 48
    v_add_u32 v243, s66, v243
    s_mov_b64 exec, -1
    ds_read_b128 v[148:151], v247
    s_waitcnt lgkmcnt(0)
    global_store_dwordx4 v243, v[148:151], s[18:19] sc0 sc1
L_end:
    s_endpgm
L_general:
    s_waitcnt vmcnt(0)
    ds_read_b128 v[44:47], v246 offset:20480
    ds_read_b128 v[48:51], v246 offset:21504
    ds_read_b128 v[88:91], v246 offset:22528
    ds_read_b128 v[52:55], v246 offset:40960
    ds_read_b128 v[56:59], v246 offset:41984
    ds_read_b128 v[92:95], v246 offset:43008
    ds_read_b128 v[60:63], v246 offset:61440
    ds_read_b128 v[64:67], v246 offset:62464
    ds_read_b128 v[96:99], v246 offset:63488
    ds_read_u16 v224, v238 offset:0
    ds_read_u16 v225, v238 offset:8
    ds_read_u16 v226, v238 offset:64
    ds_read_u16 v227, v238 offset:72
    s_mul_i32 s35, s53, 51200
    s_movk_i32 s31, 25600
    s_mov_b32 s60, 3
    s_mov_b64 s[56:57], 0
    v_mov_b32 v148, -1
    v_mov_b32 v149, -1
    v_mov_b32 v150, -1
    v_mov_b32 v151, -1
    s_add_u32 s66, s52, 18432
    v_add_u32 v152, s66, v2
    ds_write_b128 v152, v[148:151]
    ds_write_b128 v152, v[148:151] offset:1024
    s_add_u32 s64, s52, 18448
    s_bfm_b64 s[28:29], 50, 0
    s_mul_i32 s66, s53, 800
    v_add_u32 v247, s66, v2
    s_mov_b64 exec, s[28:29]
    global_load_dwordx4 v[100:103], v247, s[8:9]
    v_add_u32 v247, 1638400, v247
    global_load_dwordx4 v[104:107], v247, s[8:9]
    v_add_u32 v247, 1638400, v247
    global_load_dwordx4 v[108:111], v247, s[8:9]
    v_add_u32 v247, 1638400, v247
    global_load_dwordx4 v[112:115], v247, s[8:9]
    v_add_u32 v247, 1638400, v247
    s_mov_b64 exec, -1
    v_cmp_lt_u32 vcc, 24, v0
    s_nop 1
    v_cndmask_b32 v145, 0, 1, vcc
    v_mul_u32_u24 v142, 25, v145
    v_sub_u32 v142, v0, v142
    v_mul_u32_u24 v142, 0x80008, v142
    v_add_u32 v141, 0x10000, v142
    v_add_u32 v143, 0x50004, v142
    v_add_u32 v144, 0x70006, v142
    v_add_u32 v142, 0x30002, v142
    s_waitcnt vmcnt(0)
    s_mov_b64 exec, s[28:29]
    v_cmp_neq_f16_sdwa s[68:69], v100, 0 src0_sel:WORD_0 src1_sel:WORD_0
    v_cmp_neq_f16_sdwa s[70:71], v100, 0 src0_sel:WORD_1 src1_sel:WORD_0
    v_cmp_neq_f16_sdwa s[72:73], v101, 0 src0_sel:WORD_0 src1_sel:WORD_0
    v_cmp_neq_f16_sdwa s[74:75], v101, 0 src0_sel:WORD_1 src1_sel:WORD_0
    v_cmp_neq_f16_sdwa s[76:77], v102, 0 src0_sel:WORD_0 src1_sel:WORD_0
    v_cmp_neq_f16_sdwa s[78:79], v102, 0 src0_sel:WORD_1 src1_sel:WORD_0
    v_cmp_neq_f16_sdwa s[80:81], v103, 0 src0_sel:WORD_0 src1_sel:WORD_0
    v_cmp_neq_f16_sdwa s[82:83], v103, 0 src0_sel:WORD_1 src1_sel:WORD_0
    s_mov_b64 exec, -1
    v_mov_b32 v132, s64
    v_mbcnt_lo_u32_b32 v132, s68, v132
    v_mbcnt_hi_u32_b32 v132, s69, v132
    v_mbcnt_lo_u32_b32 v132, s70, v132
    v_mbcnt_hi_u32_b32 v132, s71, v132
    v_mbcnt_lo_u32_b32 v132, s72, v132
    v_mbcnt_hi_u32_b32 v132, s73, v132
    v_mbcnt_lo_u32_b32 v132, s74, v132
    v_mbcnt_hi_u32_b32 v132, s75, v132
    v_mbcnt_lo_u32_b32 v132, s76, v132
    v_mbcnt_hi_u32_b32 v132, s77, v132
    v_mbcnt_lo_u32_b32 v132, s78, v132
    v_mbcnt_hi_u32_b32 v132, s79, v132
    v_mbcnt_lo_u32_b32 v132, s80, v132
    v_mbcnt_hi_u32_b32 v132, s81, v132
    v_mbcnt_lo_u32_b32 v132, s82, v132
    v_mbcnt_hi_u32_b32 v132, s83, v132
    s_add_u32 s55, s64, 16
    v_readlane_b32 s66, v132, 25
    v_readlane_b32 s67, v132, 63
    s_add_u32 s64, s66, 15
    s_and_b32 s64, s64, -16
    s_max_u32 s64, s64, s55
    s_sub_u32 s66, s64, s66
    v_mad_u32_u24 v132, v145, s66, v132
    s_mov_b32 s55, s64
    v_addc_co_u32 v133, vcc, 0, v132, s[68:69]
    v_addc_co_u32 v134, vcc, 0, v133, s[70:71]
    v_addc_co_u32 v135, vcc, 0, v134, s[72:73]
    v_addc_co_u32 v136, vcc, 0, v135, s[74:75]
    v_addc_co_u32 v137, vcc, 0, v136, s[76:77]
    v_addc_co_u32 v138, vcc, 0, v137, s[78:79]
    v_addc_co_u32 v139, vcc, 0, v138, s[80:81]
    s_add_u32 s67, s67, s66
    s_add_u32 s67, s67, 15
    s_and_b32 s67, s67, -16
    s_add_u32 s64, s64, 16
    s_max_u32 s64, s64, s67
    s_mov_b64 exec, s[68:69]
    ds_write_b8 v132, v141
    s_mov_b64 exec, s[70:71]
    ds_write_b8_d16_hi v133, v141
    s_mov_b64 exec, s[72:73]
    ds_write_b8 v134, v142
    s_mov_b64 exec, s[74:75]
    ds_write_b8_d16_hi v135, v142
    s_mov_b64 exec, s[76:77]
    ds_write_b8 v136, v143
    s_mov_b64 exec, s[78:79]
    ds_write_b8_d16_hi v137, v143
    s_mov_b64 exec, s[80:81]
    ds_write_b8 v138, v144
    s_mov_b64 exec, s[82:83]
    ds_write_b8_d16_hi v139, v144
    s_mov_b64 exec, -1
    s_lshr_b32 s95, s55, 4
    s_bitset1_b64 s[56:57], s95
    s_lshr_b32 s95, s64, 4
    s_bitset1_b64 s[56:57], s95
    s_mov_b64 exec, s[28:29]
    v_cmp_neq_f16_sdwa s[68:69], v104, 0 src0_sel:WORD_0 src1_sel:WORD_0
    v_cmp_neq_f16_sdwa s[70:71], v104, 0 src0_sel:WORD_1 src1_sel:WORD_0
    v_cmp_neq_f16_sdwa s[72:73], v105, 0 src0_sel:WORD_0 src1_sel:WORD_0
    v_cmp_neq_f16_sdwa s[74:75], v105, 0 src0_sel:WORD_1 src1_sel:WORD_0
    v_cmp_neq_f16_sdwa s[76:77], v106, 0 src0_sel:WORD_0 src1_sel:WORD_0
    v_cmp_neq_f16_sdwa s[78:79], v106, 0 src0_sel:WORD_1 src1_sel:WORD_0
    v_cmp_neq_f16_sdwa s[80:81], v107, 0 src0_sel:WORD_0 src1_sel:WORD_0
    v_cmp_neq_f16_sdwa s[82:83], v107, 0 src0_sel:WORD_1 src1_sel:WORD_0
    s_mov_b64 exec, -1
    v_mov_b32 v132, s64
    v_mbcnt_lo_u32_b32 v132, s68, v132
    v_mbcnt_hi_u32_b32 v132, s69, v132
    v_mbcnt_lo_u32_b32 v132, s70, v132
    v_mbcnt_hi_u32_b32 v132, s71, v132
    v_mbcnt_lo_u32_b32 v132, s72, v132
    v_mbcnt_hi_u32_b32 v132, s73, v132
    v_mbcnt_lo_u32_b32 v132, s74, v132
    v_mbcnt_hi_u32_b32 v132, s75, v132
    v_mbcnt_lo_u32_b32 v132, s76, v132
    v_mbcnt_hi_u32_b32 v132, s77, v132
    v_mbcnt_lo_u32_b32 v132, s78, v132
    v_mbcnt_hi_u32_b32 v132, s79, v132
    v_mbcnt_lo_u32_b32 v132, s80, v132
    v_mbcnt_hi_u32_b32 v132, s81, v132
    v_mbcnt_lo_u32_b32 v132, s82, v132
    v_mbcnt_hi_u32_b32 v132, s83, v132
    s_add_u32 s55, s64, 16
    v_readlane_b32 s66, v132, 25
    v_readlane_b32 s67, v132, 63
    s_add_u32 s64, s66, 15
    s_and_b32 s64, s64, -16
    s_max_u32 s64, s64, s55
    s_sub_u32 s66, s64, s66
    v_mad_u32_u24 v132, v145, s66, v132
    s_mov_b32 s55, s64
    v_addc_co_u32 v133, vcc, 0, v132, s[68:69]
    v_addc_co_u32 v134, vcc, 0, v133, s[70:71]
    v_addc_co_u32 v135, vcc, 0, v134, s[72:73]
    v_addc_co_u32 v136, vcc, 0, v135, s[74:75]
    v_addc_co_u32 v137, vcc, 0, v136, s[76:77]
    v_addc_co_u32 v138, vcc, 0, v137, s[78:79]
    v_addc_co_u32 v139, vcc, 0, v138, s[80:81]
    s_add_u32 s67, s67, s66
    s_add_u32 s67, s67, 15
    s_and_b32 s67, s67, -16
    s_add_u32 s64, s64, 16
    s_max_u32 s64, s64, s67
    s_mov_b64 exec, s[68:69]
    ds_write_b8 v132, v141
    s_mov_b64 exec, s[70:71]
    ds_write_b8_d16_hi v133, v141
    s_mov_b64 exec, s[72:73]
    ds_write_b8 v134, v142
    s_mov_b64 exec, s[74:75]
    ds_write_b8_d16_hi v135, v142
    s_mov_b64 exec, s[76:77]
    ds_write_b8 v136, v143
    s_mov_b64 exec, s[78:79]
    ds_write_b8_d16_hi v137, v143
    s_mov_b64 exec, s[80:81]
    ds_write_b8 v138, v144
    s_mov_b64 exec, s[82:83]
    ds_write_b8_d16_hi v139, v144
    s_mov_b64 exec, -1
    s_lshr_b32 s95, s55, 4
    s_bitset1_b64 s[56:57], s95
    s_lshr_b32 s95, s64, 4
    s_bitset1_b64 s[56:57], s95
    s_mov_b32 s44, s64
    s_mov_b64 exec, s[28:29]
    v_cmp_neq_f16_sdwa s[68:69], v108, 0 src0_sel:WORD_0 src1_sel:WORD_0
    v_cmp_neq_f16_sdwa s[70:71], v108, 0 src0_sel:WORD_1 src1_sel:WORD_0
    v_cmp_neq_f16_sdwa s[72:73], v109, 0 src0_sel:WORD_0 src1_sel:WORD_0
    v_cmp_neq_f16_sdwa s[74:75], v109, 0 src0_sel:WORD_1 src1_sel:WORD_0
    v_cmp_neq_f16_sdwa s[76:77], v110, 0 src0_sel:WORD_0 src1_sel:WORD_0
    v_cmp_neq_f16_sdwa s[78:79], v110, 0 src0_sel:WORD_1 src1_sel:WORD_0
    v_cmp_neq_f16_sdwa s[80:81], v111, 0 src0_sel:WORD_0 src1_sel:WORD_0
    v_cmp_neq_f16_sdwa s[82:83], v111, 0 src0_sel:WORD_1 src1_sel:WORD_0
    s_mov_b64 exec, -1
    v_mov_b32 v132, s64
    v_mbcnt_lo_u32_b32 v132, s68, v132
    v_mbcnt_hi_u32_b32 v132, s69, v132
    v_mbcnt_lo_u32_b32 v132, s70, v132
    v_mbcnt_hi_u32_b32 v132, s71, v132
    v_mbcnt_lo_u32_b32 v132, s72, v132
    v_mbcnt_hi_u32_b32 v132, s73, v132
    v_mbcnt_lo_u32_b32 v132, s74, v132
    v_mbcnt_hi_u32_b32 v132, s75, v132
    v_mbcnt_lo_u32_b32 v132, s76, v132
    v_mbcnt_hi_u32_b32 v132, s77, v132
    v_mbcnt_lo_u32_b32 v132, s78, v132
    v_mbcnt_hi_u32_b32 v132, s79, v132
    v_mbcnt_lo_u32_b32 v132, s80, v132
    v_mbcnt_hi_u32_b32 v132, s81, v132
    v_mbcnt_lo_u32_b32 v132, s82, v132
    v_mbcnt_hi_u32_b32 v132, s83, v132
    s_add_u32 s55, s64, 16
    v_readlane_b32 s66, v132, 25
    v_readlane_b32 s67, v132, 63
    s_add_u32 s64, s66, 15
    s_and_b32 s64, s64, -16
    s_max_u32 s64, s64, s55
    s_sub_u32 s66, s64, s66
    v_mad_u32_u24 v132, v145, s66, v132
    s_mov_b32 s55, s64
    v_addc_co_u32 v133, vcc, 0, v132, s[68:69]
    v_addc_co_u32 v134, vcc, 0, v133, s[70:71]
    v_addc_co_u32 v135, vcc, 0, v134, s[72:73]
    v_addc_co_u32 v136, vcc, 0, v135, s[74:75]
    v_addc_co_u32 v137, vcc, 0, v136, s[76:77]
    v_addc_co_u32 v138, vcc, 0, v137, s[78:79]
    v_addc_co_u32 v139, vcc, 0, v138, s[80:81]
    s_add_u32 s67, s67, s66
    s_add_u32 s67, s67, 15
    s_and_b32 s67, s67, -16
    s_add_u32 s64, s64, 16
    s_max_u32 s64, s64, s67
    s_mov_b64 exec, s[68:69]
    ds_write_b8 v132, v141
    s_mov_b64 exec, s[70:71]
    ds_write_b8_d16_hi v133, v141
    s_mov_b64 exec, s[72:73]
    ds_write_b8 v134, v142
    s_mov_b64 exec, s[74:75]
    ds_write_b8_d16_hi v135, v142
    s_mov_b64 exec, s[76:77]
    ds_write_b8 v136, v143
    s_mov_b64 exec, s[78:79]
    ds_write_b8_d16_hi v137, v143
    s_mov_b64 exec, s[80:81]
    ds_write_b8 v138, v144
    s_mov_b64 exec, s[82:83]
    ds_write_b8_d16_hi v139, v144
    s_mov_b64 exec, -1
    s_mov_b32 s45, s55
    s_mov_b32 s46, s64
    s_mov_b64 exec, s[28:29]
    v_cmp_neq_f16_sdwa s[68:69], v112, 0 src0_sel:WORD_0 src1_sel:WORD_0
    v_cmp_neq_f16_sdwa s[70:71], v112, 0 src0_sel:WORD_1 src1_sel:WORD_0
    v_cmp_neq_f16_sdwa s[72:73], v113, 0 src0_sel:WORD_0 src1_sel:WORD_0
    v_cmp_neq_f16_sdwa s[74:75], v113, 0 src0_sel:WORD_1 src1_sel:WORD_0
    v_cmp_neq_f16_sdwa s[76:77], v114, 0 src0_sel:WORD_0 src1_sel:WORD_0
    v_cmp_neq_f16_sdwa s[78:79], v114, 0 src0_sel:WORD_1 src1_sel:WORD_0
    v_cmp_neq_f16_sdwa s[80:81], v115, 0 src0_sel:WORD_0 src1_sel:WORD_0
    v_cmp_neq_f16_sdwa s[82:83], v115, 0 src0_sel:WORD_1 src1_sel:WORD_0
    s_mov_b64 exec, -1
    v_mov_b32 v132, s64
    v_mbcnt_lo_u32_b32 v132, s68, v132
    v_mbcnt_hi_u32_b32 v132, s69, v132
    v_mbcnt_lo_u32_b32 v132, s70, v132
    v_mbcnt_hi_u32_b32 v132, s71, v132
    v_mbcnt_lo_u32_b32 v132, s72, v132
    v_mbcnt_hi_u32_b32 v132, s73, v132
    v_mbcnt_lo_u32_b32 v132, s74, v132
    v_mbcnt_hi_u32_b32 v132, s75, v132
    v_mbcnt_lo_u32_b32 v132, s76, v132
    v_mbcnt_hi_u32_b32 v132, s77, v132
    v_mbcnt_lo_u32_b32 v132, s78, v132
    v_mbcnt_hi_u32_b32 v132, s79, v132
    v_mbcnt_lo_u32_b32 v132, s80, v132
    v_mbcnt_hi_u32_b32 v132, s81, v132
    v_mbcnt_lo_u32_b32 v132, s82, v132
    v_mbcnt_hi_u32_b32 v132, s83, v132
    s_add_u32 s55, s64, 16
    v_readlane_b32 s66, v132, 25
    v_readlane_b32 s67, v132, 63
    s_add_u32 s64, s66, 15
    s_and_b32 s64, s64, -16
    s_max_u32 s64, s64, s55
    s_sub_u32 s66, s64, s66
    v_mad_u32_u24 v132, v145, s66, v132
    s_mov_b32 s55, s64
    v_addc_co_u32 v133, vcc, 0, v132, s[68:69]
    v_addc_co_u32 v134, vcc, 0, v133, s[70:71]
    v_addc_co_u32 v135, vcc, 0, v134, s[72:73]
    v_addc_co_u32 v136, vcc, 0, v135, s[74:75]
    v_addc_co_u32 v137, vcc, 0, v136, s[76:77]
    v_addc_co_u32 v138, vcc, 0, v137, s[78:79]
    v_addc_co_u32 v139, vcc, 0, v138, s[80:81]
    s_add_u32 s67, s67, s66
    s_add_u32 s67, s67, 15
    s_and_b32 s67, s67, -16
    s_add_u32 s64, s64, 16
    s_max_u32 s64, s64, s67
    s_mov_b64 exec, s[68:69]
    ds_write_b8 v132, v141
    s_mov_b64 exec, s[70:71]
    ds_write_b8_d16_hi v133, v141
    s_mov_b64 exec, s[72:73]
    ds_write_b8 v134, v142
    s_mov_b64 exec, s[74:75]
    ds_write_b8_d16_hi v135, v142
    s_mov_b64 exec, s[76:77]
    ds_write_b8 v136, v143
    s_mov_b64 exec, s[78:79]
    ds_write_b8_d16_hi v137, v143
    s_mov_b64 exec, s[80:81]
    ds_write_b8 v138, v144
    s_mov_b64 exec, s[82:83]
    ds_write_b8_d16_hi v139, v144
    s_mov_b64 exec, -1
    s_mov_b32 s47, s55
    s_mov_b32 s48, s64
    s_mov_b32 s94, 0
    s_mov_b64 s[84:85], -1
    s_branch L_listed
Ls_loop:
Ls_mid:
    s_bitcmp1_b32 s36, 0
    s_cbranch_scc1 Ls_ev0
Ls_evd0:
    v_mfma_f32_16x16x32_bf16 v[208:211], v[136:139], v[200:203], v[208:211]
    ds_read_b32 v246, v244 offset:0
    s_waitcnt lgkmcnt(0)
    v_bfe_u32 v247, v246, 0, 8
    v_lshlrev_b32 v247, 1, v247
    v_bfe_u32 v248, v246, 8, 8
    v_lshlrev_b32 v248, 1, v248
    v_bfe_u32 v249, v246, 16, 8
    v_lshlrev_b32 v249, 1, v249
    v_bfe_u32 v250, v246, 24, 8
    v_lshlrev_b32 v250, 1, v250
    buffer_load_ushort v247, v247, s[24:27], 0 offen
    buffer_load_ushort v248, v248, s[24:27], 0 offen
    buffer_load_ushort v249, v249, s[24:27], 0 offen
    buffer_load_ushort v250, v250, s[24:27], 0 offen
    s_waitcnt vmcnt(0)
    v_lshlrev_b32 v247, 16, v247
    v_mul_f32 v208, v208, v247
    v_lshlrev_b32 v248, 16, v248
    v_mul_f32 v209, v209, v248
    v_lshlrev_b32 v249, 16, v249
    v_mul_f32 v210, v210, v249
    v_lshlrev_b32 v250, 16, v250
    v_mul_f32 v211, v211, v250
    v_exp_f32 v132, v148
    v_exp_f32 v133, v149
    v_exp_f32 v134, v150
    v_exp_f32 v135, v151
    v_exp_f32 v136, v152
    v_exp_f32 v137, v153
    v_mfma_f32_4x4x4_16b_bf16 v[132:135], v[228:229], v[228:229], v[132:135]
    v_exp_f32 v138, v154
    v_exp_f32 v139, v155
    v_cvt_pk_bf16_f32 v208, v208, v209
    v_cvt_pk_bf16_f32 v209, v210, v211
    v_exp_f32 v140, v156
    v_exp_f32 v141, v157
    v_mfma_f32_4x4x4_16b_bf16 v[212:215], v[208:209], v[188:189], v[212:215] cbsz:4 abid:0
    v_mfma_f32_4x4x4_16b_bf16 v[136:139], v[228:229], v[228:229], v[136:139]
    v_exp_f32 v142, v158
    v_mfma_f32_4x4x4_16b_bf16 v[212:215], v[208:209], v[190:191], v[212:215] cbsz:4 abid:4
    v_exp_f32 v143, v159
    v_exp_f32 v144, v160
    v_mfma_f32_4x4x4_16b_bf16 v[212:215], v[208:209], v[192:193], v[212:215] cbsz:4 abid:8
    v_exp_f32 v145, v161
    v_mfma_f32_4x4x4_16b_bf16 v[140:143], v[228:229], v[228:229], v[140:143]
    v_mfma_f32_4x4x4_16b_bf16 v[212:215], v[208:209], v[194:195], v[212:215] cbsz:4 abid:12
    ds_add_rtn_u32 v1, v2, v3
    ds_read_u8 v230, v237 offset:64
    ds_read_u8 v232, v237 offset:72
    ds_read_b64_tr_b16 v[188:189], v236 offset:0
    ds_read_b64_tr_b16 v[190:191], v236 offset:512
    ds_read_b64_tr_b16 v[192:193], v236 offset:1056
    ds_read_b64_tr_b16 v[194:195], v236 offset:1568
    s_waitcnt vmcnt(4)
    ds_read_b128 v[180:183], v234 offset:2080
    ds_read_b128 v[184:187], v235 offset:2080
    s_add_u32 m0, s52, 0
    v_exp_f32 v146, v162
    v_exp_f32 v147, v163
    v_rcp_f32 v132, v132
    v_rcp_f32 v133, v133
    v_mfma_f32_4x4x4_16b_bf16 v[144:147], v[228:229], v[228:229], v[144:147]
    v_rcp_f32 v134, v134
    v_cvt_pk_bf16_f32 v132, v132, v133
    s_waitcnt lgkmcnt(0)
    v_mfma_f32_16x16x32_bf16 v[148:151], v[100:103], v[180:183], v[164:167]
    v_rcp_f32 v135, v135
    v_mfma_f32_16x16x32_bf16 v[152:155], v[108:111], v[180:183], v[168:171]
    v_rcp_f32 v136, v136
    v_cvt_pk_bf16_f32 v133, v134, v135
    v_mfma_f32_16x16x32_bf16 v[148:151], v[104:107], v[184:187], v[148:151]
    v_rcp_f32 v137, v137
    v_cmp_gt_i32 vcc, v1, v245
    s_setprio 0
    s_cbranch_vccz Ls_lo0
    s_setprio 1
Ls_lo0:
    v_mfma_f32_16x16x32_bf16 v[152:155], v[112:115], v[184:187], v[152:155]
    v_rcp_f32 v138, v138
    v_cvt_pk_bf16_f32 v134, v136, v137
    v_mfma_f32_16x16x32_bf16 v[156:159], v[116:119], v[180:183], v[172:175]
    v_rcp_f32 v139, v139
    v_mfma_f32_16x16x32_bf16 v[160:163], v[124:127], v[180:183], v[176:179]
    v_rcp_f32 v140, v140
    v_cvt_pk_bf16_f32 v135, v138, v139
    v_mfma_f32_16x16x32_bf16 v[156:159], v[120:123], v[184:187], v[156:159]
    v_rcp_f32 v141, v141
    v_mfma_f32_16x16x32_bf16 v[160:163], v[128:131], v[184:187], v[160:163]
    v_rcp_f32 v142, v142
    v_cvt_pk_bf16_f32 v136, v140, v141
    v_mfma_f32_16x16x32_bf16 v[208:211], v[132:135], v[196:199], v[204:207]
    v_rcp_f32 v143, v143
    v_rcp_f32 v144, v144
    v_cvt_pk_bf16_f32 v137, v142, v143
    v_rcp_f32 v145, v145
    v_rcp_f32 v146, v146
    v_rcp_f32 v147, v147
    v_cvt_pk_bf16_f32 v138, v144, v145
    v_cvt_pk_bf16_f32 v139, v146, v147
    buffer_load_dwordx4 v[230:231], s[20:23], s35 idxen offen nt lds
    buffer_load_dwordx4 v[232:233], s[40:43], s35 idxen offen offset:1056 nt lds
    s_bitcmp1_b32 s36, 1
    s_cbranch_scc1 Ls_ev1
Ls_evd1:
    v_mfma_f32_16x16x32_bf16 v[208:211], v[136:139], v[200:203], v[208:211]
    ds_read_b32 v246, v244 offset:16
    s_waitcnt lgkmcnt(0)
    v_bfe_u32 v247, v246, 0, 8
    v_lshlrev_b32 v247, 1, v247
    v_bfe_u32 v248, v246, 8, 8
    v_lshlrev_b32 v248, 1, v248
    v_bfe_u32 v249, v246, 16, 8
    v_lshlrev_b32 v249, 1, v249
    v_bfe_u32 v250, v246, 24, 8
    v_lshlrev_b32 v250, 1, v250
    buffer_load_ushort v247, v247, s[24:27], 0 offen
    buffer_load_ushort v248, v248, s[24:27], 0 offen
    buffer_load_ushort v249, v249, s[24:27], 0 offen
    buffer_load_ushort v250, v250, s[24:27], 0 offen
    s_waitcnt vmcnt(0)
    v_lshlrev_b32 v247, 16, v247
    v_mul_f32 v208, v208, v247
    v_lshlrev_b32 v248, 16, v248
    v_mul_f32 v209, v209, v248
    v_lshlrev_b32 v249, 16, v249
    v_mul_f32 v210, v210, v249
    v_lshlrev_b32 v250, 16, v250
    v_mul_f32 v211, v211, v250
    v_exp_f32 v132, v148
    v_exp_f32 v133, v149
    v_exp_f32 v134, v150
    v_exp_f32 v135, v151
    v_exp_f32 v136, v152
    v_exp_f32 v137, v153
    v_mfma_f32_4x4x4_16b_bf16 v[132:135], v[228:229], v[228:229], v[132:135]
    v_exp_f32 v138, v154
    v_exp_f32 v139, v155
    v_cvt_pk_bf16_f32 v208, v208, v209
    v_cvt_pk_bf16_f32 v209, v210, v211
    v_exp_f32 v140, v156
    v_exp_f32 v141, v157
    v_mfma_f32_4x4x4_16b_bf16 v[212:215], v[208:209], v[188:189], v[212:215] cbsz:4 abid:0
    v_mfma_f32_4x4x4_16b_bf16 v[136:139], v[228:229], v[228:229], v[136:139]
    v_exp_f32 v142, v158
    v_mfma_f32_4x4x4_16b_bf16 v[212:215], v[208:209], v[190:191], v[212:215] cbsz:4 abid:4
    v_exp_f32 v143, v159
    v_exp_f32 v144, v160
    v_mfma_f32_4x4x4_16b_bf16 v[212:215], v[208:209], v[192:193], v[212:215] cbsz:4 abid:8
    v_exp_f32 v145, v161
    v_mfma_f32_4x4x4_16b_bf16 v[140:143], v[228:229], v[228:229], v[140:143]
    v_mfma_f32_4x4x4_16b_bf16 v[212:215], v[208:209], v[194:195], v[212:215] cbsz:4 abid:12
    ds_read_u8 v230, v237 offset:80
    ds_read_u8 v232, v237 offset:88
    ds_read_b64_tr_b16 v[188:189], v236 offset:2080
    ds_read_b64_tr_b16 v[190:191], v236 offset:2592
    ds_read_b64_tr_b16 v[192:193], v236 offset:3136
    ds_read_b64_tr_b16 v[194:195], v236 offset:3648
    s_waitcnt vmcnt(4)
    ds_read_b128 v[180:183], v234 offset:4160
    ds_read_b128 v[184:187], v235 offset:4160
    s_add_u32 m0, s52, 2080
    v_exp_f32 v146, v162
    v_exp_f32 v147, v163
    v_rcp_f32 v132, v132
    v_rcp_f32 v133, v133
    v_mfma_f32_4x4x4_16b_bf16 v[144:147], v[228:229], v[228:229], v[144:147]
    v_rcp_f32 v134, v134
    v_cvt_pk_bf16_f32 v132, v132, v133
    s_waitcnt lgkmcnt(0)
    v_mfma_f32_16x16x32_bf16 v[148:151], v[100:103], v[180:183], v[164:167]
    v_rcp_f32 v135, v135
    v_mfma_f32_16x16x32_bf16 v[152:155], v[108:111], v[180:183], v[168:171]
    v_rcp_f32 v136, v136
    v_cvt_pk_bf16_f32 v133, v134, v135
    v_mfma_f32_16x16x32_bf16 v[148:151], v[104:107], v[184:187], v[148:151]
    v_rcp_f32 v137, v137
    v_mfma_f32_16x16x32_bf16 v[152:155], v[112:115], v[184:187], v[152:155]
    v_rcp_f32 v138, v138
    v_cvt_pk_bf16_f32 v134, v136, v137
    v_mfma_f32_16x16x32_bf16 v[156:159], v[116:119], v[180:183], v[172:175]
    v_rcp_f32 v139, v139
    v_mfma_f32_16x16x32_bf16 v[160:163], v[124:127], v[180:183], v[176:179]
    v_rcp_f32 v140, v140
    v_cvt_pk_bf16_f32 v135, v138, v139
    v_mfma_f32_16x16x32_bf16 v[156:159], v[120:123], v[184:187], v[156:159]
    v_rcp_f32 v141, v141
    v_mfma_f32_16x16x32_bf16 v[160:163], v[128:131], v[184:187], v[160:163]
    v_rcp_f32 v142, v142
    v_cvt_pk_bf16_f32 v136, v140, v141
    v_mfma_f32_16x16x32_bf16 v[208:211], v[132:135], v[196:199], v[204:207]
    v_rcp_f32 v143, v143
    v_rcp_f32 v144, v144
    v_cvt_pk_bf16_f32 v137, v142, v143
    v_rcp_f32 v145, v145
    v_rcp_f32 v146, v146
    v_rcp_f32 v147, v147
    v_cvt_pk_bf16_f32 v138, v144, v145
    v_cvt_pk_bf16_f32 v139, v146, v147
    buffer_load_dwordx4 v[230:231], s[20:23], s35 idxen offen nt lds
    buffer_load_dwordx4 v[232:233], s[40:43], s35 idxen offen offset:1056 nt lds
    s_bitcmp1_b32 s36, 2
    s_cbranch_scc1 Ls_ev2
Ls_evd2:
    v_mfma_f32_16x16x32_bf16 v[208:211], v[136:139], v[200:203], v[208:211]
    ds_read_b32 v246, v244 offset:32
    s_waitcnt lgkmcnt(0)
    v_bfe_u32 v247, v246, 0, 8
    v_lshlrev_b32 v247, 1, v247
    v_bfe_u32 v248, v246, 8, 8
    v_lshlrev_b32 v248, 1, v248
    v_bfe_u32 v249, v246, 16, 8
    v_lshlrev_b32 v249, 1, v249
    v_bfe_u32 v250, v246, 24, 8
    v_lshlrev_b32 v250, 1, v250
    buffer_load_ushort v247, v247, s[24:27], 0 offen
    buffer_load_ushort v248, v248, s[24:27], 0 offen
    buffer_load_ushort v249, v249, s[24:27], 0 offen
    buffer_load_ushort v250, v250, s[24:27], 0 offen
    s_waitcnt vmcnt(0)
    v_lshlrev_b32 v247, 16, v247
    v_mul_f32 v208, v208, v247
    v_lshlrev_b32 v248, 16, v248
    v_mul_f32 v209, v209, v248
    v_lshlrev_b32 v249, 16, v249
    v_mul_f32 v210, v210, v249
    v_lshlrev_b32 v250, 16, v250
    v_mul_f32 v211, v211, v250
    v_exp_f32 v132, v148
    v_exp_f32 v133, v149
    v_exp_f32 v134, v150
    v_exp_f32 v135, v151
    v_exp_f32 v136, v152
    v_exp_f32 v137, v153
    v_mfma_f32_4x4x4_16b_bf16 v[132:135], v[228:229], v[228:229], v[132:135]
    v_exp_f32 v138, v154
    v_exp_f32 v139, v155
    v_cvt_pk_bf16_f32 v208, v208, v209
    v_cvt_pk_bf16_f32 v209, v210, v211
    v_exp_f32 v140, v156
    v_exp_f32 v141, v157
    v_mfma_f32_4x4x4_16b_bf16 v[212:215], v[208:209], v[188:189], v[212:215] cbsz:4 abid:0
    v_mfma_f32_4x4x4_16b_bf16 v[136:139], v[228:229], v[228:229], v[136:139]
    v_exp_f32 v142, v158
    v_mfma_f32_4x4x4_16b_bf16 v[212:215], v[208:209], v[190:191], v[212:215] cbsz:4 abid:4
    v_exp_f32 v143, v159
    v_exp_f32 v144, v160
    v_mfma_f32_4x4x4_16b_bf16 v[212:215], v[208:209], v[192:193], v[212:215] cbsz:4 abid:8
    v_exp_f32 v145, v161
    v_mfma_f32_4x4x4_16b_bf16 v[140:143], v[228:229], v[228:229], v[140:143]
    v_mfma_f32_4x4x4_16b_bf16 v[212:215], v[208:209], v[194:195], v[212:215] cbsz:4 abid:12
    ds_read_u8 v230, v237 offset:96
    ds_read_u8 v232, v237 offset:104
    ds_read_b64_tr_b16 v[188:189], v236 offset:4160
    ds_read_b64_tr_b16 v[190:191], v236 offset:4672
    ds_read_b64_tr_b16 v[192:193], v236 offset:5216
    ds_read_b64_tr_b16 v[194:195], v236 offset:5728
    s_waitcnt vmcnt(4)
    ds_read_b128 v[180:183], v234 offset:6240
    ds_read_b128 v[184:187], v235 offset:6240
    s_add_u32 m0, s52, 4160
    v_exp_f32 v146, v162
    v_exp_f32 v147, v163
    v_rcp_f32 v132, v132
    v_rcp_f32 v133, v133
    v_mfma_f32_4x4x4_16b_bf16 v[144:147], v[228:229], v[228:229], v[144:147]
    v_rcp_f32 v134, v134
    v_cvt_pk_bf16_f32 v132, v132, v133
    s_waitcnt lgkmcnt(0)
    v_mfma_f32_16x16x32_bf16 v[148:151], v[100:103], v[180:183], v[164:167]
    v_rcp_f32 v135, v135
    v_mfma_f32_16x16x32_bf16 v[152:155], v[108:111], v[180:183], v[168:171]
    v_rcp_f32 v136, v136
    v_cvt_pk_bf16_f32 v133, v134, v135
    v_mfma_f32_16x16x32_bf16 v[148:151], v[104:107], v[184:187], v[148:151]
    v_rcp_f32 v137, v137
    v_mfma_f32_16x16x32_bf16 v[152:155], v[112:115], v[184:187], v[152:155]
    v_rcp_f32 v138, v138
    v_cvt_pk_bf16_f32 v134, v136, v137
    v_mfma_f32_16x16x32_bf16 v[156:159], v[116:119], v[180:183], v[172:175]
    v_rcp_f32 v139, v139
    v_mfma_f32_16x16x32_bf16 v[160:163], v[124:127], v[180:183], v[176:179]
    v_rcp_f32 v140, v140
    v_cvt_pk_bf16_f32 v135, v138, v139
    v_mfma_f32_16x16x32_bf16 v[156:159], v[120:123], v[184:187], v[156:159]
    v_rcp_f32 v141, v141
    v_mfma_f32_16x16x32_bf16 v[160:163], v[128:131], v[184:187], v[160:163]
    v_rcp_f32 v142, v142
    v_cvt_pk_bf16_f32 v136, v140, v141
    v_mfma_f32_16x16x32_bf16 v[208:211], v[132:135], v[196:199], v[204:207]
    v_rcp_f32 v143, v143
    v_rcp_f32 v144, v144
    v_cvt_pk_bf16_f32 v137, v142, v143
    v_rcp_f32 v145, v145
    v_rcp_f32 v146, v146
    v_rcp_f32 v147, v147
    v_cvt_pk_bf16_f32 v138, v144, v145
    v_cvt_pk_bf16_f32 v139, v146, v147
    buffer_load_dwordx4 v[230:231], s[20:23], s35 idxen offen nt lds
    buffer_load_dwordx4 v[232:233], s[40:43], s35 idxen offen offset:1056 nt lds
    s_bitcmp1_b32 s36, 3
    s_cbranch_scc1 Ls_ev3
Ls_evd3:
    v_mfma_f32_16x16x32_bf16 v[208:211], v[136:139], v[200:203], v[208:211]
    ds_read_b32 v246, v244 offset:48
    s_waitcnt lgkmcnt(0)
    v_bfe_u32 v247, v246, 0, 8
    v_lshlrev_b32 v247, 1, v247
    v_bfe_u32 v248, v246, 8, 8
    v_lshlrev_b32 v248, 1, v248
    v_bfe_u32 v249, v246, 16, 8
    v_lshlrev_b32 v249, 1, v249
    v_bfe_u32 v250, v246, 24, 8
    v_lshlrev_b32 v250, 1, v250
    buffer_load_ushort v247, v247, s[24:27], 0 offen
    buffer_load_ushort v248, v248, s[24:27], 0 offen
    buffer_load_ushort v249, v249, s[24:27], 0 offen
    buffer_load_ushort v250, v250, s[24:27], 0 offen
    s_waitcnt vmcnt(0)
    v_lshlrev_b32 v247, 16, v247
    v_mul_f32 v208, v208, v247
    v_lshlrev_b32 v248, 16, v248
    v_mul_f32 v209, v209, v248
    v_lshlrev_b32 v249, 16, v249
    v_mul_f32 v210, v210, v249
    v_lshlrev_b32 v250, 16, v250
    v_mul_f32 v211, v211, v250
    v_exp_f32 v132, v148
    v_exp_f32 v133, v149
    v_exp_f32 v134, v150
    v_exp_f32 v135, v151
    v_exp_f32 v136, v152
    v_exp_f32 v137, v153
    v_mfma_f32_4x4x4_16b_bf16 v[132:135], v[228:229], v[228:229], v[132:135]
    v_exp_f32 v138, v154
    v_exp_f32 v139, v155
    v_cvt_pk_bf16_f32 v208, v208, v209
    v_cvt_pk_bf16_f32 v209, v210, v211
    v_exp_f32 v140, v156
    v_exp_f32 v141, v157
    v_mfma_f32_4x4x4_16b_bf16 v[212:215], v[208:209], v[188:189], v[212:215] cbsz:4 abid:0
    v_mfma_f32_4x4x4_16b_bf16 v[136:139], v[228:229], v[228:229], v[136:139]
    v_exp_f32 v142, v158
    v_mfma_f32_4x4x4_16b_bf16 v[212:215], v[208:209], v[190:191], v[212:215] cbsz:4 abid:4
    v_exp_f32 v143, v159
    v_exp_f32 v144, v160
    v_mfma_f32_4x4x4_16b_bf16 v[212:215], v[208:209], v[192:193], v[212:215] cbsz:4 abid:8
    v_exp_f32 v145, v161
    v_mfma_f32_4x4x4_16b_bf16 v[140:143], v[228:229], v[228:229], v[140:143]
    v_mfma_f32_4x4x4_16b_bf16 v[212:215], v[208:209], v[194:195], v[212:215] cbsz:4 abid:12
    ds_read_u8 v230, v237 offset:112
    ds_read_u8 v232, v237 offset:120
    ds_read_b64_tr_b16 v[188:189], v236 offset:6240
    ds_read_b64_tr_b16 v[190:191], v236 offset:6752
    ds_read_b64_tr_b16 v[192:193], v236 offset:7296
    ds_read_b64_tr_b16 v[194:195], v236 offset:7808
    s_waitcnt vmcnt(4)
    ds_read_b128 v[180:183], v234 offset:0
    ds_read_b128 v[184:187], v235 offset:0
    s_add_u32 m0, s52, 6240
    v_exp_f32 v146, v162
    v_exp_f32 v147, v163
    v_rcp_f32 v132, v132
    v_rcp_f32 v133, v133
    v_mfma_f32_4x4x4_16b_bf16 v[144:147], v[228:229], v[228:229], v[144:147]
    v_rcp_f32 v134, v134
    v_cvt_pk_bf16_f32 v132, v132, v133
    s_waitcnt lgkmcnt(0)
    v_mfma_f32_16x16x32_bf16 v[148:151], v[100:103], v[180:183], v[164:167]
    v_rcp_f32 v135, v135
    v_mfma_f32_16x16x32_bf16 v[152:155], v[108:111], v[180:183], v[168:171]
    v_rcp_f32 v136, v136
    v_cvt_pk_bf16_f32 v133, v134, v135
    v_mfma_f32_16x16x32_bf16 v[148:151], v[104:107], v[184:187], v[148:151]
    v_rcp_f32 v137, v137
    v_mfma_f32_16x16x32_bf16 v[152:155], v[112:115], v[184:187], v[152:155]
    v_rcp_f32 v138, v138
    v_cvt_pk_bf16_f32 v134, v136, v137
    v_mfma_f32_16x16x32_bf16 v[156:159], v[116:119], v[180:183], v[172:175]
    v_rcp_f32 v139, v139
    v_mfma_f32_16x16x32_bf16 v[160:163], v[124:127], v[180:183], v[176:179]
    v_rcp_f32 v140, v140
    v_cvt_pk_bf16_f32 v135, v138, v139
    v_mfma_f32_16x16x32_bf16 v[156:159], v[120:123], v[184:187], v[156:159]
    v_rcp_f32 v141, v141
    v_mfma_f32_16x16x32_bf16 v[160:163], v[128:131], v[184:187], v[160:163]
    v_rcp_f32 v142, v142
    v_cvt_pk_bf16_f32 v136, v140, v141
    v_mfma_f32_16x16x32_bf16 v[208:211], v[132:135], v[196:199], v[204:207]
    v_rcp_f32 v143, v143
    v_rcp_f32 v144, v144
    v_cvt_pk_bf16_f32 v137, v142, v143
    s_lshr_b64 s[56:57], s[56:57], 4
    s_lshr_b64 s[86:87], s[56:57], 2
    s_lshr_b64 s[36:37], s[56:57], 5
    s_or_b32 s37, s36, s86
    s_or_b32 s36, s37, s56
    v_add_u32 v237, 64, v237
    v_add_u32 v244, 64, v244
    v_rcp_f32 v145, v145
    v_rcp_f32 v146, v146
    v_rcp_f32 v147, v147
    v_cvt_pk_bf16_f32 v138, v144, v145
    v_cvt_pk_bf16_f32 v139, v146, v147
    buffer_load_dwordx4 v[230:231], s[20:23], s35 idxen offen nt lds
    buffer_load_dwordx4 v[232:233], s[40:43], s35 idxen offen offset:1056 nt lds
    s_branch Ls_loop
Ls_fl0:
    v_cvt_pk_bf16_f32 v246, v212, v212
    v_mov_b32 v212, 0
    ds_write_b16 v240, v246
    v_add_u32 v240, 128, v240
    s_add_u32 s24, s24, s32
    s_addc_u32 s25, s25, 0
    s_xor_b32 s32, s32, 0x18ffe0
    s_bitcmp0_b32 s37, 0
    s_cbranch_scc1 Ls_evd0
    s_branch Ls_ev20
Ls_ev0:
    s_bitcmp1_b64 s[56:57], 0
    s_cbranch_scc1 Ls_fl0
Ls_ev20:
    s_bitcmp1_b64 s[56:57], 2
    s_cbranch_scc1 Ls_w0
    s_sub_u32 s60, s60, 1
    s_cbranch_scc0 Ls_nsa0
    s_mov_b32 s49, 5
    s_call_b64 s[62:63], L_swap
Ls_nsa0:
    s_add_u32 s35, s35, s31
    s_min_u32 s35, s35, 419404800
    s_xor_b32 s31, s31, 0x63ff800
    s_branch Ls_evd0
Ls_w0:
    s_bitcmp0_b64 s[56:57], 5
    s_cbranch_scc1 Ls_e10
    s_sub_u32 s60, s60, 1
    s_cbranch_scc0 Ls_nsb0
    s_mov_b32 s49, 5
    s_call_b64 s[62:63], L_swap
    s_waitcnt lgkmcnt(0)
Ls_nsb0:
    s_add_u32 s35, s35, s31
    s_min_u32 s35, s35, 419404800
    s_xor_b32 s31, s31, 0x63ff800
Ls_e10:
    s_sub_u32 s61, s61, 1
    s_cbranch_scc1 Ls_last0
    s_bitcmp0_b32 s33, s61
    s_cbranch_scc1 Ls_nw0
    s_cmp_eq_u32 s61, 3
    s_cselect_b32 s66, s80, s81
    v_add_u32 v238, s66, v238
    v_add_u32 v239, s66, v239
    ds_read_u16 v224, v238 offset:0
    ds_read_u16 v225, v238 offset:8
    ds_read_u16 v226, v238 offset:64
    ds_read_u16 v227, v238 offset:72
    s_waitcnt lgkmcnt(0)
Ls_nw0:
    v_mul_u32_u24 v216, v224, v241
    v_mul_u32_u24 v217, v224, v242
    v_mul_u32_u24 v218, v225, v241
    v_mul_u32_u24 v219, v225, v242
    v_mul_u32_u24 v220, v226, v241
    v_mul_u32_u24 v221, v226, v242
    v_mul_u32_u24 v222, v227, v241
    v_mul_u32_u24 v223, v227, v242
    v_mfma_f32_4x4x4_16b_bf16 v[140:143], v[216:217], v[68:69], v[4:7]
    v_add_u32 v238, 128, v238
    ds_read_b128 v[164:167], v239 offset:0
    ds_read_b128 v[168:171], v239 offset:64
    v_mfma_f32_4x4x4_16b_bf16 v[144:147], v[218:219], v[70:71], v[8:11]
    ds_read_b128 v[172:175], v239 offset:128
    ds_read_b128 v[176:179], v239 offset:192
    ds_read_u16 v224, v238 offset:0
    ds_read_u16 v225, v238 offset:8
    ds_read_u16 v226, v238 offset:64
    ds_read_u16 v227, v238 offset:72
    v_mfma_f32_4x4x4_16b_bf16 v[246:249], v[220:221], v[72:73], v[12:15]
    v_cvt_pk_bf16_f32 v100, v140, v141
    v_cvt_pk_bf16_f32 v101, v142, v143
    v_mfma_f32_4x4x4_16b_bf16 v[250:253], v[222:223], v[74:75], v[16:19]
    v_cvt_pk_bf16_f32 v102, v144, v145
    v_cvt_pk_bf16_f32 v103, v146, v147
    v_mfma_f32_4x4x4_16b_bf16 v[140:143], v[216:217], v[76:77], v[20:23]
    v_cvt_pk_bf16_f32 v104, v246, v247
    v_cvt_pk_bf16_f32 v105, v248, v249
    v_mfma_f32_4x4x4_16b_bf16 v[144:147], v[218:219], v[78:79], v[24:27]
    v_cvt_pk_bf16_f32 v106, v250, v251
    v_cvt_pk_bf16_f32 v107, v252, v253
    v_mfma_f32_4x4x4_16b_bf16 v[246:249], v[220:221], v[80:81], v[28:31]
    v_cvt_pk_bf16_f32 v108, v140, v141
    v_cvt_pk_bf16_f32 v109, v142, v143
    v_mfma_f32_4x4x4_16b_bf16 v[250:253], v[222:223], v[82:83], v[32:35]
    v_cvt_pk_bf16_f32 v110, v144, v145
    v_cvt_pk_bf16_f32 v111, v146, v147
    v_mfma_f32_4x4x4_16b_bf16 v[140:143], v[216:217], v[84:85], v[36:39]
    v_cvt_pk_bf16_f32 v112, v246, v247
    v_cvt_pk_bf16_f32 v113, v248, v249
    v_mfma_f32_4x4x4_16b_bf16 v[144:147], v[218:219], v[86:87], v[40:43]
    v_cvt_pk_bf16_f32 v114, v250, v251
    v_cvt_pk_bf16_f32 v115, v252, v253
    v_mfma_f32_4x4x4_16b_bf16 v[246:249], v[220:221], v[88:89], v[44:47]
    v_cvt_pk_bf16_f32 v116, v140, v141
    v_cvt_pk_bf16_f32 v117, v142, v143
    v_mfma_f32_4x4x4_16b_bf16 v[250:253], v[222:223], v[90:91], v[48:51]
    v_cvt_pk_bf16_f32 v118, v144, v145
    v_cvt_pk_bf16_f32 v119, v146, v147
    v_mfma_f32_4x4x4_16b_bf16 v[140:143], v[216:217], v[92:93], v[52:55]
    v_cvt_pk_bf16_f32 v120, v246, v247
    v_cvt_pk_bf16_f32 v121, v248, v249
    v_mfma_f32_4x4x4_16b_bf16 v[144:147], v[218:219], v[94:95], v[56:59]
    v_cvt_pk_bf16_f32 v122, v250, v251
    v_cvt_pk_bf16_f32 v123, v252, v253
    v_mfma_f32_4x4x4_16b_bf16 v[246:249], v[220:221], v[96:97], v[60:63]
    v_cvt_pk_bf16_f32 v124, v140, v141
    v_cvt_pk_bf16_f32 v125, v142, v143
    v_mfma_f32_4x4x4_16b_bf16 v[250:253], v[222:223], v[98:99], v[64:67]
    v_cvt_pk_bf16_f32 v126, v144, v145
    v_cvt_pk_bf16_f32 v127, v146, v147
    v_cvt_pk_bf16_f32 v128, v246, v247
    v_cvt_pk_bf16_f32 v129, v248, v249
    v_add_u32 v239, 272, v239
    v_cvt_pk_bf16_f32 v130, v250, v251
    v_cvt_pk_bf16_f32 v131, v252, v253
    s_waitcnt lgkmcnt(0)
    s_branch Ls_evd0
Ls_fl1:
    v_cvt_pk_bf16_f32 v246, v212, v212
    v_mov_b32 v212, 0
    ds_write_b16 v240, v246
    v_add_u32 v240, 128, v240
    s_add_u32 s24, s24, s32
    s_addc_u32 s25, s25, 0
    s_xor_b32 s32, s32, 0x18ffe0
    s_bitcmp0_b32 s37, 1
    s_cbranch_scc1 Ls_evd1
    s_branch Ls_ev21
Ls_ev1:
    s_bitcmp1_b64 s[56:57], 1
    s_cbranch_scc1 Ls_fl1
Ls_ev21:
    s_bitcmp1_b64 s[56:57], 3
    s_cbranch_scc1 Ls_w1
    s_sub_u32 s60, s60, 1
    s_cbranch_scc0 Ls_nsa1
    s_mov_b32 s49, 6
    s_call_b64 s[62:63], L_swap
Ls_nsa1:
    s_add_u32 s35, s35, s31
    s_min_u32 s35, s35, 419404800
    s_xor_b32 s31, s31, 0x63ff800
    s_branch Ls_evd1
Ls_w1:
    s_bitcmp0_b64 s[56:57], 6
    s_cbranch_scc1 Ls_e11
    s_sub_u32 s60, s60, 1
    s_cbranch_scc0 Ls_nsb1
    s_mov_b32 s49, 6
    s_call_b64 s[62:63], L_swap
    s_waitcnt lgkmcnt(0)
Ls_nsb1:
    s_add_u32 s35, s35, s31
    s_min_u32 s35, s35, 419404800
    s_xor_b32 s31, s31, 0x63ff800
Ls_e11:
    s_sub_u32 s61, s61, 1
    s_cbranch_scc1 Ls_last1
    s_bitcmp0_b32 s33, s61
    s_cbranch_scc1 Ls_nw1
    s_cmp_eq_u32 s61, 3
    s_cselect_b32 s66, s80, s81
    v_add_u32 v238, s66, v238
    v_add_u32 v239, s66, v239
    ds_read_u16 v224, v238 offset:0
    ds_read_u16 v225, v238 offset:8
    ds_read_u16 v226, v238 offset:64
    ds_read_u16 v227, v238 offset:72
    s_waitcnt lgkmcnt(0)
Ls_nw1:
    v_mul_u32_u24 v216, v224, v241
    v_mul_u32_u24 v217, v224, v242
    v_mul_u32_u24 v218, v225, v241
    v_mul_u32_u24 v219, v225, v242
    v_mul_u32_u24 v220, v226, v241
    v_mul_u32_u24 v221, v226, v242
    v_mul_u32_u24 v222, v227, v241
    v_mul_u32_u24 v223, v227, v242
    v_mfma_f32_4x4x4_16b_bf16 v[140:143], v[216:217], v[68:69], v[4:7]
    v_add_u32 v238, 128, v238
    ds_read_b128 v[164:167], v239 offset:0
    ds_read_b128 v[168:171], v239 offset:64
    v_mfma_f32_4x4x4_16b_bf16 v[144:147], v[218:219], v[70:71], v[8:11]
    ds_read_b128 v[172:175], v239 offset:128
    ds_read_b128 v[176:179], v239 offset:192
    ds_read_u16 v224, v238 offset:0
    ds_read_u16 v225, v238 offset:8
    ds_read_u16 v226, v238 offset:64
    ds_read_u16 v227, v238 offset:72
    v_mfma_f32_4x4x4_16b_bf16 v[246:249], v[220:221], v[72:73], v[12:15]
    v_cvt_pk_bf16_f32 v100, v140, v141
    v_cvt_pk_bf16_f32 v101, v142, v143
    v_mfma_f32_4x4x4_16b_bf16 v[250:253], v[222:223], v[74:75], v[16:19]
    v_cvt_pk_bf16_f32 v102, v144, v145
    v_cvt_pk_bf16_f32 v103, v146, v147
    v_mfma_f32_4x4x4_16b_bf16 v[140:143], v[216:217], v[76:77], v[20:23]
    v_cvt_pk_bf16_f32 v104, v246, v247
    v_cvt_pk_bf16_f32 v105, v248, v249
    v_mfma_f32_4x4x4_16b_bf16 v[144:147], v[218:219], v[78:79], v[24:27]
    v_cvt_pk_bf16_f32 v106, v250, v251
    v_cvt_pk_bf16_f32 v107, v252, v253
    v_mfma_f32_4x4x4_16b_bf16 v[246:249], v[220:221], v[80:81], v[28:31]
    v_cvt_pk_bf16_f32 v108, v140, v141
    v_cvt_pk_bf16_f32 v109, v142, v143
    v_mfma_f32_4x4x4_16b_bf16 v[250:253], v[222:223], v[82:83], v[32:35]
    v_cvt_pk_bf16_f32 v110, v144, v145
    v_cvt_pk_bf16_f32 v111, v146, v147
    v_mfma_f32_4x4x4_16b_bf16 v[140:143], v[216:217], v[84:85], v[36:39]
    v_cvt_pk_bf16_f32 v112, v246, v247
    v_cvt_pk_bf16_f32 v113, v248, v249
    v_mfma_f32_4x4x4_16b_bf16 v[144:147], v[218:219], v[86:87], v[40:43]
    v_cvt_pk_bf16_f32 v114, v250, v251
    v_cvt_pk_bf16_f32 v115, v252, v253
    v_mfma_f32_4x4x4_16b_bf16 v[246:249], v[220:221], v[88:89], v[44:47]
    v_cvt_pk_bf16_f32 v116, v140, v141
    v_cvt_pk_bf16_f32 v117, v142, v143
    v_mfma_f32_4x4x4_16b_bf16 v[250:253], v[222:223], v[90:91], v[48:51]
    v_cvt_pk_bf16_f32 v118, v144, v145
    v_cvt_pk_bf16_f32 v119, v146, v147
    v_mfma_f32_4x4x4_16b_bf16 v[140:143], v[216:217], v[92:93], v[52:55]
    v_cvt_pk_bf16_f32 v120, v246, v247
    v_cvt_pk_bf16_f32 v121, v248, v249
    v_mfma_f32_4x4x4_16b_bf16 v[144:147], v[218:219], v[94:95], v[56:59]
    v_cvt_pk_bf16_f32 v122, v250, v251
    v_cvt_pk_bf16_f32 v123, v252, v253
    v_mfma_f32_4x4x4_16b_bf16 v[246:249], v[220:221], v[96:97], v[60:63]
    v_cvt_pk_bf16_f32 v124, v140, v141
    v_cvt_pk_bf16_f32 v125, v142, v143
    v_mfma_f32_4x4x4_16b_bf16 v[250:253], v[222:223], v[98:99], v[64:67]
    v_cvt_pk_bf16_f32 v126, v144, v145
    v_cvt_pk_bf16_f32 v127, v146, v147
    v_cvt_pk_bf16_f32 v128, v246, v247
    v_cvt_pk_bf16_f32 v129, v248, v249
    v_add_u32 v239, 272, v239
    v_cvt_pk_bf16_f32 v130, v250, v251
    v_cvt_pk_bf16_f32 v131, v252, v253
    s_waitcnt lgkmcnt(0)
    s_branch Ls_evd1
Ls_fl2:
    v_cvt_pk_bf16_f32 v246, v212, v212
    v_mov_b32 v212, 0
    ds_write_b16 v240, v246
    v_add_u32 v240, 128, v240
    s_add_u32 s24, s24, s32
    s_addc_u32 s25, s25, 0
    s_xor_b32 s32, s32, 0x18ffe0
    s_bitcmp0_b32 s37, 2
    s_cbranch_scc1 Ls_evd2
    s_branch Ls_ev22
Ls_ev2:
    s_bitcmp1_b64 s[56:57], 2
    s_cbranch_scc1 Ls_fl2
Ls_ev22:
    s_bitcmp1_b64 s[56:57], 4
    s_cbranch_scc1 Ls_w2
    s_sub_u32 s60, s60, 1
    s_cbranch_scc0 Ls_nsa2
    s_mov_b32 s49, 7
    s_call_b64 s[62:63], L_swap
Ls_nsa2:
    s_add_u32 s35, s35, s31
    s_min_u32 s35, s35, 419404800
    s_xor_b32 s31, s31, 0x63ff800
    s_branch Ls_evd2
Ls_w2:
    s_bitcmp0_b64 s[56:57], 7
    s_cbranch_scc1 Ls_e12
    s_sub_u32 s60, s60, 1
    s_cbranch_scc0 Ls_nsb2
    s_mov_b32 s49, 7
    s_call_b64 s[62:63], L_swap
    s_waitcnt lgkmcnt(0)
Ls_nsb2:
    s_add_u32 s35, s35, s31
    s_min_u32 s35, s35, 419404800
    s_xor_b32 s31, s31, 0x63ff800
Ls_e12:
    s_sub_u32 s61, s61, 1
    s_cbranch_scc1 Ls_last2
    s_bitcmp0_b32 s33, s61
    s_cbranch_scc1 Ls_nw2
    s_cmp_eq_u32 s61, 3
    s_cselect_b32 s66, s80, s81
    v_add_u32 v238, s66, v238
    v_add_u32 v239, s66, v239
    ds_read_u16 v224, v238 offset:0
    ds_read_u16 v225, v238 offset:8
    ds_read_u16 v226, v238 offset:64
    ds_read_u16 v227, v238 offset:72
    s_waitcnt lgkmcnt(0)
Ls_nw2:
    v_mul_u32_u24 v216, v224, v241
    v_mul_u32_u24 v217, v224, v242
    v_mul_u32_u24 v218, v225, v241
    v_mul_u32_u24 v219, v225, v242
    v_mul_u32_u24 v220, v226, v241
    v_mul_u32_u24 v221, v226, v242
    v_mul_u32_u24 v222, v227, v241
    v_mul_u32_u24 v223, v227, v242
    v_mfma_f32_4x4x4_16b_bf16 v[140:143], v[216:217], v[68:69], v[4:7]
    v_add_u32 v238, 128, v238
    ds_read_b128 v[164:167], v239 offset:0
    ds_read_b128 v[168:171], v239 offset:64
    v_mfma_f32_4x4x4_16b_bf16 v[144:147], v[218:219], v[70:71], v[8:11]
    ds_read_b128 v[172:175], v239 offset:128
    ds_read_b128 v[176:179], v239 offset:192
    ds_read_u16 v224, v238 offset:0
    ds_read_u16 v225, v238 offset:8
    ds_read_u16 v226, v238 offset:64
    ds_read_u16 v227, v238 offset:72
    v_mfma_f32_4x4x4_16b_bf16 v[246:249], v[220:221], v[72:73], v[12:15]
    v_cvt_pk_bf16_f32 v100, v140, v141
    v_cvt_pk_bf16_f32 v101, v142, v143
    v_mfma_f32_4x4x4_16b_bf16 v[250:253], v[222:223], v[74:75], v[16:19]
    v_cvt_pk_bf16_f32 v102, v144, v145
    v_cvt_pk_bf16_f32 v103, v146, v147
    v_mfma_f32_4x4x4_16b_bf16 v[140:143], v[216:217], v[76:77], v[20:23]
    v_cvt_pk_bf16_f32 v104, v246, v247
    v_cvt_pk_bf16_f32 v105, v248, v249
    v_mfma_f32_4x4x4_16b_bf16 v[144:147], v[218:219], v[78:79], v[24:27]
    v_cvt_pk_bf16_f32 v106, v250, v251
    v_cvt_pk_bf16_f32 v107, v252, v253
    v_mfma_f32_4x4x4_16b_bf16 v[246:249], v[220:221], v[80:81], v[28:31]
    v_cvt_pk_bf16_f32 v108, v140, v141
    v_cvt_pk_bf16_f32 v109, v142, v143
    v_mfma_f32_4x4x4_16b_bf16 v[250:253], v[222:223], v[82:83], v[32:35]
    v_cvt_pk_bf16_f32 v110, v144, v145
    v_cvt_pk_bf16_f32 v111, v146, v147
    v_mfma_f32_4x4x4_16b_bf16 v[140:143], v[216:217], v[84:85], v[36:39]
    v_cvt_pk_bf16_f32 v112, v246, v247
    v_cvt_pk_bf16_f32 v113, v248, v249
    v_mfma_f32_4x4x4_16b_bf16 v[144:147], v[218:219], v[86:87], v[40:43]
    v_cvt_pk_bf16_f32 v114, v250, v251
    v_cvt_pk_bf16_f32 v115, v252, v253
    v_mfma_f32_4x4x4_16b_bf16 v[246:249], v[220:221], v[88:89], v[44:47]
    v_cvt_pk_bf16_f32 v116, v140, v141
    v_cvt_pk_bf16_f32 v117, v142, v143
    v_mfma_f32_4x4x4_16b_bf16 v[250:253], v[222:223], v[90:91], v[48:51]
    v_cvt_pk_bf16_f32 v118, v144, v145
    v_cvt_pk_bf16_f32 v119, v146, v147
    v_mfma_f32_4x4x4_16b_bf16 v[140:143], v[216:217], v[92:93], v[52:55]
    v_cvt_pk_bf16_f32 v120, v246, v247
    v_cvt_pk_bf16_f32 v121, v248, v249
    v_mfma_f32_4x4x4_16b_bf16 v[144:147], v[218:219], v[94:95], v[56:59]
    v_cvt_pk_bf16_f32 v122, v250, v251
    v_cvt_pk_bf16_f32 v123, v252, v253
    v_mfma_f32_4x4x4_16b_bf16 v[246:249], v[220:221], v[96:97], v[60:63]
    v_cvt_pk_bf16_f32 v124, v140, v141
    v_cvt_pk_bf16_f32 v125, v142, v143
    v_mfma_f32_4x4x4_16b_bf16 v[250:253], v[222:223], v[98:99], v[64:67]
    v_cvt_pk_bf16_f32 v126, v144, v145
    v_cvt_pk_bf16_f32 v127, v146, v147
    v_cvt_pk_bf16_f32 v128, v246, v247
    v_cvt_pk_bf16_f32 v129, v248, v249
    v_add_u32 v239, 272, v239
    v_cvt_pk_bf16_f32 v130, v250, v251
    v_cvt_pk_bf16_f32 v131, v252, v253
    s_waitcnt lgkmcnt(0)
    s_branch Ls_evd2
Ls_fl3:
    v_cvt_pk_bf16_f32 v246, v212, v212
    v_mov_b32 v212, 0
    ds_write_b16 v240, v246
    v_add_u32 v240, 128, v240
    s_add_u32 s24, s24, s32
    s_addc_u32 s25, s25, 0
    s_xor_b32 s32, s32, 0x18ffe0
    s_bitcmp0_b32 s37, 3
    s_cbranch_scc1 Ls_evd3
    s_branch Ls_ev23
Ls_ev3:
    s_bitcmp1_b64 s[56:57], 3
    s_cbranch_scc1 Ls_fl3
Ls_ev23:
    s_bitcmp1_b64 s[56:57], 5
    s_cbranch_scc1 Ls_w3
    s_sub_u32 s60, s60, 1
    s_cbranch_scc0 Ls_nsa3
    s_mov_b32 s49, 8
    s_call_b64 s[62:63], L_swap
Ls_nsa3:
    s_add_u32 s35, s35, s31
    s_min_u32 s35, s35, 419404800
    s_xor_b32 s31, s31, 0x63ff800
    s_branch Ls_evd3
Ls_w3:
    s_bitcmp0_b64 s[56:57], 8
    s_cbranch_scc1 Ls_e13
    s_sub_u32 s60, s60, 1
    s_cbranch_scc0 Ls_nsb3
    s_mov_b32 s49, 8
    s_call_b64 s[62:63], L_swap
    s_waitcnt lgkmcnt(0)
Ls_nsb3:
    s_add_u32 s35, s35, s31
    s_min_u32 s35, s35, 419404800
    s_xor_b32 s31, s31, 0x63ff800
Ls_e13:
    s_sub_u32 s61, s61, 1
    s_cbranch_scc1 Ls_last3
    s_bitcmp0_b32 s33, s61
    s_cbranch_scc1 Ls_nw3
    s_cmp_eq_u32 s61, 3
    s_cselect_b32 s66, s80, s81
    v_add_u32 v238, s66, v238
    v_add_u32 v239, s66, v239
    ds_read_u16 v224, v238 offset:0
    ds_read_u16 v225, v238 offset:8
    ds_read_u16 v226, v238 offset:64
    ds_read_u16 v227, v238 offset:72
    s_waitcnt lgkmcnt(0)
Ls_nw3:
    v_mul_u32_u24 v216, v224, v241
    v_mul_u32_u24 v217, v224, v242
    v_mul_u32_u24 v218, v225, v241
    v_mul_u32_u24 v219, v225, v242
    v_mul_u32_u24 v220, v226, v241
    v_mul_u32_u24 v221, v226, v242
    v_mul_u32_u24 v222, v227, v241
    v_mul_u32_u24 v223, v227, v242
    v_mfma_f32_4x4x4_16b_bf16 v[140:143], v[216:217], v[68:69], v[4:7]
    v_add_u32 v238, 128, v238
    ds_read_b128 v[164:167], v239 offset:0
    ds_read_b128 v[168:171], v239 offset:64
    v_mfma_f32_4x4x4_16b_bf16 v[144:147], v[218:219], v[70:71], v[8:11]
    ds_read_b128 v[172:175], v239 offset:128
    ds_read_b128 v[176:179], v239 offset:192
    ds_read_u16 v224, v238 offset:0
    ds_read_u16 v225, v238 offset:8
    ds_read_u16 v226, v238 offset:64
    ds_read_u16 v227, v238 offset:72
    v_mfma_f32_4x4x4_16b_bf16 v[246:249], v[220:221], v[72:73], v[12:15]
    v_cvt_pk_bf16_f32 v100, v140, v141
    v_cvt_pk_bf16_f32 v101, v142, v143
    v_mfma_f32_4x4x4_16b_bf16 v[250:253], v[222:223], v[74:75], v[16:19]
    v_cvt_pk_bf16_f32 v102, v144, v145
    v_cvt_pk_bf16_f32 v103, v146, v147
    v_mfma_f32_4x4x4_16b_bf16 v[140:143], v[216:217], v[76:77], v[20:23]
    v_cvt_pk_bf16_f32 v104, v246, v247
    v_cvt_pk_bf16_f32 v105, v248, v249
    v_mfma_f32_4x4x4_16b_bf16 v[144:147], v[218:219], v[78:79], v[24:27]
    v_cvt_pk_bf16_f32 v106, v250, v251
    v_cvt_pk_bf16_f32 v107, v252, v253
    v_mfma_f32_4x4x4_16b_bf16 v[246:249], v[220:221], v[80:81], v[28:31]
    v_cvt_pk_bf16_f32 v108, v140, v141
    v_cvt_pk_bf16_f32 v109, v142, v143
    v_mfma_f32_4x4x4_16b_bf16 v[250:253], v[222:223], v[82:83], v[32:35]
    v_cvt_pk_bf16_f32 v110, v144, v145
    v_cvt_pk_bf16_f32 v111, v146, v147
    v_mfma_f32_4x4x4_16b_bf16 v[140:143], v[216:217], v[84:85], v[36:39]
    v_cvt_pk_bf16_f32 v112, v246, v247
    v_cvt_pk_bf16_f32 v113, v248, v249
    v_mfma_f32_4x4x4_16b_bf16 v[144:147], v[218:219], v[86:87], v[40:43]
    v_cvt_pk_bf16_f32 v114, v250, v251
    v_cvt_pk_bf16_f32 v115, v252, v253
    v_mfma_f32_4x4x4_16b_bf16 v[246:249], v[220:221], v[88:89], v[44:47]
    v_cvt_pk_bf16_f32 v116, v140, v141
    v_cvt_pk_bf16_f32 v117, v142, v143
    v_mfma_f32_4x4x4_16b_bf16 v[250:253], v[222:223], v[90:91], v[48:51]
    v_cvt_pk_bf16_f32 v118, v144, v145
    v_cvt_pk_bf16_f32 v119, v146, v147
    v_mfma_f32_4x4x4_16b_bf16 v[140:143], v[216:217], v[92:93], v[52:55]
    v_cvt_pk_bf16_f32 v120, v246, v247
    v_cvt_pk_bf16_f32 v121, v248, v249
    v_mfma_f32_4x4x4_16b_bf16 v[144:147], v[218:219], v[94:95], v[56:59]
    v_cvt_pk_bf16_f32 v122, v250, v251
    v_cvt_pk_bf16_f32 v123, v252, v253
    v_mfma_f32_4x4x4_16b_bf16 v[246:249], v[220:221], v[96:97], v[60:63]
    v_cvt_pk_bf16_f32 v124, v140, v141
    v_cvt_pk_bf16_f32 v125, v142, v143
    v_mfma_f32_4x4x4_16b_bf16 v[250:253], v[222:223], v[98:99], v[64:67]
    v_cvt_pk_bf16_f32 v126, v144, v145
    v_cvt_pk_bf16_f32 v127, v146, v147
    v_cvt_pk_bf16_f32 v128, v246, v247
    v_cvt_pk_bf16_f32 v129, v248, v249
    v_add_u32 v239, 272, v239
    v_cvt_pk_bf16_f32 v130, v250, v251
    v_cvt_pk_bf16_f32 v131, v252, v253
    s_waitcnt lgkmcnt(0)
    s_branch Ls_evd3
Ls_last0:
    s_branch Ls_tail
Ls_last1:
    v_add_u32 v236, 2080, v236
    s_lshr_b64 s[56:57], s[56:57], 1
    v_add_u32 v244, 16, v244
    s_branch Ls_tail
Ls_last2:
    v_add_u32 v236, 4160, v236
    s_lshr_b64 s[56:57], s[56:57], 2
    v_add_u32 v244, 32, v244
    s_branch Ls_tail
Ls_last3:
    v_add_u32 v236, 6240, v236
    s_lshr_b64 s[56:57], s[56:57], 3
    v_add_u32 v244, 48, v244
Ls_tail:
    v_mfma_f32_16x16x32_bf16 v[208:211], v[136:139], v[200:203], v[208:211]
    ds_read_b32 v246, v244 offset:0
    s_waitcnt lgkmcnt(0)
    v_bfe_u32 v247, v246, 0, 8
    v_lshlrev_b32 v247, 1, v247
    v_bfe_u32 v248, v246, 8, 8
    v_lshlrev_b32 v248, 1, v248
    v_bfe_u32 v249, v246, 16, 8
    v_lshlrev_b32 v249, 1, v249
    v_bfe_u32 v250, v246, 24, 8
    v_lshlrev_b32 v250, 1, v250
    buffer_load_ushort v247, v247, s[24:27], 0 offen
    buffer_load_ushort v248, v248, s[24:27], 0 offen
    buffer_load_ushort v249, v249, s[24:27], 0 offen
    buffer_load_ushort v250, v250, s[24:27], 0 offen
    s_waitcnt vmcnt(0)
    v_lshlrev_b32 v247, 16, v247
    v_mul_f32 v208, v208, v247
    v_lshlrev_b32 v248, 16, v248
    v_mul_f32 v209, v209, v248
    v_lshlrev_b32 v249, 16, v249
    v_mul_f32 v210, v210, v249
    v_lshlrev_b32 v250, 16, v250
    v_mul_f32 v211, v211, v250
    v_exp_f32 v132, v148
    v_exp_f32 v133, v149
    v_exp_f32 v134, v150
    v_exp_f32 v135, v151
    v_exp_f32 v136, v152
    v_exp_f32 v137, v153
    v_mfma_f32_4x4x4_16b_bf16 v[132:135], v[228:229], v[228:229], v[132:135]
    v_exp_f32 v138, v154
    v_exp_f32 v139, v155
    v_cvt_pk_bf16_f32 v208, v208, v209
    v_cvt_pk_bf16_f32 v209, v210, v211
    v_exp_f32 v140, v156
    v_exp_f32 v141, v157
    v_mfma_f32_4x4x4_16b_bf16 v[212:215], v[208:209], v[188:189], v[212:215] cbsz:4 abid:0
    v_mfma_f32_4x4x4_16b_bf16 v[136:139], v[228:229], v[228:229], v[136:139]
    v_exp_f32 v142, v158
    v_mfma_f32_4x4x4_16b_bf16 v[212:215], v[208:209], v[190:191], v[212:215] cbsz:4 abid:4
    v_exp_f32 v143, v159
    v_exp_f32 v144, v160
    v_mfma_f32_4x4x4_16b_bf16 v[212:215], v[208:209], v[192:193], v[212:215] cbsz:4 abid:8
    v_exp_f32 v145, v161
    v_mfma_f32_4x4x4_16b_bf16 v[140:143], v[228:229], v[228:229], v[140:143]
    v_mfma_f32_4x4x4_16b_bf16 v[212:215], v[208:209], v[194:195], v[212:215] cbsz:4 abid:12
    ds_read_b64_tr_b16 v[188:189], v236 offset:0
    ds_read_b64_tr_b16 v[190:191], v236 offset:512
    ds_read_b64_tr_b16 v[192:193], v236 offset:1056
    ds_read_b64_tr_b16 v[194:195], v236 offset:1568
    v_exp_f32 v146, v162
    v_exp_f32 v147, v163
    v_rcp_f32 v132, v132
    v_rcp_f32 v133, v133
    v_mfma_f32_4x4x4_16b_bf16 v[144:147], v[228:229], v[228:229], v[144:147]
    v_rcp_f32 v134, v134
    s_bitcmp0_b64 s[56:57], 1
    s_cbranch_scc1 Ls_tnf
    v_cvt_pk_bf16_f32 v246, v212, v212
    v_mov_b32 v212, 0
    ds_write_b16 v240, v246
    v_add_u32 v240, 128, v240
    s_add_u32 s24, s24, s32
    s_addc_u32 s25, s25, 0
    s_xor_b32 s32, s32, 0x18ffe0
Ls_tnf:
    v_cvt_pk_bf16_f32 v132, v132, v133
    s_waitcnt lgkmcnt(0)
    v_rcp_f32 v135, v135
    v_rcp_f32 v136, v136
    v_cvt_pk_bf16_f32 v133, v134, v135
    v_rcp_f32 v137, v137
    v_rcp_f32 v138, v138
    v_cvt_pk_bf16_f32 v134, v136, v137
    v_rcp_f32 v139, v139
    v_rcp_f32 v140, v140
    v_cvt_pk_bf16_f32 v135, v138, v139
    v_rcp_f32 v141, v141
    v_rcp_f32 v142, v142
    v_cvt_pk_bf16_f32 v136, v140, v141
    v_mfma_f32_16x16x32_bf16 v[208:211], v[132:135], v[196:199], v[204:207]
    v_rcp_f32 v143, v143
    v_rcp_f32 v144, v144
    v_cvt_pk_bf16_f32 v137, v142, v143
    v_rcp_f32 v145, v145
    v_rcp_f32 v146, v146
    v_rcp_f32 v147, v147
    v_cvt_pk_bf16_f32 v138, v144, v145
    v_cvt_pk_bf16_f32 v139, v146, v147
    s_nop 1
    v_mfma_f32_16x16x32_bf16 v[208:211], v[136:139], v[200:203], v[208:211]
    ds_read_b32 v246, v244 offset:16
    s_waitcnt lgkmcnt(0)
    v_bfe_u32 v247, v246, 0, 8
    v_lshlrev_b32 v247, 1, v247
    v_bfe_u32 v248, v246, 8, 8
    v_lshlrev_b32 v248, 1, v248
    v_bfe_u32 v249, v246, 16, 8
    v_lshlrev_b32 v249, 1, v249
    v_bfe_u32 v250, v246, 24, 8
    v_lshlrev_b32 v250, 1, v250
    buffer_load_ushort v247, v247, s[24:27], 0 offen
    buffer_load_ushort v248, v248, s[24:27], 0 offen
    buffer_load_ushort v249, v249, s[24:27], 0 offen
    buffer_load_ushort v250, v250, s[24:27], 0 offen
    s_waitcnt vmcnt(0)
    v_lshlrev_b32 v247, 16, v247
    v_mul_f32 v208, v208, v247
    v_lshlrev_b32 v248, 16, v248
    v_mul_f32 v209, v209, v248
    v_lshlrev_b32 v249, 16, v249
    v_mul_f32 v210, v210, v249
    v_lshlrev_b32 v250, 16, v250
    v_mul_f32 v211, v211, v250
    v_cvt_pk_bf16_f32 v208, v208, v209
    v_cvt_pk_bf16_f32 v209, v210, v211
    s_nop 1
    v_mfma_f32_4x4x4_16b_bf16 v[212:215], v[208:209], v[188:189], v[212:215] cbsz:4 abid:0
    s_nop 1
    v_mfma_f32_4x4x4_16b_bf16 v[212:215], v[208:209], v[190:191], v[212:215] cbsz:4 abid:4
    s_nop 1
    v_mfma_f32_4x4x4_16b_bf16 v[212:215], v[208:209], v[192:193], v[212:215] cbsz:4 abid:8
    s_nop 1
    v_mfma_f32_4x4x4_16b_bf16 v[212:215], v[208:209], v[194:195], v[212:215] cbsz:4 abid:12
    s_nop 4
    v_cvt_pk_bf16_f32 v246, v212, v212
    ds_write_b16 v240, v246
    s_branch L_store
.section .rodata,"a"
.p2align 6
.amdhsa_kernel standalone__sequential_behavior_din__recsys_kernel
  .amdhsa_next_free_vgpr 256
  .amdhsa_next_free_sgpr 102
  .amdhsa_accum_offset 256
  .amdhsa_group_segment_fixed_size 0
  .amdhsa_kernarg_size 80
  .amdhsa_user_sgpr_count 2
  .amdhsa_user_sgpr_kernarg_segment_ptr 1
  .amdhsa_system_sgpr_workgroup_id_x 1
.end_amdhsa_kernel
```

```asm
; @launch grid=(256,1,1) block=(512,1,1) lds=163840
.amdgcn_target "amdgcn-amd-amdhsa--gfx950"
.text
.globl standalone__sequential_behavior_din__recsys_kernel
.p2align 8
.type standalone__sequential_behavior_din__recsys_kernel,@function
standalone__sequential_behavior_din__recsys_kernel:
    s_load_dwordx16 s[4:19], s[0:1], 0
    s_cmp_ge_u32 s2, 256
    s_cbranch_scc1 L_end
    v_lshrrev_b32 v1, 6, v0
    v_and_b32 v0, 63, v0
    v_readfirstlane_b32 s54, v1
    s_lshl_b32 s53, s2, 3
    v_lshlrev_b32 v2, 4, v0
    v_lshrrev_b32 v1, 4, v0
    v_and_b32 v3, 0xf0, v2
    v_lshlrev_b32 v3, 2, v3
    v_lshl_add_u32 v130, v1, 4, v3
    v_bfrev_b32 v3, 1
    s_add_u32 s53, s53, s54
    s_movk_i32 s66, 800
    v_cmp_gt_u32 vcc, s66, v130
    s_mul_i32 s93, s53, 800
    s_mul_i32 s52, s54, 20480
    s_mov_b64 s[28:29], vcc
    v_cndmask_b32 v3, v3, v130, vcc
    v_and_b32 v248, 16, v0
    v_lshlrev_b32 v246, 1, v248
    v_xor_b32 v246, v246, v2
    v_and_b32 v243, 0xf0, v2
    v_lshl_add_u32 v243, v1, 19, v243
    s_lshl_b32 s66, s53, 8
    v_add_u32 v243, s66, v243
    s_lshl_b32 s67, s54, 12
    s_add_u32 m0, s52, 8320
    s_mov_b32 s26, 6553600
    s_mov_b32 s27, 0x20000
    s_waitcnt lgkmcnt(0)
    s_mov_b32 s24, s8
    s_and_b32 s25, s9, 0xffff
    s_cmp_ge_u32 s54, 4
    s_cbranch_scc1 L_young0
    buffer_load_dwordx4 v[100:103], v3, s[24:27], s93 offen nt
L_young0:
    global_load_lds_dwordx4 v243, s[4:5] nt
    s_add_u32 m0, s52, 4160
    s_add_u32 s10, s10, s67
    s_addc_u32 s11, s11, 0
    v_xor_b32 v247, 64, v246
    global_load_lds_dwordx4 v246, s[10:11] offset:0
    global_load_lds_dwordx4 v247, s[10:11] offset:1024
    global_load_lds_dwordx4 v246, s[10:11] offset:2048
    global_load_lds_dwordx4 v247, s[10:11] offset:3072
    s_load_dword s30, s[16:17], 0
    s_and_b32 s67, s54, 3
    v_and_b32 v250, 3, v0
    s_mov_b32 s20, s6
    s_and_b32 s21, s7, 0xffff
    s_or_b32 s21, s21, 0x800000
    s_mov_b32 s22, 200
    s_mov_b32 s23, 0x20000
    s_sub_u32 s40, s20, 1056
    s_subb_u32 s41, s21, 0
    s_mov_b32 s42, 200
    s_mov_b32 s43, 0x20000
    s_mul_i32 s35, s53, 51200
    s_movk_i32 s31, 25600
    s_mov_b32 s60, 3
    s_mov_b64 s[56:57], 0
    v_mov_b32 v148, -1
    v_mov_b32 v149, -1
    v_mov_b32 v150, -1
    v_mov_b32 v151, -1
    s_add_u32 s66, s52, 18432
    v_add_u32 v152, s66, v2
    ds_write_b128 v152, v[148:151]
    ds_write_b128 v152, v[148:151] offset:1024
    s_add_u32 s64, s52, 18448
    v_mov_b32 v153, -1
    v_mov_b32 v154, -1
    v_mov_b32 v155, -1
    v_lshrrev_b32 v237, 3, v0
    v_add_u32 v237, s64, v237
    v_lshl_add_u32 v244, v1, 2, s66
    v_and_b32 v231, 0x70, v2
    v_lshlrev_b32 v248, 2, v248
    v_xor_b32 v231, v231, v248
    v_mov_b32 v233, v231
    s_movk_i32 s66, 400
    v_cmp_le_u32 vcc, s66, v130
    v_lshrrev_b32 v126, 1, v130
    s_movk_i32 s66, -200
    v_cndmask_b32 v130, 0, 1, vcc
    v_mad_i32_i24 v126, v130, s66, v126
    v_mul_u32_u24 v127, 0x10001, v126
    v_add_u32 v126, 0x10000, v127
    v_add_u32 v128, 0x50004, v127
    v_add_u32 v129, 0x70006, v127
    v_add_u32 v127, 0x30002, v127
    v_mov_b32 v131, 0xbfe0bfe0
    s_mov_b32 s86, 0xfff0ffff
    s_mov_b32 s87, 0xf000ff00
    s_mov_b32 s88, 0xff00fff0
    s_mov_b32 s89, 0xf000
    s_mov_b32 s90, 0xf0000f
    s_mov_b32 s91, 0xf0000f00
    s_mov_b32 s84, 0x11111113
    s_mov_b32 s85, 0x11111111
    v_cndmask_b32 v116, 0, v131, s[86:87]
    v_cndmask_b32 v120, 0, v131, s[88:89]
    v_cndmask_b32 v117, 0, v131, s[86:87]
    v_cndmask_b32 v121, 0, v131, s[88:89]
    v_cndmask_b32 v122, 0, v131, s[84:85]
    v_cndmask_b32 v123, 0, v131, s[84:85]
    v_cndmask_b32 v124, 0, v131, s[84:85]
    v_cndmask_b32 v125, 0, v131, s[84:85]
    v_lshlrev_b32 v246, 4, v250
    v_sub_u32 v246, 48, v246
    s_mov_b32 s86, 0xbfe0bfe0
    s_mov_b32 s87, 0xf0bfe0
    v_lshrrev_b64 v[118:119], v246, s[86:87]
    v_mov_b32 v131, 0
    s_mov_b64 s[84:85], 0
    v_cndmask_b32 v118, v120, v118, s[90:91]
    v_cndmask_b32 v119, v121, v119, s[90:91]
    s_mov_b32 s61, 7
    s_mov_b32 s92, 0xbfb8aa3b
    v_and_b32 v251, 15, v0
    v_bfe_u32 v252, v0, 2, 2
    v_lshlrev_b32 v253, 3, v250
    v_lshl_add_u32 v253, v252, 7, v253
    v_and_b32 v246, 24, v0
    v_lshlrev_b32 v246, 2, v246
    v_xor_b32 v246, v253, v246
    v_lshl_add_u32 v246, v1, 10, v246
    s_lshl_b32 s66, s67, 5
    v_xor_b32 v66, s66, v246
    v_add_u32 v66, 45120, v66
    s_lshr_b32 s66, s54, 1
    s_lshl_b32 s66, s66, 5
    v_xor_b32 v64, s66, v246
    s_and_b32 s66, s54, 1
    s_mul_i32 s66, s66, 20480
    s_add_u32 s66, s66, 4160
    v_add_u32 v64, s66, v64
    v_add_u32 v65, 81920, v64
    s_and_b32 s66, s54, 4
    v_lshrrev_b32 v246, 3, v251
    v_add_u32 v246, s66, v246
    v_mul_u32_u24 v246, 20480, v246
    v_lshl_add_u32 v246, v1, 4, v246
    v_and_b32 v247, 7, v0
    v_lshl_add_u32 v67, v247, 7, v246
    v_and_b32 v247, 1, v0
    v_lshlrev_b32 v247, 4, v247
    v_lshlrev_b32 v247, v247, 1
    v_cmp_gt_u32 vcc, 2, v250
    v_mov_b32 v229, 0
    v_mov_b32 v228, 0x3f80
    v_cndmask_b32 v241, 0, v247, vcc
    v_cmp_eq_u32 vcc, 0, v251
    v_sub_u32 v242, v247, v241
    v_mul_u32_u24 v218, 0x3f80, v241
    v_cndmask_b32 v220, 0, -1, vcc
    v_mul_u32_u24 v219, 0x3f80, v242
    s_and_b32 s66, s54, 3
    s_lshl_b32 s66, s66, 6
    s_add_u32 s66, s66, 9344
    v_and_b32 v247, 7, v0
    v_mul_u32_u24 v247, 144, v247
    v_add3_u32 v98, v67, v247, s66
    s_add_u32 s66, s52, 14592
    v_lshl_add_u32 v221, v0, 2, s66
    ds_write_b32 v221, v229
    s_xor_b32 s66, s54, 4
    s_mul_i32 s66, s66, 20480
    s_add_u32 s66, s66, 14592
    v_writelane_b32 v221, s66, 1
    v_add_u32 v222, s52, v2
    s_mov_b64 exec, 15
    ds_write_b32 v222, v229 offset:14848
    s_mov_b64 exec, -1
    v_and_b32 v247, 8, v0
    v_lshlrev_b32 v247, 2, v247
    v_lshl_add_u32 v247, v251, 7, v247
    v_add_u32 v247, s52, v247
    v_and_b32 v248, 2, v0
    v_lshlrev_b32 v248, 1, v248
    v_xor_b32 v248, v248, v1
    v_lshl_add_u32 v234, v248, 4, v247
    v_xor_b32 v248, 4, v248
    v_lshl_add_u32 v235, v248, 4, v247
    v_and_b32 v247, 8, v0
    v_lshlrev_b32 v247, 3, v247
    v_lshl_add_u32 v248, v1, 5, v253
    v_xor_b32 v248, v248, v247
    v_add_u32 v236, s52, v248
    s_add_u32 s66, s52, 8320
    v_lshl_add_u32 v238, v250, 1, s66
    v_lshl_add_u32 v238, v1, 4, v238
    s_add_u32 s66, s52, 14912
    v_lshl_add_u32 v240, v0, 1, s66
    s_add_u32 s66, s52, 9344
    v_lshl_add_u32 v239, v1, 4, s66
    v_mov_b32 v188, 0
    v_mov_b32 v189, 0
    v_mov_b32 v190, 0
    v_mov_b32 v191, 0
    v_mov_b32 v192, 0
    v_mov_b32 v193, 0
    v_mov_b32 v194, 0
    v_mov_b32 v195, 0
    v_mov_b32 v208, 0
    v_mov_b32 v212, 0
    v_mov_b32 v209, 0
    v_mov_b32 v213, 0
    v_mov_b32 v210, 0
    v_mov_b32 v214, 0
    v_mov_b32 v211, 0
    v_mov_b32 v215, 0
    s_and_b32 s66, s54, 3
    s_lshl_b32 s66, s66, 5
    v_lshl_add_u32 v249, v1, 3, s66
    global_load_dwordx2 v[96:97], v249, s[12:13]
    s_cmp_ge_u32 s54, 4
    s_cbranch_scc0 L_old3z
    buffer_load_dwordx4 v[100:103], v3, s[24:27], s93 offen nt
L_old3z:
    s_cmp_ge_u32 s54, 4
    s_cbranch_scc1 L_young1
    s_waitcnt vmcnt(6) lgkmcnt(0)
    s_call_b64 s[62:63], L_fp
    s_waitcnt vmcnt(5)
    s_branch L_old1
L_young1:
    s_waitcnt vmcnt(2)
L_old1:
    s_waitcnt lgkmcnt(0)
    s_barrier
    ds_read_b64_tr_b16 v[16:17], v66 offset:0
    ds_read_b64_tr_b16 v[18:19], v66 offset:512
    ds_read_b64_tr_b16 v[20:21], v66 offset:20480
    ds_read_b64_tr_b16 v[22:23], v66 offset:20992
    ds_read_b64_tr_b16 v[24:25], v66 offset:40960
    ds_read_b64_tr_b16 v[26:27], v66 offset:41472
    ds_read_b64_tr_b16 v[28:29], v66 offset:61440
    ds_read_b64_tr_b16 v[30:31], v66 offset:61952
    ds_read_b128 v[32:35], v67 offset:8320
    ds_read_b128 v[36:39], v67 offset:8384
    ds_read_b128 v[40:43], v67 offset:49280
    ds_read_b128 v[44:47], v67 offset:49344
    ds_read_b64_tr_b16 v[4:5], v64 offset:0
    ds_read_b64_tr_b16 v[8:9], v65 offset:0
    ds_read_b64_tr_b16 v[12:13], v65 offset:40960
    ds_read_b64_tr_b16 v[6:7], v64 offset:512
    ds_read_b64_tr_b16 v[10:11], v65 offset:512
    ds_read_b64_tr_b16 v[14:15], v65 offset:41472
    s_cmp_ge_u32 s54, 4
    s_cbranch_scc1 L_young2
    s_waitcnt vmcnt(4)
    s_branch L_old2
L_young2:
    s_waitcnt vmcnt(1)
L_old2:
    s_add_u32 s93, s93, 1638400
    buffer_load_dwordx4 v[104:107], v3, s[24:27], s93 offen nt
    s_add_u32 s93, s93, 1638400
    buffer_load_dwordx4 v[108:111], v3, s[24:27], s93 offen nt
    s_add_u32 s93, s93, 1638400
    buffer_load_dwordx4 v[112:115], v3, s[24:27], s93 offen nt
L_old3y:
    v_lshlrev_b32 v249, 3, v1
    v_lshl_add_u32 v249, v250, 5, v249
    global_load_dwordx2 v[216:217], v249, s[14:15]
    v_lshlrev_b32 v48, 16, v96
    v_and_b32 v49, 0xffff0000, v96
    v_lshlrev_b32 v50, 16, v97
    v_and_b32 v51, 0xffff0000, v97
    s_lshl_b32 s30, s30, 16
    v_and_b32 v204, s30, v220
    v_and_b32 v205, s30, v220
    v_and_b32 v206, s30, v220
    v_and_b32 v207, s30, v220
    s_waitcnt lgkmcnt(0)
    v_xor_b32 v24, 0x80008000, v24
    v_xor_b32 v25, 0x80008000, v25
    v_xor_b32 v26, 0x80008000, v26
    v_xor_b32 v27, 0x80008000, v27
    v_xor_b32 v28, 0x80008000, v28
    v_xor_b32 v29, 0x80008000, v29
    v_xor_b32 v30, 0x80008000, v30
    v_xor_b32 v31, 0x80008000, v31
    v_mfma_f32_4x4x4_16b_bf16 v[56:59], v[218:219], v[4:5], 0
    v_mfma_f32_4x4x4_16b_bf16 v[68:71], v[218:219], v[12:13], 0
    v_mfma_f32_4x4x4_16b_bf16 v[60:63], v[218:219], v[6:7], 0
    v_mfma_f32_4x4x4_16b_bf16 v[72:75], v[218:219], v[14:15], 0
    v_mfma_f32_4x4x4_16b_bf16 v[56:59], v[218:219], v[8:9], v[56:59]
    v_mfma_f32_4x4x4_16b_bf16 v[60:63], v[218:219], v[10:11], v[60:63]
    v_mfma_f32_16x16x32_bf16 v[52:55], v[16:19], v[40:43], v[48:51]
    v_mfma_f32_16x16x32_bf16 v[52:55], v[20:23], v[44:47], v[52:55]
    v_mfma_f32_16x16x32_bf16 v[52:55], v[24:27], v[40:43], v[52:55]
    v_mfma_f32_16x16x32_bf16 v[52:55], v[28:31], v[44:47], v[52:55]
    v_mfma_f32_16x16x32_bf16 v[48:51], v[16:19], v[32:35], v[48:51]
    v_mfma_f32_16x16x32_bf16 v[48:51], v[20:23], v[36:39], v[48:51]
    v_mfma_f32_16x16x32_bf16 v[48:51], v[24:27], v[32:35], v[48:51]
    v_mfma_f32_16x16x32_bf16 v[48:51], v[28:31], v[36:39], v[48:51]
    v_mul_f32 v56, s92, v56
    v_mul_f32 v57, s92, v57
    v_mul_f32 v58, s92, v58
    v_mul_f32 v59, s92, v59
    v_mul_f32 v60, s92, v60
    v_mul_f32 v61, s92, v61
    v_mul_f32 v62, s92, v62
    v_mul_f32 v63, s92, v63
    v_mul_f32 v68, s92, v68
    v_mul_f32 v69, s92, v69
    v_mul_f32 v70, s92, v70
    v_mul_f32 v71, s92, v71
    v_mul_f32 v72, s92, v72
    v_mul_f32 v73, s92, v73
    v_mul_f32 v74, s92, v74
    v_mul_f32 v75, s92, v75
    s_add_u32 s66, s52, 11520
    v_add_u32 v3, s66, v2
    v_cvt_pk_bf16_f32 v68, v68, v69
    v_cvt_pk_bf16_f32 v69, v70, v71
    v_cvt_pk_bf16_f32 v70, v72, v73
    v_cvt_pk_bf16_f32 v71, v74, v75
    v_mul_f32 v48, s92, v48
    v_mul_f32 v49, s92, v49
    v_mul_f32 v50, s92, v50
    v_mul_f32 v51, s92, v51
    v_mul_f32 v52, s92, v52
    v_mul_f32 v53, s92, v53
    v_mul_f32 v54, s92, v54
    v_mul_f32 v55, s92, v55
    ds_write_b128 v3, v[56:59]
    ds_write_b128 v3, v[60:63] offset:1024
    ds_write_b128 v3, v[68:71] offset:2048
    ds_write_b128 v98, v[48:51]
    ds_write_b128 v98, v[52:55] offset:40960
    v_add_u32 v3, 11520, v2
    v_add_u32 v246, 81920, v3
    s_waitcnt lgkmcnt(0)
    s_barrier
    s_cmp_ge_u32 s54, 4
    s_cbranch_scc0 L_old3
    s_waitcnt vmcnt(4)
    s_call_b64 s[62:63], L_fp
    s_branch L_yng3
L_old3:
    s_call_b64 s[62:63], L_t23
L_yng3:
    ds_read_b128 v[4:7], v3 offset:0
    ds_read_b128 v[8:11], v3 offset:1024
    ds_read_b128 v[68:71], v3 offset:2048
    ds_read_b128 v[12:15], v3 offset:20480
    ds_read_b128 v[16:19], v3 offset:21504
    ds_read_b128 v[72:75], v3 offset:22528
    ds_read_b128 v[20:23], v3 offset:40960
    ds_read_b128 v[24:27], v3 offset:41984
    ds_read_b128 v[76:79], v3 offset:43008
    s_waitcnt vmcnt(4)
    v_mfma_i32_16x16x64_i8 v[172:175], v[122:125], v[104:107], 0
    v_mfma_i32_16x16x64_i8 v[176:179], v[122:125], v[108:111], 0
    v_mfma_i32_16x16x64_i8 v[180:183], v[122:125], v[112:115], 0
    v_and_b32 v160, 0x800080, v104
    v_mul_u32_u24 v160, 0x7f, v160
    v_bitop3_b32 v131, v104, v160, v131 bitop3:0xbe
    v_and_b32 v161, 0x800080, v105
    v_mul_u32_u24 v161, 0x7f, v161
    v_bitop3_b32 v131, v105, v161, v131 bitop3:0xbe
    v_and_b32 v160, 0x800080, v106
    v_mul_u32_u24 v160, 0x7f, v160
    v_bitop3_b32 v131, v106, v160, v131 bitop3:0xbe
    v_mov_b32_dpp v184, v172 row_shr:1 row_mask:0xf bank_mask:0xf bound_ctrl:0
    v_mov_b32_dpp v185, v176 row_shr:1 row_mask:0xf bank_mask:0xf bound_ctrl:0
    v_mov_b32_dpp v186, v180 row_shr:1 row_mask:0xf bank_mask:0xf bound_ctrl:0
    v_add_u32_dpp v184, v184, v184 row_shr:1 row_mask:0xf bank_mask:0xf bound_ctrl:0
    v_add_u32_dpp v185, v185, v185 row_shr:1 row_mask:0xf bank_mask:0xf bound_ctrl:0
    v_add_u32_dpp v186, v186, v186 row_shr:1 row_mask:0xf bank_mask:0xf bound_ctrl:0
    v_add_u32_dpp v184, v184, v184 row_shr:2 row_mask:0xf bank_mask:0xf bound_ctrl:0
    v_add_u32_dpp v185, v185, v185 row_shr:2 row_mask:0xf bank_mask:0xf bound_ctrl:0
    v_add_u32_dpp v186, v186, v186 row_shr:2 row_mask:0xf bank_mask:0xf bound_ctrl:0
    v_add_u32_dpp v184, v184, v184 row_shr:4 row_mask:0xf bank_mask:0xf bound_ctrl:0
    v_add_u32_dpp v185, v185, v185 row_shr:4 row_mask:0xf bank_mask:0xf bound_ctrl:0
    v_add_u32_dpp v186, v186, v186 row_shr:4 row_mask:0xf bank_mask:0xf bound_ctrl:0
    v_add_u32_dpp v184, v184, v184 row_shr:8 row_mask:0xf bank_mask:0xf bound_ctrl:0
    v_add_u32_dpp v185, v185, v185 row_shr:8 row_mask:0xf bank_mask:0xf bound_ctrl:0
    v_add_u32_dpp v186, v186, v186 row_shr:8 row_mask:0xf bank_mask:0xf bound_ctrl:0
    ds_read_b128 v[28:31], v3 offset:61440
    ds_read_b128 v[32:35], v3 offset:62464
    ds_read_b128 v[80:83], v3 offset:63488
    ds_read_b128 v[36:39], v246 offset:0
    ds_read_b128 v[40:43], v246 offset:1024
    ds_read_b128 v[84:87], v246 offset:2048
    v_and_b32 v161, 0x800080, v107
    v_mul_u32_u24 v161, 0x7f, v161
    v_bitop3_b32 v131, v107, v161, v131 bitop3:0xbe
    v_and_b32 v160, 0x800080, v108
    v_mul_u32_u24 v160, 0x7f, v160
    v_bitop3_b32 v131, v108, v160, v131 bitop3:0xbe
    v_and_b32 v161, 0x800080, v109
    v_mul_u32_u24 v161, 0x7f, v161
    v_bitop3_b32 v131, v109, v161, v131 bitop3:0xbe
    v_and_b32 v160, 0x800080, v110
    v_mul_u32_u24 v160, 0x7f, v160
    v_bitop3_b32 v131, v110, v160, v131 bitop3:0xbe
    v_and_b32 v161, 0x800080, v111
    v_mul_u32_u24 v161, 0x7f, v161
    v_bitop3_b32 v131, v111, v161, v131 bitop3:0xbe
    v_and_b32 v160, 0x800080, v112
    v_mul_u32_u24 v160, 0x7f, v160
    v_bitop3_b32 v131, v112, v160, v131 bitop3:0xbe
    v_and_b32 v161, 0x800080, v113
    v_mul_u32_u24 v161, 0x7f, v161
    v_bitop3_b32 v131, v113, v161, v131 bitop3:0xbe
    v_and_b32 v160, 0x800080, v114
    v_mul_u32_u24 v160, 0x7f, v160
    v_bitop3_b32 v131, v114, v160, v131 bitop3:0xbe
    v_and_b32 v161, 0x800080, v115
    v_mul_u32_u24 v161, 0x7f, v161
    v_bitop3_b32 v131, v115, v161, v131 bitop3:0xbe
    v_cmp_ne_u32 vcc, 0, v131
    v_readlane_b32 s68, v184, 6
    v_readlane_b32 s69, v173, 6
    v_readlane_b32 s70, v184, 15
    v_readlane_b32 s72, v185, 6
    v_readlane_b32 s73, v177, 6
    v_readlane_b32 s74, v185, 15
    v_readlane_b32 s76, v186, 6
    v_readlane_b32 s77, v181, 6
    v_readlane_b32 s78, v186, 15
    s_cbranch_vccnz L_general
    s_add_u32 s66, s68, s69
    s_add_u32 s66, s66, s64
    s_add_u32 s67, s66, 15
    s_and_b32 s67, s67, -16
    s_add_u32 s55, s64, 16
    s_max_u32 s67, s67, s55
    s_sub_u32 s66, s67, s66
    v_mad_u32_u24 v184, v130, s66, v184
    s_sub_u32 s55, s64, 2048
    v_add_u32 v172, s55, v184
    v_add_u32 v173, s55, v184
    v_add_u32 v174, s55, v184
    v_add_u32 v175, s55, v184
    s_add_u32 s64, s64, s70
    s_add_u32 s64, s64, s66
    v_mfma_i32_16x16x64_i8 v[132:135], v[118:121], v[104:107], v[172:175]
    v_mfma_i32_16x16x64_i8 v[136:139], v[116:119], v[104:107], v[172:175]
    s_add_u32 s64, s64, 15
    s_and_b32 s64, s64, -16
    s_add_u32 s55, s67, 16
    s_max_u32 s64, s64, s55
    s_lshr_b32 s95, s67, 4
    s_bitset1_b64 s[56:57], s95
    s_lshr_b32 s95, s64, 4
    s_bitset1_b64 s[56:57], s95
    s_mov_b32 s44, s64
    s_add_u32 s66, s72, s73
    s_add_u32 s66, s66, s64
    s_add_u32 s67, s66, 15
    s_and_b32 s67, s67, -16
    s_add_u32 s55, s64, 16
    s_max_u32 s67, s67, s55
    s_sub_u32 s66, s67, s66
    v_mad_u32_u24 v185, v130, s66, v185
    s_sub_u32 s55, s64, 2048
    v_add_u32 v176, s55, v185
    v_add_u32 v177, s55, v185
    v_add_u32 v178, s55, v185
    v_add_u32 v179, s55, v185
    s_add_u32 s64, s64, s74
    s_add_u32 s64, s64, s66
    v_mfma_i32_16x16x64_i8 v[140:143], v[118:121], v[108:111], v[176:179]
    v_mfma_i32_16x16x64_i8 v[144:147], v[116:119], v[108:111], v[176:179]
    s_add_u32 s64, s64, 15
    s_and_b32 s64, s64, -16
    s_add_u32 s55, s67, 16
    s_max_u32 s64, s64, s55
    s_mov_b32 s45, s67
    s_mov_b32 s46, s64
    ds_write_b8 v132, v126
    ds_write_b8_d16_hi v133, v126
    ds_write_b8 v134, v127
    ds_write_b8_d16_hi v135, v127
    ds_write_b8 v136, v128
    ds_write_b8_d16_hi v137, v128
    ds_write_b8 v138, v129
    ds_write_b8_d16_hi v139, v129
    s_add_u32 s66, s76, s77
    s_add_u32 s66, s66, s64
    s_add_u32 s67, s66, 15
    s_and_b32 s67, s67, -16
    s_add_u32 s55, s64, 16
    s_max_u32 s67, s67, s55
    s_sub_u32 s66, s67, s66
    v_mad_u32_u24 v186, v130, s66, v186
    s_sub_u32 s55, s64, 2048
    v_add_u32 v180, s55, v186
    v_add_u32 v181, s55, v186
    v_add_u32 v182, s55, v186
    v_add_u32 v183, s55, v186
    s_add_u32 s64, s64, s78
    s_add_u32 s64, s64, s66
    v_mfma_i32_16x16x64_i8 v[164:167], v[118:121], v[112:115], v[180:183]
    v_mfma_i32_16x16x64_i8 v[168:171], v[116:119], v[112:115], v[180:183]
    s_add_u32 s64, s64, 15
    s_and_b32 s64, s64, -16
    s_add_u32 s55, s67, 16
    s_max_u32 s64, s64, s55
    s_mov_b32 s47, s67
    s_mov_b32 s48, s64
    ds_write_b8 v140, v126
    ds_write_b8_d16_hi v141, v126
    ds_write_b8 v142, v127
    ds_write_b8_d16_hi v143, v127
    ds_write_b8 v144, v128
    ds_write_b8_d16_hi v145, v128
    ds_write_b8 v146, v129
    ds_write_b8_d16_hi v147, v129
    ds_read_b128 v[44:47], v246 offset:20480
    ds_read_b128 v[48:51], v246 offset:21504
    ds_read_b128 v[88:91], v246 offset:22528
    ds_read_b128 v[52:55], v246 offset:40960
    ds_read_b128 v[56:59], v246 offset:41984
    ds_read_b128 v[92:95], v246 offset:43008
    ds_read_b128 v[60:63], v246 offset:61440
    ds_read_b128 v[64:67], v246 offset:62464
    ds_read_b128 v[96:99], v246 offset:63488
    ds_read_u16 v224, v238 offset:0
    ds_read_u16 v225, v238 offset:8
    ds_read_u16 v226, v238 offset:64
    ds_read_u16 v227, v238 offset:72
    ds_write_b8 v164, v126
    ds_write_b8_d16_hi v165, v126
    ds_write_b8 v166, v127
    ds_write_b8_d16_hi v167, v127
    ds_write_b8 v168, v128
    ds_write_b8_d16_hi v169, v128
    ds_write_b8 v170, v129
    ds_write_b8_d16_hi v171, v129
    s_cmp_ge_u32 s54, 4
    s_cbranch_scc0 L_old3b
    s_call_b64 s[62:63], L_t23
L_old3b:
L_listed:
    s_and_b32 s55, s84, 0x40000000
    s_or_b32 s55, s55, s54
    s_bitset1_b32 s55, 31
    s_and_b32 s66, s74, 0x1ff
    s_lshl_b32 s66, s66, 3
    s_or_b32 s66, s66, s55
    s_and_b32 s67, s78, 0x1ff
    s_lshl_b32 s67, s67, 3
    s_or_b32 s67, s67, s55
    v_mov_b32 v132, s66
    v_mov_b32 v133, s44
    v_mov_b32 v134, s45
    v_mov_b32 v135, s46
    v_writelane_b32 v132, s67, 1
    v_writelane_b32 v133, s46, 1
    v_writelane_b32 v134, s47, 1
    v_writelane_b32 v135, s48, 1
    s_mov_b64 exec, 3
    ds_write_b128 v222, v[132:135] offset:14848
    s_mov_b64 exec, -1
    s_sub_u32 s68, s46, s44
    s_sub_u32 s69, s48, s46
    s_lshl_b32 s50, s54, 3
    s_mov_b32 s51, 0
    s_mov_b32 s33, 0
    s_sub_u32 s66, s64, s52
    s_sub_u32 s66, s66, 18448
    s_lshr_b32 s66, s66, 3
    s_lshr_b32 s67, s54, 2
    s_mul_i32 s67, s67, 2
    s_add_u32 s66, s66, s67
    s_sub_u32 s67, 0, s66
    v_mov_b32 v2, v221
    v_mov_b32 v1, s66
    v_mov_b32 v3, -8
    v_writelane_b32 v1, s67, 1
    v_writelane_b32 v3, 8, 1
    ds_add_u32 v2, v1
    v_bfrev_b32 v245, -2
    v_writelane_b32 v245, 0, 0
    s_cmp_eq_u32 s94, 1
    s_cbranch_scc1 L_nolate
    ds_read_u8 v148, v237 offset:0
    ds_read_u8 v149, v237 offset:8
    ds_read_u8 v150, v237 offset:16
    ds_read_u8 v151, v237 offset:24
    ds_read_u8 v152, v237 offset:32
    ds_read_u8 v153, v237 offset:40
    ds_read_u8 v154, v237 offset:48
    ds_read_u8 v155, v237 offset:56
    s_waitcnt lgkmcnt(0)
    s_add_u32 m0, s52, 0
    v_mov_b32 v230, v148
    v_mov_b32 v232, v149
    buffer_load_dwordx4 v[230:231], s[20:23], s35 idxen offen sc1 nt lds
    buffer_load_dwordx4 v[232:233], s[40:43], s35 idxen offen offset:1056 sc1 nt lds
    s_bitcmp0_b64 s[56:57], 2
    s_cbranch_scc1 L_noadvl1
    s_add_u32 s35, s35, s31
    s_min_u32 s35, s35, 419404800
    s_xor_b32 s31, s31, 0x63ff800
    s_sub_u32 s60, s60, 1
L_noadvl1:
    s_add_u32 m0, s52, 2080
    v_mov_b32 v230, v150
    v_mov_b32 v232, v151
    buffer_load_dwordx4 v[230:231], s[20:23], s35 idxen offen sc1 nt lds
    buffer_load_dwordx4 v[232:233], s[40:43], s35 idxen offen offset:1056 sc1 nt lds
    s_bitcmp0_b64 s[56:57], 3
    s_cbranch_scc1 L_noadvl2
    s_add_u32 s35, s35, s31
    s_min_u32 s35, s35, 419404800
    s_xor_b32 s31, s31, 0x63ff800
    s_sub_u32 s60, s60, 1
L_noadvl2:
    s_add_u32 m0, s52, 4160
    v_mov_b32 v230, v152
    v_mov_b32 v232, v153
    buffer_load_dwordx4 v[230:231], s[20:23], s35 idxen offen sc1 nt lds
    buffer_load_dwordx4 v[232:233], s[40:43], s35 idxen offen offset:1056 sc1 nt lds
    s_bitcmp0_b64 s[56:57], 4
    s_cbranch_scc1 L_noadvl3
    s_add_u32 s35, s35, s31
    s_min_u32 s35, s35, 419404800
    s_xor_b32 s31, s31, 0x63ff800
    s_sub_u32 s60, s60, 1
L_noadvl3:
    s_add_u32 m0, s52, 6240
    v_mov_b32 v230, v154
    v_mov_b32 v232, v155
    buffer_load_dwordx4 v[230:231], s[20:23], s35 idxen offen sc1 nt lds
    buffer_load_dwordx4 v[232:233], s[40:43], s35 idxen offen offset:1056 sc1 nt lds
L_nolate:
    v_and_b32_dpp v196, v216, v220 quad_perm:[0,0,0,0] row_mask:0xf bank_mask:0xf
    v_and_b32_dpp v197, v217, v220 quad_perm:[0,0,0,0] row_mask:0xf bank_mask:0xf
    v_and_b32_dpp v198, v216, v220 quad_perm:[1,1,1,1] row_mask:0xf bank_mask:0xf
    v_and_b32_dpp v199, v217, v220 quad_perm:[1,1,1,1] row_mask:0xf bank_mask:0xf
    v_and_b32_dpp v200, v216, v220 quad_perm:[2,2,2,2] row_mask:0xf bank_mask:0xf
    v_and_b32_dpp v201, v217, v220 quad_perm:[2,2,2,2] row_mask:0xf bank_mask:0xf
    v_and_b32_dpp v202, v216, v220 quad_perm:[3,3,3,3] row_mask:0xf bank_mask:0xf
    v_and_b32_dpp v203, v217, v220 quad_perm:[3,3,3,3] row_mask:0xf bank_mask:0xf
    s_waitcnt vmcnt(6) lgkmcnt(0)
    ds_read_b128 v[180:183], v234 offset:0
    ds_read_b128 v[184:187], v235 offset:0
    v_mul_u32_u24 v216, v224, v241
    v_mul_u32_u24 v217, v224, v242
    v_mul_u32_u24 v218, v225, v241
    v_mul_u32_u24 v219, v225, v242
    v_mul_u32_u24 v220, v226, v241
    v_mul_u32_u24 v221, v226, v242
    v_mul_u32_u24 v222, v227, v241
    v_mul_u32_u24 v223, v227, v242
    v_mfma_f32_4x4x4_16b_bf16 v[140:143], v[216:217], v[68:69], v[4:7]
    v_add_u32 v238, 128, v238
    ds_read_b128 v[164:167], v239 offset:0
    ds_read_b128 v[168:171], v239 offset:64
    v_mfma_f32_4x4x4_16b_bf16 v[144:147], v[218:219], v[70:71], v[8:11]
    ds_read_b128 v[172:175], v239 offset:128
    ds_read_b128 v[176:179], v239 offset:192
    ds_read_u16 v224, v238 offset:0
    ds_read_u16 v225, v238 offset:8
    ds_read_u16 v226, v238 offset:64
    ds_read_u16 v227, v238 offset:72
    v_mfma_f32_4x4x4_16b_bf16 v[246:249], v[220:221], v[72:73], v[12:15]
    v_cvt_pk_bf16_f32 v100, v140, v141
    v_cvt_pk_bf16_f32 v101, v142, v143
    v_mfma_f32_4x4x4_16b_bf16 v[250:253], v[222:223], v[74:75], v[16:19]
    v_cvt_pk_bf16_f32 v102, v144, v145
    v_cvt_pk_bf16_f32 v103, v146, v147
    v_mfma_f32_4x4x4_16b_bf16 v[140:143], v[216:217], v[76:77], v[20:23]
    v_cvt_pk_bf16_f32 v104, v246, v247
    v_cvt_pk_bf16_f32 v105, v248, v249
    v_mfma_f32_4x4x4_16b_bf16 v[144:147], v[218:219], v[78:79], v[24:27]
    v_cvt_pk_bf16_f32 v106, v250, v251
    v_cvt_pk_bf16_f32 v107, v252, v253
    v_mfma_f32_4x4x4_16b_bf16 v[246:249], v[220:221], v[80:81], v[28:31]
    v_cvt_pk_bf16_f32 v108, v140, v141
    v_cvt_pk_bf16_f32 v109, v142, v143
    v_mfma_f32_4x4x4_16b_bf16 v[250:253], v[222:223], v[82:83], v[32:35]
    v_cvt_pk_bf16_f32 v110, v144, v145
    v_cvt_pk_bf16_f32 v111, v146, v147
    v_mfma_f32_4x4x4_16b_bf16 v[140:143], v[216:217], v[84:85], v[36:39]
    v_cvt_pk_bf16_f32 v112, v246, v247
    v_cvt_pk_bf16_f32 v113, v248, v249
    v_mfma_f32_4x4x4_16b_bf16 v[144:147], v[218:219], v[86:87], v[40:43]
    v_cvt_pk_bf16_f32 v114, v250, v251
    v_cvt_pk_bf16_f32 v115, v252, v253
    v_mfma_f32_4x4x4_16b_bf16 v[246:249], v[220:221], v[88:89], v[44:47]
    v_cvt_pk_bf16_f32 v116, v140, v141
    v_cvt_pk_bf16_f32 v117, v142, v143
    v_mfma_f32_4x4x4_16b_bf16 v[250:253], v[222:223], v[90:91], v[48:51]
    v_cvt_pk_bf16_f32 v118, v144, v145
    v_cvt_pk_bf16_f32 v119, v146, v147
    v_mfma_f32_4x4x4_16b_bf16 v[140:143], v[216:217], v[92:93], v[52:55]
    v_cvt_pk_bf16_f32 v120, v246, v247
    v_cvt_pk_bf16_f32 v121, v248, v249
    v_mfma_f32_4x4x4_16b_bf16 v[144:147], v[218:219], v[94:95], v[56:59]
    v_cvt_pk_bf16_f32 v122, v250, v251
    v_cvt_pk_bf16_f32 v123, v252, v253
    v_mfma_f32_4x4x4_16b_bf16 v[246:249], v[220:221], v[96:97], v[60:63]
    v_cvt_pk_bf16_f32 v124, v140, v141
    v_cvt_pk_bf16_f32 v125, v142, v143
    v_mfma_f32_4x4x4_16b_bf16 v[250:253], v[222:223], v[98:99], v[64:67]
    v_cvt_pk_bf16_f32 v126, v144, v145
    v_cvt_pk_bf16_f32 v127, v146, v147
    v_cvt_pk_bf16_f32 v128, v246, v247
    v_cvt_pk_bf16_f32 v129, v248, v249
    v_add_u32 v239, 272, v239
    v_cvt_pk_bf16_f32 v130, v250, v251
    v_cvt_pk_bf16_f32 v131, v252, v253
    s_waitcnt lgkmcnt(0)
    v_mfma_f32_16x16x32_bf16 v[148:151], v[100:103], v[180:183], v[164:167]
    v_mfma_f32_16x16x32_bf16 v[148:151], v[104:107], v[184:187], v[148:151]
    v_mfma_f32_16x16x32_bf16 v[152:155], v[108:111], v[180:183], v[168:171]
    v_mfma_f32_16x16x32_bf16 v[152:155], v[112:115], v[184:187], v[152:155]
    v_mfma_f32_16x16x32_bf16 v[156:159], v[116:119], v[180:183], v[172:175]
    v_mfma_f32_16x16x32_bf16 v[156:159], v[120:123], v[184:187], v[156:159]
    v_mfma_f32_16x16x32_bf16 v[160:163], v[124:127], v[180:183], v[176:179]
    v_mfma_f32_16x16x32_bf16 v[160:163], v[128:131], v[184:187], v[160:163]
    v_mov_b32 v136, 0
    v_mov_b32 v137, 0
    v_mov_b32 v138, 0
    v_mov_b32 v139, 0
    s_lshr_b64 s[86:87], s[56:57], 2
    s_lshr_b64 s[36:37], s[56:57], 5
    s_or_b32 s37, s36, s86
    s_or_b32 s36, s37, s56
    s_cmp_lg_u64 s[84:85], 0
    s_cbranch_scc0 Lf_mid
    s_mul_i32 s66, s53, 800
    s_add_u32 s8, s8, s66
    s_addc_u32 s9, s9, 0
    s_mov_b32 s24, s8
    s_and_b32 s25, s9, 0xffff
    s_mov_b32 s26, 400
    s_mov_b32 s27, 0x20000
    s_movk_i32 s32, 400
    s_branch Ls_mid
L_fp:
    v_mfma_i32_16x16x64_i8 v[172:175], v[122:125], v[100:103], 0
    v_and_b32 v160, 0x800080, v100
    v_mul_u32_u24 v160, 0x7f, v160
    v_bitop3_b32 v131, v100, v160, v131 bitop3:0xbe
    v_and_b32 v161, 0x800080, v101
    v_mul_u32_u24 v161, 0x7f, v161
    v_bitop3_b32 v131, v101, v161, v131 bitop3:0xbe
    v_and_b32 v160, 0x800080, v102
    v_mul_u32_u24 v160, 0x7f, v160
    v_mov_b32_dpp v184, v172 row_shr:1 row_mask:0xf bank_mask:0xf bound_ctrl:0
    v_bitop3_b32 v131, v102, v160, v131 bitop3:0xbe
    s_nop 0
    v_add_u32_dpp v184, v184, v184 row_shr:1 row_mask:0xf bank_mask:0xf bound_ctrl:0
    v_and_b32 v161, 0x800080, v103
    s_nop 0
    v_add_u32_dpp v184, v184, v184 row_shr:2 row_mask:0xf bank_mask:0xf bound_ctrl:0
    v_mul_u32_u24 v161, 0x7f, v161
    s_nop 0
    v_add_u32_dpp v184, v184, v184 row_shr:4 row_mask:0xf bank_mask:0xf bound_ctrl:0
    v_bitop3_b32 v131, v103, v161, v131 bitop3:0xbe
    s_nop 0
    v_add_u32_dpp v184, v184, v184 row_shr:8 row_mask:0xf bank_mask:0xf bound_ctrl:0
    v_cmp_ne_u32 vcc, 0, v131
    v_readlane_b32 s68, v184, 6
    v_readlane_b32 s69, v173, 6
    v_readlane_b32 s70, v184, 15
    s_mov_b32 s94, 0
    s_cbranch_vccnz L_late
    s_add_u32 s66, s68, s69
    s_add_u32 s66, s66, s64
    s_add_u32 s67, s66, 15
    s_and_b32 s67, s67, -16
    s_add_u32 s55, s64, 16
    s_max_u32 s67, s67, s55
    s_sub_u32 s66, s67, s66
    v_mad_u32_u24 v184, v130, s66, v184
    s_sub_u32 s55, s64, 2048
    v_add_u32 v172, s55, v184
    v_add_u32 v173, s55, v184
    v_add_u32 v174, s55, v184
    v_add_u32 v175, s55, v184
    s_add_u32 s64, s64, s70
    s_add_u32 s64, s64, s66
    v_mfma_i32_16x16x64_i8 v[132:135], v[118:121], v[100:103], v[172:175]
    v_mfma_i32_16x16x64_i8 v[136:139], v[116:119], v[100:103], v[172:175]
    s_add_u32 s64, s64, 15
    s_and_b32 s64, s64, -16
    s_add_u32 s55, s67, 16
    s_max_u32 s64, s64, s55
    s_lshr_b32 s95, s67, 4
    s_bitset1_b64 s[56:57], s95
    s_lshr_b32 s95, s64, 4
    s_bitset1_b64 s[56:57], s95
    s_add_u32 s66, s52, 18512
    s_cmp_ge_u32 s64, s66
    ds_write_b8 v132, v126
    ds_write_b8_d16_hi v133, v126
    ds_write_b8 v134, v127
    ds_write_b8_d16_hi v135, v127
    ds_write_b8 v136, v128
    ds_write_b8_d16_hi v137, v128
    ds_write_b8 v138, v129
    ds_write_b8_d16_hi v139, v129
    s_cbranch_scc0 L_late
    s_mov_b32 s94, 1
    ds_read_u8 v148, v237 offset:0
    ds_read_u8 v149, v237 offset:8
    ds_read_u8 v150, v237 offset:16
    ds_read_u8 v151, v237 offset:24
    ds_read_u8 v152, v237 offset:32
    ds_read_u8 v153, v237 offset:40
    ds_read_u8 v154, v237 offset:48
    ds_read_u8 v155, v237 offset:56
    s_waitcnt lgkmcnt(0)
    s_add_u32 m0, s52, 0
    v_mov_b32 v230, v148
    v_mov_b32 v232, v149
    buffer_load_dwordx4 v[230:231], s[20:23], s35 idxen offen sc1 nt lds
    buffer_load_dwordx4 v[232:233], s[40:43], s35 idxen offen offset:1056 sc1 nt lds
    s_bitcmp0_b64 s[56:57], 2
    s_cbranch_scc1 L_noadve1
    s_add_u32 s35, s35, s31
    s_min_u32 s35, s35, 419404800
    s_xor_b32 s31, s31, 0x63ff800
    s_sub_u32 s60, s60, 1
L_noadve1:
    s_add_u32 m0, s52, 2080
    v_mov_b32 v230, v150
    v_mov_b32 v232, v151
    buffer_load_dwordx4 v[230:231], s[20:23], s35 idxen offen sc1 nt lds
    buffer_load_dwordx4 v[232:233], s[40:43], s35 idxen offen offset:1056 sc1 nt lds
    s_setpc_b64 s[62:63]
L_late:
    s_waitcnt vmcnt(0)
    s_setpc_b64 s[62:63]
L_swap:
    v_lshrrev_b32 v140, 3, v0
    v_and_b32 v141, 7, v0
    v_mul_u32_u24 v140, 20480, v140
    v_mul_u32_u24 v141, 20480, v141
    v_add_u32 v140, s51, v140
    v_add_u32 v141, s51, v141
    v_mov_b32 v143, 1
    s_mov_b64 exec, 1
    ds_add_rtn_u32 v143, v140, v143 offset:14880
    s_mov_b64 exec, -1
L_swap_poll:
    ds_read_b32 v142, v141 offset:14848
    ds_read_b128 v[144:147], v140 offset:14848
    v_and_b32 v248, 56, v0
    s_waitcnt lgkmcnt(0)
    v_cmp_le_i32 vcc, 0, v142
    v_cmp_gt_u32 s[86:87], v142, v144
    v_lshlrev_b32 v249, 1, v142
    v_readfirstlane_b32 s66, v143
    s_cbranch_vccnz L_swap_poll
    v_lshrrev_b64 v[246:247], v248, s[86:87]
    v_cmp_gt_i32 s[88:89], 0, v249
    v_and_b32 v246, 0xff, v246
    v_bcnt_u32_b32 v246, v246, 0
    v_cmp_eq_u32 vcc, s66, v246
    s_lshl_b32 s67, s54, 3
    s_ff1_i32_b64 s66, vcc
    s_cmp_lg_u64 s[88:89], 0
    s_cselect_b32 s66, s67, s66
    s_sub_u32 s95, s66, s50
    s_mov_b32 s50, s66
    s_sub_u32 s83, s66, s67
    v_readlane_b32 s67, v146, s66
    v_readlane_b32 s55, v147, s66
    v_readlane_b32 s66, v145, s66
    s_mul_i32 s81, s95, 2560
    s_mul_i32 s95, s95, 6400
    s_add_u32 s35, s35, s95
    s_sub_u32 s95, s66, s44
    v_add_u32 v237, s95, v237
    s_mov_b32 s44, s55
    s_sub_u32 s67, s67, s66
    s_sub_u32 s55, s55, s66
    s_sub_u32 s95, s55, s68
    s_lshr_b32 s67, s67, 4
    s_add_u32 s67, s67, s49
    s_bitset1_b64 s[56:57], s67
    s_lshr_b32 s55, s55, 4
    s_add_u32 s55, s55, s49
    s_bitset1_b64 s[56:57], s55
    s_lshr_b64 s[86:87], s[56:57], 2
    s_lshr_b64 s[36:37], s[56:57], 5
    s_or_b32 s37, s36, s86
    s_or_b32 s36, s37, s56
    s_ashr_i32 s95, s95, 3
    v_mov_b32 v140, s95
    s_sub_u32 s95, 0, s95
    v_writelane_b32 v140, s95, 1
    ds_add_u32 v2, v140
    s_cmp_eq_u32 s51, 0
    s_cselect_b32 s80, s81, s80
    s_cselect_b32 s82, s83, s82
    s_cselect_b32 s60, 1, 8
    s_cselect_b32 s66, 4, 2
    s_mov_b32 s68, s69
    s_mov_b32 s51, 16
    s_cmp_eq_u32 s61, s66
    s_cbranch_scc1 L_swap_now
    s_sub_u32 s66, s66, 1
    s_bitset1_b32 s33, s66
    s_setpc_b64 s[62:63]
L_swap_now:
    v_add_u32 v238, s81, v238
    v_add_u32 v239, s81, v239
    ds_read_u16 v224, v238 offset:0
    ds_read_u16 v225, v238 offset:8
    ds_read_u16 v226, v238 offset:64
    ds_read_u16 v227, v238 offset:72
    s_setpc_b64 s[62:63]
L_t23:
    s_cmp_eq_u32 s94, 0
    s_cbranch_scc1 L_skip23
    s_bitcmp0_b64 s[56:57], 3
    s_cbranch_scc1 L_noadve2
    s_add_u32 s35, s35, s31
    s_min_u32 s35, s35, 419404800
    s_xor_b32 s31, s31, 0x63ff800
    s_sub_u32 s60, s60, 1
L_noadve2:
    s_add_u32 m0, s52, 4160
    v_mov_b32 v230, v152
    v_mov_b32 v232, v153
    buffer_load_dwordx4 v[230:231], s[20:23], s35 idxen offen sc1 nt lds
    buffer_load_dwordx4 v[232:233], s[40:43], s35 idxen offen offset:1056 sc1 nt lds
    s_bitcmp0_b64 s[56:57], 4
    s_cbranch_scc1 L_noadve3
    s_add_u32 s35, s35, s31
    s_min_u32 s35, s35, 419404800
    s_xor_b32 s31, s31, 0x63ff800
    s_sub_u32 s60, s60, 1
L_noadve3:
    s_add_u32 m0, s52, 6240
    v_mov_b32 v230, v154
    v_mov_b32 v232, v155
    buffer_load_dwordx4 v[230:231], s[20:23], s35 idxen offen sc1 nt lds
    buffer_load_dwordx4 v[232:233], s[40:43], s35 idxen offen offset:1056 sc1 nt lds
    s_setpc_b64 s[62:63]
L_skip23:
    s_waitcnt vmcnt(0)
    s_setpc_b64 s[62:63]
.p2align 6
Lf_loop:
Lf_mid:
    s_bitcmp1_b32 s36, 0
    s_cbranch_scc1 Lf_ev0
Lf_evd0:
    v_mfma_f32_16x16x32_bf16 v[208:211], v[136:139], v[200:203], v[208:211]
    v_exp_f32 v132, v148
    v_exp_f32 v133, v149
    v_exp_f32 v134, v150
    v_exp_f32 v135, v151
    v_exp_f32 v136, v152
    v_exp_f32 v137, v153
    v_mfma_f32_4x4x4_16b_bf16 v[132:135], v[228:229], v[228:229], v[132:135]
    v_exp_f32 v138, v154
    v_exp_f32 v139, v155
    v_cvt_pk_bf16_f32 v208, v208, v209
    v_cvt_pk_bf16_f32 v209, v210, v211
    v_exp_f32 v140, v156
    v_exp_f32 v141, v157
    v_mfma_f32_4x4x4_16b_bf16 v[212:215], v[208:209], v[188:189], v[212:215] cbsz:4 abid:0
    v_mfma_f32_4x4x4_16b_bf16 v[136:139], v[228:229], v[228:229], v[136:139]
    v_exp_f32 v142, v158
    v_mfma_f32_4x4x4_16b_bf16 v[212:215], v[208:209], v[190:191], v[212:215] cbsz:4 abid:4
    v_exp_f32 v143, v159
    v_exp_f32 v144, v160
    v_mfma_f32_4x4x4_16b_bf16 v[212:215], v[208:209], v[192:193], v[212:215] cbsz:4 abid:8
    v_exp_f32 v145, v161
    v_mfma_f32_4x4x4_16b_bf16 v[140:143], v[228:229], v[228:229], v[140:143]
    v_mfma_f32_4x4x4_16b_bf16 v[212:215], v[208:209], v[194:195], v[212:215] cbsz:4 abid:12
    ds_add_rtn_u32 v1, v2, v3
    ds_read_u8 v230, v237 offset:64
    ds_read_u8 v232, v237 offset:72
    ds_read_b64_tr_b16 v[188:189], v236 offset:0
    ds_read_b64_tr_b16 v[190:191], v236 offset:512
    ds_read_b64_tr_b16 v[192:193], v236 offset:1056
    ds_read_b64_tr_b16 v[194:195], v236 offset:1568
    s_waitcnt vmcnt(4)
    ds_read_b128 v[180:183], v234 offset:2080
    ds_read_b128 v[184:187], v235 offset:2080
    s_add_u32 m0, s52, 0
    v_exp_f32 v146, v162
    v_exp_f32 v147, v163
    v_rcp_f32 v132, v132
    v_rcp_f32 v133, v133
    v_mfma_f32_4x4x4_16b_bf16 v[144:147], v[228:229], v[228:229], v[144:147]
    v_rcp_f32 v134, v134
    v_cvt_pk_bf16_f32 v132, v132, v133
    s_waitcnt lgkmcnt(2)
    buffer_load_dwordx4 v[230:231], s[20:23], s35 idxen offen sc1 nt lds
    buffer_load_dwordx4 v[232:233], s[40:43], s35 idxen offen offset:1056 sc1 nt lds
    s_waitcnt lgkmcnt(0)
    v_mfma_f32_16x16x32_bf16 v[148:151], v[100:103], v[180:183], v[164:167]
    v_rcp_f32 v135, v135
    v_mfma_f32_16x16x32_bf16 v[152:155], v[108:111], v[180:183], v[168:171]
    v_rcp_f32 v136, v136
    v_cvt_pk_bf16_f32 v133, v134, v135
    v_mfma_f32_16x16x32_bf16 v[148:151], v[104:107], v[184:187], v[148:151]
    v_rcp_f32 v137, v137
    v_cmp_gt_i32 vcc, v1, v245
    s_setprio 0
    s_cbranch_vccz Lf_lo0
    s_setprio 1
Lf_lo0:
    v_mfma_f32_16x16x32_bf16 v[152:155], v[112:115], v[184:187], v[152:155]
    v_rcp_f32 v138, v138
    v_cvt_pk_bf16_f32 v134, v136, v137
    v_mfma_f32_16x16x32_bf16 v[156:159], v[116:119], v[180:183], v[172:175]
    v_rcp_f32 v139, v139
    v_mfma_f32_16x16x32_bf16 v[160:163], v[124:127], v[180:183], v[176:179]
    v_rcp_f32 v140, v140
    v_cvt_pk_bf16_f32 v135, v138, v139
    v_mfma_f32_16x16x32_bf16 v[156:159], v[120:123], v[184:187], v[156:159]
    v_rcp_f32 v141, v141
    v_mfma_f32_16x16x32_bf16 v[160:163], v[128:131], v[184:187], v[160:163]
    v_rcp_f32 v142, v142
    v_cvt_pk_bf16_f32 v136, v140, v141
    v_mfma_f32_16x16x32_bf16 v[208:211], v[132:135], v[196:199], v[204:207]
    v_rcp_f32 v143, v143
    v_rcp_f32 v144, v144
    v_cvt_pk_bf16_f32 v137, v142, v143
    v_rcp_f32 v145, v145
    v_rcp_f32 v146, v146
    v_rcp_f32 v147, v147
    v_cvt_pk_bf16_f32 v138, v144, v145
    v_cvt_pk_bf16_f32 v139, v146, v147
    s_bitcmp1_b32 s36, 1
    s_cbranch_scc1 Lf_ev1
Lf_evd1:
    v_mfma_f32_16x16x32_bf16 v[208:211], v[136:139], v[200:203], v[208:211]
    v_exp_f32 v132, v148
    v_exp_f32 v133, v149
    v_exp_f32 v134, v150
    v_exp_f32 v135, v151
    v_exp_f32 v136, v152
    v_exp_f32 v137, v153
    v_mfma_f32_4x4x4_16b_bf16 v[132:135], v[228:229], v[228:229], v[132:135]
    v_exp_f32 v138, v154
    v_exp_f32 v139, v155
    v_cvt_pk_bf16_f32 v208, v208, v209
    v_cvt_pk_bf16_f32 v209, v210, v211
    v_exp_f32 v140, v156
    v_exp_f32 v141, v157
    v_mfma_f32_4x4x4_16b_bf16 v[212:215], v[208:209], v[188:189], v[212:215] cbsz:4 abid:0
    v_mfma_f32_4x4x4_16b_bf16 v[136:139], v[228:229], v[228:229], v[136:139]
    v_exp_f32 v142, v158
    v_mfma_f32_4x4x4_16b_bf16 v[212:215], v[208:209], v[190:191], v[212:215] cbsz:4 abid:4
    v_exp_f32 v143, v159
    v_exp_f32 v144, v160
    v_mfma_f32_4x4x4_16b_bf16 v[212:215], v[208:209], v[192:193], v[212:215] cbsz:4 abid:8
    v_exp_f32 v145, v161
    v_mfma_f32_4x4x4_16b_bf16 v[140:143], v[228:229], v[228:229], v[140:143]
    v_mfma_f32_4x4x4_16b_bf16 v[212:215], v[208:209], v[194:195], v[212:215] cbsz:4 abid:12
    ds_read_u8 v230, v237 offset:80
    ds_read_u8 v232, v237 offset:88
    ds_read_b64_tr_b16 v[188:189], v236 offset:2080
    ds_read_b64_tr_b16 v[190:191], v236 offset:2592
    ds_read_b64_tr_b16 v[192:193], v236 offset:3136
    ds_read_b64_tr_b16 v[194:195], v236 offset:3648
    s_waitcnt vmcnt(4)
    ds_read_b128 v[180:183], v234 offset:4160
    ds_read_b128 v[184:187], v235 offset:4160
    s_add_u32 m0, s52, 2080
    v_exp_f32 v146, v162
    v_exp_f32 v147, v163
    v_rcp_f32 v132, v132
    v_rcp_f32 v133, v133
    v_mfma_f32_4x4x4_16b_bf16 v[144:147], v[228:229], v[228:229], v[144:147]
    v_rcp_f32 v134, v134
    v_cvt_pk_bf16_f32 v132, v132, v133
    s_waitcnt lgkmcnt(2)
    buffer_load_dwordx4 v[230:231], s[20:23], s35 idxen offen sc1 nt lds
    buffer_load_dwordx4 v[232:233], s[40:43], s35 idxen offen offset:1056 sc1 nt lds
    s_waitcnt lgkmcnt(0)
    v_mfma_f32_16x16x32_bf16 v[148:151], v[100:103], v[180:183], v[164:167]
    v_rcp_f32 v135, v135
    v_mfma_f32_16x16x32_bf16 v[152:155], v[108:111], v[180:183], v[168:171]
    v_rcp_f32 v136, v136
    v_cvt_pk_bf16_f32 v133, v134, v135
    v_mfma_f32_16x16x32_bf16 v[148:151], v[104:107], v[184:187], v[148:151]
    v_rcp_f32 v137, v137
    v_mfma_f32_16x16x32_bf16 v[152:155], v[112:115], v[184:187], v[152:155]
    v_rcp_f32 v138, v138
    v_cvt_pk_bf16_f32 v134, v136, v137
    v_mfma_f32_16x16x32_bf16 v[156:159], v[116:119], v[180:183], v[172:175]
    v_rcp_f32 v139, v139
    v_mfma_f32_16x16x32_bf16 v[160:163], v[124:127], v[180:183], v[176:179]
    v_rcp_f32 v140, v140
    v_cvt_pk_bf16_f32 v135, v138, v139
    v_mfma_f32_16x16x32_bf16 v[156:159], v[120:123], v[184:187], v[156:159]
    v_rcp_f32 v141, v141
    v_mfma_f32_16x16x32_bf16 v[160:163], v[128:131], v[184:187], v[160:163]
    v_rcp_f32 v142, v142
    v_cvt_pk_bf16_f32 v136, v140, v141
    v_mfma_f32_16x16x32_bf16 v[208:211], v[132:135], v[196:199], v[204:207]
    v_rcp_f32 v143, v143
    v_rcp_f32 v144, v144
    v_cvt_pk_bf16_f32 v137, v142, v143
    v_rcp_f32 v145, v145
    v_rcp_f32 v146, v146
    v_rcp_f32 v147, v147
    v_cvt_pk_bf16_f32 v138, v144, v145
    v_cvt_pk_bf16_f32 v139, v146, v147
    s_bitcmp1_b32 s36, 2
    s_cbranch_scc1 Lf_ev2
Lf_evd2:
    v_mfma_f32_16x16x32_bf16 v[208:211], v[136:139], v[200:203], v[208:211]
    v_exp_f32 v132, v148
    v_exp_f32 v133, v149
    v_exp_f32 v134, v150
    v_exp_f32 v135, v151
    v_exp_f32 v136, v152
    v_exp_f32 v137, v153
    v_mfma_f32_4x4x4_16b_bf16 v[132:135], v[228:229], v[228:229], v[132:135]
    v_exp_f32 v138, v154
    v_exp_f32 v139, v155
    v_cvt_pk_bf16_f32 v208, v208, v209
    v_cvt_pk_bf16_f32 v209, v210, v211
    v_exp_f32 v140, v156
    v_exp_f32 v141, v157
    v_mfma_f32_4x4x4_16b_bf16 v[212:215], v[208:209], v[188:189], v[212:215] cbsz:4 abid:0
    v_mfma_f32_4x4x4_16b_bf16 v[136:139], v[228:229], v[228:229], v[136:139]
    v_exp_f32 v142, v158
    v_mfma_f32_4x4x4_16b_bf16 v[212:215], v[208:209], v[190:191], v[212:215] cbsz:4 abid:4
    v_exp_f32 v143, v159
    v_exp_f32 v144, v160
    v_mfma_f32_4x4x4_16b_bf16 v[212:215], v[208:209], v[192:193], v[212:215] cbsz:4 abid:8
    v_exp_f32 v145, v161
    v_mfma_f32_4x4x4_16b_bf16 v[140:143], v[228:229], v[228:229], v[140:143]
    v_mfma_f32_4x4x4_16b_bf16 v[212:215], v[208:209], v[194:195], v[212:215] cbsz:4 abid:12
    ds_read_u8 v230, v237 offset:96
    ds_read_u8 v232, v237 offset:104
    ds_read_b64_tr_b16 v[188:189], v236 offset:4160
    ds_read_b64_tr_b16 v[190:191], v236 offset:4672
    ds_read_b64_tr_b16 v[192:193], v236 offset:5216
    ds_read_b64_tr_b16 v[194:195], v236 offset:5728
    s_waitcnt vmcnt(4)
    ds_read_b128 v[180:183], v234 offset:6240
    ds_read_b128 v[184:187], v235 offset:6240
    s_add_u32 m0, s52, 4160
    v_exp_f32 v146, v162
    v_exp_f32 v147, v163
    v_rcp_f32 v132, v132
    v_rcp_f32 v133, v133
    v_mfma_f32_4x4x4_16b_bf16 v[144:147], v[228:229], v[228:229], v[144:147]
    v_rcp_f32 v134, v134
    v_cvt_pk_bf16_f32 v132, v132, v133
    s_waitcnt lgkmcnt(2)
    buffer_load_dwordx4 v[230:231], s[20:23], s35 idxen offen sc1 nt lds
    buffer_load_dwordx4 v[232:233], s[40:43], s35 idxen offen offset:1056 sc1 nt lds
    s_waitcnt lgkmcnt(0)
    v_mfma_f32_16x16x32_bf16 v[148:151], v[100:103], v[180:183], v[164:167]
    v_rcp_f32 v135, v135
    v_mfma_f32_16x16x32_bf16 v[152:155], v[108:111], v[180:183], v[168:171]
    v_rcp_f32 v136, v136
    v_cvt_pk_bf16_f32 v133, v134, v135
    v_mfma_f32_16x16x32_bf16 v[148:151], v[104:107], v[184:187], v[148:151]
    v_rcp_f32 v137, v137
    v_mfma_f32_16x16x32_bf16 v[152:155], v[112:115], v[184:187], v[152:155]
    v_rcp_f32 v138, v138
    v_cvt_pk_bf16_f32 v134, v136, v137
    v_mfma_f32_16x16x32_bf16 v[156:159], v[116:119], v[180:183], v[172:175]
    v_rcp_f32 v139, v139
    v_mfma_f32_16x16x32_bf16 v[160:163], v[124:127], v[180:183], v[176:179]
    v_rcp_f32 v140, v140
    v_cvt_pk_bf16_f32 v135, v138, v139
    v_mfma_f32_16x16x32_bf16 v[156:159], v[120:123], v[184:187], v[156:159]
    v_rcp_f32 v141, v141
    v_mfma_f32_16x16x32_bf16 v[160:163], v[128:131], v[184:187], v[160:163]
    v_rcp_f32 v142, v142
    v_cvt_pk_bf16_f32 v136, v140, v141
    v_mfma_f32_16x16x32_bf16 v[208:211], v[132:135], v[196:199], v[204:207]
    v_rcp_f32 v143, v143
    v_rcp_f32 v144, v144
    v_cvt_pk_bf16_f32 v137, v142, v143
    v_rcp_f32 v145, v145
    v_rcp_f32 v146, v146
    v_rcp_f32 v147, v147
    v_cvt_pk_bf16_f32 v138, v144, v145
    v_cvt_pk_bf16_f32 v139, v146, v147
    s_bitcmp1_b32 s36, 3
    s_cbranch_scc1 Lf_ev3
Lf_evd3:
    v_mfma_f32_16x16x32_bf16 v[208:211], v[136:139], v[200:203], v[208:211]
    v_exp_f32 v132, v148
    v_exp_f32 v133, v149
    v_exp_f32 v134, v150
    v_exp_f32 v135, v151
    v_exp_f32 v136, v152
    v_exp_f32 v137, v153
    v_mfma_f32_4x4x4_16b_bf16 v[132:135], v[228:229], v[228:229], v[132:135]
    v_exp_f32 v138, v154
    v_exp_f32 v139, v155
    v_cvt_pk_bf16_f32 v208, v208, v209
    v_cvt_pk_bf16_f32 v209, v210, v211
    v_exp_f32 v140, v156
    v_exp_f32 v141, v157
    v_mfma_f32_4x4x4_16b_bf16 v[212:215], v[208:209], v[188:189], v[212:215] cbsz:4 abid:0
    v_mfma_f32_4x4x4_16b_bf16 v[136:139], v[228:229], v[228:229], v[136:139]
    v_exp_f32 v142, v158
    v_mfma_f32_4x4x4_16b_bf16 v[212:215], v[208:209], v[190:191], v[212:215] cbsz:4 abid:4
    v_exp_f32 v143, v159
    v_exp_f32 v144, v160
    v_mfma_f32_4x4x4_16b_bf16 v[212:215], v[208:209], v[192:193], v[212:215] cbsz:4 abid:8
    v_exp_f32 v145, v161
    v_mfma_f32_4x4x4_16b_bf16 v[140:143], v[228:229], v[228:229], v[140:143]
    v_mfma_f32_4x4x4_16b_bf16 v[212:215], v[208:209], v[194:195], v[212:215] cbsz:4 abid:12
    ds_read_u8 v230, v237 offset:112
    ds_read_u8 v232, v237 offset:120
    ds_read_b64_tr_b16 v[188:189], v236 offset:6240
    ds_read_b64_tr_b16 v[190:191], v236 offset:6752
    ds_read_b64_tr_b16 v[192:193], v236 offset:7296
    ds_read_b64_tr_b16 v[194:195], v236 offset:7808
    s_waitcnt vmcnt(4)
    ds_read_b128 v[180:183], v234 offset:0
    ds_read_b128 v[184:187], v235 offset:0
    s_add_u32 m0, s52, 6240
    v_exp_f32 v146, v162
    v_exp_f32 v147, v163
    v_rcp_f32 v132, v132
    v_rcp_f32 v133, v133
    v_mfma_f32_4x4x4_16b_bf16 v[144:147], v[228:229], v[228:229], v[144:147]
    v_rcp_f32 v134, v134
    v_cvt_pk_bf16_f32 v132, v132, v133
    s_waitcnt lgkmcnt(2)
    buffer_load_dwordx4 v[230:231], s[20:23], s35 idxen offen sc1 nt lds
    buffer_load_dwordx4 v[232:233], s[40:43], s35 idxen offen offset:1056 sc1 nt lds
    s_waitcnt lgkmcnt(0)
    v_mfma_f32_16x16x32_bf16 v[148:151], v[100:103], v[180:183], v[164:167]
    v_rcp_f32 v135, v135
    v_mfma_f32_16x16x32_bf16 v[152:155], v[108:111], v[180:183], v[168:171]
    v_rcp_f32 v136, v136
    v_cvt_pk_bf16_f32 v133, v134, v135
    v_mfma_f32_16x16x32_bf16 v[148:151], v[104:107], v[184:187], v[148:151]
    v_rcp_f32 v137, v137
    v_mfma_f32_16x16x32_bf16 v[152:155], v[112:115], v[184:187], v[152:155]
    v_rcp_f32 v138, v138
    v_cvt_pk_bf16_f32 v134, v136, v137
    v_mfma_f32_16x16x32_bf16 v[156:159], v[116:119], v[180:183], v[172:175]
    v_rcp_f32 v139, v139
    v_mfma_f32_16x16x32_bf16 v[160:163], v[124:127], v[180:183], v[176:179]
    v_rcp_f32 v140, v140
    v_cvt_pk_bf16_f32 v135, v138, v139
    v_mfma_f32_16x16x32_bf16 v[156:159], v[120:123], v[184:187], v[156:159]
    v_rcp_f32 v141, v141
    v_mfma_f32_16x16x32_bf16 v[160:163], v[128:131], v[184:187], v[160:163]
    v_rcp_f32 v142, v142
    v_cvt_pk_bf16_f32 v136, v140, v141
    v_mfma_f32_16x16x32_bf16 v[208:211], v[132:135], v[196:199], v[204:207]
    v_rcp_f32 v143, v143
    v_rcp_f32 v144, v144
    v_cvt_pk_bf16_f32 v137, v142, v143
    s_lshr_b64 s[56:57], s[56:57], 4
    s_lshr_b64 s[86:87], s[56:57], 2
    s_lshr_b64 s[36:37], s[56:57], 5
    s_or_b32 s37, s36, s86
    s_or_b32 s36, s37, s56
    v_add_u32 v237, 64, v237
    v_rcp_f32 v145, v145
    v_rcp_f32 v146, v146
    v_rcp_f32 v147, v147
    v_cvt_pk_bf16_f32 v138, v144, v145
    v_cvt_pk_bf16_f32 v139, v146, v147
    s_branch Lf_loop
Lf_fl0:
    v_cvt_pk_bf16_f32 v246, v212, v212
    v_mov_b32 v212, 0
    ds_write_b16 v240, v246
    v_add_u32 v240, 128, v240
    s_bitcmp0_b32 s37, 0
    s_cbranch_scc1 Lf_evd0
    s_branch Lf_ev20
Lf_ev0:
    s_bitcmp1_b64 s[56:57], 0
    s_cbranch_scc1 Lf_fl0
Lf_ev20:
    s_bitcmp1_b64 s[56:57], 2
    s_cbranch_scc1 Lf_w0
    s_sub_u32 s60, s60, 1
    s_cbranch_scc0 Lf_nsa0
    s_mov_b32 s49, 5
    s_call_b64 s[62:63], L_swap
Lf_nsa0:
    s_add_u32 s35, s35, s31
    s_min_u32 s35, s35, 419404800
    s_xor_b32 s31, s31, 0x63ff800
    s_branch Lf_evd0
Lf_w0:
    s_bitcmp0_b64 s[56:57], 5
    s_cbranch_scc1 Lf_e10
    s_sub_u32 s60, s60, 1
    s_cbranch_scc0 Lf_nsb0
    s_mov_b32 s49, 5
    s_call_b64 s[62:63], L_swap
    s_waitcnt lgkmcnt(0)
Lf_nsb0:
    s_add_u32 s35, s35, s31
    s_min_u32 s35, s35, 419404800
    s_xor_b32 s31, s31, 0x63ff800
Lf_e10:
    s_sub_u32 s61, s61, 1
    s_cbranch_scc1 Lf_last0
    s_bitcmp0_b32 s33, s61
    s_cbranch_scc1 Lf_nw0
    s_cmp_eq_u32 s61, 3
    s_cselect_b32 s66, s80, s81
    v_add_u32 v238, s66, v238
    v_add_u32 v239, s66, v239
    ds_read_u16 v224, v238 offset:0
    ds_read_u16 v225, v238 offset:8
    ds_read_u16 v226, v238 offset:64
    ds_read_u16 v227, v238 offset:72
    s_waitcnt lgkmcnt(0)
Lf_nw0:
    v_mul_u32_u24 v216, v224, v241
    v_mul_u32_u24 v217, v224, v242
    v_mul_u32_u24 v218, v225, v241
    v_mul_u32_u24 v219, v225, v242
    v_mul_u32_u24 v220, v226, v241
    v_mul_u32_u24 v221, v226, v242
    v_mul_u32_u24 v222, v227, v241
    v_mul_u32_u24 v223, v227, v242
    v_mfma_f32_4x4x4_16b_bf16 v[140:143], v[216:217], v[68:69], v[4:7]
    v_add_u32 v238, 128, v238
    ds_read_b128 v[164:167], v239 offset:0
    ds_read_b128 v[168:171], v239 offset:64
    v_mfma_f32_4x4x4_16b_bf16 v[144:147], v[218:219], v[70:71], v[8:11]
    ds_read_b128 v[172:175], v239 offset:128
    ds_read_b128 v[176:179], v239 offset:192
    ds_read_u16 v224, v238 offset:0
    ds_read_u16 v225, v238 offset:8
    ds_read_u16 v226, v238 offset:64
    ds_read_u16 v227, v238 offset:72
    v_mfma_f32_4x4x4_16b_bf16 v[246:249], v[220:221], v[72:73], v[12:15]
    v_cvt_pk_bf16_f32 v100, v140, v141
    v_cvt_pk_bf16_f32 v101, v142, v143
    v_mfma_f32_4x4x4_16b_bf16 v[250:253], v[222:223], v[74:75], v[16:19]
    v_cvt_pk_bf16_f32 v102, v144, v145
    v_cvt_pk_bf16_f32 v103, v146, v147
    v_mfma_f32_4x4x4_16b_bf16 v[140:143], v[216:217], v[76:77], v[20:23]
    v_cvt_pk_bf16_f32 v104, v246, v247
    v_cvt_pk_bf16_f32 v105, v248, v249
    v_mfma_f32_4x4x4_16b_bf16 v[144:147], v[218:219], v[78:79], v[24:27]
    v_cvt_pk_bf16_f32 v106, v250, v251
    v_cvt_pk_bf16_f32 v107, v252, v253
    v_mfma_f32_4x4x4_16b_bf16 v[246:249], v[220:221], v[80:81], v[28:31]
    v_cvt_pk_bf16_f32 v108, v140, v141
    v_cvt_pk_bf16_f32 v109, v142, v143
    v_mfma_f32_4x4x4_16b_bf16 v[250:253], v[222:223], v[82:83], v[32:35]
    v_cvt_pk_bf16_f32 v110, v144, v145
    v_cvt_pk_bf16_f32 v111, v146, v147
    v_mfma_f32_4x4x4_16b_bf16 v[140:143], v[216:217], v[84:85], v[36:39]
    v_cvt_pk_bf16_f32 v112, v246, v247
    v_cvt_pk_bf16_f32 v113, v248, v249
    v_mfma_f32_4x4x4_16b_bf16 v[144:147], v[218:219], v[86:87], v[40:43]
    v_cvt_pk_bf16_f32 v114, v250, v251
    v_cvt_pk_bf16_f32 v115, v252, v253
    v_mfma_f32_4x4x4_16b_bf16 v[246:249], v[220:221], v[88:89], v[44:47]
    v_cvt_pk_bf16_f32 v116, v140, v141
    v_cvt_pk_bf16_f32 v117, v142, v143
    v_mfma_f32_4x4x4_16b_bf16 v[250:253], v[222:223], v[90:91], v[48:51]
    v_cvt_pk_bf16_f32 v118, v144, v145
    v_cvt_pk_bf16_f32 v119, v146, v147
    v_mfma_f32_4x4x4_16b_bf16 v[140:143], v[216:217], v[92:93], v[52:55]
    v_cvt_pk_bf16_f32 v120, v246, v247
    v_cvt_pk_bf16_f32 v121, v248, v249
    v_mfma_f32_4x4x4_16b_bf16 v[144:147], v[218:219], v[94:95], v[56:59]
    v_cvt_pk_bf16_f32 v122, v250, v251
    v_cvt_pk_bf16_f32 v123, v252, v253
    v_mfma_f32_4x4x4_16b_bf16 v[246:249], v[220:221], v[96:97], v[60:63]
    v_cvt_pk_bf16_f32 v124, v140, v141
    v_cvt_pk_bf16_f32 v125, v142, v143
    v_mfma_f32_4x4x4_16b_bf16 v[250:253], v[222:223], v[98:99], v[64:67]
    v_cvt_pk_bf16_f32 v126, v144, v145
    v_cvt_pk_bf16_f32 v127, v146, v147
    v_cvt_pk_bf16_f32 v128, v246, v247
    v_cvt_pk_bf16_f32 v129, v248, v249
    v_add_u32 v239, 272, v239
    v_cvt_pk_bf16_f32 v130, v250, v251
    v_cvt_pk_bf16_f32 v131, v252, v253
    s_waitcnt lgkmcnt(0)
    s_branch Lf_evd0
Lf_fl1:
    v_cvt_pk_bf16_f32 v246, v212, v212
    v_mov_b32 v212, 0
    ds_write_b16 v240, v246
    v_add_u32 v240, 128, v240
    s_bitcmp0_b32 s37, 1
    s_cbranch_scc1 Lf_evd1
    s_branch Lf_ev21
Lf_ev1:
    s_bitcmp1_b64 s[56:57], 1
    s_cbranch_scc1 Lf_fl1
Lf_ev21:
    s_bitcmp1_b64 s[56:57], 3
    s_cbranch_scc1 Lf_w1
    s_sub_u32 s60, s60, 1
    s_cbranch_scc0 Lf_nsa1
    s_mov_b32 s49, 6
    s_call_b64 s[62:63], L_swap
Lf_nsa1:
    s_add_u32 s35, s35, s31
    s_min_u32 s35, s35, 419404800
    s_xor_b32 s31, s31, 0x63ff800
    s_branch Lf_evd1
Lf_w1:
    s_bitcmp0_b64 s[56:57], 6
    s_cbranch_scc1 Lf_e11
    s_sub_u32 s60, s60, 1
    s_cbranch_scc0 Lf_nsb1
    s_mov_b32 s49, 6
    s_call_b64 s[62:63], L_swap
    s_waitcnt lgkmcnt(0)
Lf_nsb1:
    s_add_u32 s35, s35, s31
    s_min_u32 s35, s35, 419404800
    s_xor_b32 s31, s31, 0x63ff800
Lf_e11:
    s_sub_u32 s61, s61, 1
    s_cbranch_scc1 Lf_last1
    s_bitcmp0_b32 s33, s61
    s_cbranch_scc1 Lf_nw1
    s_cmp_eq_u32 s61, 3
    s_cselect_b32 s66, s80, s81
    v_add_u32 v238, s66, v238
    v_add_u32 v239, s66, v239
    ds_read_u16 v224, v238 offset:0
    ds_read_u16 v225, v238 offset:8
    ds_read_u16 v226, v238 offset:64
    ds_read_u16 v227, v238 offset:72
    s_waitcnt lgkmcnt(0)
Lf_nw1:
    v_mul_u32_u24 v216, v224, v241
    v_mul_u32_u24 v217, v224, v242
    v_mul_u32_u24 v218, v225, v241
    v_mul_u32_u24 v219, v225, v242
    v_mul_u32_u24 v220, v226, v241
    v_mul_u32_u24 v221, v226, v242
    v_mul_u32_u24 v222, v227, v241
    v_mul_u32_u24 v223, v227, v242
    v_mfma_f32_4x4x4_16b_bf16 v[140:143], v[216:217], v[68:69], v[4:7]
    v_add_u32 v238, 128, v238
    ds_read_b128 v[164:167], v239 offset:0
    ds_read_b128 v[168:171], v239 offset:64
    v_mfma_f32_4x4x4_16b_bf16 v[144:147], v[218:219], v[70:71], v[8:11]
    ds_read_b128 v[172:175], v239 offset:128
    ds_read_b128 v[176:179], v239 offset:192
    ds_read_u16 v224, v238 offset:0
    ds_read_u16 v225, v238 offset:8
    ds_read_u16 v226, v238 offset:64
    ds_read_u16 v227, v238 offset:72
    v_mfma_f32_4x4x4_16b_bf16 v[246:249], v[220:221], v[72:73], v[12:15]
    v_cvt_pk_bf16_f32 v100, v140, v141
    v_cvt_pk_bf16_f32 v101, v142, v143
    v_mfma_f32_4x4x4_16b_bf16 v[250:253], v[222:223], v[74:75], v[16:19]
    v_cvt_pk_bf16_f32 v102, v144, v145
    v_cvt_pk_bf16_f32 v103, v146, v147
    v_mfma_f32_4x4x4_16b_bf16 v[140:143], v[216:217], v[76:77], v[20:23]
    v_cvt_pk_bf16_f32 v104, v246, v247
    v_cvt_pk_bf16_f32 v105, v248, v249
    v_mfma_f32_4x4x4_16b_bf16 v[144:147], v[218:219], v[78:79], v[24:27]
    v_cvt_pk_bf16_f32 v106, v250, v251
    v_cvt_pk_bf16_f32 v107, v252, v253
    v_mfma_f32_4x4x4_16b_bf16 v[246:249], v[220:221], v[80:81], v[28:31]
    v_cvt_pk_bf16_f32 v108, v140, v141
    v_cvt_pk_bf16_f32 v109, v142, v143
    v_mfma_f32_4x4x4_16b_bf16 v[250:253], v[222:223], v[82:83], v[32:35]
    v_cvt_pk_bf16_f32 v110, v144, v145
    v_cvt_pk_bf16_f32 v111, v146, v147
    v_mfma_f32_4x4x4_16b_bf16 v[140:143], v[216:217], v[84:85], v[36:39]
    v_cvt_pk_bf16_f32 v112, v246, v247
    v_cvt_pk_bf16_f32 v113, v248, v249
    v_mfma_f32_4x4x4_16b_bf16 v[144:147], v[218:219], v[86:87], v[40:43]
    v_cvt_pk_bf16_f32 v114, v250, v251
    v_cvt_pk_bf16_f32 v115, v252, v253
    v_mfma_f32_4x4x4_16b_bf16 v[246:249], v[220:221], v[88:89], v[44:47]
    v_cvt_pk_bf16_f32 v116, v140, v141
    v_cvt_pk_bf16_f32 v117, v142, v143
    v_mfma_f32_4x4x4_16b_bf16 v[250:253], v[222:223], v[90:91], v[48:51]
    v_cvt_pk_bf16_f32 v118, v144, v145
    v_cvt_pk_bf16_f32 v119, v146, v147
    v_mfma_f32_4x4x4_16b_bf16 v[140:143], v[216:217], v[92:93], v[52:55]
    v_cvt_pk_bf16_f32 v120, v246, v247
    v_cvt_pk_bf16_f32 v121, v248, v249
    v_mfma_f32_4x4x4_16b_bf16 v[144:147], v[218:219], v[94:95], v[56:59]
    v_cvt_pk_bf16_f32 v122, v250, v251
    v_cvt_pk_bf16_f32 v123, v252, v253
    v_mfma_f32_4x4x4_16b_bf16 v[246:249], v[220:221], v[96:97], v[60:63]
    v_cvt_pk_bf16_f32 v124, v140, v141
    v_cvt_pk_bf16_f32 v125, v142, v143
    v_mfma_f32_4x4x4_16b_bf16 v[250:253], v[222:223], v[98:99], v[64:67]
    v_cvt_pk_bf16_f32 v126, v144, v145
    v_cvt_pk_bf16_f32 v127, v146, v147
    v_cvt_pk_bf16_f32 v128, v246, v247
    v_cvt_pk_bf16_f32 v129, v248, v249
    v_add_u32 v239, 272, v239
    v_cvt_pk_bf16_f32 v130, v250, v251
    v_cvt_pk_bf16_f32 v131, v252, v253
    s_waitcnt lgkmcnt(0)
    s_branch Lf_evd1
Lf_fl2:
    v_cvt_pk_bf16_f32 v246, v212, v212
    v_mov_b32 v212, 0
    ds_write_b16 v240, v246
    v_add_u32 v240, 128, v240
    s_bitcmp0_b32 s37, 2
    s_cbranch_scc1 Lf_evd2
    s_branch Lf_ev22
Lf_ev2:
    s_bitcmp1_b64 s[56:57], 2
    s_cbranch_scc1 Lf_fl2
Lf_ev22:
    s_bitcmp1_b64 s[56:57], 4
    s_cbranch_scc1 Lf_w2
    s_sub_u32 s60, s60, 1
    s_cbranch_scc0 Lf_nsa2
    s_mov_b32 s49, 7
    s_call_b64 s[62:63], L_swap
Lf_nsa2:
    s_add_u32 s35, s35, s31
    s_min_u32 s35, s35, 419404800
    s_xor_b32 s31, s31, 0x63ff800
    s_branch Lf_evd2
Lf_w2:
    s_bitcmp0_b64 s[56:57], 7
    s_cbranch_scc1 Lf_e12
    s_sub_u32 s60, s60, 1
    s_cbranch_scc0 Lf_nsb2
    s_mov_b32 s49, 7
    s_call_b64 s[62:63], L_swap
    s_waitcnt lgkmcnt(0)
Lf_nsb2:
    s_add_u32 s35, s35, s31
    s_min_u32 s35, s35, 419404800
    s_xor_b32 s31, s31, 0x63ff800
Lf_e12:
    s_sub_u32 s61, s61, 1
    s_cbranch_scc1 Lf_last2
    s_bitcmp0_b32 s33, s61
    s_cbranch_scc1 Lf_nw2
    s_cmp_eq_u32 s61, 3
    s_cselect_b32 s66, s80, s81
    v_add_u32 v238, s66, v238
    v_add_u32 v239, s66, v239
    ds_read_u16 v224, v238 offset:0
    ds_read_u16 v225, v238 offset:8
    ds_read_u16 v226, v238 offset:64
    ds_read_u16 v227, v238 offset:72
    s_waitcnt lgkmcnt(0)
Lf_nw2:
    v_mul_u32_u24 v216, v224, v241
    v_mul_u32_u24 v217, v224, v242
    v_mul_u32_u24 v218, v225, v241
    v_mul_u32_u24 v219, v225, v242
    v_mul_u32_u24 v220, v226, v241
    v_mul_u32_u24 v221, v226, v242
    v_mul_u32_u24 v222, v227, v241
    v_mul_u32_u24 v223, v227, v242
    v_mfma_f32_4x4x4_16b_bf16 v[140:143], v[216:217], v[68:69], v[4:7]
    v_add_u32 v238, 128, v238
    ds_read_b128 v[164:167], v239 offset:0
    ds_read_b128 v[168:171], v239 offset:64
    v_mfma_f32_4x4x4_16b_bf16 v[144:147], v[218:219], v[70:71], v[8:11]
    ds_read_b128 v[172:175], v239 offset:128
    ds_read_b128 v[176:179], v239 offset:192
    ds_read_u16 v224, v238 offset:0
    ds_read_u16 v225, v238 offset:8
    ds_read_u16 v226, v238 offset:64
    ds_read_u16 v227, v238 offset:72
    v_mfma_f32_4x4x4_16b_bf16 v[246:249], v[220:221], v[72:73], v[12:15]
    v_cvt_pk_bf16_f32 v100, v140, v141
    v_cvt_pk_bf16_f32 v101, v142, v143
    v_mfma_f32_4x4x4_16b_bf16 v[250:253], v[222:223], v[74:75], v[16:19]
    v_cvt_pk_bf16_f32 v102, v144, v145
    v_cvt_pk_bf16_f32 v103, v146, v147
    v_mfma_f32_4x4x4_16b_bf16 v[140:143], v[216:217], v[76:77], v[20:23]
    v_cvt_pk_bf16_f32 v104, v246, v247
    v_cvt_pk_bf16_f32 v105, v248, v249
    v_mfma_f32_4x4x4_16b_bf16 v[144:147], v[218:219], v[78:79], v[24:27]
    v_cvt_pk_bf16_f32 v106, v250, v251
    v_cvt_pk_bf16_f32 v107, v252, v253
    v_mfma_f32_4x4x4_16b_bf16 v[246:249], v[220:221], v[80:81], v[28:31]
    v_cvt_pk_bf16_f32 v108, v140, v141
    v_cvt_pk_bf16_f32 v109, v142, v143
    v_mfma_f32_4x4x4_16b_bf16 v[250:253], v[222:223], v[82:83], v[32:35]
    v_cvt_pk_bf16_f32 v110, v144, v145
    v_cvt_pk_bf16_f32 v111, v146, v147
    v_mfma_f32_4x4x4_16b_bf16 v[140:143], v[216:217], v[84:85], v[36:39]
    v_cvt_pk_bf16_f32 v112, v246, v247
    v_cvt_pk_bf16_f32 v113, v248, v249
    v_mfma_f32_4x4x4_16b_bf16 v[144:147], v[218:219], v[86:87], v[40:43]
    v_cvt_pk_bf16_f32 v114, v250, v251
    v_cvt_pk_bf16_f32 v115, v252, v253
    v_mfma_f32_4x4x4_16b_bf16 v[246:249], v[220:221], v[88:89], v[44:47]
    v_cvt_pk_bf16_f32 v116, v140, v141
    v_cvt_pk_bf16_f32 v117, v142, v143
    v_mfma_f32_4x4x4_16b_bf16 v[250:253], v[222:223], v[90:91], v[48:51]
    v_cvt_pk_bf16_f32 v118, v144, v145
    v_cvt_pk_bf16_f32 v119, v146, v147
    v_mfma_f32_4x4x4_16b_bf16 v[140:143], v[216:217], v[92:93], v[52:55]
    v_cvt_pk_bf16_f32 v120, v246, v247
    v_cvt_pk_bf16_f32 v121, v248, v249
    v_mfma_f32_4x4x4_16b_bf16 v[144:147], v[218:219], v[94:95], v[56:59]
    v_cvt_pk_bf16_f32 v122, v250, v251
    v_cvt_pk_bf16_f32 v123, v252, v253
    v_mfma_f32_4x4x4_16b_bf16 v[246:249], v[220:221], v[96:97], v[60:63]
    v_cvt_pk_bf16_f32 v124, v140, v141
    v_cvt_pk_bf16_f32 v125, v142, v143
    v_mfma_f32_4x4x4_16b_bf16 v[250:253], v[222:223], v[98:99], v[64:67]
    v_cvt_pk_bf16_f32 v126, v144, v145
    v_cvt_pk_bf16_f32 v127, v146, v147
    v_cvt_pk_bf16_f32 v128, v246, v247
    v_cvt_pk_bf16_f32 v129, v248, v249
    v_add_u32 v239, 272, v239
    v_cvt_pk_bf16_f32 v130, v250, v251
    v_cvt_pk_bf16_f32 v131, v252, v253
    s_waitcnt lgkmcnt(0)
    s_branch Lf_evd2
Lf_fl3:
    v_cvt_pk_bf16_f32 v246, v212, v212
    v_mov_b32 v212, 0
    ds_write_b16 v240, v246
    v_add_u32 v240, 128, v240
    s_bitcmp0_b32 s37, 3
    s_cbranch_scc1 Lf_evd3
    s_branch Lf_ev23
Lf_ev3:
    s_bitcmp1_b64 s[56:57], 3
    s_cbranch_scc1 Lf_fl3
Lf_ev23:
    s_bitcmp1_b64 s[56:57], 5
    s_cbranch_scc1 Lf_w3
    s_sub_u32 s60, s60, 1
    s_cbranch_scc0 Lf_nsa3
    s_mov_b32 s49, 8
    s_call_b64 s[62:63], L_swap
Lf_nsa3:
    s_add_u32 s35, s35, s31
    s_min_u32 s35, s35, 419404800
    s_xor_b32 s31, s31, 0x63ff800
    s_branch Lf_evd3
Lf_w3:
    s_bitcmp0_b64 s[56:57], 8
    s_cbranch_scc1 Lf_e13
    s_sub_u32 s60, s60, 1
    s_cbranch_scc0 Lf_nsb3
    s_mov_b32 s49, 8
    s_call_b64 s[62:63], L_swap
    s_waitcnt lgkmcnt(0)
Lf_nsb3:
    s_add_u32 s35, s35, s31
    s_min_u32 s35, s35, 419404800
    s_xor_b32 s31, s31, 0x63ff800
Lf_e13:
    s_sub_u32 s61, s61, 1
    s_cbranch_scc1 Lf_last3
    s_bitcmp0_b32 s33, s61
    s_cbranch_scc1 Lf_nw3
    s_cmp_eq_u32 s61, 3
    s_cselect_b32 s66, s80, s81
    v_add_u32 v238, s66, v238
    v_add_u32 v239, s66, v239
    ds_read_u16 v224, v238 offset:0
    ds_read_u16 v225, v238 offset:8
    ds_read_u16 v226, v238 offset:64
    ds_read_u16 v227, v238 offset:72
    s_waitcnt lgkmcnt(0)
Lf_nw3:
    v_mul_u32_u24 v216, v224, v241
    v_mul_u32_u24 v217, v224, v242
    v_mul_u32_u24 v218, v225, v241
    v_mul_u32_u24 v219, v225, v242
    v_mul_u32_u24 v220, v226, v241
    v_mul_u32_u24 v221, v226, v242
    v_mul_u32_u24 v222, v227, v241
    v_mul_u32_u24 v223, v227, v242
    v_mfma_f32_4x4x4_16b_bf16 v[140:143], v[216:217], v[68:69], v[4:7]
    v_add_u32 v238, 128, v238
    ds_read_b128 v[164:167], v239 offset:0
    ds_read_b128 v[168:171], v239 offset:64
    v_mfma_f32_4x4x4_16b_bf16 v[144:147], v[218:219], v[70:71], v[8:11]
    ds_read_b128 v[172:175], v239 offset:128
    ds_read_b128 v[176:179], v239 offset:192
    ds_read_u16 v224, v238 offset:0
    ds_read_u16 v225, v238 offset:8
    ds_read_u16 v226, v238 offset:64
    ds_read_u16 v227, v238 offset:72
    v_mfma_f32_4x4x4_16b_bf16 v[246:249], v[220:221], v[72:73], v[12:15]
    v_cvt_pk_bf16_f32 v100, v140, v141
    v_cvt_pk_bf16_f32 v101, v142, v143
    v_mfma_f32_4x4x4_16b_bf16 v[250:253], v[222:223], v[74:75], v[16:19]
    v_cvt_pk_bf16_f32 v102, v144, v145
    v_cvt_pk_bf16_f32 v103, v146, v147
    v_mfma_f32_4x4x4_16b_bf16 v[140:143], v[216:217], v[76:77], v[20:23]
    v_cvt_pk_bf16_f32 v104, v246, v247
    v_cvt_pk_bf16_f32 v105, v248, v249
    v_mfma_f32_4x4x4_16b_bf16 v[144:147], v[218:219], v[78:79], v[24:27]
    v_cvt_pk_bf16_f32 v106, v250, v251
    v_cvt_pk_bf16_f32 v107, v252, v253
    v_mfma_f32_4x4x4_16b_bf16 v[246:249], v[220:221], v[80:81], v[28:31]
    v_cvt_pk_bf16_f32 v108, v140, v141
    v_cvt_pk_bf16_f32 v109, v142, v143
    v_mfma_f32_4x4x4_16b_bf16 v[250:253], v[222:223], v[82:83], v[32:35]
    v_cvt_pk_bf16_f32 v110, v144, v145
    v_cvt_pk_bf16_f32 v111, v146, v147
    v_mfma_f32_4x4x4_16b_bf16 v[140:143], v[216:217], v[84:85], v[36:39]
    v_cvt_pk_bf16_f32 v112, v246, v247
    v_cvt_pk_bf16_f32 v113, v248, v249
    v_mfma_f32_4x4x4_16b_bf16 v[144:147], v[218:219], v[86:87], v[40:43]
    v_cvt_pk_bf16_f32 v114, v250, v251
    v_cvt_pk_bf16_f32 v115, v252, v253
    v_mfma_f32_4x4x4_16b_bf16 v[246:249], v[220:221], v[88:89], v[44:47]
    v_cvt_pk_bf16_f32 v116, v140, v141
    v_cvt_pk_bf16_f32 v117, v142, v143
    v_mfma_f32_4x4x4_16b_bf16 v[250:253], v[222:223], v[90:91], v[48:51]
    v_cvt_pk_bf16_f32 v118, v144, v145
    v_cvt_pk_bf16_f32 v119, v146, v147
    v_mfma_f32_4x4x4_16b_bf16 v[140:143], v[216:217], v[92:93], v[52:55]
    v_cvt_pk_bf16_f32 v120, v246, v247
    v_cvt_pk_bf16_f32 v121, v248, v249
    v_mfma_f32_4x4x4_16b_bf16 v[144:147], v[218:219], v[94:95], v[56:59]
    v_cvt_pk_bf16_f32 v122, v250, v251
    v_cvt_pk_bf16_f32 v123, v252, v253
    v_mfma_f32_4x4x4_16b_bf16 v[246:249], v[220:221], v[96:97], v[60:63]
    v_cvt_pk_bf16_f32 v124, v140, v141
    v_cvt_pk_bf16_f32 v125, v142, v143
    v_mfma_f32_4x4x4_16b_bf16 v[250:253], v[222:223], v[98:99], v[64:67]
    v_cvt_pk_bf16_f32 v126, v144, v145
    v_cvt_pk_bf16_f32 v127, v146, v147
    v_cvt_pk_bf16_f32 v128, v246, v247
    v_cvt_pk_bf16_f32 v129, v248, v249
    v_add_u32 v239, 272, v239
    v_cvt_pk_bf16_f32 v130, v250, v251
    v_cvt_pk_bf16_f32 v131, v252, v253
    s_waitcnt lgkmcnt(0)
    s_branch Lf_evd3
Lf_last0:
    s_branch Lf_tail
Lf_last1:
    v_add_u32 v236, 2080, v236
    s_lshr_b64 s[56:57], s[56:57], 1
    s_branch Lf_tail
Lf_last2:
    v_add_u32 v236, 4160, v236
    s_lshr_b64 s[56:57], s[56:57], 2
    s_branch Lf_tail
Lf_last3:
    v_add_u32 v236, 6240, v236
    s_lshr_b64 s[56:57], s[56:57], 3
Lf_tail:
    v_mfma_f32_16x16x32_bf16 v[208:211], v[136:139], v[200:203], v[208:211]
    v_exp_f32 v132, v148
    v_exp_f32 v133, v149
    v_exp_f32 v134, v150
    v_exp_f32 v135, v151
    v_exp_f32 v136, v152
    v_exp_f32 v137, v153
    v_mfma_f32_4x4x4_16b_bf16 v[132:135], v[228:229], v[228:229], v[132:135]
    v_exp_f32 v138, v154
    v_exp_f32 v139, v155
    v_cvt_pk_bf16_f32 v208, v208, v209
    v_cvt_pk_bf16_f32 v209, v210, v211
    v_exp_f32 v140, v156
    v_exp_f32 v141, v157
    v_mfma_f32_4x4x4_16b_bf16 v[212:215], v[208:209], v[188:189], v[212:215] cbsz:4 abid:0
    v_mfma_f32_4x4x4_16b_bf16 v[136:139], v[228:229], v[228:229], v[136:139]
    v_exp_f32 v142, v158
    v_mfma_f32_4x4x4_16b_bf16 v[212:215], v[208:209], v[190:191], v[212:215] cbsz:4 abid:4
    v_exp_f32 v143, v159
    v_exp_f32 v144, v160
    v_mfma_f32_4x4x4_16b_bf16 v[212:215], v[208:209], v[192:193], v[212:215] cbsz:4 abid:8
    v_exp_f32 v145, v161
    v_mfma_f32_4x4x4_16b_bf16 v[140:143], v[228:229], v[228:229], v[140:143]
    v_mfma_f32_4x4x4_16b_bf16 v[212:215], v[208:209], v[194:195], v[212:215] cbsz:4 abid:12
    ds_read_b64_tr_b16 v[188:189], v236 offset:0
    ds_read_b64_tr_b16 v[190:191], v236 offset:512
    ds_read_b64_tr_b16 v[192:193], v236 offset:1056
    ds_read_b64_tr_b16 v[194:195], v236 offset:1568
    v_exp_f32 v146, v162
    v_exp_f32 v147, v163
    v_rcp_f32 v132, v132
    v_rcp_f32 v133, v133
    v_mfma_f32_4x4x4_16b_bf16 v[144:147], v[228:229], v[228:229], v[144:147]
    v_rcp_f32 v134, v134
    s_bitcmp0_b64 s[56:57], 1
    s_cbranch_scc1 Lf_tnf
    v_cvt_pk_bf16_f32 v246, v212, v212
    v_mov_b32 v212, 0
    ds_write_b16 v240, v246
    v_add_u32 v240, 128, v240
Lf_tnf:
    v_cvt_pk_bf16_f32 v132, v132, v133
    s_waitcnt lgkmcnt(0)
    v_rcp_f32 v135, v135
    v_rcp_f32 v136, v136
    v_cvt_pk_bf16_f32 v133, v134, v135
    v_rcp_f32 v137, v137
    v_rcp_f32 v138, v138
    v_cvt_pk_bf16_f32 v134, v136, v137
    v_rcp_f32 v139, v139
    v_rcp_f32 v140, v140
    v_cvt_pk_bf16_f32 v135, v138, v139
    v_rcp_f32 v141, v141
    v_rcp_f32 v142, v142
    v_cvt_pk_bf16_f32 v136, v140, v141
    v_mfma_f32_16x16x32_bf16 v[208:211], v[132:135], v[196:199], v[204:207]
    v_rcp_f32 v143, v143
    v_rcp_f32 v144, v144
    v_cvt_pk_bf16_f32 v137, v142, v143
    v_rcp_f32 v145, v145
    v_rcp_f32 v146, v146
    v_rcp_f32 v147, v147
    v_cvt_pk_bf16_f32 v138, v144, v145
    v_cvt_pk_bf16_f32 v139, v146, v147
    s_nop 1
    v_mfma_f32_16x16x32_bf16 v[208:211], v[136:139], v[200:203], v[208:211]
    s_nop 7
    v_cvt_pk_bf16_f32 v208, v208, v209
    v_cvt_pk_bf16_f32 v209, v210, v211
    s_nop 1
    v_mfma_f32_4x4x4_16b_bf16 v[212:215], v[208:209], v[188:189], v[212:215] cbsz:4 abid:0
    s_nop 1
    v_mfma_f32_4x4x4_16b_bf16 v[212:215], v[208:209], v[190:191], v[212:215] cbsz:4 abid:4
    s_nop 1
    v_mfma_f32_4x4x4_16b_bf16 v[212:215], v[208:209], v[192:193], v[212:215] cbsz:4 abid:8
    s_nop 1
    v_mfma_f32_4x4x4_16b_bf16 v[212:215], v[208:209], v[194:195], v[212:215] cbsz:4 abid:12
    s_nop 4
    v_cvt_pk_bf16_f32 v246, v212, v212
    ds_write_b16 v240, v246
L_store:
    s_add_u32 s66, s52, 14912
    v_lshl_add_u32 v247, v0, 4, s66
    s_lshl_b32 s66, s82, 5
    s_bfm_b64 exec, 16, 32
    v_add_u32 v243, s66, v243
    s_lshl_b32 s66, s83, 5
    s_bfm_b64 exec, 16, 48
    v_add_u32 v243, s66, v243
    s_mov_b64 exec, -1
    ds_read_b128 v[148:151], v247
    s_waitcnt lgkmcnt(0)
    global_store_dwordx4 v243, v[148:151], s[18:19] sc0 sc1
L_end:
    s_endpgm
L_general:
    s_waitcnt vmcnt(0)
    ds_read_b128 v[44:47], v246 offset:20480
    ds_read_b128 v[48:51], v246 offset:21504
    ds_read_b128 v[88:91], v246 offset:22528
    ds_read_b128 v[52:55], v246 offset:40960
    ds_read_b128 v[56:59], v246 offset:41984
    ds_read_b128 v[92:95], v246 offset:43008
    ds_read_b128 v[60:63], v246 offset:61440
    ds_read_b128 v[64:67], v246 offset:62464
    ds_read_b128 v[96:99], v246 offset:63488
    ds_read_u16 v224, v238 offset:0
    ds_read_u16 v225, v238 offset:8
    ds_read_u16 v226, v238 offset:64
    ds_read_u16 v227, v238 offset:72
    s_mul_i32 s35, s53, 51200
    s_movk_i32 s31, 25600
    s_mov_b32 s60, 3
    s_mov_b64 s[56:57], 0
    v_mov_b32 v148, -1
    v_mov_b32 v149, -1
    v_mov_b32 v150, -1
    v_mov_b32 v151, -1
    s_add_u32 s66, s52, 18432
    v_add_u32 v152, s66, v2
    ds_write_b128 v152, v[148:151]
    ds_write_b128 v152, v[148:151] offset:1024
    s_add_u32 s64, s52, 18448
    s_bfm_b64 s[28:29], 50, 0
    s_mul_i32 s66, s53, 800
    v_add_u32 v247, s66, v2
    s_mov_b64 exec, s[28:29]
    global_load_dwordx4 v[100:103], v247, s[8:9]
    v_add_u32 v247, 1638400, v247
    global_load_dwordx4 v[104:107], v247, s[8:9]
    v_add_u32 v247, 1638400, v247
    global_load_dwordx4 v[108:111], v247, s[8:9]
    v_add_u32 v247, 1638400, v247
    global_load_dwordx4 v[112:115], v247, s[8:9]
    v_add_u32 v247, 1638400, v247
    s_mov_b64 exec, -1
    v_cmp_lt_u32 vcc, 24, v0
    s_nop 1
    v_cndmask_b32 v145, 0, 1, vcc
    v_mul_u32_u24 v142, 25, v145
    v_sub_u32 v142, v0, v142
    v_mul_u32_u24 v142, 0x80008, v142
    v_add_u32 v141, 0x10000, v142
    v_add_u32 v143, 0x50004, v142
    v_add_u32 v144, 0x70006, v142
    v_add_u32 v142, 0x30002, v142
    s_waitcnt vmcnt(0)
    s_mov_b64 exec, s[28:29]
    v_cmp_neq_f16_sdwa s[68:69], v100, 0 src0_sel:WORD_0 src1_sel:WORD_0
    v_cmp_neq_f16_sdwa s[70:71], v100, 0 src0_sel:WORD_1 src1_sel:WORD_0
    v_cmp_neq_f16_sdwa s[72:73], v101, 0 src0_sel:WORD_0 src1_sel:WORD_0
    v_cmp_neq_f16_sdwa s[74:75], v101, 0 src0_sel:WORD_1 src1_sel:WORD_0
    v_cmp_neq_f16_sdwa s[76:77], v102, 0 src0_sel:WORD_0 src1_sel:WORD_0
    v_cmp_neq_f16_sdwa s[78:79], v102, 0 src0_sel:WORD_1 src1_sel:WORD_0
    v_cmp_neq_f16_sdwa s[80:81], v103, 0 src0_sel:WORD_0 src1_sel:WORD_0
    v_cmp_neq_f16_sdwa s[82:83], v103, 0 src0_sel:WORD_1 src1_sel:WORD_0
    s_mov_b64 exec, -1
    v_mov_b32 v132, s64
    v_mbcnt_lo_u32_b32 v132, s68, v132
    v_mbcnt_hi_u32_b32 v132, s69, v132
    v_mbcnt_lo_u32_b32 v132, s70, v132
    v_mbcnt_hi_u32_b32 v132, s71, v132
    v_mbcnt_lo_u32_b32 v132, s72, v132
    v_mbcnt_hi_u32_b32 v132, s73, v132
    v_mbcnt_lo_u32_b32 v132, s74, v132
    v_mbcnt_hi_u32_b32 v132, s75, v132
    v_mbcnt_lo_u32_b32 v132, s76, v132
    v_mbcnt_hi_u32_b32 v132, s77, v132
    v_mbcnt_lo_u32_b32 v132, s78, v132
    v_mbcnt_hi_u32_b32 v132, s79, v132
    v_mbcnt_lo_u32_b32 v132, s80, v132
    v_mbcnt_hi_u32_b32 v132, s81, v132
    v_mbcnt_lo_u32_b32 v132, s82, v132
    v_mbcnt_hi_u32_b32 v132, s83, v132
    s_add_u32 s55, s64, 16
    v_readlane_b32 s66, v132, 25
    v_readlane_b32 s67, v132, 63
    s_add_u32 s64, s66, 15
    s_and_b32 s64, s64, -16
    s_max_u32 s64, s64, s55
    s_sub_u32 s66, s64, s66
    v_mad_u32_u24 v132, v145, s66, v132
    s_mov_b32 s55, s64
    v_addc_co_u32 v133, vcc, 0, v132, s[68:69]
    v_addc_co_u32 v134, vcc, 0, v133, s[70:71]
    v_addc_co_u32 v135, vcc, 0, v134, s[72:73]
    v_addc_co_u32 v136, vcc, 0, v135, s[74:75]
    v_addc_co_u32 v137, vcc, 0, v136, s[76:77]
    v_addc_co_u32 v138, vcc, 0, v137, s[78:79]
    v_addc_co_u32 v139, vcc, 0, v138, s[80:81]
    s_add_u32 s67, s67, s66
    s_add_u32 s67, s67, 15
    s_and_b32 s67, s67, -16
    s_add_u32 s64, s64, 16
    s_max_u32 s64, s64, s67
    s_mov_b64 exec, s[68:69]
    ds_write_b8 v132, v141
    s_mov_b64 exec, s[70:71]
    ds_write_b8_d16_hi v133, v141
    s_mov_b64 exec, s[72:73]
    ds_write_b8 v134, v142
    s_mov_b64 exec, s[74:75]
    ds_write_b8_d16_hi v135, v142
    s_mov_b64 exec, s[76:77]
    ds_write_b8 v136, v143
    s_mov_b64 exec, s[78:79]
    ds_write_b8_d16_hi v137, v143
    s_mov_b64 exec, s[80:81]
    ds_write_b8 v138, v144
    s_mov_b64 exec, s[82:83]
    ds_write_b8_d16_hi v139, v144
    s_mov_b64 exec, -1
    s_lshr_b32 s95, s55, 4
    s_bitset1_b64 s[56:57], s95
    s_lshr_b32 s95, s64, 4
    s_bitset1_b64 s[56:57], s95
    s_mov_b64 exec, s[28:29]
    v_cmp_neq_f16_sdwa s[68:69], v104, 0 src0_sel:WORD_0 src1_sel:WORD_0
    v_cmp_neq_f16_sdwa s[70:71], v104, 0 src0_sel:WORD_1 src1_sel:WORD_0
    v_cmp_neq_f16_sdwa s[72:73], v105, 0 src0_sel:WORD_0 src1_sel:WORD_0
    v_cmp_neq_f16_sdwa s[74:75], v105, 0 src0_sel:WORD_1 src1_sel:WORD_0
    v_cmp_neq_f16_sdwa s[76:77], v106, 0 src0_sel:WORD_0 src1_sel:WORD_0
    v_cmp_neq_f16_sdwa s[78:79], v106, 0 src0_sel:WORD_1 src1_sel:WORD_0
    v_cmp_neq_f16_sdwa s[80:81], v107, 0 src0_sel:WORD_0 src1_sel:WORD_0
    v_cmp_neq_f16_sdwa s[82:83], v107, 0 src0_sel:WORD_1 src1_sel:WORD_0
    s_mov_b64 exec, -1
    v_mov_b32 v132, s64
    v_mbcnt_lo_u32_b32 v132, s68, v132
    v_mbcnt_hi_u32_b32 v132, s69, v132
    v_mbcnt_lo_u32_b32 v132, s70, v132
    v_mbcnt_hi_u32_b32 v132, s71, v132
    v_mbcnt_lo_u32_b32 v132, s72, v132
    v_mbcnt_hi_u32_b32 v132, s73, v132
    v_mbcnt_lo_u32_b32 v132, s74, v132
    v_mbcnt_hi_u32_b32 v132, s75, v132
    v_mbcnt_lo_u32_b32 v132, s76, v132
    v_mbcnt_hi_u32_b32 v132, s77, v132
    v_mbcnt_lo_u32_b32 v132, s78, v132
    v_mbcnt_hi_u32_b32 v132, s79, v132
    v_mbcnt_lo_u32_b32 v132, s80, v132
    v_mbcnt_hi_u32_b32 v132, s81, v132
    v_mbcnt_lo_u32_b32 v132, s82, v132
    v_mbcnt_hi_u32_b32 v132, s83, v132
    s_add_u32 s55, s64, 16
    v_readlane_b32 s66, v132, 25
    v_readlane_b32 s67, v132, 63
    s_add_u32 s64, s66, 15
    s_and_b32 s64, s64, -16
    s_max_u32 s64, s64, s55
    s_sub_u32 s66, s64, s66
    v_mad_u32_u24 v132, v145, s66, v132
    s_mov_b32 s55, s64
    v_addc_co_u32 v133, vcc, 0, v132, s[68:69]
    v_addc_co_u32 v134, vcc, 0, v133, s[70:71]
    v_addc_co_u32 v135, vcc, 0, v134, s[72:73]
    v_addc_co_u32 v136, vcc, 0, v135, s[74:75]
    v_addc_co_u32 v137, vcc, 0, v136, s[76:77]
    v_addc_co_u32 v138, vcc, 0, v137, s[78:79]
    v_addc_co_u32 v139, vcc, 0, v138, s[80:81]
    s_add_u32 s67, s67, s66
    s_add_u32 s67, s67, 15
    s_and_b32 s67, s67, -16
    s_add_u32 s64, s64, 16
    s_max_u32 s64, s64, s67
    s_mov_b64 exec, s[68:69]
    ds_write_b8 v132, v141
    s_mov_b64 exec, s[70:71]
    ds_write_b8_d16_hi v133, v141
    s_mov_b64 exec, s[72:73]
    ds_write_b8 v134, v142
    s_mov_b64 exec, s[74:75]
    ds_write_b8_d16_hi v135, v142
    s_mov_b64 exec, s[76:77]
    ds_write_b8 v136, v143
    s_mov_b64 exec, s[78:79]
    ds_write_b8_d16_hi v137, v143
    s_mov_b64 exec, s[80:81]
    ds_write_b8 v138, v144
    s_mov_b64 exec, s[82:83]
    ds_write_b8_d16_hi v139, v144
    s_mov_b64 exec, -1
    s_lshr_b32 s95, s55, 4
    s_bitset1_b64 s[56:57], s95
    s_lshr_b32 s95, s64, 4
    s_bitset1_b64 s[56:57], s95
    s_mov_b32 s44, s64
    s_mov_b64 exec, s[28:29]
    v_cmp_neq_f16_sdwa s[68:69], v108, 0 src0_sel:WORD_0 src1_sel:WORD_0
    v_cmp_neq_f16_sdwa s[70:71], v108, 0 src0_sel:WORD_1 src1_sel:WORD_0
    v_cmp_neq_f16_sdwa s[72:73], v109, 0 src0_sel:WORD_0 src1_sel:WORD_0
    v_cmp_neq_f16_sdwa s[74:75], v109, 0 src0_sel:WORD_1 src1_sel:WORD_0
    v_cmp_neq_f16_sdwa s[76:77], v110, 0 src0_sel:WORD_0 src1_sel:WORD_0
    v_cmp_neq_f16_sdwa s[78:79], v110, 0 src0_sel:WORD_1 src1_sel:WORD_0
    v_cmp_neq_f16_sdwa s[80:81], v111, 0 src0_sel:WORD_0 src1_sel:WORD_0
    v_cmp_neq_f16_sdwa s[82:83], v111, 0 src0_sel:WORD_1 src1_sel:WORD_0
    s_mov_b64 exec, -1
    v_mov_b32 v132, s64
    v_mbcnt_lo_u32_b32 v132, s68, v132
    v_mbcnt_hi_u32_b32 v132, s69, v132
    v_mbcnt_lo_u32_b32 v132, s70, v132
    v_mbcnt_hi_u32_b32 v132, s71, v132
    v_mbcnt_lo_u32_b32 v132, s72, v132
    v_mbcnt_hi_u32_b32 v132, s73, v132
    v_mbcnt_lo_u32_b32 v132, s74, v132
    v_mbcnt_hi_u32_b32 v132, s75, v132
    v_mbcnt_lo_u32_b32 v132, s76, v132
    v_mbcnt_hi_u32_b32 v132, s77, v132
    v_mbcnt_lo_u32_b32 v132, s78, v132
    v_mbcnt_hi_u32_b32 v132, s79, v132
    v_mbcnt_lo_u32_b32 v132, s80, v132
    v_mbcnt_hi_u32_b32 v132, s81, v132
    v_mbcnt_lo_u32_b32 v132, s82, v132
    v_mbcnt_hi_u32_b32 v132, s83, v132
    s_add_u32 s55, s64, 16
    v_readlane_b32 s66, v132, 25
    v_readlane_b32 s67, v132, 63
    s_add_u32 s64, s66, 15
    s_and_b32 s64, s64, -16
    s_max_u32 s64, s64, s55
    s_sub_u32 s66, s64, s66
    v_mad_u32_u24 v132, v145, s66, v132
    s_mov_b32 s55, s64
    v_addc_co_u32 v133, vcc, 0, v132, s[68:69]
    v_addc_co_u32 v134, vcc, 0, v133, s[70:71]
    v_addc_co_u32 v135, vcc, 0, v134, s[72:73]
    v_addc_co_u32 v136, vcc, 0, v135, s[74:75]
    v_addc_co_u32 v137, vcc, 0, v136, s[76:77]
    v_addc_co_u32 v138, vcc, 0, v137, s[78:79]
    v_addc_co_u32 v139, vcc, 0, v138, s[80:81]
    s_add_u32 s67, s67, s66
    s_add_u32 s67, s67, 15
    s_and_b32 s67, s67, -16
    s_add_u32 s64, s64, 16
    s_max_u32 s64, s64, s67
    s_mov_b64 exec, s[68:69]
    ds_write_b8 v132, v141
    s_mov_b64 exec, s[70:71]
    ds_write_b8_d16_hi v133, v141
    s_mov_b64 exec, s[72:73]
    ds_write_b8 v134, v142
    s_mov_b64 exec, s[74:75]
    ds_write_b8_d16_hi v135, v142
    s_mov_b64 exec, s[76:77]
    ds_write_b8 v136, v143
    s_mov_b64 exec, s[78:79]
    ds_write_b8_d16_hi v137, v143
    s_mov_b64 exec, s[80:81]
    ds_write_b8 v138, v144
    s_mov_b64 exec, s[82:83]
    ds_write_b8_d16_hi v139, v144
    s_mov_b64 exec, -1
    s_mov_b32 s45, s55
    s_mov_b32 s46, s64
    s_mov_b64 exec, s[28:29]
    v_cmp_neq_f16_sdwa s[68:69], v112, 0 src0_sel:WORD_0 src1_sel:WORD_0
    v_cmp_neq_f16_sdwa s[70:71], v112, 0 src0_sel:WORD_1 src1_sel:WORD_0
    v_cmp_neq_f16_sdwa s[72:73], v113, 0 src0_sel:WORD_0 src1_sel:WORD_0
    v_cmp_neq_f16_sdwa s[74:75], v113, 0 src0_sel:WORD_1 src1_sel:WORD_0
    v_cmp_neq_f16_sdwa s[76:77], v114, 0 src0_sel:WORD_0 src1_sel:WORD_0
    v_cmp_neq_f16_sdwa s[78:79], v114, 0 src0_sel:WORD_1 src1_sel:WORD_0
    v_cmp_neq_f16_sdwa s[80:81], v115, 0 src0_sel:WORD_0 src1_sel:WORD_0
    v_cmp_neq_f16_sdwa s[82:83], v115, 0 src0_sel:WORD_1 src1_sel:WORD_0
    s_mov_b64 exec, -1
    v_mov_b32 v132, s64
    v_mbcnt_lo_u32_b32 v132, s68, v132
    v_mbcnt_hi_u32_b32 v132, s69, v132
    v_mbcnt_lo_u32_b32 v132, s70, v132
    v_mbcnt_hi_u32_b32 v132, s71, v132
    v_mbcnt_lo_u32_b32 v132, s72, v132
    v_mbcnt_hi_u32_b32 v132, s73, v132
    v_mbcnt_lo_u32_b32 v132, s74, v132
    v_mbcnt_hi_u32_b32 v132, s75, v132
    v_mbcnt_lo_u32_b32 v132, s76, v132
    v_mbcnt_hi_u32_b32 v132, s77, v132
    v_mbcnt_lo_u32_b32 v132, s78, v132
    v_mbcnt_hi_u32_b32 v132, s79, v132
    v_mbcnt_lo_u32_b32 v132, s80, v132
    v_mbcnt_hi_u32_b32 v132, s81, v132
    v_mbcnt_lo_u32_b32 v132, s82, v132
    v_mbcnt_hi_u32_b32 v132, s83, v132
    s_add_u32 s55, s64, 16
    v_readlane_b32 s66, v132, 25
    v_readlane_b32 s67, v132, 63
    s_add_u32 s64, s66, 15
    s_and_b32 s64, s64, -16
    s_max_u32 s64, s64, s55
    s_sub_u32 s66, s64, s66
    v_mad_u32_u24 v132, v145, s66, v132
    s_mov_b32 s55, s64
    v_addc_co_u32 v133, vcc, 0, v132, s[68:69]
    v_addc_co_u32 v134, vcc, 0, v133, s[70:71]
    v_addc_co_u32 v135, vcc, 0, v134, s[72:73]
    v_addc_co_u32 v136, vcc, 0, v135, s[74:75]
    v_addc_co_u32 v137, vcc, 0, v136, s[76:77]
    v_addc_co_u32 v138, vcc, 0, v137, s[78:79]
    v_addc_co_u32 v139, vcc, 0, v138, s[80:81]
    s_add_u32 s67, s67, s66
    s_add_u32 s67, s67, 15
    s_and_b32 s67, s67, -16
    s_add_u32 s64, s64, 16
    s_max_u32 s64, s64, s67
    s_mov_b64 exec, s[68:69]
    ds_write_b8 v132, v141
    s_mov_b64 exec, s[70:71]
    ds_write_b8_d16_hi v133, v141
    s_mov_b64 exec, s[72:73]
    ds_write_b8 v134, v142
    s_mov_b64 exec, s[74:75]
    ds_write_b8_d16_hi v135, v142
    s_mov_b64 exec, s[76:77]
    ds_write_b8 v136, v143
    s_mov_b64 exec, s[78:79]
    ds_write_b8_d16_hi v137, v143
    s_mov_b64 exec, s[80:81]
    ds_write_b8 v138, v144
    s_mov_b64 exec, s[82:83]
    ds_write_b8_d16_hi v139, v144
    s_mov_b64 exec, -1
    s_mov_b32 s47, s55
    s_mov_b32 s48, s64
    s_mov_b32 s94, 0
    s_mov_b64 s[84:85], -1
    s_branch L_listed
Ls_loop:
Ls_mid:
    s_bitcmp1_b32 s36, 0
    s_cbranch_scc1 Ls_ev0
Ls_evd0:
    v_mfma_f32_16x16x32_bf16 v[208:211], v[136:139], v[200:203], v[208:211]
    ds_read_b32 v246, v244 offset:0
    s_waitcnt lgkmcnt(0)
    v_bfe_u32 v247, v246, 0, 8
    v_lshlrev_b32 v247, 1, v247
    v_bfe_u32 v248, v246, 8, 8
    v_lshlrev_b32 v248, 1, v248
    v_bfe_u32 v249, v246, 16, 8
    v_lshlrev_b32 v249, 1, v249
    v_bfe_u32 v250, v246, 24, 8
    v_lshlrev_b32 v250, 1, v250
    buffer_load_ushort v247, v247, s[24:27], 0 offen
    buffer_load_ushort v248, v248, s[24:27], 0 offen
    buffer_load_ushort v249, v249, s[24:27], 0 offen
    buffer_load_ushort v250, v250, s[24:27], 0 offen
    s_waitcnt vmcnt(0)
    v_lshlrev_b32 v247, 16, v247
    v_mul_f32 v208, v208, v247
    v_lshlrev_b32 v248, 16, v248
    v_mul_f32 v209, v209, v248
    v_lshlrev_b32 v249, 16, v249
    v_mul_f32 v210, v210, v249
    v_lshlrev_b32 v250, 16, v250
    v_mul_f32 v211, v211, v250
    v_exp_f32 v132, v148
    v_exp_f32 v133, v149
    v_exp_f32 v134, v150
    v_exp_f32 v135, v151
    v_exp_f32 v136, v152
    v_exp_f32 v137, v153
    v_mfma_f32_4x4x4_16b_bf16 v[132:135], v[228:229], v[228:229], v[132:135]
    v_exp_f32 v138, v154
    v_exp_f32 v139, v155
    v_cvt_pk_bf16_f32 v208, v208, v209
    v_cvt_pk_bf16_f32 v209, v210, v211
    v_exp_f32 v140, v156
    v_exp_f32 v141, v157
    v_mfma_f32_4x4x4_16b_bf16 v[212:215], v[208:209], v[188:189], v[212:215] cbsz:4 abid:0
    v_mfma_f32_4x4x4_16b_bf16 v[136:139], v[228:229], v[228:229], v[136:139]
    v_exp_f32 v142, v158
    v_mfma_f32_4x4x4_16b_bf16 v[212:215], v[208:209], v[190:191], v[212:215] cbsz:4 abid:4
    v_exp_f32 v143, v159
    v_exp_f32 v144, v160
    v_mfma_f32_4x4x4_16b_bf16 v[212:215], v[208:209], v[192:193], v[212:215] cbsz:4 abid:8
    v_exp_f32 v145, v161
    v_mfma_f32_4x4x4_16b_bf16 v[140:143], v[228:229], v[228:229], v[140:143]
    v_mfma_f32_4x4x4_16b_bf16 v[212:215], v[208:209], v[194:195], v[212:215] cbsz:4 abid:12
    ds_add_rtn_u32 v1, v2, v3
    ds_read_u8 v230, v237 offset:64
    ds_read_u8 v232, v237 offset:72
    ds_read_b64_tr_b16 v[188:189], v236 offset:0
    ds_read_b64_tr_b16 v[190:191], v236 offset:512
    ds_read_b64_tr_b16 v[192:193], v236 offset:1056
    ds_read_b64_tr_b16 v[194:195], v236 offset:1568
    s_waitcnt vmcnt(4)
    ds_read_b128 v[180:183], v234 offset:2080
    ds_read_b128 v[184:187], v235 offset:2080
    s_add_u32 m0, s52, 0
    v_exp_f32 v146, v162
    v_exp_f32 v147, v163
    v_rcp_f32 v132, v132
    v_rcp_f32 v133, v133
    v_mfma_f32_4x4x4_16b_bf16 v[144:147], v[228:229], v[228:229], v[144:147]
    v_rcp_f32 v134, v134
    v_cvt_pk_bf16_f32 v132, v132, v133
    s_waitcnt lgkmcnt(2)
    buffer_load_dwordx4 v[230:231], s[20:23], s35 idxen offen sc1 nt lds
    buffer_load_dwordx4 v[232:233], s[40:43], s35 idxen offen offset:1056 sc1 nt lds
    s_waitcnt lgkmcnt(0)
    v_mfma_f32_16x16x32_bf16 v[148:151], v[100:103], v[180:183], v[164:167]
    v_rcp_f32 v135, v135
    v_mfma_f32_16x16x32_bf16 v[152:155], v[108:111], v[180:183], v[168:171]
    v_rcp_f32 v136, v136
    v_cvt_pk_bf16_f32 v133, v134, v135
    v_mfma_f32_16x16x32_bf16 v[148:151], v[104:107], v[184:187], v[148:151]
    v_rcp_f32 v137, v137
    v_cmp_gt_i32 vcc, v1, v245
    s_setprio 0
    s_cbranch_vccz Ls_lo0
    s_setprio 1
Ls_lo0:
    v_mfma_f32_16x16x32_bf16 v[152:155], v[112:115], v[184:187], v[152:155]
    v_rcp_f32 v138, v138
    v_cvt_pk_bf16_f32 v134, v136, v137
    v_mfma_f32_16x16x32_bf16 v[156:159], v[116:119], v[180:183], v[172:175]
    v_rcp_f32 v139, v139
    v_mfma_f32_16x16x32_bf16 v[160:163], v[124:127], v[180:183], v[176:179]
    v_rcp_f32 v140, v140
    v_cvt_pk_bf16_f32 v135, v138, v139
    v_mfma_f32_16x16x32_bf16 v[156:159], v[120:123], v[184:187], v[156:159]
    v_rcp_f32 v141, v141
    v_mfma_f32_16x16x32_bf16 v[160:163], v[128:131], v[184:187], v[160:163]
    v_rcp_f32 v142, v142
    v_cvt_pk_bf16_f32 v136, v140, v141
    v_mfma_f32_16x16x32_bf16 v[208:211], v[132:135], v[196:199], v[204:207]
    v_rcp_f32 v143, v143
    v_rcp_f32 v144, v144
    v_cvt_pk_bf16_f32 v137, v142, v143
    v_rcp_f32 v145, v145
    v_rcp_f32 v146, v146
    v_rcp_f32 v147, v147
    v_cvt_pk_bf16_f32 v138, v144, v145
    v_cvt_pk_bf16_f32 v139, v146, v147
    s_bitcmp1_b32 s36, 1
    s_cbranch_scc1 Ls_ev1
Ls_evd1:
    v_mfma_f32_16x16x32_bf16 v[208:211], v[136:139], v[200:203], v[208:211]
    ds_read_b32 v246, v244 offset:16
    s_waitcnt lgkmcnt(0)
    v_bfe_u32 v247, v246, 0, 8
    v_lshlrev_b32 v247, 1, v247
    v_bfe_u32 v248, v246, 8, 8
    v_lshlrev_b32 v248, 1, v248
    v_bfe_u32 v249, v246, 16, 8
    v_lshlrev_b32 v249, 1, v249
    v_bfe_u32 v250, v246, 24, 8
    v_lshlrev_b32 v250, 1, v250
    buffer_load_ushort v247, v247, s[24:27], 0 offen
    buffer_load_ushort v248, v248, s[24:27], 0 offen
    buffer_load_ushort v249, v249, s[24:27], 0 offen
    buffer_load_ushort v250, v250, s[24:27], 0 offen
    s_waitcnt vmcnt(0)
    v_lshlrev_b32 v247, 16, v247
    v_mul_f32 v208, v208, v247
    v_lshlrev_b32 v248, 16, v248
    v_mul_f32 v209, v209, v248
    v_lshlrev_b32 v249, 16, v249
    v_mul_f32 v210, v210, v249
    v_lshlrev_b32 v250, 16, v250
    v_mul_f32 v211, v211, v250
    v_exp_f32 v132, v148
    v_exp_f32 v133, v149
    v_exp_f32 v134, v150
    v_exp_f32 v135, v151
    v_exp_f32 v136, v152
    v_exp_f32 v137, v153
    v_mfma_f32_4x4x4_16b_bf16 v[132:135], v[228:229], v[228:229], v[132:135]
    v_exp_f32 v138, v154
    v_exp_f32 v139, v155
    v_cvt_pk_bf16_f32 v208, v208, v209
    v_cvt_pk_bf16_f32 v209, v210, v211
    v_exp_f32 v140, v156
    v_exp_f32 v141, v157
    v_mfma_f32_4x4x4_16b_bf16 v[212:215], v[208:209], v[188:189], v[212:215] cbsz:4 abid:0
    v_mfma_f32_4x4x4_16b_bf16 v[136:139], v[228:229], v[228:229], v[136:139]
    v_exp_f32 v142, v158
    v_mfma_f32_4x4x4_16b_bf16 v[212:215], v[208:209], v[190:191], v[212:215] cbsz:4 abid:4
    v_exp_f32 v143, v159
    v_exp_f32 v144, v160
    v_mfma_f32_4x4x4_16b_bf16 v[212:215], v[208:209], v[192:193], v[212:215] cbsz:4 abid:8
    v_exp_f32 v145, v161
    v_mfma_f32_4x4x4_16b_bf16 v[140:143], v[228:229], v[228:229], v[140:143]
    v_mfma_f32_4x4x4_16b_bf16 v[212:215], v[208:209], v[194:195], v[212:215] cbsz:4 abid:12
    ds_read_u8 v230, v237 offset:80
    ds_read_u8 v232, v237 offset:88
    ds_read_b64_tr_b16 v[188:189], v236 offset:2080
    ds_read_b64_tr_b16 v[190:191], v236 offset:2592
    ds_read_b64_tr_b16 v[192:193], v236 offset:3136
    ds_read_b64_tr_b16 v[194:195], v236 offset:3648
    s_waitcnt vmcnt(4)
    ds_read_b128 v[180:183], v234 offset:4160
    ds_read_b128 v[184:187], v235 offset:4160
    s_add_u32 m0, s52, 2080
    v_exp_f32 v146, v162
    v_exp_f32 v147, v163
    v_rcp_f32 v132, v132
    v_rcp_f32 v133, v133
    v_mfma_f32_4x4x4_16b_bf16 v[144:147], v[228:229], v[228:229], v[144:147]
    v_rcp_f32 v134, v134
    v_cvt_pk_bf16_f32 v132, v132, v133
    s_waitcnt lgkmcnt(2)
    buffer_load_dwordx4 v[230:231], s[20:23], s35 idxen offen sc1 nt lds
    buffer_load_dwordx4 v[232:233], s[40:43], s35 idxen offen offset:1056 sc1 nt lds
    s_waitcnt lgkmcnt(0)
    v_mfma_f32_16x16x32_bf16 v[148:151], v[100:103], v[180:183], v[164:167]
    v_rcp_f32 v135, v135
    v_mfma_f32_16x16x32_bf16 v[152:155], v[108:111], v[180:183], v[168:171]
    v_rcp_f32 v136, v136
    v_cvt_pk_bf16_f32 v133, v134, v135
    v_mfma_f32_16x16x32_bf16 v[148:151], v[104:107], v[184:187], v[148:151]
    v_rcp_f32 v137, v137
    v_mfma_f32_16x16x32_bf16 v[152:155], v[112:115], v[184:187], v[152:155]
    v_rcp_f32 v138, v138
    v_cvt_pk_bf16_f32 v134, v136, v137
    v_mfma_f32_16x16x32_bf16 v[156:159], v[116:119], v[180:183], v[172:175]
    v_rcp_f32 v139, v139
    v_mfma_f32_16x16x32_bf16 v[160:163], v[124:127], v[180:183], v[176:179]
    v_rcp_f32 v140, v140
    v_cvt_pk_bf16_f32 v135, v138, v139
    v_mfma_f32_16x16x32_bf16 v[156:159], v[120:123], v[184:187], v[156:159]
    v_rcp_f32 v141, v141
    v_mfma_f32_16x16x32_bf16 v[160:163], v[128:131], v[184:187], v[160:163]
    v_rcp_f32 v142, v142
    v_cvt_pk_bf16_f32 v136, v140, v141
    v_mfma_f32_16x16x32_bf16 v[208:211], v[132:135], v[196:199], v[204:207]
    v_rcp_f32 v143, v143
    v_rcp_f32 v144, v144
    v_cvt_pk_bf16_f32 v137, v142, v143
    v_rcp_f32 v145, v145
    v_rcp_f32 v146, v146
    v_rcp_f32 v147, v147
    v_cvt_pk_bf16_f32 v138, v144, v145
    v_cvt_pk_bf16_f32 v139, v146, v147
    s_bitcmp1_b32 s36, 2
    s_cbranch_scc1 Ls_ev2
Ls_evd2:
    v_mfma_f32_16x16x32_bf16 v[208:211], v[136:139], v[200:203], v[208:211]
    ds_read_b32 v246, v244 offset:32
    s_waitcnt lgkmcnt(0)
    v_bfe_u32 v247, v246, 0, 8
    v_lshlrev_b32 v247, 1, v247
    v_bfe_u32 v248, v246, 8, 8
    v_lshlrev_b32 v248, 1, v248
    v_bfe_u32 v249, v246, 16, 8
    v_lshlrev_b32 v249, 1, v249
    v_bfe_u32 v250, v246, 24, 8
    v_lshlrev_b32 v250, 1, v250
    buffer_load_ushort v247, v247, s[24:27], 0 offen
    buffer_load_ushort v248, v248, s[24:27], 0 offen
    buffer_load_ushort v249, v249, s[24:27], 0 offen
    buffer_load_ushort v250, v250, s[24:27], 0 offen
    s_waitcnt vmcnt(0)
    v_lshlrev_b32 v247, 16, v247
    v_mul_f32 v208, v208, v247
    v_lshlrev_b32 v248, 16, v248
    v_mul_f32 v209, v209, v248
    v_lshlrev_b32 v249, 16, v249
    v_mul_f32 v210, v210, v249
    v_lshlrev_b32 v250, 16, v250
    v_mul_f32 v211, v211, v250
    v_exp_f32 v132, v148
    v_exp_f32 v133, v149
    v_exp_f32 v134, v150
    v_exp_f32 v135, v151
    v_exp_f32 v136, v152
    v_exp_f32 v137, v153
    v_mfma_f32_4x4x4_16b_bf16 v[132:135], v[228:229], v[228:229], v[132:135]
    v_exp_f32 v138, v154
    v_exp_f32 v139, v155
    v_cvt_pk_bf16_f32 v208, v208, v209
    v_cvt_pk_bf16_f32 v209, v210, v211
    v_exp_f32 v140, v156
    v_exp_f32 v141, v157
    v_mfma_f32_4x4x4_16b_bf16 v[212:215], v[208:209], v[188:189], v[212:215] cbsz:4 abid:0
    v_mfma_f32_4x4x4_16b_bf16 v[136:139], v[228:229], v[228:229], v[136:139]
    v_exp_f32 v142, v158
    v_mfma_f32_4x4x4_16b_bf16 v[212:215], v[208:209], v[190:191], v[212:215] cbsz:4 abid:4
    v_exp_f32 v143, v159
    v_exp_f32 v144, v160
    v_mfma_f32_4x4x4_16b_bf16 v[212:215], v[208:209], v[192:193], v[212:215] cbsz:4 abid:8
    v_exp_f32 v145, v161
    v_mfma_f32_4x4x4_16b_bf16 v[140:143], v[228:229], v[228:229], v[140:143]
    v_mfma_f32_4x4x4_16b_bf16 v[212:215], v[208:209], v[194:195], v[212:215] cbsz:4 abid:12
    ds_read_u8 v230, v237 offset:96
    ds_read_u8 v232, v237 offset:104
    ds_read_b64_tr_b16 v[188:189], v236 offset:4160
    ds_read_b64_tr_b16 v[190:191], v236 offset:4672
    ds_read_b64_tr_b16 v[192:193], v236 offset:5216
    ds_read_b64_tr_b16 v[194:195], v236 offset:5728
    s_waitcnt vmcnt(4)
    ds_read_b128 v[180:183], v234 offset:6240
    ds_read_b128 v[184:187], v235 offset:6240
    s_add_u32 m0, s52, 4160
    v_exp_f32 v146, v162
    v_exp_f32 v147, v163
    v_rcp_f32 v132, v132
    v_rcp_f32 v133, v133
    v_mfma_f32_4x4x4_16b_bf16 v[144:147], v[228:229], v[228:229], v[144:147]
    v_rcp_f32 v134, v134
    v_cvt_pk_bf16_f32 v132, v132, v133
    s_waitcnt lgkmcnt(2)
    buffer_load_dwordx4 v[230:231], s[20:23], s35 idxen offen sc1 nt lds
    buffer_load_dwordx4 v[232:233], s[40:43], s35 idxen offen offset:1056 sc1 nt lds
    s_waitcnt lgkmcnt(0)
    v_mfma_f32_16x16x32_bf16 v[148:151], v[100:103], v[180:183], v[164:167]
    v_rcp_f32 v135, v135
    v_mfma_f32_16x16x32_bf16 v[152:155], v[108:111], v[180:183], v[168:171]
    v_rcp_f32 v136, v136
    v_cvt_pk_bf16_f32 v133, v134, v135
    v_mfma_f32_16x16x32_bf16 v[148:151], v[104:107], v[184:187], v[148:151]
    v_rcp_f32 v137, v137
    v_mfma_f32_16x16x32_bf16 v[152:155], v[112:115], v[184:187], v[152:155]
    v_rcp_f32 v138, v138
    v_cvt_pk_bf16_f32 v134, v136, v137
    v_mfma_f32_16x16x32_bf16 v[156:159], v[116:119], v[180:183], v[172:175]
    v_rcp_f32 v139, v139
    v_mfma_f32_16x16x32_bf16 v[160:163], v[124:127], v[180:183], v[176:179]
    v_rcp_f32 v140, v140
    v_cvt_pk_bf16_f32 v135, v138, v139
    v_mfma_f32_16x16x32_bf16 v[156:159], v[120:123], v[184:187], v[156:159]
    v_rcp_f32 v141, v141
    v_mfma_f32_16x16x32_bf16 v[160:163], v[128:131], v[184:187], v[160:163]
    v_rcp_f32 v142, v142
    v_cvt_pk_bf16_f32 v136, v140, v141
    v_mfma_f32_16x16x32_bf16 v[208:211], v[132:135], v[196:199], v[204:207]
    v_rcp_f32 v143, v143
    v_rcp_f32 v144, v144
    v_cvt_pk_bf16_f32 v137, v142, v143
    v_rcp_f32 v145, v145
    v_rcp_f32 v146, v146
    v_rcp_f32 v147, v147
    v_cvt_pk_bf16_f32 v138, v144, v145
    v_cvt_pk_bf16_f32 v139, v146, v147
    s_bitcmp1_b32 s36, 3
    s_cbranch_scc1 Ls_ev3
Ls_evd3:
    v_mfma_f32_16x16x32_bf16 v[208:211], v[136:139], v[200:203], v[208:211]
    ds_read_b32 v246, v244 offset:48
    s_waitcnt lgkmcnt(0)
    v_bfe_u32 v247, v246, 0, 8
    v_lshlrev_b32 v247, 1, v247
    v_bfe_u32 v248, v246, 8, 8
    v_lshlrev_b32 v248, 1, v248
    v_bfe_u32 v249, v246, 16, 8
    v_lshlrev_b32 v249, 1, v249
    v_bfe_u32 v250, v246, 24, 8
    v_lshlrev_b32 v250, 1, v250
    buffer_load_ushort v247, v247, s[24:27], 0 offen
    buffer_load_ushort v248, v248, s[24:27], 0 offen
    buffer_load_ushort v249, v249, s[24:27], 0 offen
    buffer_load_ushort v250, v250, s[24:27], 0 offen
    s_waitcnt vmcnt(0)
    v_lshlrev_b32 v247, 16, v247
    v_mul_f32 v208, v208, v247
    v_lshlrev_b32 v248, 16, v248
    v_mul_f32 v209, v209, v248
    v_lshlrev_b32 v249, 16, v249
    v_mul_f32 v210, v210, v249
    v_lshlrev_b32 v250, 16, v250
    v_mul_f32 v211, v211, v250
    v_exp_f32 v132, v148
    v_exp_f32 v133, v149
    v_exp_f32 v134, v150
    v_exp_f32 v135, v151
    v_exp_f32 v136, v152
    v_exp_f32 v137, v153
    v_mfma_f32_4x4x4_16b_bf16 v[132:135], v[228:229], v[228:229], v[132:135]
    v_exp_f32 v138, v154
    v_exp_f32 v139, v155
    v_cvt_pk_bf16_f32 v208, v208, v209
    v_cvt_pk_bf16_f32 v209, v210, v211
    v_exp_f32 v140, v156
    v_exp_f32 v141, v157
    v_mfma_f32_4x4x4_16b_bf16 v[212:215], v[208:209], v[188:189], v[212:215] cbsz:4 abid:0
    v_mfma_f32_4x4x4_16b_bf16 v[136:139], v[228:229], v[228:229], v[136:139]
    v_exp_f32 v142, v158
    v_mfma_f32_4x4x4_16b_bf16 v[212:215], v[208:209], v[190:191], v[212:215] cbsz:4 abid:4
    v_exp_f32 v143, v159
    v_exp_f32 v144, v160
    v_mfma_f32_4x4x4_16b_bf16 v[212:215], v[208:209], v[192:193], v[212:215] cbsz:4 abid:8
    v_exp_f32 v145, v161
    v_mfma_f32_4x4x4_16b_bf16 v[140:143], v[228:229], v[228:229], v[140:143]
    v_mfma_f32_4x4x4_16b_bf16 v[212:215], v[208:209], v[194:195], v[212:215] cbsz:4 abid:12
    ds_read_u8 v230, v237 offset:112
    ds_read_u8 v232, v237 offset:120
    ds_read_b64_tr_b16 v[188:189], v236 offset:6240
    ds_read_b64_tr_b16 v[190:191], v236 offset:6752
    ds_read_b64_tr_b16 v[192:193], v236 offset:7296
    ds_read_b64_tr_b16 v[194:195], v236 offset:7808
    s_waitcnt vmcnt(4)
    ds_read_b128 v[180:183], v234 offset:0
    ds_read_b128 v[184:187], v235 offset:0
    s_add_u32 m0, s52, 6240
    v_exp_f32 v146, v162
    v_exp_f32 v147, v163
    v_rcp_f32 v132, v132
    v_rcp_f32 v133, v133
    v_mfma_f32_4x4x4_16b_bf16 v[144:147], v[228:229], v[228:229], v[144:147]
    v_rcp_f32 v134, v134
    v_cvt_pk_bf16_f32 v132, v132, v133
    s_waitcnt lgkmcnt(2)
    buffer_load_dwordx4 v[230:231], s[20:23], s35 idxen offen sc1 nt lds
    buffer_load_dwordx4 v[232:233], s[40:43], s35 idxen offen offset:1056 sc1 nt lds
    s_waitcnt lgkmcnt(0)
    v_mfma_f32_16x16x32_bf16 v[148:151], v[100:103], v[180:183], v[164:167]
    v_rcp_f32 v135, v135
    v_mfma_f32_16x16x32_bf16 v[152:155], v[108:111], v[180:183], v[168:171]
    v_rcp_f32 v136, v136
    v_cvt_pk_bf16_f32 v133, v134, v135
    v_mfma_f32_16x16x32_bf16 v[148:151], v[104:107], v[184:187], v[148:151]
    v_rcp_f32 v137, v137
    v_mfma_f32_16x16x32_bf16 v[152:155], v[112:115], v[184:187], v[152:155]
    v_rcp_f32 v138, v138
    v_cvt_pk_bf16_f32 v134, v136, v137
    v_mfma_f32_16x16x32_bf16 v[156:159], v[116:119], v[180:183], v[172:175]
    v_rcp_f32 v139, v139
    v_mfma_f32_16x16x32_bf16 v[160:163], v[124:127], v[180:183], v[176:179]
    v_rcp_f32 v140, v140
    v_cvt_pk_bf16_f32 v135, v138, v139
    v_mfma_f32_16x16x32_bf16 v[156:159], v[120:123], v[184:187], v[156:159]
    v_rcp_f32 v141, v141
    v_mfma_f32_16x16x32_bf16 v[160:163], v[128:131], v[184:187], v[160:163]
    v_rcp_f32 v142, v142
    v_cvt_pk_bf16_f32 v136, v140, v141
    v_mfma_f32_16x16x32_bf16 v[208:211], v[132:135], v[196:199], v[204:207]
    v_rcp_f32 v143, v143
    v_rcp_f32 v144, v144
    v_cvt_pk_bf16_f32 v137, v142, v143
    s_lshr_b64 s[56:57], s[56:57], 4
    s_lshr_b64 s[86:87], s[56:57], 2
    s_lshr_b64 s[36:37], s[56:57], 5
    s_or_b32 s37, s36, s86
    s_or_b32 s36, s37, s56
    v_add_u32 v237, 64, v237
    v_add_u32 v244, 64, v244
    v_rcp_f32 v145, v145
    v_rcp_f32 v146, v146
    v_rcp_f32 v147, v147
    v_cvt_pk_bf16_f32 v138, v144, v145
    v_cvt_pk_bf16_f32 v139, v146, v147
    s_branch Ls_loop
Ls_fl0:
    v_cvt_pk_bf16_f32 v246, v212, v212
    v_mov_b32 v212, 0
    ds_write_b16 v240, v246
    v_add_u32 v240, 128, v240
    s_add_u32 s24, s24, s32
    s_addc_u32 s25, s25, 0
    s_xor_b32 s32, s32, 0x18ffe0
    s_bitcmp0_b32 s37, 0
    s_cbranch_scc1 Ls_evd0
    s_branch Ls_ev20
Ls_ev0:
    s_bitcmp1_b64 s[56:57], 0
    s_cbranch_scc1 Ls_fl0
Ls_ev20:
    s_bitcmp1_b64 s[56:57], 2
    s_cbranch_scc1 Ls_w0
    s_sub_u32 s60, s60, 1
    s_cbranch_scc0 Ls_nsa0
    s_mov_b32 s49, 5
    s_call_b64 s[62:63], L_swap
Ls_nsa0:
    s_add_u32 s35, s35, s31
    s_min_u32 s35, s35, 419404800
    s_xor_b32 s31, s31, 0x63ff800
    s_branch Ls_evd0
Ls_w0:
    s_bitcmp0_b64 s[56:57], 5
    s_cbranch_scc1 Ls_e10
    s_sub_u32 s60, s60, 1
    s_cbranch_scc0 Ls_nsb0
    s_mov_b32 s49, 5
    s_call_b64 s[62:63], L_swap
    s_waitcnt lgkmcnt(0)
Ls_nsb0:
    s_add_u32 s35, s35, s31
    s_min_u32 s35, s35, 419404800
    s_xor_b32 s31, s31, 0x63ff800
Ls_e10:
    s_sub_u32 s61, s61, 1
    s_cbranch_scc1 Ls_last0
    s_bitcmp0_b32 s33, s61
    s_cbranch_scc1 Ls_nw0
    s_cmp_eq_u32 s61, 3
    s_cselect_b32 s66, s80, s81
    v_add_u32 v238, s66, v238
    v_add_u32 v239, s66, v239
    ds_read_u16 v224, v238 offset:0
    ds_read_u16 v225, v238 offset:8
    ds_read_u16 v226, v238 offset:64
    ds_read_u16 v227, v238 offset:72
    s_waitcnt lgkmcnt(0)
Ls_nw0:
    v_mul_u32_u24 v216, v224, v241
    v_mul_u32_u24 v217, v224, v242
    v_mul_u32_u24 v218, v225, v241
    v_mul_u32_u24 v219, v225, v242
    v_mul_u32_u24 v220, v226, v241
    v_mul_u32_u24 v221, v226, v242
    v_mul_u32_u24 v222, v227, v241
    v_mul_u32_u24 v223, v227, v242
    v_mfma_f32_4x4x4_16b_bf16 v[140:143], v[216:217], v[68:69], v[4:7]
    v_add_u32 v238, 128, v238
    ds_read_b128 v[164:167], v239 offset:0
    ds_read_b128 v[168:171], v239 offset:64
    v_mfma_f32_4x4x4_16b_bf16 v[144:147], v[218:219], v[70:71], v[8:11]
    ds_read_b128 v[172:175], v239 offset:128
    ds_read_b128 v[176:179], v239 offset:192
    ds_read_u16 v224, v238 offset:0
    ds_read_u16 v225, v238 offset:8
    ds_read_u16 v226, v238 offset:64
    ds_read_u16 v227, v238 offset:72
    v_mfma_f32_4x4x4_16b_bf16 v[246:249], v[220:221], v[72:73], v[12:15]
    v_cvt_pk_bf16_f32 v100, v140, v141
    v_cvt_pk_bf16_f32 v101, v142, v143
    v_mfma_f32_4x4x4_16b_bf16 v[250:253], v[222:223], v[74:75], v[16:19]
    v_cvt_pk_bf16_f32 v102, v144, v145
    v_cvt_pk_bf16_f32 v103, v146, v147
    v_mfma_f32_4x4x4_16b_bf16 v[140:143], v[216:217], v[76:77], v[20:23]
    v_cvt_pk_bf16_f32 v104, v246, v247
    v_cvt_pk_bf16_f32 v105, v248, v249
    v_mfma_f32_4x4x4_16b_bf16 v[144:147], v[218:219], v[78:79], v[24:27]
    v_cvt_pk_bf16_f32 v106, v250, v251
    v_cvt_pk_bf16_f32 v107, v252, v253
    v_mfma_f32_4x4x4_16b_bf16 v[246:249], v[220:221], v[80:81], v[28:31]
    v_cvt_pk_bf16_f32 v108, v140, v141
    v_cvt_pk_bf16_f32 v109, v142, v143
    v_mfma_f32_4x4x4_16b_bf16 v[250:253], v[222:223], v[82:83], v[32:35]
    v_cvt_pk_bf16_f32 v110, v144, v145
    v_cvt_pk_bf16_f32 v111, v146, v147
    v_mfma_f32_4x4x4_16b_bf16 v[140:143], v[216:217], v[84:85], v[36:39]
    v_cvt_pk_bf16_f32 v112, v246, v247
    v_cvt_pk_bf16_f32 v113, v248, v249
    v_mfma_f32_4x4x4_16b_bf16 v[144:147], v[218:219], v[86:87], v[40:43]
    v_cvt_pk_bf16_f32 v114, v250, v251
    v_cvt_pk_bf16_f32 v115, v252, v253
    v_mfma_f32_4x4x4_16b_bf16 v[246:249], v[220:221], v[88:89], v[44:47]
    v_cvt_pk_bf16_f32 v116, v140, v141
    v_cvt_pk_bf16_f32 v117, v142, v143
    v_mfma_f32_4x4x4_16b_bf16 v[250:253], v[222:223], v[90:91], v[48:51]
    v_cvt_pk_bf16_f32 v118, v144, v145
    v_cvt_pk_bf16_f32 v119, v146, v147
    v_mfma_f32_4x4x4_16b_bf16 v[140:143], v[216:217], v[92:93], v[52:55]
    v_cvt_pk_bf16_f32 v120, v246, v247
    v_cvt_pk_bf16_f32 v121, v248, v249
    v_mfma_f32_4x4x4_16b_bf16 v[144:147], v[218:219], v[94:95], v[56:59]
    v_cvt_pk_bf16_f32 v122, v250, v251
    v_cvt_pk_bf16_f32 v123, v252, v253
    v_mfma_f32_4x4x4_16b_bf16 v[246:249], v[220:221], v[96:97], v[60:63]
    v_cvt_pk_bf16_f32 v124, v140, v141
    v_cvt_pk_bf16_f32 v125, v142, v143
    v_mfma_f32_4x4x4_16b_bf16 v[250:253], v[222:223], v[98:99], v[64:67]
    v_cvt_pk_bf16_f32 v126, v144, v145
    v_cvt_pk_bf16_f32 v127, v146, v147
    v_cvt_pk_bf16_f32 v128, v246, v247
    v_cvt_pk_bf16_f32 v129, v248, v249
    v_add_u32 v239, 272, v239
    v_cvt_pk_bf16_f32 v130, v250, v251
    v_cvt_pk_bf16_f32 v131, v252, v253
    s_waitcnt lgkmcnt(0)
    s_branch Ls_evd0
Ls_fl1:
    v_cvt_pk_bf16_f32 v246, v212, v212
    v_mov_b32 v212, 0
    ds_write_b16 v240, v246
    v_add_u32 v240, 128, v240
    s_add_u32 s24, s24, s32
    s_addc_u32 s25, s25, 0
    s_xor_b32 s32, s32, 0x18ffe0
    s_bitcmp0_b32 s37, 1
    s_cbranch_scc1 Ls_evd1
    s_branch Ls_ev21
Ls_ev1:
    s_bitcmp1_b64 s[56:57], 1
    s_cbranch_scc1 Ls_fl1
Ls_ev21:
    s_bitcmp1_b64 s[56:57], 3
    s_cbranch_scc1 Ls_w1
    s_sub_u32 s60, s60, 1
    s_cbranch_scc0 Ls_nsa1
    s_mov_b32 s49, 6
    s_call_b64 s[62:63], L_swap
Ls_nsa1:
    s_add_u32 s35, s35, s31
    s_min_u32 s35, s35, 419404800
    s_xor_b32 s31, s31, 0x63ff800
    s_branch Ls_evd1
Ls_w1:
    s_bitcmp0_b64 s[56:57], 6
    s_cbranch_scc1 Ls_e11
    s_sub_u32 s60, s60, 1
    s_cbranch_scc0 Ls_nsb1
    s_mov_b32 s49, 6
    s_call_b64 s[62:63], L_swap
    s_waitcnt lgkmcnt(0)
Ls_nsb1:
    s_add_u32 s35, s35, s31
    s_min_u32 s35, s35, 419404800
    s_xor_b32 s31, s31, 0x63ff800
Ls_e11:
    s_sub_u32 s61, s61, 1
    s_cbranch_scc1 Ls_last1
    s_bitcmp0_b32 s33, s61
    s_cbranch_scc1 Ls_nw1
    s_cmp_eq_u32 s61, 3
    s_cselect_b32 s66, s80, s81
    v_add_u32 v238, s66, v238
    v_add_u32 v239, s66, v239
    ds_read_u16 v224, v238 offset:0
    ds_read_u16 v225, v238 offset:8
    ds_read_u16 v226, v238 offset:64
    ds_read_u16 v227, v238 offset:72
    s_waitcnt lgkmcnt(0)
Ls_nw1:
    v_mul_u32_u24 v216, v224, v241
    v_mul_u32_u24 v217, v224, v242
    v_mul_u32_u24 v218, v225, v241
    v_mul_u32_u24 v219, v225, v242
    v_mul_u32_u24 v220, v226, v241
    v_mul_u32_u24 v221, v226, v242
    v_mul_u32_u24 v222, v227, v241
    v_mul_u32_u24 v223, v227, v242
    v_mfma_f32_4x4x4_16b_bf16 v[140:143], v[216:217], v[68:69], v[4:7]
    v_add_u32 v238, 128, v238
    ds_read_b128 v[164:167], v239 offset:0
    ds_read_b128 v[168:171], v239 offset:64
    v_mfma_f32_4x4x4_16b_bf16 v[144:147], v[218:219], v[70:71], v[8:11]
    ds_read_b128 v[172:175], v239 offset:128
    ds_read_b128 v[176:179], v239 offset:192
    ds_read_u16 v224, v238 offset:0
    ds_read_u16 v225, v238 offset:8
    ds_read_u16 v226, v238 offset:64
    ds_read_u16 v227, v238 offset:72
    v_mfma_f32_4x4x4_16b_bf16 v[246:249], v[220:221], v[72:73], v[12:15]
    v_cvt_pk_bf16_f32 v100, v140, v141
    v_cvt_pk_bf16_f32 v101, v142, v143
    v_mfma_f32_4x4x4_16b_bf16 v[250:253], v[222:223], v[74:75], v[16:19]
    v_cvt_pk_bf16_f32 v102, v144, v145
    v_cvt_pk_bf16_f32 v103, v146, v147
    v_mfma_f32_4x4x4_16b_bf16 v[140:143], v[216:217], v[76:77], v[20:23]
    v_cvt_pk_bf16_f32 v104, v246, v247
    v_cvt_pk_bf16_f32 v105, v248, v249
    v_mfma_f32_4x4x4_16b_bf16 v[144:147], v[218:219], v[78:79], v[24:27]
    v_cvt_pk_bf16_f32 v106, v250, v251
    v_cvt_pk_bf16_f32 v107, v252, v253
    v_mfma_f32_4x4x4_16b_bf16 v[246:249], v[220:221], v[80:81], v[28:31]
    v_cvt_pk_bf16_f32 v108, v140, v141
    v_cvt_pk_bf16_f32 v109, v142, v143
    v_mfma_f32_4x4x4_16b_bf16 v[250:253], v[222:223], v[82:83], v[32:35]
    v_cvt_pk_bf16_f32 v110, v144, v145
    v_cvt_pk_bf16_f32 v111, v146, v147
    v_mfma_f32_4x4x4_16b_bf16 v[140:143], v[216:217], v[84:85], v[36:39]
    v_cvt_pk_bf16_f32 v112, v246, v247
    v_cvt_pk_bf16_f32 v113, v248, v249
    v_mfma_f32_4x4x4_16b_bf16 v[144:147], v[218:219], v[86:87], v[40:43]
    v_cvt_pk_bf16_f32 v114, v250, v251
    v_cvt_pk_bf16_f32 v115, v252, v253
    v_mfma_f32_4x4x4_16b_bf16 v[246:249], v[220:221], v[88:89], v[44:47]
    v_cvt_pk_bf16_f32 v116, v140, v141
    v_cvt_pk_bf16_f32 v117, v142, v143
    v_mfma_f32_4x4x4_16b_bf16 v[250:253], v[222:223], v[90:91], v[48:51]
    v_cvt_pk_bf16_f32 v118, v144, v145
    v_cvt_pk_bf16_f32 v119, v146, v147
    v_mfma_f32_4x4x4_16b_bf16 v[140:143], v[216:217], v[92:93], v[52:55]
    v_cvt_pk_bf16_f32 v120, v246, v247
    v_cvt_pk_bf16_f32 v121, v248, v249
    v_mfma_f32_4x4x4_16b_bf16 v[144:147], v[218:219], v[94:95], v[56:59]
    v_cvt_pk_bf16_f32 v122, v250, v251
    v_cvt_pk_bf16_f32 v123, v252, v253
    v_mfma_f32_4x4x4_16b_bf16 v[246:249], v[220:221], v[96:97], v[60:63]
    v_cvt_pk_bf16_f32 v124, v140, v141
    v_cvt_pk_bf16_f32 v125, v142, v143
    v_mfma_f32_4x4x4_16b_bf16 v[250:253], v[222:223], v[98:99], v[64:67]
    v_cvt_pk_bf16_f32 v126, v144, v145
    v_cvt_pk_bf16_f32 v127, v146, v147
    v_cvt_pk_bf16_f32 v128, v246, v247
    v_cvt_pk_bf16_f32 v129, v248, v249
    v_add_u32 v239, 272, v239
    v_cvt_pk_bf16_f32 v130, v250, v251
    v_cvt_pk_bf16_f32 v131, v252, v253
    s_waitcnt lgkmcnt(0)
    s_branch Ls_evd1
Ls_fl2:
    v_cvt_pk_bf16_f32 v246, v212, v212
    v_mov_b32 v212, 0
    ds_write_b16 v240, v246
    v_add_u32 v240, 128, v240
    s_add_u32 s24, s24, s32
    s_addc_u32 s25, s25, 0
    s_xor_b32 s32, s32, 0x18ffe0
    s_bitcmp0_b32 s37, 2
    s_cbranch_scc1 Ls_evd2
    s_branch Ls_ev22
Ls_ev2:
    s_bitcmp1_b64 s[56:57], 2
    s_cbranch_scc1 Ls_fl2
Ls_ev22:
    s_bitcmp1_b64 s[56:57], 4
    s_cbranch_scc1 Ls_w2
    s_sub_u32 s60, s60, 1
    s_cbranch_scc0 Ls_nsa2
    s_mov_b32 s49, 7
    s_call_b64 s[62:63], L_swap
Ls_nsa2:
    s_add_u32 s35, s35, s31
    s_min_u32 s35, s35, 419404800
    s_xor_b32 s31, s31, 0x63ff800
    s_branch Ls_evd2
Ls_w2:
    s_bitcmp0_b64 s[56:57], 7
    s_cbranch_scc1 Ls_e12
    s_sub_u32 s60, s60, 1
    s_cbranch_scc0 Ls_nsb2
    s_mov_b32 s49, 7
    s_call_b64 s[62:63], L_swap
    s_waitcnt lgkmcnt(0)
Ls_nsb2:
    s_add_u32 s35, s35, s31
    s_min_u32 s35, s35, 419404800
    s_xor_b32 s31, s31, 0x63ff800
Ls_e12:
    s_sub_u32 s61, s61, 1
    s_cbranch_scc1 Ls_last2
    s_bitcmp0_b32 s33, s61
    s_cbranch_scc1 Ls_nw2
    s_cmp_eq_u32 s61, 3
    s_cselect_b32 s66, s80, s81
    v_add_u32 v238, s66, v238
    v_add_u32 v239, s66, v239
    ds_read_u16 v224, v238 offset:0
    ds_read_u16 v225, v238 offset:8
    ds_read_u16 v226, v238 offset:64
    ds_read_u16 v227, v238 offset:72
    s_waitcnt lgkmcnt(0)
Ls_nw2:
    v_mul_u32_u24 v216, v224, v241
    v_mul_u32_u24 v217, v224, v242
    v_mul_u32_u24 v218, v225, v241
    v_mul_u32_u24 v219, v225, v242
    v_mul_u32_u24 v220, v226, v241
    v_mul_u32_u24 v221, v226, v242
    v_mul_u32_u24 v222, v227, v241
    v_mul_u32_u24 v223, v227, v242
    v_mfma_f32_4x4x4_16b_bf16 v[140:143], v[216:217], v[68:69], v[4:7]
    v_add_u32 v238, 128, v238
    ds_read_b128 v[164:167], v239 offset:0
    ds_read_b128 v[168:171], v239 offset:64
    v_mfma_f32_4x4x4_16b_bf16 v[144:147], v[218:219], v[70:71], v[8:11]
    ds_read_b128 v[172:175], v239 offset:128
    ds_read_b128 v[176:179], v239 offset:192
    ds_read_u16 v224, v238 offset:0
    ds_read_u16 v225, v238 offset:8
    ds_read_u16 v226, v238 offset:64
    ds_read_u16 v227, v238 offset:72
    v_mfma_f32_4x4x4_16b_bf16 v[246:249], v[220:221], v[72:73], v[12:15]
    v_cvt_pk_bf16_f32 v100, v140, v141
    v_cvt_pk_bf16_f32 v101, v142, v143
    v_mfma_f32_4x4x4_16b_bf16 v[250:253], v[222:223], v[74:75], v[16:19]
    v_cvt_pk_bf16_f32 v102, v144, v145
    v_cvt_pk_bf16_f32 v103, v146, v147
    v_mfma_f32_4x4x4_16b_bf16 v[140:143], v[216:217], v[76:77], v[20:23]
    v_cvt_pk_bf16_f32 v104, v246, v247
    v_cvt_pk_bf16_f32 v105, v248, v249
    v_mfma_f32_4x4x4_16b_bf16 v[144:147], v[218:219], v[78:79], v[24:27]
    v_cvt_pk_bf16_f32 v106, v250, v251
    v_cvt_pk_bf16_f32 v107, v252, v253
    v_mfma_f32_4x4x4_16b_bf16 v[246:249], v[220:221], v[80:81], v[28:31]
    v_cvt_pk_bf16_f32 v108, v140, v141
    v_cvt_pk_bf16_f32 v109, v142, v143
    v_mfma_f32_4x4x4_16b_bf16 v[250:253], v[222:223], v[82:83], v[32:35]
    v_cvt_pk_bf16_f32 v110, v144, v145
    v_cvt_pk_bf16_f32 v111, v146, v147
    v_mfma_f32_4x4x4_16b_bf16 v[140:143], v[216:217], v[84:85], v[36:39]
    v_cvt_pk_bf16_f32 v112, v246, v247
    v_cvt_pk_bf16_f32 v113, v248, v249
    v_mfma_f32_4x4x4_16b_bf16 v[144:147], v[218:219], v[86:87], v[40:43]
    v_cvt_pk_bf16_f32 v114, v250, v251
    v_cvt_pk_bf16_f32 v115, v252, v253
    v_mfma_f32_4x4x4_16b_bf16 v[246:249], v[220:221], v[88:89], v[44:47]
    v_cvt_pk_bf16_f32 v116, v140, v141
    v_cvt_pk_bf16_f32 v117, v142, v143
    v_mfma_f32_4x4x4_16b_bf16 v[250:253], v[222:223], v[90:91], v[48:51]
    v_cvt_pk_bf16_f32 v118, v144, v145
    v_cvt_pk_bf16_f32 v119, v146, v147
    v_mfma_f32_4x4x4_16b_bf16 v[140:143], v[216:217], v[92:93], v[52:55]
    v_cvt_pk_bf16_f32 v120, v246, v247
    v_cvt_pk_bf16_f32 v121, v248, v249
    v_mfma_f32_4x4x4_16b_bf16 v[144:147], v[218:219], v[94:95], v[56:59]
    v_cvt_pk_bf16_f32 v122, v250, v251
    v_cvt_pk_bf16_f32 v123, v252, v253
    v_mfma_f32_4x4x4_16b_bf16 v[246:249], v[220:221], v[96:97], v[60:63]
    v_cvt_pk_bf16_f32 v124, v140, v141
    v_cvt_pk_bf16_f32 v125, v142, v143
    v_mfma_f32_4x4x4_16b_bf16 v[250:253], v[222:223], v[98:99], v[64:67]
    v_cvt_pk_bf16_f32 v126, v144, v145
    v_cvt_pk_bf16_f32 v127, v146, v147
    v_cvt_pk_bf16_f32 v128, v246, v247
    v_cvt_pk_bf16_f32 v129, v248, v249
    v_add_u32 v239, 272, v239
    v_cvt_pk_bf16_f32 v130, v250, v251
    v_cvt_pk_bf16_f32 v131, v252, v253
    s_waitcnt lgkmcnt(0)
    s_branch Ls_evd2
Ls_fl3:
    v_cvt_pk_bf16_f32 v246, v212, v212
    v_mov_b32 v212, 0
    ds_write_b16 v240, v246
    v_add_u32 v240, 128, v240
    s_add_u32 s24, s24, s32
    s_addc_u32 s25, s25, 0
    s_xor_b32 s32, s32, 0x18ffe0
    s_bitcmp0_b32 s37, 3
    s_cbranch_scc1 Ls_evd3
    s_branch Ls_ev23
Ls_ev3:
    s_bitcmp1_b64 s[56:57], 3
    s_cbranch_scc1 Ls_fl3
Ls_ev23:
    s_bitcmp1_b64 s[56:57], 5
    s_cbranch_scc1 Ls_w3
    s_sub_u32 s60, s60, 1
    s_cbranch_scc0 Ls_nsa3
    s_mov_b32 s49, 8
    s_call_b64 s[62:63], L_swap
Ls_nsa3:
    s_add_u32 s35, s35, s31
    s_min_u32 s35, s35, 419404800
    s_xor_b32 s31, s31, 0x63ff800
    s_branch Ls_evd3
Ls_w3:
    s_bitcmp0_b64 s[56:57], 8
    s_cbranch_scc1 Ls_e13
    s_sub_u32 s60, s60, 1
    s_cbranch_scc0 Ls_nsb3
    s_mov_b32 s49, 8
    s_call_b64 s[62:63], L_swap
    s_waitcnt lgkmcnt(0)
Ls_nsb3:
    s_add_u32 s35, s35, s31
    s_min_u32 s35, s35, 419404800
    s_xor_b32 s31, s31, 0x63ff800
Ls_e13:
    s_sub_u32 s61, s61, 1
    s_cbranch_scc1 Ls_last3
    s_bitcmp0_b32 s33, s61
    s_cbranch_scc1 Ls_nw3
    s_cmp_eq_u32 s61, 3
    s_cselect_b32 s66, s80, s81
    v_add_u32 v238, s66, v238
    v_add_u32 v239, s66, v239
    ds_read_u16 v224, v238 offset:0
    ds_read_u16 v225, v238 offset:8
    ds_read_u16 v226, v238 offset:64
    ds_read_u16 v227, v238 offset:72
    s_waitcnt lgkmcnt(0)
Ls_nw3:
    v_mul_u32_u24 v216, v224, v241
    v_mul_u32_u24 v217, v224, v242
    v_mul_u32_u24 v218, v225, v241
    v_mul_u32_u24 v219, v225, v242
    v_mul_u32_u24 v220, v226, v241
    v_mul_u32_u24 v221, v226, v242
    v_mul_u32_u24 v222, v227, v241
    v_mul_u32_u24 v223, v227, v242
    v_mfma_f32_4x4x4_16b_bf16 v[140:143], v[216:217], v[68:69], v[4:7]
    v_add_u32 v238, 128, v238
    ds_read_b128 v[164:167], v239 offset:0
    ds_read_b128 v[168:171], v239 offset:64
    v_mfma_f32_4x4x4_16b_bf16 v[144:147], v[218:219], v[70:71], v[8:11]
    ds_read_b128 v[172:175], v239 offset:128
    ds_read_b128 v[176:179], v239 offset:192
    ds_read_u16 v224, v238 offset:0
    ds_read_u16 v225, v238 offset:8
    ds_read_u16 v226, v238 offset:64
    ds_read_u16 v227, v238 offset:72
    v_mfma_f32_4x4x4_16b_bf16 v[246:249], v[220:221], v[72:73], v[12:15]
    v_cvt_pk_bf16_f32 v100, v140, v141
    v_cvt_pk_bf16_f32 v101, v142, v143
    v_mfma_f32_4x4x4_16b_bf16 v[250:253], v[222:223], v[74:75], v[16:19]
    v_cvt_pk_bf16_f32 v102, v144, v145
    v_cvt_pk_bf16_f32 v103, v146, v147
    v_mfma_f32_4x4x4_16b_bf16 v[140:143], v[216:217], v[76:77], v[20:23]
    v_cvt_pk_bf16_f32 v104, v246, v247
    v_cvt_pk_bf16_f32 v105, v248, v249
    v_mfma_f32_4x4x4_16b_bf16 v[144:147], v[218:219], v[78:79], v[24:27]
    v_cvt_pk_bf16_f32 v106, v250, v251
    v_cvt_pk_bf16_f32 v107, v252, v253
    v_mfma_f32_4x4x4_16b_bf16 v[246:249], v[220:221], v[80:81], v[28:31]
    v_cvt_pk_bf16_f32 v108, v140, v141
    v_cvt_pk_bf16_f32 v109, v142, v143
    v_mfma_f32_4x4x4_16b_bf16 v[250:253], v[222:223], v[82:83], v[32:35]
    v_cvt_pk_bf16_f32 v110, v144, v145
    v_cvt_pk_bf16_f32 v111, v146, v147
    v_mfma_f32_4x4x4_16b_bf16 v[140:143], v[216:217], v[84:85], v[36:39]
    v_cvt_pk_bf16_f32 v112, v246, v247
    v_cvt_pk_bf16_f32 v113, v248, v249
    v_mfma_f32_4x4x4_16b_bf16 v[144:147], v[218:219], v[86:87], v[40:43]
    v_cvt_pk_bf16_f32 v114, v250, v251
    v_cvt_pk_bf16_f32 v115, v252, v253
    v_mfma_f32_4x4x4_16b_bf16 v[246:249], v[220:221], v[88:89], v[44:47]
    v_cvt_pk_bf16_f32 v116, v140, v141
    v_cvt_pk_bf16_f32 v117, v142, v143
    v_mfma_f32_4x4x4_16b_bf16 v[250:253], v[222:223], v[90:91], v[48:51]
    v_cvt_pk_bf16_f32 v118, v144, v145
    v_cvt_pk_bf16_f32 v119, v146, v147
    v_mfma_f32_4x4x4_16b_bf16 v[140:143], v[216:217], v[92:93], v[52:55]
    v_cvt_pk_bf16_f32 v120, v246, v247
    v_cvt_pk_bf16_f32 v121, v248, v249
    v_mfma_f32_4x4x4_16b_bf16 v[144:147], v[218:219], v[94:95], v[56:59]
    v_cvt_pk_bf16_f32 v122, v250, v251
    v_cvt_pk_bf16_f32 v123, v252, v253
    v_mfma_f32_4x4x4_16b_bf16 v[246:249], v[220:221], v[96:97], v[60:63]
    v_cvt_pk_bf16_f32 v124, v140, v141
    v_cvt_pk_bf16_f32 v125, v142, v143
    v_mfma_f32_4x4x4_16b_bf16 v[250:253], v[222:223], v[98:99], v[64:67]
    v_cvt_pk_bf16_f32 v126, v144, v145
    v_cvt_pk_bf16_f32 v127, v146, v147
    v_cvt_pk_bf16_f32 v128, v246, v247
    v_cvt_pk_bf16_f32 v129, v248, v249
    v_add_u32 v239, 272, v239
    v_cvt_pk_bf16_f32 v130, v250, v251
    v_cvt_pk_bf16_f32 v131, v252, v253
    s_waitcnt lgkmcnt(0)
    s_branch Ls_evd3
Ls_last0:
    s_branch Ls_tail
Ls_last1:
    v_add_u32 v236, 2080, v236
    s_lshr_b64 s[56:57], s[56:57], 1
    v_add_u32 v244, 16, v244
    s_branch Ls_tail
Ls_last2:
    v_add_u32 v236, 4160, v236
    s_lshr_b64 s[56:57], s[56:57], 2
    v_add_u32 v244, 32, v244
    s_branch Ls_tail
Ls_last3:
    v_add_u32 v236, 6240, v236
    s_lshr_b64 s[56:57], s[56:57], 3
    v_add_u32 v244, 48, v244
Ls_tail:
    v_mfma_f32_16x16x32_bf16 v[208:211], v[136:139], v[200:203], v[208:211]
    ds_read_b32 v246, v244 offset:0
    s_waitcnt lgkmcnt(0)
    v_bfe_u32 v247, v246, 0, 8
    v_lshlrev_b32 v247, 1, v247
    v_bfe_u32 v248, v246, 8, 8
    v_lshlrev_b32 v248, 1, v248
    v_bfe_u32 v249, v246, 16, 8
    v_lshlrev_b32 v249, 1, v249
    v_bfe_u32 v250, v246, 24, 8
    v_lshlrev_b32 v250, 1, v250
    buffer_load_ushort v247, v247, s[24:27], 0 offen
    buffer_load_ushort v248, v248, s[24:27], 0 offen
    buffer_load_ushort v249, v249, s[24:27], 0 offen
    buffer_load_ushort v250, v250, s[24:27], 0 offen
    s_waitcnt vmcnt(0)
    v_lshlrev_b32 v247, 16, v247
    v_mul_f32 v208, v208, v247
    v_lshlrev_b32 v248, 16, v248
    v_mul_f32 v209, v209, v248
    v_lshlrev_b32 v249, 16, v249
    v_mul_f32 v210, v210, v249
    v_lshlrev_b32 v250, 16, v250
    v_mul_f32 v211, v211, v250
    v_exp_f32 v132, v148
    v_exp_f32 v133, v149
    v_exp_f32 v134, v150
    v_exp_f32 v135, v151
    v_exp_f32 v136, v152
    v_exp_f32 v137, v153
    v_mfma_f32_4x4x4_16b_bf16 v[132:135], v[228:229], v[228:229], v[132:135]
    v_exp_f32 v138, v154
    v_exp_f32 v139, v155
    v_cvt_pk_bf16_f32 v208, v208, v209
    v_cvt_pk_bf16_f32 v209, v210, v211
    v_exp_f32 v140, v156
    v_exp_f32 v141, v157
    v_mfma_f32_4x4x4_16b_bf16 v[212:215], v[208:209], v[188:189], v[212:215] cbsz:4 abid:0
    v_mfma_f32_4x4x4_16b_bf16 v[136:139], v[228:229], v[228:229], v[136:139]
    v_exp_f32 v142, v158
    v_mfma_f32_4x4x4_16b_bf16 v[212:215], v[208:209], v[190:191], v[212:215] cbsz:4 abid:4
    v_exp_f32 v143, v159
    v_exp_f32 v144, v160
    v_mfma_f32_4x4x4_16b_bf16 v[212:215], v[208:209], v[192:193], v[212:215] cbsz:4 abid:8
    v_exp_f32 v145, v161
    v_mfma_f32_4x4x4_16b_bf16 v[140:143], v[228:229], v[228:229], v[140:143]
    v_mfma_f32_4x4x4_16b_bf16 v[212:215], v[208:209], v[194:195], v[212:215] cbsz:4 abid:12
    ds_read_b64_tr_b16 v[188:189], v236 offset:0
    ds_read_b64_tr_b16 v[190:191], v236 offset:512
    ds_read_b64_tr_b16 v[192:193], v236 offset:1056
    ds_read_b64_tr_b16 v[194:195], v236 offset:1568
    v_exp_f32 v146, v162
    v_exp_f32 v147, v163
    v_rcp_f32 v132, v132
    v_rcp_f32 v133, v133
    v_mfma_f32_4x4x4_16b_bf16 v[144:147], v[228:229], v[228:229], v[144:147]
    v_rcp_f32 v134, v134
    s_bitcmp0_b64 s[56:57], 1
    s_cbranch_scc1 Ls_tnf
    v_cvt_pk_bf16_f32 v246, v212, v212
    v_mov_b32 v212, 0
    ds_write_b16 v240, v246
    v_add_u32 v240, 128, v240
    s_add_u32 s24, s24, s32
    s_addc_u32 s25, s25, 0
    s_xor_b32 s32, s32, 0x18ffe0
Ls_tnf:
    v_cvt_pk_bf16_f32 v132, v132, v133
    s_waitcnt lgkmcnt(0)
    v_rcp_f32 v135, v135
    v_rcp_f32 v136, v136
    v_cvt_pk_bf16_f32 v133, v134, v135
    v_rcp_f32 v137, v137
    v_rcp_f32 v138, v138
    v_cvt_pk_bf16_f32 v134, v136, v137
    v_rcp_f32 v139, v139
    v_rcp_f32 v140, v140
    v_cvt_pk_bf16_f32 v135, v138, v139
    v_rcp_f32 v141, v141
    v_rcp_f32 v142, v142
    v_cvt_pk_bf16_f32 v136, v140, v141
    v_mfma_f32_16x16x32_bf16 v[208:211], v[132:135], v[196:199], v[204:207]
    v_rcp_f32 v143, v143
    v_rcp_f32 v144, v144
    v_cvt_pk_bf16_f32 v137, v142, v143
    v_rcp_f32 v145, v145
    v_rcp_f32 v146, v146
    v_rcp_f32 v147, v147
    v_cvt_pk_bf16_f32 v138, v144, v145
    v_cvt_pk_bf16_f32 v139, v146, v147
    s_nop 1
    v_mfma_f32_16x16x32_bf16 v[208:211], v[136:139], v[200:203], v[208:211]
    ds_read_b32 v246, v244 offset:16
    s_waitcnt lgkmcnt(0)
    v_bfe_u32 v247, v246, 0, 8
    v_lshlrev_b32 v247, 1, v247
    v_bfe_u32 v248, v246, 8, 8
    v_lshlrev_b32 v248, 1, v248
    v_bfe_u32 v249, v246, 16, 8
    v_lshlrev_b32 v249, 1, v249
    v_bfe_u32 v250, v246, 24, 8
    v_lshlrev_b32 v250, 1, v250
    buffer_load_ushort v247, v247, s[24:27], 0 offen
    buffer_load_ushort v248, v248, s[24:27], 0 offen
    buffer_load_ushort v249, v249, s[24:27], 0 offen
    buffer_load_ushort v250, v250, s[24:27], 0 offen
    s_waitcnt vmcnt(0)
    v_lshlrev_b32 v247, 16, v247
    v_mul_f32 v208, v208, v247
    v_lshlrev_b32 v248, 16, v248
    v_mul_f32 v209, v209, v248
    v_lshlrev_b32 v249, 16, v249
    v_mul_f32 v210, v210, v249
    v_lshlrev_b32 v250, 16, v250
    v_mul_f32 v211, v211, v250
    v_cvt_pk_bf16_f32 v208, v208, v209
    v_cvt_pk_bf16_f32 v209, v210, v211
    s_nop 1
    v_mfma_f32_4x4x4_16b_bf16 v[212:215], v[208:209], v[188:189], v[212:215] cbsz:4 abid:0
    s_nop 1
    v_mfma_f32_4x4x4_16b_bf16 v[212:215], v[208:209], v[190:191], v[212:215] cbsz:4 abid:4
    s_nop 1
    v_mfma_f32_4x4x4_16b_bf16 v[212:215], v[208:209], v[192:193], v[212:215] cbsz:4 abid:8
    s_nop 1
    v_mfma_f32_4x4x4_16b_bf16 v[212:215], v[208:209], v[194:195], v[212:215] cbsz:4 abid:12
    s_nop 4
    v_cvt_pk_bf16_f32 v246, v212, v212
    ds_write_b16 v240, v246
    s_branch L_store
.section .rodata,"a"
.p2align 6
.amdhsa_kernel standalone__sequential_behavior_din__recsys_kernel
  .amdhsa_next_free_vgpr 256
  .amdhsa_next_free_sgpr 102
  .amdhsa_accum_offset 256
  .amdhsa_group_segment_fixed_size 0
  .amdhsa_kernarg_size 80
  .amdhsa_user_sgpr_count 2
  .amdhsa_user_sgpr_kernarg_segment_ptr 1
  .amdhsa_system_sgpr_workgroup_id_x 1
.end_amdhsa_kernel
```
